```python
import torch

def _softmax(x, axis=-1):
    return torch.softmax(x, dim=axis)
def _gelu(x):
    return torch.nn.functional.gelu(x, approximate="tanh")
def _silu(x):
    return torch.nn.functional.silu(x)
def _sigmoid(x):
    return torch.sigmoid(x)
def _layernorm(x, axis=-1, eps=1e-5):
    m = x.mean(dim=axis, keepdim=True)
    v = x.var(dim=axis, keepdim=True, unbiased=False)
    return (x - m) / torch.sqrt(v + eps)
def _scatter_add(tgt, idx, src, axis=0):
    return tgt.clone().index_add_(axis, idx, src)
def _segment_sum(src, seg, n):
    out = torch.zeros((n,) + src.shape[1:], dtype=src.dtype)
    return out.index_add_(0, seg, src)
def _pad(x, pw):
    flat = tuple(v for pair in reversed(pw) for v in pair)
    return torch.nn.functional.pad(x, flat)

kernel_name = 'sequential_preLN__linear_kernel_hedgehog__moe_arch_mod__prompt'

def setup_inputs():

    _w = (lambda a: (lambda t: t.to(torch.bfloat16) if t.is_floating_point() else t)(torch.as_tensor(a)))
    def _A_setup():
        B, S, D, H = 1, 2048, 1024, 32
        Dh = D // H
        return {
            "x": _w((lambda *s: torch.randn(*s, dtype=torch.bfloat16) * 0.05)(B, S, D)),
            "wqkv": _w((lambda *s: torch.randn(*s, dtype=torch.bfloat16) * 0.2)(D, 3 * D)),
            "w_phi": _w((lambda *s: torch.randn(*s, dtype=torch.bfloat16) * 0.2)(H, Dh, Dh) * (Dh ** -0.5)),
            "wo": _w((lambda *s: torch.randn(*s, dtype=torch.bfloat16) * 0.05)(D, D)),
        }
    _A_in = _A_setup()

    def _B_setup():
        B, S, D, F, C = 1, 2048, 1024, 3584, 1
        return {
            "x": _w((lambda *s: torch.randn(*s, dtype=torch.bfloat16) * 0.05)(B, S, D)),
            "w_r": _w((lambda *s: torch.randn(*s, dtype=torch.bfloat16) * 0.1)(D)),
            "w_gate": _w((lambda *s: torch.randn(*s, dtype=torch.bfloat16) * 0.05)(D, F)),
            "w_up": _w((lambda *s: torch.randn(*s, dtype=torch.bfloat16) * 0.05)(D, F)),
            "w_down": _w((lambda *s: torch.randn(*s, dtype=torch.bfloat16) * 0.05)(F, D)),
        }
    _B_in = _B_setup()

    return {
        "A_x": _A_in["x"],
        "A_wqkv": _A_in["wqkv"],
        "A_w_phi": _A_in["w_phi"],
        "A_wo": _A_in["wo"],
        "B_x": _B_in["x"],
        "B_w_r": _B_in["w_r"],
        "B_w_gate": _B_in["w_gate"],
        "B_w_up": _B_in["w_up"],
        "B_w_down": _B_in["w_down"],
    }

def reference(A_x, A_wqkv, A_w_phi, A_wo, B_x, B_w_r, B_w_gate, B_w_up, B_w_down):
    def _A_ref(x, wqkv, w_phi, wo):
        B, S, D = x.shape
        H = 32; Dh = D // H
        qkv = (lambda x, *d: x.permute(*d))((x @ wqkv).reshape(B, S, 3, H, Dh), 2, 0, 3, 1, 4)
        q, k, v = qkv[0], qkv[1], qkv[2]
        pq = torch.einsum("bhsd,hdf->bhsf", q, w_phi)
        pk = torch.einsum("bhsd,hdf->bhsf", k, w_phi)
        phi_q = torch.concatenate([_softmax(pq, axis=-1), _softmax(-pq, axis=-1)], axis=-1)
        phi_k = torch.concatenate([_softmax(pk, axis=-1), _softmax(-pk, axis=-1)], axis=-1)
        kv = torch.einsum("bhsf,bhsd->bhfd", phi_k, v)
        z  = torch.einsum("bhsf->bhf", phi_k)
        num = torch.einsum("bhqf,bhfd->bhqd", phi_q, kv)
        den = torch.einsum("bhqf,bhf->bhq", phi_q, z)[..., None] + 1e-6
        o = num / den
        return (lambda x, *d: x.permute(*d))(o, 0, 2, 1, 3).reshape(B, S, D) @ wo

    def _B_ref(x, w_r, w_gate, w_up, w_down):
        B, S, D = x.shape
        C = 1
        r = x @ w_r
        idx = torch.argsort(-r, axis=-1)[:, :C]
        idx_e = (lambda x, n, axis: torch.repeat_interleave(x, n, dim=axis))(idx.reshape(B, C, 1), D, axis=2)
        x_sel = (lambda x, i, axis: torch.take_along_dim(x, i, dim=axis))(x, idx_e, axis=1)
        g = _silu(x_sel @ w_gate)
        u = x_sel @ w_up
        y = (g * u) @ w_down
        r_sel = _sigmoid((lambda x, i, axis: torch.take_along_dim(x, i, dim=axis))(r, idx, axis=1))
        y = y * r_sel.reshape(B, C, 1)
        b_off = (torch.arange(B) * S).reshape(B, 1)
        flat_idx = (idx + b_off).reshape(B * C)
        zero = (x * 0.0).reshape(B * S, D)
        upd = _scatter_add(zero, flat_idx, y.reshape(B * C, D), axis=0)
        return x + upd.reshape(B, S, D)

    x = A_x
    h = x + _A_ref(_layernorm(x, axis=-1), A_wqkv, A_w_phi, A_wo)
    h2 = h + _B_ref(_layernorm(h, axis=-1), B_w_r, B_w_gate, B_w_up, B_w_down)
    return h2
```

```asm
; @launch grid=(256,1,1) block=(256,1,1) lds=163840
.amdgcn_target "amdgcn-amd-amdhsa--gfx950"
.text
.globl sequential_preLN__linear_kernel_hedgehog__moe_arch_mod__prompt_kernel
.p2align 8
.type sequential_preLN__linear_kernel_hedgehog__moe_arch_mod__prompt_kernel,@function
sequential_preLN__linear_kernel_hedgehog__moe_arch_mod__prompt_kernel:
    s_cmp_ge_u32 s2, 256
    s_cbranch_scc1 L_end
    s_load_dwordx8 s[4:11], s[0:1], 0
    s_load_dwordx8 s[12:19], s[0:1], 32
    s_load_dwordx8 s[20:27], s[0:1], 64
    v_lshrrev_b32 v4, 6, v0
    v_and_b32 v1, 63, v0
    v_readfirstlane_b32 s62, v4
    s_and_b32 s76, s2, 7
    s_lshr_b32 s77, s2, 3
    s_and_b32 s60, s76, 1
    s_lshl_b32 s60, s60, 3
    s_and_b32 s78, s77, 7
    s_add_u32 s60, s60, s78
    s_lshr_b32 s61, s76, 1
    s_lshl_b32 s61, s61, 2
    s_lshr_b32 s78, s77, 3
    s_add_u32 s61, s61, s78
    s_and_b32 s63, s62, 1
    s_lshr_b32 s64, s62, 1
    s_add_u32 s76, s60, s61
    s_and_b32 s76, s76, 3
    s_mov_b32 s66, 0x65473210
    s_mov_b32 s67, 0xedcfa98b
    s_mov_b32 s70, 0xc653
    s_cmp_eq_u32 s76, 1
    s_cselect_b32 s66, 0x65803241, s66
    s_cselect_b32 s67, 0xfedba9c7, s67
    s_cselect_b32 s70, 0x9c58, s70
    s_cmp_eq_u32 s76, 2
    s_cselect_b32 s66, 0x69410532, s66
    s_cselect_b32 s67, 0xfecbad87, s67
    s_cselect_b32 s70, 0xa643, s70
    s_cmp_eq_u32 s76, 3
    s_cselect_b32 s66, 0xa5426103, s66
    s_cselect_b32 s67, 0xfdcbe987, s67
    s_cselect_b32 s70, 0xb734, s70
    v_lshrrev_b32 v4, 3, v1
    v_and_b32 v5, 7, v1
    v_lshrrev_b32 v6, 4, v1
    s_lshl_b32 s76, s60, 18
    s_lshl_b32 s77, s62, 16
    s_add_u32 s76, s76, s77
    v_xor_b32 v7, v5, v6
    v_lshlrev_b32 v7, 4, v7
    v_lshl_add_u32 v7, v4, 11, v7
    v_add_u32 v152, s76, v7
    v_xor_b32 v7, 64, v152
    v_add_u32 v153, 15360, v7
    v_add_u32 v154, 30720, v152
    v_add_u32 v155, 46080, v7
    v_and_b32 v6, 1, v6
    v_lshlrev_b32 v6, 2, v6
    v_xor_b32 v8, v5, v6
    v_lshlrev_b32 v8, 4, v8
    s_lshl_b32 s76, s61, 7
    s_mul_i32 s77, s62, 98304
    s_add_u32 s76, s76, s77
    v_mul_u32_u24 v7, 6144, v4
    v_add3_u32 v156, v7, v8, s76
    v_add_u32 v157, 48128, v156
    v_add_u32 v158, 0, v156
    v_add_u32 v159, 48128, v156
    v_add_u32 v160, 4096, v156
    v_add_u32 v161, 52224, v156
    s_lshl_b32 s76, s61, 7
    s_lshl_b32 s77, s62, 15
    s_add_u32 s76, s76, s77
    v_lshlrev_b32 v7, 11, v4
    v_add3_u32 v15, v7, v8, s76
    s_mul_i32 s71, s62, 10240
    s_waitcnt lgkmcnt(0)
    s_mov_b32 s28, s4
    s_and_b32 s29, s5, 0xffff
    s_mov_b32 s30, 4194304
    s_mov_b32 s31, 0x20000
    s_mov_b32 s32, s6
    s_and_b32 s33, s7, 0xffff
    s_mov_b32 s34, 6291456
    s_mov_b32 s35, 0x20000
    s_and_b32 s73, s66, 15
    s_lshr_b64 s[66:67], s[66:67], 4
    s_lshl_b32 s72, s73, 7
    s_mov_b32 m0, s71
    s_mul_i32 s73, s73, 393216
    buffer_load_dwordx4 v152, s[28:31], s72 offen offset:0 lds
    buffer_load_dwordx4 v153, s[28:31], s72 offen offset:1024 lds
    buffer_load_dwordx4 v154, s[28:31], s72 offen offset:2048 lds
    buffer_load_dwordx4 v155, s[28:31], s72 offen offset:3072 lds
    s_add_u32 m0, s71, 4096
    s_nop 0
    buffer_load_dwordx4 v156, s[32:35], s73 offen offset:0 lds
    buffer_load_dwordx4 v157, s[32:35], s73 offen offset:1024 lds
    buffer_load_dwordx4 v158, s[32:35], s73 offen offset:2048 lds
    buffer_load_dwordx4 v159, s[32:35], s73 offen offset:3072 lds
    s_add_u32 m0, s71, 8192
    s_nop 0
    buffer_load_dwordx4 v160, s[32:35], s73 offen offset:0 lds
    buffer_load_dwordx4 v161, s[32:35], s73 offen offset:1024 lds
    s_add_u32 s71, s71, 40960
    s_cmp_ge_u32 s71, 122880
    s_cselect_b32 s76, 122880, 0
    s_sub_u32 s71, s71, s76
    s_getpc_b64 s[78:79]
L_pc:
    s_lshr_b32 s76, s2, 3
    s_mul_i32 s76, s76, 768
    v_lshlrev_b32 v7, 7, v0
    v_add_u32 v7, s76, v7
    v_cmp_gt_u32 vcc, 6, v0
    s_nop 0
    s_and_saveexec_b64 s[80:81], vcc
    s_cbranch_execz L_nopf
    global_load_dword v12, v7, s[78:79]
L_nopf:
    s_mov_b64 exec, -1
    s_and_b32 s73, s66, 15
    s_lshr_b64 s[66:67], s[66:67], 4
    s_lshl_b32 s72, s73, 7
    s_mov_b32 m0, s71
    s_mul_i32 s73, s73, 393216
    buffer_load_dwordx4 v152, s[28:31], s72 offen offset:0 lds
    buffer_load_dwordx4 v153, s[28:31], s72 offen offset:1024 lds
    buffer_load_dwordx4 v154, s[28:31], s72 offen offset:2048 lds
    buffer_load_dwordx4 v155, s[28:31], s72 offen offset:3072 lds
    s_add_u32 m0, s71, 4096
    s_nop 0
    buffer_load_dwordx4 v156, s[32:35], s73 offen offset:0 lds
    buffer_load_dwordx4 v157, s[32:35], s73 offen offset:1024 lds
    buffer_load_dwordx4 v158, s[32:35], s73 offen offset:2048 lds
    buffer_load_dwordx4 v159, s[32:35], s73 offen offset:3072 lds
    s_add_u32 m0, s71, 8192
    s_nop 0
    buffer_load_dwordx4 v160, s[32:35], s73 offen offset:0 lds
    buffer_load_dwordx4 v161, s[32:35], s73 offen offset:1024 lds
    s_add_u32 s71, s71, 40960
    s_cmp_ge_u32 s71, 122880
    s_cselect_b32 s76, 122880, 0
    s_sub_u32 s71, s71, s76
    s_mov_b32 s40, s26
    s_and_b32 s41, s27, 0xffff
    s_mov_b32 s42, 16777216
    s_mov_b32 s43, 0x20000
    s_mov_b32 s56, s8
    s_and_b32 s57, s9, 0xffff
    s_mov_b32 s58, 65536
    s_mov_b32 s59, 0x20000
    s_lshl_b32 s74, s60, 4
    s_add_u32 s74, s74, s61
    s_mul_i32 s74, s74, 12416
    v_mov_b32 v4, -1
    v_mov_b32 v5, -1
    v_mov_b32 v6, -1
    v_mov_b32 v7, -1
    v_lshlrev_b32 v9, 4, v1
    s_mul_i32 s76, s62, 3072
    s_add_u32 s76, s76, s74
    buffer_store_dwordx4 v[4:7], v9, s[40:43], s76 offen offset:0 sc1
    buffer_store_dwordx4 v[4:7], v9, s[40:43], s76 offen offset:1024 sc1
    buffer_store_dwordx4 v[4:7], v9, s[40:43], s76 offen offset:2048 sc1
    s_lshl_b32 s76, s61, 12
    s_lshl_b32 s77, s62, 10
    s_add_u32 s76, s76, s77
    s_add_u32 m0, s77, 122880
    s_nop 0
    buffer_load_dwordx4 v9, s[56:59], s76 offen lds
    s_mov_b32 s36, s10
    s_and_b32 s37, s11, 0xffff
    s_mov_b32 s38, 2097152
    s_mov_b32 s39, 0x20000
    s_mov_b32 s44, s22
    s_and_b32 s45, s23, 0xffff
    s_mov_b32 s46, 4194304
    s_mov_b32 s47, 0x20000
    s_mov_b32 s52, s20
    s_and_b32 s53, s21, 0xffff
    s_mov_b32 s54, 7340032
    s_mov_b32 s55, 0x20000
    s_cmp_eq_u32 s64, 0
    s_cselect_b32 s48, s16, s18
    s_cselect_b32 s49, s17, s19
    s_and_b32 s49, s49, 0xffff
    s_mov_b32 s50, 7340032
    s_mov_b32 s51, 0x20000
    s_mov_b32 s89, 0x3f803f80
    s_mov_b32 s90, 0xffff0000
    s_lshr_b32 s76, s60, 2
    s_lshr_b32 s77, s61, 2
    s_add_u32 s76, s76, s77
    s_and_b32 s76, s76, 3
    s_lshl_b32 s76, s76, 2
    s_lshr_b32 s70, s70, s76
    s_and_b32 s70, s70, 15
    s_lshl_b32 s69, 1, s70
    s_or_b32 s69, s69, 8196
    s_lshl_b32 s76, s61, 1
    s_add_u32 s76, s76, s60
    s_lshl_b32 s76, s76, 1
    s_and_b32 s65, s76, 15
    s_mov_b32 s68, 0
    s_mov_b32 s75, 0
    s_mov_b32 s96, 40960
    v_and_b32 v2, 31, v1
    v_lshrrev_b32 v3, 5, v1
    s_mul_i32 s76, s63, 20480
    v_lshrrev_b32 v4, 1, v2
    v_and_b32 v4, 7, v4
    v_xor_b32 v4, v4, v3
    v_lshlrev_b32 v4, 4, v4
    v_lshl_add_u32 v4, v2, 7, v4
    v_add_u32 v162, s76, v4
    v_xor_b32 v163, 32, v162
    v_xor_b32 v164, 64, v162
    v_xor_b32 v165, 96, v162
    v_bfe_u32 v4, v1, 2, 2
    v_lshl_add_u32 v5, v3, 3, v4
    v_lshlrev_b32 v5, 7, v5
    v_lshrrev_b32 v4, 1, v4
    v_xor_b32 v4, s64, v4
    v_lshl_add_u32 v5, v4, 6, v5
    v_bfe_u32 v4, v1, 4, 1
    v_lshl_add_u32 v5, v4, 5, v5
    v_and_b32 v4, 3, v1
    v_lshl_add_u32 v5, v4, 3, v5
    v_add_u32 v166, 4096, v5
    v_mul_u32_u24 v13, 12416, v3
    v_lshl_add_u32 v13, v2, 3, v13
    v_lshlrev_b32 v14, 4, v1
    v_mov_b32 v16, 0
    v_mov_b32 v17, 0
    v_mov_b32 v18, 0
    v_mov_b32 v19, 0
    v_mov_b32 v20, 0
    v_mov_b32 v21, 0
    v_mov_b32 v22, 0
    v_mov_b32 v23, 0
    v_mov_b32 v24, 0
    v_mov_b32 v25, 0
    v_mov_b32 v26, 0
    v_mov_b32 v27, 0
    v_mov_b32 v28, 0
    v_mov_b32 v29, 0
    v_mov_b32 v30, 0
    v_mov_b32 v31, 0
    v_mov_b32 v32, 0
    v_mov_b32 v33, 0
    v_mov_b32 v34, 0
    v_mov_b32 v35, 0
    v_mov_b32 v36, 0
    v_mov_b32 v37, 0
    v_mov_b32 v38, 0
    v_mov_b32 v39, 0
    v_mov_b32 v40, 0
    v_mov_b32 v41, 0
    v_mov_b32 v42, 0
    v_mov_b32 v43, 0
    v_mov_b32 v44, 0
    v_mov_b32 v45, 0
    v_mov_b32 v46, 0
    v_mov_b32 v47, 0
    v_mov_b32 v48, 0
    v_mov_b32 v49, 0
    v_mov_b32 v50, 0
    v_mov_b32 v51, 0
    v_mov_b32 v52, 0
    v_mov_b32 v53, 0
    v_mov_b32 v54, 0
    v_mov_b32 v55, 0
    v_mov_b32 v56, 0
    v_mov_b32 v57, 0
    v_mov_b32 v58, 0
    v_mov_b32 v59, 0
    v_mov_b32 v60, 0
    v_mov_b32 v61, 0
    v_mov_b32 v62, 0
    v_mov_b32 v63, 0
    v_mov_b32 v64, 0
    v_mov_b32 v65, 0
    v_mov_b32 v66, 0
    v_mov_b32 v67, 0
    v_mov_b32 v68, 0
    v_mov_b32 v69, 0
    v_mov_b32 v70, 0
    v_mov_b32 v71, 0
    v_mov_b32 v72, 0
    v_mov_b32 v73, 0
    v_mov_b32 v74, 0
    v_mov_b32 v75, 0
    v_mov_b32 v76, 0
    v_mov_b32 v77, 0
    v_mov_b32 v78, 0
    v_mov_b32 v79, 0
    v_mov_b32 v80, 0
    v_mov_b32 v81, 0
    v_mov_b32 v82, 0
    v_mov_b32 v83, 0
    v_mov_b32 v84, 0
    v_mov_b32 v85, 0
    v_mov_b32 v86, 0
    v_mov_b32 v87, 0
    v_mov_b32 v88, 0
    v_mov_b32 v89, 0
    v_mov_b32 v90, 0
    v_mov_b32 v91, 0
    v_mov_b32 v92, 0
    v_mov_b32 v93, 0
    v_mov_b32 v94, 0
    v_mov_b32 v95, 0
    v_mov_b32 v96, 0
    v_mov_b32 v97, 0
    v_mov_b32 v98, 0
    v_mov_b32 v99, 0
    v_mov_b32 v100, 0
    v_mov_b32 v101, 0
    v_mov_b32 v102, 0
    v_mov_b32 v103, 0
    v_mov_b32 v104, 0
    v_mov_b32 v105, 0
    v_mov_b32 v106, 0
    v_mov_b32 v107, 0
    v_mov_b32 v108, 0
    v_mov_b32 v109, 0
    v_mov_b32 v110, 0
    v_mov_b32 v111, 0
    v_mov_b32 v132, 0
    v_mov_b32 v133, 0
    v_mov_b32 v134, 0
    v_mov_b32 v135, 0
    v_mov_b32 v136, 0
    v_mov_b32 v137, 0
    v_mov_b32 v138, 0
    v_mov_b32 v139, 0
    v_mov_b32 v140, 0
    v_mov_b32 v141, 0
    v_mov_b32 v142, 0
    v_mov_b32 v143, 0
    v_mov_b32 v144, 0
    v_mov_b32 v145, 0
    v_mov_b32 v146, 0
    v_mov_b32 v147, 0
    v_mov_b32 v148, 0
    v_mov_b32 v149, 0
    v_mov_b32 v150, 0
    v_mov_b32 v151, 0
    s_waitcnt vmcnt(14)
    s_barrier
.p2align 3
L_loop:
    v_mfma_f32_32x32x16_bf16 v[32:47], v[140:143], v[136:139], v[32:47]
    ds_read_b128 v[112:115], v162
    ds_read_b64_tr_b16 v[120:121], v166 offset:0
    v_mfma_f32_32x32x16_bf16 v[48:63], v[144:147], v[132:135], v[48:63]
    ds_read_b64_tr_b16 v[122:123], v166 offset:512
    ds_read_b128 v[116:119], v162 offset:10240
    v_mfma_f32_32x32x16_bf16 v[64:79], v[144:147], v[136:139], v[64:79]
    ds_read_b64_tr_b16 v[124:125], v166 offset:2048
    ds_read_b64_tr_b16 v[126:127], v166 offset:2560
    v_mfma_f32_32x32x16_bf16 v[80:95], v[148:151], v[132:135], v[80:95]
    ds_read_b64_tr_b16 v[128:129], v166 offset:4096
    ds_read_b64_tr_b16 v[130:131], v166 offset:4608
    s_and_b32 s73, s66, 15
    s_lshr_b64 s[66:67], s[66:67], 4
    s_lshl_b32 s72, s73, 7
    s_mov_b32 m0, s71
    s_mul_i32 s73, s73, 393216
    buffer_load_dwordx4 v152, s[28:31], s72 offen offset:0 lds
    v_mfma_f32_32x32x16_bf16 v[96:111], v[148:151], v[136:139], v[96:111]
    buffer_load_dwordx4 v153, s[28:31], s72 offen offset:1024 lds
    s_bitcmp1_b32 s69, s68
    s_cbranch_scc1 L_event
L_event_ret:
    s_waitcnt lgkmcnt(4)
    v_mfma_f32_32x32x16_bf16 v[16:31], v[120:123], v[112:115], v[16:31]
    ds_read_b128 v[132:135], v163
    ds_read_b64_tr_b16 v[140:141], v166 offset:10240
    v_mfma_f32_32x32x16_bf16 v[32:47], v[120:123], v[116:119], v[32:47]
    ds_read_b64_tr_b16 v[142:143], v166 offset:10752
    ds_read_b128 v[136:139], v163 offset:10240
    s_waitcnt lgkmcnt(4)
    v_mfma_f32_32x32x16_bf16 v[48:63], v[124:127], v[112:115], v[48:63]
    ds_read_b64_tr_b16 v[144:145], v166 offset:12288
    ds_read_b64_tr_b16 v[146:147], v166 offset:12800
    buffer_load_dwordx4 v154, s[28:31], s72 offen offset:2048 lds
    v_mfma_f32_32x32x16_bf16 v[64:79], v[124:127], v[116:119], v[64:79]
    ds_read_b64_tr_b16 v[148:149], v166 offset:14336
    ds_read_b64_tr_b16 v[150:151], v166 offset:14848
    v_mfma_f32_32x32x16_bf16 v[80:95], v[128:131], v[112:115], v[80:95]
    buffer_load_dwordx4 v155, s[28:31], s72 offen offset:3072 lds
    v_mfma_f32_32x32x16_bf16 v[96:111], v[128:131], v[116:119], v[96:111]
    s_add_u32 m0, s71, 4096
    s_nop 0
    buffer_load_dwordx4 v156, s[32:35], s73 offen offset:0 lds
    s_waitcnt lgkmcnt(4)
    v_mfma_f32_32x32x16_bf16 v[16:31], v[140:143], v[132:135], v[16:31]
    ds_read_b128 v[112:115], v164
    ds_read_b64_tr_b16 v[120:121], v166 offset:20480
    v_mfma_f32_32x32x16_bf16 v[32:47], v[140:143], v[136:139], v[32:47]
    ds_read_b64_tr_b16 v[122:123], v166 offset:20992
    ds_read_b128 v[116:119], v164 offset:10240
    s_waitcnt lgkmcnt(4)
    v_mfma_f32_32x32x16_bf16 v[48:63], v[144:147], v[132:135], v[48:63]
    ds_read_b64_tr_b16 v[124:125], v166 offset:22528
    ds_read_b64_tr_b16 v[126:127], v166 offset:23040
    buffer_load_dwordx4 v157, s[32:35], s73 offen offset:1024 lds
    v_mfma_f32_32x32x16_bf16 v[64:79], v[144:147], v[136:139], v[64:79]
    ds_read_b64_tr_b16 v[128:129], v166 offset:24576
    ds_read_b64_tr_b16 v[130:131], v166 offset:25088
    v_mfma_f32_32x32x16_bf16 v[80:95], v[148:151], v[132:135], v[80:95]
    buffer_load_dwordx4 v158, s[32:35], s73 offen offset:2048 lds
    v_mfma_f32_32x32x16_bf16 v[96:111], v[148:151], v[136:139], v[96:111]
    buffer_load_dwordx4 v159, s[32:35], s73 offen offset:3072 lds
    s_waitcnt lgkmcnt(4)
    v_mfma_f32_32x32x16_bf16 v[16:31], v[120:123], v[112:115], v[16:31]
    ds_read_b128 v[132:135], v165
    ds_read_b64_tr_b16 v[140:141], v166 offset:30720
    v_mfma_f32_32x32x16_bf16 v[32:47], v[120:123], v[116:119], v[32:47]
    ds_read_b64_tr_b16 v[142:143], v166 offset:31232
    ds_read_b128 v[136:139], v165 offset:10240
    s_waitcnt lgkmcnt(4)
    v_mfma_f32_32x32x16_bf16 v[48:63], v[124:127], v[112:115], v[48:63]
    ds_read_b64_tr_b16 v[144:145], v166 offset:32768
    ds_read_b64_tr_b16 v[146:147], v166 offset:33280
    s_add_u32 m0, s71, 8192
    s_nop 0
    buffer_load_dwordx4 v160, s[32:35], s73 offen offset:0 lds
    v_mfma_f32_32x32x16_bf16 v[64:79], v[124:127], v[116:119], v[64:79]
    ds_read_b64_tr_b16 v[148:149], v166 offset:34816
    ds_read_b64_tr_b16 v[150:151], v166 offset:35328
    v_mfma_f32_32x32x16_bf16 v[80:95], v[128:131], v[112:115], v[80:95]
    s_add_u32 s75, s75, 1
    s_cmp_eq_u32 s75, 3
    s_cselect_b32 s77, -81920, s96
    s_cselect_b32 s75, 0, s75
    buffer_load_dwordx4 v161, s[32:35], s73 offen offset:1024 lds
    s_add_u32 s71, s71, 40960
    s_cmp_ge_u32 s71, 122880
    s_cselect_b32 s76, 122880, 0
    s_sub_u32 s71, s71, s76
    v_mfma_f32_32x32x16_bf16 v[96:111], v[128:131], v[116:119], v[96:111]
    v_add_u32 v162, s77, v162
    v_add_u32 v163, s77, v163
    v_add_u32 v164, s77, v164
    v_add_u32 v165, s77, v165
    v_add_u32 v166, s77, v166
    s_waitcnt lgkmcnt(4)
    v_mfma_f32_32x32x16_bf16 v[16:31], v[140:143], v[132:135], v[16:31]
    s_waitcnt vmcnt(10) lgkmcnt(0)
    s_barrier
    s_add_u32 s68, s68, 1
    s_cmp_lt_u32 s68, 14
    s_cbranch_scc1 L_loop
    v_mfma_f32_32x32x16_bf16 v[32:47], v[140:143], v[136:139], v[32:47]
    ds_read_b128 v[112:115], v162
    ds_read_b64_tr_b16 v[120:121], v166 offset:0
    v_mfma_f32_32x32x16_bf16 v[48:63], v[144:147], v[132:135], v[48:63]
    ds_read_b64_tr_b16 v[122:123], v166 offset:512
    ds_read_b128 v[116:119], v162 offset:10240
    v_mfma_f32_32x32x16_bf16 v[64:79], v[144:147], v[136:139], v[64:79]
    ds_read_b64_tr_b16 v[124:125], v166 offset:2048
    ds_read_b64_tr_b16 v[126:127], v166 offset:2560
    v_mfma_f32_32x32x16_bf16 v[80:95], v[148:151], v[132:135], v[80:95]
    ds_read_b64_tr_b16 v[128:129], v166 offset:4096
    ds_read_b64_tr_b16 v[130:131], v166 offset:4608
    v_mfma_f32_32x32x16_bf16 v[96:111], v[148:151], v[136:139], v[96:111]
    s_waitcnt lgkmcnt(4)
    v_mfma_f32_32x32x16_bf16 v[16:31], v[120:123], v[112:115], v[16:31]
    ds_read_b128 v[132:135], v163
    ds_read_b64_tr_b16 v[140:141], v166 offset:10240
    v_mfma_f32_32x32x16_bf16 v[32:47], v[120:123], v[116:119], v[32:47]
    ds_read_b64_tr_b16 v[142:143], v166 offset:10752
    ds_read_b128 v[136:139], v163 offset:10240
    s_waitcnt lgkmcnt(4)
    v_mfma_f32_32x32x16_bf16 v[48:63], v[124:127], v[112:115], v[48:63]
    ds_read_b64_tr_b16 v[144:145], v166 offset:12288
    ds_read_b64_tr_b16 v[146:147], v166 offset:12800
    v_mfma_f32_32x32x16_bf16 v[64:79], v[124:127], v[116:119], v[64:79]
    ds_read_b64_tr_b16 v[148:149], v166 offset:14336
    ds_read_b64_tr_b16 v[150:151], v166 offset:14848
    v_mfma_f32_32x32x16_bf16 v[80:95], v[128:131], v[112:115], v[80:95]
    v_mfma_f32_32x32x16_bf16 v[96:111], v[128:131], v[116:119], v[96:111]
    s_waitcnt lgkmcnt(4)
    v_mfma_f32_32x32x16_bf16 v[16:31], v[140:143], v[132:135], v[16:31]
    ds_read_b128 v[112:115], v164
    ds_read_b64_tr_b16 v[120:121], v166 offset:20480
    v_mfma_f32_32x32x16_bf16 v[32:47], v[140:143], v[136:139], v[32:47]
    ds_read_b64_tr_b16 v[122:123], v166 offset:20992
    ds_read_b128 v[116:119], v164 offset:10240
    s_waitcnt lgkmcnt(4)
    v_mfma_f32_32x32x16_bf16 v[48:63], v[144:147], v[132:135], v[48:63]
    ds_read_b64_tr_b16 v[124:125], v166 offset:22528
    ds_read_b64_tr_b16 v[126:127], v166 offset:23040
    v_mfma_f32_32x32x16_bf16 v[64:79], v[144:147], v[136:139], v[64:79]
    ds_read_b64_tr_b16 v[128:129], v166 offset:24576
    ds_read_b64_tr_b16 v[130:131], v166 offset:25088
    v_mfma_f32_32x32x16_bf16 v[80:95], v[148:151], v[132:135], v[80:95]
    v_mfma_f32_32x32x16_bf16 v[96:111], v[148:151], v[136:139], v[96:111]
    s_waitcnt lgkmcnt(4)
    v_mfma_f32_32x32x16_bf16 v[16:31], v[120:123], v[112:115], v[16:31]
    ds_read_b128 v[132:135], v165
    ds_read_b64_tr_b16 v[140:141], v166 offset:30720
    v_mfma_f32_32x32x16_bf16 v[32:47], v[120:123], v[116:119], v[32:47]
    ds_read_b64_tr_b16 v[142:143], v166 offset:31232
    ds_read_b128 v[136:139], v165 offset:10240
    s_waitcnt lgkmcnt(4)
    v_mfma_f32_32x32x16_bf16 v[48:63], v[124:127], v[112:115], v[48:63]
    ds_read_b64_tr_b16 v[144:145], v166 offset:32768
    ds_read_b64_tr_b16 v[146:147], v166 offset:33280
    v_mfma_f32_32x32x16_bf16 v[64:79], v[124:127], v[116:119], v[64:79]
    ds_read_b64_tr_b16 v[148:149], v166 offset:34816
    ds_read_b64_tr_b16 v[150:151], v166 offset:35328
    v_mfma_f32_32x32x16_bf16 v[80:95], v[128:131], v[112:115], v[80:95]
    s_add_u32 s75, s75, 1
    s_cmp_eq_u32 s75, 3
    s_cselect_b32 s77, -81920, s96
    s_cselect_b32 s75, 0, s75
    v_mfma_f32_32x32x16_bf16 v[96:111], v[128:131], v[116:119], v[96:111]
    v_add_u32 v162, s77, v162
    v_add_u32 v163, s77, v163
    v_add_u32 v164, s77, v164
    v_add_u32 v165, s77, v165
    v_add_u32 v166, s77, v166
    s_waitcnt lgkmcnt(4)
    v_mfma_f32_32x32x16_bf16 v[16:31], v[140:143], v[132:135], v[16:31]
    s_waitcnt vmcnt(0) lgkmcnt(0)
    s_barrier
    v_cmp_ne_u32 vcc, 0x01010101, v12
    s_nop 0
    s_cbranch_vccz L_hello_ok_1
    s_mov_b32 s88, 0
L_spin_2:
    v_lshlrev_b32 v4, 2, v1
    global_load_dword v12, v4, s[24:25] sc1
    s_waitcnt vmcnt(0)
    v_cmp_ne_u32 vcc, 0x01010101, v12
    s_nop 0
    s_cbranch_vccz L_hello_ok_1
    s_add_u32 s88, s88, 1
    s_cmp_lt_u32 s88, 65536
    s_cbranch_scc1 L_spin_2
L_hello_ok_1:
    v_mfma_f32_32x32x16_bf16 v[32:47], v[140:143], v[136:139], v[32:47]
    ds_read_b128 v[112:115], v162
    ds_read_b64_tr_b16 v[120:121], v166 offset:0
    s_mul_i32 s80, s60, 198656
    s_lshl_b32 s81, s62, 8
    s_add_u32 s80, s80, s81
    buffer_load_dwordx2 v[176:177], v13, s[40:43], s80 offen offset:0 sc1
    v_mfma_f32_32x32x16_bf16 v[48:63], v[144:147], v[132:135], v[48:63]
    ds_read_b64_tr_b16 v[122:123], v166 offset:512
    ds_read_b128 v[116:119], v162 offset:10240
    s_add_u32 s80, s80, 24832
    buffer_load_dwordx2 v[178:179], v13, s[40:43], s80 offen offset:0 sc1
    v_mfma_f32_32x32x16_bf16 v[64:79], v[144:147], v[136:139], v[64:79]
    ds_read_b64_tr_b16 v[124:125], v166 offset:2048
    ds_read_b64_tr_b16 v[126:127], v166 offset:2560
    s_add_u32 s80, s80, 24832
    buffer_load_dwordx2 v[180:181], v13, s[40:43], s80 offen offset:0 sc1
    v_mfma_f32_32x32x16_bf16 v[80:95], v[148:151], v[132:135], v[80:95]
    ds_read_b64_tr_b16 v[128:129], v166 offset:4096
    ds_read_b64_tr_b16 v[130:131], v166 offset:4608
    s_add_u32 s80, s80, 24832
    buffer_load_dwordx2 v[182:183], v13, s[40:43], s80 offen offset:0 sc1
    v_mfma_f32_32x32x16_bf16 v[96:111], v[148:151], v[136:139], v[96:111]
    s_add_u32 s80, s80, 24832
    buffer_load_dwordx2 v[184:185], v13, s[40:43], s80 offen offset:0 sc1
    s_waitcnt lgkmcnt(4)
    v_mfma_f32_32x32x16_bf16 v[16:31], v[120:123], v[112:115], v[16:31]
    ds_read_b128 v[132:135], v163
    ds_read_b64_tr_b16 v[140:141], v166 offset:10240
    s_add_u32 s80, s80, 24832
    buffer_load_dwordx2 v[186:187], v13, s[40:43], s80 offen offset:0 sc1
    v_mfma_f32_32x32x16_bf16 v[32:47], v[120:123], v[116:119], v[32:47]
    ds_read_b64_tr_b16 v[142:143], v166 offset:10752
    ds_read_b128 v[136:139], v163 offset:10240
    s_add_u32 s80, s80, 24832
    buffer_load_dwordx2 v[188:189], v13, s[40:43], s80 offen offset:0 sc1
    s_waitcnt lgkmcnt(4)
    v_mfma_f32_32x32x16_bf16 v[48:63], v[124:127], v[112:115], v[48:63]
    ds_read_b64_tr_b16 v[144:145], v166 offset:12288
    ds_read_b64_tr_b16 v[146:147], v166 offset:12800
    s_add_u32 s80, s80, 24832
    buffer_load_dwordx2 v[190:191], v13, s[40:43], s80 offen offset:0 sc1
    v_mfma_f32_32x32x16_bf16 v[64:79], v[124:127], v[116:119], v[64:79]
    ds_read_b64_tr_b16 v[148:149], v166 offset:14336
    ds_read_b64_tr_b16 v[150:151], v166 offset:14848
    s_lshl_b32 s80, s62, 6
    s_add_u32 s80, s80, s61
    s_mul_i32 s80, s80, 12416
    buffer_load_dwordx4 v[192:195], v14, s[40:43], s80 offen offset:1024 sc1
    v_mfma_f32_32x32x16_bf16 v[80:95], v[128:131], v[112:115], v[80:95]
    s_add_u32 s80, s80, 198656
    buffer_load_dwordx4 v[196:199], v14, s[40:43], s80 offen offset:1024 sc1
    v_mfma_f32_32x32x16_bf16 v[96:111], v[128:131], v[116:119], v[96:111]
    s_add_u32 s80, s80, 198656
    buffer_load_dwordx4 v[200:203], v14, s[40:43], s80 offen offset:1024 sc1
    s_waitcnt lgkmcnt(4)
    v_mfma_f32_32x32x16_bf16 v[16:31], v[140:143], v[132:135], v[16:31]
    ds_read_b128 v[112:115], v164
    ds_read_b64_tr_b16 v[120:121], v166 offset:20480
    s_add_u32 s80, s80, 198656
    buffer_load_dwordx4 v[204:207], v14, s[40:43], s80 offen offset:1024 sc1
    v_mfma_f32_32x32x16_bf16 v[32:47], v[140:143], v[136:139], v[32:47]
    ds_read_b64_tr_b16 v[122:123], v166 offset:20992
    ds_read_b128 v[116:119], v164 offset:10240
    s_add_u32 s78, s65, 0
    s_and_b32 s78, s78, 15
    s_lshl_b32 s78, s78, 17
    s_lshl_b32 s79, s62, 11
    s_add_u32 m0, s79, 57344
    s_add_u32 s79, s78, 15360
    buffer_load_dwordx4 v15, s[36:39], s78 offen lds
    s_waitcnt lgkmcnt(4)
    v_mfma_f32_32x32x16_bf16 v[48:63], v[144:147], v[132:135], v[48:63]
    ds_read_b64_tr_b16 v[124:125], v166 offset:22528
    ds_read_b64_tr_b16 v[126:127], v166 offset:23040
    buffer_load_dwordx4 v15, s[36:39], s79 offen offset:1024 lds
    v_mfma_f32_32x32x16_bf16 v[64:79], v[144:147], v[136:139], v[64:79]
    ds_read_b64_tr_b16 v[128:129], v166 offset:24576
    ds_read_b64_tr_b16 v[130:131], v166 offset:25088
    v_mfma_f32_32x32x16_bf16 v[80:95], v[148:151], v[132:135], v[80:95]
    s_add_u32 s78, s65, 1
    s_and_b32 s78, s78, 15
    s_lshl_b32 s78, s78, 17
    s_lshl_b32 s79, s62, 11
    s_add_u32 m0, s79, 65536
    s_add_u32 s79, s78, 15360
    buffer_load_dwordx4 v15, s[36:39], s78 offen lds
    v_mfma_f32_32x32x16_bf16 v[96:111], v[148:151], v[136:139], v[96:111]
    buffer_load_dwordx4 v15, s[36:39], s79 offen offset:1024 lds
    s_waitcnt lgkmcnt(4)
    v_mfma_f32_32x32x16_bf16 v[16:31], v[120:123], v[112:115], v[16:31]
    ds_read_b128 v[132:135], v165
    ds_read_b64_tr_b16 v[140:141], v166 offset:30720
    s_add_u32 s78, s65, 2
    s_and_b32 s78, s78, 15
    s_lshl_b32 s78, s78, 17
    s_lshl_b32 s79, s62, 11
    s_add_u32 m0, s79, 73728
    s_add_u32 s79, s78, 15360
    buffer_load_dwordx4 v15, s[36:39], s78 offen lds
    v_mfma_f32_32x32x16_bf16 v[32:47], v[120:123], v[116:119], v[32:47]
    ds_read_b64_tr_b16 v[142:143], v166 offset:31232
    ds_read_b128 v[136:139], v165 offset:10240
    buffer_load_dwordx4 v15, s[36:39], s79 offen offset:1024 lds
    s_waitcnt lgkmcnt(4)
    v_mfma_f32_32x32x16_bf16 v[48:63], v[124:127], v[112:115], v[48:63]
    ds_read_b64_tr_b16 v[144:145], v166 offset:32768
    ds_read_b64_tr_b16 v[146:147], v166 offset:33280
    s_add_u32 s78, s65, 3
    s_and_b32 s78, s78, 15
    s_lshl_b32 s78, s78, 17
    s_lshl_b32 s79, s62, 11
    s_add_u32 m0, s79, 81920
    s_add_u32 s79, s78, 15360
    buffer_load_dwordx4 v15, s[36:39], s78 offen lds
    v_mfma_f32_32x32x16_bf16 v[64:79], v[124:127], v[116:119], v[64:79]
    ds_read_b64_tr_b16 v[148:149], v166 offset:34816
    ds_read_b64_tr_b16 v[150:151], v166 offset:35328
    v_mfma_f32_32x32x16_bf16 v[80:95], v[128:131], v[112:115], v[80:95]
    buffer_load_dwordx4 v15, s[36:39], s79 offen offset:1024 lds
    v_mfma_f32_32x32x16_bf16 v[96:111], v[128:131], v[116:119], v[96:111]
    s_waitcnt lgkmcnt(4)
    v_mfma_f32_32x32x16_bf16 v[16:31], v[140:143], v[132:135], v[16:31]
    s_waitcnt lgkmcnt(0)
    s_barrier
    v_mfma_f32_32x32x16_bf16 v[32:47], v[140:143], v[136:139], v[32:47]
    v_mfma_f32_32x32x16_bf16 v[48:63], v[144:147], v[132:135], v[48:63]
    v_mfma_f32_32x32x16_bf16 v[64:79], v[144:147], v[136:139], v[64:79]
    v_mfma_f32_32x32x16_bf16 v[80:95], v[148:151], v[132:135], v[80:95]
    v_mfma_f32_32x32x16_bf16 v[96:111], v[148:151], v[136:139], v[96:111]
    s_waitcnt vmcnt(8)
    s_mov_b32 s88, 0
    s_branch L_g1first_3
L_g1_4:
    s_mul_i32 s80, s60, 198656
    s_lshl_b32 s81, s62, 8
    s_add_u32 s80, s80, s81
    buffer_load_dwordx2 v[176:177], v13, s[40:43], s80 offen offset:0 sc1
    s_add_u32 s80, s80, 24832
    buffer_load_dwordx2 v[178:179], v13, s[40:43], s80 offen offset:0 sc1
    s_add_u32 s80, s80, 24832
    buffer_load_dwordx2 v[180:181], v13, s[40:43], s80 offen offset:0 sc1
    s_add_u32 s80, s80, 24832
    buffer_load_dwordx2 v[182:183], v13, s[40:43], s80 offen offset:0 sc1
    s_add_u32 s80, s80, 24832
    buffer_load_dwordx2 v[184:185], v13, s[40:43], s80 offen offset:0 sc1
    s_add_u32 s80, s80, 24832
    buffer_load_dwordx2 v[186:187], v13, s[40:43], s80 offen offset:0 sc1
    s_add_u32 s80, s80, 24832
    buffer_load_dwordx2 v[188:189], v13, s[40:43], s80 offen offset:0 sc1
    s_add_u32 s80, s80, 24832
    buffer_load_dwordx2 v[190:191], v13, s[40:43], s80 offen offset:0 sc1
    s_lshl_b32 s80, s62, 6
    s_add_u32 s80, s80, s61
    s_mul_i32 s80, s80, 12416
    buffer_load_dwordx4 v[192:195], v14, s[40:43], s80 offen offset:1024 sc1
    s_add_u32 s80, s80, 198656
    buffer_load_dwordx4 v[196:199], v14, s[40:43], s80 offen offset:1024 sc1
    s_add_u32 s80, s80, 198656
    buffer_load_dwordx4 v[200:203], v14, s[40:43], s80 offen offset:1024 sc1
    s_add_u32 s80, s80, 198656
    buffer_load_dwordx4 v[204:207], v14, s[40:43], s80 offen offset:1024 sc1
    s_waitcnt vmcnt(0)
L_g1first_3:
    v_max3_u32 v4, v176, v178, v180
    v_max3_u32 v5, v182, v184, v186
    v_max3_u32 v4, v4, v188, v190
    v_max3_u32 v5, v5, v192, v196
    v_max3_u32 v4, v4, v200, v204
    v_max_u32 v4, v4, v5
    v_cmp_eq_u32 vcc, -1, v4
    s_nop 0
    s_cbranch_vccz L_ok_5
    s_add_u32 s88, s88, 1
    s_cmp_lt_u32 s88, 65536
    s_cbranch_scc1 L_g1_4
L_ok_5:
    s_add_u32 s78, s65, 4
    s_and_b32 s78, s78, 15
    s_lshl_b32 s78, s78, 17
    s_lshl_b32 s79, s62, 11
    s_add_u32 m0, s79, 90112
    s_add_u32 s79, s78, 15360
    buffer_load_dwordx4 v15, s[36:39], s78 offen lds
    buffer_load_dwordx4 v15, s[36:39], s79 offen offset:1024 lds
    s_add_u32 s78, s65, 5
    s_and_b32 s78, s78, 15
    s_lshl_b32 s78, s78, 17
    s_lshl_b32 s79, s62, 11
    s_add_u32 m0, s79, 98304
    s_add_u32 s79, s78, 15360
    buffer_load_dwordx4 v15, s[36:39], s78 offen lds
    buffer_load_dwordx4 v15, s[36:39], s79 offen offset:1024 lds
    s_add_u32 s78, s65, 6
    s_and_b32 s78, s78, 15
    s_lshl_b32 s78, s78, 17
    s_lshl_b32 s79, s62, 11
    s_add_u32 m0, s79, 106496
    s_add_u32 s79, s78, 15360
    buffer_load_dwordx4 v15, s[36:39], s78 offen lds
    buffer_load_dwordx4 v15, s[36:39], s79 offen offset:1024 lds
    s_add_u32 s78, s65, 7
    s_and_b32 s78, s78, 15
    s_lshl_b32 s78, s78, 17
    s_lshl_b32 s79, s62, 11
    s_add_u32 m0, s79, 114688
    s_add_u32 s79, s78, 15360
    buffer_load_dwordx4 v15, s[36:39], s78 offen lds
    buffer_load_dwordx4 v15, s[36:39], s79 offen offset:1024 lds
    s_add_u32 s78, s65, 8
    s_and_b32 s78, s78, 15
    s_lshl_b32 s78, s78, 17
    s_lshl_b32 s79, s62, 11
    s_add_u32 m0, s79, 122880
    s_add_u32 s79, s78, 15360
    buffer_load_dwordx4 v15, s[36:39], s78 offen lds
    buffer_load_dwordx4 v15, s[36:39], s79 offen offset:1024 lds
    s_add_u32 s78, s65, 9
    s_and_b32 s78, s78, 15
    s_lshl_b32 s78, s78, 17
    s_lshl_b32 s79, s62, 11
    s_add_u32 m0, s79, 131072
    s_add_u32 s79, s78, 15360
    buffer_load_dwordx4 v15, s[36:39], s78 offen lds
    buffer_load_dwordx4 v15, s[36:39], s79 offen offset:1024 lds
    s_add_u32 s78, s65, 10
    s_and_b32 s78, s78, 15
    s_lshl_b32 s78, s78, 17
    s_lshl_b32 s79, s62, 11
    s_add_u32 m0, s79, 139264
    s_add_u32 s79, s78, 15360
    buffer_load_dwordx4 v15, s[36:39], s78 offen lds
    buffer_load_dwordx4 v15, s[36:39], s79 offen offset:1024 lds
    s_add_u32 s78, s65, 11
    s_and_b32 s78, s78, 15
    s_lshl_b32 s78, s78, 17
    s_lshl_b32 s79, s62, 11
    s_add_u32 m0, s79, 147456
    s_add_u32 s79, s78, 15360
    buffer_load_dwordx4 v15, s[36:39], s78 offen lds
    buffer_load_dwordx4 v15, s[36:39], s79 offen offset:1024 lds
    s_add_u32 s78, s65, 12
    s_and_b32 s78, s78, 15
    s_lshl_b32 s78, s78, 17
    s_lshl_b32 s79, s62, 11
    s_add_u32 m0, s79, 155648
    s_add_u32 s79, s78, 15360
    buffer_load_dwordx4 v15, s[36:39], s78 offen lds
    buffer_load_dwordx4 v15, s[36:39], s79 offen offset:1024 lds
    v_pk_add_f32 v[176:177], v[176:177], v[184:185]
    v_pk_add_f32 v[178:179], v[178:179], v[186:187]
    v_pk_add_f32 v[180:181], v[180:181], v[188:189]
    v_pk_add_f32 v[182:183], v[182:183], v[190:191]
    v_pk_add_f32 v[176:177], v[176:177], v[180:181]
    v_pk_add_f32 v[178:179], v[178:179], v[182:183]
    v_pk_add_f32 v[176:177], v[176:177], v[178:179]
    v_pk_add_f32 v[192:193], v[192:193], v[200:201]
    v_pk_add_f32 v[194:195], v[194:195], v[202:203]
    v_pk_add_f32 v[196:197], v[196:197], v[204:205]
    v_pk_add_f32 v[198:199], v[198:199], v[206:207]
    v_pk_add_f32 v[192:193], v[192:193], v[196:197]
    v_pk_add_f32 v[194:195], v[194:195], v[198:199]
    s_lshl_b32 s76, s62, 10
    s_add_u32 s76, s76, 50176
    v_add_u32 v4, s76, v14
    ds_write_b128 v4, v[192:195]
    v_mov_b32 v5, v176
    s_nop 1
    v_permlane32_swap_b32 v176, v5
    v_add_f32 v176, v176, v5
    v_mov_b32 v6, v177
    s_nop 1
    v_permlane32_swap_b32 v177, v6
    v_add_f32 v177, v177, v6
    v_mul_f32 v176, 0x3a800000, v176
    v_mul_f32 v177, 0x3a800000, v177
    v_fma_f32 v7, -v176, v176, v177
    v_max_f32 v7, 0, v7
    v_cvt_pk_bf16_f32 v5, v176, v176
    v_and_b32 v5, s90, v5
    v_cvt_pk_bf16_f32 v7, v7, v7
    v_and_b32 v7, s90, v7
    v_add_f32 v7, 0x3727c5ac, v7
    v_cvt_pk_bf16_f32 v7, v7, v7
    v_and_b32 v7, s90, v7
    v_sqrt_f32 v7, v7
    s_nop 0
    v_cvt_pk_bf16_f32 v7, v7, v7
    v_and_b32 v7, s90, v7
    v_rcp_f32 v6, v7
    v_xor_b32 v5, 0x80000000, v5
    v_cvt_pk_bf16_f32 v4, v5, v5
    v_mov_b32 v5, v6
    s_lshl_b32 s76, s62, 8
    s_add_u32 s76, s76, 49152
    v_lshl_add_u32 v6, v2, 3, s76
    ds_write_b64 v6, v[4:5]
    s_waitcnt lgkmcnt(0)
    s_barrier
    s_lshl_b32 s76, s63, 9
    s_add_u32 s76, s76, 49152
    v_lshl_add_u32 v6, v2, 3, s76
    s_lshl_b32 s76, s64, 9
    s_add_u32 s76, s76, 50176
    v_lshl_add_u32 v7, v2, 4, s76
    ds_read_b128 v[192:195], v7 offset:0
    ds_read_b128 v[196:199], v7 offset:1024
    ds_read_b128 v[200:203], v7 offset:2048
    ds_read_b128 v[204:207], v7 offset:3072
    ds_read_b64 v[112:113], v6
    ds_read_b64 v[116:117], v6 offset:256
    v_mov_b32 v114, 0
    v_mov_b32 v115, 0
    v_mov_b32 v118, 0
    v_mov_b32 v119, 0
    v_mov_b32 v126, 0
    v_mov_b32 v127, 0
    v_mov_b32 v130, 0
    v_mov_b32 v131, 0
    v_mov_b32 v134, 0
    v_mov_b32 v135, 0
    v_cmp_eq_u32 vcc, 0, v3
    s_waitcnt lgkmcnt(2)
    v_pk_add_f32 v[192:193], v[192:193], v[200:201]
    v_pk_add_f32 v[194:195], v[194:195], v[202:203]
    v_pk_add_f32 v[196:197], v[196:197], v[204:205]
    v_pk_add_f32 v[198:199], v[198:199], v[206:207]
    v_pk_add_f32 v[192:193], v[192:193], v[196:197]
    v_pk_add_f32 v[194:195], v[194:195], v[198:199]
    v_cndmask_b32 v192, 0, v192, vcc
    v_cndmask_b32 v193, 0, v193, vcc
    v_cndmask_b32 v194, 0, v194, vcc
    v_cvt_pk_bf16_f32 v196, v192, v192
    v_and_b32 v196, s90, v196
    v_cvt_pk_bf16_f32 v197, v193, v193
    v_and_b32 v197, s90, v197
    v_cvt_pk_bf16_f32 v198, v194, v194
    v_and_b32 v198, s90, v198
    v_sub_f32 v196, v192, v196
    v_sub_f32 v197, v193, v197
    v_sub_f32 v198, v194, v198
    v_cvt_pk_bf16_f32 v124, v192, v196
    v_cvt_pk_bf16_f32 v128, v193, v197
    v_cvt_pk_bf16_f32 v132, v194, v198
    v_and_b32 v200, s90, v124
    v_and_b32 v201, s90, v128
    v_and_b32 v202, s90, v132
    v_sub_f32 v196, v196, v200
    v_sub_f32 v197, v197, v201
    v_sub_f32 v198, v198, v202
    v_cvt_pk_bf16_f32 v125, v196, 0
    v_cvt_pk_bf16_f32 v129, v197, 0
    v_cvt_pk_bf16_f32 v133, v198, 0
    s_waitcnt lgkmcnt(0)
    v_mov_b32 v120, v113
    v_mov_b32 v122, v117
    v_mov_b32 v113, v112
    v_mov_b32 v117, v116
    s_nop 0
    v_mfma_f32_32x32x16_bf16 v[48:63], v[128:131], v[112:115], v[48:63]
    v_mfma_f32_32x32x16_bf16 v[64:79], v[128:131], v[116:119], v[64:79]
    v_mfma_f32_32x32x16_bf16 v[80:95], v[132:135], v[112:115], v[80:95]
    v_mfma_f32_32x32x16_bf16 v[96:111], v[132:135], v[116:119], v[96:111]
    v_mfma_f32_32x32x16_bf16 v[16:31], v[124:127], v[112:115], v[16:31]
    v_mfma_f32_32x32x16_bf16 v[32:47], v[124:127], v[116:119], v[32:47]
    v_mul_f32 v121, 0x3fb8aa3b, v120
    v_mul_f32 v123, 0x3fb8aa3b, v122
    s_nop 4
    v_cvt_pk_bf16_f32 v176, v48, v49
    v_cvt_pk_bf16_f32 v177, v50, v51
    v_cvt_pk_bf16_f32 v178, v52, v53
    v_cvt_pk_bf16_f32 v179, v54, v55
    v_cvt_pk_bf16_f32 v180, v56, v57
    v_cvt_pk_bf16_f32 v181, v58, v59
    v_cvt_pk_bf16_f32 v182, v60, v61
    v_cvt_pk_bf16_f32 v183, v62, v63
    v_cvt_pk_bf16_f32 v184, v64, v65
    v_cvt_pk_bf16_f32 v185, v66, v67
    v_cvt_pk_bf16_f32 v186, v68, v69
    v_cvt_pk_bf16_f32 v187, v70, v71
    v_cvt_pk_bf16_f32 v188, v72, v73
    v_cvt_pk_bf16_f32 v189, v74, v75
    v_cvt_pk_bf16_f32 v190, v76, v77
    v_cvt_pk_bf16_f32 v191, v78, v79
    v_mfma_f32_32x32x16_bf16 v[48:63], v[168:171], v[176:179], 0
    v_mfma_f32_32x32x16_bf16 v[64:79], v[168:171], v[184:187], 0
    v_mfma_f32_32x32x16_bf16 v[48:63], v[172:175], v[180:183], v[48:63]
    v_mfma_f32_32x32x16_bf16 v[64:79], v[172:175], v[188:191], v[64:79]
    v_bfe_u32 v4, v2, 1, 1
    v_bfe_u32 v5, v2, 2, 2
    v_and_b32 v6, 1, v2
    v_xor_b32 v6, v6, v3
    v_lshlrev_b32 v4, 6, v4
    v_lshl_add_u32 v4, v5, 4, v4
    v_lshl_add_u32 v4, v6, 3, v4
    v_lshl_add_u32 v4, v2, 7, v4
    s_lshl_b32 s76, s63, 13
    v_add_u32 v4, s76, v4
    s_lshl_b32 s76, s64, 6
    v_xor_b32 v5, s76, v4
    v_xor_b32 v144, 0, v5
    v_xor_b32 v145, 16, v5
    v_xor_b32 v146, 32, v5
    v_xor_b32 v147, 48, v5
    v_pk_mul_f32 v[80:81], v[80:81], v[120:121] op_sel_hi:[1,0]
    v_pk_mul_f32 v[82:83], v[82:83], v[120:121] op_sel_hi:[1,0]
    v_pk_mul_f32 v[84:85], v[84:85], v[120:121] op_sel_hi:[1,0]
    v_pk_mul_f32 v[86:87], v[86:87], v[120:121] op_sel_hi:[1,0]
    v_pk_mul_f32 v[88:89], v[88:89], v[120:121] op_sel_hi:[1,0]
    v_pk_mul_f32 v[90:91], v[90:91], v[120:121] op_sel_hi:[1,0]
    v_pk_mul_f32 v[92:93], v[92:93], v[120:121] op_sel_hi:[1,0]
    v_pk_mul_f32 v[94:95], v[94:95], v[120:121] op_sel_hi:[1,0]
    v_cvt_pk_bf16_f32 v80, v80, v81
    v_cvt_pk_bf16_f32 v81, v82, v83
    v_cvt_pk_bf16_f32 v82, v84, v85
    v_cvt_pk_bf16_f32 v83, v86, v87
    v_cvt_pk_bf16_f32 v84, v88, v89
    v_cvt_pk_bf16_f32 v85, v90, v91
    v_cvt_pk_bf16_f32 v86, v92, v93
    v_cvt_pk_bf16_f32 v87, v94, v95
    ds_write_b64 v144, v[80:81] offset:32768
    ds_write_b64 v145, v[82:83] offset:32768
    ds_write_b64 v146, v[84:85] offset:32768
    ds_write_b64 v147, v[86:87] offset:32768
    v_pk_mul_f32 v[96:97], v[96:97], v[122:123] op_sel_hi:[1,0]
    v_pk_mul_f32 v[98:99], v[98:99], v[122:123] op_sel_hi:[1,0]
    v_pk_mul_f32 v[100:101], v[100:101], v[122:123] op_sel_hi:[1,0]
    v_pk_mul_f32 v[102:103], v[102:103], v[122:123] op_sel_hi:[1,0]
    v_pk_mul_f32 v[104:105], v[104:105], v[122:123] op_sel_hi:[1,0]
    v_pk_mul_f32 v[106:107], v[106:107], v[122:123] op_sel_hi:[1,0]
    v_pk_mul_f32 v[108:109], v[108:109], v[122:123] op_sel_hi:[1,0]
    v_pk_mul_f32 v[110:111], v[110:111], v[122:123] op_sel_hi:[1,0]
    v_cvt_pk_bf16_f32 v96, v96, v97
    v_cvt_pk_bf16_f32 v97, v98, v99
    v_cvt_pk_bf16_f32 v98, v100, v101
    v_cvt_pk_bf16_f32 v99, v102, v103
    v_cvt_pk_bf16_f32 v100, v104, v105
    v_cvt_pk_bf16_f32 v101, v106, v107
    v_cvt_pk_bf16_f32 v102, v108, v109
    v_cvt_pk_bf16_f32 v103, v110, v111
    ds_write_b64 v144, v[96:97] offset:36864
    ds_write_b64 v145, v[98:99] offset:36864
    ds_write_b64 v146, v[100:101] offset:36864
    ds_write_b64 v147, v[102:103] offset:36864
    s_lshl_b32 s76, s64, 14
    v_add_u32 v4, s76, v4
    v_xor_b32 v144, 0, v4
    v_xor_b32 v145, 16, v4
    v_xor_b32 v146, 32, v4
    v_xor_b32 v147, 48, v4
    v_xor_b32 v148, 64, v4
    v_xor_b32 v149, 80, v4
    v_xor_b32 v150, 96, v4
    v_xor_b32 v151, 112, v4
    v_max3_f32 v136, v48, v49, v50
    v_min3_f32 v138, v48, v49, v50
    v_max3_f32 v136, v136, v51, v52
    v_min3_f32 v138, v138, v51, v52
    v_max3_f32 v136, v136, v53, v54
    v_min3_f32 v138, v138, v53, v54
    v_max3_f32 v136, v136, v55, v56
    v_min3_f32 v138, v138, v55, v56
    v_max3_f32 v136, v136, v57, v58
    v_min3_f32 v138, v138, v57, v58
    v_max3_f32 v136, v136, v59, v60
    v_min3_f32 v138, v138, v59, v60
    v_max3_f32 v136, v136, v61, v62
    v_min3_f32 v138, v138, v61, v62
    v_max_f32 v136, v136, v63
    v_min_f32 v138, v138, v63
    v_max3_f32 v140, v64, v65, v66
    v_min3_f32 v142, v64, v65, v66
    v_max3_f32 v140, v140, v67, v68
    v_min3_f32 v142, v142, v67, v68
    v_max3_f32 v140, v140, v69, v70
    v_min3_f32 v142, v142, v69, v70
    v_max3_f32 v140, v140, v71, v72
    v_min3_f32 v142, v142, v71, v72
    v_max3_f32 v140, v140, v73, v74
    v_min3_f32 v142, v142, v73, v74
    v_max3_f32 v140, v140, v75, v76
    v_min3_f32 v142, v142, v75, v76
    v_max3_f32 v140, v140, v77, v78
    v_min3_f32 v142, v142, v77, v78
    v_max_f32 v140, v140, v79
    v_min_f32 v142, v142, v79
    v_mov_b32 v137, v136
    v_mov_b32 v139, v138
    v_mov_b32 v141, v140
    v_mov_b32 v143, v142
    v_permlane32_swap_b32 v136, v137
    v_permlane32_swap_b32 v138, v139
    v_permlane32_swap_b32 v140, v141
    v_permlane32_swap_b32 v142, v143
    v_max_f32 v136, v136, v137
    v_min_f32 v138, v138, v139
    v_max_f32 v140, v140, v141
    v_min_f32 v142, v142, v143
    v_mul_f32 v136, v136, v121
    v_mul_f32 v138, v138, v121
    v_mul_f32 v140, v140, v123
    v_mul_f32 v142, v142, v123
    v_pk_fma_f32 v[192:193], v[48:49], v[120:121], v[136:137] op_sel:[0,1,0] op_sel_hi:[1,1,0] neg_lo:[0,0,1] neg_hi:[0,0,1]
    v_pk_fma_f32 v[48:49], v[48:49], v[120:121], v[138:139] op_sel:[0,1,0] op_sel_hi:[1,1,0] neg_lo:[0,1,0] neg_hi:[0,1,0]
    v_pk_fma_f32 v[194:195], v[50:51], v[120:121], v[136:137] op_sel:[0,1,0] op_sel_hi:[1,1,0] neg_lo:[0,0,1] neg_hi:[0,0,1]
    v_pk_fma_f32 v[50:51], v[50:51], v[120:121], v[138:139] op_sel:[0,1,0] op_sel_hi:[1,1,0] neg_lo:[0,1,0] neg_hi:[0,1,0]
    v_pk_fma_f32 v[196:197], v[52:53], v[120:121], v[136:137] op_sel:[0,1,0] op_sel_hi:[1,1,0] neg_lo:[0,0,1] neg_hi:[0,0,1]
    v_pk_fma_f32 v[52:53], v[52:53], v[120:121], v[138:139] op_sel:[0,1,0] op_sel_hi:[1,1,0] neg_lo:[0,1,0] neg_hi:[0,1,0]
    v_pk_fma_f32 v[198:199], v[54:55], v[120:121], v[136:137] op_sel:[0,1,0] op_sel_hi:[1,1,0] neg_lo:[0,0,1] neg_hi:[0,0,1]
    v_pk_fma_f32 v[54:55], v[54:55], v[120:121], v[138:139] op_sel:[0,1,0] op_sel_hi:[1,1,0] neg_lo:[0,1,0] neg_hi:[0,1,0]
    v_pk_fma_f32 v[200:201], v[56:57], v[120:121], v[136:137] op_sel:[0,1,0] op_sel_hi:[1,1,0] neg_lo:[0,0,1] neg_hi:[0,0,1]
    v_pk_fma_f32 v[56:57], v[56:57], v[120:121], v[138:139] op_sel:[0,1,0] op_sel_hi:[1,1,0] neg_lo:[0,1,0] neg_hi:[0,1,0]
    v_pk_fma_f32 v[202:203], v[58:59], v[120:121], v[136:137] op_sel:[0,1,0] op_sel_hi:[1,1,0] neg_lo:[0,0,1] neg_hi:[0,0,1]
    v_pk_fma_f32 v[58:59], v[58:59], v[120:121], v[138:139] op_sel:[0,1,0] op_sel_hi:[1,1,0] neg_lo:[0,1,0] neg_hi:[0,1,0]
    v_pk_fma_f32 v[204:205], v[60:61], v[120:121], v[136:137] op_sel:[0,1,0] op_sel_hi:[1,1,0] neg_lo:[0,0,1] neg_hi:[0,0,1]
    v_pk_fma_f32 v[60:61], v[60:61], v[120:121], v[138:139] op_sel:[0,1,0] op_sel_hi:[1,1,0] neg_lo:[0,1,0] neg_hi:[0,1,0]
    v_pk_fma_f32 v[206:207], v[62:63], v[120:121], v[136:137] op_sel:[0,1,0] op_sel_hi:[1,1,0] neg_lo:[0,0,1] neg_hi:[0,0,1]
    v_pk_fma_f32 v[62:63], v[62:63], v[120:121], v[138:139] op_sel:[0,1,0] op_sel_hi:[1,1,0] neg_lo:[0,1,0] neg_hi:[0,1,0]
    v_exp_f32 v192, v192
    v_exp_f32 v48, v48
    v_exp_f32 v193, v193
    v_exp_f32 v49, v49
    v_exp_f32 v194, v194
    v_exp_f32 v50, v50
    v_exp_f32 v195, v195
    v_exp_f32 v51, v51
    v_exp_f32 v196, v196
    v_exp_f32 v52, v52
    v_exp_f32 v197, v197
    v_exp_f32 v53, v53
    v_exp_f32 v198, v198
    v_exp_f32 v54, v54
    v_exp_f32 v199, v199
    v_exp_f32 v55, v55
    v_exp_f32 v200, v200
    v_exp_f32 v56, v56
    v_exp_f32 v201, v201
    v_exp_f32 v57, v57
    v_exp_f32 v202, v202
    v_exp_f32 v58, v58
    v_exp_f32 v203, v203
    v_exp_f32 v59, v59
    v_exp_f32 v204, v204
    v_exp_f32 v60, v60
    v_exp_f32 v205, v205
    v_exp_f32 v61, v61
    v_exp_f32 v206, v206
    v_exp_f32 v62, v62
    v_exp_f32 v207, v207
    v_exp_f32 v63, v63
    v_pk_fma_f32 v[208:209], v[64:65], v[122:123], v[140:141] op_sel:[0,1,0] op_sel_hi:[1,1,0] neg_lo:[0,0,1] neg_hi:[0,0,1]
    v_pk_fma_f32 v[64:65], v[64:65], v[122:123], v[142:143] op_sel:[0,1,0] op_sel_hi:[1,1,0] neg_lo:[0,1,0] neg_hi:[0,1,0]
    v_pk_fma_f32 v[210:211], v[66:67], v[122:123], v[140:141] op_sel:[0,1,0] op_sel_hi:[1,1,0] neg_lo:[0,0,1] neg_hi:[0,0,1]
    v_pk_fma_f32 v[66:67], v[66:67], v[122:123], v[142:143] op_sel:[0,1,0] op_sel_hi:[1,1,0] neg_lo:[0,1,0] neg_hi:[0,1,0]
    v_pk_fma_f32 v[212:213], v[68:69], v[122:123], v[140:141] op_sel:[0,1,0] op_sel_hi:[1,1,0] neg_lo:[0,0,1] neg_hi:[0,0,1]
    v_pk_fma_f32 v[68:69], v[68:69], v[122:123], v[142:143] op_sel:[0,1,0] op_sel_hi:[1,1,0] neg_lo:[0,1,0] neg_hi:[0,1,0]
    v_pk_fma_f32 v[214:215], v[70:71], v[122:123], v[140:141] op_sel:[0,1,0] op_sel_hi:[1,1,0] neg_lo:[0,0,1] neg_hi:[0,0,1]
    v_pk_fma_f32 v[70:71], v[70:71], v[122:123], v[142:143] op_sel:[0,1,0] op_sel_hi:[1,1,0] neg_lo:[0,1,0] neg_hi:[0,1,0]
    v_pk_fma_f32 v[216:217], v[72:73], v[122:123], v[140:141] op_sel:[0,1,0] op_sel_hi:[1,1,0] neg_lo:[0,0,1] neg_hi:[0,0,1]
    v_pk_fma_f32 v[72:73], v[72:73], v[122:123], v[142:143] op_sel:[0,1,0] op_sel_hi:[1,1,0] neg_lo:[0,1,0] neg_hi:[0,1,0]
    v_pk_fma_f32 v[218:219], v[74:75], v[122:123], v[140:141] op_sel:[0,1,0] op_sel_hi:[1,1,0] neg_lo:[0,0,1] neg_hi:[0,0,1]
    v_pk_fma_f32 v[74:75], v[74:75], v[122:123], v[142:143] op_sel:[0,1,0] op_sel_hi:[1,1,0] neg_lo:[0,1,0] neg_hi:[0,1,0]
    v_pk_fma_f32 v[220:221], v[76:77], v[122:123], v[140:141] op_sel:[0,1,0] op_sel_hi:[1,1,0] neg_lo:[0,0,1] neg_hi:[0,0,1]
    v_pk_fma_f32 v[76:77], v[76:77], v[122:123], v[142:143] op_sel:[0,1,0] op_sel_hi:[1,1,0] neg_lo:[0,1,0] neg_hi:[0,1,0]
    v_pk_fma_f32 v[222:223], v[78:79], v[122:123], v[140:141] op_sel:[0,1,0] op_sel_hi:[1,1,0] neg_lo:[0,0,1] neg_hi:[0,0,1]
    v_pk_fma_f32 v[78:79], v[78:79], v[122:123], v[142:143] op_sel:[0,1,0] op_sel_hi:[1,1,0] neg_lo:[0,1,0] neg_hi:[0,1,0]
    v_exp_f32 v208, v208
    v_exp_f32 v64, v64
    v_exp_f32 v209, v209
    v_exp_f32 v65, v65
    v_exp_f32 v210, v210
    v_exp_f32 v66, v66
    v_exp_f32 v211, v211
    v_exp_f32 v67, v67
    v_exp_f32 v212, v212
    v_exp_f32 v68, v68
    v_exp_f32 v213, v213
    v_exp_f32 v69, v69
    v_exp_f32 v214, v214
    v_exp_f32 v70, v70
    v_exp_f32 v215, v215
    v_exp_f32 v71, v71
    v_exp_f32 v216, v216
    v_exp_f32 v72, v72
    v_exp_f32 v217, v217
    v_exp_f32 v73, v73
    v_exp_f32 v218, v218
    v_exp_f32 v74, v74
    v_exp_f32 v219, v219
    v_exp_f32 v75, v75
    v_exp_f32 v220, v220
    v_exp_f32 v76, v76
    v_exp_f32 v221, v221
    v_exp_f32 v77, v77
    v_exp_f32 v222, v222
    v_exp_f32 v78, v78
    v_exp_f32 v223, v223
    v_exp_f32 v79, v79
    v_pk_add_f32 v[176:177], v[192:193], v[194:195]
    v_pk_add_f32 v[176:177], v[176:177], v[196:197]
    v_pk_add_f32 v[176:177], v[176:177], v[198:199]
    v_pk_add_f32 v[176:177], v[176:177], v[200:201]
    v_pk_add_f32 v[176:177], v[176:177], v[202:203]
    v_pk_add_f32 v[176:177], v[176:177], v[204:205]
    v_pk_add_f32 v[176:177], v[176:177], v[206:207]
    v_pk_add_f32 v[178:179], v[48:49], v[50:51]
    v_pk_add_f32 v[178:179], v[178:179], v[52:53]
    v_pk_add_f32 v[178:179], v[178:179], v[54:55]
    v_pk_add_f32 v[178:179], v[178:179], v[56:57]
    v_pk_add_f32 v[178:179], v[178:179], v[58:59]
    v_pk_add_f32 v[178:179], v[178:179], v[60:61]
    v_pk_add_f32 v[178:179], v[178:179], v[62:63]
    v_pk_add_f32 v[180:181], v[208:209], v[210:211]
    v_pk_add_f32 v[180:181], v[180:181], v[212:213]
    v_pk_add_f32 v[180:181], v[180:181], v[214:215]
    v_pk_add_f32 v[180:181], v[180:181], v[216:217]
    v_pk_add_f32 v[180:181], v[180:181], v[218:219]
    v_pk_add_f32 v[180:181], v[180:181], v[220:221]
    v_pk_add_f32 v[180:181], v[180:181], v[222:223]
    v_pk_add_f32 v[182:183], v[64:65], v[66:67]
    v_pk_add_f32 v[182:183], v[182:183], v[68:69]
    v_pk_add_f32 v[182:183], v[182:183], v[70:71]
    v_pk_add_f32 v[182:183], v[182:183], v[72:73]
    v_pk_add_f32 v[182:183], v[182:183], v[74:75]
    v_pk_add_f32 v[182:183], v[182:183], v[76:77]
    v_pk_add_f32 v[182:183], v[182:183], v[78:79]
    v_add_f32 v176, v176, v177
    v_add_f32 v178, v178, v179
    v_add_f32 v180, v180, v181
    v_add_f32 v182, v182, v183
    v_mov_b32 v177, v176
    v_mov_b32 v179, v178
    v_mov_b32 v181, v180
    v_mov_b32 v183, v182
    v_permlane32_swap_b32 v176, v177
    v_permlane32_swap_b32 v178, v179
    v_permlane32_swap_b32 v180, v181
    v_permlane32_swap_b32 v182, v183
    v_add_f32 v176, v176, v177
    v_add_f32 v178, v178, v179
    v_add_f32 v180, v180, v181
    v_add_f32 v182, v182, v183
    v_rcp_f32 v176, v176
    v_rcp_f32 v178, v178
    v_rcp_f32 v180, v180
    v_rcp_f32 v182, v182
    v_pk_mul_f32 v[192:193], v[192:193], v[176:177] op_sel_hi:[1,0]
    v_pk_mul_f32 v[194:195], v[194:195], v[176:177] op_sel_hi:[1,0]
    v_pk_mul_f32 v[196:197], v[196:197], v[176:177] op_sel_hi:[1,0]
    v_pk_mul_f32 v[198:199], v[198:199], v[176:177] op_sel_hi:[1,0]
    v_pk_mul_f32 v[200:201], v[200:201], v[176:177] op_sel_hi:[1,0]
    v_pk_mul_f32 v[202:203], v[202:203], v[176:177] op_sel_hi:[1,0]
    v_pk_mul_f32 v[204:205], v[204:205], v[176:177] op_sel_hi:[1,0]
    v_pk_mul_f32 v[206:207], v[206:207], v[176:177] op_sel_hi:[1,0]
    v_cvt_pk_bf16_f32 v192, v192, v193
    v_cvt_pk_bf16_f32 v193, v194, v195
    v_cvt_pk_bf16_f32 v194, v196, v197
    v_cvt_pk_bf16_f32 v195, v198, v199
    v_cvt_pk_bf16_f32 v196, v200, v201
    v_cvt_pk_bf16_f32 v197, v202, v203
    v_cvt_pk_bf16_f32 v198, v204, v205
    v_cvt_pk_bf16_f32 v199, v206, v207
    ds_write_b64 v144, v[192:193] offset:0
    ds_write_b64 v145, v[194:195] offset:0
    ds_write_b64 v146, v[196:197] offset:0
    ds_write_b64 v147, v[198:199] offset:0
    v_pk_mul_f32 v[48:49], v[48:49], v[178:179] op_sel_hi:[1,0]
    v_pk_mul_f32 v[50:51], v[50:51], v[178:179] op_sel_hi:[1,0]
    v_pk_mul_f32 v[52:53], v[52:53], v[178:179] op_sel_hi:[1,0]
    v_pk_mul_f32 v[54:55], v[54:55], v[178:179] op_sel_hi:[1,0]
    v_pk_mul_f32 v[56:57], v[56:57], v[178:179] op_sel_hi:[1,0]
    v_pk_mul_f32 v[58:59], v[58:59], v[178:179] op_sel_hi:[1,0]
    v_pk_mul_f32 v[60:61], v[60:61], v[178:179] op_sel_hi:[1,0]
    v_pk_mul_f32 v[62:63], v[62:63], v[178:179] op_sel_hi:[1,0]
    v_cvt_pk_bf16_f32 v48, v48, v49
    v_cvt_pk_bf16_f32 v49, v50, v51
    v_cvt_pk_bf16_f32 v50, v52, v53
    v_cvt_pk_bf16_f32 v51, v54, v55
    v_cvt_pk_bf16_f32 v52, v56, v57
    v_cvt_pk_bf16_f32 v53, v58, v59
    v_cvt_pk_bf16_f32 v54, v60, v61
    v_cvt_pk_bf16_f32 v55, v62, v63
    ds_write_b64 v148, v[48:49] offset:0
    ds_write_b64 v149, v[50:51] offset:0
    ds_write_b64 v150, v[52:53] offset:0
    ds_write_b64 v151, v[54:55] offset:0
    v_pk_mul_f32 v[208:209], v[208:209], v[180:181] op_sel_hi:[1,0]
    v_pk_mul_f32 v[210:211], v[210:211], v[180:181] op_sel_hi:[1,0]
    v_pk_mul_f32 v[212:213], v[212:213], v[180:181] op_sel_hi:[1,0]
    v_pk_mul_f32 v[214:215], v[214:215], v[180:181] op_sel_hi:[1,0]
    v_pk_mul_f32 v[216:217], v[216:217], v[180:181] op_sel_hi:[1,0]
    v_pk_mul_f32 v[218:219], v[218:219], v[180:181] op_sel_hi:[1,0]
    v_pk_mul_f32 v[220:221], v[220:221], v[180:181] op_sel_hi:[1,0]
    v_pk_mul_f32 v[222:223], v[222:223], v[180:181] op_sel_hi:[1,0]
    v_cvt_pk_bf16_f32 v208, v208, v209
    v_cvt_pk_bf16_f32 v209, v210, v211
    v_cvt_pk_bf16_f32 v210, v212, v213
    v_cvt_pk_bf16_f32 v211, v214, v215
    v_cvt_pk_bf16_f32 v212, v216, v217
    v_cvt_pk_bf16_f32 v213, v218, v219
    v_cvt_pk_bf16_f32 v214, v220, v221
    v_cvt_pk_bf16_f32 v215, v222, v223
    ds_write_b64 v144, v[208:209] offset:4096
    ds_write_b64 v145, v[210:211] offset:4096
    ds_write_b64 v146, v[212:213] offset:4096
    ds_write_b64 v147, v[214:215] offset:4096
    v_pk_mul_f32 v[64:65], v[64:65], v[182:183] op_sel_hi:[1,0]
    v_pk_mul_f32 v[66:67], v[66:67], v[182:183] op_sel_hi:[1,0]
    v_pk_mul_f32 v[68:69], v[68:69], v[182:183] op_sel_hi:[1,0]
    v_pk_mul_f32 v[70:71], v[70:71], v[182:183] op_sel_hi:[1,0]
    v_pk_mul_f32 v[72:73], v[72:73], v[182:183] op_sel_hi:[1,0]
    v_pk_mul_f32 v[74:75], v[74:75], v[182:183] op_sel_hi:[1,0]
    v_pk_mul_f32 v[76:77], v[76:77], v[182:183] op_sel_hi:[1,0]
    v_pk_mul_f32 v[78:79], v[78:79], v[182:183] op_sel_hi:[1,0]
    v_cvt_pk_bf16_f32 v64, v64, v65
    v_cvt_pk_bf16_f32 v65, v66, v67
    v_cvt_pk_bf16_f32 v66, v68, v69
    v_cvt_pk_bf16_f32 v67, v70, v71
    v_cvt_pk_bf16_f32 v68, v72, v73
    v_cvt_pk_bf16_f32 v69, v74, v75
    v_cvt_pk_bf16_f32 v70, v76, v77
    v_cvt_pk_bf16_f32 v71, v78, v79
    ds_write_b64 v148, v[64:65] offset:4096
    ds_write_b64 v149, v[66:67] offset:4096
    ds_write_b64 v150, v[68:69] offset:4096
    ds_write_b64 v151, v[70:71] offset:4096
    v_bfe_u32 v4, v1, 2, 2
    v_lshl_add_u32 v5, v3, 3, v4
    v_lshlrev_b32 v5, 7, v5
    v_lshrrev_b32 v6, 1, v4
    v_lshl_add_u32 v5, v6, 6, v5
    v_bfe_u32 v6, v1, 4, 1
    v_xor_b32 v6, v6, v3
    v_lshl_add_u32 v5, v6, 5, v5
    v_bfe_u32 v6, v1, 1, 1
    v_lshl_add_u32 v5, v6, 4, v5
    v_xor_b32 v6, v1, v4
    v_and_b32 v6, 1, v6
    v_lshl_add_u32 v5, v6, 3, v5
    s_waitcnt lgkmcnt(0)
    s_lshl_b32 s76, s63, 6
    s_lshl_b32 s77, s64, 14
    s_or_b32 s76, s76, s77
    v_xor_b32 v144, s76, v5
    s_lshl_b32 s76, s64, 6
    v_xor_b32 v146, s76, v5
    v_xor_b32 v145, 528, v144
    v_xor_b32 v147, 528, v146
    s_barrier
    ds_read_b64_tr_b16 v[176:177], v144 offset:0
    ds_read_b64_tr_b16 v[178:179], v145 offset:0
    ds_read_b64_tr_b16 v[208:209], v146 offset:32768
    ds_read_b64_tr_b16 v[210:211], v147 offset:32768
    ds_read_b64_tr_b16 v[180:181], v144 offset:2048
    ds_read_b64_tr_b16 v[182:183], v145 offset:2048
    ds_read_b64_tr_b16 v[212:213], v146 offset:34816
    ds_read_b64_tr_b16 v[214:215], v147 offset:34816
    ds_read_b64_tr_b16 v[184:185], v144 offset:4096
    ds_read_b64_tr_b16 v[186:187], v145 offset:4096
    ds_read_b64_tr_b16 v[216:217], v146 offset:36864
    ds_read_b64_tr_b16 v[218:219], v147 offset:36864
    s_waitcnt lgkmcnt(8)
    v_mfma_f32_32x32x16_bf16 v[48:63], v[176:179], v[208:211], 0
    ds_read_b64_tr_b16 v[188:189], v144 offset:6144
    ds_read_b64_tr_b16 v[190:191], v145 offset:6144
    ds_read_b64_tr_b16 v[220:221], v146 offset:38912
    ds_read_b64_tr_b16 v[222:223], v147 offset:38912
    s_waitcnt lgkmcnt(8)
    v_mfma_f32_32x32x16_bf16 v[48:63], v[180:183], v[212:215], v[48:63]
    ds_read_b64_tr_b16 v[192:193], v144 offset:8192
    ds_read_b64_tr_b16 v[194:195], v145 offset:8192
    ds_read_b64_tr_b16 v[224:225], v146 offset:40960
    ds_read_b64_tr_b16 v[226:227], v147 offset:40960
    s_waitcnt lgkmcnt(8)
    v_mfma_f32_32x32x16_bf16 v[48:63], v[184:187], v[216:219], v[48:63]
    ds_read_b64_tr_b16 v[196:197], v144 offset:10240
    ds_read_b64_tr_b16 v[198:199], v145 offset:10240
    ds_read_b64_tr_b16 v[228:229], v146 offset:43008
    ds_read_b64_tr_b16 v[230:231], v147 offset:43008
    s_waitcnt lgkmcnt(8)
    v_mfma_f32_32x32x16_bf16 v[48:63], v[188:191], v[220:223], v[48:63]
    ds_read_b64_tr_b16 v[200:201], v144 offset:12288
    ds_read_b64_tr_b16 v[202:203], v145 offset:12288
    ds_read_b64_tr_b16 v[232:233], v146 offset:45056
    ds_read_b64_tr_b16 v[234:235], v147 offset:45056
    s_waitcnt lgkmcnt(8)
    v_mfma_f32_32x32x16_bf16 v[48:63], v[192:195], v[224:227], v[48:63]
    ds_read_b64_tr_b16 v[204:205], v144 offset:14336
    ds_read_b64_tr_b16 v[206:207], v145 offset:14336
    ds_read_b64_tr_b16 v[236:237], v146 offset:47104
    ds_read_b64_tr_b16 v[238:239], v147 offset:47104
    s_waitcnt lgkmcnt(8)
    v_mfma_f32_32x32x16_bf16 v[48:63], v[196:199], v[228:231], v[48:63]
    s_waitcnt lgkmcnt(4)
    v_mfma_f32_32x32x16_bf16 v[48:63], v[200:203], v[232:235], v[48:63]
    s_waitcnt lgkmcnt(0)
    v_mfma_f32_32x32x16_bf16 v[48:63], v[204:207], v[236:239], v[48:63]
    s_barrier
    s_lshl_b32 s76, s61, 2
    s_add_u32 s76, s76, s62
    s_lshl_b32 s80, s76, 15
    s_add_u32 s80, s80, 4194304
    s_lshl_b32 s77, s60, 11
    s_add_u32 s77, s77, s80
    s_nop 4
    v_cvt_pk_bf16_f32 v64, v48, v49
    v_cvt_pk_bf16_f32 v65, v50, v51
    v_cvt_pk_bf16_f32 v66, v52, v53
    v_cvt_pk_bf16_f32 v67, v54, v55
    v_cvt_pk_bf16_f32 v68, v56, v57
    v_cvt_pk_bf16_f32 v69, v58, v59
    v_cvt_pk_bf16_f32 v70, v60, v61
    v_cvt_pk_bf16_f32 v71, v62, v63
    buffer_store_dwordx4 v[64:67], v14, s[40:43], s77 offen offset:0 sc1
    buffer_store_dwordx4 v[68:71], v14, s[40:43], s77 offen offset:1024 sc1
    v_dot2_f32_bf16 v72, v176, s89, 0
    v_dot2_f32_bf16 v73, v177, s89, 0
    v_dot2_f32_bf16 v72, v178, s89, v72
    v_dot2_f32_bf16 v73, v179, s89, v73
    v_dot2_f32_bf16 v72, v180, s89, v72
    v_dot2_f32_bf16 v73, v181, s89, v73
    v_dot2_f32_bf16 v72, v182, s89, v72
    v_dot2_f32_bf16 v73, v183, s89, v73
    v_dot2_f32_bf16 v72, v184, s89, v72
    v_dot2_f32_bf16 v73, v185, s89, v73
    v_dot2_f32_bf16 v72, v186, s89, v72
    v_dot2_f32_bf16 v73, v187, s89, v73
    v_dot2_f32_bf16 v72, v188, s89, v72
    v_dot2_f32_bf16 v73, v189, s89, v73
    v_dot2_f32_bf16 v72, v190, s89, v72
    v_dot2_f32_bf16 v73, v191, s89, v73
    v_dot2_f32_bf16 v72, v192, s89, v72
    v_dot2_f32_bf16 v73, v193, s89, v73
    v_dot2_f32_bf16 v72, v194, s89, v72
    v_dot2_f32_bf16 v73, v195, s89, v73
    v_dot2_f32_bf16 v72, v196, s89, v72
    v_dot2_f32_bf16 v73, v197, s89, v73
    v_dot2_f32_bf16 v72, v198, s89, v72
    v_dot2_f32_bf16 v73, v199, s89, v73
    v_dot2_f32_bf16 v72, v200, s89, v72
    v_dot2_f32_bf16 v73, v201, s89, v73
    v_dot2_f32_bf16 v72, v202, s89, v72
    v_dot2_f32_bf16 v73, v203, s89, v73
    v_dot2_f32_bf16 v72, v204, s89, v72
    v_dot2_f32_bf16 v73, v205, s89, v73
    v_dot2_f32_bf16 v72, v206, s89, v72
    v_dot2_f32_bf16 v73, v207, s89, v73
    s_nop 2
    v_add_f32 v72, v72, v73
    v_mov_b32 v73, v72
    s_nop 1
    v_permlane32_swap_b32 v72, v73
    v_add_f32 v72, v72, v73
    v_cvt_pk_bf16_f32 v176, v16, v17
    v_cvt_pk_bf16_f32 v177, v18, v19
    v_cvt_pk_bf16_f32 v178, v20, v21
    v_cvt_pk_bf16_f32 v179, v22, v23
    v_cvt_pk_bf16_f32 v180, v24, v25
    v_cvt_pk_bf16_f32 v181, v26, v27
    v_cvt_pk_bf16_f32 v182, v28, v29
    v_cvt_pk_bf16_f32 v183, v30, v31
    v_cvt_pk_bf16_f32 v184, v32, v33
    v_cvt_pk_bf16_f32 v185, v34, v35
    v_cvt_pk_bf16_f32 v186, v36, v37
    v_cvt_pk_bf16_f32 v187, v38, v39
    v_cvt_pk_bf16_f32 v188, v40, v41
    v_cvt_pk_bf16_f32 v189, v42, v43
    v_cvt_pk_bf16_f32 v190, v44, v45
    v_cvt_pk_bf16_f32 v191, v46, v47
    v_mfma_f32_32x32x16_bf16 v[16:31], v[168:171], v[176:179], 0
    v_mfma_f32_32x32x16_bf16 v[32:47], v[168:171], v[184:187], 0
    v_mfma_f32_32x32x16_bf16 v[16:31], v[172:175], v[180:183], v[16:31]
    v_mfma_f32_32x32x16_bf16 v[32:47], v[172:175], v[188:191], v[32:47]
    v_lshlrev_b32 v4, 2, v2
    s_lshl_b32 s76, s62, 7
    s_add_u32 s76, s76, s74
    s_waitcnt vmcnt(0)
    s_mov_b32 exec_hi, 0
    buffer_store_dword v72, v4, s[40:43], s76 offen offset:2048 sc1
    s_mov_b64 exec, -1
    s_add_u32 s78, s65, 13
    s_and_b32 s78, s78, 15
    s_lshl_b32 s78, s78, 17
    s_lshl_b32 s79, s62, 11
    s_add_u32 m0, s79, 32768
    s_add_u32 s79, s78, 15360
    buffer_load_dwordx4 v15, s[36:39], s78 offen lds
    buffer_load_dwordx4 v15, s[36:39], s79 offen offset:1024 lds
    s_add_u32 s78, s65, 14
    s_and_b32 s78, s78, 15
    s_lshl_b32 s78, s78, 17
    s_lshl_b32 s79, s62, 11
    s_add_u32 m0, s79, 40960
    s_add_u32 s79, s78, 15360
    buffer_load_dwordx4 v15, s[36:39], s78 offen lds
    buffer_load_dwordx4 v15, s[36:39], s79 offen offset:1024 lds
    s_add_u32 s78, s65, 15
    s_and_b32 s78, s78, 15
    s_lshl_b32 s78, s78, 17
    s_lshl_b32 s79, s62, 11
    s_add_u32 m0, s79, 49152
    s_add_u32 s79, s78, 15360
    buffer_load_dwordx4 v15, s[36:39], s78 offen lds
    buffer_load_dwordx4 v15, s[36:39], s79 offen offset:1024 lds
    s_lshl_b32 s76, s61, 7
    s_lshl_b32 s77, s62, 12
    s_add_u32 m0, s77, 0
    s_nop 0
    buffer_load_dwordx4 v152, s[28:31], s76 offen offset:0 lds
    buffer_load_dwordx4 v153, s[28:31], s76 offen offset:1024 lds
    buffer_load_dwordx4 v154, s[28:31], s76 offen offset:2048 lds
    buffer_load_dwordx4 v155, s[28:31], s76 offen offset:3072 lds
    v_max3_f32 v136, v16, v17, v18
    v_min3_f32 v138, v16, v17, v18
    v_max3_f32 v136, v136, v19, v20
    v_min3_f32 v138, v138, v19, v20
    v_max3_f32 v136, v136, v21, v22
    v_min3_f32 v138, v138, v21, v22
    v_max3_f32 v136, v136, v23, v24
    v_min3_f32 v138, v138, v23, v24
    v_max3_f32 v136, v136, v25, v26
    v_min3_f32 v138, v138, v25, v26
    v_max3_f32 v136, v136, v27, v28
    v_min3_f32 v138, v138, v27, v28
    v_max3_f32 v136, v136, v29, v30
    v_min3_f32 v138, v138, v29, v30
    v_max_f32 v136, v136, v31
    v_min_f32 v138, v138, v31
    v_max3_f32 v140, v32, v33, v34
    v_min3_f32 v142, v32, v33, v34
    v_max3_f32 v140, v140, v35, v36
    v_min3_f32 v142, v142, v35, v36
    v_max3_f32 v140, v140, v37, v38
    v_min3_f32 v142, v142, v37, v38
    v_max3_f32 v140, v140, v39, v40
    v_min3_f32 v142, v142, v39, v40
    v_max3_f32 v140, v140, v41, v42
    v_min3_f32 v142, v142, v41, v42
    v_max3_f32 v140, v140, v43, v44
    v_min3_f32 v142, v142, v43, v44
    v_max3_f32 v140, v140, v45, v46
    v_min3_f32 v142, v142, v45, v46
    v_max_f32 v140, v140, v47
    v_min_f32 v142, v142, v47
    v_mov_b32 v137, v136
    v_mov_b32 v139, v138
    v_mov_b32 v141, v140
    v_mov_b32 v143, v142
    v_permlane32_swap_b32 v136, v137
    v_permlane32_swap_b32 v138, v139
    v_permlane32_swap_b32 v140, v141
    v_permlane32_swap_b32 v142, v143
    v_max_f32 v136, v136, v137
    v_min_f32 v138, v138, v139
    v_max_f32 v140, v140, v141
    v_min_f32 v142, v142, v143
    v_mul_f32 v136, v136, v121
    v_mul_f32 v138, v138, v121
    v_mul_f32 v140, v140, v123
    v_mul_f32 v142, v142, v123
    v_pk_fma_f32 v[192:193], v[16:17], v[120:121], v[136:137] op_sel:[0,1,0] op_sel_hi:[1,1,0] neg_lo:[0,0,1] neg_hi:[0,0,1]
    v_pk_fma_f32 v[16:17], v[16:17], v[120:121], v[138:139] op_sel:[0,1,0] op_sel_hi:[1,1,0] neg_lo:[0,1,0] neg_hi:[0,1,0]
    v_pk_fma_f32 v[194:195], v[18:19], v[120:121], v[136:137] op_sel:[0,1,0] op_sel_hi:[1,1,0] neg_lo:[0,0,1] neg_hi:[0,0,1]
    v_pk_fma_f32 v[18:19], v[18:19], v[120:121], v[138:139] op_sel:[0,1,0] op_sel_hi:[1,1,0] neg_lo:[0,1,0] neg_hi:[0,1,0]
    v_pk_fma_f32 v[196:197], v[20:21], v[120:121], v[136:137] op_sel:[0,1,0] op_sel_hi:[1,1,0] neg_lo:[0,0,1] neg_hi:[0,0,1]
    v_pk_fma_f32 v[20:21], v[20:21], v[120:121], v[138:139] op_sel:[0,1,0] op_sel_hi:[1,1,0] neg_lo:[0,1,0] neg_hi:[0,1,0]
    v_pk_fma_f32 v[198:199], v[22:23], v[120:121], v[136:137] op_sel:[0,1,0] op_sel_hi:[1,1,0] neg_lo:[0,0,1] neg_hi:[0,0,1]
    v_pk_fma_f32 v[22:23], v[22:23], v[120:121], v[138:139] op_sel:[0,1,0] op_sel_hi:[1,1,0] neg_lo:[0,1,0] neg_hi:[0,1,0]
    v_pk_fma_f32 v[200:201], v[24:25], v[120:121], v[136:137] op_sel:[0,1,0] op_sel_hi:[1,1,0] neg_lo:[0,0,1] neg_hi:[0,0,1]
    v_pk_fma_f32 v[24:25], v[24:25], v[120:121], v[138:139] op_sel:[0,1,0] op_sel_hi:[1,1,0] neg_lo:[0,1,0] neg_hi:[0,1,0]
    v_pk_fma_f32 v[202:203], v[26:27], v[120:121], v[136:137] op_sel:[0,1,0] op_sel_hi:[1,1,0] neg_lo:[0,0,1] neg_hi:[0,0,1]
    v_pk_fma_f32 v[26:27], v[26:27], v[120:121], v[138:139] op_sel:[0,1,0] op_sel_hi:[1,1,0] neg_lo:[0,1,0] neg_hi:[0,1,0]
    v_pk_fma_f32 v[204:205], v[28:29], v[120:121], v[136:137] op_sel:[0,1,0] op_sel_hi:[1,1,0] neg_lo:[0,0,1] neg_hi:[0,0,1]
    v_pk_fma_f32 v[28:29], v[28:29], v[120:121], v[138:139] op_sel:[0,1,0] op_sel_hi:[1,1,0] neg_lo:[0,1,0] neg_hi:[0,1,0]
    v_pk_fma_f32 v[206:207], v[30:31], v[120:121], v[136:137] op_sel:[0,1,0] op_sel_hi:[1,1,0] neg_lo:[0,0,1] neg_hi:[0,0,1]
    v_pk_fma_f32 v[30:31], v[30:31], v[120:121], v[138:139] op_sel:[0,1,0] op_sel_hi:[1,1,0] neg_lo:[0,1,0] neg_hi:[0,1,0]
    v_exp_f32 v192, v192
    v_exp_f32 v16, v16
    v_exp_f32 v193, v193
    v_exp_f32 v17, v17
    v_exp_f32 v194, v194
    v_exp_f32 v18, v18
    v_exp_f32 v195, v195
    v_exp_f32 v19, v19
    v_exp_f32 v196, v196
    v_exp_f32 v20, v20
    v_exp_f32 v197, v197
    v_exp_f32 v21, v21
    v_exp_f32 v198, v198
    v_exp_f32 v22, v22
    v_exp_f32 v199, v199
    v_exp_f32 v23, v23
    v_exp_f32 v200, v200
    v_exp_f32 v24, v24
    v_exp_f32 v201, v201
    v_exp_f32 v25, v25
    v_exp_f32 v202, v202
    v_exp_f32 v26, v26
    v_exp_f32 v203, v203
    v_exp_f32 v27, v27
    v_exp_f32 v204, v204
    v_exp_f32 v28, v28
    v_exp_f32 v205, v205
    v_exp_f32 v29, v29
    v_exp_f32 v206, v206
    v_exp_f32 v30, v30
    v_exp_f32 v207, v207
    v_exp_f32 v31, v31
    v_pk_fma_f32 v[208:209], v[32:33], v[122:123], v[140:141] op_sel:[0,1,0] op_sel_hi:[1,1,0] neg_lo:[0,0,1] neg_hi:[0,0,1]
    v_pk_fma_f32 v[32:33], v[32:33], v[122:123], v[142:143] op_sel:[0,1,0] op_sel_hi:[1,1,0] neg_lo:[0,1,0] neg_hi:[0,1,0]
    v_pk_fma_f32 v[210:211], v[34:35], v[122:123], v[140:141] op_sel:[0,1,0] op_sel_hi:[1,1,0] neg_lo:[0,0,1] neg_hi:[0,0,1]
    v_pk_fma_f32 v[34:35], v[34:35], v[122:123], v[142:143] op_sel:[0,1,0] op_sel_hi:[1,1,0] neg_lo:[0,1,0] neg_hi:[0,1,0]
    v_pk_fma_f32 v[212:213], v[36:37], v[122:123], v[140:141] op_sel:[0,1,0] op_sel_hi:[1,1,0] neg_lo:[0,0,1] neg_hi:[0,0,1]
    v_pk_fma_f32 v[36:37], v[36:37], v[122:123], v[142:143] op_sel:[0,1,0] op_sel_hi:[1,1,0] neg_lo:[0,1,0] neg_hi:[0,1,0]
    v_pk_fma_f32 v[214:215], v[38:39], v[122:123], v[140:141] op_sel:[0,1,0] op_sel_hi:[1,1,0] neg_lo:[0,0,1] neg_hi:[0,0,1]
    v_pk_fma_f32 v[38:39], v[38:39], v[122:123], v[142:143] op_sel:[0,1,0] op_sel_hi:[1,1,0] neg_lo:[0,1,0] neg_hi:[0,1,0]
    v_pk_fma_f32 v[216:217], v[40:41], v[122:123], v[140:141] op_sel:[0,1,0] op_sel_hi:[1,1,0] neg_lo:[0,0,1] neg_hi:[0,0,1]
    v_pk_fma_f32 v[40:41], v[40:41], v[122:123], v[142:143] op_sel:[0,1,0] op_sel_hi:[1,1,0] neg_lo:[0,1,0] neg_hi:[0,1,0]
    v_pk_fma_f32 v[218:219], v[42:43], v[122:123], v[140:141] op_sel:[0,1,0] op_sel_hi:[1,1,0] neg_lo:[0,0,1] neg_hi:[0,0,1]
    v_pk_fma_f32 v[42:43], v[42:43], v[122:123], v[142:143] op_sel:[0,1,0] op_sel_hi:[1,1,0] neg_lo:[0,1,0] neg_hi:[0,1,0]
    v_pk_fma_f32 v[220:221], v[44:45], v[122:123], v[140:141] op_sel:[0,1,0] op_sel_hi:[1,1,0] neg_lo:[0,0,1] neg_hi:[0,0,1]
    v_pk_fma_f32 v[44:45], v[44:45], v[122:123], v[142:143] op_sel:[0,1,0] op_sel_hi:[1,1,0] neg_lo:[0,1,0] neg_hi:[0,1,0]
    v_pk_fma_f32 v[222:223], v[46:47], v[122:123], v[140:141] op_sel:[0,1,0] op_sel_hi:[1,1,0] neg_lo:[0,0,1] neg_hi:[0,0,1]
    v_pk_fma_f32 v[46:47], v[46:47], v[122:123], v[142:143] op_sel:[0,1,0] op_sel_hi:[1,1,0] neg_lo:[0,1,0] neg_hi:[0,1,0]
    v_exp_f32 v208, v208
    v_exp_f32 v32, v32
    v_exp_f32 v209, v209
    v_exp_f32 v33, v33
    v_exp_f32 v210, v210
    v_exp_f32 v34, v34
    v_exp_f32 v211, v211
    v_exp_f32 v35, v35
    v_exp_f32 v212, v212
    v_exp_f32 v36, v36
    v_exp_f32 v213, v213
    v_exp_f32 v37, v37
    v_exp_f32 v214, v214
    v_exp_f32 v38, v38
    v_exp_f32 v215, v215
    v_exp_f32 v39, v39
    v_exp_f32 v216, v216
    v_exp_f32 v40, v40
    v_exp_f32 v217, v217
    v_exp_f32 v41, v41
    v_exp_f32 v218, v218
    v_exp_f32 v42, v42
    v_exp_f32 v219, v219
    v_exp_f32 v43, v43
    v_exp_f32 v220, v220
    v_exp_f32 v44, v44
    v_exp_f32 v221, v221
    v_exp_f32 v45, v45
    v_exp_f32 v222, v222
    v_exp_f32 v46, v46
    v_exp_f32 v223, v223
    v_exp_f32 v47, v47
    v_cvt_pk_bf16_f32 v224, v192, v193
    v_cvt_pk_bf16_f32 v225, v194, v195
    v_cvt_pk_bf16_f32 v226, v196, v197
    v_cvt_pk_bf16_f32 v227, v198, v199
    v_cvt_pk_bf16_f32 v228, v200, v201
    v_cvt_pk_bf16_f32 v229, v202, v203
    v_cvt_pk_bf16_f32 v230, v204, v205
    v_cvt_pk_bf16_f32 v231, v206, v207
    v_cvt_pk_bf16_f32 v232, v16, v17
    v_cvt_pk_bf16_f32 v233, v18, v19
    v_cvt_pk_bf16_f32 v234, v20, v21
    v_cvt_pk_bf16_f32 v235, v22, v23
    v_cvt_pk_bf16_f32 v236, v24, v25
    v_cvt_pk_bf16_f32 v237, v26, v27
    v_cvt_pk_bf16_f32 v238, v28, v29
    v_cvt_pk_bf16_f32 v239, v30, v31
    v_cvt_pk_bf16_f32 v240, v208, v209
    v_cvt_pk_bf16_f32 v241, v210, v211
    v_cvt_pk_bf16_f32 v242, v212, v213
    v_cvt_pk_bf16_f32 v243, v214, v215
    v_cvt_pk_bf16_f32 v244, v216, v217
    v_cvt_pk_bf16_f32 v245, v218, v219
    v_cvt_pk_bf16_f32 v246, v220, v221
    v_cvt_pk_bf16_f32 v247, v222, v223
    v_cvt_pk_bf16_f32 v248, v32, v33
    v_cvt_pk_bf16_f32 v249, v34, v35
    v_cvt_pk_bf16_f32 v250, v36, v37
    v_cvt_pk_bf16_f32 v251, v38, v39
    v_cvt_pk_bf16_f32 v252, v40, v41
    v_cvt_pk_bf16_f32 v253, v42, v43
    v_cvt_pk_bf16_f32 v254, v44, v45
    v_cvt_pk_bf16_f32 v255, v46, v47
    v_and_b32 v4, 1, v2
    v_lshlrev_b32 v4, 4, v4
    v_mov_b32 v5, 0x3f80
    v_lshlrev_b32 v4, v4, v5
    v_lshrrev_b32 v5, 3, v2
    v_bfe_u32 v6, v2, 1, 1
    v_lshl_add_u32 v5, v5, 1, v6
    v_bfe_u32 v6, v2, 2, 1
    v_xor_b32 v6, v6, v3
    v_lshl_add_u32 v5, v6, 4, v5
    v_cmp_eq_u32 vcc, 0, v5
    s_nop 1
    v_cndmask_b32 v112, 0, v4, vcc
    v_cmp_eq_u32 vcc, 1, v5
    s_nop 1
    v_cndmask_b32 v113, 0, v4, vcc
    v_cmp_eq_u32 vcc, 2, v5
    s_nop 1
    v_cndmask_b32 v114, 0, v4, vcc
    v_cmp_eq_u32 vcc, 3, v5
    s_nop 1
    v_cndmask_b32 v115, 0, v4, vcc
    v_cmp_eq_u32 vcc, 4, v5
    s_nop 1
    v_cndmask_b32 v116, 0, v4, vcc
    v_cmp_eq_u32 vcc, 5, v5
    s_nop 1
    v_cndmask_b32 v117, 0, v4, vcc
    v_cmp_eq_u32 vcc, 6, v5
    s_nop 1
    v_cndmask_b32 v118, 0, v4, vcc
    v_cmp_eq_u32 vcc, 7, v5
    s_nop 1
    v_cndmask_b32 v119, 0, v4, vcc
    v_mov_b32 v4, s89
    v_lshlrev_b32 v5, 2, v1
    ds_write_b32 v5, v4 offset:24832
    v_mul_u32_u24 v6, 198656, v3
    v_lshl_add_u32 v6, v2, 2, v6
    s_mov_b32 s88, 0
L_spin_6:
    s_mul_i32 s76, s61, 12416
    s_lshl_b32 s77, s62, 7
    s_add_u32 s76, s76, s77
    buffer_load_dword v120, v6, s[40:43], s76 offen offset:2048 sc1
    s_add_u32 s76, s76, 397312
    buffer_load_dword v121, v6, s[40:43], s76 offen offset:2048 sc1
    s_add_u32 s76, s76, 397312
    buffer_load_dword v122, v6, s[40:43], s76 offen offset:2048 sc1
    s_add_u32 s76, s76, 397312
    buffer_load_dword v123, v6, s[40:43], s76 offen offset:2048 sc1
    s_add_u32 s76, s76, 397312
    buffer_load_dword v124, v6, s[40:43], s76 offen offset:2048 sc1
    s_add_u32 s76, s76, 397312
    buffer_load_dword v125, v6, s[40:43], s76 offen offset:2048 sc1
    s_add_u32 s76, s76, 397312
    buffer_load_dword v126, v6, s[40:43], s76 offen offset:2048 sc1
    s_add_u32 s76, s76, 397312
    buffer_load_dword v127, v6, s[40:43], s76 offen offset:2048 sc1
    s_waitcnt vmcnt(0)
    v_max3_u32 v4, v120, v121, v122
    v_max3_u32 v5, v123, v124, v125
    v_max3_u32 v4, v4, v126, v127
    v_max_u32 v4, v4, v5
    v_cmp_eq_u32 vcc, -1, v4
    s_nop 0
    s_cbranch_vccz L_ok_7
    s_add_u32 s88, s88, 1
    s_cmp_lt_u32 s88, 65536
    s_cbranch_scc1 L_spin_6
L_ok_7:
    s_add_u32 s76, s65, 0
    s_and_b32 s76, s76, 15
    s_lshl_b32 s76, s76, 11
    s_add_u32 s76, s76, s80
    buffer_load_dwordx4 a[0:3], v14, s[40:43], s76 offen offset:0 sc1
    buffer_load_dwordx4 a[4:7], v14, s[40:43], s76 offen offset:1024 sc1
    s_add_u32 s76, s65, 1
    s_and_b32 s76, s76, 15
    s_lshl_b32 s76, s76, 11
    s_add_u32 s76, s76, s80
    buffer_load_dwordx4 a[8:11], v14, s[40:43], s76 offen offset:0 sc1
    buffer_load_dwordx4 a[12:15], v14, s[40:43], s76 offen offset:1024 sc1
    s_add_u32 s76, s65, 2
    s_and_b32 s76, s76, 15
    s_lshl_b32 s76, s76, 11
    s_add_u32 s76, s76, s80
    buffer_load_dwordx4 a[16:19], v14, s[40:43], s76 offen offset:0 sc1
    buffer_load_dwordx4 a[20:23], v14, s[40:43], s76 offen offset:1024 sc1
    s_add_u32 s76, s65, 3
    s_and_b32 s76, s76, 15
    s_lshl_b32 s76, s76, 11
    s_add_u32 s76, s76, s80
    buffer_load_dwordx4 a[24:27], v14, s[40:43], s76 offen offset:0 sc1
    buffer_load_dwordx4 a[28:31], v14, s[40:43], s76 offen offset:1024 sc1
    s_add_u32 s76, s65, 4
    s_and_b32 s76, s76, 15
    s_lshl_b32 s76, s76, 11
    s_add_u32 s76, s76, s80
    buffer_load_dwordx4 a[32:35], v14, s[40:43], s76 offen offset:0 sc1
    buffer_load_dwordx4 a[36:39], v14, s[40:43], s76 offen offset:1024 sc1
    s_add_u32 s76, s65, 5
    s_and_b32 s76, s76, 15
    s_lshl_b32 s76, s76, 11
    s_add_u32 s76, s76, s80
    buffer_load_dwordx4 a[40:43], v14, s[40:43], s76 offen offset:0 sc1
    buffer_load_dwordx4 a[44:47], v14, s[40:43], s76 offen offset:1024 sc1
    v_add_f32 v120, v120, v124
    v_add_f32 v121, v121, v125
    v_add_f32 v122, v122, v126
    v_add_f32 v123, v123, v127
    v_add_f32 v120, v120, v122
    v_add_f32 v121, v121, v123
    v_add_f32 v120, v120, v121
    v_mov_b32 v121, v120
    s_nop 1
    v_permlane32_swap_b32 v120, v121
    v_add_f32 v120, v120, v121
    v_cvt_pk_bf16_f32 v120, v120, v120
    v_and_b32 v4, 19, v2
    v_lshlrev_b32 v4, 1, v4
    v_bfe_u32 v5, v2, 2, 1
    v_lshl_add_u32 v4, v5, 4, v4
    v_and_b32 v5, 8, v2
    s_lshl_b32 s77, s62, 6
    v_add3_u32 v4, v4, v5, s77
    ds_write_b16 v4, v120 offset:24576
    s_add_u32 s76, s65, 6
    s_and_b32 s76, s76, 15
    s_lshl_b32 s76, s76, 11
    s_add_u32 s76, s76, s80
    buffer_load_dwordx4 a[48:51], v14, s[40:43], s76 offen offset:0 sc1
    buffer_load_dwordx4 a[52:55], v14, s[40:43], s76 offen offset:1024 sc1
    s_waitcnt vmcnt(13)
    v_mfma_f32_32x32x16_bf16 v[16:31], v[112:115], a[0:3], 0
    s_waitcnt vmcnt(12)
    v_mfma_f32_32x32x16_bf16 v[16:31], v[116:119], a[4:7], v[16:31]
    s_add_u32 s76, s65, 7
    s_and_b32 s76, s76, 15
    s_lshl_b32 s76, s76, 11
    s_add_u32 s76, s76, s80
    buffer_load_dwordx4 a[56:59], v14, s[40:43], s76 offen offset:0 sc1
    buffer_load_dwordx4 a[60:63], v14, s[40:43], s76 offen offset:1024 sc1
    s_waitcnt vmcnt(13)
    v_mfma_f32_32x32x16_bf16 v[16:31], v[112:115], a[8:11], v[16:31]
    s_waitcnt vmcnt(12)
    v_mfma_f32_32x32x16_bf16 v[16:31], v[116:119], a[12:15], v[16:31]
    s_add_u32 s76, s65, 8
    s_and_b32 s76, s76, 15
    s_lshl_b32 s76, s76, 11
    s_add_u32 s76, s76, s80
    buffer_load_dwordx4 a[64:67], v14, s[40:43], s76 offen offset:0 sc1
    buffer_load_dwordx4 a[68:71], v14, s[40:43], s76 offen offset:1024 sc1
    s_waitcnt vmcnt(13)
    v_mfma_f32_32x32x16_bf16 v[16:31], v[112:115], a[16:19], v[16:31]
    s_waitcnt vmcnt(12)
    v_mfma_f32_32x32x16_bf16 v[16:31], v[116:119], a[20:23], v[16:31]
    s_add_u32 s76, s65, 9
    s_and_b32 s76, s76, 15
    s_lshl_b32 s76, s76, 11
    s_add_u32 s76, s76, s80
    buffer_load_dwordx4 a[72:75], v14, s[40:43], s76 offen offset:0 sc1
    buffer_load_dwordx4 a[76:79], v14, s[40:43], s76 offen offset:1024 sc1
    s_waitcnt vmcnt(13)
    v_mfma_f32_32x32x16_bf16 v[16:31], v[112:115], a[24:27], v[16:31]
    s_waitcnt vmcnt(12)
    v_mfma_f32_32x32x16_bf16 v[16:31], v[116:119], a[28:31], v[16:31]
    s_add_u32 s76, s65, 10
    s_and_b32 s76, s76, 15
    s_lshl_b32 s76, s76, 11
    s_add_u32 s76, s76, s80
    buffer_load_dwordx4 a[80:83], v14, s[40:43], s76 offen offset:0 sc1
    buffer_load_dwordx4 a[84:87], v14, s[40:43], s76 offen offset:1024 sc1
    s_waitcnt vmcnt(13)
    v_mfma_f32_32x32x16_bf16 v[16:31], v[112:115], a[32:35], v[16:31]
    s_waitcnt vmcnt(12)
    v_mfma_f32_32x32x16_bf16 v[16:31], v[116:119], a[36:39], v[16:31]
    s_add_u32 s76, s65, 11
    s_and_b32 s76, s76, 15
    s_lshl_b32 s76, s76, 11
    s_add_u32 s76, s76, s80
    buffer_load_dwordx4 a[88:91], v14, s[40:43], s76 offen offset:0 sc1
    buffer_load_dwordx4 a[92:95], v14, s[40:43], s76 offen offset:1024 sc1
    s_waitcnt vmcnt(13)
    v_mfma_f32_32x32x16_bf16 v[16:31], v[112:115], a[40:43], v[16:31]
    s_waitcnt vmcnt(12)
    v_mfma_f32_32x32x16_bf16 v[16:31], v[116:119], a[44:47], v[16:31]
    s_add_u32 s76, s65, 12
    s_and_b32 s76, s76, 15
    s_lshl_b32 s76, s76, 11
    s_add_u32 s76, s76, s80
    buffer_load_dwordx4 a[96:99], v14, s[40:43], s76 offen offset:0 sc1
    buffer_load_dwordx4 a[100:103], v14, s[40:43], s76 offen offset:1024 sc1
    s_waitcnt vmcnt(13)
    v_mfma_f32_32x32x16_bf16 v[16:31], v[112:115], a[48:51], v[16:31]
    s_waitcnt vmcnt(12)
    v_mfma_f32_32x32x16_bf16 v[16:31], v[116:119], a[52:55], v[16:31]
    s_add_u32 s76, s65, 13
    s_and_b32 s76, s76, 15
    s_lshl_b32 s76, s76, 11
    s_add_u32 s76, s76, s80
    buffer_load_dwordx4 a[104:107], v14, s[40:43], s76 offen offset:0 sc1
    buffer_load_dwordx4 a[108:111], v14, s[40:43], s76 offen offset:1024 sc1
    s_waitcnt vmcnt(13)
    v_mfma_f32_32x32x16_bf16 v[16:31], v[112:115], a[56:59], v[16:31]
    s_waitcnt vmcnt(12)
    v_mfma_f32_32x32x16_bf16 v[16:31], v[116:119], a[60:63], v[16:31]
    s_add_u32 s76, s65, 14
    s_and_b32 s76, s76, 15
    s_lshl_b32 s76, s76, 11
    s_add_u32 s76, s76, s80
    buffer_load_dwordx4 a[112:115], v14, s[40:43], s76 offen offset:0 sc1
    buffer_load_dwordx4 a[116:119], v14, s[40:43], s76 offen offset:1024 sc1
    s_waitcnt vmcnt(13)
    v_mfma_f32_32x32x16_bf16 v[16:31], v[112:115], a[64:67], v[16:31]
    s_waitcnt vmcnt(12)
    v_mfma_f32_32x32x16_bf16 v[16:31], v[116:119], a[68:71], v[16:31]
    s_add_u32 s76, s65, 15
    s_and_b32 s76, s76, 15
    s_lshl_b32 s76, s76, 11
    s_add_u32 s76, s76, s80
    buffer_load_dwordx4 a[120:123], v14, s[40:43], s76 offen offset:0 sc1
    buffer_load_dwordx4 a[124:127], v14, s[40:43], s76 offen offset:1024 sc1
    s_waitcnt vmcnt(13)
    v_mfma_f32_32x32x16_bf16 v[16:31], v[112:115], a[72:75], v[16:31]
    s_waitcnt vmcnt(12)
    v_mfma_f32_32x32x16_bf16 v[16:31], v[116:119], a[76:79], v[16:31]
    s_waitcnt vmcnt(11)
    v_mfma_f32_32x32x16_bf16 v[16:31], v[112:115], a[80:83], v[16:31]
    s_waitcnt vmcnt(10)
    v_mfma_f32_32x32x16_bf16 v[16:31], v[116:119], a[84:87], v[16:31]
    s_waitcnt vmcnt(9)
    v_mfma_f32_32x32x16_bf16 v[16:31], v[112:115], a[88:91], v[16:31]
    s_waitcnt vmcnt(8)
    v_mfma_f32_32x32x16_bf16 v[16:31], v[116:119], a[92:95], v[16:31]
    s_waitcnt vmcnt(7)
    v_mfma_f32_32x32x16_bf16 v[16:31], v[112:115], a[96:99], v[16:31]
    s_waitcnt vmcnt(6)
    v_mfma_f32_32x32x16_bf16 v[16:31], v[116:119], a[100:103], v[16:31]
    s_waitcnt vmcnt(5)
    v_mfma_f32_32x32x16_bf16 v[16:31], v[112:115], a[104:107], v[16:31]
    s_waitcnt vmcnt(4)
    v_mfma_f32_32x32x16_bf16 v[16:31], v[116:119], a[108:111], v[16:31]
    s_waitcnt vmcnt(3)
    v_mfma_f32_32x32x16_bf16 v[16:31], v[112:115], a[112:115], v[16:31]
    s_waitcnt vmcnt(2)
    v_mfma_f32_32x32x16_bf16 v[16:31], v[116:119], a[116:119], v[16:31]
    s_waitcnt vmcnt(1)
    v_mfma_f32_32x32x16_bf16 v[16:31], v[112:115], a[120:123], v[16:31]
    s_waitcnt vmcnt(0)
    v_mfma_f32_32x32x16_bf16 v[16:31], v[116:119], a[124:127], v[16:31]
    s_lshl_b32 s76, s62, 11
    s_add_u32 s76, s76, 16384
    v_add_u32 v4, s76, v14
    s_lshl_b32 s76, s64, 12
    s_add_u32 s76, s76, 16384
    v_add_u32 v5, s76, v14
    v_and_b32 v6, 1, v1
    v_lshlrev_b32 v6, 8, v6
    v_lshl_add_u32 v6, v3, 4, v6
    s_lshl_b32 s76, s64, 7
    v_add_u32 v6, s76, v6
    s_nop 0
    v_cvt_pk_bf16_f32 v32, v16, v17
    v_cvt_pk_bf16_f32 v33, v18, v19
    v_cvt_pk_bf16_f32 v34, v20, v21
    v_cvt_pk_bf16_f32 v35, v22, v23
    v_cvt_pk_bf16_f32 v36, v24, v25
    v_cvt_pk_bf16_f32 v37, v26, v27
    v_cvt_pk_bf16_f32 v38, v28, v29
    v_cvt_pk_bf16_f32 v39, v30, v31
    ds_write_b128 v4, v[32:35] offset:0
    ds_write_b128 v4, v[36:39] offset:1024
    s_waitcnt lgkmcnt(0)
    s_barrier
    ds_read_b128 v[16:19], v6 offset:24576
    ds_read_b128 v[20:23], v6 offset:24608
    ds_read_b128 v[24:27], v6 offset:24640
    ds_read_b128 v[28:31], v6 offset:24672
    ds_read_b128 v[32:35], v5 offset:0
    ds_read_b128 v[36:39], v5 offset:1024
    ds_read_b128 v[40:43], v5 offset:2048
    ds_read_b128 v[44:47], v5 offset:3072
    s_waitcnt lgkmcnt(4)
    v_mfma_f32_32x32x16_bf16 v[48:63], v[16:19], v[224:227], 0
    v_mfma_f32_32x32x16_bf16 v[64:79], v[24:27], v[232:235], 0
    v_mfma_f32_32x32x16_bf16 v[80:95], v[16:19], v[240:243], 0
    v_mfma_f32_32x32x16_bf16 v[96:111], v[24:27], v[248:251], 0
    v_mfma_f32_32x32x16_bf16 v[48:63], v[20:23], v[228:231], v[48:63]
    v_mfma_f32_32x32x16_bf16 v[64:79], v[28:31], v[236:239], v[64:79]
    v_mfma_f32_32x32x16_bf16 v[80:95], v[20:23], v[244:247], v[80:95]
    v_mfma_f32_32x32x16_bf16 v[96:111], v[28:31], v[252:255], v[96:111]
    s_waitcnt lgkmcnt(0)
    v_mfma_f32_32x32x16_bf16 v[112:127], v[32:35], v[224:227], 0
    v_mfma_f32_32x32x16_bf16 v[128:143], v[40:43], v[232:235], 0
    v_mfma_f32_32x32x16_bf16 v[112:127], v[36:39], v[228:231], v[112:127]
    v_mfma_f32_32x32x16_bf16 v[128:143], v[44:47], v[236:239], v[128:143]
    v_mfma_f32_32x32x16_bf16 v[144:159], v[32:35], v[240:243], 0
    v_mfma_f32_32x32x16_bf16 v[160:175], v[40:43], v[248:251], 0
    v_mfma_f32_32x32x16_bf16 v[144:159], v[36:39], v[244:247], v[144:159]
    v_mfma_f32_32x32x16_bf16 v[160:175], v[44:47], v[252:255], v[160:175]
    v_rcp_f32 v176, v49
    v_rcp_f32 v177, v65
    v_rcp_f32 v178, v81
    v_rcp_f32 v179, v97
    v_mul_f32 v4, v48, v176
    v_fmac_f32 v4, v64, v177
    v_add_f32 v4, 0x358637bd, v4
    v_mul_f32 v5, v80, v178
    v_fmac_f32 v5, v96, v179
    v_add_f32 v5, 0x358637bd, v5
    v_rcp_f32 v4, v4
    v_rcp_f32 v5, v5
    v_mul_f32 v176, v176, v4
    v_mul_f32 v177, v177, v4
    v_mul_f32 v178, v178, v5
    v_mul_f32 v179, v179, v5
    s_lshl_b32 s76, s60, 18
    s_lshl_b32 s77, s63, 17
    s_add_u32 s76, s76, s77
    s_lshl_b32 s77, s61, 12
    s_add_u32 s76, s76, s77
    s_lshl_b32 s77, s64, 11
    s_add_u32 s76, s76, s77
    s_add_u32 s76, s76, 8388608
    s_add_u32 s77, s76, 65536
    v_pk_mul_f32 v[112:113], v[112:113], v[176:177] op_sel_hi:[1,0]
    v_pk_fma_f32 v[112:113], v[128:129], v[176:177], v[112:113] op_sel:[0,1,0] op_sel_hi:[1,1,1]
    v_pk_mul_f32 v[114:115], v[114:115], v[176:177] op_sel_hi:[1,0]
    v_pk_fma_f32 v[114:115], v[130:131], v[176:177], v[114:115] op_sel:[0,1,0] op_sel_hi:[1,1,1]
    v_pk_mul_f32 v[116:117], v[116:117], v[176:177] op_sel_hi:[1,0]
    v_pk_fma_f32 v[116:117], v[132:133], v[176:177], v[116:117] op_sel:[0,1,0] op_sel_hi:[1,1,1]
    v_pk_mul_f32 v[118:119], v[118:119], v[176:177] op_sel_hi:[1,0]
    v_pk_fma_f32 v[118:119], v[134:135], v[176:177], v[118:119] op_sel:[0,1,0] op_sel_hi:[1,1,1]
    v_pk_mul_f32 v[120:121], v[120:121], v[176:177] op_sel_hi:[1,0]
    v_pk_fma_f32 v[120:121], v[136:137], v[176:177], v[120:121] op_sel:[0,1,0] op_sel_hi:[1,1,1]
    v_pk_mul_f32 v[122:123], v[122:123], v[176:177] op_sel_hi:[1,0]
    v_pk_fma_f32 v[122:123], v[138:139], v[176:177], v[122:123] op_sel:[0,1,0] op_sel_hi:[1,1,1]
    v_pk_mul_f32 v[124:125], v[124:125], v[176:177] op_sel_hi:[1,0]
    v_pk_fma_f32 v[124:125], v[140:141], v[176:177], v[124:125] op_sel:[0,1,0] op_sel_hi:[1,1,1]
    v_pk_mul_f32 v[126:127], v[126:127], v[176:177] op_sel_hi:[1,0]
    v_pk_fma_f32 v[126:127], v[142:143], v[176:177], v[126:127] op_sel:[0,1,0] op_sel_hi:[1,1,1]
    v_cvt_pk_bf16_f32 v180, v112, v113
    v_cvt_pk_bf16_f32 v181, v114, v115
    v_cvt_pk_bf16_f32 v182, v116, v117
    v_cvt_pk_bf16_f32 v183, v118, v119
    v_cvt_pk_bf16_f32 v184, v120, v121
    v_cvt_pk_bf16_f32 v185, v122, v123
    v_cvt_pk_bf16_f32 v186, v124, v125
    v_cvt_pk_bf16_f32 v187, v126, v127
    buffer_store_dwordx4 v[180:183], v14, s[40:43], s76 offen offset:0 sc1
    buffer_store_dwordx4 v[184:187], v14, s[40:43], s76 offen offset:1024 sc1
    v_pk_mul_f32 v[144:145], v[144:145], v[178:179] op_sel_hi:[1,0]
    v_pk_fma_f32 v[144:145], v[160:161], v[178:179], v[144:145] op_sel:[0,1,0] op_sel_hi:[1,1,1]
    v_pk_mul_f32 v[146:147], v[146:147], v[178:179] op_sel_hi:[1,0]
    v_pk_fma_f32 v[146:147], v[162:163], v[178:179], v[146:147] op_sel:[0,1,0] op_sel_hi:[1,1,1]
    v_pk_mul_f32 v[148:149], v[148:149], v[178:179] op_sel_hi:[1,0]
    v_pk_fma_f32 v[148:149], v[164:165], v[178:179], v[148:149] op_sel:[0,1,0] op_sel_hi:[1,1,1]
    v_pk_mul_f32 v[150:151], v[150:151], v[178:179] op_sel_hi:[1,0]
    v_pk_fma_f32 v[150:151], v[166:167], v[178:179], v[150:151] op_sel:[0,1,0] op_sel_hi:[1,1,1]
    v_pk_mul_f32 v[152:153], v[152:153], v[178:179] op_sel_hi:[1,0]
    v_pk_fma_f32 v[152:153], v[168:169], v[178:179], v[152:153] op_sel:[0,1,0] op_sel_hi:[1,1,1]
    v_pk_mul_f32 v[154:155], v[154:155], v[178:179] op_sel_hi:[1,0]
    v_pk_fma_f32 v[154:155], v[170:171], v[178:179], v[154:155] op_sel:[0,1,0] op_sel_hi:[1,1,1]
    v_pk_mul_f32 v[156:157], v[156:157], v[178:179] op_sel_hi:[1,0]
    v_pk_fma_f32 v[156:157], v[172:173], v[178:179], v[156:157] op_sel:[0,1,0] op_sel_hi:[1,1,1]
    v_pk_mul_f32 v[158:159], v[158:159], v[178:179] op_sel_hi:[1,0]
    v_pk_fma_f32 v[158:159], v[174:175], v[178:179], v[158:159] op_sel:[0,1,0] op_sel_hi:[1,1,1]
    v_cvt_pk_bf16_f32 v188, v144, v145
    v_cvt_pk_bf16_f32 v189, v146, v147
    v_cvt_pk_bf16_f32 v190, v148, v149
    v_cvt_pk_bf16_f32 v191, v150, v151
    v_cvt_pk_bf16_f32 v192, v152, v153
    v_cvt_pk_bf16_f32 v193, v154, v155
    v_cvt_pk_bf16_f32 v194, v156, v157
    v_cvt_pk_bf16_f32 v195, v158, v159
    buffer_store_dwordx4 v[188:191], v14, s[40:43], s77 offen offset:0 sc1
    buffer_store_dwordx4 v[192:195], v14, s[40:43], s77 offen offset:1024 sc1
    s_lshl_b32 s76, s62, 2
    s_add_u32 s76, s76, s74
    v_mov_b32 v4, 0
    s_waitcnt vmcnt(0)
    s_mov_b64 exec, 1
    buffer_store_dword v4, v4, s[40:43], s76 offen offset:2560 sc1
    s_mov_b64 exec, -1
    s_lshl_b32 s76, s61, 7
    v_lshl_add_u32 v4, v3, 3, s76
    v_lshlrev_b32 v5, 5, v1
    global_load_dwordx2 v[48:49], v4, s[14:15] offset:0
    global_load_dwordx2 v[50:51], v4, s[14:15] offset:16
    global_load_dwordx2 v[52:53], v4, s[14:15] offset:32
    global_load_dwordx2 v[54:55], v4, s[14:15] offset:48
    global_load_dwordx2 v[56:57], v4, s[14:15] offset:64
    global_load_dwordx2 v[58:59], v4, s[14:15] offset:80
    global_load_dwordx2 v[60:61], v4, s[14:15] offset:96
    global_load_dwordx2 v[62:63], v4, s[14:15] offset:112
    global_load_dwordx4 v[68:71], v5, s[14:15] offset:0
    global_load_dwordx4 v[72:75], v5, s[14:15] offset:16
    s_cmp_ge_u32 s60, 14
    s_cbranch_scc1 L_noffn_8
    v_lshrrev_b32 v4, 4, v1
    v_mul_u32_u24 v4, 114688, v4
    v_and_b32 v5, 15, v1
    v_lshl_add_u32 v4, v5, 4, v4
    s_mul_i32 s76, s61, 458752
    s_lshl_b32 s77, s60, 9
    s_add_u32 s76, s76, s77
    s_lshl_b32 s77, s63, 8
    s_add_u32 s76, s76, s77
    buffer_load_dwordx4 a[128:131], v4, s[48:51], s76 offen nt
    s_add_u32 s76, s76, 7168
    buffer_load_dwordx4 a[132:135], v4, s[48:51], s76 offen nt
    s_add_u32 s76, s76, 7168
    buffer_load_dwordx4 a[136:139], v4, s[48:51], s76 offen nt
    s_add_u32 s76, s76, 7168
    buffer_load_dwordx4 a[140:143], v4, s[48:51], s76 offen nt
    s_add_u32 s76, s76, 7168
    buffer_load_dwordx4 a[144:147], v4, s[48:51], s76 offen nt
    s_add_u32 s76, s76, 7168
    buffer_load_dwordx4 a[148:151], v4, s[48:51], s76 offen nt
    s_add_u32 s76, s76, 7168
    buffer_load_dwordx4 a[152:155], v4, s[48:51], s76 offen nt
    s_add_u32 s76, s76, 7168
    buffer_load_dwordx4 a[156:159], v4, s[48:51], s76 offen nt
    s_add_u32 s76, s76, 7168
    buffer_load_dwordx4 a[160:163], v4, s[48:51], s76 offen nt
    s_add_u32 s76, s76, 7168
    buffer_load_dwordx4 a[164:167], v4, s[48:51], s76 offen nt
    s_add_u32 s76, s76, 7168
    buffer_load_dwordx4 a[168:171], v4, s[48:51], s76 offen nt
    s_add_u32 s76, s76, 7168
    buffer_load_dwordx4 a[172:175], v4, s[48:51], s76 offen nt
    s_add_u32 s76, s76, 7168
    buffer_load_dwordx4 a[176:179], v4, s[48:51], s76 offen nt
    s_add_u32 s76, s76, 7168
    buffer_load_dwordx4 a[180:183], v4, s[48:51], s76 offen nt
    s_add_u32 s76, s76, 7168
    buffer_load_dwordx4 a[184:187], v4, s[48:51], s76 offen nt
    s_add_u32 s76, s76, 7168
    buffer_load_dwordx4 a[188:191], v4, s[48:51], s76 offen nt
    s_lshl_b32 s76, s60, 19
    s_lshl_b32 s77, s61, 15
    s_add_u32 s76, s76, s77
    s_lshl_b32 s77, s62, 9
    s_add_u32 s76, s76, s77
    v_lshlrev_b32 v5, 3, v1
    buffer_load_dwordx2 a[192:193], v5, s[52:55], s76 offen offset:0 nt
    buffer_load_dwordx2 a[194:195], v5, s[52:55], s76 offen offset:2048 nt
    s_add_u32 s76, s76, 4096
    buffer_load_dwordx2 a[196:197], v5, s[52:55], s76 offen offset:0 nt
    buffer_load_dwordx2 a[198:199], v5, s[52:55], s76 offen offset:2048 nt
    s_add_u32 s76, s76, 4096
    buffer_load_dwordx2 a[200:201], v5, s[52:55], s76 offen offset:0 nt
    buffer_load_dwordx2 a[202:203], v5, s[52:55], s76 offen offset:2048 nt
    s_add_u32 s76, s76, 4096
    buffer_load_dwordx2 a[204:205], v5, s[52:55], s76 offen offset:0 nt
    buffer_load_dwordx2 a[206:207], v5, s[52:55], s76 offen offset:2048 nt
    s_add_u32 s76, s76, 4096
    buffer_load_dwordx2 a[208:209], v5, s[52:55], s76 offen offset:0 nt
    buffer_load_dwordx2 a[210:211], v5, s[52:55], s76 offen offset:2048 nt
    s_add_u32 s76, s76, 4096
    buffer_load_dwordx2 a[212:213], v5, s[52:55], s76 offen offset:0 nt
    buffer_load_dwordx2 a[214:215], v5, s[52:55], s76 offen offset:2048 nt
    s_add_u32 s76, s76, 4096
    buffer_load_dwordx2 a[216:217], v5, s[52:55], s76 offen offset:0 nt
    buffer_load_dwordx2 a[218:219], v5, s[52:55], s76 offen offset:2048 nt
    s_add_u32 s76, s76, 4096
    buffer_load_dwordx2 a[220:221], v5, s[52:55], s76 offen offset:0 nt
    buffer_load_dwordx2 a[222:223], v5, s[52:55], s76 offen offset:2048 nt
L_noffn_8:
    v_bfe_u32 v4, v2, 1, 3
    v_lshlrev_b32 v4, 4, v4
    v_lshl_add_u32 v4, v3, 3, v4
    v_lshl_add_u32 v4, v2, 7, v4
    s_lshl_b32 s76, s62, 12
    s_add_u32 s76, s76, 0
    v_add_u32 v76, s76, v4
    v_xor_b32 v77, 16, v76
    v_xor_b32 v78, 32, v76
    v_xor_b32 v79, 48, v76
    v_xor_b32 v80, 64, v76
    v_xor_b32 v81, 80, v76
    v_xor_b32 v82, 96, v76
    v_xor_b32 v83, 112, v76
    ds_read_b64 v[84:85], v76
    ds_read_b64 v[86:87], v77
    ds_read_b64 v[88:89], v78
    ds_read_b64 v[90:91], v79
    ds_read_b64 v[92:93], v80
    ds_read_b64 v[94:95], v81
    ds_read_b64 v[96:97], v82
    ds_read_b64 v[98:99], v83
    v_bfe_u32 v4, v1, 2, 2
    v_lshl_add_u32 v5, v3, 2, v4
    v_lshlrev_b32 v5, 7, v5
    v_lshrrev_b32 v4, 1, v4
    v_lshl_add_u32 v5, v4, 6, v5
    v_bfe_u32 v4, v1, 4, 1
    v_lshl_add_u32 v5, v4, 5, v5
    v_and_b32 v4, 3, v1
    v_lshl_add_u32 v5, v4, 3, v5
    v_add_u32 v100, 32768, v5
    v_xor_b32 v101, 64, v100
    v_add_u32 v102, 65536, v100
    v_add_u32 v103, 65536, v101
    s_waitcnt lgkmcnt(0)
    v_lshlrev_b32 v16, 16, v84
    v_and_b32 v17, s90, v84
    v_lshlrev_b32 v18, 16, v85
    v_and_b32 v19, s90, v85
    v_lshlrev_b32 v20, 16, v86
    v_and_b32 v21, s90, v86
    v_lshlrev_b32 v22, 16, v87
    v_and_b32 v23, s90, v87
    v_lshlrev_b32 v24, 16, v88
    v_and_b32 v25, s90, v88
    v_lshlrev_b32 v26, 16, v89
    v_and_b32 v27, s90, v89
    v_lshlrev_b32 v28, 16, v90
    v_and_b32 v29, s90, v90
    v_lshlrev_b32 v30, 16, v91
    v_and_b32 v31, s90, v91
    v_lshlrev_b32 v32, 16, v92
    v_and_b32 v33, s90, v92
    v_lshlrev_b32 v34, 16, v93
    v_and_b32 v35, s90, v93
    v_lshlrev_b32 v36, 16, v94
    v_and_b32 v37, s90, v94
    v_lshlrev_b32 v38, 16, v95
    v_and_b32 v39, s90, v95
    v_lshlrev_b32 v40, 16, v96
    v_and_b32 v41, s90, v96
    v_lshlrev_b32 v42, 16, v97
    v_and_b32 v43, s90, v97
    v_lshlrev_b32 v44, 16, v98
    v_and_b32 v45, s90, v98
    v_lshlrev_b32 v46, 16, v99
    v_and_b32 v47, s90, v99
    v_lshrrev_b32 v6, 2, v1
    v_mul_u32_u24 v6, 12416, v6
    v_and_b32 v4, 3, v1
    v_lshl_add_u32 v6, v4, 2, v6
    s_mul_i32 s76, s60, 198656
    s_mov_b32 s88, 0
L_spin_9:
    buffer_load_dword v4, v6, s[40:43], s76 offen offset:2560 sc1
    s_waitcnt vmcnt(0)
    v_cmp_eq_u32 vcc, -1, v4
    s_nop 0
    s_cbranch_vccz L_ok_10
    s_add_u32 s88, s88, 1
    s_cmp_lt_u32 s88, 65536
    s_cbranch_scc1 L_spin_9
L_ok_10:
    s_barrier
    s_lshl_b32 s80, s60, 18
    s_lshl_b32 s77, s62, 16
    s_add_u32 s80, s80, s77
    s_add_u32 s80, s80, 8388608
    s_add_u32 s76, s65, 0
    s_and_b32 s76, s76, 15
    s_lshl_b32 s76, s76, 12
    s_add_u32 s76, s76, s80
    buffer_load_dwordx4 a[0:3], v14, s[40:43], s76 offen offset:0 sc1
    buffer_load_dwordx4 a[4:7], v14, s[40:43], s76 offen offset:1024 sc1
    buffer_load_dwordx4 a[8:11], v14, s[40:43], s76 offen offset:2048 sc1
    buffer_load_dwordx4 a[12:15], v14, s[40:43], s76 offen offset:3072 sc1
    s_add_u32 s76, s65, 1
    s_and_b32 s76, s76, 15
    s_lshl_b32 s76, s76, 12
    s_add_u32 s76, s76, s80
    buffer_load_dwordx4 a[16:19], v14, s[40:43], s76 offen offset:0 sc1
    buffer_load_dwordx4 a[20:23], v14, s[40:43], s76 offen offset:1024 sc1
    buffer_load_dwordx4 a[24:27], v14, s[40:43], s76 offen offset:2048 sc1
    buffer_load_dwordx4 a[28:31], v14, s[40:43], s76 offen offset:3072 sc1
    s_add_u32 s76, s65, 2
    s_and_b32 s76, s76, 15
    s_lshl_b32 s76, s76, 12
    s_add_u32 s76, s76, s80
    buffer_load_dwordx4 a[32:35], v14, s[40:43], s76 offen offset:0 sc1
    buffer_load_dwordx4 a[36:39], v14, s[40:43], s76 offen offset:1024 sc1
    buffer_load_dwordx4 a[40:43], v14, s[40:43], s76 offen offset:2048 sc1
    buffer_load_dwordx4 a[44:47], v14, s[40:43], s76 offen offset:3072 sc1
    ds_read_b64_tr_b16 v[104:105], v100 offset:24576
    ds_read_b64_tr_b16 v[106:107], v100 offset:25600
    ds_read_b64_tr_b16 v[108:109], v101 offset:24576
    ds_read_b64_tr_b16 v[110:111], v101 offset:25600
    ds_read_b64_tr_b16 v[112:113], v100 offset:26624
    ds_read_b64_tr_b16 v[114:115], v100 offset:27648
    ds_read_b64_tr_b16 v[116:117], v101 offset:26624
    ds_read_b64_tr_b16 v[118:119], v101 offset:27648
    v_dot2_f32_bf16 v64, v68, s89, 0
    v_dot2_f32_bf16 v64, v69, s89, v64
    v_dot2_f32_bf16 v64, v70, s89, v64
    v_dot2_f32_bf16 v64, v71, s89, v64
    v_dot2_f32_bf16 v64, v72, s89, v64
    v_dot2_f32_bf16 v64, v73, s89, v64
    v_dot2_f32_bf16 v64, v74, s89, v64
    v_dot2_f32_bf16 v64, v75, s89, v64
    s_nop 2
    v_add_f32_dpp v64, v64, v64 row_ror:8 row_mask:0xf bank_mask:0xf
    s_nop 1
    v_add_f32_dpp v64, v64, v64 row_ror:4 row_mask:0xf bank_mask:0xf
    s_nop 1
    v_add_f32_dpp v64, v64, v64 row_ror:2 row_mask:0xf bank_mask:0xf
    s_nop 1
    v_add_f32_dpp v64, v64, v64 row_ror:1 row_mask:0xf bank_mask:0xf
    v_mov_b32 v4, v64
    s_nop 1
    v_permlane16_swap_b32 v64, v4
    v_add_f32 v64, v64, v4
    v_mov_b32 v4, v64
    s_nop 1
    v_permlane32_swap_b32 v64, v4
    v_add_f32 v64, v64, v4
    s_waitcnt vmcnt(11) lgkmcnt(4)
    v_mfma_f32_32x32x16_bf16 v[16:31], v[104:107], a[0:3], v[16:31]
    ds_read_b64_tr_b16 v[120:121], v100 offset:28672
    ds_read_b64_tr_b16 v[122:123], v100 offset:29696
    s_add_u32 s76, s65, 3
    s_and_b32 s76, s76, 15
    s_lshl_b32 s76, s76, 12
    s_add_u32 s76, s76, s80
    buffer_load_dwordx4 a[48:51], v14, s[40:43], s76 offen offset:0 sc1
    v_mfma_f32_32x32x16_bf16 v[32:47], v[108:111], a[0:3], v[32:47]
    ds_read_b64_tr_b16 v[124:125], v101 offset:28672
    ds_read_b64_tr_b16 v[126:127], v101 offset:29696
    s_waitcnt vmcnt(11) lgkmcnt(4)
    v_mfma_f32_32x32x16_bf16 v[16:31], v[112:115], a[4:7], v[16:31]
    ds_read_b64_tr_b16 v[104:105], v100 offset:30720
    ds_read_b64_tr_b16 v[106:107], v100 offset:31744
    buffer_load_dwordx4 a[52:55], v14, s[40:43], s76 offen offset:1024 sc1
    v_mfma_f32_32x32x16_bf16 v[32:47], v[116:119], a[4:7], v[32:47]
    ds_read_b64_tr_b16 v[108:109], v101 offset:30720
    ds_read_b64_tr_b16 v[110:111], v101 offset:31744
    s_waitcnt vmcnt(11) lgkmcnt(4)
    v_mfma_f32_32x32x16_bf16 v[16:31], v[120:123], a[8:11], v[16:31]
    ds_read_b64_tr_b16 v[112:113], v100 offset:32768
    ds_read_b64_tr_b16 v[114:115], v100 offset:33792
    buffer_load_dwordx4 a[56:59], v14, s[40:43], s76 offen offset:2048 sc1
    v_mfma_f32_32x32x16_bf16 v[32:47], v[124:127], a[8:11], v[32:47]
    ds_read_b64_tr_b16 v[116:117], v101 offset:32768
    ds_read_b64_tr_b16 v[118:119], v101 offset:33792
    s_waitcnt vmcnt(11) lgkmcnt(4)
    v_mfma_f32_32x32x16_bf16 v[16:31], v[104:107], a[12:15], v[16:31]
    ds_read_b64_tr_b16 v[120:121], v100 offset:34816
    ds_read_b64_tr_b16 v[122:123], v100 offset:35840
    buffer_load_dwordx4 a[60:63], v14, s[40:43], s76 offen offset:3072 sc1
    v_mfma_f32_32x32x16_bf16 v[32:47], v[108:111], a[12:15], v[32:47]
    ds_read_b64_tr_b16 v[124:125], v101 offset:34816
    ds_read_b64_tr_b16 v[126:127], v101 offset:35840
    s_waitcnt vmcnt(11) lgkmcnt(4)
    v_mfma_f32_32x32x16_bf16 v[16:31], v[112:115], a[16:19], v[16:31]
    ds_read_b64_tr_b16 v[104:105], v100 offset:36864
    ds_read_b64_tr_b16 v[106:107], v100 offset:37888
    s_add_u32 s76, s65, 4
    s_and_b32 s76, s76, 15
    s_lshl_b32 s76, s76, 12
    s_add_u32 s76, s76, s80
    buffer_load_dwordx4 a[0:3], v14, s[40:43], s76 offen offset:0 sc1
    v_mfma_f32_32x32x16_bf16 v[32:47], v[116:119], a[16:19], v[32:47]
    ds_read_b64_tr_b16 v[108:109], v101 offset:36864
    ds_read_b64_tr_b16 v[110:111], v101 offset:37888
    s_waitcnt vmcnt(11) lgkmcnt(4)
    v_mfma_f32_32x32x16_bf16 v[16:31], v[120:123], a[20:23], v[16:31]
    ds_read_b64_tr_b16 v[112:113], v100 offset:38912
    ds_read_b64_tr_b16 v[114:115], v100 offset:39936
    buffer_load_dwordx4 a[4:7], v14, s[40:43], s76 offen offset:1024 sc1
    v_mfma_f32_32x32x16_bf16 v[32:47], v[124:127], a[20:23], v[32:47]
    ds_read_b64_tr_b16 v[116:117], v101 offset:38912
    ds_read_b64_tr_b16 v[118:119], v101 offset:39936
    s_waitcnt vmcnt(11) lgkmcnt(4)
    v_mfma_f32_32x32x16_bf16 v[16:31], v[104:107], a[24:27], v[16:31]
    ds_read_b64_tr_b16 v[120:121], v100 offset:40960
    ds_read_b64_tr_b16 v[122:123], v100 offset:41984
    buffer_load_dwordx4 a[8:11], v14, s[40:43], s76 offen offset:2048 sc1
    v_mfma_f32_32x32x16_bf16 v[32:47], v[108:111], a[24:27], v[32:47]
    ds_read_b64_tr_b16 v[124:125], v101 offset:40960
    ds_read_b64_tr_b16 v[126:127], v101 offset:41984
    s_waitcnt vmcnt(11) lgkmcnt(4)
    v_mfma_f32_32x32x16_bf16 v[16:31], v[112:115], a[28:31], v[16:31]
    ds_read_b64_tr_b16 v[104:105], v100 offset:43008
    ds_read_b64_tr_b16 v[106:107], v100 offset:44032
    buffer_load_dwordx4 a[12:15], v14, s[40:43], s76 offen offset:3072 sc1
    v_mfma_f32_32x32x16_bf16 v[32:47], v[116:119], a[28:31], v[32:47]
    ds_read_b64_tr_b16 v[108:109], v101 offset:43008
    ds_read_b64_tr_b16 v[110:111], v101 offset:44032
    s_waitcnt vmcnt(11) lgkmcnt(4)
    v_mfma_f32_32x32x16_bf16 v[16:31], v[120:123], a[32:35], v[16:31]
    ds_read_b64_tr_b16 v[112:113], v100 offset:45056
    ds_read_b64_tr_b16 v[114:115], v100 offset:46080
    s_add_u32 s76, s65, 5
    s_and_b32 s76, s76, 15
    s_lshl_b32 s76, s76, 12
    s_add_u32 s76, s76, s80
    buffer_load_dwordx4 a[16:19], v14, s[40:43], s76 offen offset:0 sc1
    v_mfma_f32_32x32x16_bf16 v[32:47], v[124:127], a[32:35], v[32:47]
    ds_read_b64_tr_b16 v[116:117], v101 offset:45056
    ds_read_b64_tr_b16 v[118:119], v101 offset:46080
    s_waitcnt vmcnt(11) lgkmcnt(4)
    v_mfma_f32_32x32x16_bf16 v[16:31], v[104:107], a[36:39], v[16:31]
    ds_read_b64_tr_b16 v[120:121], v100 offset:47104
    ds_read_b64_tr_b16 v[122:123], v100 offset:48128
    buffer_load_dwordx4 a[20:23], v14, s[40:43], s76 offen offset:1024 sc1
    v_mfma_f32_32x32x16_bf16 v[32:47], v[108:111], a[36:39], v[32:47]
    ds_read_b64_tr_b16 v[124:125], v101 offset:47104
    ds_read_b64_tr_b16 v[126:127], v101 offset:48128
    s_waitcnt vmcnt(11) lgkmcnt(4)
    v_mfma_f32_32x32x16_bf16 v[16:31], v[112:115], a[40:43], v[16:31]
    ds_read_b64_tr_b16 v[104:105], v100 offset:49152
    ds_read_b64_tr_b16 v[106:107], v100 offset:50176
    buffer_load_dwordx4 a[24:27], v14, s[40:43], s76 offen offset:2048 sc1
    v_mfma_f32_32x32x16_bf16 v[32:47], v[116:119], a[40:43], v[32:47]
    ds_read_b64_tr_b16 v[108:109], v101 offset:49152
    ds_read_b64_tr_b16 v[110:111], v101 offset:50176
    s_waitcnt vmcnt(11) lgkmcnt(4)
    v_mfma_f32_32x32x16_bf16 v[16:31], v[120:123], a[44:47], v[16:31]
    ds_read_b64_tr_b16 v[112:113], v100 offset:51200
    ds_read_b64_tr_b16 v[114:115], v100 offset:52224
    buffer_load_dwordx4 a[28:31], v14, s[40:43], s76 offen offset:3072 sc1
    v_mfma_f32_32x32x16_bf16 v[32:47], v[124:127], a[44:47], v[32:47]
    ds_read_b64_tr_b16 v[116:117], v101 offset:51200
    ds_read_b64_tr_b16 v[118:119], v101 offset:52224
    s_waitcnt vmcnt(11) lgkmcnt(4)
    v_mfma_f32_32x32x16_bf16 v[16:31], v[104:107], a[48:51], v[16:31]
    ds_read_b64_tr_b16 v[120:121], v100 offset:53248
    ds_read_b64_tr_b16 v[122:123], v100 offset:54272
    s_add_u32 s76, s65, 6
    s_and_b32 s76, s76, 15
    s_lshl_b32 s76, s76, 12
    s_add_u32 s76, s76, s80
    buffer_load_dwordx4 a[32:35], v14, s[40:43], s76 offen offset:0 sc1
    v_mfma_f32_32x32x16_bf16 v[32:47], v[108:111], a[48:51], v[32:47]
    ds_read_b64_tr_b16 v[124:125], v101 offset:53248
    ds_read_b64_tr_b16 v[126:127], v101 offset:54272
    s_waitcnt vmcnt(11) lgkmcnt(4)
    v_mfma_f32_32x32x16_bf16 v[16:31], v[112:115], a[52:55], v[16:31]
    ds_read_b64_tr_b16 v[104:105], v100 offset:55296
    ds_read_b64_tr_b16 v[106:107], v100 offset:56320
    buffer_load_dwordx4 a[36:39], v14, s[40:43], s76 offen offset:1024 sc1
    v_mfma_f32_32x32x16_bf16 v[32:47], v[116:119], a[52:55], v[32:47]
    ds_read_b64_tr_b16 v[108:109], v101 offset:55296
    ds_read_b64_tr_b16 v[110:111], v101 offset:56320
    s_waitcnt vmcnt(11) lgkmcnt(4)
    v_mfma_f32_32x32x16_bf16 v[16:31], v[120:123], a[56:59], v[16:31]
    ds_read_b64_tr_b16 v[112:113], v100 offset:57344
    ds_read_b64_tr_b16 v[114:115], v100 offset:58368
    buffer_load_dwordx4 a[40:43], v14, s[40:43], s76 offen offset:2048 sc1
    v_mfma_f32_32x32x16_bf16 v[32:47], v[124:127], a[56:59], v[32:47]
    ds_read_b64_tr_b16 v[116:117], v101 offset:57344
    ds_read_b64_tr_b16 v[118:119], v101 offset:58368
    s_waitcnt vmcnt(11) lgkmcnt(4)
    v_mfma_f32_32x32x16_bf16 v[16:31], v[104:107], a[60:63], v[16:31]
    ds_read_b64_tr_b16 v[120:121], v100 offset:59392
    ds_read_b64_tr_b16 v[122:123], v100 offset:60416
    buffer_load_dwordx4 a[44:47], v14, s[40:43], s76 offen offset:3072 sc1
    v_mfma_f32_32x32x16_bf16 v[32:47], v[108:111], a[60:63], v[32:47]
    ds_read_b64_tr_b16 v[124:125], v101 offset:59392
    ds_read_b64_tr_b16 v[126:127], v101 offset:60416
    s_waitcnt vmcnt(11) lgkmcnt(4)
    v_mfma_f32_32x32x16_bf16 v[16:31], v[112:115], a[0:3], v[16:31]
    ds_read_b64_tr_b16 v[104:105], v100 offset:61440
    ds_read_b64_tr_b16 v[106:107], v100 offset:62464
    s_add_u32 s76, s65, 7
    s_and_b32 s76, s76, 15
    s_lshl_b32 s76, s76, 12
    s_add_u32 s76, s76, s80
    buffer_load_dwordx4 a[48:51], v14, s[40:43], s76 offen offset:0 sc1
    v_mfma_f32_32x32x16_bf16 v[32:47], v[116:119], a[0:3], v[32:47]
    ds_read_b64_tr_b16 v[108:109], v101 offset:61440
    ds_read_b64_tr_b16 v[110:111], v101 offset:62464
    s_waitcnt vmcnt(11) lgkmcnt(4)
    v_mfma_f32_32x32x16_bf16 v[16:31], v[120:123], a[4:7], v[16:31]
    ds_read_b64_tr_b16 v[112:113], v100 offset:63488
    ds_read_b64_tr_b16 v[114:115], v100 offset:64512
    buffer_load_dwordx4 a[52:55], v14, s[40:43], s76 offen offset:1024 sc1
    v_mfma_f32_32x32x16_bf16 v[32:47], v[124:127], a[4:7], v[32:47]
    ds_read_b64_tr_b16 v[116:117], v101 offset:63488
    ds_read_b64_tr_b16 v[118:119], v101 offset:64512
    s_waitcnt vmcnt(11) lgkmcnt(4)
    v_mfma_f32_32x32x16_bf16 v[16:31], v[104:107], a[8:11], v[16:31]
    ds_read_b64_tr_b16 v[120:121], v102 offset:0
    ds_read_b64_tr_b16 v[122:123], v102 offset:1024
    buffer_load_dwordx4 a[56:59], v14, s[40:43], s76 offen offset:2048 sc1
    v_mfma_f32_32x32x16_bf16 v[32:47], v[108:111], a[8:11], v[32:47]
    ds_read_b64_tr_b16 v[124:125], v103 offset:0
    ds_read_b64_tr_b16 v[126:127], v103 offset:1024
    s_waitcnt vmcnt(11) lgkmcnt(4)
    v_mfma_f32_32x32x16_bf16 v[16:31], v[112:115], a[12:15], v[16:31]
    ds_read_b64_tr_b16 v[104:105], v102 offset:2048
    ds_read_b64_tr_b16 v[106:107], v102 offset:3072
    buffer_load_dwordx4 a[60:63], v14, s[40:43], s76 offen offset:3072 sc1
    v_mfma_f32_32x32x16_bf16 v[32:47], v[116:119], a[12:15], v[32:47]
    ds_read_b64_tr_b16 v[108:109], v103 offset:2048
    ds_read_b64_tr_b16 v[110:111], v103 offset:3072
    s_waitcnt vmcnt(11) lgkmcnt(4)
    v_mfma_f32_32x32x16_bf16 v[16:31], v[120:123], a[16:19], v[16:31]
    ds_read_b64_tr_b16 v[112:113], v102 offset:4096
    ds_read_b64_tr_b16 v[114:115], v102 offset:5120
    s_add_u32 s76, s65, 8
    s_and_b32 s76, s76, 15
    s_lshl_b32 s76, s76, 12
    s_add_u32 s76, s76, s80
    buffer_load_dwordx4 a[0:3], v14, s[40:43], s76 offen offset:0 sc1
    v_mfma_f32_32x32x16_bf16 v[32:47], v[124:127], a[16:19], v[32:47]
    ds_read_b64_tr_b16 v[116:117], v103 offset:4096
    ds_read_b64_tr_b16 v[118:119], v103 offset:5120
    s_waitcnt vmcnt(11) lgkmcnt(4)
    v_mfma_f32_32x32x16_bf16 v[16:31], v[104:107], a[20:23], v[16:31]
    ds_read_b64_tr_b16 v[120:121], v102 offset:6144
    ds_read_b64_tr_b16 v[122:123], v102 offset:7168
    buffer_load_dwordx4 a[4:7], v14, s[40:43], s76 offen offset:1024 sc1
    v_mfma_f32_32x32x16_bf16 v[32:47], v[108:111], a[20:23], v[32:47]
    ds_read_b64_tr_b16 v[124:125], v103 offset:6144
    ds_read_b64_tr_b16 v[126:127], v103 offset:7168
    s_waitcnt vmcnt(11) lgkmcnt(4)
    v_mfma_f32_32x32x16_bf16 v[16:31], v[112:115], a[24:27], v[16:31]
    ds_read_b64_tr_b16 v[104:105], v102 offset:8192
    ds_read_b64_tr_b16 v[106:107], v102 offset:9216
    buffer_load_dwordx4 a[8:11], v14, s[40:43], s76 offen offset:2048 sc1
    v_mfma_f32_32x32x16_bf16 v[32:47], v[116:119], a[24:27], v[32:47]
    ds_read_b64_tr_b16 v[108:109], v103 offset:8192
    ds_read_b64_tr_b16 v[110:111], v103 offset:9216
    s_waitcnt vmcnt(11) lgkmcnt(4)
    v_mfma_f32_32x32x16_bf16 v[16:31], v[120:123], a[28:31], v[16:31]
    ds_read_b64_tr_b16 v[112:113], v102 offset:10240
    ds_read_b64_tr_b16 v[114:115], v102 offset:11264
    buffer_load_dwordx4 a[12:15], v14, s[40:43], s76 offen offset:3072 sc1
    v_mfma_f32_32x32x16_bf16 v[32:47], v[124:127], a[28:31], v[32:47]
    ds_read_b64_tr_b16 v[116:117], v103 offset:10240
    ds_read_b64_tr_b16 v[118:119], v103 offset:11264
    s_waitcnt vmcnt(11) lgkmcnt(4)
    v_mfma_f32_32x32x16_bf16 v[16:31], v[104:107], a[32:35], v[16:31]
    ds_read_b64_tr_b16 v[120:121], v102 offset:12288
    ds_read_b64_tr_b16 v[122:123], v102 offset:13312
    s_add_u32 s76, s65, 9
    s_and_b32 s76, s76, 15
    s_lshl_b32 s76, s76, 12
    s_add_u32 s76, s76, s80
    buffer_load_dwordx4 a[16:19], v14, s[40:43], s76 offen offset:0 sc1
    v_mfma_f32_32x32x16_bf16 v[32:47], v[108:111], a[32:35], v[32:47]
    ds_read_b64_tr_b16 v[124:125], v103 offset:12288
    ds_read_b64_tr_b16 v[126:127], v103 offset:13312
    s_waitcnt vmcnt(11) lgkmcnt(4)
    v_mfma_f32_32x32x16_bf16 v[16:31], v[112:115], a[36:39], v[16:31]
    ds_read_b64_tr_b16 v[104:105], v102 offset:14336
    ds_read_b64_tr_b16 v[106:107], v102 offset:15360
    buffer_load_dwordx4 a[20:23], v14, s[40:43], s76 offen offset:1024 sc1
    v_mfma_f32_32x32x16_bf16 v[32:47], v[116:119], a[36:39], v[32:47]
    ds_read_b64_tr_b16 v[108:109], v103 offset:14336
    ds_read_b64_tr_b16 v[110:111], v103 offset:15360
    s_waitcnt vmcnt(11) lgkmcnt(4)
    v_mfma_f32_32x32x16_bf16 v[16:31], v[120:123], a[40:43], v[16:31]
    ds_read_b64_tr_b16 v[112:113], v102 offset:16384
    ds_read_b64_tr_b16 v[114:115], v102 offset:17408
    buffer_load_dwordx4 a[24:27], v14, s[40:43], s76 offen offset:2048 sc1
    v_mfma_f32_32x32x16_bf16 v[32:47], v[124:127], a[40:43], v[32:47]
    ds_read_b64_tr_b16 v[116:117], v103 offset:16384
    ds_read_b64_tr_b16 v[118:119], v103 offset:17408
    s_waitcnt vmcnt(11) lgkmcnt(4)
    v_mfma_f32_32x32x16_bf16 v[16:31], v[104:107], a[44:47], v[16:31]
    ds_read_b64_tr_b16 v[120:121], v102 offset:18432
    ds_read_b64_tr_b16 v[122:123], v102 offset:19456
    buffer_load_dwordx4 a[28:31], v14, s[40:43], s76 offen offset:3072 sc1
    v_mfma_f32_32x32x16_bf16 v[32:47], v[108:111], a[44:47], v[32:47]
    ds_read_b64_tr_b16 v[124:125], v103 offset:18432
    ds_read_b64_tr_b16 v[126:127], v103 offset:19456
    s_waitcnt vmcnt(11) lgkmcnt(4)
    v_mfma_f32_32x32x16_bf16 v[16:31], v[112:115], a[48:51], v[16:31]
    ds_read_b64_tr_b16 v[104:105], v102 offset:20480
    ds_read_b64_tr_b16 v[106:107], v102 offset:21504
    s_add_u32 s76, s65, 10
    s_and_b32 s76, s76, 15
    s_lshl_b32 s76, s76, 12
    s_add_u32 s76, s76, s80
    buffer_load_dwordx4 a[32:35], v14, s[40:43], s76 offen offset:0 sc1
    v_mfma_f32_32x32x16_bf16 v[32:47], v[116:119], a[48:51], v[32:47]
    ds_read_b64_tr_b16 v[108:109], v103 offset:20480
    ds_read_b64_tr_b16 v[110:111], v103 offset:21504
    s_waitcnt vmcnt(11) lgkmcnt(4)
    v_mfma_f32_32x32x16_bf16 v[16:31], v[120:123], a[52:55], v[16:31]
    ds_read_b64_tr_b16 v[112:113], v102 offset:22528
    ds_read_b64_tr_b16 v[114:115], v102 offset:23552
    buffer_load_dwordx4 a[36:39], v14, s[40:43], s76 offen offset:1024 sc1
    v_mfma_f32_32x32x16_bf16 v[32:47], v[124:127], a[52:55], v[32:47]
    ds_read_b64_tr_b16 v[116:117], v103 offset:22528
    ds_read_b64_tr_b16 v[118:119], v103 offset:23552
    s_waitcnt vmcnt(11) lgkmcnt(4)
    v_mfma_f32_32x32x16_bf16 v[16:31], v[104:107], a[56:59], v[16:31]
    ds_read_b64_tr_b16 v[120:121], v102 offset:24576
    ds_read_b64_tr_b16 v[122:123], v102 offset:25600
    buffer_load_dwordx4 a[40:43], v14, s[40:43], s76 offen offset:2048 sc1
    v_mfma_f32_32x32x16_bf16 v[32:47], v[108:111], a[56:59], v[32:47]
    ds_read_b64_tr_b16 v[124:125], v103 offset:24576
    ds_read_b64_tr_b16 v[126:127], v103 offset:25600
    s_waitcnt vmcnt(11) lgkmcnt(4)
    v_mfma_f32_32x32x16_bf16 v[16:31], v[112:115], a[60:63], v[16:31]
    ds_read_b64_tr_b16 v[104:105], v102 offset:26624
    ds_read_b64_tr_b16 v[106:107], v102 offset:27648
    buffer_load_dwordx4 a[44:47], v14, s[40:43], s76 offen offset:3072 sc1
    v_mfma_f32_32x32x16_bf16 v[32:47], v[116:119], a[60:63], v[32:47]
    ds_read_b64_tr_b16 v[108:109], v103 offset:26624
    ds_read_b64_tr_b16 v[110:111], v103 offset:27648
    s_waitcnt vmcnt(11) lgkmcnt(4)
    v_mfma_f32_32x32x16_bf16 v[16:31], v[120:123], a[0:3], v[16:31]
    ds_read_b64_tr_b16 v[112:113], v102 offset:28672
    ds_read_b64_tr_b16 v[114:115], v102 offset:29696
    s_add_u32 s76, s65, 11
    s_and_b32 s76, s76, 15
    s_lshl_b32 s76, s76, 12
    s_add_u32 s76, s76, s80
    buffer_load_dwordx4 a[48:51], v14, s[40:43], s76 offen offset:0 sc1
    v_mfma_f32_32x32x16_bf16 v[32:47], v[124:127], a[0:3], v[32:47]
    ds_read_b64_tr_b16 v[116:117], v103 offset:28672
    ds_read_b64_tr_b16 v[118:119], v103 offset:29696
    s_waitcnt vmcnt(11) lgkmcnt(4)
    v_mfma_f32_32x32x16_bf16 v[16:31], v[104:107], a[4:7], v[16:31]
    ds_read_b64_tr_b16 v[120:121], v102 offset:30720
    ds_read_b64_tr_b16 v[122:123], v102 offset:31744
    buffer_load_dwordx4 a[52:55], v14, s[40:43], s76 offen offset:1024 sc1
    v_mfma_f32_32x32x16_bf16 v[32:47], v[108:111], a[4:7], v[32:47]
    ds_read_b64_tr_b16 v[124:125], v103 offset:30720
    ds_read_b64_tr_b16 v[126:127], v103 offset:31744
    s_waitcnt vmcnt(11) lgkmcnt(4)
    v_mfma_f32_32x32x16_bf16 v[16:31], v[112:115], a[8:11], v[16:31]
    ds_read_b64_tr_b16 v[104:105], v102 offset:32768
    ds_read_b64_tr_b16 v[106:107], v102 offset:33792
    buffer_load_dwordx4 a[56:59], v14, s[40:43], s76 offen offset:2048 sc1
    v_mfma_f32_32x32x16_bf16 v[32:47], v[116:119], a[8:11], v[32:47]
    ds_read_b64_tr_b16 v[108:109], v103 offset:32768
    ds_read_b64_tr_b16 v[110:111], v103 offset:33792
    s_waitcnt vmcnt(11) lgkmcnt(4)
    v_mfma_f32_32x32x16_bf16 v[16:31], v[120:123], a[12:15], v[16:31]
    ds_read_b64_tr_b16 v[112:113], v102 offset:34816
    ds_read_b64_tr_b16 v[114:115], v102 offset:35840
    buffer_load_dwordx4 a[60:63], v14, s[40:43], s76 offen offset:3072 sc1
    v_mfma_f32_32x32x16_bf16 v[32:47], v[124:127], a[12:15], v[32:47]
    ds_read_b64_tr_b16 v[116:117], v103 offset:34816
    ds_read_b64_tr_b16 v[118:119], v103 offset:35840
    s_waitcnt vmcnt(11) lgkmcnt(4)
    v_mfma_f32_32x32x16_bf16 v[16:31], v[104:107], a[16:19], v[16:31]
    ds_read_b64_tr_b16 v[120:121], v102 offset:36864
    ds_read_b64_tr_b16 v[122:123], v102 offset:37888
    s_add_u32 s76, s65, 12
    s_and_b32 s76, s76, 15
    s_lshl_b32 s76, s76, 12
    s_add_u32 s76, s76, s80
    buffer_load_dwordx4 a[0:3], v14, s[40:43], s76 offen offset:0 sc1
    v_mfma_f32_32x32x16_bf16 v[32:47], v[108:111], a[16:19], v[32:47]
    ds_read_b64_tr_b16 v[124:125], v103 offset:36864
    ds_read_b64_tr_b16 v[126:127], v103 offset:37888
    s_waitcnt vmcnt(11) lgkmcnt(4)
    v_mfma_f32_32x32x16_bf16 v[16:31], v[112:115], a[20:23], v[16:31]
    ds_read_b64_tr_b16 v[104:105], v102 offset:38912
    ds_read_b64_tr_b16 v[106:107], v102 offset:39936
    buffer_load_dwordx4 a[4:7], v14, s[40:43], s76 offen offset:1024 sc1
    v_mfma_f32_32x32x16_bf16 v[32:47], v[116:119], a[20:23], v[32:47]
    ds_read_b64_tr_b16 v[108:109], v103 offset:38912
    ds_read_b64_tr_b16 v[110:111], v103 offset:39936
    s_waitcnt vmcnt(11) lgkmcnt(4)
    v_mfma_f32_32x32x16_bf16 v[16:31], v[120:123], a[24:27], v[16:31]
    ds_read_b64_tr_b16 v[112:113], v102 offset:40960
    ds_read_b64_tr_b16 v[114:115], v102 offset:41984
    buffer_load_dwordx4 a[8:11], v14, s[40:43], s76 offen offset:2048 sc1
    v_mfma_f32_32x32x16_bf16 v[32:47], v[124:127], a[24:27], v[32:47]
    ds_read_b64_tr_b16 v[116:117], v103 offset:40960
    ds_read_b64_tr_b16 v[118:119], v103 offset:41984
    s_waitcnt vmcnt(11) lgkmcnt(4)
    v_mfma_f32_32x32x16_bf16 v[16:31], v[104:107], a[28:31], v[16:31]
    ds_read_b64_tr_b16 v[120:121], v102 offset:43008
    ds_read_b64_tr_b16 v[122:123], v102 offset:44032
    buffer_load_dwordx4 a[12:15], v14, s[40:43], s76 offen offset:3072 sc1
    v_mfma_f32_32x32x16_bf16 v[32:47], v[108:111], a[28:31], v[32:47]
    ds_read_b64_tr_b16 v[124:125], v103 offset:43008
    ds_read_b64_tr_b16 v[126:127], v103 offset:44032
    s_waitcnt vmcnt(11) lgkmcnt(4)
    v_mfma_f32_32x32x16_bf16 v[16:31], v[112:115], a[32:35], v[16:31]
    ds_read_b64_tr_b16 v[104:105], v102 offset:45056
    ds_read_b64_tr_b16 v[106:107], v102 offset:46080
    s_add_u32 s76, s65, 13
    s_and_b32 s76, s76, 15
    s_lshl_b32 s76, s76, 12
    s_add_u32 s76, s76, s80
    buffer_load_dwordx4 a[16:19], v14, s[40:43], s76 offen offset:0 sc1
    v_mfma_f32_32x32x16_bf16 v[32:47], v[116:119], a[32:35], v[32:47]
    ds_read_b64_tr_b16 v[108:109], v103 offset:45056
    ds_read_b64_tr_b16 v[110:111], v103 offset:46080
    s_waitcnt vmcnt(11) lgkmcnt(4)
    v_mfma_f32_32x32x16_bf16 v[16:31], v[120:123], a[36:39], v[16:31]
    ds_read_b64_tr_b16 v[112:113], v102 offset:47104
    ds_read_b64_tr_b16 v[114:115], v102 offset:48128
    buffer_load_dwordx4 a[20:23], v14, s[40:43], s76 offen offset:1024 sc1
    v_mfma_f32_32x32x16_bf16 v[32:47], v[124:127], a[36:39], v[32:47]
    ds_read_b64_tr_b16 v[116:117], v103 offset:47104
    ds_read_b64_tr_b16 v[118:119], v103 offset:48128
    s_waitcnt vmcnt(11) lgkmcnt(4)
    v_mfma_f32_32x32x16_bf16 v[16:31], v[104:107], a[40:43], v[16:31]
    ds_read_b64_tr_b16 v[120:121], v102 offset:49152
    ds_read_b64_tr_b16 v[122:123], v102 offset:50176
    buffer_load_dwordx4 a[24:27], v14, s[40:43], s76 offen offset:2048 sc1
    v_mfma_f32_32x32x16_bf16 v[32:47], v[108:111], a[40:43], v[32:47]
    ds_read_b64_tr_b16 v[124:125], v103 offset:49152
    ds_read_b64_tr_b16 v[126:127], v103 offset:50176
    s_waitcnt vmcnt(11) lgkmcnt(4)
    v_mfma_f32_32x32x16_bf16 v[16:31], v[112:115], a[44:47], v[16:31]
    ds_read_b64_tr_b16 v[104:105], v102 offset:51200
    ds_read_b64_tr_b16 v[106:107], v102 offset:52224
    buffer_load_dwordx4 a[28:31], v14, s[40:43], s76 offen offset:3072 sc1
    v_mfma_f32_32x32x16_bf16 v[32:47], v[116:119], a[44:47], v[32:47]
    ds_read_b64_tr_b16 v[108:109], v103 offset:51200
    ds_read_b64_tr_b16 v[110:111], v103 offset:52224
    s_waitcnt vmcnt(11) lgkmcnt(4)
    v_mfma_f32_32x32x16_bf16 v[16:31], v[120:123], a[48:51], v[16:31]
    ds_read_b64_tr_b16 v[112:113], v102 offset:53248
    ds_read_b64_tr_b16 v[114:115], v102 offset:54272
    s_add_u32 s76, s65, 14
    s_and_b32 s76, s76, 15
    s_lshl_b32 s76, s76, 12
    s_add_u32 s76, s76, s80
    buffer_load_dwordx4 a[32:35], v14, s[40:43], s76 offen offset:0 sc1
    v_mfma_f32_32x32x16_bf16 v[32:47], v[124:127], a[48:51], v[32:47]
    ds_read_b64_tr_b16 v[116:117], v103 offset:53248
    ds_read_b64_tr_b16 v[118:119], v103 offset:54272
    s_waitcnt vmcnt(11) lgkmcnt(4)
    v_mfma_f32_32x32x16_bf16 v[16:31], v[104:107], a[52:55], v[16:31]
    ds_read_b64_tr_b16 v[120:121], v102 offset:55296
    ds_read_b64_tr_b16 v[122:123], v102 offset:56320
    buffer_load_dwordx4 a[36:39], v14, s[40:43], s76 offen offset:1024 sc1
    v_mfma_f32_32x32x16_bf16 v[32:47], v[108:111], a[52:55], v[32:47]
    ds_read_b64_tr_b16 v[124:125], v103 offset:55296
    ds_read_b64_tr_b16 v[126:127], v103 offset:56320
    s_waitcnt vmcnt(11) lgkmcnt(4)
    v_mfma_f32_32x32x16_bf16 v[16:31], v[112:115], a[56:59], v[16:31]
    ds_read_b64_tr_b16 v[104:105], v102 offset:57344
    ds_read_b64_tr_b16 v[106:107], v102 offset:58368
    buffer_load_dwordx4 a[40:43], v14, s[40:43], s76 offen offset:2048 sc1
    v_mfma_f32_32x32x16_bf16 v[32:47], v[116:119], a[56:59], v[32:47]
    ds_read_b64_tr_b16 v[108:109], v103 offset:57344
    ds_read_b64_tr_b16 v[110:111], v103 offset:58368
    s_waitcnt vmcnt(11) lgkmcnt(4)
    v_mfma_f32_32x32x16_bf16 v[16:31], v[120:123], a[60:63], v[16:31]
    ds_read_b64_tr_b16 v[112:113], v102 offset:59392
    ds_read_b64_tr_b16 v[114:115], v102 offset:60416
    buffer_load_dwordx4 a[44:47], v14, s[40:43], s76 offen offset:3072 sc1
    v_mfma_f32_32x32x16_bf16 v[32:47], v[124:127], a[60:63], v[32:47]
    ds_read_b64_tr_b16 v[116:117], v103 offset:59392
    ds_read_b64_tr_b16 v[118:119], v103 offset:60416
    s_waitcnt vmcnt(11) lgkmcnt(4)
    v_mfma_f32_32x32x16_bf16 v[16:31], v[104:107], a[0:3], v[16:31]
    ds_read_b64_tr_b16 v[120:121], v102 offset:61440
    ds_read_b64_tr_b16 v[122:123], v102 offset:62464
    s_add_u32 s76, s65, 15
    s_and_b32 s76, s76, 15
    s_lshl_b32 s76, s76, 12
    s_add_u32 s76, s76, s80
    buffer_load_dwordx4 a[48:51], v14, s[40:43], s76 offen offset:0 sc1
    v_mfma_f32_32x32x16_bf16 v[32:47], v[108:111], a[0:3], v[32:47]
    ds_read_b64_tr_b16 v[124:125], v103 offset:61440
    ds_read_b64_tr_b16 v[126:127], v103 offset:62464
    s_waitcnt vmcnt(11) lgkmcnt(4)
    v_mfma_f32_32x32x16_bf16 v[16:31], v[112:115], a[4:7], v[16:31]
    ds_read_b64_tr_b16 v[104:105], v102 offset:63488
    ds_read_b64_tr_b16 v[106:107], v102 offset:64512
    buffer_load_dwordx4 a[52:55], v14, s[40:43], s76 offen offset:1024 sc1
    v_mfma_f32_32x32x16_bf16 v[32:47], v[116:119], a[4:7], v[32:47]
    ds_read_b64_tr_b16 v[108:109], v103 offset:63488
    ds_read_b64_tr_b16 v[110:111], v103 offset:64512
    s_waitcnt vmcnt(11) lgkmcnt(4)
    v_mfma_f32_32x32x16_bf16 v[16:31], v[120:123], a[8:11], v[16:31]
    ds_read_b64_tr_b16 v[112:113], v100 offset:0
    ds_read_b64_tr_b16 v[114:115], v100 offset:1024
    buffer_load_dwordx4 a[56:59], v14, s[40:43], s76 offen offset:2048 sc1
    v_mfma_f32_32x32x16_bf16 v[32:47], v[124:127], a[8:11], v[32:47]
    ds_read_b64_tr_b16 v[116:117], v101 offset:0
    ds_read_b64_tr_b16 v[118:119], v101 offset:1024
    s_waitcnt vmcnt(11) lgkmcnt(4)
    v_mfma_f32_32x32x16_bf16 v[16:31], v[104:107], a[12:15], v[16:31]
    ds_read_b64_tr_b16 v[120:121], v100 offset:2048
    ds_read_b64_tr_b16 v[122:123], v100 offset:3072
    buffer_load_dwordx4 a[60:63], v14, s[40:43], s76 offen offset:3072 sc1
    v_mfma_f32_32x32x16_bf16 v[32:47], v[108:111], a[12:15], v[32:47]
    ds_read_b64_tr_b16 v[124:125], v101 offset:2048
    ds_read_b64_tr_b16 v[126:127], v101 offset:3072
    s_waitcnt vmcnt(11) lgkmcnt(4)
    v_mfma_f32_32x32x16_bf16 v[16:31], v[112:115], a[16:19], v[16:31]
    ds_read_b64_tr_b16 v[104:105], v100 offset:4096
    ds_read_b64_tr_b16 v[106:107], v100 offset:5120
    v_mfma_f32_32x32x16_bf16 v[32:47], v[116:119], a[16:19], v[32:47]
    ds_read_b64_tr_b16 v[108:109], v101 offset:4096
    ds_read_b64_tr_b16 v[110:111], v101 offset:5120
    s_waitcnt vmcnt(10) lgkmcnt(4)
    v_mfma_f32_32x32x16_bf16 v[16:31], v[120:123], a[20:23], v[16:31]
    ds_read_b64_tr_b16 v[112:113], v100 offset:6144
    ds_read_b64_tr_b16 v[114:115], v100 offset:7168
    v_mfma_f32_32x32x16_bf16 v[32:47], v[124:127], a[20:23], v[32:47]
    ds_read_b64_tr_b16 v[116:117], v101 offset:6144
    ds_read_b64_tr_b16 v[118:119], v101 offset:7168
    s_waitcnt vmcnt(9) lgkmcnt(4)
    v_mfma_f32_32x32x16_bf16 v[16:31], v[104:107], a[24:27], v[16:31]
    ds_read_b64_tr_b16 v[120:121], v100 offset:8192
    ds_read_b64_tr_b16 v[122:123], v100 offset:9216
    v_mfma_f32_32x32x16_bf16 v[32:47], v[108:111], a[24:27], v[32:47]
    ds_read_b64_tr_b16 v[124:125], v101 offset:8192
    ds_read_b64_tr_b16 v[126:127], v101 offset:9216
    s_waitcnt vmcnt(8) lgkmcnt(4)
    v_mfma_f32_32x32x16_bf16 v[16:31], v[112:115], a[28:31], v[16:31]
    ds_read_b64_tr_b16 v[104:105], v100 offset:10240
    ds_read_b64_tr_b16 v[106:107], v100 offset:11264
    v_mfma_f32_32x32x16_bf16 v[32:47], v[116:119], a[28:31], v[32:47]
    ds_read_b64_tr_b16 v[108:109], v101 offset:10240
    ds_read_b64_tr_b16 v[110:111], v101 offset:11264
    s_waitcnt vmcnt(7) lgkmcnt(4)
    v_mfma_f32_32x32x16_bf16 v[16:31], v[120:123], a[32:35], v[16:31]
    ds_read_b64_tr_b16 v[112:113], v100 offset:12288
    ds_read_b64_tr_b16 v[114:115], v100 offset:13312
    v_mfma_f32_32x32x16_bf16 v[32:47], v[124:127], a[32:35], v[32:47]
    ds_read_b64_tr_b16 v[116:117], v101 offset:12288
    ds_read_b64_tr_b16 v[118:119], v101 offset:13312
    s_waitcnt vmcnt(6) lgkmcnt(4)
    v_mfma_f32_32x32x16_bf16 v[16:31], v[104:107], a[36:39], v[16:31]
    ds_read_b64_tr_b16 v[120:121], v100 offset:14336
    ds_read_b64_tr_b16 v[122:123], v100 offset:15360
    v_mfma_f32_32x32x16_bf16 v[32:47], v[108:111], a[36:39], v[32:47]
    ds_read_b64_tr_b16 v[124:125], v101 offset:14336
    ds_read_b64_tr_b16 v[126:127], v101 offset:15360
    s_waitcnt vmcnt(5) lgkmcnt(4)
    v_mfma_f32_32x32x16_bf16 v[16:31], v[112:115], a[40:43], v[16:31]
    ds_read_b64_tr_b16 v[104:105], v100 offset:16384
    ds_read_b64_tr_b16 v[106:107], v100 offset:17408
    v_mfma_f32_32x32x16_bf16 v[32:47], v[116:119], a[40:43], v[32:47]
    ds_read_b64_tr_b16 v[108:109], v101 offset:16384
    ds_read_b64_tr_b16 v[110:111], v101 offset:17408
    s_waitcnt vmcnt(4) lgkmcnt(4)
    v_mfma_f32_32x32x16_bf16 v[16:31], v[120:123], a[44:47], v[16:31]
    ds_read_b64_tr_b16 v[112:113], v100 offset:18432
    ds_read_b64_tr_b16 v[114:115], v100 offset:19456
    v_mfma_f32_32x32x16_bf16 v[32:47], v[124:127], a[44:47], v[32:47]
    ds_read_b64_tr_b16 v[116:117], v101 offset:18432
    ds_read_b64_tr_b16 v[118:119], v101 offset:19456
    s_waitcnt vmcnt(3) lgkmcnt(4)
    v_mfma_f32_32x32x16_bf16 v[16:31], v[104:107], a[48:51], v[16:31]
    ds_read_b64_tr_b16 v[120:121], v100 offset:20480
    ds_read_b64_tr_b16 v[122:123], v100 offset:21504
    v_mfma_f32_32x32x16_bf16 v[32:47], v[108:111], a[48:51], v[32:47]
    ds_read_b64_tr_b16 v[124:125], v101 offset:20480
    ds_read_b64_tr_b16 v[126:127], v101 offset:21504
    s_waitcnt vmcnt(2) lgkmcnt(4)
    v_mfma_f32_32x32x16_bf16 v[16:31], v[112:115], a[52:55], v[16:31]
    ds_read_b64_tr_b16 v[104:105], v100 offset:22528
    ds_read_b64_tr_b16 v[106:107], v100 offset:23552
    v_mfma_f32_32x32x16_bf16 v[32:47], v[116:119], a[52:55], v[32:47]
    ds_read_b64_tr_b16 v[108:109], v101 offset:22528
    ds_read_b64_tr_b16 v[110:111], v101 offset:23552
    s_waitcnt vmcnt(1) lgkmcnt(4)
    v_mfma_f32_32x32x16_bf16 v[16:31], v[120:123], a[56:59], v[16:31]
    v_mfma_f32_32x32x16_bf16 v[32:47], v[124:127], a[56:59], v[32:47]
    s_waitcnt vmcnt(0) lgkmcnt(0)
    v_mfma_f32_32x32x16_bf16 v[16:31], v[104:107], a[60:63], v[16:31]
    v_mfma_f32_32x32x16_bf16 v[32:47], v[108:111], a[60:63], v[32:47]
    s_nop 10
    v_cvt_pk_bf16_f32 v84, v16, v17
    v_cvt_pk_bf16_f32 v85, v18, v19
    v_cvt_pk_bf16_f32 v86, v20, v21
    v_cvt_pk_bf16_f32 v87, v22, v23
    v_cvt_pk_bf16_f32 v88, v24, v25
    v_cvt_pk_bf16_f32 v89, v26, v27
    v_cvt_pk_bf16_f32 v90, v28, v29
    v_cvt_pk_bf16_f32 v91, v30, v31
    v_cvt_pk_bf16_f32 v92, v32, v33
    v_cvt_pk_bf16_f32 v93, v34, v35
    v_cvt_pk_bf16_f32 v94, v36, v37
    v_cvt_pk_bf16_f32 v95, v38, v39
    v_cvt_pk_bf16_f32 v96, v40, v41
    v_cvt_pk_bf16_f32 v97, v42, v43
    v_cvt_pk_bf16_f32 v98, v44, v45
    v_cvt_pk_bf16_f32 v99, v46, v47
    v_dot2_f32_bf16 v100, v84, s89, 0
    v_dot2_f32_bf16 v101, v84, v84, 0
    v_dot2_f32_bf16 v102, v84, v48, 0
    v_dot2_f32_bf16 v100, v85, s89, v100
    v_dot2_f32_bf16 v101, v85, v85, v101
    v_dot2_f32_bf16 v102, v85, v49, v102
    v_dot2_f32_bf16 v100, v86, s89, v100
    v_dot2_f32_bf16 v101, v86, v86, v101
    v_dot2_f32_bf16 v102, v86, v50, v102
    v_dot2_f32_bf16 v100, v87, s89, v100
    v_dot2_f32_bf16 v101, v87, v87, v101
    v_dot2_f32_bf16 v102, v87, v51, v102
    v_dot2_f32_bf16 v100, v88, s89, v100
    v_dot2_f32_bf16 v101, v88, v88, v101
    v_dot2_f32_bf16 v102, v88, v52, v102
    v_dot2_f32_bf16 v100, v89, s89, v100
    v_dot2_f32_bf16 v101, v89, v89, v101
    v_dot2_f32_bf16 v102, v89, v53, v102
    v_dot2_f32_bf16 v100, v90, s89, v100
    v_dot2_f32_bf16 v101, v90, v90, v101
    v_dot2_f32_bf16 v102, v90, v54, v102
    v_dot2_f32_bf16 v100, v91, s89, v100
    v_dot2_f32_bf16 v101, v91, v91, v101
    v_dot2_f32_bf16 v102, v91, v55, v102
    v_dot2_f32_bf16 v100, v92, s89, v100
    v_dot2_f32_bf16 v101, v92, v92, v101
    v_dot2_f32_bf16 v102, v92, v56, v102
    v_dot2_f32_bf16 v100, v93, s89, v100
    v_dot2_f32_bf16 v101, v93, v93, v101
    v_dot2_f32_bf16 v102, v93, v57, v102
    v_dot2_f32_bf16 v100, v94, s89, v100
    v_dot2_f32_bf16 v101, v94, v94, v101
    v_dot2_f32_bf16 v102, v94, v58, v102
    v_dot2_f32_bf16 v100, v95, s89, v100
    v_dot2_f32_bf16 v101, v95, v95, v101
    v_dot2_f32_bf16 v102, v95, v59, v102
    v_dot2_f32_bf16 v100, v96, s89, v100
    v_dot2_f32_bf16 v101, v96, v96, v101
    v_dot2_f32_bf16 v102, v96, v60, v102
    v_dot2_f32_bf16 v100, v97, s89, v100
    v_dot2_f32_bf16 v101, v97, v97, v101
    v_dot2_f32_bf16 v102, v97, v61, v102
    v_dot2_f32_bf16 v100, v98, s89, v100
    v_dot2_f32_bf16 v101, v98, v98, v101
    v_dot2_f32_bf16 v102, v98, v62, v102
    v_dot2_f32_bf16 v100, v99, s89, v100
    v_dot2_f32_bf16 v101, v99, v99, v101
    v_dot2_f32_bf16 v102, v99, v63, v102
    s_lshl_b32 s76, s62, 9
    s_add_u32 s77, s76, s74
    v_mov_b32 v103, 0
    v_mov_b32 v4, v100
    v_mov_b32 v5, v101
    v_mov_b32 v6, v102
    v_permlane32_swap_b32 v100, v4
    v_permlane32_swap_b32 v101, v5
    v_permlane32_swap_b32 v102, v6
    v_add_f32 v100, v100, v4
    v_add_f32 v101, v101, v5
    v_add_f32 v102, v102, v6
    s_mov_b32 exec_hi, 0
    buffer_store_dwordx4 v[100:103], v14, s[40:43], s77 offen offset:3072 sc1
    s_mov_b64 exec, -1
    v_lshlrev_b32 v16, 16, v84
    v_and_b32 v17, s90, v84
    v_lshlrev_b32 v18, 16, v85
    v_and_b32 v19, s90, v85
    v_lshlrev_b32 v20, 16, v86
    v_and_b32 v21, s90, v86
    v_lshlrev_b32 v22, 16, v87
    v_and_b32 v23, s90, v87
    v_lshlrev_b32 v24, 16, v88
    v_and_b32 v25, s90, v88
    v_lshlrev_b32 v26, 16, v89
    v_and_b32 v27, s90, v89
    v_lshlrev_b32 v28, 16, v90
    v_and_b32 v29, s90, v90
    v_lshlrev_b32 v30, 16, v91
    v_and_b32 v31, s90, v91
    v_lshlrev_b32 v32, 16, v92
    v_and_b32 v33, s90, v92
    v_lshlrev_b32 v34, 16, v93
    v_and_b32 v35, s90, v93
    v_lshlrev_b32 v36, 16, v94
    v_and_b32 v37, s90, v94
    v_lshlrev_b32 v38, 16, v95
    v_and_b32 v39, s90, v95
    v_lshlrev_b32 v40, 16, v96
    v_and_b32 v41, s90, v96
    v_lshlrev_b32 v42, 16, v97
    v_and_b32 v43, s90, v97
    v_lshlrev_b32 v44, 16, v98
    v_and_b32 v45, s90, v98
    v_lshlrev_b32 v46, 16, v99
    v_and_b32 v47, s90, v99
    s_mov_b32 s78, 0x05040100
    s_mov_b32 s79, 0x07060302
    v_accvgpr_read_b32 v4, a128
    v_accvgpr_read_b32 v8, a132
    v_accvgpr_read_b32 v5, a129
    v_accvgpr_read_b32 v9, a133
    v_accvgpr_read_b32 v6, a130
    v_accvgpr_read_b32 v10, a134
    v_accvgpr_read_b32 v7, a131
    v_accvgpr_read_b32 v11, a135
    v_perm_b32 v136, v8, v4, s78
    v_perm_b32 v140, v8, v4, s79
    v_perm_b32 v144, v9, v5, s78
    v_perm_b32 v148, v9, v5, s79
    v_perm_b32 v152, v10, v6, s78
    v_perm_b32 v156, v10, v6, s79
    v_perm_b32 v160, v11, v7, s78
    v_perm_b32 v164, v11, v7, s79
    v_accvgpr_read_b32 v4, a136
    v_accvgpr_read_b32 v8, a140
    v_accvgpr_read_b32 v5, a137
    v_accvgpr_read_b32 v9, a141
    v_accvgpr_read_b32 v6, a138
    v_accvgpr_read_b32 v10, a142
    v_accvgpr_read_b32 v7, a139
    v_accvgpr_read_b32 v11, a143
    v_perm_b32 v137, v8, v4, s78
    v_perm_b32 v141, v8, v4, s79
    v_perm_b32 v145, v9, v5, s78
    v_perm_b32 v149, v9, v5, s79
    v_perm_b32 v153, v10, v6, s78
    v_perm_b32 v157, v10, v6, s79
    v_perm_b32 v161, v11, v7, s78
    v_perm_b32 v165, v11, v7, s79
    v_accvgpr_read_b32 v4, a160
    v_accvgpr_read_b32 v8, a164
    v_accvgpr_read_b32 v5, a161
    v_accvgpr_read_b32 v9, a165
    v_accvgpr_read_b32 v6, a162
    v_accvgpr_read_b32 v10, a166
    v_accvgpr_read_b32 v7, a163
    v_accvgpr_read_b32 v11, a167
    v_perm_b32 v138, v8, v4, s78
    v_perm_b32 v142, v8, v4, s79
    v_perm_b32 v146, v9, v5, s78
    v_perm_b32 v150, v9, v5, s79
    v_perm_b32 v154, v10, v6, s78
    v_perm_b32 v158, v10, v6, s79
    v_perm_b32 v162, v11, v7, s78
    v_perm_b32 v166, v11, v7, s79
    v_accvgpr_read_b32 v4, a168
    v_accvgpr_read_b32 v8, a172
    v_accvgpr_read_b32 v5, a169
    v_accvgpr_read_b32 v9, a173
    v_accvgpr_read_b32 v6, a170
    v_accvgpr_read_b32 v10, a174
    v_accvgpr_read_b32 v7, a171
    v_accvgpr_read_b32 v11, a175
    v_perm_b32 v139, v8, v4, s78
    v_perm_b32 v143, v8, v4, s79
    v_perm_b32 v147, v9, v5, s78
    v_perm_b32 v151, v9, v5, s79
    v_perm_b32 v155, v10, v6, s78
    v_perm_b32 v159, v10, v6, s79
    v_perm_b32 v163, v11, v7, s78
    v_perm_b32 v167, v11, v7, s79
    v_accvgpr_read_b32 v4, a144
    v_accvgpr_read_b32 v8, a148
    v_accvgpr_read_b32 v5, a145
    v_accvgpr_read_b32 v9, a149
    v_accvgpr_read_b32 v6, a146
    v_accvgpr_read_b32 v10, a150
    v_accvgpr_read_b32 v7, a147
    v_accvgpr_read_b32 v11, a151
    v_perm_b32 v168, v8, v4, s78
    v_perm_b32 v172, v8, v4, s79
    v_perm_b32 v176, v9, v5, s78
    v_perm_b32 v180, v9, v5, s79
    v_perm_b32 v184, v10, v6, s78
    v_perm_b32 v188, v10, v6, s79
    v_perm_b32 v192, v11, v7, s78
    v_perm_b32 v196, v11, v7, s79
    v_accvgpr_read_b32 v4, a152
    v_accvgpr_read_b32 v8, a156
    v_accvgpr_read_b32 v5, a153
    v_accvgpr_read_b32 v9, a157
    v_accvgpr_read_b32 v6, a154
    v_accvgpr_read_b32 v10, a158
    v_accvgpr_read_b32 v7, a155
    v_accvgpr_read_b32 v11, a159
    v_perm_b32 v169, v8, v4, s78
    v_perm_b32 v173, v8, v4, s79
    v_perm_b32 v177, v9, v5, s78
    v_perm_b32 v181, v9, v5, s79
    v_perm_b32 v185, v10, v6, s78
    v_perm_b32 v189, v10, v6, s79
    v_perm_b32 v193, v11, v7, s78
    v_perm_b32 v197, v11, v7, s79
    v_accvgpr_read_b32 v4, a176
    v_accvgpr_read_b32 v8, a180
    v_accvgpr_read_b32 v5, a177
    v_accvgpr_read_b32 v9, a181
    v_accvgpr_read_b32 v6, a178
    v_accvgpr_read_b32 v10, a182
    v_accvgpr_read_b32 v7, a179
    v_accvgpr_read_b32 v11, a183
    v_perm_b32 v170, v8, v4, s78
    v_perm_b32 v174, v8, v4, s79
    v_perm_b32 v178, v9, v5, s78
    v_perm_b32 v182, v9, v5, s79
    v_perm_b32 v186, v10, v6, s78
    v_perm_b32 v190, v10, v6, s79
    v_perm_b32 v194, v11, v7, s78
    v_perm_b32 v198, v11, v7, s79
    v_accvgpr_read_b32 v4, a184
    v_accvgpr_read_b32 v8, a188
    v_accvgpr_read_b32 v5, a185
    v_accvgpr_read_b32 v9, a189
    v_accvgpr_read_b32 v6, a186
    v_accvgpr_read_b32 v10, a190
    v_accvgpr_read_b32 v7, a187
    v_accvgpr_read_b32 v11, a191
    v_perm_b32 v171, v8, v4, s78
    v_perm_b32 v175, v8, v4, s79
    v_perm_b32 v179, v9, v5, s78
    v_perm_b32 v183, v9, v5, s79
    v_perm_b32 v187, v10, v6, s78
    v_perm_b32 v191, v10, v6, s79
    v_perm_b32 v195, v11, v7, s78
    v_perm_b32 v199, v11, v7, s79
    v_mul_u32_u24 v6, 12416, v3
    v_lshl_add_u32 v6, v2, 4, v6
    s_mov_b32 s88, 0
L_spin_11:
    s_mul_i32 s77, s60, 198656
    s_add_u32 s77, s77, s76
    buffer_load_dwordx4 v[104:107], v6, s[40:43], s77 offen offset:3072 sc1
    s_add_u32 s77, s77, 24832
    buffer_load_dwordx4 v[108:111], v6, s[40:43], s77 offen offset:3072 sc1
    s_add_u32 s77, s77, 24832
    buffer_load_dwordx4 v[112:115], v6, s[40:43], s77 offen offset:3072 sc1
    s_add_u32 s77, s77, 24832
    buffer_load_dwordx4 v[116:119], v6, s[40:43], s77 offen offset:3072 sc1
    s_add_u32 s77, s77, 24832
    buffer_load_dwordx4 v[120:123], v6, s[40:43], s77 offen offset:3072 sc1
    s_add_u32 s77, s77, 24832
    buffer_load_dwordx4 v[124:127], v6, s[40:43], s77 offen offset:3072 sc1
    s_add_u32 s77, s77, 24832
    buffer_load_dwordx4 v[128:131], v6, s[40:43], s77 offen offset:3072 sc1
    s_add_u32 s77, s77, 24832
    buffer_load_dwordx4 v[132:135], v6, s[40:43], s77 offen offset:3072 sc1
    s_waitcnt vmcnt(0)
    v_max3_u32 v4, v104, v108, v112
    v_max3_u32 v5, v116, v120, v124
    v_max3_u32 v4, v4, v128, v132
    v_max_u32 v4, v4, v5
    v_cmp_eq_u32 vcc, -1, v4
    s_nop 0
    s_cbranch_vccz L_ok_12
    s_add_u32 s88, s88, 1
    s_cmp_lt_u32 s88, 65536
    s_cbranch_scc1 L_spin_11
L_ok_12:
    v_pk_add_f32 v[104:105], v[104:105], v[120:121]
    v_pk_add_f32 v[106:107], v[106:107], v[122:123]
    v_pk_add_f32 v[108:109], v[108:109], v[124:125]
    v_pk_add_f32 v[110:111], v[110:111], v[126:127]
    v_pk_add_f32 v[112:113], v[112:113], v[128:129]
    v_pk_add_f32 v[114:115], v[114:115], v[130:131]
    v_pk_add_f32 v[116:117], v[116:117], v[132:133]
    v_pk_add_f32 v[118:119], v[118:119], v[134:135]
    v_pk_add_f32 v[104:105], v[104:105], v[112:113]
    v_pk_add_f32 v[106:107], v[106:107], v[114:115]
    v_pk_add_f32 v[108:109], v[108:109], v[116:117]
    v_pk_add_f32 v[110:111], v[110:111], v[118:119]
    v_pk_add_f32 v[104:105], v[104:105], v[108:109]
    v_pk_add_f32 v[106:107], v[106:107], v[110:111]
    v_mov_b32 v4, v104
    v_mov_b32 v5, v105
    v_mov_b32 v6, v106
    v_permlane32_swap_b32 v104, v4
    v_permlane32_swap_b32 v105, v5
    v_permlane32_swap_b32 v106, v6
    v_add_f32 v104, v104, v4
    v_add_f32 v105, v105, v5
    v_add_f32 v106, v106, v6
    v_mul_f32 v104, 0x3a800000, v104
    v_mul_f32 v105, 0x3a800000, v105
    v_fma_f32 v4, -v104, v104, v105
    v_max_f32 v4, 0, v4
    v_cvt_pk_bf16_f32 v108, v104, v104
    v_and_b32 v108, s90, v108
    v_cvt_pk_bf16_f32 v4, v4, v4
    v_and_b32 v4, s90, v4
    v_add_f32 v4, 0x3727c5ac, v4
    v_cvt_pk_bf16_f32 v4, v4, v4
    v_and_b32 v4, s90, v4
    v_sqrt_f32 v4, v4
    s_nop 0
    v_cvt_pk_bf16_f32 v4, v4, v4
    v_and_b32 v4, s90, v4
    v_rcp_f32 v110, v4
    v_fma_f32 v112, -v108, v64, v106
    v_mul_f32 v112, v112, v110
    v_mul_f32 v111, v108, v110
    s_nop 0
    v_max_f32_dpp v4, v112, v112 row_ror:8 row_mask:0xf bank_mask:0xf
    s_nop 1
    v_max_f32_dpp v4, v4, v4 row_ror:4 row_mask:0xf bank_mask:0xf
    s_nop 1
    v_max_f32_dpp v4, v4, v4 row_ror:2 row_mask:0xf bank_mask:0xf
    s_nop 1
    v_max_f32_dpp v4, v4, v4 row_ror:1 row_mask:0xf bank_mask:0xf
    v_mov_b32 v5, v4
    s_nop 1
    v_permlane16_swap_b32 v4, v5
    v_max_f32 v4, v4, v5
    v_cmp_eq_f32 vcc, v4, v112
    s_nop 0
    s_ff1_i32_b32 s77, vcc_lo
    s_and_b32 s77, s77, 31
    s_lshl_b32 s78, s62, 2
    v_mov_b32 v6, s78
    ds_write_b32 v6, v4 offset:25600
    v_pk_fma_f32 v[232:233], v[16:17], v[110:111], v[110:111] op_sel:[0,0,1] op_sel_hi:[1,0,1] neg_lo:[0,0,1] neg_hi:[0,0,1]
    v_cvt_pk_bf16_f32 v116, v232, v233
    v_pk_fma_f32 v[234:235], v[18:19], v[110:111], v[110:111] op_sel:[0,0,1] op_sel_hi:[1,0,1] neg_lo:[0,0,1] neg_hi:[0,0,1]
    v_cvt_pk_bf16_f32 v117, v234, v235
    v_pk_fma_f32 v[236:237], v[20:21], v[110:111], v[110:111] op_sel:[0,0,1] op_sel_hi:[1,0,1] neg_lo:[0,0,1] neg_hi:[0,0,1]
    v_cvt_pk_bf16_f32 v118, v236, v237
    v_pk_fma_f32 v[238:239], v[22:23], v[110:111], v[110:111] op_sel:[0,0,1] op_sel_hi:[1,0,1] neg_lo:[0,0,1] neg_hi:[0,0,1]
    v_cvt_pk_bf16_f32 v119, v238, v239
    s_waitcnt lgkmcnt(0)
    s_barrier
    v_mov_b32 v6, 0
    ds_read_b128 v[8:11], v6 offset:25600
    v_pk_fma_f32 v[240:241], v[24:25], v[110:111], v[110:111] op_sel:[0,0,1] op_sel_hi:[1,0,1] neg_lo:[0,0,1] neg_hi:[0,0,1]
    v_cvt_pk_bf16_f32 v120, v240, v241
    v_pk_fma_f32 v[242:243], v[26:27], v[110:111], v[110:111] op_sel:[0,0,1] op_sel_hi:[1,0,1] neg_lo:[0,0,1] neg_hi:[0,0,1]
    v_cvt_pk_bf16_f32 v121, v242, v243
    v_pk_fma_f32 v[244:245], v[28:29], v[110:111], v[110:111] op_sel:[0,0,1] op_sel_hi:[1,0,1] neg_lo:[0,0,1] neg_hi:[0,0,1]
    v_cvt_pk_bf16_f32 v122, v244, v245
    v_pk_fma_f32 v[246:247], v[30:31], v[110:111], v[110:111] op_sel:[0,0,1] op_sel_hi:[1,0,1] neg_lo:[0,0,1] neg_hi:[0,0,1]
    v_cvt_pk_bf16_f32 v123, v246, v247
    v_pk_fma_f32 v[232:233], v[32:33], v[110:111], v[110:111] op_sel:[0,0,1] op_sel_hi:[1,0,1] neg_lo:[0,0,1] neg_hi:[0,0,1]
    v_cvt_pk_bf16_f32 v124, v232, v233
    v_pk_fma_f32 v[234:235], v[34:35], v[110:111], v[110:111] op_sel:[0,0,1] op_sel_hi:[1,0,1] neg_lo:[0,0,1] neg_hi:[0,0,1]
    v_cvt_pk_bf16_f32 v125, v234, v235
    v_pk_fma_f32 v[236:237], v[36:37], v[110:111], v[110:111] op_sel:[0,0,1] op_sel_hi:[1,0,1] neg_lo:[0,0,1] neg_hi:[0,0,1]
    v_cvt_pk_bf16_f32 v126, v236, v237
    v_pk_fma_f32 v[238:239], v[38:39], v[110:111], v[110:111] op_sel:[0,0,1] op_sel_hi:[1,0,1] neg_lo:[0,0,1] neg_hi:[0,0,1]
    v_cvt_pk_bf16_f32 v127, v238, v239
    v_pk_fma_f32 v[240:241], v[40:41], v[110:111], v[110:111] op_sel:[0,0,1] op_sel_hi:[1,0,1] neg_lo:[0,0,1] neg_hi:[0,0,1]
    v_cvt_pk_bf16_f32 v128, v240, v241
    v_pk_fma_f32 v[242:243], v[42:43], v[110:111], v[110:111] op_sel:[0,0,1] op_sel_hi:[1,0,1] neg_lo:[0,0,1] neg_hi:[0,0,1]
    v_cvt_pk_bf16_f32 v129, v242, v243
    v_pk_fma_f32 v[244:245], v[44:45], v[110:111], v[110:111] op_sel:[0,0,1] op_sel_hi:[1,0,1] neg_lo:[0,0,1] neg_hi:[0,0,1]
    v_cvt_pk_bf16_f32 v130, v244, v245
    v_pk_fma_f32 v[246:247], v[46:47], v[110:111], v[110:111] op_sel:[0,0,1] op_sel_hi:[1,0,1] neg_lo:[0,0,1] neg_hi:[0,0,1]
    v_cvt_pk_bf16_f32 v131, v246, v247
    s_waitcnt lgkmcnt(0)
    v_max3_f32 v5, v8, v9, v10
    v_max_f32 v5, v5, v11
    s_mov_b32 s79, 3
    v_cmp_eq_f32 vcc, v5, v10
    s_nop 0
    s_cmp_lg_u32 vcc_lo, 0
    s_cselect_b32 s79, 2, s79
    v_cmp_eq_f32 vcc, v5, v9
    s_nop 0
    s_cmp_lg_u32 vcc_lo, 0
    s_cselect_b32 s79, 1, s79
    v_cmp_eq_f32 vcc, v5, v8
    s_nop 0
    s_cmp_lg_u32 vcc_lo, 0
    s_cselect_b32 s79, 0, s79
    s_cmp_eq_u32 s79, s62
    s_cbranch_scc0 L_nopub_13
    s_lshl_b32 s78, s60, 7
    s_lshl_b32 s79, s62, 5
    s_add_u32 s78, s78, s79
    s_add_u32 s78, s78, s77
    v_mov_b32 v113, s78
    v_lshlrev_b32 v6, 6, v3
    v_mov_b32 v7, 0
    s_mov_b32 s80, 1
    s_mov_b32 s81, 1
    s_lshl_b64 exec, s[80:81], s77
    buffer_store_dwordx4 v[116:119], v6, s[40:43], s74 offen offset:2688 sc1
    buffer_store_dwordx4 v[120:123], v6, s[40:43], s74 offen offset:2704 sc1
    buffer_store_dwordx4 v[124:127], v6, s[40:43], s74 offen offset:2720 sc1
    buffer_store_dwordx4 v[128:131], v6, s[40:43], s74 offen offset:2736 sc1
    buffer_store_dwordx2 v[112:113], v7, s[40:43], s74 offen offset:2944 sc1
    buffer_store_dwordx4 v[84:87], v6, s[40:43], s74 offen offset:2816 sc1
    buffer_store_dwordx4 v[88:91], v6, s[40:43], s74 offen offset:2832 sc1
    buffer_store_dwordx4 v[92:95], v6, s[40:43], s74 offen offset:2848 sc1
    buffer_store_dwordx4 v[96:99], v6, s[40:43], s74 offen offset:2864 sc1
    s_mov_b64 exec, -1
L_nopub_13:
    v_lshlrev_b32 v232, 16, v116
    v_and_b32 v233, s90, v116
    v_pk_add_f32 v[232:233], v[232:233], v[16:17]
    v_cvt_pk_bf16_f32 v16, v232, v233
    v_lshlrev_b32 v232, 16, v117
    v_and_b32 v233, s90, v117
    v_pk_add_f32 v[232:233], v[232:233], v[18:19]
    v_cvt_pk_bf16_f32 v17, v232, v233
    v_lshlrev_b32 v232, 16, v118
    v_and_b32 v233, s90, v118
    v_pk_add_f32 v[232:233], v[232:233], v[20:21]
    v_cvt_pk_bf16_f32 v18, v232, v233
    v_lshlrev_b32 v232, 16, v119
    v_and_b32 v233, s90, v119
    v_pk_add_f32 v[232:233], v[232:233], v[22:23]
    v_cvt_pk_bf16_f32 v19, v232, v233
    v_lshlrev_b32 v232, 16, v120
    v_and_b32 v233, s90, v120
    v_pk_add_f32 v[232:233], v[232:233], v[24:25]
    v_cvt_pk_bf16_f32 v20, v232, v233
    v_lshlrev_b32 v232, 16, v121
    v_and_b32 v233, s90, v121
    v_pk_add_f32 v[232:233], v[232:233], v[26:27]
    v_cvt_pk_bf16_f32 v21, v232, v233
    v_lshlrev_b32 v232, 16, v122
    v_and_b32 v233, s90, v122
    v_pk_add_f32 v[232:233], v[232:233], v[28:29]
    v_cvt_pk_bf16_f32 v22, v232, v233
    v_lshlrev_b32 v232, 16, v123
    v_and_b32 v233, s90, v123
    v_pk_add_f32 v[232:233], v[232:233], v[30:31]
    v_cvt_pk_bf16_f32 v23, v232, v233
    v_lshlrev_b32 v232, 16, v124
    v_and_b32 v233, s90, v124
    v_pk_add_f32 v[232:233], v[232:233], v[32:33]
    v_cvt_pk_bf16_f32 v24, v232, v233
    v_lshlrev_b32 v232, 16, v125
    v_and_b32 v233, s90, v125
    v_pk_add_f32 v[232:233], v[232:233], v[34:35]
    v_cvt_pk_bf16_f32 v25, v232, v233
    v_lshlrev_b32 v232, 16, v126
    v_and_b32 v233, s90, v126
    v_pk_add_f32 v[232:233], v[232:233], v[36:37]
    v_cvt_pk_bf16_f32 v26, v232, v233
    v_lshlrev_b32 v232, 16, v127
    v_and_b32 v233, s90, v127
    v_pk_add_f32 v[232:233], v[232:233], v[38:39]
    v_cvt_pk_bf16_f32 v27, v232, v233
    v_lshlrev_b32 v232, 16, v128
    v_and_b32 v233, s90, v128
    v_pk_add_f32 v[232:233], v[232:233], v[40:41]
    v_cvt_pk_bf16_f32 v28, v232, v233
    v_lshlrev_b32 v232, 16, v129
    v_and_b32 v233, s90, v129
    v_pk_add_f32 v[232:233], v[232:233], v[42:43]
    v_cvt_pk_bf16_f32 v29, v232, v233
    v_lshlrev_b32 v232, 16, v130
    v_and_b32 v233, s90, v130
    v_pk_add_f32 v[232:233], v[232:233], v[44:45]
    v_cvt_pk_bf16_f32 v30, v232, v233
    v_lshlrev_b32 v232, 16, v131
    v_and_b32 v233, s90, v131
    v_pk_add_f32 v[232:233], v[232:233], v[46:47]
    v_cvt_pk_bf16_f32 v31, v232, v233
    ds_write_b64 v76, v[16:17]
    ds_write_b64 v77, v[18:19]
    ds_write_b64 v78, v[20:21]
    ds_write_b64 v79, v[22:23]
    ds_write_b64 v80, v[24:25]
    ds_write_b64 v81, v[26:27]
    ds_write_b64 v82, v[28:29]
    ds_write_b64 v83, v[30:31]
    s_mov_b32 s78, 0x05040100
    s_mov_b32 s79, 0x07060302
    v_accvgpr_read_b32 v4, a192
    v_accvgpr_read_b32 v8, a194
    v_accvgpr_read_b32 v5, a193
    v_accvgpr_read_b32 v9, a195
    v_perm_b32 v200, v8, v4, s78
    v_perm_b32 v201, v8, v4, s79
    v_perm_b32 v202, v9, v5, s78
    v_perm_b32 v203, v9, v5, s79
    v_accvgpr_read_b32 v4, a196
    v_accvgpr_read_b32 v8, a198
    v_accvgpr_read_b32 v5, a197
    v_accvgpr_read_b32 v9, a199
    v_perm_b32 v204, v8, v4, s78
    v_perm_b32 v205, v8, v4, s79
    v_perm_b32 v206, v9, v5, s78
    v_perm_b32 v207, v9, v5, s79
    v_accvgpr_read_b32 v4, a200
    v_accvgpr_read_b32 v8, a202
    v_accvgpr_read_b32 v5, a201
    v_accvgpr_read_b32 v9, a203
    v_perm_b32 v208, v8, v4, s78
    v_perm_b32 v209, v8, v4, s79
    v_perm_b32 v210, v9, v5, s78
    v_perm_b32 v211, v9, v5, s79
    v_accvgpr_read_b32 v4, a204
    v_accvgpr_read_b32 v8, a206
    v_accvgpr_read_b32 v5, a205
    v_accvgpr_read_b32 v9, a207
    v_perm_b32 v212, v8, v4, s78
    v_perm_b32 v213, v8, v4, s79
    v_perm_b32 v214, v9, v5, s78
    v_perm_b32 v215, v9, v5, s79
    v_accvgpr_read_b32 v4, a208
    v_accvgpr_read_b32 v8, a210
    v_accvgpr_read_b32 v5, a209
    v_accvgpr_read_b32 v9, a211
    v_perm_b32 v216, v8, v4, s78
    v_perm_b32 v217, v8, v4, s79
    v_perm_b32 v218, v9, v5, s78
    v_perm_b32 v219, v9, v5, s79
    v_accvgpr_read_b32 v4, a212
    v_accvgpr_read_b32 v8, a214
    v_accvgpr_read_b32 v5, a213
    v_accvgpr_read_b32 v9, a215
    v_perm_b32 v220, v8, v4, s78
    v_perm_b32 v221, v8, v4, s79
    v_perm_b32 v222, v9, v5, s78
    v_perm_b32 v223, v9, v5, s79
    v_accvgpr_read_b32 v4, a216
    v_accvgpr_read_b32 v8, a218
    v_accvgpr_read_b32 v5, a217
    v_accvgpr_read_b32 v9, a219
    v_perm_b32 v224, v8, v4, s78
    v_perm_b32 v225, v8, v4, s79
    v_perm_b32 v226, v9, v5, s78
    v_perm_b32 v227, v9, v5, s79
    v_accvgpr_read_b32 v4, a220
    v_accvgpr_read_b32 v8, a222
    v_accvgpr_read_b32 v5, a221
    v_accvgpr_read_b32 v9, a223
    v_perm_b32 v228, v8, v4, s78
    v_perm_b32 v229, v8, v4, s79
    v_perm_b32 v230, v9, v5, s78
    v_perm_b32 v231, v9, v5, s79
    v_and_b32 v4, 15, v1
    v_mul_u32_u24 v7, 198656, v4
    v_and_b32 v4, 48, v1
    v_add_u32 v6, v7, v4
    s_mul_i32 s76, s61, 12416
    s_mov_b32 s88, 0
L_spin_14:
    buffer_load_dwordx2 v[40:41], v7, s[40:43], s76 offen offset:2944 sc1
    buffer_load_dwordx4 v[32:35], v6, s[40:43], s76 offen offset:2688 sc1
    buffer_load_dwordx4 v[36:39], v6, s[40:43], s76 offen offset:2752 sc1
    s_waitcnt vmcnt(0)
    v_max3_u32 v4, v41, v32, v36
    v_cmp_eq_u32 vcc, -1, v4
    s_nop 0
    s_cbranch_vccz L_ok_15
    s_add_u32 s88, s88, 1
    s_cmp_lt_u32 s88, 65536
    s_cbranch_scc1 L_spin_14
L_ok_15:
    s_waitcnt lgkmcnt(0)
    v_mfma_f32_16x16x32_bf16 v[48:51], v[32:35], v[136:139], 0
    v_mfma_f32_16x16x32_bf16 v[52:55], v[32:35], v[140:143], 0
    v_mfma_f32_16x16x32_bf16 v[56:59], v[32:35], v[144:147], 0
    v_mfma_f32_16x16x32_bf16 v[60:63], v[32:35], v[148:151], 0
    v_mfma_f32_16x16x32_bf16 v[64:67], v[32:35], v[152:155], 0
    v_mfma_f32_16x16x32_bf16 v[68:71], v[32:35], v[156:159], 0
    v_mfma_f32_16x16x32_bf16 v[72:75], v[32:35], v[160:163], 0
    v_mfma_f32_16x16x32_bf16 v[76:79], v[32:35], v[164:167], 0
    v_mfma_f32_16x16x32_bf16 v[48:51], v[36:39], v[168:171], v[48:51]
    v_mfma_f32_16x16x32_bf16 v[52:55], v[36:39], v[172:175], v[52:55]
    v_mfma_f32_16x16x32_bf16 v[56:59], v[36:39], v[176:179], v[56:59]
    v_mfma_f32_16x16x32_bf16 v[60:63], v[36:39], v[180:183], v[60:63]
    v_mfma_f32_16x16x32_bf16 v[64:67], v[36:39], v[184:187], v[64:67]
    v_mfma_f32_16x16x32_bf16 v[68:71], v[36:39], v[188:191], v[68:71]
    v_mfma_f32_16x16x32_bf16 v[72:75], v[36:39], v[192:195], v[72:75]
    v_mfma_f32_16x16x32_bf16 v[76:79], v[36:39], v[196:199], v[76:79]
    v_max_f32_dpp v4, v40, v40 row_ror:8 row_mask:0xf bank_mask:0xf
    s_nop 1
    v_max_f32_dpp v4, v4, v4 row_ror:4 row_mask:0xf bank_mask:0xf
    s_nop 1
    v_max_f32_dpp v4, v4, v4 row_ror:2 row_mask:0xf bank_mask:0xf
    s_nop 1
    v_max_f32_dpp v4, v4, v4 row_ror:1 row_mask:0xf bank_mask:0xf
    v_cmp_eq_f32 vcc, v4, v40
    s_nop 0
    s_ff1_i32_b32 s92, vcc_lo
    s_and_b32 s92, s92, 15
    s_nop 3
    v_readlane_b32 s91, v41, s92
    v_readlane_b32 s93, v40, s92
    s_cmp_ge_u32 s60, 14
    s_cbranch_scc1 L_noffn1_16
    v_and_b32 v4, 15, v1
    v_lshrrev_b32 v5, 1, v4
    v_and_b32 v4, 1, v4
    v_lshlrev_b32 v4, 5, v4
    v_lshl_add_u32 v4, v5, 7, v4
    s_lshl_b32 s76, s63, 10
    s_lshl_b32 s77, s64, 6
    s_add_u32 s76, s76, s77
    s_add_u32 s76, s76, s74
    s_add_u32 s76, s76, 5120
    s_and_b32 s77, s92, 3
    s_cmp_eq_u32 s77, 0
    s_cbranch_scc0 L_sel_18
    v_mov_b32 v32, v48
    v_mov_b32 v33, v52
    v_mov_b32 v34, v56
    v_mov_b32 v35, v60
    v_mov_b32 v36, v64
    v_mov_b32 v37, v68
    v_mov_b32 v38, v72
    v_mov_b32 v39, v76
    s_branch L_seldone_17
L_sel_18:
    s_cmp_eq_u32 s77, 1
    s_cbranch_scc0 L_sel_19
    v_mov_b32 v32, v49
    v_mov_b32 v33, v53
    v_mov_b32 v34, v57
    v_mov_b32 v35, v61
    v_mov_b32 v36, v65
    v_mov_b32 v37, v69
    v_mov_b32 v38, v73
    v_mov_b32 v39, v77
    s_branch L_seldone_17
L_sel_19:
    s_cmp_eq_u32 s77, 2
    s_cbranch_scc0 L_sel_20
    v_mov_b32 v32, v50
    v_mov_b32 v33, v54
    v_mov_b32 v34, v58
    v_mov_b32 v35, v62
    v_mov_b32 v36, v66
    v_mov_b32 v37, v70
    v_mov_b32 v38, v74
    v_mov_b32 v39, v78
    s_branch L_seldone_17
L_sel_20:
    v_mov_b32 v32, v51
    v_mov_b32 v33, v55
    v_mov_b32 v34, v59
    v_mov_b32 v35, v63
    v_mov_b32 v36, v67
    v_mov_b32 v37, v71
    v_mov_b32 v38, v75
    v_mov_b32 v39, v79
L_seldone_17:
    s_lshr_b32 s77, s92, 2
    s_lshl_b32 s77, s77, 4
    s_mov_b64 s[80:81], 0xffff
    s_lshl_b64 exec, s[80:81], s77
    buffer_store_dwordx4 v[32:35], v4, s[40:43], s76 offen offset:0 sc1
    buffer_store_dwordx4 v[36:39], v4, s[40:43], s76 offen offset:16 sc1
    s_mov_b64 exec, -1
L_noffn1_16:
    s_lshl_b32 s76, s62, 12
    s_add_u32 s76, s76, 0
    v_add_u32 v4, s76, v14
    ds_read_b128 v[48:51], v4 offset:0
    ds_read_b128 v[52:55], v4 offset:1024
    ds_read_b128 v[56:59], v4 offset:2048
    ds_read_b128 v[60:63], v4 offset:3072
    s_lshl_b32 s77, s60, 7
    s_lshl_b32 s78, s62, 5
    s_add_u32 s77, s77, s78
    s_sub_u32 s77, s91, s77
    v_lshrrev_b32 v5, 3, v1
    v_sub_u32 v5, s77, v5
    v_mov_b32 v6, 2146435072
    v_lshrrev_b32 v7, 3, v1
    v_and_b32 v8, 7, v1
    v_lshrrev_b32 v9, 4, v1
    v_xor_b32 v8, v8, v9
    v_lshlrev_b32 v8, 4, v8
    v_lshl_add_u32 v7, v7, 11, v8
    v_xor_b32 v8, 64, v7
    s_lshl_b32 s76, s60, 18
    s_lshl_b32 s78, s62, 16
    s_add_u32 s76, s76, s78
    s_lshl_b32 s78, s61, 7
    s_add_u32 s76, s76, s78
    v_cmp_eq_u32 vcc, 0, v5
    s_nop 1
    v_cndmask_b32 v64, v7, v6, vcc
    v_cmp_eq_u32 vcc, 8, v5
    s_nop 1
    v_cndmask_b32 v65, v8, v6, vcc
    v_cmp_eq_u32 vcc, 16, v5
    s_nop 1
    v_cndmask_b32 v66, v7, v6, vcc
    v_cmp_eq_u32 vcc, 24, v5
    s_nop 1
    v_cndmask_b32 v67, v8, v6, vcc
    s_waitcnt lgkmcnt(3)
    buffer_store_dwordx4 v[48:51], v64, s[44:47], s76 offen
    s_add_u32 s76, s76, 16384
    s_waitcnt lgkmcnt(2)
    buffer_store_dwordx4 v[52:55], v65, s[44:47], s76 offen
    s_add_u32 s76, s76, 16384
    s_waitcnt lgkmcnt(1)
    buffer_store_dwordx4 v[56:59], v66, s[44:47], s76 offen
    s_add_u32 s76, s76, 16384
    s_waitcnt lgkmcnt(0)
    buffer_store_dwordx4 v[60:63], v67, s[44:47], s76 offen
    s_cmp_ge_u32 s60, 14
    s_cbranch_scc1 L_noffn2_22
    v_mul_u32_u24 v6, 12416, v3
    v_lshl_add_u32 v6, v2, 2, v6
    s_mov_b32 s88, 0
L_spin_23:
    s_mul_i32 s76, s60, 198656
    s_lshl_b32 s77, s61, 7
    s_add_u32 s76, s76, s77
    s_add_u32 s76, s76, 5120
    buffer_load_dword v68, v6, s[40:43], s76 offen sc1
    s_add_u32 s76, s76, 24832
    buffer_load_dword v69, v6, s[40:43], s76 offen sc1
    s_add_u32 s76, s76, 24832
    buffer_load_dword v70, v6, s[40:43], s76 offen sc1
    s_add_u32 s76, s76, 24832
    buffer_load_dword v71, v6, s[40:43], s76 offen sc1
    s_add_u32 s76, s76, 24832
    buffer_load_dword v72, v6, s[40:43], s76 offen sc1
    s_add_u32 s76, s76, 24832
    buffer_load_dword v73, v6, s[40:43], s76 offen sc1
    s_add_u32 s76, s76, 24832
    buffer_load_dword v74, v6, s[40:43], s76 offen sc1
    s_add_u32 s76, s76, 24832
    buffer_load_dword v75, v6, s[40:43], s76 offen sc1
    s_waitcnt vmcnt(0)
    v_max3_u32 v4, v68, v69, v70
    v_max3_u32 v5, v71, v72, v73
    v_max3_u32 v4, v4, v74, v75
    v_max_u32 v4, v4, v5
    v_cmp_eq_u32 vcc, -1, v4
    s_nop 0
    s_cbranch_vccz L_ok_24
    s_add_u32 s88, s88, 1
    s_cmp_lt_u32 s88, 65536
    s_cbranch_scc1 L_spin_23
L_ok_24:
    v_pk_add_f32 v[68:69], v[68:69], v[72:73]
    v_pk_add_f32 v[70:71], v[70:71], v[74:75]
    v_pk_add_f32 v[68:69], v[68:69], v[70:71]
    v_add_f32 v68, v68, v69
    v_mov_b32 v69, v68
    s_nop 1
    v_permlane32_swap_b32 v68, v69
    v_add_f32 v68, v68, v69
    v_cvt_pk_bf16_f32 v68, v68, v68
    v_and_b32 v68, s90, v68
    v_mov_b32 v69, v68
    s_nop 1
    v_permlane16_swap_b32 v68, v69
    v_mul_f32 v4, 0xbfb8aa3b, v68
    v_exp_f32 v4, v4
    s_nop 0
    v_add_f32 v4, 1.0, v4
    v_rcp_f32 v4, v4
    s_nop 0
    v_mul_f32 v4, v4, v68
    v_cvt_pk_bf16_f32 v4, v4, v4
    v_and_b32 v4, s90, v4
    v_mul_f32 v4, v4, v69
    s_nop 1
    v_mov_b32_dpp v5, v4 quad_perm:[1,0,3,2] row_mask:0xf bank_mask:0xf
    v_cvt_pk_bf16_f32 v4, v4, v5
    s_nop 0
    v_readlane_b32 s76, v4, 0
    v_readlane_b32 s77, v4, 2
    v_readlane_b32 s78, v4, 4
    v_readlane_b32 s79, v4, 6
    v_readlane_b32 s80, v4, 8
    v_readlane_b32 s81, v4, 10
    v_readlane_b32 s82, v4, 12
    v_readlane_b32 s83, v4, 14
    v_dot2_f32_bf16 v72, v200, s76, 0
    v_dot2_f32_bf16 v73, v201, s76, 0
    v_dot2_f32_bf16 v74, v202, s76, 0
    v_dot2_f32_bf16 v75, v203, s76, 0
    v_dot2_f32_bf16 v72, v204, s77, v72
    v_dot2_f32_bf16 v73, v205, s77, v73
    v_dot2_f32_bf16 v74, v206, s77, v74
    v_dot2_f32_bf16 v75, v207, s77, v75
    v_dot2_f32_bf16 v72, v208, s78, v72
    v_dot2_f32_bf16 v73, v209, s78, v73
    v_dot2_f32_bf16 v74, v210, s78, v74
    v_dot2_f32_bf16 v75, v211, s78, v75
    v_dot2_f32_bf16 v72, v212, s79, v72
    v_dot2_f32_bf16 v73, v213, s79, v73
    v_dot2_f32_bf16 v74, v214, s79, v74
    v_dot2_f32_bf16 v75, v215, s79, v75
    v_dot2_f32_bf16 v72, v216, s80, v72
    v_dot2_f32_bf16 v73, v217, s80, v73
    v_dot2_f32_bf16 v74, v218, s80, v74
    v_dot2_f32_bf16 v75, v219, s80, v75
    v_dot2_f32_bf16 v72, v220, s81, v72
    v_dot2_f32_bf16 v73, v221, s81, v73
    v_dot2_f32_bf16 v74, v222, s81, v74
    v_dot2_f32_bf16 v75, v223, s81, v75
    v_dot2_f32_bf16 v72, v224, s82, v72
    v_dot2_f32_bf16 v73, v225, s82, v73
    v_dot2_f32_bf16 v74, v226, s82, v74
    v_dot2_f32_bf16 v75, v227, s82, v75
    v_dot2_f32_bf16 v72, v228, s83, v72
    v_dot2_f32_bf16 v73, v229, s83, v73
    v_dot2_f32_bf16 v74, v230, s83, v74
    v_dot2_f32_bf16 v75, v231, s83, v75
    s_lshl_b32 s84, s62, 10
    s_add_u32 s84, s84, s74
    s_add_u32 s84, s84, 7168
    buffer_store_dwordx4 v[72:75], v14, s[40:43], s84 offen sc1
L_noffn2_22:
    s_cmp_eq_u32 s62, 0
    s_cbranch_scc0 L_fin
    v_mov_b32 v8, s93
    v_cvt_pk_bf16_f32 v8, v8, v8
    v_and_b32 v8, s90, v8
    v_mul_f32 v8, 0xbfb8aa3b, v8
    v_exp_f32 v8, v8
    s_nop 0
    v_add_f32 v8, 1.0, v8
    v_rcp_f32 v8, v8
    s_nop 0
    v_cvt_pk_bf16_f32 v8, v8, v8
    v_and_b32 v8, s90, v8
    v_bfe_u32 v9, v1, 4, 1
    v_lshl_add_u32 v9, v9, 1, v3
    s_lshl_b32 s76, s92, 4
    s_add_u32 s76, s76, s61
    s_mul_i32 s76, s76, 12416
    s_and_b32 s77, s60, 1
    s_lshl_b32 s77, s77, 6
    s_add_u32 s76, s76, s77
    s_lshr_b32 s77, s60, 1
    s_lshl_b32 s77, s77, 3
    s_add_u32 s76, s76, s77
    v_lshrrev_b32 v10, 1, v9
    v_lshlrev_b32 v10, 2, v10
    v_mul_u32_u24 v6, 12416, v1
    v_mov_b32 v7, 2146435072
    v_cmp_gt_u32 vcc, 32, v1
    s_nop 1
    v_cndmask_b32 v7, v7, v6, vcc
    s_mov_b32 s88, 0
L_spin_25:
    s_lshl_b32 s77, s61, 8
    s_lshl_b32 s78, s60, 4
    s_add_u32 s77, s77, s78
    s_add_u32 s77, s77, 7168
    buffer_load_dwordx4 v[16:19], v6, s[40:43], s77 offen sc1
    s_add_u32 s77, s77, 794624
    buffer_load_dwordx4 v[20:23], v6, s[40:43], s77 offen sc1
    s_add_u32 s77, s77, 794624
    buffer_load_dwordx4 v[24:27], v6, s[40:43], s77 offen sc1
    s_add_u32 s77, s77, 794624
    buffer_load_dwordx4 v[28:31], v7, s[40:43], s77 offen sc1
    buffer_load_dword v32, v10, s[40:43], s76 offen offset:2688 sc1
    buffer_load_dword v33, v10, s[40:43], s76 offen offset:2816 sc1
    s_waitcnt vmcnt(0)
    v_max3_u32 v4, v16, v20, v24
    v_max3_u32 v5, v28, v32, v33
    v_max_u32 v4, v4, v5
    v_cmp_eq_u32 vcc, -1, v4
    s_nop 0
    s_cbranch_vccz L_ok_26
    s_add_u32 s88, s88, 1
    s_cmp_lt_u32 s88, 65536
    s_cbranch_scc1 L_spin_25
L_ok_26:
    v_pk_add_f32 v[16:17], v[16:17], v[24:25]
    v_pk_add_f32 v[18:19], v[18:19], v[26:27]
    v_pk_add_f32 v[20:21], v[20:21], v[28:29]
    v_pk_add_f32 v[22:23], v[22:23], v[30:31]
    v_pk_add_f32 v[16:17], v[16:17], v[20:21]
    v_pk_add_f32 v[18:19], v[18:19], v[22:23]
    s_nop 0
    v_permlane32_swap_b32 v16, v17
    v_permlane32_swap_b32 v18, v19
    v_add_f32 v16, v16, v17
    v_add_f32 v18, v18, v19
    v_and_b32 v4, 1, v9
    v_lshlrev_b32 v4, 4, v4
    v_permlane16_swap_b32 v16, v18
    v_add_f32 v16, v16, v18
    v_lshrrev_b32 v32, v4, v32
    v_lshrrev_b32 v33, v4, v33
    v_add_f32_dpp v16, v16, v16 row_ror:8 row_mask:0xf bank_mask:0xf
    s_nop 1
    v_add_f32_dpp v16, v16, v16 row_ror:4 row_mask:0xf bank_mask:0xf
    s_nop 1
    v_add_f32_dpp v16, v16, v16 row_ror:2 row_mask:0xf bank_mask:0xf
    s_nop 1
    v_add_f32_dpp v16, v16, v16 row_ror:1 row_mask:0xf bank_mask:0xf
    v_lshlrev_b32 v32, 16, v32
    v_lshlrev_b32 v33, 16, v33
    v_cvt_pk_bf16_f32 v16, v16, v16
    v_and_b32 v16, s90, v16
    v_mul_f32 v16, v16, v8
    v_cvt_pk_bf16_f32 v16, v16, v16
    v_and_b32 v16, s90, v16
    v_add_f32 v16, v16, v32
    v_cvt_pk_bf16_f32 v16, v16, v16
    v_and_b32 v16, s90, v16
    v_add_f32 v16, v16, v33
    v_cvt_pk_bf16_f32 v16, v16, v16
    s_lshl_b32 s76, s91, 11
    s_lshl_b32 s77, s61, 7
    s_add_u32 s76, s76, s77
    s_lshl_b32 s77, s60, 3
    s_add_u32 s76, s76, s77
    v_lshlrev_b32 v9, 1, v9
    s_mov_b32 exec_lo, 0x00010001
    s_mov_b32 exec_hi, 0x00010001
    buffer_store_short v16, v9, s[44:47], s76 offen
    s_mov_b64 exec, -1
L_fin:
L_end:
    s_endpgm
L_event:
    s_cmp_eq_u32 s68, 2
    s_cbranch_scc1 L_ev_hello
    s_cmp_eq_u32 s68, 13
    s_cbranch_scc1 L_ev_chk
    s_mul_i32 s78, s64, 10240
    s_waitcnt lgkmcnt(0)
    v_add_u32 v4, s78, v162
    v_add_u32 v5, s78, v163
    v_add_u32 v6, s78, v164
    v_add_u32 v7, s78, v165
    ds_read_b128 v[176:179], v4
    ds_read_b128 v[180:183], v5
    ds_read_b128 v[184:187], v6
    ds_read_b128 v[188:191], v7
    ds_read_b64_tr_b16 v[192:193], v166 offset:0
    ds_read_b64_tr_b16 v[194:195], v166 offset:512
    ds_read_b64_tr_b16 v[196:197], v166 offset:10240
    ds_read_b64_tr_b16 v[198:199], v166 offset:10752
    ds_read_b64_tr_b16 v[200:201], v166 offset:20480
    ds_read_b64_tr_b16 v[202:203], v166 offset:20992
    ds_read_b64_tr_b16 v[204:205], v166 offset:30720
    ds_read_b64_tr_b16 v[206:207], v166 offset:31232
    s_waitcnt lgkmcnt(0)
    ds_read_b64_tr_b16 v[208:209], v166 offset:2048
    ds_read_b64_tr_b16 v[210:211], v166 offset:2560
    ds_read_b64_tr_b16 v[212:213], v166 offset:12288
    ds_read_b64_tr_b16 v[214:215], v166 offset:12800
    ds_read_b64_tr_b16 v[216:217], v166 offset:22528
    ds_read_b64_tr_b16 v[218:219], v166 offset:23040
    ds_read_b64_tr_b16 v[220:221], v166 offset:32768
    ds_read_b64_tr_b16 v[222:223], v166 offset:33280
    s_waitcnt lgkmcnt(0)
    ds_read_b64_tr_b16 v[224:225], v166 offset:4096
    ds_read_b64_tr_b16 v[226:227], v166 offset:4608
    ds_read_b64_tr_b16 v[228:229], v166 offset:14336
    ds_read_b64_tr_b16 v[230:231], v166 offset:14848
    ds_read_b64_tr_b16 v[232:233], v166 offset:24576
    ds_read_b64_tr_b16 v[234:235], v166 offset:25088
    ds_read_b64_tr_b16 v[236:237], v166 offset:34816
    ds_read_b64_tr_b16 v[238:239], v166 offset:35328
    s_waitcnt lgkmcnt(0)
    v_dot2_f32_bf16 v240, v176, s89, 0
    v_dot2_f32_bf16 v241, v176, v176, 0
    v_dot2_f32_bf16 v244, v192, s89, 0
    v_dot2_f32_bf16 v245, v208, s89, 0
    v_dot2_f32_bf16 v246, v224, s89, 0
    v_dot2_f32_bf16 v240, v177, s89, v240
    v_dot2_f32_bf16 v241, v177, v177, v241
    v_dot2_f32_bf16 v244, v193, s89, v244
    v_dot2_f32_bf16 v245, v209, s89, v245
    v_dot2_f32_bf16 v246, v225, s89, v246
    v_dot2_f32_bf16 v240, v178, s89, v240
    v_dot2_f32_bf16 v241, v178, v178, v241
    v_dot2_f32_bf16 v244, v194, s89, v244
    v_dot2_f32_bf16 v245, v210, s89, v245
    v_dot2_f32_bf16 v246, v226, s89, v246
    v_dot2_f32_bf16 v240, v179, s89, v240
    v_dot2_f32_bf16 v241, v179, v179, v241
    v_dot2_f32_bf16 v244, v195, s89, v244
    v_dot2_f32_bf16 v245, v211, s89, v245
    v_dot2_f32_bf16 v246, v227, s89, v246
    v_dot2_f32_bf16 v240, v180, s89, v240
    v_dot2_f32_bf16 v241, v180, v180, v241
    v_dot2_f32_bf16 v244, v196, s89, v244
    v_dot2_f32_bf16 v245, v212, s89, v245
    v_dot2_f32_bf16 v246, v228, s89, v246
    v_dot2_f32_bf16 v240, v181, s89, v240
    v_dot2_f32_bf16 v241, v181, v181, v241
    v_dot2_f32_bf16 v244, v197, s89, v244
    v_dot2_f32_bf16 v245, v213, s89, v245
    v_dot2_f32_bf16 v246, v229, s89, v246
    v_dot2_f32_bf16 v240, v182, s89, v240
    v_dot2_f32_bf16 v241, v182, v182, v241
    v_dot2_f32_bf16 v244, v198, s89, v244
    v_dot2_f32_bf16 v245, v214, s89, v245
    v_dot2_f32_bf16 v246, v230, s89, v246
    v_dot2_f32_bf16 v240, v183, s89, v240
    v_dot2_f32_bf16 v241, v183, v183, v241
    v_dot2_f32_bf16 v244, v199, s89, v244
    v_dot2_f32_bf16 v245, v215, s89, v245
    v_dot2_f32_bf16 v246, v231, s89, v246
    v_dot2_f32_bf16 v240, v184, s89, v240
    v_dot2_f32_bf16 v241, v184, v184, v241
    v_dot2_f32_bf16 v244, v200, s89, v244
    v_dot2_f32_bf16 v245, v216, s89, v245
    v_dot2_f32_bf16 v246, v232, s89, v246
    v_dot2_f32_bf16 v240, v185, s89, v240
    v_dot2_f32_bf16 v241, v185, v185, v241
    v_dot2_f32_bf16 v244, v201, s89, v244
    v_dot2_f32_bf16 v245, v217, s89, v245
    v_dot2_f32_bf16 v246, v233, s89, v246
    v_dot2_f32_bf16 v240, v186, s89, v240
    v_dot2_f32_bf16 v241, v186, v186, v241
    v_dot2_f32_bf16 v244, v202, s89, v244
    v_dot2_f32_bf16 v245, v218, s89, v245
    v_dot2_f32_bf16 v246, v234, s89, v246
    v_dot2_f32_bf16 v240, v187, s89, v240
    v_dot2_f32_bf16 v241, v187, v187, v241
    v_dot2_f32_bf16 v244, v203, s89, v244
    v_dot2_f32_bf16 v245, v219, s89, v245
    v_dot2_f32_bf16 v246, v235, s89, v246
    v_dot2_f32_bf16 v240, v188, s89, v240
    v_dot2_f32_bf16 v241, v188, v188, v241
    v_dot2_f32_bf16 v244, v204, s89, v244
    v_dot2_f32_bf16 v245, v220, s89, v245
    v_dot2_f32_bf16 v246, v236, s89, v246
    v_dot2_f32_bf16 v240, v189, s89, v240
    v_dot2_f32_bf16 v241, v189, v189, v241
    v_dot2_f32_bf16 v244, v205, s89, v244
    v_dot2_f32_bf16 v245, v221, s89, v245
    v_dot2_f32_bf16 v246, v237, s89, v246
    v_dot2_f32_bf16 v240, v190, s89, v240
    v_dot2_f32_bf16 v241, v190, v190, v241
    v_dot2_f32_bf16 v244, v206, s89, v244
    v_dot2_f32_bf16 v245, v222, s89, v245
    v_dot2_f32_bf16 v246, v238, s89, v246
    v_dot2_f32_bf16 v240, v191, s89, v240
    v_dot2_f32_bf16 v241, v191, v191, v241
    v_dot2_f32_bf16 v244, v207, s89, v244
    v_dot2_f32_bf16 v245, v223, s89, v245
    v_dot2_f32_bf16 v246, v239, s89, v246
    v_mov_b32 v8, v240
    s_nop 1
    v_permlane32_swap_b32 v240, v8
    v_add_f32 v240, v240, v8
    v_mov_b32 v8, v241
    s_nop 1
    v_permlane32_swap_b32 v241, v8
    v_add_f32 v241, v241, v8
    v_mov_b32 v8, v244
    s_nop 1
    v_permlane32_swap_b32 v244, v8
    v_add_f32 v244, v244, v8
    v_mov_b32 v8, v245
    s_nop 1
    v_permlane32_swap_b32 v245, v8
    v_add_f32 v245, v245, v8
    v_mov_b32 v8, v246
    s_nop 1
    v_permlane32_swap_b32 v246, v8
    v_add_f32 v246, v246, v8
    v_mov_b32 v247, 0
    s_lshl_b32 s78, s63, 1
    s_add_u32 s78, s78, s64
    s_lshl_b32 s78, s78, 8
    s_add_u32 s78, s78, s74
    s_lshl_b32 s79, s64, 9
    s_add_u32 s79, s79, s74
    s_mov_b32 exec_hi, 0
    buffer_store_dwordx2 v[240:241], v13, s[40:43], s78 offen offset:0 sc1
    s_cmp_eq_u32 s63, 0
    s_cbranch_scc0 L_ev_nocs
    buffer_store_dwordx4 v[244:247], v14, s[40:43], s79 offen offset:1024 sc1
L_ev_nocs:
    s_mov_b64 exec, -1
    s_branch L_event_ret
L_ev_hello:
    v_bfe_u32 v4, v1, 2, 2
    v_lshl_add_u32 v4, v3, 2, v4
    v_lshlrev_b32 v4, 6, v4
    v_bfe_u32 v5, v1, 4, 1
    v_lshl_add_u32 v4, v5, 5, v4
    v_and_b32 v5, 3, v1
    v_lshl_add_u32 v4, v5, 3, v4
    s_lshl_b32 s78, s64, 11
    s_add_u32 s78, s78, 122880
    v_add_u32 v4, s78, v4
    ds_read_b64_tr_b16 v[168:169], v4 offset:0
    ds_read_b64_tr_b16 v[170:171], v4 offset:512
    ds_read_b64_tr_b16 v[172:173], v4 offset:1024
    ds_read_b64_tr_b16 v[174:175], v4 offset:1536
    s_cmp_eq_u32 s62, 0
    s_cbranch_scc0 L_ev_nohello
    v_mov_b32 v5, s2
    v_mov_b32 v6, 1
    s_mov_b64 exec, 1
    global_store_byte v5, v6, s[24:25] sc1
    s_mov_b64 exec, -1
L_ev_nohello:
    s_waitcnt lgkmcnt(0)
    s_branch L_event_ret
L_ev_chk:
    v_lshlrev_b32 v4, 2, v1
    global_load_dword v12, v4, s[24:25] sc1
    s_branch L_event_ret
L_code_end:
s_endpgm
.fill 1056, 4, 0xbf800000
.section .rodata,"a"
.p2align 6
.amdhsa_kernel sequential_preLN__linear_kernel_hedgehog__moe_arch_mod__prompt_kernel
  .amdhsa_next_free_vgpr 512
  .amdhsa_next_free_sgpr 102
  .amdhsa_accum_offset 256
  .amdhsa_group_segment_fixed_size 0
  .amdhsa_kernarg_size 96
  .amdhsa_user_sgpr_count 2
  .amdhsa_user_sgpr_kernarg_segment_ptr 1
  .amdhsa_system_sgpr_workgroup_id_x 1
  .amdhsa_float_denorm_mode_32 3
.end_amdhsa_kernel
```

```asm
; @launch grid=(256,1,1) block=(512,1,1) lds=163840
.amdgcn_target "amdgcn-amd-amdhsa--gfx950"
.text
.globl sequential_preLN__linear_kernel_hedgehog__moe_arch_mod__prompt_kernel
.p2align 8
.type sequential_preLN__linear_kernel_hedgehog__moe_arch_mod__prompt_kernel,@function
sequential_preLN__linear_kernel_hedgehog__moe_arch_mod__prompt_kernel:
    s_cmp_ge_u32 s2, 256
    s_cbranch_scc1 L_end
    s_load_dwordx8 s[4:11], s[0:1], 0
    s_load_dwordx8 s[12:19], s[0:1], 32
    s_load_dwordx8 s[20:27], s[0:1], 64
    v_lshrrev_b32 v4, 6, v0
    v_and_b32_e64 v1, 63, v0
    v_readfirstlane_b32 s79, v4
    s_and_b32 s76, s2, 7
    s_lshr_b32 s77, s2, 3
    s_and_b32 s60, s76, 1
    s_lshl_b32 s60, s60, 3
    s_and_b32 s78, s77, 7
    s_add_u32 s60, s60, s78
    s_lshr_b32 s61, s76, 1
    s_lshl_b32 s61, s61, 2
    s_lshr_b32 s78, s77, 3
    s_add_u32 s61, s61, s78
    s_and_b32 s62, s79, 3
    s_cmp_ge_u32 s79, 4
    s_cbranch_scc1 L_compute
    s_add_u32 s76, s60, s61
    s_and_b32 s76, s76, 3
    s_mov_b32 s66, 0x65473210
    s_mov_b32 s67, 0xedcfa98b
    s_mov_b32 s69, 0xc421
    s_cmp_eq_u32 s76, 1
    s_cselect_b32 s66, 0x65803241, s66
    s_cselect_b32 s67, 0xfedba9c7, s67
    s_cselect_b32 s69, 0x9c51, s69
    s_cmp_eq_u32 s76, 2
    s_cselect_b32 s66, 0x69410532, s66
    s_cselect_b32 s67, 0xfecbad87, s67
    s_cselect_b32 s69, 0xa621, s69
    s_cmp_eq_u32 s76, 3
    s_cselect_b32 s66, 0xa5426103, s66
    s_cselect_b32 s67, 0xfdcbe987, s67
    s_cselect_b32 s69, 0xb731, s69
    v_lshrrev_b32 v4, 3, v1
    v_and_b32 v5, 7, v1
    v_lshrrev_b32 v6, 4, v1
    s_lshl_b32 s76, s60, 18
    s_lshl_b32 s77, s62, 16
    s_add_u32 s76, s76, s77
    v_xor_b32 v7, v5, v6
    v_lshlrev_b32_e64 v7, 4, v7
    v_lshl_add_u32 v78, v4, 11, v7
    v_add_u32 v16, s76, v78
    v_xor_b32 v7, 64, v16
    v_add_u32 v17, 15360, v7
    v_add_u32 v18, 30720, v16
    v_add_u32 v19, 46080, v7
    v_and_b32 v6, 1, v6
    v_lshlrev_b32 v6, 2, v6
    v_xor_b32 v8, v5, v6
    v_lshlrev_b32_e64 v8, 4, v8
    s_lshl_b32 s76, s61, 7
    s_mul_i32 s77, s62, 98304
    s_add_u32 s76, s76, s77
    v_mul_u32_u24 v7, 6144, v4
    v_add3_u32 v20, v7, v8, s76
    v_xor_b32 v7, 32, v20
    v_add_u32 v21, 48128, v7
    v_add_u32_e64 v22, 0, v20
    v_add_u32 v23, 48128, v7
    v_add_u32 v24, 4096, v20
    v_add_u32 v25, 52224, v7
    s_mul_i32 s70, s62, 10240
    s_waitcnt lgkmcnt(0)
    s_mov_b32 s28, s4
    s_and_b32 s29, s5, 0xffff
    s_mov_b32 s30, 4194304
    s_mov_b32 s31, 0x20000
    s_mov_b32 s32, s6
    s_and_b32 s33, s7, 0xffff
    s_mov_b32 s34, 6291456
    s_mov_b32 s35, 0x20000
    s_and_b32 s72, s66, 15
    s_mov_b32 m0, s70
    s_lshl_b32 s71, s72, 7
    buffer_load_dwordx4 v16, s[28:31], s71 offen offset:0 lds
    s_mul_i32 s72, s72, 393216
    s_lshr_b64 s[66:67], s[66:67], 4
    buffer_load_dwordx4 v17, s[28:31], s71 offen offset:1024 lds
    buffer_load_dwordx4 v18, s[28:31], s71 offen offset:2048 lds
    buffer_load_dwordx4 v19, s[28:31], s71 offen offset:3072 lds
    s_add_u32 m0, s70, 4096
    s_nop 0
    buffer_load_dwordx4 v20, s[32:35], s72 offen offset:0 lds
    buffer_load_dwordx4 v21, s[32:35], s72 offen offset:1024 lds
    buffer_load_dwordx4 v22, s[32:35], s72 offen offset:2048 lds
    buffer_load_dwordx4 v23, s[32:35], s72 offen offset:3072 lds
    s_add_u32 m0, s70, 8192
    s_nop 0
    buffer_load_dwordx4 v24, s[32:35], s72 offen offset:0 lds
    buffer_load_dwordx4 v25, s[32:35], s72 offen offset:1024 lds
    s_add_u32 s70, s70, 40960
    s_cmp_ge_u32 s70, 122880
    s_cselect_b32 s76, 122880, 0
    s_sub_u32 s70, s70, s76
    s_getpc_b64 s[78:79]
L_pc:
    s_lshr_b32 s76, s2, 3
    s_mul_i32 s76, s76, 896
    v_lshlrev_b32 v7, 7, v0
    v_add_u32 v7, s76, v7
    v_cmp_gt_u32 vcc, 7, v0
    s_nop 0
    s_and_saveexec_b64 s[80:81], vcc
    s_cbranch_execz L_nopf
    global_load_dword v27, v7, s[78:79]
L_nopf:
    s_mov_b64 exec, -1
    v_lshl_add_u32 v26, v4, 11, v8
    v_xor_b32 v79, 64, v78
    s_and_b32 s63, s62, 1
    s_lshr_b32 s64, s62, 1
    s_lshl_b32 s73, s60, 4
    s_add_u32 s73, s73, s61
    s_mul_i32 s73, s73, 28800
    s_and_b32 s76, s2, 7
    s_lshr_b32 s77, s2, 3
    s_and_b32 s97, s76, 3
    s_lshl_b32 s97, s97, 2
    s_and_b32 s78, s77, 3
    s_add_u32 s97, s97, s78
    s_lshr_b32 s98, s76, 2
    s_lshl_b32 s98, s98, 3
    s_lshr_b32 s78, s77, 2
    s_add_u32 s98, s98, s78
    s_lshl_b32 s99, s97, 4
    s_add_u32 s99, s99, s98
    s_mul_i32 s99, s99, 9344
    s_add_u32 s99, s99, 8388608
    s_add_u32 s65, s97, s98
    s_and_b32 s65, s65, 1
    s_mul_i32 s65, s65, 8
    s_mov_b32 s89, 0x3f803f80
    s_mov_b32 s90, 0xffff0000
    v_and_b32 v2, 31, v1
    v_lshrrev_b32 v3, 5, v1
    v_lshlrev_b32 v12, 4, v1
    v_lshrrev_b32_e64 v4, 3, v1
    v_mul_u32_u24 v13, 460800, v4
    v_and_b32_e64 v4, 7, v1
    v_lshl_add_u32 v13, v4, 4, v13
    s_lshl_b32 s76, s98, 7
    s_lshl_b32 s77, s62, 15
    s_add_u32 s76, s76, s77
    v_add_u32_e64 v26, s76, v26
    s_mov_b32 s40, s26
    s_and_b32 s41, s27, 0xffff
    s_mov_b32 s42, 16777216
    s_mov_b32 s43, 0x20000
    s_mov_b32 s56, s8
    s_and_b32 s57, s9, 0xffff
    s_mov_b32 s58, 65536
    s_mov_b32 s59, 0x20000
    v_mov_b32 v28, -1
    v_mov_b32 v29, -1
    v_mov_b32 v30, -1
    v_mov_b32 v31, -1
    s_and_b32 s72, s66, 15
    s_mov_b32 m0, s70
    s_lshl_b32 s71, s72, 7
    buffer_load_dwordx4 v16, s[28:31], s71 offen offset:0 lds
    s_mul_i32 s72, s72, 393216
    s_lshr_b64 s[66:67], s[66:67], 4
    buffer_load_dwordx4 v17, s[28:31], s71 offen offset:1024 lds
    buffer_load_dwordx4 v18, s[28:31], s71 offen offset:2048 lds
    buffer_load_dwordx4 v19, s[28:31], s71 offen offset:3072 lds
    s_add_u32 m0, s70, 4096
    s_nop 0
    buffer_load_dwordx4 v20, s[32:35], s72 offen offset:0 lds
    buffer_load_dwordx4 v21, s[32:35], s72 offen offset:1024 lds
    buffer_load_dwordx4 v22, s[32:35], s72 offen offset:2048 lds
    buffer_load_dwordx4 v23, s[32:35], s72 offen offset:3072 lds
    s_add_u32 m0, s70, 8192
    s_nop 0
    buffer_load_dwordx4 v24, s[32:35], s72 offen offset:0 lds
    buffer_load_dwordx4 v25, s[32:35], s72 offen offset:1024 lds
    s_add_u32 s70, s70, 40960
    s_cmp_ge_u32 s70, 122880
    s_cselect_b32 s76, 122880, 0
    s_sub_u32 s70, s70, s76
    s_lshl_b32 s77, s62, 10
    s_add_u32 s76, s77, s73
    buffer_store_dwordx4 v[28:31], v12, s[40:43], s76 offen sc1
    s_lshl_b32 s76, s61, 12
    s_add_u32 s76, s76, s77
    s_add_u32 m0, s77, 122880
    s_nop 0
    buffer_load_dwordx4 v12, s[56:59], s76 offen lds
    s_waitcnt vmcnt(12)
    s_barrier
    s_and_b32 s72, s66, 15
    s_mov_b32 m0, s70
    s_lshl_b32 s71, s72, 7
    buffer_load_dwordx4 v16, s[28:31], s71 offen offset:0 lds
    s_mul_i32 s72, s72, 393216
    s_lshr_b64 s[66:67], s[66:67], 4
    buffer_load_dwordx4 v17, s[28:31], s71 offen offset:1024 lds
    buffer_load_dwordx4 v18, s[28:31], s71 offen offset:2048 lds
    buffer_load_dwordx4 v19, s[28:31], s71 offen offset:3072 lds
    s_add_u32 m0, s70, 4096
    s_nop 0
    buffer_load_dwordx4 v20, s[32:35], s72 offen offset:0 lds
    buffer_load_dwordx4 v21, s[32:35], s72 offen offset:1024 lds
    buffer_load_dwordx4 v22, s[32:35], s72 offen offset:2048 lds
    buffer_load_dwordx4 v23, s[32:35], s72 offen offset:3072 lds
    s_add_u32 m0, s70, 8192
    s_nop 0
    buffer_load_dwordx4 v24, s[32:35], s72 offen offset:0 lds
    buffer_load_dwordx4 v25, s[32:35], s72 offen offset:1024 lds
    s_add_u32 s70, s70, 40960
    s_cmp_ge_u32 s70, 122880
    s_cselect_b32 s76, 122880, 0
    s_sub_u32 s70, s70, s76
    s_mov_b32 s36, s10
    s_and_b32 s37, s11, 0xffff
    s_mov_b32 s38, 2097152
    s_mov_b32 s39, 0x20000
    s_mov_b32 s44, s22
    s_and_b32 s45, s23, 0xffff
    s_mov_b32 s46, 4194304
    s_mov_b32 s47, 0x20000
    s_mov_b32 s52, s20
    s_and_b32 s53, s21, 0xffff
    s_mov_b32 s54, 7340032
    s_mov_b32 s55, 0x20000
    s_cmp_eq_u32 s64, 0
    s_cselect_b32 s48, s16, s18
    s_cselect_b32 s49, s17, s19
    s_and_b32 s49, s49, 0xffff
    s_mov_b32 s51, 0x20000
    s_cmp_lt_u32 s97, 14
    s_cselect_b32 s50, 7340032, 0
    s_cselect_b32 s54, 7340032, 0
    s_lshr_b32 s76, s60, 2
    s_lshr_b32 s77, s61, 2
    s_add_u32 s76, s76, s77
    s_and_b32 s76, s76, 3
    s_lshl_b32 s76, s76, 2
    s_lshr_b32 s69, s69, s76
    s_and_b32 s69, s69, 15
    s_mul_i32 s76, s69, 43
    s_lshr_b32 s76, s76, 7
    s_mul_i32 s76, s76, 3
    s_sub_u32 s76, s69, s76
    s_mul_i32 s74, s76, 40960
    s_mul_i32 s76, s62, 10240
    s_add_u32 s76, s76, s74
    v_bfe_u32 v4, v2, 1, 3
    v_xor_b32 v4, v4, v3
    v_lshlrev_b32_e64 v4, 4, v4
    v_lshl_add_u32 v4, v2, 7, v4
    v_add_u32_e64 v72, s76, v4
    v_bfe_u32 v4, v1, 2, 2
    v_lshl_add_u32 v5, v3, 3, v4
    v_lshlrev_b32 v5, 7, v5
    v_lshrrev_b32 v4, 1, v4
    v_xor_b32_e64 v4, s64, v4
    v_lshl_add_u32 v5, v4, 6, v5
    v_bfe_u32 v4, v1, 4, 1
    v_xor_b32_e64 v4, v4, v3
    v_lshl_add_u32 v5, v4, 5, v5
    v_and_b32_e64 v4, 3, v1
    v_lshl_add_u32 v5, v4, 3, v5
    s_add_u32 s76, s74, 4096
    v_add_u32_e64 v73, s76, v5
    v_mul_u32_u24 v74, 28800, v3
    v_lshl_add_u32 v74, v2, 3, v74
    v_lshrrev_b32 v4, 4, v1
    v_and_b32 v5, 15, v1
    v_mul_u32_u24 v75, 460800, v4
    v_lshl_add_u32 v75, v5, 4, v75
    v_mul_u32_u24 v76, 114688, v4
    v_lshl_add_u32 v76, v5, 4, v76
    v_lshlrev_b32_e64 v77, 3, v1
    s_mul_i32 s75, s98, 458752
    s_lshl_b32 s77, s97, 9
    s_add_u32 s75, s75, s77
    s_lshl_b32 s77, s63, 8
    s_add_u32 s75, s75, s77
    s_lshl_b32 s96, s97, 19
    s_lshl_b32 s77, s98, 15
    s_add_u32 s96, s96, s77
    s_lshl_b32 s77, s62, 9
    s_add_u32 s96, s96, s77
    s_mov_b32 s68, 1
    s_waitcnt vmcnt(10)
    s_barrier
    s_cmp_eq_u32 s62, 0
    s_cbranch_scc0 L_hloop
    v_mov_b32 v5, s2
    v_mov_b32_e64 v6, 1
    s_mov_b64 exec, 1
    global_store_byte v5, v6, s[24:25] sc1
    s_mov_b64 exec, -1
L_hloop:
    s_cmp_eq_u32 s68, s69
    s_cbranch_scc1 L_special
    s_and_b32 s72, s66, 15
    s_mov_b32 m0, s70
    s_lshl_b32 s71, s72, 7
    buffer_load_dwordx4 v16, s[28:31], s71 offen offset:0 lds
    s_mul_i32 s72, s72, 393216
    s_lshr_b64 s[66:67], s[66:67], 4
    buffer_load_dwordx4 v17, s[28:31], s71 offen offset:1024 lds
    buffer_load_dwordx4 v18, s[28:31], s71 offen offset:2048 lds
    buffer_load_dwordx4 v19, s[28:31], s71 offen offset:3072 lds
    s_add_u32 m0, s70, 4096
    s_nop 0
    buffer_load_dwordx4 v20, s[32:35], s72 offen offset:0 lds
    buffer_load_dwordx4 v21, s[32:35], s72 offen offset:1024 lds
    buffer_load_dwordx4 v22, s[32:35], s72 offen offset:2048 lds
    buffer_load_dwordx4 v23, s[32:35], s72 offen offset:3072 lds
    s_add_u32 m0, s70, 8192
    s_nop 0
    buffer_load_dwordx4 v24, s[32:35], s72 offen offset:0 lds
    buffer_load_dwordx4 v25, s[32:35], s72 offen offset:1024 lds
    s_add_u32 s70, s70, 40960
    s_cmp_ge_u32 s70, 122880
    s_cselect_b32 s76, 122880, 0
    s_sub_u32 s70, s70, s76
    s_add_u32 s68, s68, 1
L_hnext:
    s_cmp_lt_u32 s68, 14
    s_waitcnt vmcnt(10)
    s_barrier
    s_cbranch_scc1 L_hloop
    s_mov_b32 s88, 0
L_spin_1:
    v_lshlrev_b32_e64 v4, 2, v1
    global_load_dword v27, v4, s[24:25] sc1
    s_waitcnt vmcnt(0)
    v_cmp_ne_u32 vcc, 0x01010101, v27
    s_nop 0
    s_cbranch_vccz L_hello_ok_2
    s_add_u32 s88, s88, 1
    s_cmp_lt_u32 s88, 65536
    s_cbranch_scc1 L_spin_1
L_hello_ok_2:
    s_mul_i32 s80, s60, 460800
    s_lshl_b32 s81, s62, 8
    s_add_u32 s80, s80, s81
    buffer_load_dwordx2 v[32:33], v74, s[40:43], s80 offen offset:0 sc1
    s_add_u32 s80, s80, 57600
    buffer_load_dwordx2 v[34:35], v74, s[40:43], s80 offen offset:0 sc1
    s_add_u32 s80, s80, 57600
    buffer_load_dwordx2 v[36:37], v74, s[40:43], s80 offen offset:0 sc1
    s_add_u32 s80, s80, 57600
    buffer_load_dwordx2 v[38:39], v74, s[40:43], s80 offen offset:0 sc1
    s_add_u32 s80, s80, 57600
    buffer_load_dwordx2 v[40:41], v74, s[40:43], s80 offen offset:0 sc1
    s_add_u32 s80, s80, 57600
    buffer_load_dwordx2 v[42:43], v74, s[40:43], s80 offen offset:0 sc1
    s_add_u32 s80, s80, 57600
    buffer_load_dwordx2 v[44:45], v74, s[40:43], s80 offen offset:0 sc1
    s_add_u32 s80, s80, 57600
    buffer_load_dwordx2 v[46:47], v74, s[40:43], s80 offen offset:0 sc1
    s_mul_i32 s80, s61, 28800
    s_add_u32 s80, s80, s81
    buffer_load_dwordx4 v[48:51], v75, s[40:43], s80 offen offset:1024 sc1
    s_add_u32 s80, s80, 1843200
    buffer_load_dwordx4 v[52:55], v75, s[40:43], s80 offen offset:1024 sc1
    s_add_u32 s80, s80, 1843200
    buffer_load_dwordx4 v[56:59], v75, s[40:43], s80 offen offset:1024 sc1
    s_add_u32 s80, s80, 1843200
    buffer_load_dwordx4 v[60:63], v75, s[40:43], s80 offen offset:1024 sc1
    s_barrier
    s_lshl_b32 s78, s62, 11
    s_add_u32 s79, s78, s73
    s_add_u32 s79, s79, 4096
    buffer_store_dwordx4 v[28:31], v12, s[40:43], s79 offen offset:0 sc1
    buffer_store_dwordx4 v[28:31], v12, s[40:43], s79 offen offset:1024 sc1
    s_add_u32 s79, s78, s99
    buffer_store_dwordx4 v[28:31], v12, s[40:43], s79 offen offset:1024 sc1
    buffer_store_dwordx4 v[28:31], v12, s[40:43], s79 offen offset:2048 sc1
    s_lshl_b32 s79, s62, 8
    s_add_u32 s79, s79, s99
    s_mov_b64 exec, 0xffff
    buffer_store_dwordx4 v[28:31], v12, s[40:43], s79 offen sc1
    s_mov_b64 exec, -1
    s_lshl_b32 s79, s62, 12
    s_add_u32 s79, s79, s73
    s_add_u32 s79, s79, 12288
    buffer_store_dwordx4 v[28:31], v12, s[40:43], s79 offen offset:0 sc1
    buffer_store_dwordx4 v[28:31], v12, s[40:43], s79 offen offset:1024 sc1
    buffer_store_dwordx4 v[28:31], v12, s[40:43], s79 offen offset:2048 sc1
    buffer_store_dwordx4 v[28:31], v12, s[40:43], s79 offen offset:3072 sc1
    s_waitcnt vmcnt(9)
    s_mov_b32 s88, 0
    s_branch L_g1first_3
L_g1_4:
    s_mul_i32 s80, s60, 460800
    s_lshl_b32 s81, s62, 8
    s_add_u32 s80, s80, s81
    buffer_load_dwordx2 v[32:33], v74, s[40:43], s80 offen offset:0 sc1
    s_add_u32 s80, s80, 57600
    buffer_load_dwordx2 v[34:35], v74, s[40:43], s80 offen offset:0 sc1
    s_add_u32 s80, s80, 57600
    buffer_load_dwordx2 v[36:37], v74, s[40:43], s80 offen offset:0 sc1
    s_add_u32 s80, s80, 57600
    buffer_load_dwordx2 v[38:39], v74, s[40:43], s80 offen offset:0 sc1
    s_add_u32 s80, s80, 57600
    buffer_load_dwordx2 v[40:41], v74, s[40:43], s80 offen offset:0 sc1
    s_add_u32 s80, s80, 57600
    buffer_load_dwordx2 v[42:43], v74, s[40:43], s80 offen offset:0 sc1
    s_add_u32 s80, s80, 57600
    buffer_load_dwordx2 v[44:45], v74, s[40:43], s80 offen offset:0 sc1
    s_add_u32 s80, s80, 57600
    buffer_load_dwordx2 v[46:47], v74, s[40:43], s80 offen offset:0 sc1
    s_mul_i32 s80, s61, 28800
    s_add_u32 s80, s80, s81
    buffer_load_dwordx4 v[48:51], v75, s[40:43], s80 offen offset:1024 sc1
    s_add_u32 s80, s80, 1843200
    buffer_load_dwordx4 v[52:55], v75, s[40:43], s80 offen offset:1024 sc1
    s_add_u32 s80, s80, 1843200
    buffer_load_dwordx4 v[56:59], v75, s[40:43], s80 offen offset:1024 sc1
    s_add_u32 s80, s80, 1843200
    buffer_load_dwordx4 v[60:63], v75, s[40:43], s80 offen offset:1024 sc1
    s_waitcnt vmcnt(0)
L_g1first_3:
    v_max3_u32 v4, v32, v34, v36
    v_max3_u32 v4, v4, v38, v40
    v_max3_u32 v4, v4, v42, v44
    v_max3_u32 v4, v4, v46, v48
    v_max3_u32 v4, v4, v50, v52
    v_max3_u32 v4, v4, v54, v56
    v_max3_u32 v4, v4, v58, v60
    v_max_u32 v4, v4, v62
    v_cmp_eq_u32_e64 vcc, -1, v4
    s_nop 0
    s_cbranch_vccz L_ok_5
    s_add_u32 s88, s88, 1
    s_cmp_lt_u32 s88, 65536
    s_cbranch_scc1 L_g1_4
L_ok_5:
    v_add_f32 v32, v32, v40
    v_add_f32 v33, v33, v41
    v_add_f32 v34, v34, v42
    v_add_f32 v35, v35, v43
    v_add_f32 v36, v36, v44
    v_add_f32 v37, v37, v45
    v_add_f32 v38, v38, v46
    v_add_f32 v39, v39, v47
    v_add_f32 v32, v32, v36
    v_add_f32 v33, v33, v37
    v_add_f32 v34, v34, v38
    v_add_f32 v35, v35, v39
    v_add_f32 v32, v32, v34
    v_add_f32 v33, v33, v35
    v_add_f32 v48, v48, v56
    v_add_f32 v49, v49, v57
    v_add_f32 v50, v50, v58
    v_add_f32 v51, v51, v59
    v_add_f32 v52, v52, v60
    v_add_f32 v53, v53, v61
    v_add_f32 v54, v54, v62
    v_add_f32 v55, v55, v63
    v_add_f32 v48, v48, v52
    v_add_f32 v49, v49, v53
    v_add_f32 v50, v50, v54
    v_add_f32 v51, v51, v55
    v_add_f32 v49, v49, v51
    v_mov_b32 v5, v32
    v_mov_b32 v6, v33
    v_mov_b32 v51, v49
    v_permlane32_swap_b32 v48, v50
    v_permlane32_swap_b32 v32, v5
    v_permlane32_swap_b32 v33, v6
    v_permlane32_swap_b32 v49, v51
    v_add_f32 v48, v48, v50
    v_add_f32 v49, v49, v51
    v_add_f32 v32, v32, v5
    v_add_f32 v33, v33, v6
    v_permlane16_swap_b32 v48, v49
    v_add_f32_e64 v48, v48, v49
    v_cvt_pk_bf16_f32 v49, v48, v48
    v_and_b32 v49, s90, v49
    v_sub_f32 v49, v48, v49
    v_cvt_pk_bf16_f32 v50, v48, v49
    v_and_b32 v51, s90, v50
    v_sub_f32 v49, v49, v51
    v_cvt_pk_bf16_f32 v51, v49, 0
    v_bfe_u32 v4, v1, 4, 1
    v_lshl_add_u32 v4, v4, 1, v3
    v_min_u32 v4, 2, v4
    v_and_b32 v7, 15, v1
    v_lshlrev_b32 v7, 3, v7
    s_lshl_b32 s76, s62, 7
    v_lshl_add_u32 v4, v4, 9, v7
    v_add_u32_e64 v4, s76, v4
    ds_write_b64 v4, v[50:51] offset:50176
    v_mul_f32 v32, 0x3a800000, v32
    v_mul_f32 v33, 0x3a800000, v33
    v_fma_f32 v7, -v32, v32, v33
    v_max_f32_e64 v7, 0, v7
    v_cvt_pk_bf16_f32 v5, v32, v32
    v_and_b32_e64 v5, s90, v5
    v_cvt_pk_bf16_f32 v7, v7, v7
    v_and_b32_e64 v7, s90, v7
    v_add_f32 v7, 0x3727c5ac, v7
    v_cvt_pk_bf16_f32 v7, v7, v7
    v_and_b32 v7, s90, v7
    v_sqrt_f32_e64 v7, v7
    s_nop 0
    v_cvt_pk_bf16_f32 v7, v7, v7
    v_and_b32 v7, s90, v7
    v_rcp_f32 v9, v7
    v_xor_b32 v5, 0x80000000, v5
    v_cvt_pk_bf16_f32 v8, v5, v5
    s_lshl_b32 s76, s62, 8
    v_lshl_add_u32 v6, v2, 3, s76
    ds_write_b64 v6, v[8:9] offset:49152
    s_waitcnt lgkmcnt(0)
    s_barrier
    s_add_u32 s78, s65, 0
    s_and_b32 s78, s78, 15
    s_lshl_b32 s78, s78, 17
    s_lshl_b32 s79, s62, 11
    s_add_u32 m0, s79, 57344
    s_add_u32 s79, s78, 15360
    buffer_load_dwordx4 v26, s[36:39], s78 offen lds
    buffer_load_dwordx4 v26, s[36:39], s79 offen offset:1024 lds
    s_add_u32 s78, s65, 1
    s_and_b32 s78, s78, 15
    s_lshl_b32 s78, s78, 17
    s_lshl_b32 s79, s62, 11
    s_add_u32 m0, s79, 65536
    s_add_u32 s79, s78, 15360
    buffer_load_dwordx4 v26, s[36:39], s78 offen lds
    buffer_load_dwordx4 v26, s[36:39], s79 offen offset:1024 lds
    s_add_u32 s78, s65, 2
    s_and_b32 s78, s78, 15
    s_lshl_b32 s78, s78, 17
    s_lshl_b32 s79, s62, 11
    s_add_u32 m0, s79, 73728
    s_add_u32 s79, s78, 15360
    buffer_load_dwordx4 v26, s[36:39], s78 offen lds
    buffer_load_dwordx4 v26, s[36:39], s79 offen offset:1024 lds
    s_waitcnt vmcnt(6)
    s_lshl_b32 s76, s62, 2
    s_add_u32 s76, s76, s73
    v_mov_b32 v4, 0
    s_mov_b64 exec, 1
    buffer_store_dword v4, v4, s[40:43], s76 offen offset:2560 sc1
    s_mov_b64 exec, -1
    s_add_u32 s78, s65, 3
    s_and_b32 s78, s78, 15
    s_lshl_b32 s78, s78, 17
    s_lshl_b32 s79, s62, 11
    s_add_u32 m0, s79, 81920
    s_add_u32 s79, s78, 15360
    buffer_load_dwordx4 v26, s[36:39], s78 offen lds
    buffer_load_dwordx4 v26, s[36:39], s79 offen offset:1024 lds
    s_add_u32 s78, s65, 4
    s_and_b32 s78, s78, 15
    s_lshl_b32 s78, s78, 17
    s_lshl_b32 s79, s62, 11
    s_add_u32 m0, s79, 90112
    s_add_u32 s79, s78, 15360
    buffer_load_dwordx4 v26, s[36:39], s78 offen lds
    buffer_load_dwordx4 v26, s[36:39], s79 offen offset:1024 lds
    s_add_u32 s78, s65, 5
    s_and_b32 s78, s78, 15
    s_lshl_b32 s78, s78, 17
    s_lshl_b32 s79, s62, 11
    s_add_u32 m0, s79, 98304
    s_add_u32 s79, s78, 15360
    buffer_load_dwordx4 v26, s[36:39], s78 offen lds
    buffer_load_dwordx4 v26, s[36:39], s79 offen offset:1024 lds
    s_add_u32 s78, s65, 6
    s_and_b32 s78, s78, 15
    s_lshl_b32 s78, s78, 17
    s_lshl_b32 s79, s62, 11
    s_add_u32 m0, s79, 106496
    s_add_u32 s79, s78, 15360
    buffer_load_dwordx4 v26, s[36:39], s78 offen lds
    buffer_load_dwordx4 v26, s[36:39], s79 offen offset:1024 lds
    s_add_u32 s78, s65, 7
    s_and_b32 s78, s78, 15
    s_lshl_b32 s78, s78, 17
    s_lshl_b32 s79, s62, 11
    s_add_u32 m0, s79, 114688
    s_add_u32 s79, s78, 15360
    buffer_load_dwordx4 v26, s[36:39], s78 offen lds
    buffer_load_dwordx4 v26, s[36:39], s79 offen offset:1024 lds
    s_add_u32 s78, s65, 8
    s_and_b32 s78, s78, 15
    s_lshl_b32 s78, s78, 17
    s_lshl_b32 s79, s62, 11
    s_add_u32 m0, s79, 122880
    s_add_u32 s79, s78, 15360
    buffer_load_dwordx4 v26, s[36:39], s78 offen lds
    buffer_load_dwordx4 v26, s[36:39], s79 offen offset:1024 lds
    s_add_u32 s78, s65, 9
    s_and_b32 s78, s78, 15
    s_lshl_b32 s78, s78, 17
    s_lshl_b32 s79, s62, 11
    s_add_u32 m0, s79, 131072
    s_add_u32 s79, s78, 15360
    buffer_load_dwordx4 v26, s[36:39], s78 offen lds
    buffer_load_dwordx4 v26, s[36:39], s79 offen offset:1024 lds
    s_add_u32 s78, s65, 10
    s_and_b32 s78, s78, 15
    s_lshl_b32 s78, s78, 17
    s_lshl_b32 s79, s62, 11
    s_add_u32 m0, s79, 139264
    s_add_u32 s79, s78, 15360
    buffer_load_dwordx4 v26, s[36:39], s78 offen lds
    buffer_load_dwordx4 v26, s[36:39], s79 offen offset:1024 lds
    s_add_u32 s78, s65, 11
    s_and_b32 s78, s78, 15
    s_lshl_b32 s78, s78, 17
    s_lshl_b32 s79, s62, 11
    s_add_u32 m0, s79, 147456
    s_add_u32 s79, s78, 15360
    buffer_load_dwordx4 v26, s[36:39], s78 offen lds
    buffer_load_dwordx4 v26, s[36:39], s79 offen offset:1024 lds
    s_add_u32 s78, s65, 12
    s_and_b32 s78, s78, 15
    s_lshl_b32 s78, s78, 17
    s_lshl_b32 s79, s62, 11
    s_add_u32 m0, s79, 155648
    s_add_u32 s79, s78, 15360
    buffer_load_dwordx4 v26, s[36:39], s78 offen lds
    buffer_load_dwordx4 v26, s[36:39], s79 offen offset:1024 lds
    s_barrier
    s_barrier
    v_mov_b32 v4, s89
    v_lshlrev_b32_e64 v5, 2, v1
    ds_write_b32 v5, v4 offset:24832
    v_and_b32_e64 v6, 15, v1
    v_mul_u32_u24 v6, 460800, v6
    s_mul_i32 s80, s61, 28800
    s_lshl_b32 s77, s62, 2
    s_add_u32 s77, s77, s80
    s_mov_b32 s88, 0
L_spin_6:
    buffer_load_dword v7, v6, s[40:43], s77 offen offset:2560 sc1
    s_waitcnt vmcnt(0)
    v_cmp_eq_u32 vcc, -1, v7
    s_nop 0
    s_cbranch_vccz L_ok_7
    s_add_u32 s88, s88, 1
    s_cmp_lt_u32 s88, 65536
    s_cbranch_scc1 L_spin_6
L_ok_7:
    s_add_u32 s78, s65, 13
    s_and_b32 s78, s78, 15
    s_lshl_b32 s78, s78, 17
    s_lshl_b32 s79, s62, 11
    s_add_u32 m0, s79, 32768
    s_add_u32 s79, s78, 15360
    buffer_load_dwordx4 v26, s[36:39], s78 offen lds
    buffer_load_dwordx4 v26, s[36:39], s79 offen offset:1024 lds
    s_add_u32 s78, s65, 14
    s_and_b32 s78, s78, 15
    s_lshl_b32 s78, s78, 17
    s_lshl_b32 s79, s62, 11
    s_add_u32 m0, s79, 40960
    s_add_u32 s79, s78, 15360
    buffer_load_dwordx4 v26, s[36:39], s78 offen lds
    buffer_load_dwordx4 v26, s[36:39], s79 offen offset:1024 lds
    s_add_u32 s78, s65, 15
    s_and_b32 s78, s78, 15
    s_lshl_b32 s78, s78, 17
    s_lshl_b32 s79, s62, 11
    s_add_u32 m0, s79, 49152
    s_add_u32 s79, s78, 15360
    buffer_load_dwordx4 v26, s[36:39], s78 offen lds
    buffer_load_dwordx4 v26, s[36:39], s79 offen offset:1024 lds
    s_lshl_b32 s78, s97, 18
    s_lshl_b32 s79, s62, 16
    s_add_u32 s78, s78, s79
    s_lshl_b32 s79, s98, 7
    s_add_u32 s78, s78, s79
    s_lshl_b32 s79, s62, 12
    s_add_u32 m0, s79, 0
    s_nop 0
    buffer_load_dwordx4 v78, s[28:31], s78 offen offset:0 lds
    s_add_u32 s78, s78, 15360
    buffer_load_dwordx4 v79, s[28:31], s78 offen offset:1024 lds
    s_add_u32 s78, s78, 15360
    buffer_load_dwordx4 v78, s[28:31], s78 offen offset:2048 lds
    s_add_u32 s78, s78, 15360
    buffer_load_dwordx4 v79, s[28:31], s78 offen offset:3072 lds
    s_lshl_b32 s76, s62, 11
    s_lshl_b32 s77, s60, 7
    s_add_u32 s76, s76, s77
    s_add_u32 s76, s76, s80
    s_add_u32 s76, s76, 4096
    s_add_u32 s77, s76, 3686400
    s_mov_b32 s78, 0x00003f80
    s_mov_b32 s79, 0x3f800000
    s_mov_b32 s88, 0
L_spin_8:
    buffer_load_dwordx4 v[32:35], v13, s[40:43], s76 offen sc1
    buffer_load_dwordx4 v[36:39], v13, s[40:43], s77 offen sc1
    s_waitcnt vmcnt(0)
    v_max_u32 v4, v32, v36
    v_cmp_eq_u32_e64 vcc, -1, v4
    s_nop 0
    s_cbranch_vccz L_ok_9
    s_add_u32 s88, s88, 1
    s_cmp_lt_u32 s88, 65536
    s_cbranch_scc1 L_spin_8
L_ok_9:
    v_dot2_f32_bf16 v48, v32, s78, 0
    v_dot2_f32_bf16 v49, v32, s79, 0
    v_dot2_f32_bf16 v50, v33, s78, 0
    v_dot2_f32_bf16 v51, v33, s79, 0
    v_dot2_f32_bf16 v52, v34, s78, 0
    v_dot2_f32_bf16 v53, v34, s79, 0
    v_dot2_f32_bf16 v54, v35, s78, 0
    v_dot2_f32_bf16 v55, v35, s79, 0
    v_dot2_f32_bf16 v48, v36, s78, v48
    v_dot2_f32_bf16 v49, v36, s79, v49
    v_dot2_f32_bf16 v50, v37, s78, v50
    v_dot2_f32_bf16 v51, v37, s79, v51
    v_dot2_f32_bf16 v52, v38, s78, v52
    v_dot2_f32_bf16 v53, v38, s79, v53
    v_dot2_f32_bf16 v54, v39, s78, v54
    v_dot2_f32_bf16 v55, v39, s79, v55
    v_mul_u32_u24 v6, 460800, v3
    v_lshl_add_u32 v6, v2, 2, v6
    v_and_b32 v4, 7, v1
    v_lshrrev_b32 v5, 4, v1
    v_lshlrev_b32 v5, 2, v5
    v_lshl_add_u32 v7, v4, 4, v5
    v_permlane32_swap_b32 v48, v52
    v_permlane32_swap_b32 v49, v53
    v_permlane32_swap_b32 v50, v54
    v_permlane32_swap_b32 v51, v55
    v_add_f32 v48, v48, v52
    v_add_f32 v49, v49, v53
    v_add_f32 v50, v50, v54
    v_add_f32 v51, v51, v55
    s_nop 0
    v_permlane16_swap_b32 v48, v50
    v_permlane16_swap_b32 v49, v51
    v_add_f32 v48, v48, v50
    v_add_f32_e64 v49, v49, v51
    s_lshl_b32 s76, s62, 7
    s_add_u32 s76, s76, s73
    v_add_f32_dpp v48, v48, v48 row_ror:8 row_mask:0xf bank_mask:0xf
    v_add_f32_dpp v49, v49, v49 row_ror:8 row_mask:0xf bank_mask:0xf
    v_cvt_pk_bf16_f32 v48, v48, v49
    buffer_store_dword v48, v7, s[40:43], s76 offen offset:3072 sc1
    s_mov_b32 s88, 0
L_spin_10:
    s_lshl_b32 s81, s62, 7
    s_add_u32 s81, s81, s80
    buffer_load_dword v40, v6, s[40:43], s81 offen offset:2048 sc1
    s_add_u32 s81, s81, 921600
    buffer_load_dword v41, v6, s[40:43], s81 offen offset:2048 sc1
    s_add_u32 s81, s81, 921600
    buffer_load_dword v42, v6, s[40:43], s81 offen offset:2048 sc1
    s_add_u32 s81, s81, 921600
    buffer_load_dword v43, v6, s[40:43], s81 offen offset:2048 sc1
    s_add_u32 s81, s81, 921600
    buffer_load_dword v44, v6, s[40:43], s81 offen offset:2048 sc1
    s_add_u32 s81, s81, 921600
    buffer_load_dword v45, v6, s[40:43], s81 offen offset:2048 sc1
    s_add_u32 s81, s81, 921600
    buffer_load_dword v46, v6, s[40:43], s81 offen offset:2048 sc1
    s_add_u32 s81, s81, 921600
    buffer_load_dword v47, v6, s[40:43], s81 offen offset:2048 sc1
    s_waitcnt vmcnt(0)
    v_max3_u32 v4, v40, v41, v42
    v_max3_u32 v4, v4, v43, v44
    v_max3_u32 v4, v4, v45, v46
    v_max_u32 v4, v4, v47
    v_cmp_eq_u32_e64 vcc, -1, v4
    s_nop 0
    s_cbranch_vccz L_ok_11
    s_add_u32 s88, s88, 1
    s_cmp_lt_u32 s88, 65536
    s_cbranch_scc1 L_spin_10
L_ok_11:
    v_add_f32 v40, v40, v44
    v_add_f32 v41, v41, v45
    v_add_f32 v42, v42, v46
    v_add_f32 v43, v43, v47
    v_add_f32 v40, v40, v42
    v_add_f32 v41, v41, v43
    v_add_f32 v40, v40, v41
    v_mov_b32 v41, v40
    s_nop 1
    v_permlane32_swap_b32 v40, v41
    v_add_f32 v40, v40, v41
    v_cvt_pk_bf16_f32 v40, v40, v40
    v_and_b32 v4, 19, v2
    v_lshlrev_b32 v4, 1, v4
    v_bfe_u32 v5, v2, 2, 1
    v_lshl_add_u32 v4, v5, 4, v4
    v_and_b32 v5, 8, v2
    s_lshl_b32 s77, s62, 6
    v_add3_u32 v4, v4, v5, s77
    ds_write_b16 v4, v40 offset:24576
    s_waitcnt lgkmcnt(0)
    s_barrier
    s_barrier
    buffer_load_dwordx4 v[96:99], v76, s[48:51], s75 offen nt
    s_add_u32 s75, s75, 7168
    buffer_load_dwordx4 v[100:103], v76, s[48:51], s75 offen nt
    s_add_u32 s75, s75, 7168
    buffer_load_dwordx4 v[104:107], v76, s[48:51], s75 offen nt
    s_add_u32 s75, s75, 7168
    buffer_load_dwordx4 v[108:111], v76, s[48:51], s75 offen nt
    s_add_u32 s75, s75, 7168
    buffer_load_dwordx4 v[128:131], v76, s[48:51], s75 offen nt
    s_add_u32 s75, s75, 7168
    buffer_load_dwordx4 v[132:135], v76, s[48:51], s75 offen nt
    s_add_u32 s75, s75, 7168
    buffer_load_dwordx4 v[136:139], v76, s[48:51], s75 offen nt
    s_add_u32 s75, s75, 7168
    buffer_load_dwordx4 v[140:143], v76, s[48:51], s75 offen nt
    s_add_u32 s75, s75, 7168
    buffer_load_dwordx4 v[112:115], v76, s[48:51], s75 offen nt
    s_add_u32 s75, s75, 7168
    buffer_load_dwordx4 v[116:119], v76, s[48:51], s75 offen nt
    s_add_u32 s75, s75, 7168
    buffer_load_dwordx4 v[120:123], v76, s[48:51], s75 offen nt
    s_add_u32 s75, s75, 7168
    buffer_load_dwordx4 v[124:127], v76, s[48:51], s75 offen nt
    s_add_u32 s75, s75, 7168
    buffer_load_dwordx4 v[144:147], v76, s[48:51], s75 offen nt
    s_add_u32 s75, s75, 7168
    buffer_load_dwordx4 v[148:151], v76, s[48:51], s75 offen nt
    s_add_u32 s75, s75, 7168
    buffer_load_dwordx4 v[152:155], v76, s[48:51], s75 offen nt
    s_add_u32 s75, s75, 7168
    buffer_load_dwordx4 v[156:159], v76, s[48:51], s75 offen nt
    s_add_u32 s75, s75, 7168
    s_waitcnt vmcnt(16)
    s_barrier
    s_waitcnt vmcnt(0)
    s_mov_b32 s78, 0x05040100
    s_mov_b32 s79, 0x07060302
    v_perm_b32 v160, v100, v96, s78
    v_perm_b32 v164, v100, v96, s79
    v_perm_b32 v168, v101, v97, s78
    v_perm_b32 v172, v101, v97, s79
    v_perm_b32 v176, v102, v98, s78
    v_perm_b32 v180, v102, v98, s79
    v_perm_b32 v184, v103, v99, s78
    v_perm_b32 v188, v103, v99, s79
    v_perm_b32 v161, v108, v104, s78
    v_perm_b32 v165, v108, v104, s79
    v_perm_b32 v169, v109, v105, s78
    v_perm_b32 v173, v109, v105, s79
    v_perm_b32 v177, v110, v106, s78
    v_perm_b32 v181, v110, v106, s79
    v_perm_b32 v185, v111, v107, s78
    v_perm_b32 v189, v111, v107, s79
    v_perm_b32 v162, v116, v112, s78
    v_perm_b32 v166, v116, v112, s79
    v_perm_b32 v170, v117, v113, s78
    v_perm_b32 v174, v117, v113, s79
    v_perm_b32 v178, v118, v114, s78
    v_perm_b32 v182, v118, v114, s79
    v_perm_b32 v186, v119, v115, s78
    v_perm_b32 v190, v119, v115, s79
    v_perm_b32 v163, v124, v120, s78
    v_perm_b32 v167, v124, v120, s79
    v_perm_b32 v171, v125, v121, s78
    v_perm_b32 v175, v125, v121, s79
    v_perm_b32 v179, v126, v122, s78
    v_perm_b32 v183, v126, v122, s79
    v_perm_b32 v187, v127, v123, s78
    v_perm_b32 v191, v127, v123, s79
    v_perm_b32 v192, v132, v128, s78
    v_perm_b32 v196, v132, v128, s79
    v_perm_b32 v200, v133, v129, s78
    v_perm_b32 v204, v133, v129, s79
    v_perm_b32 v208, v134, v130, s78
    v_perm_b32 v212, v134, v130, s79
    v_perm_b32 v216, v135, v131, s78
    v_perm_b32 v220, v135, v131, s79
    v_perm_b32 v193, v140, v136, s78
    v_perm_b32 v197, v140, v136, s79
    v_perm_b32 v201, v141, v137, s78
    v_perm_b32 v205, v141, v137, s79
    v_perm_b32 v209, v142, v138, s78
    v_perm_b32 v213, v142, v138, s79
    v_perm_b32 v217, v143, v139, s78
    v_perm_b32 v221, v143, v139, s79
    v_perm_b32 v194, v148, v144, s78
    v_perm_b32 v198, v148, v144, s79
    v_perm_b32 v202, v149, v145, s78
    v_perm_b32 v206, v149, v145, s79
    v_perm_b32 v210, v150, v146, s78
    v_perm_b32 v214, v150, v146, s79
    v_perm_b32 v218, v151, v147, s78
    v_perm_b32 v222, v151, v147, s79
    v_perm_b32 v195, v156, v152, s78
    v_perm_b32 v199, v156, v152, s79
    v_perm_b32 v203, v157, v153, s78
    v_perm_b32 v207, v157, v153, s79
    v_perm_b32 v211, v158, v154, s78
    v_perm_b32 v215, v158, v154, s79
    v_perm_b32 v219, v159, v155, s78
    v_perm_b32 v223, v159, v155, s79
    s_barrier
    buffer_load_dwordx2 v[32:33], v77, s[52:55], s96 offen nt
    s_add_u32 s96, s96, 2048
    buffer_load_dwordx2 v[34:35], v77, s[52:55], s96 offen nt
    s_add_u32 s96, s96, 2048
    buffer_load_dwordx2 v[36:37], v77, s[52:55], s96 offen nt
    s_add_u32 s96, s96, 2048
    buffer_load_dwordx2 v[38:39], v77, s[52:55], s96 offen nt
    s_add_u32 s96, s96, 2048
    buffer_load_dwordx2 v[40:41], v77, s[52:55], s96 offen nt
    s_add_u32 s96, s96, 2048
    buffer_load_dwordx2 v[42:43], v77, s[52:55], s96 offen nt
    s_add_u32 s96, s96, 2048
    buffer_load_dwordx2 v[44:45], v77, s[52:55], s96 offen nt
    s_add_u32 s96, s96, 2048
    buffer_load_dwordx2 v[46:47], v77, s[52:55], s96 offen nt
    s_add_u32 s96, s96, 2048
    buffer_load_dwordx2 v[48:49], v77, s[52:55], s96 offen nt
    s_add_u32 s96, s96, 2048
    buffer_load_dwordx2 v[50:51], v77, s[52:55], s96 offen nt
    s_add_u32 s96, s96, 2048
    buffer_load_dwordx2 v[52:53], v77, s[52:55], s96 offen nt
    s_add_u32 s96, s96, 2048
    buffer_load_dwordx2 v[54:55], v77, s[52:55], s96 offen nt
    s_add_u32 s96, s96, 2048
    buffer_load_dwordx2 v[56:57], v77, s[52:55], s96 offen nt
    s_add_u32 s96, s96, 2048
    buffer_load_dwordx2 v[58:59], v77, s[52:55], s96 offen nt
    s_add_u32 s96, s96, 2048
    buffer_load_dwordx2 v[60:61], v77, s[52:55], s96 offen nt
    s_add_u32 s96, s96, 2048
    buffer_load_dwordx2 v[62:63], v77, s[52:55], s96 offen nt
    s_add_u32 s96, s96, 2048
    v_and_b32 v4, 15, v1
    v_mul_u32_u24 v7, 149504, v4
    v_and_b32 v5, 48, v1
    v_add_u32 v6, v7, v5
    v_lshrrev_b32 v5, 1, v4
    v_and_b32 v4, 1, v4
    v_lshlrev_b32_e64 v4, 5, v4
    v_lshl_add_u32 v8, v5, 7, v4
    v_mul_u32_u24 v9, 9344, v3
    v_lshl_add_u32 v9, v2, 2, v9
    s_waitcnt vmcnt(0)
    s_mov_b32 s78, 0x05040100
    s_mov_b32 s79, 0x07060302
    v_perm_b32 v224, v34, v32, s78
    v_perm_b32 v225, v34, v32, s79
    v_perm_b32 v226, v35, v33, s78
    v_perm_b32 v227, v35, v33, s79
    v_perm_b32 v228, v38, v36, s78
    v_perm_b32 v229, v38, v36, s79
    v_perm_b32 v230, v39, v37, s78
    v_perm_b32 v231, v39, v37, s79
    v_perm_b32 v232, v42, v40, s78
    v_perm_b32 v233, v42, v40, s79
    v_perm_b32 v234, v43, v41, s78
    v_perm_b32 v235, v43, v41, s79
    v_perm_b32 v236, v46, v44, s78
    v_perm_b32 v237, v46, v44, s79
    v_perm_b32 v238, v47, v45, s78
    v_perm_b32 v239, v47, v45, s79
    v_perm_b32 v240, v50, v48, s78
    v_perm_b32 v241, v50, v48, s79
    v_perm_b32 v242, v51, v49, s78
    v_perm_b32 v243, v51, v49, s79
    v_perm_b32 v244, v54, v52, s78
    v_perm_b32 v245, v54, v52, s79
    v_perm_b32 v246, v55, v53, s78
    v_perm_b32 v247, v55, v53, s79
    v_perm_b32 v248, v58, v56, s78
    v_perm_b32 v249, v58, v56, s79
    v_perm_b32 v250, v59, v57, s78
    v_perm_b32 v251, v59, v57, s79
    v_perm_b32 v252, v62, v60, s78
    v_perm_b32 v253, v62, v60, s79
    v_perm_b32 v254, v63, v61, s78
    v_perm_b32 v255, v63, v61, s79
    s_mul_i32 s76, s98, 9344
    s_add_u32 s76, s76, 8388608
    s_barrier
    s_mov_b32 s88, 0
L_spin_12:
    buffer_load_dwordx2 v[20:21], v7, s[40:43], s76 offen offset:256 sc1
    buffer_load_dwordx4 v[64:67], v6, s[40:43], s76 offen offset:0 sc1
    buffer_load_dwordx4 v[68:71], v6, s[40:43], s76 offen offset:64 sc1
    s_waitcnt vmcnt(0)
    v_max3_u32 v4, v21, v64, v68
    v_cmp_eq_u32 vcc, -1, v4
    s_nop 0
    s_cbranch_vccz L_ok_13
    s_add_u32 s88, s88, 1
    s_cmp_lt_u32 s88, 65536
    s_cbranch_scc1 L_spin_12
L_ok_13:
    v_mfma_f32_16x16x32_bf16 v[96:99], v[64:67], v[160:163], 0
    v_max_f32_dpp v4, v20, v20 row_ror:8 row_mask:0xf bank_mask:0xf
    v_mfma_f32_16x16x32_bf16 v[100:103], v[64:67], v[164:167], 0
    v_mfma_f32_16x16x32_bf16 v[104:107], v[64:67], v[168:171], 0
    v_max_f32_dpp v4, v4, v4 row_ror:4 row_mask:0xf bank_mask:0xf
    v_mfma_f32_16x16x32_bf16 v[108:111], v[64:67], v[172:175], 0
    v_mfma_f32_16x16x32_bf16 v[112:115], v[64:67], v[176:179], 0
    v_max_f32_dpp v4, v4, v4 row_ror:2 row_mask:0xf bank_mask:0xf
    v_mfma_f32_16x16x32_bf16 v[116:119], v[64:67], v[180:183], 0
    v_mfma_f32_16x16x32_bf16 v[120:123], v[64:67], v[184:187], 0
    v_max_f32_dpp v4, v4, v4 row_ror:1 row_mask:0xf bank_mask:0xf
    v_mfma_f32_16x16x32_bf16 v[124:127], v[64:67], v[188:191], 0
    v_mfma_f32_16x16x32_bf16 v[96:99], v[68:71], v[192:195], v[96:99]
    v_cmp_eq_f32 vcc, v4, v20
    v_mfma_f32_16x16x32_bf16 v[100:103], v[68:71], v[196:199], v[100:103]
    s_ff1_i32_b32 s92, vcc_lo
    s_and_b32 s92, s92, 15
    v_mfma_f32_16x16x32_bf16 v[104:107], v[68:71], v[200:203], v[104:107]
    s_lshl_b32 s76, s63, 10
    s_lshl_b32 s77, s64, 6
    v_mfma_f32_16x16x32_bf16 v[108:111], v[68:71], v[204:207], v[108:111]
    s_add_u32 s76, s76, s77
    s_add_u32 s76, s76, s99
    v_mfma_f32_16x16x32_bf16 v[112:115], v[68:71], v[208:211], v[112:115]
    v_readlane_b32 s91, v21, s92
    v_readlane_b32 s93, v20, s92
    v_mfma_f32_16x16x32_bf16 v[116:119], v[68:71], v[212:215], v[116:119]
    s_lshr_b32 s78, s92, 2
    s_lshl_b32 s78, s78, 4
    v_mfma_f32_16x16x32_bf16 v[120:123], v[68:71], v[216:219], v[120:123]
    s_mov_b64 s[80:81], 0xffff
    s_and_b32 s77, s92, 3
    v_mfma_f32_16x16x32_bf16 v[124:127], v[68:71], v[220:223], v[124:127]
    s_cmp_ge_u32 s97, 14
    s_cbranch_scc1 L_noffn
    s_cmp_eq_u32 s77, 0
    s_cbranch_scc0 L_sel_15
    v_mov_b32 v64, v96
    v_mov_b32 v65, v100
    v_mov_b32 v66, v104
    v_mov_b32 v67, v108
    v_mov_b32 v68, v112
    v_mov_b32 v69, v116
    v_mov_b32 v70, v120
    v_mov_b32 v71, v124
    s_branch L_seldone_14
L_sel_15:
    s_cmp_eq_u32 s77, 1
    s_cbranch_scc0 L_sel_16
    v_mov_b32 v64, v97
    v_mov_b32 v65, v101
    v_mov_b32 v66, v105
    v_mov_b32 v67, v109
    v_mov_b32 v68, v113
    v_mov_b32 v69, v117
    v_mov_b32 v70, v121
    v_mov_b32 v71, v125
    s_branch L_seldone_14
L_sel_16:
    s_cmp_eq_u32 s77, 2
    s_cbranch_scc0 L_sel_17
    v_mov_b32 v64, v98
    v_mov_b32 v65, v102
    v_mov_b32 v66, v106
    v_mov_b32 v67, v110
    v_mov_b32 v68, v114
    v_mov_b32 v69, v118
    v_mov_b32 v70, v122
    v_mov_b32 v71, v126
    s_branch L_seldone_14
L_sel_17:
    v_mov_b32 v64, v99
    v_mov_b32 v65, v103
    v_mov_b32 v66, v107
    v_mov_b32 v67, v111
    v_mov_b32 v68, v115
    v_mov_b32 v69, v119
    v_mov_b32 v70, v123
    v_mov_b32_e64 v71, v127
L_seldone_14:
    s_lshl_b64 exec, s[80:81], s78
    buffer_store_dwordx4 v[64:67], v8, s[40:43], s76 offen offset:3072 sc1
    buffer_store_dwordx4 v[68:71], v8, s[40:43], s76 offen offset:3088 sc1
    s_mov_b64 exec, -1
    s_mul_i32 s84, s97, 149504
    s_lshl_b32 s77, s98, 7
    s_add_u32 s84, s84, s77
    s_add_u32 s84, s84, 8388608
    s_lshl_b32 s85, s62, 10
    s_add_u32 s85, s85, s99
    s_add_u32 s85, s85, 5120
    s_mov_b32 s88, 0
L_spin_19:
    s_mov_b32 s76, s84
    buffer_load_dword v32, v9, s[40:43], s76 offen offset:3072 sc1
    s_add_u32 s76, s76, 18688
    buffer_load_dword v33, v9, s[40:43], s76 offen offset:3072 sc1
    s_add_u32 s76, s76, 18688
    buffer_load_dword v34, v9, s[40:43], s76 offen offset:3072 sc1
    s_add_u32 s76, s76, 18688
    buffer_load_dword v35, v9, s[40:43], s76 offen offset:3072 sc1
    s_add_u32 s76, s76, 18688
    buffer_load_dword v36, v9, s[40:43], s76 offen offset:3072 sc1
    s_add_u32 s76, s76, 18688
    buffer_load_dword v37, v9, s[40:43], s76 offen offset:3072 sc1
    s_add_u32 s76, s76, 18688
    buffer_load_dword v38, v9, s[40:43], s76 offen offset:3072 sc1
    s_add_u32 s76, s76, 18688
    buffer_load_dword v39, v9, s[40:43], s76 offen offset:3072 sc1
    s_waitcnt vmcnt(0)
    v_max3_u32 v4, v32, v33, v34
    v_max3_u32 v4, v4, v35, v36
    v_max3_u32 v4, v4, v37, v38
    v_max_u32 v4, v4, v39
    v_cmp_eq_u32_e64 vcc, -1, v4
    s_nop 0
    s_cbranch_vccz L_ok_20
    s_add_u32 s88, s88, 1
    s_cmp_lt_u32 s88, 65536
    s_cbranch_scc1 L_spin_19
L_ok_20:
    v_pk_add_f32 v[32:33], v[32:33], v[36:37]
    v_pk_add_f32 v[34:35], v[34:35], v[38:39]
    v_pk_add_f32 v[32:33], v[32:33], v[34:35]
    v_add_f32 v32, v32, v33
    v_mov_b32 v33, v32
    s_nop 1
    v_permlane32_swap_b32 v32, v33
    v_add_f32 v32, v32, v33
    v_cvt_pk_bf16_f32 v32, v32, v32
    v_and_b32 v32, s90, v32
    v_mov_b32 v33, v32
    v_mul_f32 v4, 0xbfb8aa3b, v32
    v_exp_f32 v4, v4
    v_permlane16_swap_b32 v32, v33
    v_add_f32 v4, 1.0, v4
    v_rcp_f32 v4, v4
    s_nop 0
    v_mul_f32 v4, v4, v32
    v_cvt_pk_bf16_f32 v4, v4, v4
    v_and_b32 v4, s90, v4
    v_mul_f32_e64 v4, v4, v33
    s_nop 1
    v_mov_b32_dpp v5, v4 quad_perm:[1,0,3,2] row_mask:0xf bank_mask:0xf
    v_cvt_pk_bf16_f32 v4, v4, v5
    s_nop 0
    v_readlane_b32 s76, v4, 0
    v_readlane_b32 s77, v4, 2
    v_readlane_b32 s78, v4, 4
    v_readlane_b32 s79, v4, 6
    v_readlane_b32 s80, v4, 8
    v_readlane_b32 s81, v4, 10
    v_readlane_b32 s82, v4, 12
    v_readlane_b32 s83, v4, 14
    v_dot2_f32_bf16 v40, v224, s76, 0
    v_dot2_f32_bf16 v41, v225, s76, 0
    v_dot2_f32_bf16 v42, v226, s76, 0
    v_dot2_f32_bf16 v43, v227, s76, 0
    v_dot2_f32_bf16 v40, v228, s77, v40
    v_dot2_f32_bf16 v41, v229, s77, v41
    v_dot2_f32_bf16 v42, v230, s77, v42
    v_dot2_f32_bf16 v43, v231, s77, v43
    v_dot2_f32_bf16 v40, v232, s78, v40
    v_dot2_f32_bf16 v41, v233, s78, v41
    v_dot2_f32_bf16 v42, v234, s78, v42
    v_dot2_f32_bf16 v43, v235, s78, v43
    v_dot2_f32_bf16 v40, v236, s79, v40
    v_dot2_f32_bf16 v41, v237, s79, v41
    v_dot2_f32_bf16 v42, v238, s79, v42
    v_dot2_f32_bf16 v43, v239, s79, v43
    v_dot2_f32_bf16 v40, v240, s80, v40
    v_dot2_f32_bf16 v41, v241, s80, v41
    v_dot2_f32_bf16 v42, v242, s80, v42
    v_dot2_f32_bf16 v43, v243, s80, v43
    v_dot2_f32_bf16 v40, v244, s81, v40
    v_dot2_f32_bf16 v41, v245, s81, v41
    v_dot2_f32_bf16 v42, v246, s81, v42
    v_dot2_f32_bf16 v43, v247, s81, v43
    v_dot2_f32_bf16 v40, v248, s82, v40
    v_dot2_f32_bf16 v41, v249, s82, v41
    v_dot2_f32_bf16 v42, v250, s82, v42
    v_dot2_f32_bf16 v43, v251, s82, v43
    v_dot2_f32_bf16 v40, v252, s83, v40
    v_dot2_f32_bf16 v41, v253, s83, v41
    v_dot2_f32_bf16 v42, v254, s83, v42
    v_dot2_f32_bf16 v43, v255, s83, v43
    s_nop 2
    buffer_store_dwordx4 v[40:43], v12, s[40:43], s85 offen sc1
L_noffn:
    s_cmp_eq_u32 s62, 0
    s_cbranch_scc0 L_hfin
    v_mov_b32_e64 v8, s93
    v_cvt_pk_bf16_f32 v8, v8, v8
    v_and_b32_e64 v8, s90, v8
    v_mul_f32 v8, 0xbfb8aa3b, v8
    v_exp_f32 v8, v8
    s_nop 0
    v_add_f32 v8, 1.0, v8
    v_rcp_f32_e64 v8, v8
    s_nop 0
    v_cvt_pk_bf16_f32 v8, v8, v8
    v_and_b32_e64 v8, s90, v8
    v_bfe_u32 v9, v1, 4, 1
    v_lshl_add_u32 v9, v9, 1, v3
    s_lshl_b32 s76, s92, 4
    s_add_u32 s76, s76, s98
    s_mul_i32 s76, s76, 9344
    s_add_u32 s76, s76, 8388608
    s_and_b32 s77, s97, 1
    s_lshl_b32 s77, s77, 6
    s_add_u32 s76, s76, s77
    s_lshr_b32 s77, s97, 1
    s_lshl_b32 s77, s77, 3
    s_add_u32 s76, s76, s77
    v_lshrrev_b32 v10, 1, v9
    v_lshlrev_b32 v10, 2, v10
    v_mul_u32_u24 v6, 9344, v1
    v_mov_b32 v7, 2146435072
    v_cmp_gt_u32 vcc, 32, v1
    s_nop 1
    v_cndmask_b32 v7, v7, v6, vcc
    s_lshl_b32 s79, s98, 8
    s_lshl_b32 s78, s97, 4
    s_add_u32 s79, s79, s78
    s_add_u32 s79, s79, 8393728
    s_lshl_b32 s80, s91, 11
    s_lshl_b32 s77, s98, 7
    s_add_u32 s80, s80, s77
    s_lshl_b32 s77, s97, 3
    s_add_u32 s80, s80, s77
    s_mov_b32 s88, 0
L_spin_21:
    s_mov_b32 s77, s79
    buffer_load_dwordx4 v[48:51], v6, s[40:43], s77 offen sc1
    s_add_u32 s77, s77, 598016
    buffer_load_dwordx4 v[52:55], v6, s[40:43], s77 offen sc1
    s_add_u32 s77, s77, 598016
    buffer_load_dwordx4 v[56:59], v6, s[40:43], s77 offen sc1
    s_add_u32 s77, s77, 598016
    buffer_load_dwordx4 v[60:63], v7, s[40:43], s77 offen sc1
    buffer_load_dword v64, v10, s[40:43], s76 offen offset:0 sc1
    buffer_load_dword v65, v10, s[40:43], s76 offen offset:128 sc1
    s_waitcnt vmcnt(0)
    v_max3_u32 v4, v48, v52, v56
    v_max3_u32 v4, v4, v60, v64
    v_max_u32 v4, v4, v65
    v_cmp_eq_u32_e64 vcc, -1, v4
    s_nop 0
    s_cbranch_vccz L_ok_22
    s_add_u32 s88, s88, 1
    s_cmp_lt_u32 s88, 65536
    s_cbranch_scc1 L_spin_21
L_ok_22:
    v_pk_add_f32 v[48:49], v[48:49], v[56:57]
    v_pk_add_f32 v[50:51], v[50:51], v[58:59]
    v_pk_add_f32 v[52:53], v[52:53], v[60:61]
    v_pk_add_f32 v[54:55], v[54:55], v[62:63]
    v_pk_add_f32 v[48:49], v[48:49], v[52:53]
    v_pk_add_f32 v[50:51], v[50:51], v[54:55]
    v_and_b32 v4, 1, v9
    v_lshlrev_b32 v4, 4, v4
    v_permlane32_swap_b32 v48, v49
    v_permlane32_swap_b32 v50, v51
    v_add_f32 v48, v48, v49
    v_add_f32 v50, v50, v51
    v_lshrrev_b32 v64, v4, v64
    v_lshrrev_b32 v65, v4, v65
    v_permlane16_swap_b32 v48, v50
    v_add_f32 v48, v48, v50
    v_lshlrev_b32 v64, 16, v64
    v_lshlrev_b32_e64 v65, 16, v65
    v_add_f32_dpp v48, v48, v48 row_ror:8 row_mask:0xf bank_mask:0xf
    s_nop 1
    v_add_f32_dpp v48, v48, v48 row_ror:4 row_mask:0xf bank_mask:0xf
    s_nop 1
    v_add_f32_dpp v48, v48, v48 row_ror:2 row_mask:0xf bank_mask:0xf
    s_nop 1
    v_add_f32_dpp v48, v48, v48 row_ror:1 row_mask:0xf bank_mask:0xf
    v_cvt_pk_bf16_f32 v48, v48, v48
    v_and_b32 v48, s90, v48
    v_mul_f32_e64 v48, v48, v8
    v_cvt_pk_bf16_f32 v48, v48, v48
    v_and_b32 v48, s90, v48
    v_add_f32 v48, v48, v64
    v_cvt_pk_bf16_f32 v48, v48, v48
    v_and_b32 v48, s90, v48
    v_add_f32 v48, v48, v65
    v_cvt_pk_bf16_f32 v48, v48, v48
    v_lshlrev_b32_e64 v9, 1, v9
    s_mov_b32 exec_lo, 0x00010001
    s_mov_b32 exec_hi, 0x00010001
    buffer_store_short v48, v9, s[44:47], s80 offen sc1
    s_mov_b64 exec, -1
L_hfin:
    s_endpgm
L_special:
    s_mul_i32 s78, s63, 2048
    s_mul_i32 s79, s63, 20480
    v_xor_b32 v5, 32, v72
    v_xor_b32 v6, 64, v72
    v_xor_b32 v7, 96, v72
    v_add_u32 v8, s78, v73
    v_add_u32_e64 v9, s79, v73
    s_and_b32 s72, s66, 15
    s_mov_b32 m0, s70
    s_lshl_b32 s71, s72, 7
    buffer_load_dwordx4 v16, s[28:31], s71 offen offset:0 lds
    s_mul_i32 s72, s72, 393216
    s_lshr_b64 s[66:67], s[66:67], 4
    ds_read_b128 v[32:35], v72
    ds_read_b128 v[36:39], v5
    ds_read_b128 v[40:43], v6
    ds_read_b128 v[44:47], v7
    ds_read_b64_tr_b16 v[48:49], v8 offset:0
    ds_read_b64_tr_b16 v[50:51], v8 offset:512
    ds_read_b64_tr_b16 v[52:53], v8 offset:10240
    ds_read_b64_tr_b16 v[54:55], v8 offset:10752
    ds_read_b64_tr_b16 v[56:57], v8 offset:20480
    ds_read_b64_tr_b16 v[58:59], v8 offset:20992
    ds_read_b64_tr_b16 v[60:61], v8 offset:30720
    ds_read_b64_tr_b16 v[62:63], v8 offset:31232
    buffer_load_dwordx4 v17, s[28:31], s71 offen offset:1024 lds
    ds_read_b64_tr_b16 v[64:65], v9 offset:4096
    ds_read_b64_tr_b16 v[66:67], v9 offset:4608
    ds_read_b64_tr_b16 v[68:69], v9 offset:14336
    ds_read_b64_tr_b16 v[70:71], v9 offset:14848
    buffer_load_dwordx4 v18, s[28:31], s71 offen offset:2048 lds
    s_waitcnt lgkmcnt(0)
    v_lshlrev_b32 v4, 16, v32
    v_and_b32 v5, s90, v32
    v_mov_b32 v80, v4
    v_mov_b32 v84, v5
    v_mul_f32 v81, v4, v4
    v_mul_f32 v85, v5, v5
    v_lshlrev_b32 v6, 16, v33
    v_and_b32 v7, s90, v33
    v_add_f32 v80, v80, v6
    v_add_f32 v84, v84, v7
    v_fmac_f32_e64 v81, v6, v6
    buffer_load_dwordx4 v19, s[28:31], s71 offen offset:3072 lds
    v_fmac_f32 v85, v7, v7
    v_lshlrev_b32 v4, 16, v34
    v_and_b32 v5, s90, v34
    v_add_f32 v80, v80, v4
    v_add_f32 v84, v84, v5
    v_fmac_f32 v81, v4, v4
    v_fmac_f32 v85, v5, v5
    v_lshlrev_b32 v6, 16, v35
    v_and_b32 v7, s90, v35
    v_add_f32 v80, v80, v6
    v_add_f32_e64 v84, v84, v7
    s_add_u32 m0, s70, 4096
    s_nop 0
    buffer_load_dwordx4 v20, s[32:35], s72 offen offset:0 lds
    v_fmac_f32 v81, v6, v6
    v_fmac_f32 v85, v7, v7
    v_lshlrev_b32 v4, 16, v36
    v_and_b32 v5, s90, v36
    v_add_f32 v80, v80, v4
    v_add_f32 v84, v84, v5
    v_fmac_f32 v81, v4, v4
    v_fmac_f32 v85, v5, v5
    v_lshlrev_b32 v6, 16, v37
    v_and_b32 v7, s90, v37
    v_add_f32 v80, v80, v6
    buffer_load_dwordx4 v21, s[32:35], s72 offen offset:1024 lds
    v_add_f32 v84, v84, v7
    v_fmac_f32 v81, v6, v6
    v_fmac_f32 v85, v7, v7
    v_lshlrev_b32 v4, 16, v38
    v_and_b32 v5, s90, v38
    v_add_f32 v80, v80, v4
    v_add_f32 v84, v84, v5
    v_fmac_f32 v81, v4, v4
    v_fmac_f32 v85, v5, v5
    v_lshlrev_b32 v6, 16, v39
    v_and_b32_e64 v7, s90, v39
    buffer_load_dwordx4 v22, s[32:35], s72 offen offset:2048 lds
    v_add_f32 v80, v80, v6
    v_add_f32 v84, v84, v7
    v_fmac_f32 v81, v6, v6
    v_fmac_f32 v85, v7, v7
    v_lshlrev_b32 v4, 16, v40
    v_and_b32 v5, s90, v40
    v_add_f32 v80, v80, v4
    v_add_f32 v84, v84, v5
    v_fmac_f32 v81, v4, v4
    v_fmac_f32 v85, v5, v5
    v_lshlrev_b32_e64 v6, 16, v41
    buffer_load_dwordx4 v23, s[32:35], s72 offen offset:3072 lds
    v_and_b32 v7, s90, v41
    v_add_f32 v80, v80, v6
    v_add_f32 v84, v84, v7
    v_fmac_f32 v81, v6, v6
    v_fmac_f32 v85, v7, v7
    v_lshlrev_b32 v4, 16, v42
    v_and_b32 v5, s90, v42
    v_add_f32 v80, v80, v4
    v_add_f32 v84, v84, v5
    v_fmac_f32 v81, v4, v4
    v_fmac_f32_e64 v85, v5, v5
    s_add_u32 m0, s70, 8192
    s_nop 0
    buffer_load_dwordx4 v24, s[32:35], s72 offen offset:0 lds
    v_lshlrev_b32 v6, 16, v43
    v_and_b32 v7, s90, v43
    v_add_f32 v80, v80, v6
    v_add_f32 v84, v84, v7
    v_fmac_f32 v81, v6, v6
    v_fmac_f32 v85, v7, v7
    v_lshlrev_b32 v4, 16, v44
    v_and_b32 v5, s90, v44
    v_add_f32 v80, v80, v4
    v_add_f32 v84, v84, v5
    v_fmac_f32 v81, v4, v4
    buffer_load_dwordx4 v25, s[32:35], s72 offen offset:1024 lds
    s_add_u32 s70, s70, 40960
    s_cmp_ge_u32 s70, 122880
    s_cselect_b32 s76, 122880, 0
    s_sub_u32 s70, s70, s76
    s_waitcnt vmcnt(10)
    s_barrier
    s_and_b32 s72, s66, 15
    s_mov_b32 m0, s70
    s_lshl_b32 s71, s72, 7
    buffer_load_dwordx4 v16, s[28:31], s71 offen offset:0 lds
    s_mul_i32 s72, s72, 393216
    s_lshr_b64 s[66:67], s[66:67], 4
    v_fmac_f32 v85, v5, v5
    v_lshlrev_b32 v6, 16, v45
    v_and_b32 v7, s90, v45
    v_add_f32 v80, v80, v6
    v_add_f32 v84, v84, v7
    v_fmac_f32 v81, v6, v6
    v_fmac_f32 v85, v7, v7
    v_lshlrev_b32 v4, 16, v46
    v_and_b32 v5, s90, v46
    v_add_f32 v80, v80, v4
    v_add_f32 v84, v84, v5
    v_fmac_f32 v81, v4, v4
    v_fmac_f32 v85, v5, v5
    buffer_load_dwordx4 v17, s[28:31], s71 offen offset:1024 lds
    v_lshlrev_b32 v6, 16, v47
    v_and_b32 v7, s90, v47
    v_add_f32 v80, v80, v6
    v_add_f32 v84, v84, v7
    v_fmac_f32 v81, v6, v6
    v_fmac_f32 v85, v7, v7
    v_lshlrev_b32 v82, 16, v48
    v_and_b32 v86, s90, v48
    v_lshlrev_b32 v6, 16, v49
    v_and_b32 v7, s90, v49
    v_add_f32 v82, v82, v6
    v_add_f32 v86, v86, v7
    v_lshlrev_b32_e64 v4, 16, v50
    buffer_load_dwordx4 v18, s[28:31], s71 offen offset:2048 lds
    v_and_b32 v5, s90, v50
    v_add_f32 v82, v82, v4
    v_add_f32 v86, v86, v5
    v_lshlrev_b32 v6, 16, v51
    v_and_b32 v7, s90, v51
    v_add_f32 v82, v82, v6
    v_add_f32 v86, v86, v7
    v_lshlrev_b32 v4, 16, v52
    v_and_b32 v5, s90, v52
    v_add_f32 v82, v82, v4
    v_add_f32 v86, v86, v5
    v_lshlrev_b32 v6, 16, v53
    v_and_b32_e64 v7, s90, v53
    buffer_load_dwordx4 v19, s[28:31], s71 offen offset:3072 lds
    v_add_f32 v82, v82, v6
    v_add_f32 v86, v86, v7
    v_lshlrev_b32 v4, 16, v54
    v_and_b32 v5, s90, v54
    v_add_f32 v82, v82, v4
    v_add_f32 v86, v86, v5
    v_lshlrev_b32 v6, 16, v55
    v_and_b32 v7, s90, v55
    v_add_f32 v82, v82, v6
    v_add_f32 v86, v86, v7
    v_lshlrev_b32 v4, 16, v56
    v_and_b32 v5, s90, v56
    v_add_f32_e64 v82, v82, v4
    s_add_u32 m0, s70, 4096
    s_nop 0
    buffer_load_dwordx4 v20, s[32:35], s72 offen offset:0 lds
    v_add_f32 v86, v86, v5
    v_lshlrev_b32 v6, 16, v57
    v_and_b32 v7, s90, v57
    v_add_f32 v82, v82, v6
    v_add_f32 v86, v86, v7
    v_lshlrev_b32 v4, 16, v58
    v_and_b32 v5, s90, v58
    v_add_f32 v82, v82, v4
    v_add_f32 v86, v86, v5
    v_lshlrev_b32 v6, 16, v59
    v_and_b32 v7, s90, v59
    v_add_f32 v82, v82, v6
    v_add_f32 v86, v86, v7
    buffer_load_dwordx4 v21, s[32:35], s72 offen offset:1024 lds
    v_lshlrev_b32 v4, 16, v60
    v_and_b32 v5, s90, v60
    v_add_f32 v82, v82, v4
    v_add_f32 v86, v86, v5
    v_lshlrev_b32 v6, 16, v61
    v_and_b32 v7, s90, v61
    v_add_f32 v82, v82, v6
    v_add_f32 v86, v86, v7
    v_lshlrev_b32 v4, 16, v62
    v_and_b32 v5, s90, v62
    v_add_f32 v82, v82, v4
    v_add_f32 v86, v86, v5
    v_lshlrev_b32_e64 v6, 16, v63
    buffer_load_dwordx4 v22, s[32:35], s72 offen offset:2048 lds
    v_and_b32 v7, s90, v63
    v_add_f32 v82, v82, v6
    v_add_f32 v86, v86, v7
    v_lshlrev_b32 v83, 16, v64
    v_and_b32 v87, s90, v64
    v_lshlrev_b32 v6, 16, v65
    v_and_b32 v7, s90, v65
    v_add_f32 v83, v83, v6
    v_add_f32 v87, v87, v7
    v_lshlrev_b32 v4, 16, v66
    v_and_b32 v5, s90, v66
    v_add_f32 v83, v83, v4
    v_add_f32_e64 v87, v87, v5
    buffer_load_dwordx4 v23, s[32:35], s72 offen offset:3072 lds
    v_lshlrev_b32 v6, 16, v67
    v_and_b32 v7, s90, v67
    v_add_f32 v83, v83, v6
    v_add_f32 v87, v87, v7
    v_lshlrev_b32 v4, 16, v68
    v_and_b32 v5, s90, v68
    v_add_f32 v83, v83, v4
    v_add_f32 v87, v87, v5
    v_lshlrev_b32 v6, 16, v69
    v_and_b32 v7, s90, v69
    v_add_f32 v83, v83, v6
    v_add_f32 v87, v87, v7
    v_lshlrev_b32_e64 v4, 16, v70
    s_add_u32 m0, s70, 8192
    s_nop 0
    buffer_load_dwordx4 v24, s[32:35], s72 offen offset:0 lds
    v_and_b32 v5, s90, v70
    v_add_f32 v83, v83, v4
    v_add_f32 v87, v87, v5
    v_lshlrev_b32 v6, 16, v71
    v_and_b32 v7, s90, v71
    v_add_f32 v83, v83, v6
    v_add_f32 v87, v87, v7
    buffer_load_dwordx4 v25, s[32:35], s72 offen offset:1024 lds
    s_add_u32 s70, s70, 40960
    s_cmp_ge_u32 s70, 122880
    s_cselect_b32 s76, 122880, 0
    s_sub_u32 s70, s70, s76
    v_add_f32 v80, v80, v84
    v_add_f32 v81, v81, v85
    v_add_f32 v82, v82, v86
    v_add_f32 v83, v83, v87
    v_mov_b32 v84, v80
    v_mov_b32 v85, v81
    v_mov_b32 v86, v82
    v_mov_b32 v87, v83
    v_permlane32_swap_b32 v80, v84
    v_permlane32_swap_b32 v81, v85
    v_permlane32_swap_b32 v82, v86
    v_permlane32_swap_b32 v83, v87
    v_add_f32 v80, v80, v84
    v_add_f32 v81, v81, v85
    v_add_f32 v82, v82, v86
    v_add_f32 v83, v83, v87
    s_lshl_b32 s78, s62, 8
    s_add_u32 s78, s78, s73
    s_lshl_b32 s79, s64, 9
    s_lshl_b32 s80, s63, 3
    s_add_u32 s79, s79, s80
    s_add_u32 s79, s79, s73
    s_mov_b32 exec_hi, 0
    buffer_store_dwordx2 v[80:81], v74, s[40:43], s78 offen offset:0 sc1
    buffer_store_dwordx2 v[82:83], v12, s[40:43], s79 offen offset:1024 sc1
    s_mov_b64 exec, -1
    s_add_u32 s68, s68, 2
    s_branch L_hnext
L_compute:
    s_setprio 2
    s_and_b32 s63, s62, 1
    s_lshr_b32 s64, s62, 1
    s_lshl_b32 s73, s60, 4
    s_add_u32 s73, s73, s61
    s_mul_i32 s73, s73, 28800
    s_and_b32 s76, s2, 7
    s_lshr_b32 s77, s2, 3
    s_and_b32 s97, s76, 3
    s_lshl_b32 s97, s97, 2
    s_and_b32 s78, s77, 3
    s_add_u32 s97, s97, s78
    s_lshr_b32 s98, s76, 2
    s_lshl_b32 s98, s98, 3
    s_lshr_b32 s78, s77, 2
    s_add_u32 s98, s98, s78
    s_lshl_b32 s99, s97, 4
    s_add_u32 s99, s99, s98
    s_mul_i32 s99, s99, 9344
    s_add_u32 s99, s99, 8388608
    s_add_u32 s65, s97, s98
    s_and_b32 s65, s65, 1
    s_mul_i32 s65, s65, 8
    s_mov_b32 s89, 0x3f803f80
    s_mov_b32 s90, 0xffff0000
    v_and_b32 v2, 31, v1
    v_lshrrev_b32 v3, 5, v1
    v_lshlrev_b32 v12, 4, v1
    v_lshrrev_b32_e64 v4, 3, v1
    v_mul_u32_u24 v13, 460800, v4
    v_and_b32_e64 v4, 7, v1
    v_lshl_add_u32 v13, v4, 4, v13
    v_and_b32 v10, 15, v1
    v_lshrrev_b32 v11, 4, v1
    s_mul_i32 s76, s63, 20480
    v_lshrrev_b32 v4, 1, v10
    v_xor_b32 v4, v4, v11
    v_lshlrev_b32_e64 v4, 4, v4
    v_lshl_add_u32 v4, v10, 7, v4
    v_add_u32 v192, s76, v4
    v_xor_b32 v193, 64, v192
    v_bfe_u32 v4, v1, 2, 2
    v_and_b32_e64 v6, 1, v11
    v_lshl_add_u32 v5, v6, 3, v4
    v_lshlrev_b32 v5, 7, v5
    v_lshrrev_b32 v4, 1, v4
    v_xor_b32_e64 v4, s64, v4
    v_lshl_add_u32 v5, v4, 6, v5
    v_lshl_add_u32 v5, v6, 5, v5
    v_and_b32_e64 v4, 3, v1
    v_lshl_add_u32 v5, v4, 3, v5
    v_mul_u32_u24 v4, 10240, v3
    v_add_u32_e64 v5, v5, v4
    v_add_u32 v194, 4096, v5
    v_xor_b32_e64 v195, 32, v194
    v_add_u32 v196, 40960, v192
    v_add_u32 v197, 40960, v193
    v_add_u32 v198, 40960, v194
    v_add_u32 v199, 40960, v195
    v_add_u32 v200, 81920, v192
    v_add_u32 v201, 81920, v193
    v_add_u32 v202, 81920, v194
    v_add_u32 v203, 81920, v195
    v_bfe_u32 v4, v1, 2, 2
    v_lshl_add_u32 v4, v3, 3, v4
    v_lshlrev_b32 v4, 6, v4
    v_and_b32 v5, 1, v11
    v_lshl_add_u32 v4, v5, 5, v4
    v_and_b32_e64 v5, 3, v1
    v_lshl_add_u32 v4, v5, 3, v4
    s_lshl_b32 s76, s64, 11
    s_add_u32 s76, s76, 122880
    v_add_u32_e64 v212, s76, v4
    s_lshl_b32 s76, s63, 9
    v_lshl_add_u32 v213, v10, 3, s76
    v_lshl_add_u32 v214, v2, 3, s76
    s_lshl_b32 s76, s64, 8
    v_lshl_add_u32 v215, v10, 3, s76
    v_bfe_u32 v4, v10, 1, 1
    v_xor_b32 v4, s64, v4
    v_lshrrev_b32 v5, 2, v10
    v_xor_b32 v5, v5, v3
    v_xor_b32 v6, v10, v11
    v_and_b32 v6, 1, v6
    v_lshlrev_b32_e64 v4, 6, v4
    v_lshl_add_u32 v4, v5, 4, v4
    v_lshl_add_u32 v4, v6, 3, v4
    v_lshl_add_u32 v4, v10, 7, v4
    s_lshl_b32 s76, s63, 13
    v_add_u32 v216, s76, v4
    v_bfe_u32 v4, v2, 1, 1
    v_bfe_u32 v5, v2, 2, 2
    v_and_b32 v6, 1, v2
    v_xor_b32 v6, v6, v3
    v_lshlrev_b32_e64 v4, 6, v4
    v_lshl_add_u32 v4, v5, 4, v4
    v_lshl_add_u32 v4, v6, 3, v4
    v_lshl_add_u32 v4, v2, 7, v4
    s_lshl_b32 s77, s64, 14
    s_add_u32 s76, s76, s77
    v_add_u32_e64 v217, s76, v4
    v_bfe_u32 v4, v1, 2, 2
    v_lshl_add_u32 v5, v3, 3, v4
    v_lshlrev_b32 v5, 7, v5
    v_lshrrev_b32 v6, 1, v4
    v_lshl_add_u32 v5, v6, 6, v5
    v_bfe_u32 v6, v1, 4, 1
    v_xor_b32_e64 v6, v6, v3
    v_lshl_add_u32 v5, v6, 5, v5
    v_bfe_u32 v6, v1, 1, 1
    v_lshl_add_u32 v5, v6, 4, v5
    v_xor_b32 v6, v1, v4
    v_and_b32 v6, 1, v6
    v_lshl_add_u32 v5, v6, 3, v5
    s_lshl_b32 s76, s63, 6
    s_or_b32 s76, s76, s77
    v_xor_b32 v218, s76, v5
    s_lshl_b32 s76, s64, 6
    v_xor_b32_e64 v220, s76, v5
    v_xor_b32 v219, 528, v218
    v_xor_b32 v221, 528, v220
    v_cmp_gt_u32 s[86:87], 16, v1
    s_waitcnt lgkmcnt(0)
    s_mov_b32 s40, s26
    s_and_b32 s41, s27, 0xffff
    s_mov_b32 s42, 16777216
    s_mov_b32 s43, 0x20000
    s_mov_b32 s44, s22
    s_and_b32 s45, s23, 0xffff
    s_mov_b32 s46, 4194304
    s_mov_b32 s47, 0x20000
    s_mov_b32 s68, 0
    s_barrier
    ds_read_b128 v[112:115], v192 offset:0
    ds_read_b64_tr_b16 v[128:129], v194 offset:0
    ds_read_b64_tr_b16 v[130:131], v194 offset:512
    ds_read_b128 v[116:119], v192 offset:2048
    ds_read_b128 v[120:123], v192 offset:10240
    ds_read_b128 v[124:127], v192 offset:12288
    ds_read_b64_tr_b16 v[132:133], v195 offset:0
    ds_read_b64_tr_b16 v[134:135], v195 offset:512
    ds_read_b64_tr_b16 v[136:137], v194 offset:2048
    ds_read_b64_tr_b16 v[138:139], v194 offset:2560
    ds_read_b64_tr_b16 v[140:141], v195 offset:2048
    ds_read_b64_tr_b16 v[142:143], v195 offset:2560
    ds_read_b64_tr_b16 v[144:145], v194 offset:4096
    ds_read_b64_tr_b16 v[146:147], v194 offset:4608
    s_waitcnt lgkmcnt(8)
    ds_read_b64_tr_b16 v[148:149], v195 offset:4096
    ds_read_b64_tr_b16 v[150:151], v195 offset:4608
    v_mfma_f32_16x16x32_bf16 v[16:19], v[128:131], v[112:115], 0
    ds_read_b128 v[152:155], v193 offset:0
    v_mfma_f32_16x16x32_bf16 v[20:23], v[128:131], v[116:119], 0
    ds_read_b64_tr_b16 v[168:169], v194 offset:20480
    v_mfma_f32_16x16x32_bf16 v[24:27], v[128:131], v[120:123], 0
    ds_read_b64_tr_b16 v[170:171], v194 offset:20992
    v_mfma_f32_16x16x32_bf16 v[28:31], v[128:131], v[124:127], 0
    ds_read_b128 v[156:159], v193 offset:2048
    s_waitcnt lgkmcnt(4)
    v_mfma_f32_16x16x32_bf16 v[32:35], v[132:135], v[112:115], 0
    ds_read_b128 v[160:163], v193 offset:10240
    v_mfma_f32_16x16x32_bf16 v[36:39], v[132:135], v[116:119], 0
    ds_read_b128 v[164:167], v193 offset:12288
    v_mfma_f32_16x16x32_bf16 v[40:43], v[132:135], v[120:123], 0
    ds_read_b64_tr_b16 v[172:173], v195 offset:20480
    v_mfma_f32_16x16x32_bf16 v[44:47], v[132:135], v[124:127], 0
    ds_read_b64_tr_b16 v[174:175], v195 offset:20992
    v_mfma_f32_16x16x32_bf16 v[48:51], v[136:139], v[112:115], 0
    ds_read_b64_tr_b16 v[176:177], v194 offset:22528
    v_mfma_f32_16x16x32_bf16 v[52:55], v[136:139], v[116:119], 0
    ds_read_b64_tr_b16 v[178:179], v194 offset:23040
    v_mfma_f32_16x16x32_bf16 v[56:59], v[136:139], v[120:123], 0
    ds_read_b64_tr_b16 v[180:181], v195 offset:22528
    v_mfma_f32_16x16x32_bf16 v[60:63], v[136:139], v[124:127], 0
    ds_read_b64_tr_b16 v[182:183], v195 offset:23040
    v_mfma_f32_16x16x32_bf16 v[64:67], v[140:143], v[112:115], 0
    ds_read_b64_tr_b16 v[184:185], v194 offset:24576
    v_mfma_f32_16x16x32_bf16 v[68:71], v[140:143], v[116:119], 0
    ds_read_b64_tr_b16 v[186:187], v194 offset:25088
    v_mfma_f32_16x16x32_bf16 v[72:75], v[140:143], v[120:123], 0
    ds_read_b64_tr_b16 v[188:189], v195 offset:24576
    v_mfma_f32_16x16x32_bf16 v[76:79], v[140:143], v[124:127], 0
    ds_read_b64_tr_b16 v[190:191], v195 offset:25088
    v_mfma_f32_16x16x32_bf16 v[80:83], v[144:147], v[112:115], 0
    v_mfma_f32_16x16x32_bf16 v[84:87], v[144:147], v[116:119], 0
    v_mfma_f32_16x16x32_bf16 v[88:91], v[144:147], v[120:123], 0
    v_mfma_f32_16x16x32_bf16 v[92:95], v[144:147], v[124:127], 0
    v_mfma_f32_16x16x32_bf16 v[96:99], v[148:151], v[112:115], 0
    v_mfma_f32_16x16x32_bf16 v[100:103], v[148:151], v[116:119], 0
    v_mfma_f32_16x16x32_bf16 v[104:107], v[148:151], v[120:123], 0
    v_mfma_f32_16x16x32_bf16 v[108:111], v[148:151], v[124:127], 0
    s_waitcnt lgkmcnt(0)
    v_mfma_f32_16x16x32_bf16 v[16:19], v[168:171], v[152:155], v[16:19]
    s_barrier
    v_mfma_f32_16x16x32_bf16 v[20:23], v[168:171], v[156:159], v[20:23]
    ds_read_b128 v[112:115], v196 offset:0
    ds_read_b64_tr_b16 v[204:205], v212 offset:0
    ds_read_b64_tr_b16 v[206:207], v212 offset:256
    ds_read_b64_tr_b16 v[208:209], v212 offset:1024
    ds_read_b64_tr_b16 v[210:211], v212 offset:1280
    v_mfma_f32_16x16x32_bf16 v[24:27], v[168:171], v[160:163], v[24:27]
    ds_read_b64_tr_b16 v[128:129], v198 offset:0
.p2align 3
L_cloop:
    v_mfma_f32_16x16x32_bf16 v[28:31], v[168:171], v[164:167], v[28:31]
    ds_read_b64_tr_b16 v[130:131], v198 offset:512
    v_mfma_f32_16x16x32_bf16 v[32:35], v[172:175], v[152:155], v[32:35]
    ds_read_b128 v[116:119], v196 offset:2048
    v_mfma_f32_16x16x32_bf16 v[36:39], v[172:175], v[156:159], v[36:39]
    ds_read_b128 v[120:123], v196 offset:10240
    v_mfma_f32_16x16x32_bf16 v[40:43], v[172:175], v[160:163], v[40:43]
    ds_read_b128 v[124:127], v196 offset:12288
    v_mfma_f32_16x16x32_bf16 v[44:47], v[172:175], v[164:167], v[44:47]
    ds_read_b64_tr_b16 v[132:133], v199 offset:0
    v_mfma_f32_16x16x32_bf16 v[48:51], v[176:179], v[152:155], v[48:51]
    ds_read_b64_tr_b16 v[134:135], v199 offset:512
    v_mfma_f32_16x16x32_bf16 v[52:55], v[176:179], v[156:159], v[52:55]
    ds_read_b64_tr_b16 v[136:137], v198 offset:2048
    v_mfma_f32_16x16x32_bf16 v[56:59], v[176:179], v[160:163], v[56:59]
    ds_read_b64_tr_b16 v[138:139], v198 offset:2560
    v_mfma_f32_16x16x32_bf16 v[60:63], v[176:179], v[164:167], v[60:63]
    ds_read_b64_tr_b16 v[140:141], v199 offset:2048
    v_mfma_f32_16x16x32_bf16 v[64:67], v[180:183], v[152:155], v[64:67]
    ds_read_b64_tr_b16 v[142:143], v199 offset:2560
    v_mfma_f32_16x16x32_bf16 v[68:71], v[180:183], v[156:159], v[68:71]
    ds_read_b64_tr_b16 v[144:145], v198 offset:4096
    v_mfma_f32_16x16x32_bf16 v[72:75], v[180:183], v[160:163], v[72:75]
    ds_read_b64_tr_b16 v[146:147], v198 offset:4608
    v_mfma_f32_16x16x32_bf16 v[76:79], v[180:183], v[164:167], v[76:79]
    ds_read_b64_tr_b16 v[148:149], v199 offset:4096
    v_mfma_f32_16x16x32_bf16 v[80:83], v[184:187], v[152:155], v[80:83]
    ds_read_b64_tr_b16 v[150:151], v199 offset:4608
    v_mfma_f32_16x16x32_bf16 v[84:87], v[184:187], v[156:159], v[84:87]
    v_mfma_f32_16x16x32_bf16 v[88:91], v[184:187], v[160:163], v[88:91]
    v_mfma_f32_16x16x32_bf16 v[92:95], v[184:187], v[164:167], v[92:95]
    v_mfma_f32_16x16x32_bf16 v[96:99], v[188:191], v[152:155], v[96:99]
    v_mfma_f32_16x16x32_bf16 v[100:103], v[188:191], v[156:159], v[100:103]
    v_mfma_f32_16x16x32_bf16 v[104:107], v[188:191], v[160:163], v[104:107]
    v_mfma_f32_16x16x32_bf16 v[108:111], v[188:191], v[164:167], v[108:111]
    s_waitcnt lgkmcnt(0)
    v_mfma_f32_16x16x32_bf16 v[16:19], v[128:131], v[112:115], v[16:19]
    ds_read_b128 v[152:155], v197 offset:0
    v_mfma_f32_16x16x32_bf16 v[20:23], v[128:131], v[116:119], v[20:23]
    ds_read_b64_tr_b16 v[168:169], v198 offset:20480
    v_mfma_f32_16x16x32_bf16 v[24:27], v[128:131], v[120:123], v[24:27]
    ds_read_b64_tr_b16 v[170:171], v198 offset:20992
    v_mfma_f32_16x16x32_bf16 v[28:31], v[128:131], v[124:127], v[28:31]
    ds_read_b128 v[156:159], v197 offset:2048
    v_mfma_f32_16x16x32_bf16 v[32:35], v[132:135], v[112:115], v[32:35]
    ds_read_b128 v[160:163], v197 offset:10240
    v_mfma_f32_16x16x32_bf16 v[36:39], v[132:135], v[116:119], v[36:39]
    ds_read_b128 v[164:167], v197 offset:12288
    v_mfma_f32_16x16x32_bf16 v[40:43], v[132:135], v[120:123], v[40:43]
    ds_read_b64_tr_b16 v[172:173], v199 offset:20480
    v_mfma_f32_16x16x32_bf16 v[44:47], v[132:135], v[124:127], v[44:47]
    ds_read_b64_tr_b16 v[174:175], v199 offset:20992
    v_mfma_f32_16x16x32_bf16 v[48:51], v[136:139], v[112:115], v[48:51]
    ds_read_b64_tr_b16 v[176:177], v198 offset:22528
    v_mfma_f32_16x16x32_bf16 v[52:55], v[136:139], v[116:119], v[52:55]
    ds_read_b64_tr_b16 v[178:179], v198 offset:23040
    v_mfma_f32_16x16x32_bf16 v[56:59], v[136:139], v[120:123], v[56:59]
    ds_read_b64_tr_b16 v[180:181], v199 offset:22528
    v_mfma_f32_16x16x32_bf16 v[60:63], v[136:139], v[124:127], v[60:63]
    ds_read_b64_tr_b16 v[182:183], v199 offset:23040
    v_mfma_f32_16x16x32_bf16 v[64:67], v[140:143], v[112:115], v[64:67]
    ds_read_b64_tr_b16 v[184:185], v198 offset:24576
    v_mfma_f32_16x16x32_bf16 v[68:71], v[140:143], v[116:119], v[68:71]
    ds_read_b64_tr_b16 v[186:187], v198 offset:25088
    v_mfma_f32_16x16x32_bf16 v[72:75], v[140:143], v[120:123], v[72:75]
    ds_read_b64_tr_b16 v[188:189], v199 offset:24576
    v_mfma_f32_16x16x32_bf16 v[76:79], v[140:143], v[124:127], v[76:79]
    ds_read_b64_tr_b16 v[190:191], v199 offset:25088
    v_mfma_f32_16x16x32_bf16 v[80:83], v[144:147], v[112:115], v[80:83]
    v_mfma_f32_16x16x32_bf16 v[84:87], v[144:147], v[116:119], v[84:87]
    v_mfma_f32_16x16x32_bf16 v[88:91], v[144:147], v[120:123], v[88:91]
    v_mfma_f32_16x16x32_bf16 v[92:95], v[144:147], v[124:127], v[92:95]
    v_mfma_f32_16x16x32_bf16 v[96:99], v[148:151], v[112:115], v[96:99]
    v_mfma_f32_16x16x32_bf16 v[100:103], v[148:151], v[116:119], v[100:103]
    v_mfma_f32_16x16x32_bf16 v[104:107], v[148:151], v[120:123], v[104:107]
    v_mfma_f32_16x16x32_bf16 v[108:111], v[148:151], v[124:127], v[108:111]
    s_waitcnt lgkmcnt(0)
    v_mfma_f32_16x16x32_bf16 v[16:19], v[168:171], v[152:155], v[16:19]
    s_barrier
    v_mfma_f32_16x16x32_bf16 v[20:23], v[168:171], v[156:159], v[20:23]
    ds_read_b128 v[112:115], v200 offset:0
    v_mfma_f32_16x16x32_bf16 v[24:27], v[168:171], v[160:163], v[24:27]
    ds_read_b64_tr_b16 v[128:129], v202 offset:0
    v_mfma_f32_16x16x32_bf16 v[28:31], v[168:171], v[164:167], v[28:31]
    ds_read_b64_tr_b16 v[130:131], v202 offset:512
    v_mfma_f32_16x16x32_bf16 v[32:35], v[172:175], v[152:155], v[32:35]
    ds_read_b128 v[116:119], v200 offset:2048
    v_mfma_f32_16x16x32_bf16 v[36:39], v[172:175], v[156:159], v[36:39]
    ds_read_b128 v[120:123], v200 offset:10240
    v_mfma_f32_16x16x32_bf16 v[40:43], v[172:175], v[160:163], v[40:43]
    ds_read_b128 v[124:127], v200 offset:12288
    v_mfma_f32_16x16x32_bf16 v[44:47], v[172:175], v[164:167], v[44:47]
    ds_read_b64_tr_b16 v[132:133], v203 offset:0
    v_mfma_f32_16x16x32_bf16 v[48:51], v[176:179], v[152:155], v[48:51]
    ds_read_b64_tr_b16 v[134:135], v203 offset:512
    v_mfma_f32_16x16x32_bf16 v[52:55], v[176:179], v[156:159], v[52:55]
    ds_read_b64_tr_b16 v[136:137], v202 offset:2048
    v_mfma_f32_16x16x32_bf16 v[56:59], v[176:179], v[160:163], v[56:59]
    ds_read_b64_tr_b16 v[138:139], v202 offset:2560
    v_mfma_f32_16x16x32_bf16 v[60:63], v[176:179], v[164:167], v[60:63]
    ds_read_b64_tr_b16 v[140:141], v203 offset:2048
    v_mfma_f32_16x16x32_bf16 v[64:67], v[180:183], v[152:155], v[64:67]
    ds_read_b64_tr_b16 v[142:143], v203 offset:2560
    v_mfma_f32_16x16x32_bf16 v[68:71], v[180:183], v[156:159], v[68:71]
    ds_read_b64_tr_b16 v[144:145], v202 offset:4096
    v_mfma_f32_16x16x32_bf16 v[72:75], v[180:183], v[160:163], v[72:75]
    ds_read_b64_tr_b16 v[146:147], v202 offset:4608
    v_mfma_f32_16x16x32_bf16 v[76:79], v[180:183], v[164:167], v[76:79]
    ds_read_b64_tr_b16 v[148:149], v203 offset:4096
    v_mfma_f32_16x16x32_bf16 v[80:83], v[184:187], v[152:155], v[80:83]
    ds_read_b64_tr_b16 v[150:151], v203 offset:4608
    v_mfma_f32_16x16x32_bf16 v[84:87], v[184:187], v[156:159], v[84:87]
    v_mfma_f32_16x16x32_bf16 v[88:91], v[184:187], v[160:163], v[88:91]
    v_mfma_f32_16x16x32_bf16 v[92:95], v[184:187], v[164:167], v[92:95]
    v_mfma_f32_16x16x32_bf16 v[96:99], v[188:191], v[152:155], v[96:99]
    v_mfma_f32_16x16x32_bf16 v[100:103], v[188:191], v[156:159], v[100:103]
    v_mfma_f32_16x16x32_bf16 v[104:107], v[188:191], v[160:163], v[104:107]
    v_mfma_f32_16x16x32_bf16 v[108:111], v[188:191], v[164:167], v[108:111]
    s_waitcnt lgkmcnt(0)
    v_mfma_f32_16x16x32_bf16 v[16:19], v[128:131], v[112:115], v[16:19]
    ds_read_b128 v[152:155], v201 offset:0
    v_mfma_f32_16x16x32_bf16 v[20:23], v[128:131], v[116:119], v[20:23]
    ds_read_b64_tr_b16 v[168:169], v202 offset:20480
    v_mfma_f32_16x16x32_bf16 v[24:27], v[128:131], v[120:123], v[24:27]
    ds_read_b64_tr_b16 v[170:171], v202 offset:20992
    v_mfma_f32_16x16x32_bf16 v[28:31], v[128:131], v[124:127], v[28:31]
    ds_read_b128 v[156:159], v201 offset:2048
    v_mfma_f32_16x16x32_bf16 v[32:35], v[132:135], v[112:115], v[32:35]
    ds_read_b128 v[160:163], v201 offset:10240
    v_mfma_f32_16x16x32_bf16 v[36:39], v[132:135], v[116:119], v[36:39]
    ds_read_b128 v[164:167], v201 offset:12288
    v_mfma_f32_16x16x32_bf16 v[40:43], v[132:135], v[120:123], v[40:43]
    ds_read_b64_tr_b16 v[172:173], v203 offset:20480
    v_mfma_f32_16x16x32_bf16 v[44:47], v[132:135], v[124:127], v[44:47]
    ds_read_b64_tr_b16 v[174:175], v203 offset:20992
    v_mfma_f32_16x16x32_bf16 v[48:51], v[136:139], v[112:115], v[48:51]
    ds_read_b64_tr_b16 v[176:177], v202 offset:22528
    v_mfma_f32_16x16x32_bf16 v[52:55], v[136:139], v[116:119], v[52:55]
    ds_read_b64_tr_b16 v[178:179], v202 offset:23040
    v_mfma_f32_16x16x32_bf16 v[56:59], v[136:139], v[120:123], v[56:59]
    ds_read_b64_tr_b16 v[180:181], v203 offset:22528
    v_mfma_f32_16x16x32_bf16 v[60:63], v[136:139], v[124:127], v[60:63]
    ds_read_b64_tr_b16 v[182:183], v203 offset:23040
    v_mfma_f32_16x16x32_bf16 v[64:67], v[140:143], v[112:115], v[64:67]
    ds_read_b64_tr_b16 v[184:185], v202 offset:24576
    v_mfma_f32_16x16x32_bf16 v[68:71], v[140:143], v[116:119], v[68:71]
    ds_read_b64_tr_b16 v[186:187], v202 offset:25088
    v_mfma_f32_16x16x32_bf16 v[72:75], v[140:143], v[120:123], v[72:75]
    ds_read_b64_tr_b16 v[188:189], v203 offset:24576
    v_mfma_f32_16x16x32_bf16 v[76:79], v[140:143], v[124:127], v[76:79]
    ds_read_b64_tr_b16 v[190:191], v203 offset:25088
    v_mfma_f32_16x16x32_bf16 v[80:83], v[144:147], v[112:115], v[80:83]
    v_mfma_f32_16x16x32_bf16 v[84:87], v[144:147], v[116:119], v[84:87]
    v_mfma_f32_16x16x32_bf16 v[88:91], v[144:147], v[120:123], v[88:91]
    v_mfma_f32_16x16x32_bf16 v[92:95], v[144:147], v[124:127], v[92:95]
    v_mfma_f32_16x16x32_bf16 v[96:99], v[148:151], v[112:115], v[96:99]
    v_mfma_f32_16x16x32_bf16 v[100:103], v[148:151], v[116:119], v[100:103]
    v_mfma_f32_16x16x32_bf16 v[104:107], v[148:151], v[120:123], v[104:107]
    v_mfma_f32_16x16x32_bf16 v[108:111], v[148:151], v[124:127], v[108:111]
    s_waitcnt lgkmcnt(0)
    v_mfma_f32_16x16x32_bf16 v[16:19], v[168:171], v[152:155], v[16:19]
    s_barrier
    v_mfma_f32_16x16x32_bf16 v[20:23], v[168:171], v[156:159], v[20:23]
    ds_read_b128 v[112:115], v192 offset:0
    v_mfma_f32_16x16x32_bf16 v[24:27], v[168:171], v[160:163], v[24:27]
    ds_read_b64_tr_b16 v[128:129], v194 offset:0
    v_mfma_f32_16x16x32_bf16 v[28:31], v[168:171], v[164:167], v[28:31]
    ds_read_b64_tr_b16 v[130:131], v194 offset:512
    v_mfma_f32_16x16x32_bf16 v[32:35], v[172:175], v[152:155], v[32:35]
    ds_read_b128 v[116:119], v192 offset:2048
    v_mfma_f32_16x16x32_bf16 v[36:39], v[172:175], v[156:159], v[36:39]
    ds_read_b128 v[120:123], v192 offset:10240
    v_mfma_f32_16x16x32_bf16 v[40:43], v[172:175], v[160:163], v[40:43]
    ds_read_b128 v[124:127], v192 offset:12288
    v_mfma_f32_16x16x32_bf16 v[44:47], v[172:175], v[164:167], v[44:47]
    ds_read_b64_tr_b16 v[132:133], v195 offset:0
    v_mfma_f32_16x16x32_bf16 v[48:51], v[176:179], v[152:155], v[48:51]
    ds_read_b64_tr_b16 v[134:135], v195 offset:512
    v_mfma_f32_16x16x32_bf16 v[52:55], v[176:179], v[156:159], v[52:55]
    ds_read_b64_tr_b16 v[136:137], v194 offset:2048
    v_mfma_f32_16x16x32_bf16 v[56:59], v[176:179], v[160:163], v[56:59]
    ds_read_b64_tr_b16 v[138:139], v194 offset:2560
    v_mfma_f32_16x16x32_bf16 v[60:63], v[176:179], v[164:167], v[60:63]
    ds_read_b64_tr_b16 v[140:141], v195 offset:2048
    v_mfma_f32_16x16x32_bf16 v[64:67], v[180:183], v[152:155], v[64:67]
    ds_read_b64_tr_b16 v[142:143], v195 offset:2560
    v_mfma_f32_16x16x32_bf16 v[68:71], v[180:183], v[156:159], v[68:71]
    ds_read_b64_tr_b16 v[144:145], v194 offset:4096
    v_mfma_f32_16x16x32_bf16 v[72:75], v[180:183], v[160:163], v[72:75]
    ds_read_b64_tr_b16 v[146:147], v194 offset:4608
    v_mfma_f32_16x16x32_bf16 v[76:79], v[180:183], v[164:167], v[76:79]
    ds_read_b64_tr_b16 v[148:149], v195 offset:4096
    v_mfma_f32_16x16x32_bf16 v[80:83], v[184:187], v[152:155], v[80:83]
    ds_read_b64_tr_b16 v[150:151], v195 offset:4608
    v_mfma_f32_16x16x32_bf16 v[84:87], v[184:187], v[156:159], v[84:87]
    v_mfma_f32_16x16x32_bf16 v[88:91], v[184:187], v[160:163], v[88:91]
    v_mfma_f32_16x16x32_bf16 v[92:95], v[184:187], v[164:167], v[92:95]
    v_mfma_f32_16x16x32_bf16 v[96:99], v[188:191], v[152:155], v[96:99]
    v_mfma_f32_16x16x32_bf16 v[100:103], v[188:191], v[156:159], v[100:103]
    v_mfma_f32_16x16x32_bf16 v[104:107], v[188:191], v[160:163], v[104:107]
    v_mfma_f32_16x16x32_bf16 v[108:111], v[188:191], v[164:167], v[108:111]
    s_waitcnt lgkmcnt(0)
    v_mfma_f32_16x16x32_bf16 v[16:19], v[128:131], v[112:115], v[16:19]
    ds_read_b128 v[152:155], v193 offset:0
    v_mfma_f32_16x16x32_bf16 v[20:23], v[128:131], v[116:119], v[20:23]
    ds_read_b64_tr_b16 v[168:169], v194 offset:20480
    v_mfma_f32_16x16x32_bf16 v[24:27], v[128:131], v[120:123], v[24:27]
    ds_read_b64_tr_b16 v[170:171], v194 offset:20992
    v_mfma_f32_16x16x32_bf16 v[28:31], v[128:131], v[124:127], v[28:31]
    ds_read_b128 v[156:159], v193 offset:2048
    v_mfma_f32_16x16x32_bf16 v[32:35], v[132:135], v[112:115], v[32:35]
    ds_read_b128 v[160:163], v193 offset:10240
    v_mfma_f32_16x16x32_bf16 v[36:39], v[132:135], v[116:119], v[36:39]
    ds_read_b128 v[164:167], v193 offset:12288
    v_mfma_f32_16x16x32_bf16 v[40:43], v[132:135], v[120:123], v[40:43]
    ds_read_b64_tr_b16 v[172:173], v195 offset:20480
    v_mfma_f32_16x16x32_bf16 v[44:47], v[132:135], v[124:127], v[44:47]
    ds_read_b64_tr_b16 v[174:175], v195 offset:20992
    v_mfma_f32_16x16x32_bf16 v[48:51], v[136:139], v[112:115], v[48:51]
    ds_read_b64_tr_b16 v[176:177], v194 offset:22528
    v_mfma_f32_16x16x32_bf16 v[52:55], v[136:139], v[116:119], v[52:55]
    ds_read_b64_tr_b16 v[178:179], v194 offset:23040
    v_mfma_f32_16x16x32_bf16 v[56:59], v[136:139], v[120:123], v[56:59]
    ds_read_b64_tr_b16 v[180:181], v195 offset:22528
    v_mfma_f32_16x16x32_bf16 v[60:63], v[136:139], v[124:127], v[60:63]
    ds_read_b64_tr_b16 v[182:183], v195 offset:23040
    v_mfma_f32_16x16x32_bf16 v[64:67], v[140:143], v[112:115], v[64:67]
    ds_read_b64_tr_b16 v[184:185], v194 offset:24576
    v_mfma_f32_16x16x32_bf16 v[68:71], v[140:143], v[116:119], v[68:71]
    ds_read_b64_tr_b16 v[186:187], v194 offset:25088
    v_mfma_f32_16x16x32_bf16 v[72:75], v[140:143], v[120:123], v[72:75]
    ds_read_b64_tr_b16 v[188:189], v195 offset:24576
    v_mfma_f32_16x16x32_bf16 v[76:79], v[140:143], v[124:127], v[76:79]
    ds_read_b64_tr_b16 v[190:191], v195 offset:25088
    v_mfma_f32_16x16x32_bf16 v[80:83], v[144:147], v[112:115], v[80:83]
    v_mfma_f32_16x16x32_bf16 v[84:87], v[144:147], v[116:119], v[84:87]
    v_mfma_f32_16x16x32_bf16 v[88:91], v[144:147], v[120:123], v[88:91]
    v_mfma_f32_16x16x32_bf16 v[92:95], v[144:147], v[124:127], v[92:95]
    v_mfma_f32_16x16x32_bf16 v[96:99], v[148:151], v[112:115], v[96:99]
    s_add_u32 s68, s68, 1
    s_cmp_lt_u32 s68, 5
    v_mfma_f32_16x16x32_bf16 v[100:103], v[148:151], v[116:119], v[100:103]
    v_mfma_f32_16x16x32_bf16 v[104:107], v[148:151], v[120:123], v[104:107]
    v_mfma_f32_16x16x32_bf16 v[108:111], v[148:151], v[124:127], v[108:111]
    s_waitcnt lgkmcnt(0)
    v_mfma_f32_16x16x32_bf16 v[16:19], v[168:171], v[152:155], v[16:19]
    s_barrier
    v_mfma_f32_16x16x32_bf16 v[20:23], v[168:171], v[156:159], v[20:23]
    ds_read_b128 v[112:115], v196 offset:0
    v_mfma_f32_16x16x32_bf16 v[24:27], v[168:171], v[160:163], v[24:27]
    ds_read_b64_tr_b16 v[128:129], v198 offset:0
    s_cbranch_scc1 L_cloop
    v_mfma_f32_16x16x32_bf16 v[28:31], v[168:171], v[164:167], v[28:31]
    ds_read_b64 v[222:223], v213 offset:49152
    v_mfma_f32_16x16x32_bf16 v[32:35], v[172:175], v[152:155], v[32:35]
    ds_read_b64 v[224:225], v213 offset:49280
    v_mfma_f32_16x16x32_bf16 v[36:39], v[172:175], v[156:159], v[36:39]
    ds_read_b64 v[226:227], v213 offset:49408
    v_mfma_f32_16x16x32_bf16 v[40:43], v[172:175], v[160:163], v[40:43]
    ds_read_b64 v[228:229], v213 offset:49536
    v_mfma_f32_16x16x32_bf16 v[44:47], v[172:175], v[164:167], v[44:47]
    ds_read_b64 v[238:239], v215 offset:50176
    v_mfma_f32_16x16x32_bf16 v[48:51], v[176:179], v[152:155], v[48:51]
    ds_read_b64 v[240:241], v215 offset:50304
    v_mfma_f32_16x16x32_bf16 v[52:55], v[176:179], v[156:159], v[52:55]
    ds_read_b64 v[242:243], v215 offset:50688
    v_mfma_f32_16x16x32_bf16 v[56:59], v[176:179], v[160:163], v[56:59]
    ds_read_b64 v[244:245], v215 offset:50816
    v_mfma_f32_16x16x32_bf16 v[60:63], v[176:179], v[164:167], v[60:63]
    ds_read_b64 v[246:247], v215 offset:51200
    v_mfma_f32_16x16x32_bf16 v[64:67], v[180:183], v[152:155], v[64:67]
    ds_read_b64 v[248:249], v215 offset:51328
    v_mfma_f32_16x16x32_bf16 v[68:71], v[180:183], v[156:159], v[68:71]
    ds_read_b32 v250, v214 offset:49156
    v_mfma_f32_16x16x32_bf16 v[72:75], v[180:183], v[160:163], v[72:75]
    ds_read_b32 v252, v214 offset:49412
    v_mfma_f32_16x16x32_bf16 v[76:79], v[180:183], v[164:167], v[76:79]
    s_waitcnt lgkmcnt(8)
    v_mfma_f32_16x16x32_bf16 v[80:83], v[184:187], v[152:155], v[80:83]
    v_mov_b32 v230, v223
    v_cndmask_b32 v222, 0, v222, s[86:87]
    v_mfma_f32_16x16x32_bf16 v[84:87], v[184:187], v[156:159], v[84:87]
    v_mov_b32_e64 v232, v225
    v_cndmask_b32 v224, 0, v224, s[86:87]
    v_mfma_f32_16x16x32_bf16 v[88:91], v[184:187], v[160:163], v[88:91]
    v_mov_b32_e64 v234, v227
    v_cndmask_b32 v226, 0, v226, s[86:87]
    v_mfma_f32_16x16x32_bf16 v[92:95], v[184:187], v[164:167], v[92:95]
    v_mov_b32_e64 v236, v229
    v_cndmask_b32 v228, 0, v228, s[86:87]
    v_mfma_f32_16x16x32_bf16 v[96:99], v[188:191], v[152:155], v[96:99]
    v_mov_b32 v223, v222
    v_mov_b32 v225, v224
    v_mfma_f32_16x16x32_bf16 v[100:103], v[188:191], v[156:159], v[100:103]
    v_mov_b32 v227, v226
    v_mov_b32 v229, v228
    v_mfma_f32_16x16x32_bf16 v[104:107], v[188:191], v[160:163], v[104:107]
    s_waitcnt lgkmcnt(0)
    v_mul_f32 v251, 0x3fb8aa3b, v250
    v_mfma_f32_16x16x32_bf16 v[108:111], v[188:191], v[164:167], v[108:111]
    v_mul_f32 v253, 0x3fb8aa3b, v252
    v_mfma_f32_16x16x16_bf16 v[48:51], v[242:243], v[222:223], v[48:51]
    v_mfma_f32_16x16x16_bf16 v[52:55], v[242:243], v[224:225], v[52:55]
    v_mfma_f32_16x16x16_bf16 v[56:59], v[242:243], v[226:227], v[56:59]
    v_mfma_f32_16x16x16_bf16 v[60:63], v[242:243], v[228:229], v[60:63]
    v_mfma_f32_16x16x16_bf16 v[64:67], v[244:245], v[222:223], v[64:67]
    v_mfma_f32_16x16x16_bf16 v[68:71], v[244:245], v[224:225], v[68:71]
    v_mfma_f32_16x16x16_bf16 v[72:75], v[244:245], v[226:227], v[72:75]
    v_mfma_f32_16x16x16_bf16 v[76:79], v[244:245], v[228:229], v[76:79]
    v_mfma_f32_16x16x16_bf16 v[80:83], v[246:247], v[222:223], v[80:83]
    v_mfma_f32_16x16x16_bf16 v[84:87], v[246:247], v[224:225], v[84:87]
    v_mfma_f32_16x16x16_bf16 v[88:91], v[246:247], v[226:227], v[88:91]
    v_mfma_f32_16x16x16_bf16 v[92:95], v[246:247], v[228:229], v[92:95]
    v_mfma_f32_16x16x16_bf16 v[96:99], v[248:249], v[222:223], v[96:99]
    v_cvt_pk_bf16_f32 v112, v48, v49
    v_cvt_pk_bf16_f32 v113, v50, v51
    v_mfma_f32_16x16x16_bf16 v[100:103], v[248:249], v[224:225], v[100:103]
    v_cvt_pk_bf16_f32 v114, v52, v53
    v_cvt_pk_bf16_f32 v115, v54, v55
    v_mfma_f32_16x16x16_bf16 v[104:107], v[248:249], v[226:227], v[104:107]
    v_cvt_pk_bf16_f32 v116, v64, v65
    v_cvt_pk_bf16_f32 v117, v66, v67
    v_mfma_f32_16x16x16_bf16 v[108:111], v[248:249], v[228:229], v[108:111]
    v_cvt_pk_bf16_f32 v118, v68, v69
    v_cvt_pk_bf16_f32 v119, v70, v71
    v_mfma_f32_16x16x16_bf16 v[16:19], v[238:239], v[222:223], v[16:19]
    v_cvt_pk_bf16_f32 v120, v56, v57
    v_cvt_pk_bf16_f32 v121, v58, v59
    v_mfma_f32_16x16x16_bf16 v[20:23], v[238:239], v[224:225], v[20:23]
    v_cvt_pk_bf16_f32 v122, v60, v61
    v_cvt_pk_bf16_f32 v123, v62, v63
    v_mfma_f32_16x16x16_bf16 v[24:27], v[238:239], v[226:227], v[24:27]
    v_cvt_pk_bf16_f32 v124, v72, v73
    v_cvt_pk_bf16_f32 v125, v74, v75
    v_mfma_f32_16x16x16_bf16 v[28:31], v[238:239], v[228:229], v[28:31]
    v_cvt_pk_bf16_f32 v126, v76, v77
    v_cvt_pk_bf16_f32 v127, v78, v79
    v_mfma_f32_16x16x16_bf16 v[32:35], v[240:241], v[222:223], v[32:35]
    v_mfma_f32_16x16x16_bf16 v[36:39], v[240:241], v[224:225], v[36:39]
    v_mfma_f32_16x16x16_bf16 v[40:43], v[240:241], v[226:227], v[40:43]
    v_mfma_f32_16x16x16_bf16 v[44:47], v[240:241], v[228:229], v[44:47]
    v_permlane16_swap_b32 v112, v114
    v_permlane16_swap_b32 v113, v115
    v_permlane16_swap_b32 v116, v118
    v_permlane16_swap_b32 v117, v119
    v_permlane16_swap_b32 v120, v122
    v_permlane16_swap_b32 v121, v123
    v_permlane16_swap_b32 v124, v126
    v_permlane16_swap_b32 v125, v127
    v_xor_b32 v168, 0, v217
    v_xor_b32 v169, 16, v217
    v_xor_b32 v170, 32, v217
    v_xor_b32 v171, 48, v217
    v_xor_b32 v172, 64, v217
    v_xor_b32 v173, 80, v217
    v_xor_b32 v174, 96, v217
    v_xor_b32 v175, 112, v217
    v_xor_b32_e64 v4, 32, v216
    v_mfma_f32_32x32x16_bf16 v[48:63], v[204:207], v[112:115], 0
    v_mul_f32 v80, v80, v230
    v_mul_f32 v81, v81, v230
    v_mul_f32 v82, v82, v230
    v_mul_f32 v83, v83, v230
    v_cvt_pk_bf16_f32 v80, v80, v81
    v_cvt_pk_bf16_f32 v81, v82, v83
    ds_write_b64 v216, v[80:81] offset:32768
    v_mfma_f32_32x32x16_bf16 v[64:79], v[204:207], v[120:123], 0
    v_mul_f32 v96, v96, v230
    v_mul_f32 v97, v97, v230
    v_mul_f32 v98, v98, v230
    v_mul_f32 v99, v99, v230
    v_cvt_pk_bf16_f32 v96, v96, v97
    v_cvt_pk_bf16_f32 v97, v98, v99
    ds_write_b64 v4, v[96:97] offset:32768
    v_mfma_f32_32x32x16_bf16 v[48:63], v[208:211], v[116:119], v[48:63]
    v_mul_f32 v84, v84, v232
    v_mul_f32 v85, v85, v232
    v_mul_f32 v86, v86, v232
    v_mul_f32 v87, v87, v232
    v_cvt_pk_bf16_f32 v84, v84, v85
    v_cvt_pk_bf16_f32 v85, v86, v87
    ds_write_b64 v216, v[84:85] offset:34816
    v_mfma_f32_32x32x16_bf16 v[64:79], v[208:211], v[124:127], v[64:79]
    v_mul_f32 v100, v100, v232
    v_mul_f32 v101, v101, v232
    v_mul_f32 v102, v102, v232
    v_mul_f32 v103, v103, v232
    v_cvt_pk_bf16_f32 v100, v100, v101
    v_cvt_pk_bf16_f32 v101, v102, v103
    ds_write_b64 v4, v[100:101] offset:34816
    v_mul_f32 v88, v88, v234
    v_mul_f32 v89, v89, v234
    v_mul_f32 v90, v90, v234
    v_mul_f32 v91, v91, v234
    v_cvt_pk_bf16_f32 v88, v88, v89
    v_cvt_pk_bf16_f32 v89, v90, v91
    ds_write_b64 v216, v[88:89] offset:36864
    v_mul_f32 v104, v104, v234
    v_mul_f32 v105, v105, v234
    v_mul_f32 v106, v106, v234
    v_mul_f32 v107, v107, v234
    v_cvt_pk_bf16_f32 v104, v104, v105
    v_cvt_pk_bf16_f32 v105, v106, v107
    ds_write_b64 v4, v[104:105] offset:36864
    v_mul_f32 v92, v92, v236
    v_mul_f32 v93, v93, v236
    v_mul_f32 v94, v94, v236
    v_mul_f32 v95, v95, v236
    v_cvt_pk_bf16_f32 v92, v92, v93
    v_cvt_pk_bf16_f32 v93, v94, v95
    ds_write_b64 v216, v[92:93] offset:38912
    v_mul_f32 v108, v108, v236
    v_mul_f32 v109, v109, v236
    v_mul_f32 v110, v110, v236
    v_mul_f32 v111, v111, v236
    v_cvt_pk_bf16_f32 v108, v108, v109
    v_cvt_pk_bf16_f32 v109, v110, v111
    ds_write_b64 v4, v[108:109] offset:38912
    v_max3_f32 v160, v48, v49, v50
    v_min3_f32 v162, v48, v49, v50
    v_max3_f32 v160, v160, v51, v52
    v_min3_f32 v162, v162, v51, v52
    v_max3_f32 v160, v160, v53, v54
    v_min3_f32 v162, v162, v53, v54
    v_max3_f32 v160, v160, v55, v56
    v_min3_f32 v162, v162, v55, v56
    v_max3_f32 v160, v160, v57, v58
    v_min3_f32 v162, v162, v57, v58
    v_max3_f32 v160, v160, v59, v60
    v_min3_f32 v162, v162, v59, v60
    v_max3_f32 v160, v160, v61, v62
    v_min3_f32 v162, v162, v61, v62
    v_max_f32 v160, v160, v63
    v_min_f32 v162, v162, v63
    v_max3_f32 v164, v64, v65, v66
    v_min3_f32 v166, v64, v65, v66
    v_max3_f32 v164, v164, v67, v68
    v_min3_f32 v166, v166, v67, v68
    v_max3_f32 v164, v164, v69, v70
    v_min3_f32 v166, v166, v69, v70
    v_max3_f32 v164, v164, v71, v72
    v_min3_f32 v166, v166, v71, v72
    v_max3_f32 v164, v164, v73, v74
    v_min3_f32 v166, v166, v73, v74
    v_max3_f32 v164, v164, v75, v76
    v_min3_f32 v166, v166, v75, v76
    v_max3_f32 v164, v164, v77, v78
    v_min3_f32 v166, v166, v77, v78
    v_max_f32 v164, v164, v79
    v_min_f32 v166, v166, v79
    v_mov_b32 v161, v160
    v_mov_b32 v163, v162
    v_mov_b32 v165, v164
    v_mov_b32 v167, v166
    v_permlane32_swap_b32 v160, v161
    v_permlane32_swap_b32 v162, v163
    v_permlane32_swap_b32 v164, v165
    v_permlane32_swap_b32 v166, v167
    v_max_f32 v160, v160, v161
    v_min_f32 v162, v162, v163
    v_max_f32 v164, v164, v165
    v_min_f32 v166, v166, v167
    v_mul_f32 v160, v160, v251
    v_mul_f32 v162, v162, v251
    v_mul_f32 v164, v164, v253
    v_mul_f32 v166, v166, v253
    v_pk_fma_f32 v[128:129], v[48:49], v[250:251], v[160:161] op_sel:[0,1,0] op_sel_hi:[1,1,0] neg_lo:[0,0,1] neg_hi:[0,0,1]
    v_pk_fma_f32 v[48:49], v[48:49], v[250:251], v[162:163] op_sel:[0,1,0] op_sel_hi:[1,1,0] neg_lo:[0,1,0] neg_hi:[0,1,0]
    v_pk_fma_f32 v[130:131], v[50:51], v[250:251], v[160:161] op_sel:[0,1,0] op_sel_hi:[1,1,0] neg_lo:[0,0,1] neg_hi:[0,0,1]
    v_pk_fma_f32 v[50:51], v[50:51], v[250:251], v[162:163] op_sel:[0,1,0] op_sel_hi:[1,1,0] neg_lo:[0,1,0] neg_hi:[0,1,0]
    v_pk_fma_f32 v[132:133], v[52:53], v[250:251], v[160:161] op_sel:[0,1,0] op_sel_hi:[1,1,0] neg_lo:[0,0,1] neg_hi:[0,0,1]
    v_pk_fma_f32 v[52:53], v[52:53], v[250:251], v[162:163] op_sel:[0,1,0] op_sel_hi:[1,1,0] neg_lo:[0,1,0] neg_hi:[0,1,0]
    v_pk_fma_f32 v[134:135], v[54:55], v[250:251], v[160:161] op_sel:[0,1,0] op_sel_hi:[1,1,0] neg_lo:[0,0,1] neg_hi:[0,0,1]
    v_pk_fma_f32 v[54:55], v[54:55], v[250:251], v[162:163] op_sel:[0,1,0] op_sel_hi:[1,1,0] neg_lo:[0,1,0] neg_hi:[0,1,0]
    v_pk_fma_f32 v[136:137], v[56:57], v[250:251], v[160:161] op_sel:[0,1,0] op_sel_hi:[1,1,0] neg_lo:[0,0,1] neg_hi:[0,0,1]
    v_pk_fma_f32 v[56:57], v[56:57], v[250:251], v[162:163] op_sel:[0,1,0] op_sel_hi:[1,1,0] neg_lo:[0,1,0] neg_hi:[0,1,0]
    v_pk_fma_f32 v[138:139], v[58:59], v[250:251], v[160:161] op_sel:[0,1,0] op_sel_hi:[1,1,0] neg_lo:[0,0,1] neg_hi:[0,0,1]
    v_pk_fma_f32 v[58:59], v[58:59], v[250:251], v[162:163] op_sel:[0,1,0] op_sel_hi:[1,1,0] neg_lo:[0,1,0] neg_hi:[0,1,0]
    v_pk_fma_f32 v[140:141], v[60:61], v[250:251], v[160:161] op_sel:[0,1,0] op_sel_hi:[1,1,0] neg_lo:[0,0,1] neg_hi:[0,0,1]
    v_pk_fma_f32 v[60:61], v[60:61], v[250:251], v[162:163] op_sel:[0,1,0] op_sel_hi:[1,1,0] neg_lo:[0,1,0] neg_hi:[0,1,0]
    v_pk_fma_f32 v[142:143], v[62:63], v[250:251], v[160:161] op_sel:[0,1,0] op_sel_hi:[1,1,0] neg_lo:[0,0,1] neg_hi:[0,0,1]
    v_pk_fma_f32 v[62:63], v[62:63], v[250:251], v[162:163] op_sel:[0,1,0] op_sel_hi:[1,1,0] neg_lo:[0,1,0] neg_hi:[0,1,0]
    v_exp_f32 v128, v128
    v_exp_f32 v48, v48
    v_exp_f32 v129, v129
    v_exp_f32 v49, v49
    v_exp_f32 v130, v130
    v_exp_f32 v50, v50
    v_exp_f32 v131, v131
    v_exp_f32 v51, v51
    v_exp_f32 v132, v132
    v_exp_f32 v52, v52
    v_exp_f32 v133, v133
    v_exp_f32 v53, v53
    v_exp_f32 v134, v134
    v_exp_f32 v54, v54
    v_exp_f32 v135, v135
    v_exp_f32 v55, v55
    v_exp_f32 v136, v136
    v_exp_f32 v56, v56
    v_exp_f32 v137, v137
    v_exp_f32 v57, v57
    v_exp_f32 v138, v138
    v_exp_f32 v58, v58
    v_exp_f32 v139, v139
    v_exp_f32 v59, v59
    v_exp_f32 v140, v140
    v_exp_f32 v60, v60
    v_exp_f32 v141, v141
    v_exp_f32 v61, v61
    v_exp_f32 v142, v142
    v_exp_f32 v62, v62
    v_exp_f32 v143, v143
    v_exp_f32 v63, v63
    v_pk_fma_f32 v[144:145], v[64:65], v[252:253], v[164:165] op_sel:[0,1,0] op_sel_hi:[1,1,0] neg_lo:[0,0,1] neg_hi:[0,0,1]
    v_pk_fma_f32 v[64:65], v[64:65], v[252:253], v[166:167] op_sel:[0,1,0] op_sel_hi:[1,1,0] neg_lo:[0,1,0] neg_hi:[0,1,0]
    v_pk_fma_f32 v[146:147], v[66:67], v[252:253], v[164:165] op_sel:[0,1,0] op_sel_hi:[1,1,0] neg_lo:[0,0,1] neg_hi:[0,0,1]
    v_pk_fma_f32 v[66:67], v[66:67], v[252:253], v[166:167] op_sel:[0,1,0] op_sel_hi:[1,1,0] neg_lo:[0,1,0] neg_hi:[0,1,0]
    v_pk_fma_f32 v[148:149], v[68:69], v[252:253], v[164:165] op_sel:[0,1,0] op_sel_hi:[1,1,0] neg_lo:[0,0,1] neg_hi:[0,0,1]
    v_pk_fma_f32 v[68:69], v[68:69], v[252:253], v[166:167] op_sel:[0,1,0] op_sel_hi:[1,1,0] neg_lo:[0,1,0] neg_hi:[0,1,0]
    v_pk_fma_f32 v[150:151], v[70:71], v[252:253], v[164:165] op_sel:[0,1,0] op_sel_hi:[1,1,0] neg_lo:[0,0,1] neg_hi:[0,0,1]
    v_pk_fma_f32 v[70:71], v[70:71], v[252:253], v[166:167] op_sel:[0,1,0] op_sel_hi:[1,1,0] neg_lo:[0,1,0] neg_hi:[0,1,0]
    v_pk_fma_f32 v[152:153], v[72:73], v[252:253], v[164:165] op_sel:[0,1,0] op_sel_hi:[1,1,0] neg_lo:[0,0,1] neg_hi:[0,0,1]
    v_pk_fma_f32 v[72:73], v[72:73], v[252:253], v[166:167] op_sel:[0,1,0] op_sel_hi:[1,1,0] neg_lo:[0,1,0] neg_hi:[0,1,0]
    v_pk_fma_f32 v[154:155], v[74:75], v[252:253], v[164:165] op_sel:[0,1,0] op_sel_hi:[1,1,0] neg_lo:[0,0,1] neg_hi:[0,0,1]
    v_pk_fma_f32 v[74:75], v[74:75], v[252:253], v[166:167] op_sel:[0,1,0] op_sel_hi:[1,1,0] neg_lo:[0,1,0] neg_hi:[0,1,0]
    v_pk_fma_f32 v[156:157], v[76:77], v[252:253], v[164:165] op_sel:[0,1,0] op_sel_hi:[1,1,0] neg_lo:[0,0,1] neg_hi:[0,0,1]
    v_pk_fma_f32 v[76:77], v[76:77], v[252:253], v[166:167] op_sel:[0,1,0] op_sel_hi:[1,1,0] neg_lo:[0,1,0] neg_hi:[0,1,0]
    v_pk_fma_f32 v[158:159], v[78:79], v[252:253], v[164:165] op_sel:[0,1,0] op_sel_hi:[1,1,0] neg_lo:[0,0,1] neg_hi:[0,0,1]
    v_pk_fma_f32 v[78:79], v[78:79], v[252:253], v[166:167] op_sel:[0,1,0] op_sel_hi:[1,1,0] neg_lo:[0,1,0] neg_hi:[0,1,0]
    v_exp_f32 v144, v144
    v_exp_f32 v64, v64
    v_exp_f32 v145, v145
    v_exp_f32 v65, v65
    v_exp_f32 v146, v146
    v_exp_f32 v66, v66
    v_exp_f32 v147, v147
    v_exp_f32 v67, v67
    v_exp_f32 v148, v148
    v_exp_f32 v68, v68
    v_exp_f32 v149, v149
    v_exp_f32 v69, v69
    v_exp_f32 v150, v150
    v_exp_f32 v70, v70
    v_exp_f32 v151, v151
    v_exp_f32 v71, v71
    v_exp_f32 v152, v152
    v_exp_f32 v72, v72
    v_exp_f32 v153, v153
    v_exp_f32 v73, v73
    v_exp_f32 v154, v154
    v_exp_f32 v74, v74
    v_exp_f32 v155, v155
    v_exp_f32 v75, v75
    v_exp_f32 v156, v156
    v_exp_f32 v76, v76
    v_exp_f32 v157, v157
    v_exp_f32 v77, v77
    v_exp_f32 v158, v158
    v_exp_f32 v78, v78
    v_exp_f32 v159, v159
    v_exp_f32 v79, v79
    v_pk_add_f32 v[176:177], v[128:129], v[130:131]
    v_pk_add_f32 v[176:177], v[176:177], v[132:133]
    v_pk_add_f32 v[176:177], v[176:177], v[134:135]
    v_pk_add_f32 v[176:177], v[176:177], v[136:137]
    v_pk_add_f32 v[176:177], v[176:177], v[138:139]
    v_pk_add_f32 v[176:177], v[176:177], v[140:141]
    v_pk_add_f32 v[176:177], v[176:177], v[142:143]
    v_pk_add_f32 v[178:179], v[48:49], v[50:51]
    v_pk_add_f32 v[178:179], v[178:179], v[52:53]
    v_pk_add_f32 v[178:179], v[178:179], v[54:55]
    v_pk_add_f32 v[178:179], v[178:179], v[56:57]
    v_pk_add_f32 v[178:179], v[178:179], v[58:59]
    v_pk_add_f32 v[178:179], v[178:179], v[60:61]
    v_pk_add_f32 v[178:179], v[178:179], v[62:63]
    v_pk_add_f32 v[180:181], v[144:145], v[146:147]
    v_pk_add_f32 v[180:181], v[180:181], v[148:149]
    v_pk_add_f32 v[180:181], v[180:181], v[150:151]
    v_pk_add_f32 v[180:181], v[180:181], v[152:153]
    v_pk_add_f32 v[180:181], v[180:181], v[154:155]
    v_pk_add_f32 v[180:181], v[180:181], v[156:157]
    v_pk_add_f32 v[180:181], v[180:181], v[158:159]
    v_pk_add_f32 v[182:183], v[64:65], v[66:67]
    v_pk_add_f32 v[182:183], v[182:183], v[68:69]
    v_pk_add_f32 v[182:183], v[182:183], v[70:71]
    v_pk_add_f32 v[182:183], v[182:183], v[72:73]
    v_pk_add_f32 v[182:183], v[182:183], v[74:75]
    v_pk_add_f32 v[182:183], v[182:183], v[76:77]
    v_pk_add_f32 v[182:183], v[182:183], v[78:79]
    v_add_f32 v176, v176, v177
    v_add_f32 v178, v178, v179
    v_add_f32 v180, v180, v181
    v_add_f32 v182, v182, v183
    v_mov_b32 v177, v176
    v_mov_b32 v179, v178
    v_mov_b32 v181, v180
    v_mov_b32 v183, v182
    v_permlane32_swap_b32 v176, v177
    v_permlane32_swap_b32 v178, v179
    v_permlane32_swap_b32 v180, v181
    v_permlane32_swap_b32 v182, v183
    v_add_f32 v176, v176, v177
    v_add_f32 v178, v178, v179
    v_add_f32 v180, v180, v181
    v_add_f32 v182, v182, v183
    v_rcp_f32 v176, v176
    v_rcp_f32 v178, v178
    v_rcp_f32 v180, v180
    v_rcp_f32 v182, v182
    v_pk_mul_f32 v[128:129], v[128:129], v[176:177] op_sel_hi:[1,0]
    v_pk_mul_f32 v[130:131], v[130:131], v[176:177] op_sel_hi:[1,0]
    v_pk_mul_f32 v[132:133], v[132:133], v[176:177] op_sel_hi:[1,0]
    v_pk_mul_f32 v[134:135], v[134:135], v[176:177] op_sel_hi:[1,0]
    v_pk_mul_f32 v[136:137], v[136:137], v[176:177] op_sel_hi:[1,0]
    v_pk_mul_f32 v[138:139], v[138:139], v[176:177] op_sel_hi:[1,0]
    v_pk_mul_f32 v[140:141], v[140:141], v[176:177] op_sel_hi:[1,0]
    v_pk_mul_f32 v[142:143], v[142:143], v[176:177] op_sel_hi:[1,0]
    v_cvt_pk_bf16_f32 v128, v128, v129
    v_cvt_pk_bf16_f32 v129, v130, v131
    ds_write_b64 v168, v[128:129] offset:0
    v_cvt_pk_bf16_f32 v130, v132, v133
    v_cvt_pk_bf16_f32 v131, v134, v135
    ds_write_b64 v169, v[130:131] offset:0
    v_cvt_pk_bf16_f32 v132, v136, v137
    v_cvt_pk_bf16_f32 v133, v138, v139
    ds_write_b64 v170, v[132:133] offset:0
    v_cvt_pk_bf16_f32 v134, v140, v141
    v_cvt_pk_bf16_f32 v135, v142, v143
    ds_write_b64 v171, v[134:135] offset:0
    v_pk_mul_f32 v[48:49], v[48:49], v[178:179] op_sel_hi:[1,0]
    v_pk_mul_f32 v[50:51], v[50:51], v[178:179] op_sel_hi:[1,0]
    v_pk_mul_f32 v[52:53], v[52:53], v[178:179] op_sel_hi:[1,0]
    v_pk_mul_f32 v[54:55], v[54:55], v[178:179] op_sel_hi:[1,0]
    v_pk_mul_f32 v[56:57], v[56:57], v[178:179] op_sel_hi:[1,0]
    v_pk_mul_f32 v[58:59], v[58:59], v[178:179] op_sel_hi:[1,0]
    v_pk_mul_f32 v[60:61], v[60:61], v[178:179] op_sel_hi:[1,0]
    v_pk_mul_f32 v[62:63], v[62:63], v[178:179] op_sel_hi:[1,0]
    v_cvt_pk_bf16_f32 v48, v48, v49
    v_cvt_pk_bf16_f32 v49, v50, v51
    ds_write_b64 v172, v[48:49] offset:0
    v_cvt_pk_bf16_f32 v50, v52, v53
    v_cvt_pk_bf16_f32 v51, v54, v55
    ds_write_b64 v173, v[50:51] offset:0
    v_cvt_pk_bf16_f32 v52, v56, v57
    v_cvt_pk_bf16_f32 v53, v58, v59
    ds_write_b64 v174, v[52:53] offset:0
    v_cvt_pk_bf16_f32 v54, v60, v61
    v_cvt_pk_bf16_f32 v55, v62, v63
    ds_write_b64 v175, v[54:55] offset:0
    v_pk_mul_f32 v[144:145], v[144:145], v[180:181] op_sel_hi:[1,0]
    v_pk_mul_f32 v[146:147], v[146:147], v[180:181] op_sel_hi:[1,0]
    v_pk_mul_f32 v[148:149], v[148:149], v[180:181] op_sel_hi:[1,0]
    v_pk_mul_f32 v[150:151], v[150:151], v[180:181] op_sel_hi:[1,0]
    v_pk_mul_f32 v[152:153], v[152:153], v[180:181] op_sel_hi:[1,0]
    v_pk_mul_f32 v[154:155], v[154:155], v[180:181] op_sel_hi:[1,0]
    v_pk_mul_f32 v[156:157], v[156:157], v[180:181] op_sel_hi:[1,0]
    v_pk_mul_f32 v[158:159], v[158:159], v[180:181] op_sel_hi:[1,0]
    v_cvt_pk_bf16_f32 v144, v144, v145
    v_cvt_pk_bf16_f32 v145, v146, v147
    ds_write_b64 v168, v[144:145] offset:4096
    v_cvt_pk_bf16_f32 v146, v148, v149
    v_cvt_pk_bf16_f32 v147, v150, v151
    ds_write_b64 v169, v[146:147] offset:4096
    v_cvt_pk_bf16_f32 v148, v152, v153
    v_cvt_pk_bf16_f32 v149, v154, v155
    ds_write_b64 v170, v[148:149] offset:4096
    v_cvt_pk_bf16_f32 v150, v156, v157
    v_cvt_pk_bf16_f32 v151, v158, v159
    ds_write_b64 v171, v[150:151] offset:4096
    v_pk_mul_f32 v[64:65], v[64:65], v[182:183] op_sel_hi:[1,0]
    v_pk_mul_f32 v[66:67], v[66:67], v[182:183] op_sel_hi:[1,0]
    v_pk_mul_f32 v[68:69], v[68:69], v[182:183] op_sel_hi:[1,0]
    v_pk_mul_f32 v[70:71], v[70:71], v[182:183] op_sel_hi:[1,0]
    v_pk_mul_f32 v[72:73], v[72:73], v[182:183] op_sel_hi:[1,0]
    v_pk_mul_f32 v[74:75], v[74:75], v[182:183] op_sel_hi:[1,0]
    v_pk_mul_f32 v[76:77], v[76:77], v[182:183] op_sel_hi:[1,0]
    v_pk_mul_f32 v[78:79], v[78:79], v[182:183] op_sel_hi:[1,0]
    v_cvt_pk_bf16_f32 v64, v64, v65
    v_cvt_pk_bf16_f32 v65, v66, v67
    ds_write_b64 v172, v[64:65] offset:4096
    v_cvt_pk_bf16_f32 v66, v68, v69
    v_cvt_pk_bf16_f32 v67, v70, v71
    ds_write_b64 v173, v[66:67] offset:4096
    v_cvt_pk_bf16_f32 v68, v72, v73
    v_cvt_pk_bf16_f32 v69, v74, v75
    ds_write_b64 v174, v[68:69] offset:4096
    v_cvt_pk_bf16_f32 v70, v76, v77
    v_cvt_pk_bf16_f32 v71, v78, v79
    ds_write_b64 v175, v[70:71] offset:4096
    s_waitcnt lgkmcnt(0)
    s_barrier
    ds_read_b64_tr_b16 v[112:113], v218 offset:0
    ds_read_b64_tr_b16 v[114:115], v219 offset:0
    ds_read_b64_tr_b16 v[144:145], v220 offset:32768
    ds_read_b64_tr_b16 v[146:147], v221 offset:32768
    ds_read_b64_tr_b16 v[116:117], v218 offset:2048
    ds_read_b64_tr_b16 v[118:119], v219 offset:2048
    ds_read_b64_tr_b16 v[148:149], v220 offset:34816
    ds_read_b64_tr_b16 v[150:151], v221 offset:34816
    ds_read_b64_tr_b16 v[120:121], v218 offset:4096
    ds_read_b64_tr_b16 v[122:123], v219 offset:4096
    ds_read_b64_tr_b16 v[152:153], v220 offset:36864
    ds_read_b64_tr_b16 v[154:155], v221 offset:36864
    v_cvt_pk_bf16_f32 v176, v16, v17
    v_cvt_pk_bf16_f32 v177, v18, v19
    v_cvt_pk_bf16_f32 v178, v20, v21
    v_cvt_pk_bf16_f32 v179, v22, v23
    v_cvt_pk_bf16_f32 v180, v32, v33
    v_cvt_pk_bf16_f32 v181, v34, v35
    v_cvt_pk_bf16_f32 v182, v36, v37
    v_cvt_pk_bf16_f32 v183, v38, v39
    s_waitcnt lgkmcnt(8)
    v_mfma_f32_32x32x16_bf16 v[48:63], v[112:115], v[144:147], 0
    ds_read_b64_tr_b16 v[124:125], v218 offset:6144
    ds_read_b64_tr_b16 v[126:127], v219 offset:6144
    ds_read_b64_tr_b16 v[156:157], v220 offset:38912
    ds_read_b64_tr_b16 v[158:159], v221 offset:38912
    s_waitcnt lgkmcnt(8)
    v_mfma_f32_32x32x16_bf16 v[48:63], v[116:119], v[148:151], v[48:63]
    ds_read_b64_tr_b16 v[128:129], v218 offset:8192
    ds_read_b64_tr_b16 v[130:131], v219 offset:8192
    ds_read_b64_tr_b16 v[160:161], v220 offset:40960
    ds_read_b64_tr_b16 v[162:163], v221 offset:40960
    s_waitcnt lgkmcnt(8)
    v_mfma_f32_32x32x16_bf16 v[48:63], v[120:123], v[152:155], v[48:63]
    ds_read_b64_tr_b16 v[132:133], v218 offset:10240
    ds_read_b64_tr_b16 v[134:135], v219 offset:10240
    ds_read_b64_tr_b16 v[164:165], v220 offset:43008
    ds_read_b64_tr_b16 v[166:167], v221 offset:43008
    s_waitcnt lgkmcnt(8)
    v_mfma_f32_32x32x16_bf16 v[48:63], v[124:127], v[156:159], v[48:63]
    ds_read_b64_tr_b16 v[136:137], v218 offset:12288
    ds_read_b64_tr_b16 v[138:139], v219 offset:12288
    ds_read_b64_tr_b16 v[168:169], v220 offset:45056
    ds_read_b64_tr_b16 v[170:171], v221 offset:45056
    s_waitcnt lgkmcnt(8)
    v_mfma_f32_32x32x16_bf16 v[48:63], v[128:131], v[160:163], v[48:63]
    ds_read_b64_tr_b16 v[140:141], v218 offset:14336
    ds_read_b64_tr_b16 v[142:143], v219 offset:14336
    ds_read_b64_tr_b16 v[172:173], v220 offset:47104
    ds_read_b64_tr_b16 v[174:175], v221 offset:47104
    s_waitcnt lgkmcnt(8)
    v_mfma_f32_32x32x16_bf16 v[48:63], v[132:135], v[164:167], v[48:63]
    s_lshl_b32 s76, s62, 11
    s_add_u32 s76, s76, s73
    s_add_u32 s76, s76, 4096
    s_waitcnt lgkmcnt(4)
    v_mfma_f32_32x32x16_bf16 v[48:63], v[136:139], v[168:171], v[48:63]
    v_cvt_pk_bf16_f32 v184, v24, v25
    v_cvt_pk_bf16_f32 v185, v26, v27
    v_cvt_pk_bf16_f32 v186, v28, v29
    v_cvt_pk_bf16_f32 v187, v30, v31
    s_waitcnt lgkmcnt(0)
    v_mfma_f32_32x32x16_bf16 v[48:63], v[140:143], v[172:175], v[48:63]
    v_cvt_pk_bf16_f32 v188, v40, v41
    v_cvt_pk_bf16_f32 v189, v42, v43
    v_cvt_pk_bf16_f32 v190, v44, v45
    v_cvt_pk_bf16_f32 v191, v46, v47
    s_barrier
    s_lshl_b32 s77, s62, 7
    s_add_u32 s77, s77, s73
    v_lshlrev_b32 v4, 2, v2
    v_permlane16_swap_b32 v176, v178
    v_permlane16_swap_b32 v177, v179
    v_permlane16_swap_b32 v180, v182
    v_permlane16_swap_b32 v181, v183
    v_cvt_pk_bf16_f32 v64, v48, v49
    v_cvt_pk_bf16_f32 v65, v50, v51
    v_cvt_pk_bf16_f32 v66, v52, v53
    v_cvt_pk_bf16_f32 v67, v54, v55
    buffer_store_dwordx4 v[64:67], v12, s[40:43], s76 offen offset:0 sc1
    v_cvt_pk_bf16_f32 v68, v56, v57
    v_cvt_pk_bf16_f32 v69, v58, v59
    v_cvt_pk_bf16_f32 v70, v60, v61
    v_cvt_pk_bf16_f32 v71, v62, v63
    buffer_store_dwordx4 v[68:71], v12, s[40:43], s76 offen offset:1024 sc1
    v_dot2_f32_bf16 v72, v112, s89, 0
    v_dot2_f32_bf16 v73, v113, s89, 0
    v_dot2_f32_bf16 v72, v114, s89, v72
    v_dot2_f32_bf16 v73, v115, s89, v73
    v_dot2_f32_bf16 v72, v116, s89, v72
    v_dot2_f32_bf16 v73, v117, s89, v73
    v_dot2_f32_bf16 v72, v118, s89, v72
    v_dot2_f32_bf16 v73, v119, s89, v73
    v_dot2_f32_bf16 v72, v120, s89, v72
    v_dot2_f32_bf16 v73, v121, s89, v73
    v_dot2_f32_bf16 v72, v122, s89, v72
    v_dot2_f32_bf16 v73, v123, s89, v73
    v_dot2_f32_bf16 v72, v124, s89, v72
    v_dot2_f32_bf16 v73, v125, s89, v73
    v_dot2_f32_bf16 v72, v126, s89, v72
    v_dot2_f32_bf16 v73, v127, s89, v73
    v_dot2_f32_bf16 v72, v128, s89, v72
    v_dot2_f32_bf16 v73, v129, s89, v73
    v_dot2_f32_bf16 v72, v130, s89, v72
    v_dot2_f32_bf16 v73, v131, s89, v73
    v_dot2_f32_bf16 v72, v132, s89, v72
    v_dot2_f32_bf16 v73, v133, s89, v73
    v_dot2_f32_bf16 v72, v134, s89, v72
    v_dot2_f32_bf16 v73, v135, s89, v73
    v_dot2_f32_bf16 v72, v136, s89, v72
    v_dot2_f32_bf16 v73, v137, s89, v73
    v_dot2_f32_bf16 v72, v138, s89, v72
    v_dot2_f32_bf16 v73, v139, s89, v73
    v_dot2_f32_bf16 v72, v140, s89, v72
    v_dot2_f32_bf16 v73, v141, s89, v73
    v_dot2_f32_bf16 v72, v142, s89, v72
    v_dot2_f32_bf16 v73, v143, s89, v73
    v_permlane16_swap_b32 v184, v186
    v_permlane16_swap_b32 v185, v187
    v_permlane16_swap_b32 v188, v190
    v_permlane16_swap_b32 v189, v191
    v_add_f32_e64 v72, v72, v73
    v_mfma_f32_32x32x16_bf16 v[16:31], v[204:207], v[176:179], 0
    v_mov_b32 v73, v72
    s_nop 1
    v_permlane32_swap_b32 v72, v73
    v_add_f32 v72, v72, v73
    v_mfma_f32_32x32x16_bf16 v[32:47], v[204:207], v[184:187], 0
    s_mov_b32 exec_hi, 0
    buffer_store_dword v72, v4, s[40:43], s77 offen offset:2048 sc1
    s_mov_b64 exec, -1
    v_mfma_f32_32x32x16_bf16 v[16:31], v[208:211], v[180:183], v[16:31]
    s_lshl_b32 s76, s98, 7
    v_lshl_add_u32 v4, v3, 3, s76
    v_lshlrev_b32 v5, 5, v1
    v_mfma_f32_32x32x16_bf16 v[32:47], v[208:211], v[188:191], v[32:47]
    v_and_b32 v216, 1, v1
    v_lshlrev_b32 v216, 8, v216
    v_lshl_add_u32 v216, v3, 4, v216
    s_lshl_b32 s76, s64, 7
    v_add_u32 v216, s76, v216
    s_mul_i32 s78, s61, 28800
    s_lshl_b32 s79, s64, 8
    s_add_u32 s78, s78, s79
    s_add_u32 s79, s78, 3686400
    v_max3_f32 v160, v16, v17, v18
    v_min3_f32 v162, v16, v17, v18
    v_max3_f32 v160, v160, v19, v20
    v_min3_f32 v162, v162, v19, v20
    v_max3_f32 v160, v160, v21, v22
    v_min3_f32 v162, v162, v21, v22
    v_max3_f32 v160, v160, v23, v24
    v_min3_f32 v162, v162, v23, v24
    v_max3_f32 v160, v160, v25, v26
    v_min3_f32 v162, v162, v25, v26
    v_max3_f32 v160, v160, v27, v28
    v_min3_f32 v162, v162, v27, v28
    v_max3_f32 v160, v160, v29, v30
    v_min3_f32 v162, v162, v29, v30
    v_max_f32 v160, v160, v31
    v_min_f32 v162, v162, v31
    v_max3_f32 v164, v32, v33, v34
    v_min3_f32 v166, v32, v33, v34
    v_max3_f32 v164, v164, v35, v36
    v_min3_f32 v166, v166, v35, v36
    v_max3_f32 v164, v164, v37, v38
    v_min3_f32 v166, v166, v37, v38
    v_max3_f32 v164, v164, v39, v40
    v_min3_f32 v166, v166, v39, v40
    v_max3_f32 v164, v164, v41, v42
    v_min3_f32 v166, v166, v41, v42
    v_max3_f32 v164, v164, v43, v44
    v_min3_f32 v166, v166, v43, v44
    v_max3_f32 v164, v164, v45, v46
    v_min3_f32 v166, v166, v45, v46
    v_max_f32 v164, v164, v47
    v_min_f32 v166, v166, v47
    v_mov_b32 v161, v160
    v_mov_b32 v163, v162
    v_mov_b32 v165, v164
    v_mov_b32 v167, v166
    v_permlane32_swap_b32 v160, v161
    v_permlane32_swap_b32 v162, v163
    v_permlane32_swap_b32 v164, v165
    v_permlane32_swap_b32 v166, v167
    v_max_f32 v160, v160, v161
    v_min_f32 v162, v162, v163
    v_max_f32 v164, v164, v165
    v_min_f32 v166, v166, v167
    v_mul_f32 v160, v160, v251
    v_mul_f32 v162, v162, v251
    v_mul_f32 v164, v164, v253
    v_mul_f32 v166, v166, v253
    v_pk_fma_f32 v[128:129], v[16:17], v[250:251], v[160:161] op_sel:[0,1,0] op_sel_hi:[1,1,0] neg_lo:[0,0,1] neg_hi:[0,0,1]
    v_pk_fma_f32 v[16:17], v[16:17], v[250:251], v[162:163] op_sel:[0,1,0] op_sel_hi:[1,1,0] neg_lo:[0,1,0] neg_hi:[0,1,0]
    v_pk_fma_f32 v[130:131], v[18:19], v[250:251], v[160:161] op_sel:[0,1,0] op_sel_hi:[1,1,0] neg_lo:[0,0,1] neg_hi:[0,0,1]
    v_pk_fma_f32 v[18:19], v[18:19], v[250:251], v[162:163] op_sel:[0,1,0] op_sel_hi:[1,1,0] neg_lo:[0,1,0] neg_hi:[0,1,0]
    v_pk_fma_f32 v[132:133], v[20:21], v[250:251], v[160:161] op_sel:[0,1,0] op_sel_hi:[1,1,0] neg_lo:[0,0,1] neg_hi:[0,0,1]
    v_pk_fma_f32 v[20:21], v[20:21], v[250:251], v[162:163] op_sel:[0,1,0] op_sel_hi:[1,1,0] neg_lo:[0,1,0] neg_hi:[0,1,0]
    v_pk_fma_f32 v[134:135], v[22:23], v[250:251], v[160:161] op_sel:[0,1,0] op_sel_hi:[1,1,0] neg_lo:[0,0,1] neg_hi:[0,0,1]
    v_pk_fma_f32 v[22:23], v[22:23], v[250:251], v[162:163] op_sel:[0,1,0] op_sel_hi:[1,1,0] neg_lo:[0,1,0] neg_hi:[0,1,0]
    v_pk_fma_f32 v[136:137], v[24:25], v[250:251], v[160:161] op_sel:[0,1,0] op_sel_hi:[1,1,0] neg_lo:[0,0,1] neg_hi:[0,0,1]
    v_pk_fma_f32 v[24:25], v[24:25], v[250:251], v[162:163] op_sel:[0,1,0] op_sel_hi:[1,1,0] neg_lo:[0,1,0] neg_hi:[0,1,0]
    v_pk_fma_f32 v[138:139], v[26:27], v[250:251], v[160:161] op_sel:[0,1,0] op_sel_hi:[1,1,0] neg_lo:[0,0,1] neg_hi:[0,0,1]
    v_pk_fma_f32 v[26:27], v[26:27], v[250:251], v[162:163] op_sel:[0,1,0] op_sel_hi:[1,1,0] neg_lo:[0,1,0] neg_hi:[0,1,0]
    v_pk_fma_f32 v[140:141], v[28:29], v[250:251], v[160:161] op_sel:[0,1,0] op_sel_hi:[1,1,0] neg_lo:[0,0,1] neg_hi:[0,0,1]
    v_pk_fma_f32 v[28:29], v[28:29], v[250:251], v[162:163] op_sel:[0,1,0] op_sel_hi:[1,1,0] neg_lo:[0,1,0] neg_hi:[0,1,0]
    v_pk_fma_f32 v[142:143], v[30:31], v[250:251], v[160:161] op_sel:[0,1,0] op_sel_hi:[1,1,0] neg_lo:[0,0,1] neg_hi:[0,0,1]
    v_pk_fma_f32 v[30:31], v[30:31], v[250:251], v[162:163] op_sel:[0,1,0] op_sel_hi:[1,1,0] neg_lo:[0,1,0] neg_hi:[0,1,0]
    v_exp_f32 v128, v128
    v_exp_f32 v16, v16
    v_exp_f32 v129, v129
    v_exp_f32 v17, v17
    v_exp_f32 v130, v130
    v_exp_f32 v18, v18
    v_exp_f32 v131, v131
    v_exp_f32 v19, v19
    v_exp_f32 v132, v132
    v_exp_f32 v20, v20
    v_exp_f32 v133, v133
    v_exp_f32 v21, v21
    v_exp_f32 v134, v134
    v_exp_f32 v22, v22
    v_exp_f32 v135, v135
    v_exp_f32 v23, v23
    v_exp_f32 v136, v136
    v_exp_f32 v24, v24
    v_exp_f32 v137, v137
    v_exp_f32 v25, v25
    v_exp_f32 v138, v138
    v_exp_f32 v26, v26
    v_exp_f32 v139, v139
    v_exp_f32 v27, v27
    v_exp_f32 v140, v140
    v_exp_f32 v28, v28
    v_exp_f32 v141, v141
    v_exp_f32 v29, v29
    v_exp_f32 v142, v142
    v_exp_f32 v30, v30
    v_exp_f32 v143, v143
    v_exp_f32 v31, v31
    v_pk_fma_f32 v[144:145], v[32:33], v[252:253], v[164:165] op_sel:[0,1,0] op_sel_hi:[1,1,0] neg_lo:[0,0,1] neg_hi:[0,0,1]
    v_pk_fma_f32 v[32:33], v[32:33], v[252:253], v[166:167] op_sel:[0,1,0] op_sel_hi:[1,1,0] neg_lo:[0,1,0] neg_hi:[0,1,0]
    v_pk_fma_f32 v[146:147], v[34:35], v[252:253], v[164:165] op_sel:[0,1,0] op_sel_hi:[1,1,0] neg_lo:[0,0,1] neg_hi:[0,0,1]
    v_pk_fma_f32 v[34:35], v[34:35], v[252:253], v[166:167] op_sel:[0,1,0] op_sel_hi:[1,1,0] neg_lo:[0,1,0] neg_hi:[0,1,0]
    v_pk_fma_f32 v[148:149], v[36:37], v[252:253], v[164:165] op_sel:[0,1,0] op_sel_hi:[1,1,0] neg_lo:[0,0,1] neg_hi:[0,0,1]
    v_pk_fma_f32 v[36:37], v[36:37], v[252:253], v[166:167] op_sel:[0,1,0] op_sel_hi:[1,1,0] neg_lo:[0,1,0] neg_hi:[0,1,0]
    v_pk_fma_f32 v[150:151], v[38:39], v[252:253], v[164:165] op_sel:[0,1,0] op_sel_hi:[1,1,0] neg_lo:[0,0,1] neg_hi:[0,0,1]
    v_pk_fma_f32 v[38:39], v[38:39], v[252:253], v[166:167] op_sel:[0,1,0] op_sel_hi:[1,1,0] neg_lo:[0,1,0] neg_hi:[0,1,0]
    v_pk_fma_f32 v[152:153], v[40:41], v[252:253], v[164:165] op_sel:[0,1,0] op_sel_hi:[1,1,0] neg_lo:[0,0,1] neg_hi:[0,0,1]
    v_pk_fma_f32 v[40:41], v[40:41], v[252:253], v[166:167] op_sel:[0,1,0] op_sel_hi:[1,1,0] neg_lo:[0,1,0] neg_hi:[0,1,0]
    v_pk_fma_f32 v[154:155], v[42:43], v[252:253], v[164:165] op_sel:[0,1,0] op_sel_hi:[1,1,0] neg_lo:[0,0,1] neg_hi:[0,0,1]
    v_pk_fma_f32 v[42:43], v[42:43], v[252:253], v[166:167] op_sel:[0,1,0] op_sel_hi:[1,1,0] neg_lo:[0,1,0] neg_hi:[0,1,0]
    v_pk_fma_f32 v[156:157], v[44:45], v[252:253], v[164:165] op_sel:[0,1,0] op_sel_hi:[1,1,0] neg_lo:[0,0,1] neg_hi:[0,0,1]
    v_pk_fma_f32 v[44:45], v[44:45], v[252:253], v[166:167] op_sel:[0,1,0] op_sel_hi:[1,1,0] neg_lo:[0,1,0] neg_hi:[0,1,0]
    v_pk_fma_f32 v[158:159], v[46:47], v[252:253], v[164:165] op_sel:[0,1,0] op_sel_hi:[1,1,0] neg_lo:[0,0,1] neg_hi:[0,0,1]
    v_pk_fma_f32 v[46:47], v[46:47], v[252:253], v[166:167] op_sel:[0,1,0] op_sel_hi:[1,1,0] neg_lo:[0,1,0] neg_hi:[0,1,0]
    v_exp_f32 v144, v144
    v_exp_f32 v32, v32
    v_exp_f32 v145, v145
    v_exp_f32 v33, v33
    v_exp_f32 v146, v146
    v_exp_f32 v34, v34
    v_exp_f32 v147, v147
    v_exp_f32 v35, v35
    v_exp_f32 v148, v148
    v_exp_f32 v36, v36
    v_exp_f32 v149, v149
    v_exp_f32 v37, v37
    v_exp_f32 v150, v150
    v_exp_f32 v38, v38
    v_exp_f32 v151, v151
    v_exp_f32 v39, v39
    v_exp_f32 v152, v152
    v_exp_f32 v40, v40
    v_exp_f32 v153, v153
    v_exp_f32 v41, v41
    v_exp_f32 v154, v154
    v_exp_f32 v42, v42
    v_exp_f32 v155, v155
    v_exp_f32 v43, v43
    v_exp_f32 v156, v156
    v_exp_f32 v44, v44
    v_exp_f32 v157, v157
    v_exp_f32 v45, v45
    v_exp_f32 v158, v158
    v_exp_f32 v46, v46
    v_exp_f32 v159, v159
    v_exp_f32 v47, v47
    v_cvt_pk_bf16_f32 v218, v128, v129
    v_cvt_pk_bf16_f32 v219, v130, v131
    v_cvt_pk_bf16_f32 v220, v132, v133
    v_cvt_pk_bf16_f32 v221, v134, v135
    v_cvt_pk_bf16_f32 v222, v136, v137
    v_cvt_pk_bf16_f32 v223, v138, v139
    v_cvt_pk_bf16_f32 v224, v140, v141
    v_cvt_pk_bf16_f32 v225, v142, v143
    v_cvt_pk_bf16_f32 v226, v16, v17
    v_cvt_pk_bf16_f32 v227, v18, v19
    v_cvt_pk_bf16_f32 v228, v20, v21
    v_cvt_pk_bf16_f32 v229, v22, v23
    v_cvt_pk_bf16_f32 v230, v24, v25
    v_cvt_pk_bf16_f32 v231, v26, v27
    v_cvt_pk_bf16_f32 v232, v28, v29
    v_cvt_pk_bf16_f32 v233, v30, v31
    v_cvt_pk_bf16_f32 v234, v144, v145
    v_cvt_pk_bf16_f32 v235, v146, v147
    v_cvt_pk_bf16_f32 v236, v148, v149
    v_cvt_pk_bf16_f32 v237, v150, v151
    v_cvt_pk_bf16_f32 v238, v152, v153
    v_cvt_pk_bf16_f32 v239, v154, v155
    v_cvt_pk_bf16_f32 v240, v156, v157
    v_cvt_pk_bf16_f32 v241, v158, v159
    v_cvt_pk_bf16_f32 v242, v32, v33
    v_cvt_pk_bf16_f32 v243, v34, v35
    v_cvt_pk_bf16_f32 v244, v36, v37
    v_cvt_pk_bf16_f32 v245, v38, v39
    v_cvt_pk_bf16_f32 v246, v40, v41
    v_cvt_pk_bf16_f32 v247, v42, v43
    v_cvt_pk_bf16_f32 v248, v44, v45
    v_cvt_pk_bf16_f32 v249, v46, v47
    s_barrier
    buffer_load_dwordx4 v[32:35], v13, s[40:43], s78 offen offset:3072 sc1
    buffer_load_dwordx4 v[36:39], v13, s[40:43], s79 offen offset:3072 sc1
    buffer_load_dwordx4 v[40:43], v13, s[40:43], s78 offen offset:3200 sc1
    buffer_load_dwordx4 v[44:47], v13, s[40:43], s79 offen offset:3200 sc1
    ds_read_b128 v[16:19], v216 offset:24576
    ds_read_b128 v[20:23], v216 offset:24608
    ds_read_b128 v[24:27], v216 offset:24640
    ds_read_b128 v[28:31], v216 offset:24672
    s_waitcnt lgkmcnt(0)
    v_mfma_f32_32x32x16_bf16 v[48:63], v[16:19], v[218:221], 0
    v_mfma_f32_32x32x16_bf16 v[64:79], v[24:27], v[226:229], 0
    v_mfma_f32_32x32x16_bf16 v[80:95], v[16:19], v[234:237], 0
    v_mfma_f32_32x32x16_bf16 v[96:111], v[24:27], v[242:245], 0
    v_mfma_f32_32x32x16_bf16 v[48:63], v[20:23], v[222:225], v[48:63]
    v_mfma_f32_32x32x16_bf16 v[64:79], v[28:31], v[230:233], v[64:79]
    v_mfma_f32_32x32x16_bf16 v[80:95], v[20:23], v[238:241], v[80:95]
    v_mfma_f32_32x32x16_bf16 v[96:111], v[28:31], v[246:249], v[96:111]
    s_lshl_b32 s76, s63, 13
    s_lshl_b32 s77, s64, 11
    s_add_u32 s76, s76, s77
    s_add_u32 s76, s76, s73
    s_add_u32 s76, s76, 12288
    s_add_u32 s77, s76, 4096
    s_lshl_b32 s80, s62, 2
    s_add_u32 s80, s80, s73
    v_mov_b32 v8, 0
    v_rcp_f32 v176, v49
    v_rcp_f32 v177, v65
    v_rcp_f32 v178, v81
    v_rcp_f32 v179, v97
    v_mul_f32 v6, v48, v176
    v_fmac_f32_e64 v6, v64, v177
    v_add_f32 v6, 0x358637bd, v6
    v_mul_f32 v7, v80, v178
    v_fmac_f32 v7, v96, v179
    v_add_f32 v7, 0x358637bd, v7
    v_rcp_f32 v6, v6
    v_rcp_f32 v7, v7
    v_mul_f32 v176, v176, v6
    v_mul_f32 v177, v177, v6
    v_mul_f32 v178, v178, v7
    v_mul_f32 v179, v179, v7
    s_mov_b32 s88, 0
    s_branch L_kfirst_23
L_kr_24:
    buffer_load_dwordx4 v[32:35], v13, s[40:43], s78 offen offset:3072 sc1
    buffer_load_dwordx4 v[36:39], v13, s[40:43], s79 offen offset:3072 sc1
    buffer_load_dwordx4 v[40:43], v13, s[40:43], s78 offen offset:3200 sc1
    buffer_load_dwordx4 v[44:47], v13, s[40:43], s79 offen offset:3200 sc1
L_kfirst_23:
    s_waitcnt vmcnt(0)
    v_max3_u32 v9, v32, v33, v34
    v_max3_u32 v9, v9, v35, v36
    v_max3_u32 v9, v9, v37, v38
    v_max3_u32 v9, v9, v39, v40
    v_max3_u32 v9, v9, v41, v42
    v_max3_u32 v9, v9, v43, v44
    v_max3_u32 v9, v9, v45, v46
    v_max_u32 v9, v9, v47
    v_cmp_eq_u32 vcc, -1, v9
    s_nop 0
    s_cbranch_vccz L_ok_25
    s_add_u32 s88, s88, 1
    s_cmp_lt_u32 s88, 65536
    s_cbranch_scc1 L_kr_24
L_ok_25:
    v_mfma_f32_32x32x16_bf16 v[112:127], v[32:35], v[218:221], 0
    s_barrier
    v_mfma_f32_32x32x16_bf16 v[128:143], v[40:43], v[226:229], 0
    v_mfma_f32_32x32x16_bf16 v[112:127], v[36:39], v[222:225], v[112:127]
    v_mfma_f32_32x32x16_bf16 v[128:143], v[44:47], v[230:233], v[128:143]
    v_mfma_f32_32x32x16_bf16 v[144:159], v[32:35], v[234:237], 0
    v_mfma_f32_32x32x16_bf16 v[160:175], v[40:43], v[242:245], 0
    v_mfma_f32_32x32x16_bf16 v[144:159], v[36:39], v[238:241], v[144:159]
    v_mfma_f32_32x32x16_bf16 v[160:175], v[44:47], v[246:249], v[160:175]
    s_nop 6
    v_pk_mul_f32 v[112:113], v[112:113], v[176:177] op_sel_hi:[1,0]
    v_pk_fma_f32 v[112:113], v[128:129], v[176:177], v[112:113] op_sel:[0,1,0] op_sel_hi:[1,1,1]
    v_cvt_pk_bf16_f32 v48, v112, v113
    v_pk_mul_f32 v[114:115], v[114:115], v[176:177] op_sel_hi:[1,0]
    v_pk_fma_f32 v[114:115], v[130:131], v[176:177], v[114:115] op_sel:[0,1,0] op_sel_hi:[1,1,1]
    v_cvt_pk_bf16_f32 v49, v114, v115
    v_pk_mul_f32 v[116:117], v[116:117], v[176:177] op_sel_hi:[1,0]
    v_pk_fma_f32 v[116:117], v[132:133], v[176:177], v[116:117] op_sel:[0,1,0] op_sel_hi:[1,1,1]
    v_cvt_pk_bf16_f32 v50, v116, v117
    v_pk_mul_f32 v[118:119], v[118:119], v[176:177] op_sel_hi:[1,0]
    v_pk_fma_f32 v[118:119], v[134:135], v[176:177], v[118:119] op_sel:[0,1,0] op_sel_hi:[1,1,1]
    v_cvt_pk_bf16_f32 v51, v118, v119
    buffer_store_dwordx4 v[48:51], v12, s[40:43], s76 offen offset:0 sc1
    v_pk_mul_f32 v[120:121], v[120:121], v[176:177] op_sel_hi:[1,0]
    v_pk_fma_f32 v[120:121], v[136:137], v[176:177], v[120:121] op_sel:[0,1,0] op_sel_hi:[1,1,1]
    v_cvt_pk_bf16_f32 v52, v120, v121
    v_pk_mul_f32 v[122:123], v[122:123], v[176:177] op_sel_hi:[1,0]
    v_pk_fma_f32 v[122:123], v[138:139], v[176:177], v[122:123] op_sel:[0,1,0] op_sel_hi:[1,1,1]
    v_cvt_pk_bf16_f32 v53, v122, v123
    v_pk_mul_f32 v[124:125], v[124:125], v[176:177] op_sel_hi:[1,0]
    v_pk_fma_f32 v[124:125], v[140:141], v[176:177], v[124:125] op_sel:[0,1,0] op_sel_hi:[1,1,1]
    v_cvt_pk_bf16_f32 v54, v124, v125
    v_pk_mul_f32 v[126:127], v[126:127], v[176:177] op_sel_hi:[1,0]
    v_pk_fma_f32 v[126:127], v[142:143], v[176:177], v[126:127] op_sel:[0,1,0] op_sel_hi:[1,1,1]
    v_cvt_pk_bf16_f32 v55, v126, v127
    buffer_store_dwordx4 v[52:55], v12, s[40:43], s76 offen offset:1024 sc1
    v_pk_mul_f32 v[144:145], v[144:145], v[178:179] op_sel_hi:[1,0]
    v_pk_fma_f32 v[144:145], v[160:161], v[178:179], v[144:145] op_sel:[0,1,0] op_sel_hi:[1,1,1]
    v_cvt_pk_bf16_f32 v56, v144, v145
    v_pk_mul_f32 v[146:147], v[146:147], v[178:179] op_sel_hi:[1,0]
    v_pk_fma_f32 v[146:147], v[162:163], v[178:179], v[146:147] op_sel:[0,1,0] op_sel_hi:[1,1,1]
    v_cvt_pk_bf16_f32 v57, v146, v147
    v_pk_mul_f32 v[148:149], v[148:149], v[178:179] op_sel_hi:[1,0]
    v_pk_fma_f32 v[148:149], v[164:165], v[178:179], v[148:149] op_sel:[0,1,0] op_sel_hi:[1,1,1]
    v_cvt_pk_bf16_f32 v58, v148, v149
    v_pk_mul_f32 v[150:151], v[150:151], v[178:179] op_sel_hi:[1,0]
    v_pk_fma_f32 v[150:151], v[166:167], v[178:179], v[150:151] op_sel:[0,1,0] op_sel_hi:[1,1,1]
    v_cvt_pk_bf16_f32 v59, v150, v151
    buffer_store_dwordx4 v[56:59], v12, s[40:43], s77 offen offset:0 sc1
    v_pk_mul_f32 v[152:153], v[152:153], v[178:179] op_sel_hi:[1,0]
    v_pk_fma_f32 v[152:153], v[168:169], v[178:179], v[152:153] op_sel:[0,1,0] op_sel_hi:[1,1,1]
    v_cvt_pk_bf16_f32 v60, v152, v153
    v_pk_mul_f32 v[154:155], v[154:155], v[178:179] op_sel_hi:[1,0]
    v_pk_fma_f32 v[154:155], v[170:171], v[178:179], v[154:155] op_sel:[0,1,0] op_sel_hi:[1,1,1]
    v_cvt_pk_bf16_f32 v61, v154, v155
    v_pk_mul_f32 v[156:157], v[156:157], v[178:179] op_sel_hi:[1,0]
    v_pk_fma_f32 v[156:157], v[172:173], v[178:179], v[156:157] op_sel:[0,1,0] op_sel_hi:[1,1,1]
    v_cvt_pk_bf16_f32 v62, v156, v157
    v_pk_mul_f32 v[158:159], v[158:159], v[178:179] op_sel_hi:[1,0]
    v_pk_fma_f32 v[158:159], v[174:175], v[178:179], v[158:159] op_sel:[0,1,0] op_sel_hi:[1,1,1]
    v_cvt_pk_bf16_f32 v63, v158, v159
    buffer_store_dwordx4 v[60:63], v12, s[40:43], s77 offen offset:1024 sc1
    s_mov_b64 exec, 1
    buffer_store_dword v8, v8, s[40:43], s80 offen offset:2688 sc1
    s_mov_b64 exec, -1
    global_load_dwordx2 v[192:193], v4, s[14:15] offset:0
    global_load_dwordx2 v[194:195], v4, s[14:15] offset:16
    global_load_dwordx2 v[196:197], v4, s[14:15] offset:32
    global_load_dwordx2 v[198:199], v4, s[14:15] offset:48
    global_load_dwordx2 v[200:201], v4, s[14:15] offset:64
    global_load_dwordx2 v[202:203], v4, s[14:15] offset:80
    global_load_dwordx2 v[204:205], v4, s[14:15] offset:96
    global_load_dwordx2 v[206:207], v4, s[14:15] offset:112
    global_load_dwordx4 v[80:83], v5, s[14:15] offset:0
    global_load_dwordx4 v[84:87], v5, s[14:15] offset:16
    v_bfe_u32 v4, v2, 1, 3
    v_lshlrev_b32 v4, 4, v4
    v_lshl_add_u32 v4, v3, 3, v4
    v_lshl_add_u32 v4, v2, 7, v4
    s_lshl_b32 s76, s62, 12
    s_add_u32 s77, s76, 0
    v_add_u32 v64, s77, v4
    v_xor_b32 v65, 16, v64
    v_xor_b32 v66, 32, v64
    v_xor_b32 v67, 48, v64
    v_xor_b32_e64 v68, 64, v64
    v_xor_b32 v69, 80, v64
    v_xor_b32 v70, 96, v64
    v_xor_b32 v71, 112, v64
    v_bfe_u32 v4, v1, 2, 2
    v_lshl_add_u32 v5, v3, 2, v4
    v_lshlrev_b32 v5, 7, v5
    v_lshrrev_b32 v4, 1, v4
    v_lshl_add_u32 v5, v4, 6, v5
    v_bfe_u32 v4, v1, 4, 1
    v_lshl_add_u32 v5, v4, 5, v5
    v_and_b32_e64 v4, 3, v1
    v_lshl_add_u32 v5, v4, 3, v5
    v_add_u32 v72, 32768, v5
    v_xor_b32_e64 v73, 64, v72
    v_add_u32 v74, 65536, v72
    v_add_u32 v75, 65536, v73
    v_and_b32_e64 v6, 15, v1
    v_mul_u32_u24 v6, 28800, v6
    v_bfe_u32 v4, v1, 4, 1
    v_lshl_add_u32 v6, v4, 3, v6
    s_mul_i32 s80, s97, 460800
    s_lshl_b32 s77, s64, 2
    s_add_u32 s77, s77, s80
    s_add_u32 s80, s80, s76
    s_add_u32 s80, s80, 12288
    s_barrier
    ds_read_b64 v[88:89], v64
    ds_read_b64 v[90:91], v65
    ds_read_b64 v[92:93], v66
    ds_read_b64 v[94:95], v67
    ds_read_b64 v[96:97], v68
    ds_read_b64 v[98:99], v69
    ds_read_b64 v[100:101], v70
    ds_read_b64 v[102:103], v71
    s_mov_b32 s88, 0
L_spin_26:
    buffer_load_dword v4, v6, s[40:43], s77 offen offset:2688 sc1
    s_waitcnt vmcnt(0)
    v_cmp_eq_u32 vcc, -1, v4
    s_nop 0
    s_cbranch_vccz L_ok_27
    s_add_u32 s88, s88, 1
    s_cmp_lt_u32 s88, 65536
    s_cbranch_scc1 L_spin_26
L_ok_27:
    s_mov_b32 s88, 0
L_g2:
    s_add_u32 s76, s65, 0
    s_and_b32 s76, s76, 15
    s_mul_i32 s76, s76, 28800
    s_add_u32 s76, s76, s80
    buffer_load_dwordx4 v[128:131], v12, s[40:43], s76 offen offset:0 sc1
    buffer_load_dwordx4 v[132:135], v12, s[40:43], s76 offen offset:1024 sc1
    buffer_load_dwordx4 v[136:139], v12, s[40:43], s76 offen offset:2048 sc1
    buffer_load_dwordx4 v[140:143], v12, s[40:43], s76 offen offset:3072 sc1
    s_add_u32 s76, s65, 1
    s_and_b32 s76, s76, 15
    s_mul_i32 s76, s76, 28800
    s_add_u32 s76, s76, s80
    buffer_load_dwordx4 v[144:147], v12, s[40:43], s76 offen offset:0 sc1
    buffer_load_dwordx4 v[148:151], v12, s[40:43], s76 offen offset:1024 sc1
    buffer_load_dwordx4 v[152:155], v12, s[40:43], s76 offen offset:2048 sc1
    buffer_load_dwordx4 v[156:159], v12, s[40:43], s76 offen offset:3072 sc1
    s_add_u32 s76, s65, 2
    s_and_b32 s76, s76, 15
    s_mul_i32 s76, s76, 28800
    s_add_u32 s76, s76, s80
    buffer_load_dwordx4 v[160:163], v12, s[40:43], s76 offen offset:0 sc1
    buffer_load_dwordx4 v[164:167], v12, s[40:43], s76 offen offset:1024 sc1
    buffer_load_dwordx4 v[168:171], v12, s[40:43], s76 offen offset:2048 sc1
    buffer_load_dwordx4 v[172:175], v12, s[40:43], s76 offen offset:3072 sc1
    v_dot2_f32_bf16 v76, v80, s89, 0
    v_dot2_f32_bf16 v76, v81, s89, v76
    v_dot2_f32_bf16 v76, v82, s89, v76
    v_dot2_f32_bf16 v76, v83, s89, v76
    v_dot2_f32_bf16 v76, v84, s89, v76
    v_dot2_f32_bf16 v76, v85, s89, v76
    v_dot2_f32_bf16 v76, v86, s89, v76
    v_dot2_f32_bf16 v76, v87, s89, v76
    s_waitcnt lgkmcnt(0)
    ds_read_b64_tr_b16 v[104:105], v72 offset:24576
    ds_read_b64_tr_b16 v[106:107], v72 offset:25600
    ds_read_b64_tr_b16 v[108:109], v73 offset:24576
    ds_read_b64_tr_b16 v[110:111], v73 offset:25600
    ds_read_b64_tr_b16 v[112:113], v72 offset:26624
    ds_read_b64_tr_b16 v[114:115], v72 offset:27648
    ds_read_b64_tr_b16 v[116:117], v73 offset:26624
    ds_read_b64_tr_b16 v[118:119], v73 offset:27648
    v_lshlrev_b32 v16, 16, v88
    v_and_b32 v17, s90, v88
    v_lshlrev_b32 v18, 16, v89
    v_and_b32 v19, s90, v89
    v_lshlrev_b32 v20, 16, v90
    v_and_b32 v21, s90, v90
    v_lshlrev_b32 v22, 16, v91
    v_and_b32 v23, s90, v91
    v_lshlrev_b32 v24, 16, v92
    v_and_b32 v25, s90, v92
    v_lshlrev_b32 v26, 16, v93
    v_and_b32 v27, s90, v93
    v_lshlrev_b32 v28, 16, v94
    v_and_b32 v29, s90, v94
    v_lshlrev_b32 v30, 16, v95
    v_and_b32 v31, s90, v95
    v_lshlrev_b32 v32, 16, v96
    v_and_b32 v33, s90, v96
    v_lshlrev_b32 v34, 16, v97
    v_and_b32 v35, s90, v97
    v_lshlrev_b32 v36, 16, v98
    v_and_b32 v37, s90, v98
    v_lshlrev_b32 v38, 16, v99
    v_and_b32 v39, s90, v99
    v_lshlrev_b32 v40, 16, v100
    v_and_b32 v41, s90, v100
    v_lshlrev_b32 v42, 16, v101
    v_and_b32 v43, s90, v101
    v_lshlrev_b32 v44, 16, v102
    v_and_b32 v45, s90, v102
    v_lshlrev_b32 v46, 16, v103
    v_and_b32 v47, s90, v103
    v_add_f32_dpp v76, v76, v76 row_ror:8 row_mask:0xf bank_mask:0xf
    s_nop 1
    v_add_f32_dpp v76, v76, v76 row_ror:4 row_mask:0xf bank_mask:0xf
    s_nop 1
    v_add_f32_dpp v76, v76, v76 row_ror:2 row_mask:0xf bank_mask:0xf
    s_nop 1
    v_add_f32_dpp v76, v76, v76 row_ror:1 row_mask:0xf bank_mask:0xf
    v_mov_b32 v4, v76
    v_mov_b32 v77, 0
    s_nop 0
    v_permlane16_swap_b32 v76, v4
    v_add_f32 v76, v76, v4
    v_mov_b32 v4, v76
    s_nop 1
    v_permlane32_swap_b32 v76, v4
    v_add_f32_e64 v76, v76, v4
    s_waitcnt vmcnt(11) lgkmcnt(4)
    v_mfma_f32_32x32x16_bf16 v[16:31], v[104:107], v[128:131], v[16:31]
    ds_read_b64_tr_b16 v[120:121], v72 offset:28672
    ds_read_b64_tr_b16 v[122:123], v72 offset:29696
    s_add_u32 s76, s65, 3
    s_and_b32 s76, s76, 15
    s_mul_i32 s76, s76, 28800
    s_add_u32 s76, s76, s80
    buffer_load_dwordx4 v[176:179], v12, s[40:43], s76 offen offset:0 sc1
    v_mfma_f32_32x32x16_bf16 v[32:47], v[108:111], v[128:131], v[32:47]
    ds_read_b64_tr_b16 v[124:125], v73 offset:28672
    ds_read_b64_tr_b16 v[126:127], v73 offset:29696
    v_max_u32_e64 v77, v77, v128
    s_waitcnt vmcnt(11) lgkmcnt(4)
    v_mfma_f32_32x32x16_bf16 v[16:31], v[112:115], v[132:135], v[16:31]
    ds_read_b64_tr_b16 v[104:105], v72 offset:30720
    ds_read_b64_tr_b16 v[106:107], v72 offset:31744
    buffer_load_dwordx4 v[180:183], v12, s[40:43], s76 offen offset:1024 sc1
    v_mfma_f32_32x32x16_bf16 v[32:47], v[116:119], v[132:135], v[32:47]
    ds_read_b64_tr_b16 v[108:109], v73 offset:30720
    ds_read_b64_tr_b16 v[110:111], v73 offset:31744
    v_max_u32 v77, v77, v132
    s_waitcnt vmcnt(11) lgkmcnt(4)
    v_mfma_f32_32x32x16_bf16 v[16:31], v[120:123], v[136:139], v[16:31]
    ds_read_b64_tr_b16 v[112:113], v72 offset:32768
    ds_read_b64_tr_b16 v[114:115], v72 offset:33792
    buffer_load_dwordx4 v[184:187], v12, s[40:43], s76 offen offset:2048 sc1
    v_mfma_f32_32x32x16_bf16 v[32:47], v[124:127], v[136:139], v[32:47]
    ds_read_b64_tr_b16 v[116:117], v73 offset:32768
    ds_read_b64_tr_b16 v[118:119], v73 offset:33792
    v_max_u32 v77, v77, v136
    s_waitcnt vmcnt(11) lgkmcnt(4)
    v_mfma_f32_32x32x16_bf16 v[16:31], v[104:107], v[140:143], v[16:31]
    ds_read_b64_tr_b16 v[120:121], v72 offset:34816
    ds_read_b64_tr_b16 v[122:123], v72 offset:35840
    buffer_load_dwordx4 v[188:191], v12, s[40:43], s76 offen offset:3072 sc1
    v_mfma_f32_32x32x16_bf16 v[32:47], v[108:111], v[140:143], v[32:47]
    ds_read_b64_tr_b16 v[124:125], v73 offset:34816
    ds_read_b64_tr_b16 v[126:127], v73 offset:35840
    v_max_u32 v77, v77, v140
    s_waitcnt vmcnt(11) lgkmcnt(4)
    v_mfma_f32_32x32x16_bf16 v[16:31], v[112:115], v[144:147], v[16:31]
    ds_read_b64_tr_b16 v[104:105], v72 offset:36864
    ds_read_b64_tr_b16 v[106:107], v72 offset:37888
    s_add_u32 s76, s65, 4
    s_and_b32 s76, s76, 15
    s_mul_i32 s76, s76, 28800
    s_add_u32 s76, s76, s80
    buffer_load_dwordx4 v[128:131], v12, s[40:43], s76 offen offset:0 sc1
    v_mfma_f32_32x32x16_bf16 v[32:47], v[116:119], v[144:147], v[32:47]
    ds_read_b64_tr_b16 v[108:109], v73 offset:36864
    ds_read_b64_tr_b16 v[110:111], v73 offset:37888
    v_max_u32_e64 v77, v77, v144
    s_waitcnt vmcnt(11) lgkmcnt(4)
    v_mfma_f32_32x32x16_bf16 v[16:31], v[120:123], v[148:151], v[16:31]
    ds_read_b64_tr_b16 v[112:113], v72 offset:38912
    ds_read_b64_tr_b16 v[114:115], v72 offset:39936
    buffer_load_dwordx4 v[132:135], v12, s[40:43], s76 offen offset:1024 sc1
    v_mfma_f32_32x32x16_bf16 v[32:47], v[124:127], v[148:151], v[32:47]
    ds_read_b64_tr_b16 v[116:117], v73 offset:38912
    ds_read_b64_tr_b16 v[118:119], v73 offset:39936
    v_max_u32 v77, v77, v148
    s_waitcnt vmcnt(11) lgkmcnt(4)
    v_mfma_f32_32x32x16_bf16 v[16:31], v[104:107], v[152:155], v[16:31]
    ds_read_b64_tr_b16 v[120:121], v72 offset:40960
    ds_read_b64_tr_b16 v[122:123], v72 offset:41984
    buffer_load_dwordx4 v[136:139], v12, s[40:43], s76 offen offset:2048 sc1
    v_mfma_f32_32x32x16_bf16 v[32:47], v[108:111], v[152:155], v[32:47]
    ds_read_b64_tr_b16 v[124:125], v73 offset:40960
    ds_read_b64_tr_b16 v[126:127], v73 offset:41984
    v_max_u32 v77, v77, v152
    s_waitcnt vmcnt(11) lgkmcnt(4)
    v_mfma_f32_32x32x16_bf16 v[16:31], v[112:115], v[156:159], v[16:31]
    ds_read_b64_tr_b16 v[104:105], v72 offset:43008
    ds_read_b64_tr_b16 v[106:107], v72 offset:44032
    buffer_load_dwordx4 v[140:143], v12, s[40:43], s76 offen offset:3072 sc1
    v_mfma_f32_32x32x16_bf16 v[32:47], v[116:119], v[156:159], v[32:47]
    ds_read_b64_tr_b16 v[108:109], v73 offset:43008
    ds_read_b64_tr_b16 v[110:111], v73 offset:44032
    v_max_u32 v77, v77, v156
    s_waitcnt vmcnt(11) lgkmcnt(4)
    v_mfma_f32_32x32x16_bf16 v[16:31], v[120:123], v[160:163], v[16:31]
    ds_read_b64_tr_b16 v[112:113], v72 offset:45056
    ds_read_b64_tr_b16 v[114:115], v72 offset:46080
    s_add_u32 s76, s65, 5
    s_and_b32 s76, s76, 15
    s_mul_i32 s76, s76, 28800
    s_add_u32 s76, s76, s80
    buffer_load_dwordx4 v[144:147], v12, s[40:43], s76 offen offset:0 sc1
    v_mfma_f32_32x32x16_bf16 v[32:47], v[124:127], v[160:163], v[32:47]
    ds_read_b64_tr_b16 v[116:117], v73 offset:45056
    ds_read_b64_tr_b16 v[118:119], v73 offset:46080
    v_max_u32_e64 v77, v77, v160
    s_waitcnt vmcnt(11) lgkmcnt(4)
    v_mfma_f32_32x32x16_bf16 v[16:31], v[104:107], v[164:167], v[16:31]
    ds_read_b64_tr_b16 v[120:121], v72 offset:47104
    ds_read_b64_tr_b16 v[122:123], v72 offset:48128
    buffer_load_dwordx4 v[148:151], v12, s[40:43], s76 offen offset:1024 sc1
    v_mfma_f32_32x32x16_bf16 v[32:47], v[108:111], v[164:167], v[32:47]
    ds_read_b64_tr_b16 v[124:125], v73 offset:47104
    ds_read_b64_tr_b16 v[126:127], v73 offset:48128
    v_max_u32 v77, v77, v164
    s_waitcnt vmcnt(11) lgkmcnt(4)
    v_mfma_f32_32x32x16_bf16 v[16:31], v[112:115], v[168:171], v[16:31]
    ds_read_b64_tr_b16 v[104:105], v72 offset:49152
    ds_read_b64_tr_b16 v[106:107], v72 offset:50176
    buffer_load_dwordx4 v[152:155], v12, s[40:43], s76 offen offset:2048 sc1
    v_mfma_f32_32x32x16_bf16 v[32:47], v[116:119], v[168:171], v[32:47]
    ds_read_b64_tr_b16 v[108:109], v73 offset:49152
    ds_read_b64_tr_b16 v[110:111], v73 offset:50176
    v_max_u32 v77, v77, v168
    s_waitcnt vmcnt(11) lgkmcnt(4)
    v_mfma_f32_32x32x16_bf16 v[16:31], v[120:123], v[172:175], v[16:31]
    ds_read_b64_tr_b16 v[112:113], v72 offset:51200
    ds_read_b64_tr_b16 v[114:115], v72 offset:52224
    buffer_load_dwordx4 v[156:159], v12, s[40:43], s76 offen offset:3072 sc1
    v_mfma_f32_32x32x16_bf16 v[32:47], v[124:127], v[172:175], v[32:47]
    ds_read_b64_tr_b16 v[116:117], v73 offset:51200
    ds_read_b64_tr_b16 v[118:119], v73 offset:52224
    v_max_u32 v77, v77, v172
    s_waitcnt vmcnt(11) lgkmcnt(4)
    v_mfma_f32_32x32x16_bf16 v[16:31], v[104:107], v[176:179], v[16:31]
    ds_read_b64_tr_b16 v[120:121], v72 offset:53248
    ds_read_b64_tr_b16 v[122:123], v72 offset:54272
    s_add_u32 s76, s65, 6
    s_and_b32 s76, s76, 15
    s_mul_i32 s76, s76, 28800
    s_add_u32 s76, s76, s80
    buffer_load_dwordx4 v[160:163], v12, s[40:43], s76 offen offset:0 sc1
    v_mfma_f32_32x32x16_bf16 v[32:47], v[108:111], v[176:179], v[32:47]
    ds_read_b64_tr_b16 v[124:125], v73 offset:53248
    ds_read_b64_tr_b16 v[126:127], v73 offset:54272
    v_max_u32_e64 v77, v77, v176
    s_waitcnt vmcnt(11) lgkmcnt(4)
    v_mfma_f32_32x32x16_bf16 v[16:31], v[112:115], v[180:183], v[16:31]
    ds_read_b64_tr_b16 v[104:105], v72 offset:55296
    ds_read_b64_tr_b16 v[106:107], v72 offset:56320
    buffer_load_dwordx4 v[164:167], v12, s[40:43], s76 offen offset:1024 sc1
    v_mfma_f32_32x32x16_bf16 v[32:47], v[116:119], v[180:183], v[32:47]
    ds_read_b64_tr_b16 v[108:109], v73 offset:55296
    ds_read_b64_tr_b16 v[110:111], v73 offset:56320
    v_max_u32 v77, v77, v180
    s_waitcnt vmcnt(11) lgkmcnt(4)
    v_mfma_f32_32x32x16_bf16 v[16:31], v[120:123], v[184:187], v[16:31]
    ds_read_b64_tr_b16 v[112:113], v72 offset:57344
    ds_read_b64_tr_b16 v[114:115], v72 offset:58368
    buffer_load_dwordx4 v[168:171], v12, s[40:43], s76 offen offset:2048 sc1
    v_mfma_f32_32x32x16_bf16 v[32:47], v[124:127], v[184:187], v[32:47]
    ds_read_b64_tr_b16 v[116:117], v73 offset:57344
    ds_read_b64_tr_b16 v[118:119], v73 offset:58368
    v_max_u32 v77, v77, v184
    s_waitcnt vmcnt(11) lgkmcnt(4)
    v_mfma_f32_32x32x16_bf16 v[16:31], v[104:107], v[188:191], v[16:31]
    ds_read_b64_tr_b16 v[120:121], v72 offset:59392
    ds_read_b64_tr_b16 v[122:123], v72 offset:60416
    buffer_load_dwordx4 v[172:175], v12, s[40:43], s76 offen offset:3072 sc1
    v_mfma_f32_32x32x16_bf16 v[32:47], v[108:111], v[188:191], v[32:47]
    ds_read_b64_tr_b16 v[124:125], v73 offset:59392
    ds_read_b64_tr_b16 v[126:127], v73 offset:60416
    v_max_u32 v77, v77, v188
    s_waitcnt vmcnt(11) lgkmcnt(4)
    v_mfma_f32_32x32x16_bf16 v[16:31], v[112:115], v[128:131], v[16:31]
    ds_read_b64_tr_b16 v[104:105], v72 offset:61440
    ds_read_b64_tr_b16 v[106:107], v72 offset:62464
    s_add_u32 s76, s65, 7
    s_and_b32 s76, s76, 15
    s_mul_i32 s76, s76, 28800
    s_add_u32 s76, s76, s80
    buffer_load_dwordx4 v[176:179], v12, s[40:43], s76 offen offset:0 sc1
    v_mfma_f32_32x32x16_bf16 v[32:47], v[116:119], v[128:131], v[32:47]
    ds_read_b64_tr_b16 v[108:109], v73 offset:61440
    ds_read_b64_tr_b16 v[110:111], v73 offset:62464
    v_max_u32_e64 v77, v77, v128
    s_waitcnt vmcnt(11) lgkmcnt(4)
    v_mfma_f32_32x32x16_bf16 v[16:31], v[120:123], v[132:135], v[16:31]
    ds_read_b64_tr_b16 v[112:113], v72 offset:63488
    ds_read_b64_tr_b16 v[114:115], v72 offset:64512
    buffer_load_dwordx4 v[180:183], v12, s[40:43], s76 offen offset:1024 sc1
    v_mfma_f32_32x32x16_bf16 v[32:47], v[124:127], v[132:135], v[32:47]
    ds_read_b64_tr_b16 v[116:117], v73 offset:63488
    ds_read_b64_tr_b16 v[118:119], v73 offset:64512
    v_max_u32 v77, v77, v132
    s_waitcnt vmcnt(11) lgkmcnt(4)
    v_mfma_f32_32x32x16_bf16 v[16:31], v[104:107], v[136:139], v[16:31]
    ds_read_b64_tr_b16 v[120:121], v74 offset:0
    ds_read_b64_tr_b16 v[122:123], v74 offset:1024
    buffer_load_dwordx4 v[184:187], v12, s[40:43], s76 offen offset:2048 sc1
    v_mfma_f32_32x32x16_bf16 v[32:47], v[108:111], v[136:139], v[32:47]
    ds_read_b64_tr_b16 v[124:125], v75 offset:0
    ds_read_b64_tr_b16 v[126:127], v75 offset:1024
    v_max_u32 v77, v77, v136
    s_waitcnt vmcnt(11) lgkmcnt(4)
    v_mfma_f32_32x32x16_bf16 v[16:31], v[112:115], v[140:143], v[16:31]
    ds_read_b64_tr_b16 v[104:105], v74 offset:2048
    ds_read_b64_tr_b16 v[106:107], v74 offset:3072
    buffer_load_dwordx4 v[188:191], v12, s[40:43], s76 offen offset:3072 sc1
    v_mfma_f32_32x32x16_bf16 v[32:47], v[116:119], v[140:143], v[32:47]
    ds_read_b64_tr_b16 v[108:109], v75 offset:2048
    ds_read_b64_tr_b16 v[110:111], v75 offset:3072
    v_max_u32 v77, v77, v140
    s_waitcnt vmcnt(11) lgkmcnt(4)
    v_mfma_f32_32x32x16_bf16 v[16:31], v[120:123], v[144:147], v[16:31]
    ds_read_b64_tr_b16 v[112:113], v74 offset:4096
    ds_read_b64_tr_b16 v[114:115], v74 offset:5120
    s_add_u32 s76, s65, 8
    s_and_b32 s76, s76, 15
    s_mul_i32 s76, s76, 28800
    s_add_u32 s76, s76, s80
    buffer_load_dwordx4 v[128:131], v12, s[40:43], s76 offen offset:0 sc1
    v_mfma_f32_32x32x16_bf16 v[32:47], v[124:127], v[144:147], v[32:47]
    ds_read_b64_tr_b16 v[116:117], v75 offset:4096
    ds_read_b64_tr_b16 v[118:119], v75 offset:5120
    v_max_u32_e64 v77, v77, v144
    s_waitcnt vmcnt(11) lgkmcnt(4)
    v_mfma_f32_32x32x16_bf16 v[16:31], v[104:107], v[148:151], v[16:31]
    ds_read_b64_tr_b16 v[120:121], v74 offset:6144
    ds_read_b64_tr_b16 v[122:123], v74 offset:7168
    buffer_load_dwordx4 v[132:135], v12, s[40:43], s76 offen offset:1024 sc1
    v_mfma_f32_32x32x16_bf16 v[32:47], v[108:111], v[148:151], v[32:47]
    ds_read_b64_tr_b16 v[124:125], v75 offset:6144
    ds_read_b64_tr_b16 v[126:127], v75 offset:7168
    v_max_u32 v77, v77, v148
    s_waitcnt vmcnt(11) lgkmcnt(4)
    v_mfma_f32_32x32x16_bf16 v[16:31], v[112:115], v[152:155], v[16:31]
    ds_read_b64_tr_b16 v[104:105], v74 offset:8192
    ds_read_b64_tr_b16 v[106:107], v74 offset:9216
    buffer_load_dwordx4 v[136:139], v12, s[40:43], s76 offen offset:2048 sc1
    v_mfma_f32_32x32x16_bf16 v[32:47], v[116:119], v[152:155], v[32:47]
    ds_read_b64_tr_b16 v[108:109], v75 offset:8192
    ds_read_b64_tr_b16 v[110:111], v75 offset:9216
    v_max_u32 v77, v77, v152
    s_waitcnt vmcnt(11) lgkmcnt(4)
    v_mfma_f32_32x32x16_bf16 v[16:31], v[120:123], v[156:159], v[16:31]
    ds_read_b64_tr_b16 v[112:113], v74 offset:10240
    ds_read_b64_tr_b16 v[114:115], v74 offset:11264
    buffer_load_dwordx4 v[140:143], v12, s[40:43], s76 offen offset:3072 sc1
    v_mfma_f32_32x32x16_bf16 v[32:47], v[124:127], v[156:159], v[32:47]
    ds_read_b64_tr_b16 v[116:117], v75 offset:10240
    ds_read_b64_tr_b16 v[118:119], v75 offset:11264
    v_max_u32 v77, v77, v156
    s_waitcnt vmcnt(11) lgkmcnt(4)
    v_mfma_f32_32x32x16_bf16 v[16:31], v[104:107], v[160:163], v[16:31]
    ds_read_b64_tr_b16 v[120:121], v74 offset:12288
    ds_read_b64_tr_b16 v[122:123], v74 offset:13312
    s_add_u32 s76, s65, 9
    s_and_b32 s76, s76, 15
    s_mul_i32 s76, s76, 28800
    s_add_u32 s76, s76, s80
    buffer_load_dwordx4 v[144:147], v12, s[40:43], s76 offen offset:0 sc1
    v_mfma_f32_32x32x16_bf16 v[32:47], v[108:111], v[160:163], v[32:47]
    ds_read_b64_tr_b16 v[124:125], v75 offset:12288
    ds_read_b64_tr_b16 v[126:127], v75 offset:13312
    v_max_u32_e64 v77, v77, v160
    s_waitcnt vmcnt(11) lgkmcnt(4)
    v_mfma_f32_32x32x16_bf16 v[16:31], v[112:115], v[164:167], v[16:31]
    ds_read_b64_tr_b16 v[104:105], v74 offset:14336
    ds_read_b64_tr_b16 v[106:107], v74 offset:15360
    buffer_load_dwordx4 v[148:151], v12, s[40:43], s76 offen offset:1024 sc1
    v_mfma_f32_32x32x16_bf16 v[32:47], v[116:119], v[164:167], v[32:47]
    ds_read_b64_tr_b16 v[108:109], v75 offset:14336
    ds_read_b64_tr_b16 v[110:111], v75 offset:15360
    v_max_u32 v77, v77, v164
    s_waitcnt vmcnt(11) lgkmcnt(4)
    v_mfma_f32_32x32x16_bf16 v[16:31], v[120:123], v[168:171], v[16:31]
    ds_read_b64_tr_b16 v[112:113], v74 offset:16384
    ds_read_b64_tr_b16 v[114:115], v74 offset:17408
    buffer_load_dwordx4 v[152:155], v12, s[40:43], s76 offen offset:2048 sc1
    v_mfma_f32_32x32x16_bf16 v[32:47], v[124:127], v[168:171], v[32:47]
    ds_read_b64_tr_b16 v[116:117], v75 offset:16384
    ds_read_b64_tr_b16 v[118:119], v75 offset:17408
    v_max_u32 v77, v77, v168
    s_waitcnt vmcnt(11) lgkmcnt(4)
    v_mfma_f32_32x32x16_bf16 v[16:31], v[104:107], v[172:175], v[16:31]
    ds_read_b64_tr_b16 v[120:121], v74 offset:18432
    ds_read_b64_tr_b16 v[122:123], v74 offset:19456
    buffer_load_dwordx4 v[156:159], v12, s[40:43], s76 offen offset:3072 sc1
    v_mfma_f32_32x32x16_bf16 v[32:47], v[108:111], v[172:175], v[32:47]
    ds_read_b64_tr_b16 v[124:125], v75 offset:18432
    ds_read_b64_tr_b16 v[126:127], v75 offset:19456
    v_max_u32 v77, v77, v172
    s_waitcnt vmcnt(11) lgkmcnt(4)
    v_mfma_f32_32x32x16_bf16 v[16:31], v[112:115], v[176:179], v[16:31]
    ds_read_b64_tr_b16 v[104:105], v74 offset:20480
    ds_read_b64_tr_b16 v[106:107], v74 offset:21504
    s_add_u32 s76, s65, 10
    s_and_b32 s76, s76, 15
    s_mul_i32 s76, s76, 28800
    s_add_u32 s76, s76, s80
    buffer_load_dwordx4 v[160:163], v12, s[40:43], s76 offen offset:0 sc1
    v_mfma_f32_32x32x16_bf16 v[32:47], v[116:119], v[176:179], v[32:47]
    ds_read_b64_tr_b16 v[108:109], v75 offset:20480
    ds_read_b64_tr_b16 v[110:111], v75 offset:21504
    v_max_u32_e64 v77, v77, v176
    s_waitcnt vmcnt(11) lgkmcnt(4)
    v_mfma_f32_32x32x16_bf16 v[16:31], v[120:123], v[180:183], v[16:31]
    ds_read_b64_tr_b16 v[112:113], v74 offset:22528
    ds_read_b64_tr_b16 v[114:115], v74 offset:23552
    buffer_load_dwordx4 v[164:167], v12, s[40:43], s76 offen offset:1024 sc1
    v_mfma_f32_32x32x16_bf16 v[32:47], v[124:127], v[180:183], v[32:47]
    ds_read_b64_tr_b16 v[116:117], v75 offset:22528
    ds_read_b64_tr_b16 v[118:119], v75 offset:23552
    v_max_u32 v77, v77, v180
    s_waitcnt vmcnt(11) lgkmcnt(4)
    v_mfma_f32_32x32x16_bf16 v[16:31], v[104:107], v[184:187], v[16:31]
    ds_read_b64_tr_b16 v[120:121], v74 offset:24576
    ds_read_b64_tr_b16 v[122:123], v74 offset:25600
    buffer_load_dwordx4 v[168:171], v12, s[40:43], s76 offen offset:2048 sc1
    v_mfma_f32_32x32x16_bf16 v[32:47], v[108:111], v[184:187], v[32:47]
    ds_read_b64_tr_b16 v[124:125], v75 offset:24576
    ds_read_b64_tr_b16 v[126:127], v75 offset:25600
    v_max_u32 v77, v77, v184
    s_waitcnt vmcnt(11) lgkmcnt(4)
    v_mfma_f32_32x32x16_bf16 v[16:31], v[112:115], v[188:191], v[16:31]
    ds_read_b64_tr_b16 v[104:105], v74 offset:26624
    ds_read_b64_tr_b16 v[106:107], v74 offset:27648
    buffer_load_dwordx4 v[172:175], v12, s[40:43], s76 offen offset:3072 sc1
    v_mfma_f32_32x32x16_bf16 v[32:47], v[116:119], v[188:191], v[32:47]
    ds_read_b64_tr_b16 v[108:109], v75 offset:26624
    ds_read_b64_tr_b16 v[110:111], v75 offset:27648
    v_max_u32 v77, v77, v188
    s_waitcnt vmcnt(11) lgkmcnt(4)
    v_mfma_f32_32x32x16_bf16 v[16:31], v[120:123], v[128:131], v[16:31]
    ds_read_b64_tr_b16 v[112:113], v74 offset:28672
    ds_read_b64_tr_b16 v[114:115], v74 offset:29696
    s_add_u32 s76, s65, 11
    s_and_b32 s76, s76, 15
    s_mul_i32 s76, s76, 28800
    s_add_u32 s76, s76, s80
    buffer_load_dwordx4 v[176:179], v12, s[40:43], s76 offen offset:0 sc1
    v_mfma_f32_32x32x16_bf16 v[32:47], v[124:127], v[128:131], v[32:47]
    ds_read_b64_tr_b16 v[116:117], v75 offset:28672
    ds_read_b64_tr_b16 v[118:119], v75 offset:29696
    v_max_u32_e64 v77, v77, v128
    s_waitcnt vmcnt(11) lgkmcnt(4)
    v_mfma_f32_32x32x16_bf16 v[16:31], v[104:107], v[132:135], v[16:31]
    ds_read_b64_tr_b16 v[120:121], v74 offset:30720
    ds_read_b64_tr_b16 v[122:123], v74 offset:31744
    buffer_load_dwordx4 v[180:183], v12, s[40:43], s76 offen offset:1024 sc1
    v_mfma_f32_32x32x16_bf16 v[32:47], v[108:111], v[132:135], v[32:47]
    ds_read_b64_tr_b16 v[124:125], v75 offset:30720
    ds_read_b64_tr_b16 v[126:127], v75 offset:31744
    v_max_u32 v77, v77, v132
    s_waitcnt vmcnt(11) lgkmcnt(4)
    v_mfma_f32_32x32x16_bf16 v[16:31], v[112:115], v[136:139], v[16:31]
    ds_read_b64_tr_b16 v[104:105], v74 offset:32768
    ds_read_b64_tr_b16 v[106:107], v74 offset:33792
    buffer_load_dwordx4 v[184:187], v12, s[40:43], s76 offen offset:2048 sc1
    v_mfma_f32_32x32x16_bf16 v[32:47], v[116:119], v[136:139], v[32:47]
    ds_read_b64_tr_b16 v[108:109], v75 offset:32768
    ds_read_b64_tr_b16 v[110:111], v75 offset:33792
    v_max_u32 v77, v77, v136
    s_waitcnt vmcnt(11) lgkmcnt(4)
    v_mfma_f32_32x32x16_bf16 v[16:31], v[120:123], v[140:143], v[16:31]
    ds_read_b64_tr_b16 v[112:113], v74 offset:34816
    ds_read_b64_tr_b16 v[114:115], v74 offset:35840
    buffer_load_dwordx4 v[188:191], v12, s[40:43], s76 offen offset:3072 sc1
    v_mfma_f32_32x32x16_bf16 v[32:47], v[124:127], v[140:143], v[32:47]
    ds_read_b64_tr_b16 v[116:117], v75 offset:34816
    ds_read_b64_tr_b16 v[118:119], v75 offset:35840
    v_max_u32 v77, v77, v140
    s_waitcnt vmcnt(11) lgkmcnt(4)
    v_mfma_f32_32x32x16_bf16 v[16:31], v[104:107], v[144:147], v[16:31]
    ds_read_b64_tr_b16 v[120:121], v74 offset:36864
    ds_read_b64_tr_b16 v[122:123], v74 offset:37888
    s_add_u32 s76, s65, 12
    s_and_b32 s76, s76, 15
    s_mul_i32 s76, s76, 28800
    s_add_u32 s76, s76, s80
    buffer_load_dwordx4 v[128:131], v12, s[40:43], s76 offen offset:0 sc1
    v_mfma_f32_32x32x16_bf16 v[32:47], v[108:111], v[144:147], v[32:47]
    ds_read_b64_tr_b16 v[124:125], v75 offset:36864
    ds_read_b64_tr_b16 v[126:127], v75 offset:37888
    v_max_u32_e64 v77, v77, v144
    s_waitcnt vmcnt(11) lgkmcnt(4)
    v_mfma_f32_32x32x16_bf16 v[16:31], v[112:115], v[148:151], v[16:31]
    ds_read_b64_tr_b16 v[104:105], v74 offset:38912
    ds_read_b64_tr_b16 v[106:107], v74 offset:39936
    buffer_load_dwordx4 v[132:135], v12, s[40:43], s76 offen offset:1024 sc1
    v_mfma_f32_32x32x16_bf16 v[32:47], v[116:119], v[148:151], v[32:47]
    ds_read_b64_tr_b16 v[108:109], v75 offset:38912
    ds_read_b64_tr_b16 v[110:111], v75 offset:39936
    v_max_u32 v77, v77, v148
    s_waitcnt vmcnt(11) lgkmcnt(4)
    v_mfma_f32_32x32x16_bf16 v[16:31], v[120:123], v[152:155], v[16:31]
    ds_read_b64_tr_b16 v[112:113], v74 offset:40960
    ds_read_b64_tr_b16 v[114:115], v74 offset:41984
    buffer_load_dwordx4 v[136:139], v12, s[40:43], s76 offen offset:2048 sc1
    v_mfma_f32_32x32x16_bf16 v[32:47], v[124:127], v[152:155], v[32:47]
    ds_read_b64_tr_b16 v[116:117], v75 offset:40960
    ds_read_b64_tr_b16 v[118:119], v75 offset:41984
    v_max_u32 v77, v77, v152
    s_waitcnt vmcnt(11) lgkmcnt(4)
    v_mfma_f32_32x32x16_bf16 v[16:31], v[104:107], v[156:159], v[16:31]
    ds_read_b64_tr_b16 v[120:121], v74 offset:43008
    ds_read_b64_tr_b16 v[122:123], v74 offset:44032
    buffer_load_dwordx4 v[140:143], v12, s[40:43], s76 offen offset:3072 sc1
    v_mfma_f32_32x32x16_bf16 v[32:47], v[108:111], v[156:159], v[32:47]
    ds_read_b64_tr_b16 v[124:125], v75 offset:43008
    ds_read_b64_tr_b16 v[126:127], v75 offset:44032
    v_max_u32 v77, v77, v156
    s_waitcnt vmcnt(11) lgkmcnt(4)
    v_mfma_f32_32x32x16_bf16 v[16:31], v[112:115], v[160:163], v[16:31]
    ds_read_b64_tr_b16 v[104:105], v74 offset:45056
    ds_read_b64_tr_b16 v[106:107], v74 offset:46080
    s_add_u32 s76, s65, 13
    s_and_b32 s76, s76, 15
    s_mul_i32 s76, s76, 28800
    s_add_u32 s76, s76, s80
    buffer_load_dwordx4 v[144:147], v12, s[40:43], s76 offen offset:0 sc1
    v_mfma_f32_32x32x16_bf16 v[32:47], v[116:119], v[160:163], v[32:47]
    ds_read_b64_tr_b16 v[108:109], v75 offset:45056
    ds_read_b64_tr_b16 v[110:111], v75 offset:46080
    v_max_u32_e64 v77, v77, v160
    s_waitcnt vmcnt(11) lgkmcnt(4)
    v_mfma_f32_32x32x16_bf16 v[16:31], v[120:123], v[164:167], v[16:31]
    ds_read_b64_tr_b16 v[112:113], v74 offset:47104
    ds_read_b64_tr_b16 v[114:115], v74 offset:48128
    buffer_load_dwordx4 v[148:151], v12, s[40:43], s76 offen offset:1024 sc1
    v_mfma_f32_32x32x16_bf16 v[32:47], v[124:127], v[164:167], v[32:47]
    ds_read_b64_tr_b16 v[116:117], v75 offset:47104
    ds_read_b64_tr_b16 v[118:119], v75 offset:48128
    v_max_u32 v77, v77, v164
    s_waitcnt vmcnt(11) lgkmcnt(4)
    v_mfma_f32_32x32x16_bf16 v[16:31], v[104:107], v[168:171], v[16:31]
    ds_read_b64_tr_b16 v[120:121], v74 offset:49152
    ds_read_b64_tr_b16 v[122:123], v74 offset:50176
    buffer_load_dwordx4 v[152:155], v12, s[40:43], s76 offen offset:2048 sc1
    v_mfma_f32_32x32x16_bf16 v[32:47], v[108:111], v[168:171], v[32:47]
    ds_read_b64_tr_b16 v[124:125], v75 offset:49152
    ds_read_b64_tr_b16 v[126:127], v75 offset:50176
    v_max_u32 v77, v77, v168
    s_waitcnt vmcnt(11) lgkmcnt(4)
    v_mfma_f32_32x32x16_bf16 v[16:31], v[112:115], v[172:175], v[16:31]
    ds_read_b64_tr_b16 v[104:105], v74 offset:51200
    ds_read_b64_tr_b16 v[106:107], v74 offset:52224
    buffer_load_dwordx4 v[156:159], v12, s[40:43], s76 offen offset:3072 sc1
    v_mfma_f32_32x32x16_bf16 v[32:47], v[116:119], v[172:175], v[32:47]
    ds_read_b64_tr_b16 v[108:109], v75 offset:51200
    ds_read_b64_tr_b16 v[110:111], v75 offset:52224
    v_max_u32 v77, v77, v172
    s_waitcnt vmcnt(11) lgkmcnt(4)
    v_mfma_f32_32x32x16_bf16 v[16:31], v[120:123], v[176:179], v[16:31]
    ds_read_b64_tr_b16 v[112:113], v74 offset:53248
    ds_read_b64_tr_b16 v[114:115], v74 offset:54272
    s_add_u32 s76, s65, 14
    s_and_b32 s76, s76, 15
    s_mul_i32 s76, s76, 28800
    s_add_u32 s76, s76, s80
    buffer_load_dwordx4 v[160:163], v12, s[40:43], s76 offen offset:0 sc1
    v_mfma_f32_32x32x16_bf16 v[32:47], v[124:127], v[176:179], v[32:47]
    ds_read_b64_tr_b16 v[116:117], v75 offset:53248
    ds_read_b64_tr_b16 v[118:119], v75 offset:54272
    v_max_u32_e64 v77, v77, v176
    s_waitcnt vmcnt(11) lgkmcnt(4)
    v_mfma_f32_32x32x16_bf16 v[16:31], v[104:107], v[180:183], v[16:31]
    ds_read_b64_tr_b16 v[120:121], v74 offset:55296
    ds_read_b64_tr_b16 v[122:123], v74 offset:56320
    buffer_load_dwordx4 v[164:167], v12, s[40:43], s76 offen offset:1024 sc1
    v_mfma_f32_32x32x16_bf16 v[32:47], v[108:111], v[180:183], v[32:47]
    ds_read_b64_tr_b16 v[124:125], v75 offset:55296
    ds_read_b64_tr_b16 v[126:127], v75 offset:56320
    v_max_u32 v77, v77, v180
    s_waitcnt vmcnt(11) lgkmcnt(4)
    v_mfma_f32_32x32x16_bf16 v[16:31], v[112:115], v[184:187], v[16:31]
    ds_read_b64_tr_b16 v[104:105], v74 offset:57344
    ds_read_b64_tr_b16 v[106:107], v74 offset:58368
    buffer_load_dwordx4 v[168:171], v12, s[40:43], s76 offen offset:2048 sc1
    v_mfma_f32_32x32x16_bf16 v[32:47], v[116:119], v[184:187], v[32:47]
    ds_read_b64_tr_b16 v[108:109], v75 offset:57344
    ds_read_b64_tr_b16 v[110:111], v75 offset:58368
    v_max_u32 v77, v77, v184
    s_waitcnt vmcnt(11) lgkmcnt(4)
    v_mfma_f32_32x32x16_bf16 v[16:31], v[120:123], v[188:191], v[16:31]
    ds_read_b64_tr_b16 v[112:113], v74 offset:59392
    ds_read_b64_tr_b16 v[114:115], v74 offset:60416
    buffer_load_dwordx4 v[172:175], v12, s[40:43], s76 offen offset:3072 sc1
    v_mfma_f32_32x32x16_bf16 v[32:47], v[124:127], v[188:191], v[32:47]
    ds_read_b64_tr_b16 v[116:117], v75 offset:59392
    ds_read_b64_tr_b16 v[118:119], v75 offset:60416
    v_max_u32 v77, v77, v188
    s_waitcnt vmcnt(11) lgkmcnt(4)
    v_mfma_f32_32x32x16_bf16 v[16:31], v[104:107], v[128:131], v[16:31]
    ds_read_b64_tr_b16 v[120:121], v74 offset:61440
    ds_read_b64_tr_b16 v[122:123], v74 offset:62464
    s_add_u32 s76, s65, 15
    s_and_b32 s76, s76, 15
    s_mul_i32 s76, s76, 28800
    s_add_u32 s76, s76, s80
    buffer_load_dwordx4 v[176:179], v12, s[40:43], s76 offen offset:0 sc1
    v_mfma_f32_32x32x16_bf16 v[32:47], v[108:111], v[128:131], v[32:47]
    ds_read_b64_tr_b16 v[124:125], v75 offset:61440
    ds_read_b64_tr_b16 v[126:127], v75 offset:62464
    v_max_u32_e64 v77, v77, v128
    s_waitcnt vmcnt(11) lgkmcnt(4)
    v_mfma_f32_32x32x16_bf16 v[16:31], v[112:115], v[132:135], v[16:31]
    ds_read_b64_tr_b16 v[104:105], v74 offset:63488
    ds_read_b64_tr_b16 v[106:107], v74 offset:64512
    buffer_load_dwordx4 v[180:183], v12, s[40:43], s76 offen offset:1024 sc1
    v_mfma_f32_32x32x16_bf16 v[32:47], v[116:119], v[132:135], v[32:47]
    ds_read_b64_tr_b16 v[108:109], v75 offset:63488
    ds_read_b64_tr_b16 v[110:111], v75 offset:64512
    v_max_u32 v77, v77, v132
    s_waitcnt vmcnt(11) lgkmcnt(4)
    v_mfma_f32_32x32x16_bf16 v[16:31], v[120:123], v[136:139], v[16:31]
    ds_read_b64_tr_b16 v[112:113], v72 offset:0
    ds_read_b64_tr_b16 v[114:115], v72 offset:1024
    buffer_load_dwordx4 v[184:187], v12, s[40:43], s76 offen offset:2048 sc1
    v_mfma_f32_32x32x16_bf16 v[32:47], v[124:127], v[136:139], v[32:47]
    ds_read_b64_tr_b16 v[116:117], v73 offset:0
    ds_read_b64_tr_b16 v[118:119], v73 offset:1024
    v_max_u32 v77, v77, v136
    s_waitcnt vmcnt(11) lgkmcnt(4)
    v_mfma_f32_32x32x16_bf16 v[16:31], v[104:107], v[140:143], v[16:31]
    ds_read_b64_tr_b16 v[120:121], v72 offset:2048
    ds_read_b64_tr_b16 v[122:123], v72 offset:3072
    buffer_load_dwordx4 v[188:191], v12, s[40:43], s76 offen offset:3072 sc1
    v_mfma_f32_32x32x16_bf16 v[32:47], v[108:111], v[140:143], v[32:47]
    ds_read_b64_tr_b16 v[124:125], v73 offset:2048
    ds_read_b64_tr_b16 v[126:127], v73 offset:3072
    v_max_u32_e64 v77, v77, v140
    s_cmp_eq_u32 s88, 0
    s_cbranch_scc0 L_nobg_28
    s_barrier
L_nobg_28:
    s_waitcnt vmcnt(11) lgkmcnt(4)
    v_mfma_f32_32x32x16_bf16 v[16:31], v[112:115], v[144:147], v[16:31]
    ds_read_b64_tr_b16 v[104:105], v72 offset:4096
    ds_read_b64_tr_b16 v[106:107], v72 offset:5120
    v_mfma_f32_32x32x16_bf16 v[32:47], v[116:119], v[144:147], v[32:47]
    ds_read_b64_tr_b16 v[108:109], v73 offset:4096
    ds_read_b64_tr_b16 v[110:111], v73 offset:5120
    v_max_u32 v77, v77, v144
    s_waitcnt vmcnt(10) lgkmcnt(4)
    v_mfma_f32_32x32x16_bf16 v[16:31], v[120:123], v[148:151], v[16:31]
    ds_read_b64_tr_b16 v[112:113], v72 offset:6144
    ds_read_b64_tr_b16 v[114:115], v72 offset:7168
    v_mfma_f32_32x32x16_bf16 v[32:47], v[124:127], v[148:151], v[32:47]
    ds_read_b64_tr_b16 v[116:117], v73 offset:6144
    ds_read_b64_tr_b16 v[118:119], v73 offset:7168
    v_max_u32 v77, v77, v148
    s_waitcnt vmcnt(9) lgkmcnt(4)
    v_mfma_f32_32x32x16_bf16 v[16:31], v[104:107], v[152:155], v[16:31]
    ds_read_b64_tr_b16 v[120:121], v72 offset:8192
    ds_read_b64_tr_b16 v[122:123], v72 offset:9216
    v_mfma_f32_32x32x16_bf16 v[32:47], v[108:111], v[152:155], v[32:47]
    ds_read_b64_tr_b16 v[124:125], v73 offset:8192
    ds_read_b64_tr_b16 v[126:127], v73 offset:9216
    v_max_u32 v77, v77, v152
    s_waitcnt vmcnt(8) lgkmcnt(4)
    v_mfma_f32_32x32x16_bf16 v[16:31], v[112:115], v[156:159], v[16:31]
    ds_read_b64_tr_b16 v[104:105], v72 offset:10240
    ds_read_b64_tr_b16 v[106:107], v72 offset:11264
    v_mfma_f32_32x32x16_bf16 v[32:47], v[116:119], v[156:159], v[32:47]
    ds_read_b64_tr_b16 v[108:109], v73 offset:10240
    ds_read_b64_tr_b16 v[110:111], v73 offset:11264
    v_max_u32 v77, v77, v156
    s_waitcnt vmcnt(7) lgkmcnt(4)
    v_mfma_f32_32x32x16_bf16 v[16:31], v[120:123], v[160:163], v[16:31]
    ds_read_b64_tr_b16 v[112:113], v72 offset:12288
    ds_read_b64_tr_b16 v[114:115], v72 offset:13312
    v_mfma_f32_32x32x16_bf16 v[32:47], v[124:127], v[160:163], v[32:47]
    ds_read_b64_tr_b16 v[116:117], v73 offset:12288
    ds_read_b64_tr_b16 v[118:119], v73 offset:13312
    v_max_u32 v77, v77, v160
    s_waitcnt vmcnt(6) lgkmcnt(4)
    v_mfma_f32_32x32x16_bf16 v[16:31], v[104:107], v[164:167], v[16:31]
    ds_read_b64_tr_b16 v[120:121], v72 offset:14336
    ds_read_b64_tr_b16 v[122:123], v72 offset:15360
    v_mfma_f32_32x32x16_bf16 v[32:47], v[108:111], v[164:167], v[32:47]
    ds_read_b64_tr_b16 v[124:125], v73 offset:14336
    ds_read_b64_tr_b16 v[126:127], v73 offset:15360
    v_max_u32 v77, v77, v164
    s_waitcnt vmcnt(5) lgkmcnt(4)
    v_mfma_f32_32x32x16_bf16 v[16:31], v[112:115], v[168:171], v[16:31]
    ds_read_b64_tr_b16 v[104:105], v72 offset:16384
    ds_read_b64_tr_b16 v[106:107], v72 offset:17408
    v_mfma_f32_32x32x16_bf16 v[32:47], v[116:119], v[168:171], v[32:47]
    ds_read_b64_tr_b16 v[108:109], v73 offset:16384
    ds_read_b64_tr_b16 v[110:111], v73 offset:17408
    v_max_u32 v77, v77, v168
    s_waitcnt vmcnt(4) lgkmcnt(4)
    v_mfma_f32_32x32x16_bf16 v[16:31], v[120:123], v[172:175], v[16:31]
    ds_read_b64_tr_b16 v[112:113], v72 offset:18432
    ds_read_b64_tr_b16 v[114:115], v72 offset:19456
    v_mfma_f32_32x32x16_bf16 v[32:47], v[124:127], v[172:175], v[32:47]
    ds_read_b64_tr_b16 v[116:117], v73 offset:18432
    ds_read_b64_tr_b16 v[118:119], v73 offset:19456
    v_max_u32 v77, v77, v172
    s_waitcnt vmcnt(3) lgkmcnt(4)
    v_mfma_f32_32x32x16_bf16 v[16:31], v[104:107], v[176:179], v[16:31]
    ds_read_b64_tr_b16 v[120:121], v72 offset:20480
    ds_read_b64_tr_b16 v[122:123], v72 offset:21504
    v_mfma_f32_32x32x16_bf16 v[32:47], v[108:111], v[176:179], v[32:47]
    ds_read_b64_tr_b16 v[124:125], v73 offset:20480
    ds_read_b64_tr_b16 v[126:127], v73 offset:21504
    v_max_u32 v77, v77, v176
    s_waitcnt vmcnt(2) lgkmcnt(4)
    v_mfma_f32_32x32x16_bf16 v[16:31], v[112:115], v[180:183], v[16:31]
    ds_read_b64_tr_b16 v[104:105], v72 offset:22528
    ds_read_b64_tr_b16 v[106:107], v72 offset:23552
    v_mfma_f32_32x32x16_bf16 v[32:47], v[116:119], v[180:183], v[32:47]
    ds_read_b64_tr_b16 v[108:109], v73 offset:22528
    ds_read_b64_tr_b16 v[110:111], v73 offset:23552
    v_max_u32 v77, v77, v180
    s_waitcnt vmcnt(1) lgkmcnt(4)
    v_mfma_f32_32x32x16_bf16 v[16:31], v[120:123], v[184:187], v[16:31]
    v_mfma_f32_32x32x16_bf16 v[32:47], v[124:127], v[184:187], v[32:47]
    v_max_u32 v77, v77, v184
    s_waitcnt vmcnt(0) lgkmcnt(0)
    v_mfma_f32_32x32x16_bf16 v[16:31], v[104:107], v[188:191], v[16:31]
    v_mfma_f32_32x32x16_bf16 v[32:47], v[108:111], v[188:191], v[32:47]
    v_max_u32 v77, v77, v188
    v_cmp_eq_u32_e64 vcc, -1, v77
    s_nop 0
    s_cbranch_vccz L_ok_29
    s_add_u32 s88, s88, 1
    s_cmp_lt_u32 s88, 65536
    s_cbranch_scc1 L_g2
L_ok_29:
    s_nop 6
    v_cvt_pk_bf16_f32 v88, v16, v17
    v_cvt_pk_bf16_f32 v89, v18, v19
    v_cvt_pk_bf16_f32 v90, v20, v21
    v_cvt_pk_bf16_f32 v91, v22, v23
    v_cvt_pk_bf16_f32 v92, v24, v25
    v_cvt_pk_bf16_f32 v93, v26, v27
    v_cvt_pk_bf16_f32 v94, v28, v29
    v_cvt_pk_bf16_f32 v95, v30, v31
    v_cvt_pk_bf16_f32 v96, v32, v33
    v_cvt_pk_bf16_f32 v97, v34, v35
    v_cvt_pk_bf16_f32 v98, v36, v37
    v_cvt_pk_bf16_f32 v99, v38, v39
    v_cvt_pk_bf16_f32 v100, v40, v41
    v_cvt_pk_bf16_f32 v101, v42, v43
    v_cvt_pk_bf16_f32 v102, v44, v45
    v_cvt_pk_bf16_f32 v103, v46, v47
    v_dot2_f32_bf16 v104, v88, s89, 0
    v_dot2_f32_bf16 v105, v88, v88, 0
    v_dot2_f32_bf16 v106, v88, v192, 0
    v_dot2_f32_bf16 v104, v89, s89, v104
    v_dot2_f32_bf16 v105, v89, v89, v105
    v_dot2_f32_bf16 v106, v89, v193, v106
    v_dot2_f32_bf16 v104, v90, s89, v104
    v_dot2_f32_bf16 v105, v90, v90, v105
    v_dot2_f32_bf16 v106, v90, v194, v106
    v_dot2_f32_bf16 v104, v91, s89, v104
    v_dot2_f32_bf16 v105, v91, v91, v105
    v_dot2_f32_bf16 v106, v91, v195, v106
    v_dot2_f32_bf16 v104, v92, s89, v104
    v_dot2_f32_bf16 v105, v92, v92, v105
    v_dot2_f32_bf16 v106, v92, v196, v106
    v_dot2_f32_bf16 v104, v93, s89, v104
    v_dot2_f32_bf16 v105, v93, v93, v105
    v_dot2_f32_bf16 v106, v93, v197, v106
    v_dot2_f32_bf16 v104, v94, s89, v104
    v_dot2_f32_bf16 v105, v94, v94, v105
    v_dot2_f32_bf16 v106, v94, v198, v106
    v_dot2_f32_bf16 v104, v95, s89, v104
    v_dot2_f32_bf16 v105, v95, v95, v105
    v_dot2_f32_bf16 v106, v95, v199, v106
    v_dot2_f32_bf16 v104, v96, s89, v104
    v_dot2_f32_bf16 v105, v96, v96, v105
    v_dot2_f32_bf16 v106, v96, v200, v106
    v_dot2_f32_bf16 v104, v97, s89, v104
    v_dot2_f32_bf16 v105, v97, v97, v105
    v_dot2_f32_bf16 v106, v97, v201, v106
    v_dot2_f32_bf16 v104, v98, s89, v104
    v_dot2_f32_bf16 v105, v98, v98, v105
    v_dot2_f32_bf16 v106, v98, v202, v106
    v_dot2_f32_bf16 v104, v99, s89, v104
    v_dot2_f32_bf16 v105, v99, v99, v105
    v_dot2_f32_bf16 v106, v99, v203, v106
    v_dot2_f32_bf16 v104, v100, s89, v104
    v_dot2_f32_bf16 v105, v100, v100, v105
    v_dot2_f32_bf16 v106, v100, v204, v106
    v_dot2_f32_bf16 v104, v101, s89, v104
    v_dot2_f32_bf16 v105, v101, v101, v105
    v_dot2_f32_bf16 v106, v101, v205, v106
    v_dot2_f32_bf16 v104, v102, s89, v104
    v_dot2_f32_bf16 v105, v102, v102, v105
    v_dot2_f32_bf16 v106, v102, v206, v106
    v_dot2_f32_bf16 v104, v103, s89, v104
    v_dot2_f32_bf16 v105, v103, v103, v105
    v_dot2_f32_bf16 v106, v103, v207, v106
    s_lshl_b32 s76, s62, 9
    s_add_u32 s77, s76, s99
    v_mov_b32 v107, 0
    v_mov_b32 v4, v104
    v_mov_b32 v5, v105
    v_mov_b32 v6, v106
    v_permlane32_swap_b32 v104, v4
    v_permlane32_swap_b32 v105, v5
    v_permlane32_swap_b32 v106, v6
    v_add_f32 v104, v104, v4
    v_add_f32 v105, v105, v5
    v_add_f32_e64 v106, v106, v6
    s_mov_b32 exec_hi, 0
    buffer_store_dwordx4 v[104:107], v12, s[40:43], s77 offen offset:1024 sc1
    s_mov_b64 exec, -1
    v_lshlrev_b32 v16, 16, v88
    v_and_b32 v17, s90, v88
    v_lshlrev_b32 v18, 16, v89
    v_and_b32 v19, s90, v89
    v_lshlrev_b32 v20, 16, v90
    v_and_b32 v21, s90, v90
    v_lshlrev_b32 v22, 16, v91
    v_and_b32 v23, s90, v91
    v_lshlrev_b32 v24, 16, v92
    v_and_b32 v25, s90, v92
    v_lshlrev_b32 v26, 16, v93
    v_and_b32 v27, s90, v93
    v_lshlrev_b32 v28, 16, v94
    v_and_b32 v29, s90, v94
    v_lshlrev_b32 v30, 16, v95
    v_and_b32 v31, s90, v95
    v_lshlrev_b32 v32, 16, v96
    v_and_b32 v33, s90, v96
    v_lshlrev_b32 v34, 16, v97
    v_and_b32 v35, s90, v97
    v_lshlrev_b32 v36, 16, v98
    v_and_b32 v37, s90, v98
    v_lshlrev_b32 v38, 16, v99
    v_and_b32 v39, s90, v99
    v_lshlrev_b32 v40, 16, v100
    v_and_b32 v41, s90, v100
    v_lshlrev_b32 v42, 16, v101
    v_and_b32 v43, s90, v101
    v_lshlrev_b32 v44, 16, v102
    v_and_b32 v45, s90, v102
    v_lshlrev_b32 v46, 16, v103
    v_and_b32_e64 v47, s90, v103
    v_mul_u32_u24 v6, 9344, v3
    v_lshl_add_u32 v6, v2, 4, v6
    s_mul_i32 s78, s97, 149504
    s_add_u32 s78, s78, s76
    s_add_u32 s78, s78, 8388608
    s_mov_b32 s88, 0
L_spin_30:
    s_mov_b32 s77, s78
    buffer_load_dwordx4 v[112:115], v6, s[40:43], s77 offen offset:1024 sc1
    s_add_u32 s77, s77, 18688
    buffer_load_dwordx4 v[116:119], v6, s[40:43], s77 offen offset:1024 sc1
    s_add_u32 s77, s77, 18688
    buffer_load_dwordx4 v[120:123], v6, s[40:43], s77 offen offset:1024 sc1
    s_add_u32 s77, s77, 18688
    buffer_load_dwordx4 v[124:127], v6, s[40:43], s77 offen offset:1024 sc1
    s_add_u32 s77, s77, 18688
    buffer_load_dwordx4 v[128:131], v6, s[40:43], s77 offen offset:1024 sc1
    s_add_u32 s77, s77, 18688
    buffer_load_dwordx4 v[132:135], v6, s[40:43], s77 offen offset:1024 sc1
    s_add_u32 s77, s77, 18688
    buffer_load_dwordx4 v[136:139], v6, s[40:43], s77 offen offset:1024 sc1
    s_add_u32 s77, s77, 18688
    buffer_load_dwordx4 v[140:143], v6, s[40:43], s77 offen offset:1024 sc1
    s_waitcnt vmcnt(0)
    v_max3_u32 v4, v112, v116, v120
    v_max3_u32 v4, v4, v124, v128
    v_max3_u32 v4, v4, v132, v136
    v_max_u32 v4, v4, v140
    v_cmp_eq_u32_e64 vcc, -1, v4
    s_nop 0
    s_cbranch_vccz L_ok_31
    s_add_u32 s88, s88, 1
    s_cmp_lt_u32 s88, 65536
    s_cbranch_scc1 L_spin_30
L_ok_31:
    v_pk_add_f32 v[112:113], v[112:113], v[128:129]
    v_pk_add_f32 v[114:115], v[114:115], v[130:131]
    v_pk_add_f32 v[116:117], v[116:117], v[132:133]
    v_pk_add_f32 v[118:119], v[118:119], v[134:135]
    v_pk_add_f32 v[120:121], v[120:121], v[136:137]
    v_pk_add_f32 v[122:123], v[122:123], v[138:139]
    v_pk_add_f32 v[124:125], v[124:125], v[140:141]
    v_pk_add_f32 v[126:127], v[126:127], v[142:143]
    v_pk_add_f32 v[112:113], v[112:113], v[120:121]
    v_pk_add_f32 v[114:115], v[114:115], v[122:123]
    v_pk_add_f32 v[116:117], v[116:117], v[124:125]
    v_pk_add_f32 v[118:119], v[118:119], v[126:127]
    v_pk_add_f32 v[112:113], v[112:113], v[116:117]
    v_pk_add_f32 v[114:115], v[114:115], v[118:119]
    v_mov_b32 v4, v112
    v_mov_b32 v5, v113
    v_mov_b32 v6, v114
    v_permlane32_swap_b32 v112, v4
    v_permlane32_swap_b32 v113, v5
    v_permlane32_swap_b32 v114, v6
    v_add_f32 v112, v112, v4
    v_add_f32 v113, v113, v5
    v_add_f32 v114, v114, v6
    v_mul_f32 v112, 0x3a800000, v112
    v_mul_f32 v113, 0x3a800000, v113
    v_fma_f32 v4, -v112, v112, v113
    v_max_f32_e64 v4, 0, v4
    v_cvt_pk_bf16_f32 v116, v112, v112
    v_and_b32_e64 v116, s90, v116
    v_cvt_pk_bf16_f32 v4, v4, v4
    v_and_b32_e64 v4, s90, v4
    v_add_f32 v4, 0x3727c5ac, v4
    v_cvt_pk_bf16_f32 v4, v4, v4
    v_and_b32 v4, s90, v4
    v_sqrt_f32_e64 v4, v4
    s_nop 0
    v_cvt_pk_bf16_f32 v4, v4, v4
    v_and_b32 v4, s90, v4
    v_rcp_f32 v118, v4
    v_fma_f32 v120, -v116, v76, v114
    v_mul_f32 v119, v116, v118
    v_mul_f32 v120, v120, v118
    v_pk_fma_f32 v[144:145], v[16:17], v[118:119], v[118:119] op_sel:[0,0,1] op_sel_hi:[1,0,1] neg_lo:[0,0,1] neg_hi:[0,0,1]
    v_cvt_pk_bf16_f32 v124, v144, v145
    v_max_f32_dpp v4, v120, v120 row_ror:8 row_mask:0xf bank_mask:0xf
    v_pk_fma_f32 v[146:147], v[18:19], v[118:119], v[118:119] op_sel:[0,0,1] op_sel_hi:[1,0,1] neg_lo:[0,0,1] neg_hi:[0,0,1]
    v_cvt_pk_bf16_f32 v125, v146, v147
    v_max_f32_dpp v4, v4, v4 row_ror:4 row_mask:0xf bank_mask:0xf
    v_pk_fma_f32 v[148:149], v[20:21], v[118:119], v[118:119] op_sel:[0,0,1] op_sel_hi:[1,0,1] neg_lo:[0,0,1] neg_hi:[0,0,1]
    v_cvt_pk_bf16_f32 v126, v148, v149
    v_max_f32_dpp v4, v4, v4 row_ror:2 row_mask:0xf bank_mask:0xf
    v_pk_fma_f32 v[150:151], v[22:23], v[118:119], v[118:119] op_sel:[0,0,1] op_sel_hi:[1,0,1] neg_lo:[0,0,1] neg_hi:[0,0,1]
    v_cvt_pk_bf16_f32 v127, v150, v151
    v_max_f32_dpp v4, v4, v4 row_ror:1 row_mask:0xf bank_mask:0xf
    v_mov_b32_e64 v5, v4
    v_pk_fma_f32 v[152:153], v[24:25], v[118:119], v[118:119] op_sel:[0,0,1] op_sel_hi:[1,0,1] neg_lo:[0,0,1] neg_hi:[0,0,1]
    v_cvt_pk_bf16_f32 v128, v152, v153
    v_permlane16_swap_b32 v4, v5
    s_lshl_b32 s78, s62, 2
    v_mov_b32 v6, s78
    v_max_f32 v4, v4, v5
    ds_write_b32 v6, v4 offset:25600
    v_cmp_eq_f32 vcc, v4, v120
    v_mov_b32 v6, 0
    v_pk_fma_f32 v[154:155], v[26:27], v[118:119], v[118:119] op_sel:[0,0,1] op_sel_hi:[1,0,1] neg_lo:[0,0,1] neg_hi:[0,0,1]
    v_cvt_pk_bf16_f32 v129, v154, v155
    s_ff1_i32_b32 s77, vcc_lo
    s_and_b32 s77, s77, 31
    v_pk_fma_f32 v[156:157], v[28:29], v[118:119], v[118:119] op_sel:[0,0,1] op_sel_hi:[1,0,1] neg_lo:[0,0,1] neg_hi:[0,0,1]
    v_cvt_pk_bf16_f32 v130, v156, v157
    v_pk_fma_f32 v[158:159], v[30:31], v[118:119], v[118:119] op_sel:[0,0,1] op_sel_hi:[1,0,1] neg_lo:[0,0,1] neg_hi:[0,0,1]
    v_cvt_pk_bf16_f32 v131, v158, v159
    s_waitcnt lgkmcnt(0)
    s_barrier
    ds_read_b128 v[8:11], v6 offset:25600
    v_pk_fma_f32 v[160:161], v[32:33], v[118:119], v[118:119] op_sel:[0,0,1] op_sel_hi:[1,0,1] neg_lo:[0,0,1] neg_hi:[0,0,1]
    v_cvt_pk_bf16_f32 v132, v160, v161
    v_pk_fma_f32 v[162:163], v[34:35], v[118:119], v[118:119] op_sel:[0,0,1] op_sel_hi:[1,0,1] neg_lo:[0,0,1] neg_hi:[0,0,1]
    v_cvt_pk_bf16_f32 v133, v162, v163
    v_pk_fma_f32 v[164:165], v[36:37], v[118:119], v[118:119] op_sel:[0,0,1] op_sel_hi:[1,0,1] neg_lo:[0,0,1] neg_hi:[0,0,1]
    v_cvt_pk_bf16_f32 v134, v164, v165
    v_pk_fma_f32 v[166:167], v[38:39], v[118:119], v[118:119] op_sel:[0,0,1] op_sel_hi:[1,0,1] neg_lo:[0,0,1] neg_hi:[0,0,1]
    v_cvt_pk_bf16_f32 v135, v166, v167
    v_pk_fma_f32 v[168:169], v[40:41], v[118:119], v[118:119] op_sel:[0,0,1] op_sel_hi:[1,0,1] neg_lo:[0,0,1] neg_hi:[0,0,1]
    v_cvt_pk_bf16_f32 v136, v168, v169
    v_pk_fma_f32 v[170:171], v[42:43], v[118:119], v[118:119] op_sel:[0,0,1] op_sel_hi:[1,0,1] neg_lo:[0,0,1] neg_hi:[0,0,1]
    v_cvt_pk_bf16_f32 v137, v170, v171
    v_pk_fma_f32 v[172:173], v[44:45], v[118:119], v[118:119] op_sel:[0,0,1] op_sel_hi:[1,0,1] neg_lo:[0,0,1] neg_hi:[0,0,1]
    v_cvt_pk_bf16_f32 v138, v172, v173
    v_pk_fma_f32 v[174:175], v[46:47], v[118:119], v[118:119] op_sel:[0,0,1] op_sel_hi:[1,0,1] neg_lo:[0,0,1] neg_hi:[0,0,1]
    v_cvt_pk_bf16_f32 v139, v174, v175
    s_lshl_b32 s78, s97, 7
    s_lshl_b32 s79, s62, 5
    s_add_u32 s78, s78, s79
    s_add_u32 s81, s78, s77
    v_mov_b32 v121, s81
    v_lshlrev_b32_e64 v7, 6, v3
    s_waitcnt lgkmcnt(0)
    v_max3_f32 v5, v8, v9, v10
    v_max_f32 v5, v5, v11
    s_mov_b32 s79, 3
    v_cmp_eq_f32 vcc, v5, v10
    s_nop 0
    s_cmp_lg_u32 vcc_lo, 0
    s_cselect_b32 s79, 2, s79
    v_cmp_eq_f32 vcc, v5, v9
    s_nop 0
    s_cmp_lg_u32 vcc_lo, 0
    s_cselect_b32 s79, 1, s79
    v_cmp_eq_f32 vcc, v5, v8
    s_nop 0
    s_cmp_lg_u32 vcc_lo, 0
    s_cselect_b32 s79, 0, s79
    s_mov_b32 s91, -1
    s_cmp_eq_u32 s79, s62
    s_cbranch_scc0 L_nopub_32
    s_mov_b32 s80, 1
    s_mov_b32 s81, 1
    s_lshl_b64 exec, s[80:81], s77
    buffer_store_dwordx4 v[124:127], v7, s[40:43], s99 offen offset:0 sc1
    buffer_store_dwordx4 v[128:131], v7, s[40:43], s99 offen offset:16 sc1
    buffer_store_dwordx4 v[132:135], v7, s[40:43], s99 offen offset:32 sc1
    buffer_store_dwordx4 v[136:139], v7, s[40:43], s99 offen offset:48 sc1
    buffer_store_dwordx2 v[120:121], v6, s[40:43], s99 offen offset:256 sc1
    buffer_store_dwordx4 v[88:91], v7, s[40:43], s99 offen offset:128 sc1
    buffer_store_dwordx4 v[92:95], v7, s[40:43], s99 offen offset:144 sc1
    buffer_store_dwordx4 v[96:99], v7, s[40:43], s99 offen offset:160 sc1
    buffer_store_dwordx4 v[100:103], v7, s[40:43], s99 offen offset:176 sc1
    s_mov_b64 exec, -1
    s_mov_b32 s91, -2
L_nopub_32:
    v_lshlrev_b32 v144, 16, v124
    v_and_b32 v145, s90, v124
    v_pk_add_f32 v[144:145], v[144:145], v[16:17]
    v_cvt_pk_bf16_f32 v16, v144, v145
    v_lshlrev_b32 v144, 16, v125
    v_and_b32 v145, s90, v125
    v_pk_add_f32 v[144:145], v[144:145], v[18:19]
    v_cvt_pk_bf16_f32 v17, v144, v145
    ds_write_b64 v64, v[16:17]
    v_lshlrev_b32 v144, 16, v126
    v_and_b32 v145, s90, v126
    v_pk_add_f32 v[144:145], v[144:145], v[20:21]
    v_cvt_pk_bf16_f32 v18, v144, v145
    v_lshlrev_b32 v144, 16, v127
    v_and_b32 v145, s90, v127
    v_pk_add_f32 v[144:145], v[144:145], v[22:23]
    v_cvt_pk_bf16_f32 v19, v144, v145
    ds_write_b64 v65, v[18:19]
    v_lshlrev_b32 v144, 16, v128
    v_and_b32 v145, s90, v128
    v_pk_add_f32 v[144:145], v[144:145], v[24:25]
    v_cvt_pk_bf16_f32 v20, v144, v145
    v_lshlrev_b32 v144, 16, v129
    v_and_b32 v145, s90, v129
    v_pk_add_f32 v[144:145], v[144:145], v[26:27]
    v_cvt_pk_bf16_f32 v21, v144, v145
    ds_write_b64 v66, v[20:21]
    v_lshlrev_b32 v144, 16, v130
    v_and_b32 v145, s90, v130
    v_pk_add_f32 v[144:145], v[144:145], v[28:29]
    v_cvt_pk_bf16_f32 v22, v144, v145
    v_lshlrev_b32 v144, 16, v131
    v_and_b32 v145, s90, v131
    v_pk_add_f32 v[144:145], v[144:145], v[30:31]
    v_cvt_pk_bf16_f32 v23, v144, v145
    ds_write_b64 v67, v[22:23]
    v_lshlrev_b32 v144, 16, v132
    v_and_b32 v145, s90, v132
    v_pk_add_f32 v[144:145], v[144:145], v[32:33]
    v_cvt_pk_bf16_f32 v24, v144, v145
    v_lshlrev_b32 v144, 16, v133
    v_and_b32 v145, s90, v133
    v_pk_add_f32 v[144:145], v[144:145], v[34:35]
    v_cvt_pk_bf16_f32 v25, v144, v145
    ds_write_b64 v68, v[24:25]
    v_lshlrev_b32 v144, 16, v134
    v_and_b32 v145, s90, v134
    v_pk_add_f32 v[144:145], v[144:145], v[36:37]
    v_cvt_pk_bf16_f32 v26, v144, v145
    v_lshlrev_b32 v144, 16, v135
    v_and_b32 v145, s90, v135
    v_pk_add_f32 v[144:145], v[144:145], v[38:39]
    v_cvt_pk_bf16_f32 v27, v144, v145
    ds_write_b64 v69, v[26:27]
    v_lshlrev_b32 v144, 16, v136
    v_and_b32 v145, s90, v136
    v_pk_add_f32 v[144:145], v[144:145], v[40:41]
    v_cvt_pk_bf16_f32 v28, v144, v145
    v_lshlrev_b32 v144, 16, v137
    v_and_b32 v145, s90, v137
    v_pk_add_f32 v[144:145], v[144:145], v[42:43]
    v_cvt_pk_bf16_f32 v29, v144, v145
    ds_write_b64 v70, v[28:29]
    v_lshlrev_b32 v144, 16, v138
    v_and_b32 v145, s90, v138
    v_pk_add_f32 v[144:145], v[144:145], v[44:45]
    v_cvt_pk_bf16_f32 v30, v144, v145
    v_lshlrev_b32 v144, 16, v139
    v_and_b32 v145, s90, v139
    v_pk_add_f32 v[144:145], v[144:145], v[46:47]
    v_cvt_pk_bf16_f32 v31, v144, v145
    ds_write_b64 v71, v[30:31]
    s_lshl_b32 s76, s62, 12
    s_add_u32 s76, s76, 0
    v_add_u32 v4, s76, v12
    s_waitcnt lgkmcnt(0)
    ds_read_b128 v[48:51], v4 offset:0
    ds_read_b128 v[52:55], v4 offset:1024
    ds_read_b128 v[56:59], v4 offset:2048
    ds_read_b128 v[60:63], v4 offset:3072
    s_cmp_eq_u32 s91, -2
    s_cbranch_scc0 L_nowin_33
    v_and_b32_e64 v7, 15, v1
    v_mul_u32_u24 v7, 149504, v7
    s_mul_i32 s76, s98, 9344
    s_add_u32 s76, s76, 8388608
    s_mov_b32 s88, 0
L_spin_34:
    buffer_load_dwordx2 v[8:9], v7, s[40:43], s76 offen offset:256 sc1
    s_waitcnt vmcnt(0)
    v_cmp_eq_u32 vcc, -1, v9
    s_nop 0
    s_cbranch_vccz L_ok_35
    s_add_u32 s88, s88, 1
    s_cmp_lt_u32 s88, 65536
    s_cbranch_scc1 L_spin_34
L_ok_35:
    v_max_f32_dpp v4, v8, v8 row_ror:8 row_mask:0xf bank_mask:0xf
    s_nop 1
    v_max_f32_dpp v4, v4, v4 row_ror:4 row_mask:0xf bank_mask:0xf
    s_nop 1
    v_max_f32_dpp v4, v4, v4 row_ror:2 row_mask:0xf bank_mask:0xf
    s_nop 1
    v_max_f32_dpp v4, v4, v4 row_ror:1 row_mask:0xf bank_mask:0xf
    v_cmp_eq_f32_e64 vcc, v4, v8
    s_nop 0
    s_ff1_i32_b32 s92, vcc_lo
    s_and_b32 s92, s92, 15
    s_nop 3
    v_readlane_b32 s91, v9, s92
L_nowin_33:
    s_nop 0
    s_sub_u32 s77, s91, s78
    v_lshrrev_b32 v7, 3, v1
    v_sub_u32 v5, s77, v7
    v_mov_b32 v6, 2146435072
    v_and_b32 v8, 7, v1
    v_lshrrev_b32 v9, 4, v1
    v_xor_b32 v8, v8, v9
    v_lshlrev_b32 v8, 4, v8
    v_lshl_add_u32 v7, v7, 11, v8
    v_xor_b32 v8, 64, v7
    s_lshl_b32 s76, s78, 11
    s_lshl_b32 s79, s98, 7
    s_add_u32 s76, s76, s79
    v_cmp_eq_u32 vcc, 0, v5
    s_nop 1
    v_cndmask_b32 v64, v7, v6, vcc
    v_cmp_eq_u32 vcc, 8, v5
    s_nop 1
    v_cndmask_b32 v65, v8, v6, vcc
    v_cmp_eq_u32 vcc, 16, v5
    s_nop 1
    v_cndmask_b32 v66, v7, v6, vcc
    v_cmp_eq_u32 vcc, 24, v5
    s_nop 1
    v_cndmask_b32_e64 v67, v8, v6, vcc
    s_waitcnt lgkmcnt(0)
    buffer_store_dwordx4 v[48:51], v64, s[44:47], s76 offen sc1
    s_add_u32 s76, s76, 16384
    buffer_store_dwordx4 v[52:55], v65, s[44:47], s76 offen sc1
    s_add_u32 s76, s76, 16384
    buffer_store_dwordx4 v[56:59], v66, s[44:47], s76 offen sc1
    s_add_u32 s76, s76, 16384
    buffer_store_dwordx4 v[60:63], v67, s[44:47], s76 offen sc1
L_end:
    s_endpgm
L_code_end:
s_endpgm
.fill 1056, 4, 0xbf800000
.section .rodata,"a"
.p2align 6
.amdhsa_kernel sequential_preLN__linear_kernel_hedgehog__moe_arch_mod__prompt_kernel
  .amdhsa_next_free_vgpr 256
  .amdhsa_next_free_sgpr 102
  .amdhsa_accum_offset 256
  .amdhsa_group_segment_fixed_size 0
  .amdhsa_kernarg_size 96
  .amdhsa_user_sgpr_count 2
  .amdhsa_user_sgpr_kernarg_segment_ptr 1
  .amdhsa_system_sgpr_workgroup_id_x 1
  .amdhsa_float_denorm_mode_32 3
.end_amdhsa_kernel
```

```asm
; @launch grid=(256,1,1) block=(512,1,1) lds=163840
.amdgcn_target "amdgcn-amd-amdhsa--gfx950"
.text
.globl sequential_preLN__linear_kernel_hedgehog__moe_arch_mod__prompt_kernel
.p2align 8
.type sequential_preLN__linear_kernel_hedgehog__moe_arch_mod__prompt_kernel,@function
sequential_preLN__linear_kernel_hedgehog__moe_arch_mod__prompt_kernel:
    s_cmp_ge_u32 s2, 256
    s_cbranch_scc1 L_end
    s_load_dwordx8 s[4:11], s[0:1], 0
    s_load_dwordx8 s[12:19], s[0:1], 32
    s_load_dwordx8 s[20:27], s[0:1], 64
    v_lshrrev_b32 v4, 6, v0
    v_and_b32_e64 v1, 63, v0
    v_readfirstlane_b32 s79, v4
    s_and_b32 s76, s2, 7
    s_lshr_b32 s77, s2, 3
    s_and_b32 s60, s76, 0
    s_lshl_b32 s60, s60, 4
    s_and_b32 s78, s77, 15
    s_add_u32 s60, s60, s78
    s_lshr_b32 s61, s76, 0
    s_lshl_b32 s61, s61, 1
    s_lshr_b32 s78, s77, 4
    s_add_u32 s61, s61, s78
    s_and_b32 s62, s79, 3
    s_cmp_ge_u32 s79, 4
    s_cbranch_scc1 L_compute
    s_add_u32 s76, s60, s61
    s_and_b32 s76, s76, 3
    s_mov_b32 s66, 0x65473210
    s_mov_b32 s67, 0xedcfa98b
    s_mov_b32 s69, 0xc421
    s_cmp_eq_u32 s76, 1
    s_cselect_b32 s66, 0x65803241, s66
    s_cselect_b32 s67, 0xfedba9c7, s67
    s_cselect_b32 s69, 0x9c51, s69
    s_cmp_eq_u32 s76, 2
    s_cselect_b32 s66, 0x69410532, s66
    s_cselect_b32 s67, 0xfecbad87, s67
    s_cselect_b32 s69, 0xa621, s69
    s_cmp_eq_u32 s76, 3
    s_cselect_b32 s66, 0xa5426103, s66
    s_cselect_b32 s67, 0xfdcbe987, s67
    s_cselect_b32 s69, 0xb731, s69
    v_lshrrev_b32 v4, 3, v1
    v_and_b32 v5, 7, v1
    v_lshrrev_b32 v6, 4, v1
    s_lshl_b32 s76, s60, 18
    s_lshl_b32 s77, s62, 16
    s_add_u32 s76, s76, s77
    v_xor_b32 v7, v5, v6
    v_lshlrev_b32_e64 v7, 4, v7
    v_lshl_add_u32 v78, v4, 11, v7
    v_add_u32 v16, s76, v78
    v_xor_b32 v7, 64, v16
    v_add_u32 v17, 15360, v7
    v_add_u32 v18, 30720, v16
    v_add_u32 v19, 46080, v7
    v_and_b32 v6, 1, v6
    v_lshlrev_b32 v6, 2, v6
    v_xor_b32 v8, v5, v6
    v_lshlrev_b32_e64 v8, 4, v8
    s_lshl_b32 s76, s61, 7
    s_mul_i32 s77, s62, 98304
    s_add_u32 s76, s76, s77
    v_mul_u32_u24 v7, 6144, v4
    v_add3_u32 v20, v7, v8, s76
    v_xor_b32 v7, 32, v20
    v_add_u32 v21, 48128, v7
    v_add_u32_e64 v22, 0, v20
    v_add_u32 v23, 48128, v7
    v_add_u32 v24, 4096, v20
    v_add_u32 v25, 52224, v7
    s_mul_i32 s70, s62, 10240
    s_waitcnt lgkmcnt(0)
    s_mov_b32 s28, s4
    s_and_b32 s29, s5, 0xffff
    s_mov_b32 s30, 4194304
    s_mov_b32 s31, 0x20000
    s_mov_b32 s32, s6
    s_and_b32 s33, s7, 0xffff
    s_mov_b32 s34, 6291456
    s_mov_b32 s35, 0x20000
    s_and_b32 s72, s66, 15
    s_mov_b32 m0, s70
    s_lshl_b32 s71, s72, 7
    buffer_load_dwordx4 v16, s[28:31], s71 offen offset:0 lds
    s_mul_i32 s72, s72, 393216
    s_lshr_b64 s[66:67], s[66:67], 4
    buffer_load_dwordx4 v17, s[28:31], s71 offen offset:1024 lds
    buffer_load_dwordx4 v18, s[28:31], s71 offen offset:2048 lds
    buffer_load_dwordx4 v19, s[28:31], s71 offen offset:3072 lds
    s_add_u32 m0, s70, 4096
    s_nop 0
    buffer_load_dwordx4 v20, s[32:35], s72 offen offset:0 lds
    buffer_load_dwordx4 v21, s[32:35], s72 offen offset:1024 lds
    buffer_load_dwordx4 v22, s[32:35], s72 offen offset:2048 lds
    buffer_load_dwordx4 v23, s[32:35], s72 offen offset:3072 lds
    s_add_u32 m0, s70, 8192
    s_nop 0
    buffer_load_dwordx4 v24, s[32:35], s72 offen offset:0 lds
    buffer_load_dwordx4 v25, s[32:35], s72 offen offset:1024 lds
    s_add_u32 s70, s70, 40960
    s_cmp_ge_u32 s70, 122880
    s_cselect_b32 s76, 122880, 0
    s_sub_u32 s70, s70, s76
    s_getpc_b64 s[78:79]
L_pc:
    s_lshr_b32 s76, s2, 3
    s_mul_i32 s76, s76, 896
    v_lshlrev_b32 v7, 7, v0
    v_add_u32 v7, s76, v7
    v_cmp_gt_u32 vcc, 7, v0
    s_nop 0
    s_and_saveexec_b64 s[80:81], vcc
    s_cbranch_execz L_nopf
    global_load_dword v27, v7, s[78:79]
L_nopf:
    s_mov_b64 exec, -1
    v_lshl_add_u32 v26, v4, 11, v8
    v_xor_b32 v79, 64, v78
    s_and_b32 s63, s62, 1
    s_lshr_b32 s64, s62, 1
    s_lshl_b32 s73, s60, 4
    s_add_u32 s73, s73, s61
    s_mul_i32 s73, s73, 28800
    s_and_b32 s76, s2, 7
    s_lshr_b32 s77, s2, 3
    s_and_b32 s97, s76, 7
    s_lshl_b32 s97, s97, 1
    s_and_b32 s78, s77, 1
    s_add_u32 s97, s97, s78
    s_lshr_b32 s98, s76, 3
    s_lshl_b32 s98, s98, 4
    s_lshr_b32 s78, s77, 1
    s_add_u32 s98, s98, s78
    s_lshl_b32 s99, s97, 4
    s_add_u32 s99, s99, s98
    s_mul_i32 s99, s99, 9344
    s_add_u32 s99, s99, 8388608
    s_add_u32 s65, s97, s98
    s_and_b32 s65, s65, 1
    s_mul_i32 s65, s65, 8
    s_mov_b32 s89, 0x3f803f80
    s_mov_b32 s90, 0xffff0000
    v_and_b32 v2, 31, v1
    v_lshrrev_b32 v3, 5, v1
    v_lshlrev_b32 v12, 4, v1
    v_lshrrev_b32_e64 v4, 3, v1
    v_mul_u32_u24 v13, 460800, v4
    v_and_b32_e64 v4, 7, v1
    v_lshl_add_u32 v13, v4, 4, v13
    s_lshl_b32 s76, s98, 7
    s_lshl_b32 s77, s62, 15
    s_add_u32 s76, s76, s77
    v_add_u32_e64 v26, s76, v26
    s_mov_b32 s40, s26
    s_and_b32 s41, s27, 0xffff
    s_mov_b32 s42, 16777216
    s_mov_b32 s43, 0x20000
    s_mov_b32 s56, s8
    s_and_b32 s57, s9, 0xffff
    s_mov_b32 s58, 65536
    s_mov_b32 s59, 0x20000
    v_mov_b32 v28, -1
    v_mov_b32 v29, -1
    v_mov_b32 v30, -1
    v_mov_b32 v31, -1
    s_and_b32 s72, s66, 15
    s_mov_b32 m0, s70
    s_lshl_b32 s71, s72, 7
    buffer_load_dwordx4 v16, s[28:31], s71 offen offset:0 lds
    s_mul_i32 s72, s72, 393216
    s_lshr_b64 s[66:67], s[66:67], 4
    buffer_load_dwordx4 v17, s[28:31], s71 offen offset:1024 lds
    buffer_load_dwordx4 v18, s[28:31], s71 offen offset:2048 lds
    buffer_load_dwordx4 v19, s[28:31], s71 offen offset:3072 lds
    s_add_u32 m0, s70, 4096
    s_nop 0
    buffer_load_dwordx4 v20, s[32:35], s72 offen offset:0 lds
    buffer_load_dwordx4 v21, s[32:35], s72 offen offset:1024 lds
    buffer_load_dwordx4 v22, s[32:35], s72 offen offset:2048 lds
    buffer_load_dwordx4 v23, s[32:35], s72 offen offset:3072 lds
    s_add_u32 m0, s70, 8192
    s_nop 0
    buffer_load_dwordx4 v24, s[32:35], s72 offen offset:0 lds
    buffer_load_dwordx4 v25, s[32:35], s72 offen offset:1024 lds
    s_add_u32 s70, s70, 40960
    s_cmp_ge_u32 s70, 122880
    s_cselect_b32 s76, 122880, 0
    s_sub_u32 s70, s70, s76
    s_lshl_b32 s77, s62, 10
    s_add_u32 s76, s77, s73
    buffer_store_dwordx4 v[28:31], v12, s[40:43], s76 offen sc1
    s_lshl_b32 s76, s61, 12
    s_add_u32 s76, s76, s77
    s_add_u32 m0, s77, 122880
    s_nop 0
    buffer_load_dwordx4 v12, s[56:59], s76 offen lds
    v_mov_b32 v4, 13631488
    buffer_load_dwordx2 v[88:89], v4, s[40:43], 0 offen
    s_waitcnt vmcnt(13)
    s_barrier
    s_and_b32 s72, s66, 15
    s_mov_b32 m0, s70
    s_lshl_b32 s71, s72, 7
    buffer_load_dwordx4 v16, s[28:31], s71 offen offset:0 lds
    s_mul_i32 s72, s72, 393216
    s_lshr_b64 s[66:67], s[66:67], 4
    buffer_load_dwordx4 v17, s[28:31], s71 offen offset:1024 lds
    buffer_load_dwordx4 v18, s[28:31], s71 offen offset:2048 lds
    buffer_load_dwordx4 v19, s[28:31], s71 offen offset:3072 lds
    s_add_u32 m0, s70, 4096
    s_nop 0
    buffer_load_dwordx4 v20, s[32:35], s72 offen offset:0 lds
    buffer_load_dwordx4 v21, s[32:35], s72 offen offset:1024 lds
    buffer_load_dwordx4 v22, s[32:35], s72 offen offset:2048 lds
    buffer_load_dwordx4 v23, s[32:35], s72 offen offset:3072 lds
    s_add_u32 m0, s70, 8192
    s_nop 0
    buffer_load_dwordx4 v24, s[32:35], s72 offen offset:0 lds
    buffer_load_dwordx4 v25, s[32:35], s72 offen offset:1024 lds
    s_add_u32 s70, s70, 40960
    s_cmp_ge_u32 s70, 122880
    s_cselect_b32 s76, 122880, 0
    s_sub_u32 s70, s70, s76
    s_mov_b32 s36, s10
    s_and_b32 s37, s11, 0xffff
    s_mov_b32 s38, 2097152
    s_mov_b32 s39, 0x20000
    s_mov_b32 s44, s22
    s_and_b32 s45, s23, 0xffff
    s_mov_b32 s46, 4194304
    s_mov_b32 s47, 0x20000
    s_mov_b32 s52, s20
    s_and_b32 s53, s21, 0xffff
    s_mov_b32 s54, 7340032
    s_mov_b32 s55, 0x20000
    s_cmp_eq_u32 s64, 0
    s_cselect_b32 s48, s16, s18
    s_cselect_b32 s49, s17, s19
    s_and_b32 s49, s49, 0xffff
    s_mov_b32 s51, 0x20000
    s_cmp_lt_u32 s97, 14
    s_cselect_b32 s50, 7340032, 0
    s_cselect_b32 s54, 7340032, 0
    s_lshr_b32 s76, s60, 2
    s_lshr_b32 s77, s61, 2
    s_add_u32 s76, s76, s77
    s_and_b32 s76, s76, 3
    s_lshl_b32 s76, s76, 2
    s_lshr_b32 s69, s69, s76
    s_and_b32 s69, s69, 15
    s_mul_i32 s76, s69, 43
    s_lshr_b32 s76, s76, 7
    s_mul_i32 s76, s76, 3
    s_sub_u32 s76, s69, s76
    s_mul_i32 s74, s76, 40960
    s_mul_i32 s76, s62, 10240
    s_add_u32 s76, s76, s74
    v_bfe_u32 v4, v2, 1, 3
    v_xor_b32 v4, v4, v3
    v_lshlrev_b32_e64 v4, 4, v4
    v_lshl_add_u32 v4, v2, 7, v4
    v_add_u32_e64 v72, s76, v4
    v_bfe_u32 v4, v1, 2, 2
    v_lshl_add_u32 v5, v3, 3, v4
    v_lshlrev_b32 v5, 7, v5
    v_lshrrev_b32 v4, 1, v4
    v_xor_b32_e64 v4, s64, v4
    v_lshl_add_u32 v5, v4, 6, v5
    v_bfe_u32 v4, v1, 4, 1
    v_xor_b32_e64 v4, v4, v3
    v_lshl_add_u32 v5, v4, 5, v5
    v_and_b32_e64 v4, 3, v1
    v_lshl_add_u32 v5, v4, 3, v5
    s_add_u32 s76, s74, 4096
    v_add_u32_e64 v73, s76, v5
    v_mul_u32_u24 v74, 28800, v3
    v_lshl_add_u32 v74, v2, 3, v74
    v_lshrrev_b32 v4, 4, v1
    v_and_b32 v5, 15, v1
    v_mul_u32_u24 v75, 460800, v4
    v_lshl_add_u32 v75, v5, 4, v75
    v_mul_u32_u24 v76, 114688, v4
    v_lshl_add_u32 v76, v5, 4, v76
    v_lshlrev_b32_e64 v77, 3, v1
    s_mul_i32 s75, s98, 458752
    s_lshl_b32 s77, s97, 9
    s_add_u32 s75, s75, s77
    s_lshl_b32 s77, s63, 8
    s_add_u32 s75, s75, s77
    s_lshl_b32 s96, s97, 19
    s_lshl_b32 s77, s98, 15
    s_add_u32 s96, s96, s77
    s_lshl_b32 s77, s62, 9
    s_add_u32 s96, s96, s77
    s_mov_b32 s68, 1
    s_getreg_b32 s101, hwreg(HW_REG_XCC_ID, 0, 4)
    v_and_b32 v4, 15, v1
    v_lshl_add_u32 v5, v4, 4, s61
    s_lshl_b32 s76, s60, 4
    v_add_u32 v4, s76, v4
    v_cmp_gt_u32 vcc, 16, v1
    s_nop 1
    v_cndmask_b32_e64 v4, v4, v5, vcc
    v_mul_u32_u24 v4, 28800, v4
    v_add_u32 v4, 28672, v4
    s_lshr_b32 s76, s97, 1
    s_lshl_b32 s76, s76, 5
    v_add_u32_e64 v5, s76, v2
    v_mul_u32_u24 v5, 9344, v5
    v_add_u32 v5, 8397824, v5
    v_cmp_gt_u32 vcc, 32, v1
    s_nop 1
    v_cndmask_b32 v90, v5, v4, vcc
    s_waitcnt vmcnt(10)
    s_barrier
L_hloop:
    s_cmp_eq_u32 s68, s69
    s_cbranch_scc1 L_special
    s_and_b32 s72, s66, 15
    s_mov_b32 m0, s70
    s_lshl_b32 s71, s72, 7
    buffer_load_dwordx4 v16, s[28:31], s71 offen offset:0 lds
    s_mul_i32 s72, s72, 393216
    s_lshr_b64 s[66:67], s[66:67], 4
    buffer_load_dwordx4 v17, s[28:31], s71 offen offset:1024 lds
    buffer_load_dwordx4 v18, s[28:31], s71 offen offset:2048 lds
    buffer_load_dwordx4 v19, s[28:31], s71 offen offset:3072 lds
    s_add_u32 m0, s70, 4096
    s_nop 0
    buffer_load_dwordx4 v20, s[32:35], s72 offen offset:0 lds
    buffer_load_dwordx4 v21, s[32:35], s72 offen offset:1024 lds
    buffer_load_dwordx4 v22, s[32:35], s72 offen offset:2048 lds
    buffer_load_dwordx4 v23, s[32:35], s72 offen offset:3072 lds
    s_add_u32 m0, s70, 8192
    s_nop 0
    buffer_load_dwordx4 v24, s[32:35], s72 offen offset:0 lds
    buffer_load_dwordx4 v25, s[32:35], s72 offen offset:1024 lds
    s_add_u32 s70, s70, 40960
    s_cmp_ge_u32 s70, 122880
    s_cselect_b32 s76, 122880, 0
    s_sub_u32 s70, s70, s76
    s_add_u32 s68, s68, 1
    s_cmp_lt_u32 s68, 14
    s_waitcnt vmcnt(10)
L_hbar:
    s_barrier
    s_cbranch_scc1 L_hloop
    v_add_co_u32 v88, vcc, 1, v88
    s_nop 1
    v_addc_co_u32 v89, vcc, 0, v89, vcc
    s_mov_b32 s88, 0
L_spin_1:
    buffer_load_dwordx4 v[32:35], v90, s[40:43], 0 offen sc1
    s_waitcnt vmcnt(0)
    v_cmp_ne_u64 vcc, v[32:33], v[88:89]
    s_nop 0
    s_cbranch_vccz L_hello_ok_2
    s_add_u32 s88, s88, 1
    s_cmp_lt_u32 s88, 65536
    s_cbranch_scc1 L_spin_1
L_hello_ok_2:
    v_cmp_ne_u32_e64 vcc, s101, v34
    s_nop 0
    s_and_b32 s76, vcc_lo, 0xffff
    s_cselect_b32 s100, 0, 1
    s_cmp_eq_u32 vcc_hi, 0
    s_cselect_b32 s76, 2, 0
    s_or_b32 s100, s100, s76
    v_mov_b32 v4, s100
    v_mov_b32 v5, 0
    ds_write_b32 v5, v4 offset:53248
    s_mul_i32 s80, s60, 460800
    s_lshl_b32 s81, s62, 8
    s_add_u32 s80, s80, s81
    buffer_load_dwordx2 v[32:33], v74, s[40:43], s80 offen offset:0 sc1
    s_add_u32 s80, s80, 57600
    buffer_load_dwordx2 v[34:35], v74, s[40:43], s80 offen offset:0 sc1
    s_add_u32 s80, s80, 57600
    buffer_load_dwordx2 v[36:37], v74, s[40:43], s80 offen offset:0 sc1
    s_add_u32 s80, s80, 57600
    buffer_load_dwordx2 v[38:39], v74, s[40:43], s80 offen offset:0 sc1
    s_add_u32 s80, s80, 57600
    buffer_load_dwordx2 v[40:41], v74, s[40:43], s80 offen offset:0 sc1
    s_add_u32 s80, s80, 57600
    buffer_load_dwordx2 v[42:43], v74, s[40:43], s80 offen offset:0 sc1
    s_add_u32 s80, s80, 57600
    buffer_load_dwordx2 v[44:45], v74, s[40:43], s80 offen offset:0 sc1
    s_add_u32 s80, s80, 57600
    buffer_load_dwordx2 v[46:47], v74, s[40:43], s80 offen offset:0 sc1
    s_mul_i32 s80, s61, 28800
    s_add_u32 s80, s80, s81
    buffer_load_dwordx4 v[48:51], v75, s[40:43], s80 offen offset:1024 sc1
    s_add_u32 s80, s80, 1843200
    buffer_load_dwordx4 v[52:55], v75, s[40:43], s80 offen offset:1024 sc1
    s_add_u32 s80, s80, 1843200
    buffer_load_dwordx4 v[56:59], v75, s[40:43], s80 offen offset:1024 sc1
    s_add_u32 s80, s80, 1843200
    buffer_load_dwordx4 v[60:63], v75, s[40:43], s80 offen offset:1024 sc1
    s_barrier
    s_lshl_b32 s78, s62, 11
    s_add_u32 s79, s78, s73
    s_add_u32 s79, s79, 4096
    s_bitcmp1_b32 s100, 0
    s_cbranch_scc1 L_loc_3
    buffer_store_dwordx4 v[28:31], v12, s[40:43], s79 offen offset:0 sc1
    buffer_store_dwordx4 v[28:31], v12, s[40:43], s79 offen offset:1024 sc1
    s_branch L_pubd_4
L_loc_3:
    buffer_store_dwordx4 v[28:31], v12, s[40:43], s79 offen offset:0
    buffer_store_dwordx4 v[28:31], v12, s[40:43], s79 offen offset:1024
L_pubd_4:
    s_add_u32 s79, s78, s99
    s_bitcmp1_b32 s100, 1
    s_cbranch_scc1 L_loc_5
    buffer_store_dwordx4 v[28:31], v12, s[40:43], s79 offen offset:1024 sc1
    buffer_store_dwordx4 v[28:31], v12, s[40:43], s79 offen offset:2048 sc1
    s_branch L_pubd_6
L_loc_5:
    buffer_store_dwordx4 v[28:31], v12, s[40:43], s79 offen offset:1024
    buffer_store_dwordx4 v[28:31], v12, s[40:43], s79 offen offset:2048
L_pubd_6:
    s_lshl_b32 s79, s62, 8
    s_add_u32 s79, s79, s99
    s_mov_b64 exec, 0xffff
    buffer_store_dwordx4 v[28:31], v12, s[40:43], s79 offen sc1
    s_mov_b64 exec, -1
    s_lshl_b32 s79, s62, 12
    s_add_u32 s79, s79, s73
    s_add_u32 s79, s79, 12288
    buffer_store_dwordx4 v[28:31], v12, s[40:43], s79 offen offset:0 sc1
    buffer_store_dwordx4 v[28:31], v12, s[40:43], s79 offen offset:1024 sc1
    buffer_store_dwordx4 v[28:31], v12, s[40:43], s79 offen offset:2048 sc1
    buffer_store_dwordx4 v[28:31], v12, s[40:43], s79 offen offset:3072 sc1
    s_waitcnt vmcnt(9)
    s_mov_b32 s88, 0
    s_branch L_g1first_7
L_g1_8:
    s_mul_i32 s80, s60, 460800
    s_lshl_b32 s81, s62, 8
    s_add_u32 s80, s80, s81
    buffer_load_dwordx2 v[32:33], v74, s[40:43], s80 offen offset:0 sc1
    s_add_u32 s80, s80, 57600
    buffer_load_dwordx2 v[34:35], v74, s[40:43], s80 offen offset:0 sc1
    s_add_u32 s80, s80, 57600
    buffer_load_dwordx2 v[36:37], v74, s[40:43], s80 offen offset:0 sc1
    s_add_u32 s80, s80, 57600
    buffer_load_dwordx2 v[38:39], v74, s[40:43], s80 offen offset:0 sc1
    s_add_u32 s80, s80, 57600
    buffer_load_dwordx2 v[40:41], v74, s[40:43], s80 offen offset:0 sc1
    s_add_u32 s80, s80, 57600
    buffer_load_dwordx2 v[42:43], v74, s[40:43], s80 offen offset:0 sc1
    s_add_u32 s80, s80, 57600
    buffer_load_dwordx2 v[44:45], v74, s[40:43], s80 offen offset:0 sc1
    s_add_u32 s80, s80, 57600
    buffer_load_dwordx2 v[46:47], v74, s[40:43], s80 offen offset:0 sc1
    s_mul_i32 s80, s61, 28800
    s_add_u32 s80, s80, s81
    buffer_load_dwordx4 v[48:51], v75, s[40:43], s80 offen offset:1024 sc1
    s_add_u32 s80, s80, 1843200
    buffer_load_dwordx4 v[52:55], v75, s[40:43], s80 offen offset:1024 sc1
    s_add_u32 s80, s80, 1843200
    buffer_load_dwordx4 v[56:59], v75, s[40:43], s80 offen offset:1024 sc1
    s_add_u32 s80, s80, 1843200
    buffer_load_dwordx4 v[60:63], v75, s[40:43], s80 offen offset:1024 sc1
    s_waitcnt vmcnt(0)
L_g1first_7:
    v_max3_u32 v4, v32, v34, v36
    v_max3_u32 v4, v4, v38, v40
    v_max3_u32 v4, v4, v42, v44
    v_max3_u32 v4, v4, v46, v48
    v_max3_u32 v4, v4, v50, v52
    v_max3_u32 v4, v4, v54, v56
    v_max3_u32 v4, v4, v58, v60
    v_max_u32 v4, v4, v62
    v_cmp_eq_u32 vcc, -1, v4
    s_nop 0
    s_cbranch_vccz L_ok_9
    s_add_u32 s88, s88, 1
    s_cmp_lt_u32 s88, 65536
    s_cbranch_scc1 L_g1_8
L_ok_9:
    v_add_f32 v32, v32, v40
    v_add_f32 v33, v33, v41
    v_add_f32 v34, v34, v42
    v_add_f32 v35, v35, v43
    v_add_f32 v36, v36, v44
    v_add_f32 v37, v37, v45
    v_add_f32 v38, v38, v46
    v_add_f32 v39, v39, v47
    v_add_f32 v32, v32, v36
    v_add_f32 v33, v33, v37
    v_add_f32 v34, v34, v38
    v_add_f32 v35, v35, v39
    v_add_f32 v32, v32, v34
    v_add_f32 v33, v33, v35
    v_add_f32 v48, v48, v56
    v_add_f32 v49, v49, v57
    v_add_f32 v50, v50, v58
    v_add_f32 v51, v51, v59
    v_add_f32 v52, v52, v60
    v_add_f32 v53, v53, v61
    v_add_f32 v54, v54, v62
    v_add_f32 v55, v55, v63
    v_add_f32 v48, v48, v52
    v_add_f32 v49, v49, v53
    v_add_f32 v50, v50, v54
    v_add_f32 v51, v51, v55
    v_add_f32 v49, v49, v51
    v_mov_b32 v5, v32
    v_mov_b32 v6, v33
    v_mov_b32 v51, v49
    v_permlane32_swap_b32 v48, v50
    v_permlane32_swap_b32 v32, v5
    v_permlane32_swap_b32 v33, v6
    v_permlane32_swap_b32 v49, v51
    v_add_f32 v48, v48, v50
    v_add_f32 v49, v49, v51
    v_add_f32 v32, v32, v5
    v_add_f32 v33, v33, v6
    v_permlane16_swap_b32 v48, v49
    v_add_f32_e64 v48, v48, v49
    v_cvt_pk_bf16_f32 v49, v48, v48
    v_and_b32 v49, s90, v49
    v_sub_f32 v49, v48, v49
    v_cvt_pk_bf16_f32 v50, v48, v49
    v_and_b32 v51, s90, v50
    v_sub_f32 v49, v49, v51
    v_cvt_pk_bf16_f32 v51, v49, 0
    v_bfe_u32 v4, v1, 4, 1
    v_lshl_add_u32 v4, v4, 1, v3
    v_min_u32 v4, 2, v4
    v_and_b32 v7, 15, v1
    v_lshlrev_b32 v7, 3, v7
    s_lshl_b32 s76, s62, 7
    v_lshl_add_u32 v4, v4, 9, v7
    v_add_u32_e64 v4, s76, v4
    ds_write_b64 v4, v[50:51] offset:50176
    v_mul_f32 v32, 0x3a800000, v32
    v_mul_f32 v33, 0x3a800000, v33
    v_fma_f32 v7, -v32, v32, v33
    v_max_f32_e64 v7, 0, v7
    v_cvt_pk_bf16_f32 v5, v32, v32
    v_and_b32_e64 v5, s90, v5
    v_cvt_pk_bf16_f32 v7, v7, v7
    v_and_b32_e64 v7, s90, v7
    v_add_f32 v7, 0x3727c5ac, v7
    v_cvt_pk_bf16_f32 v7, v7, v7
    v_and_b32 v7, s90, v7
    v_sqrt_f32_e64 v7, v7
    s_nop 0
    v_cvt_pk_bf16_f32 v7, v7, v7
    v_and_b32 v7, s90, v7
    v_rcp_f32 v9, v7
    v_xor_b32 v5, 0x80000000, v5
    v_cvt_pk_bf16_f32 v8, v5, v5
    s_lshl_b32 s76, s62, 8
    v_lshl_add_u32 v6, v2, 3, s76
    ds_write_b64 v6, v[8:9] offset:49152
    s_waitcnt lgkmcnt(0)
    s_barrier
    s_add_u32 s78, s65, 0
    s_and_b32 s78, s78, 15
    s_lshl_b32 s78, s78, 17
    s_lshl_b32 s79, s62, 11
    s_add_u32 m0, s79, 57344
    s_add_u32 s79, s78, 15360
    buffer_load_dwordx4 v26, s[36:39], s78 offen lds
    buffer_load_dwordx4 v26, s[36:39], s79 offen offset:1024 lds
    s_add_u32 s78, s65, 1
    s_and_b32 s78, s78, 15
    s_lshl_b32 s78, s78, 17
    s_lshl_b32 s79, s62, 11
    s_add_u32 m0, s79, 65536
    s_add_u32 s79, s78, 15360
    buffer_load_dwordx4 v26, s[36:39], s78 offen lds
    buffer_load_dwordx4 v26, s[36:39], s79 offen offset:1024 lds
    s_add_u32 s78, s65, 2
    s_and_b32 s78, s78, 15
    s_lshl_b32 s78, s78, 17
    s_lshl_b32 s79, s62, 11
    s_add_u32 m0, s79, 73728
    s_add_u32 s79, s78, 15360
    buffer_load_dwordx4 v26, s[36:39], s78 offen lds
    buffer_load_dwordx4 v26, s[36:39], s79 offen offset:1024 lds
    s_waitcnt vmcnt(6)
    s_lshl_b32 s76, s62, 2
    s_add_u32 s76, s76, s73
    v_mov_b32 v4, 0
    s_mov_b64 exec, 1
    s_bitcmp1_b32 s100, 0
    s_cbranch_scc1 L_loc_10
    buffer_store_dword v4, v4, s[40:43], s76 offen offset:2560 sc1
    s_branch L_pubd_11
L_loc_10:
    buffer_store_dword v4, v4, s[40:43], s76 offen offset:2560
L_pubd_11:
    s_mov_b64 exec, -1
    s_add_u32 s78, s65, 3
    s_and_b32 s78, s78, 15
    s_lshl_b32 s78, s78, 17
    s_lshl_b32 s79, s62, 11
    s_add_u32 m0, s79, 81920
    s_add_u32 s79, s78, 15360
    buffer_load_dwordx4 v26, s[36:39], s78 offen lds
    buffer_load_dwordx4 v26, s[36:39], s79 offen offset:1024 lds
    s_add_u32 s78, s65, 4
    s_and_b32 s78, s78, 15
    s_lshl_b32 s78, s78, 17
    s_lshl_b32 s79, s62, 11
    s_add_u32 m0, s79, 90112
    s_add_u32 s79, s78, 15360
    buffer_load_dwordx4 v26, s[36:39], s78 offen lds
    buffer_load_dwordx4 v26, s[36:39], s79 offen offset:1024 lds
    s_add_u32 s78, s65, 5
    s_and_b32 s78, s78, 15
    s_lshl_b32 s78, s78, 17
    s_lshl_b32 s79, s62, 11
    s_add_u32 m0, s79, 98304
    s_add_u32 s79, s78, 15360
    buffer_load_dwordx4 v26, s[36:39], s78 offen lds
    buffer_load_dwordx4 v26, s[36:39], s79 offen offset:1024 lds
    s_add_u32 s78, s65, 6
    s_and_b32 s78, s78, 15
    s_lshl_b32 s78, s78, 17
    s_lshl_b32 s79, s62, 11
    s_add_u32 m0, s79, 106496
    s_add_u32 s79, s78, 15360
    buffer_load_dwordx4 v26, s[36:39], s78 offen lds
    buffer_load_dwordx4 v26, s[36:39], s79 offen offset:1024 lds
    s_add_u32 s78, s65, 7
    s_and_b32 s78, s78, 15
    s_lshl_b32 s78, s78, 17
    s_lshl_b32 s79, s62, 11
    s_add_u32 m0, s79, 114688
    s_add_u32 s79, s78, 15360
    buffer_load_dwordx4 v26, s[36:39], s78 offen lds
    buffer_load_dwordx4 v26, s[36:39], s79 offen offset:1024 lds
    s_add_u32 s78, s65, 8
    s_and_b32 s78, s78, 15
    s_lshl_b32 s78, s78, 17
    s_lshl_b32 s79, s62, 11
    s_add_u32 m0, s79, 122880
    s_add_u32 s79, s78, 15360
    buffer_load_dwordx4 v26, s[36:39], s78 offen lds
    buffer_load_dwordx4 v26, s[36:39], s79 offen offset:1024 lds
    s_add_u32 s78, s65, 9
    s_and_b32 s78, s78, 15
    s_lshl_b32 s78, s78, 17
    s_lshl_b32 s79, s62, 11
    s_add_u32 m0, s79, 131072
    s_add_u32 s79, s78, 15360
    buffer_load_dwordx4 v26, s[36:39], s78 offen lds
    buffer_load_dwordx4 v26, s[36:39], s79 offen offset:1024 lds
    s_add_u32 s78, s65, 10
    s_and_b32 s78, s78, 15
    s_lshl_b32 s78, s78, 17
    s_lshl_b32 s79, s62, 11
    s_add_u32 m0, s79, 139264
    s_add_u32 s79, s78, 15360
    buffer_load_dwordx4 v26, s[36:39], s78 offen lds
    buffer_load_dwordx4 v26, s[36:39], s79 offen offset:1024 lds
    s_add_u32 s78, s65, 11
    s_and_b32 s78, s78, 15
    s_lshl_b32 s78, s78, 17
    s_lshl_b32 s79, s62, 11
    s_add_u32 m0, s79, 147456
    s_add_u32 s79, s78, 15360
    buffer_load_dwordx4 v26, s[36:39], s78 offen lds
    buffer_load_dwordx4 v26, s[36:39], s79 offen offset:1024 lds
    s_add_u32 s78, s65, 12
    s_and_b32 s78, s78, 15
    s_lshl_b32 s78, s78, 17
    s_lshl_b32 s79, s62, 11
    s_add_u32 m0, s79, 155648
    s_add_u32 s79, s78, 15360
    buffer_load_dwordx4 v26, s[36:39], s78 offen lds
    buffer_load_dwordx4 v26, s[36:39], s79 offen offset:1024 lds
    v_and_b32_e64 v65, 15, v1
    v_mul_u32_u24 v65, 460800, v65
    s_mul_i32 s80, s61, 28800
    s_lshl_b32 s82, s62, 2
    s_add_u32 s82, s82, s80
    v_mul_u32_u24 v66, 460800, v3
    v_lshl_add_u32 v66, v2, 2, v66
    v_and_b32 v4, 7, v1
    v_lshrrev_b32 v5, 4, v1
    v_lshlrev_b32_e64 v5, 2, v5
    v_lshl_add_u32 v67, v4, 4, v5
    s_barrier
    buffer_load_dword v64, v65, s[40:43], s82 offen offset:2560 sc1
    s_barrier
    v_mov_b32 v4, s89
    v_lshlrev_b32 v5, 2, v1
    ds_write_b32 v5, v4 offset:24832
    s_mov_b32 s88, 0
    s_branch L_p2first_12
L_p2_13:
    buffer_load_dword v64, v65, s[40:43], s82 offen offset:2560 sc1
L_p2first_12:
    s_waitcnt vmcnt(0)
    v_cmp_eq_u32_e64 vcc, -1, v64
    s_nop 0
    s_cbranch_vccz L_ok_14
    s_add_u32 s88, s88, 1
    s_cmp_lt_u32 s88, 65536
    s_cbranch_scc1 L_p2_13
L_ok_14:
    s_lshl_b32 s76, s62, 11
    s_lshl_b32 s77, s60, 7
    s_add_u32 s76, s76, s77
    s_add_u32 s76, s76, s80
    s_add_u32 s76, s76, 4096
    s_add_u32 s77, s76, 3686400
    s_mov_b32 s78, 0x00003f80
    s_mov_b32 s79, 0x3f800000
    s_mov_b32 s88, 0
L_spin_15:
    buffer_load_dwordx4 v[32:35], v13, s[40:43], s76 offen sc1
    buffer_load_dwordx4 v[36:39], v13, s[40:43], s77 offen sc1
    s_waitcnt vmcnt(0)
    v_max_u32 v4, v32, v36
    v_cmp_eq_u32_e64 vcc, -1, v4
    s_nop 0
    s_cbranch_vccz L_ok_16
    s_add_u32 s88, s88, 1
    s_cmp_lt_u32 s88, 65536
    s_cbranch_scc1 L_spin_15
L_ok_16:
    v_dot2_f32_bf16 v48, v32, s78, 0
    v_dot2_f32_bf16 v49, v32, s79, 0
    v_dot2_f32_bf16 v50, v33, s78, 0
    v_dot2_f32_bf16 v51, v33, s79, 0
    v_dot2_f32_bf16 v52, v34, s78, 0
    v_dot2_f32_bf16 v53, v34, s79, 0
    v_dot2_f32_bf16 v54, v35, s78, 0
    v_dot2_f32_bf16 v55, v35, s79, 0
    v_dot2_f32_bf16 v48, v36, s78, v48
    v_dot2_f32_bf16 v49, v36, s79, v49
    v_dot2_f32_bf16 v50, v37, s78, v50
    v_dot2_f32_bf16 v51, v37, s79, v51
    v_dot2_f32_bf16 v52, v38, s78, v52
    v_dot2_f32_bf16 v53, v38, s79, v53
    v_dot2_f32_bf16 v54, v39, s78, v54
    v_dot2_f32_bf16 v55, v39, s79, v55
    s_lshl_b32 s76, s62, 7
    s_add_u32 s76, s76, s73
    v_permlane32_swap_b32 v48, v52
    v_permlane32_swap_b32 v49, v53
    v_permlane32_swap_b32 v50, v54
    v_permlane32_swap_b32 v51, v55
    v_add_f32 v48, v48, v52
    v_add_f32 v49, v49, v53
    v_add_f32 v50, v50, v54
    v_add_f32 v51, v51, v55
    s_nop 0
    v_permlane16_swap_b32 v48, v50
    v_permlane16_swap_b32 v49, v51
    v_add_f32 v48, v48, v50
    v_add_f32_e64 v49, v49, v51
    s_nop 0
    v_add_f32_dpp v48, v48, v48 row_ror:8 row_mask:0xf bank_mask:0xf
    v_add_f32_dpp v49, v49, v49 row_ror:8 row_mask:0xf bank_mask:0xf
    v_cvt_pk_bf16_f32 v48, v48, v49
    s_bitcmp1_b32 s100, 0
    s_cbranch_scc1 L_loc_17
    buffer_store_dword v48, v67, s[40:43], s76 offen offset:3072 sc1
    s_branch L_pubd_18
L_loc_17:
    buffer_store_dword v48, v67, s[40:43], s76 offen offset:3072
L_pubd_18:
    s_mov_b32 s88, 0
L_spin_19:
    s_lshl_b32 s81, s62, 7
    s_add_u32 s81, s81, s80
    buffer_load_dword v40, v66, s[40:43], s81 offen offset:2048 sc1
    s_add_u32 s81, s81, 921600
    buffer_load_dword v41, v66, s[40:43], s81 offen offset:2048 sc1
    s_add_u32 s81, s81, 921600
    buffer_load_dword v42, v66, s[40:43], s81 offen offset:2048 sc1
    s_add_u32 s81, s81, 921600
    buffer_load_dword v43, v66, s[40:43], s81 offen offset:2048 sc1
    s_add_u32 s81, s81, 921600
    buffer_load_dword v44, v66, s[40:43], s81 offen offset:2048 sc1
    s_add_u32 s81, s81, 921600
    buffer_load_dword v45, v66, s[40:43], s81 offen offset:2048 sc1
    s_add_u32 s81, s81, 921600
    buffer_load_dword v46, v66, s[40:43], s81 offen offset:2048 sc1
    s_add_u32 s81, s81, 921600
    buffer_load_dword v47, v66, s[40:43], s81 offen offset:2048 sc1
    v_and_b32 v6, 19, v2
    v_lshlrev_b32 v6, 1, v6
    v_bfe_u32 v5, v2, 2, 1
    v_lshl_add_u32 v6, v5, 4, v6
    v_and_b32 v5, 8, v2
    s_lshl_b32 s77, s62, 6
    v_add3_u32 v6, v6, v5, s77
    s_waitcnt vmcnt(0)
    v_max3_u32 v4, v40, v41, v42
    v_max3_u32 v4, v4, v43, v44
    v_max3_u32 v4, v4, v45, v46
    v_max_u32 v4, v4, v47
    v_cmp_eq_u32 vcc, -1, v4
    s_nop 0
    s_cbranch_vccz L_ok_20
    s_add_u32 s88, s88, 1
    s_cmp_lt_u32 s88, 65536
    s_cbranch_scc1 L_spin_19
L_ok_20:
    v_add_f32 v40, v40, v44
    v_add_f32 v41, v41, v45
    v_add_f32 v42, v42, v46
    v_add_f32 v43, v43, v47
    v_add_f32 v40, v40, v42
    v_add_f32 v41, v41, v43
    v_add_f32 v40, v40, v41
    v_mov_b32 v41, v40
    s_nop 1
    v_permlane32_swap_b32 v40, v41
    v_add_f32 v40, v40, v41
    v_cvt_pk_bf16_f32 v40, v40, v40
    ds_write_b16 v6, v40 offset:24576
    s_waitcnt lgkmcnt(0)
    s_barrier
    s_barrier
    s_add_u32 s78, s65, 13
    s_and_b32 s78, s78, 15
    s_lshl_b32 s78, s78, 17
    s_lshl_b32 s79, s62, 11
    s_add_u32 m0, s79, 32768
    s_add_u32 s79, s78, 15360
    buffer_load_dwordx4 v26, s[36:39], s78 offen lds
    buffer_load_dwordx4 v26, s[36:39], s79 offen offset:1024 lds
    s_add_u32 s78, s65, 14
    s_and_b32 s78, s78, 15
    s_lshl_b32 s78, s78, 17
    s_lshl_b32 s79, s62, 11
    s_add_u32 m0, s79, 40960
    s_add_u32 s79, s78, 15360
    buffer_load_dwordx4 v26, s[36:39], s78 offen lds
    buffer_load_dwordx4 v26, s[36:39], s79 offen offset:1024 lds
    s_add_u32 s78, s65, 15
    s_and_b32 s78, s78, 15
    s_lshl_b32 s78, s78, 17
    s_lshl_b32 s79, s62, 11
    s_add_u32 m0, s79, 49152
    s_add_u32 s79, s78, 15360
    buffer_load_dwordx4 v26, s[36:39], s78 offen lds
    buffer_load_dwordx4 v26, s[36:39], s79 offen offset:1024 lds
    s_lshl_b32 s78, s97, 18
    s_lshl_b32 s79, s62, 16
    s_add_u32 s78, s78, s79
    s_lshl_b32 s79, s98, 7
    s_add_u32 s78, s78, s79
    s_lshl_b32 s79, s62, 12
    s_add_u32 m0, s79, 0
    s_nop 0
    buffer_load_dwordx4 v78, s[28:31], s78 offen offset:0 lds
    s_add_u32 s78, s78, 15360
    buffer_load_dwordx4 v79, s[28:31], s78 offen offset:1024 lds
    s_add_u32 s78, s78, 15360
    buffer_load_dwordx4 v78, s[28:31], s78 offen offset:2048 lds
    s_add_u32 s78, s78, 15360
    buffer_load_dwordx4 v79, s[28:31], s78 offen offset:3072 lds
    s_cmp_eq_u32 s62, 0
    s_cbranch_scc0 L_nofo_21
    v_and_b32 v6, 15, v1
    v_mul_u32_u24 v6, 28800, v6
    v_lshrrev_b32_e64 v4, 4, v1
    v_lshl_add_u32 v6, v4, 7, v6
    s_mul_i32 s76, s97, 460800
    s_sleep 20
    s_mov_b32 s88, 0
L_spin_22:
    buffer_load_dword v7, v6, s[40:43], s76 offen offset:3584 sc1
    s_waitcnt vmcnt(0)
    v_cmp_eq_u32_e64 vcc, -1, v7
    s_nop 0
    s_cbranch_vccz L_ok_23
    s_add_u32 s88, s88, 1
    s_cmp_lt_u32 s88, 65536
    s_cbranch_scc1 L_spin_22
L_ok_23:
L_nofo_21:
    s_waitcnt vmcnt(0)
    s_barrier
    v_and_b32 v4, 15, v1
    v_lshrrev_b32 v5, 1, v4
    v_and_b32 v4, 1, v4
    v_lshlrev_b32_e64 v4, 5, v4
    v_lshl_add_u32 v16, v5, 7, v4
    v_mul_u32_u24 v17, 9344, v3
    v_lshl_add_u32 v17, v2, 2, v17
    v_lshrrev_b32 v4, 3, v1
    v_and_b32 v5, 7, v1
    v_lshlrev_b32_e64 v5, 4, v5
    v_mul_u32_u24 v18, 9344, v4
    v_add_u32_e64 v18, v18, v5
    v_bfe_u32 v6, v1, 4, 1
    v_lshl_add_u32 v6, v6, 1, v3
    v_lshl_add_u32 v19, v6, 2, v5
    s_mul_i32 s84, s97, 149504
    s_lshl_b32 s77, s98, 7
    s_add_u32 s84, s84, s77
    s_add_u32 s84, s84, 8388608
    s_lshl_b32 s85, s62, 10
    s_add_u32 s85, s85, s99
    s_add_u32 s85, s85, 5120
    s_and_b32 s87, s97, 1
    s_lshl_b32 s87, s87, 4
    s_add_u32 s87, s87, s98
    s_lshr_b32 s86, s97, 1
    s_mul_i32 s86, s86, 299008
    s_lshl_b32 s77, s87, 7
    s_add_u32 s86, s86, s77
    s_add_u32 s86, s86, 8393728
    s_barrier
    buffer_load_dwordx4 v[96:99], v76, s[48:51], s75 offen nt
    s_add_u32 s75, s75, 7168
    buffer_load_dwordx4 v[100:103], v76, s[48:51], s75 offen nt
    s_add_u32 s75, s75, 7168
    buffer_load_dwordx4 v[104:107], v76, s[48:51], s75 offen nt
    s_add_u32 s75, s75, 7168
    buffer_load_dwordx4 v[108:111], v76, s[48:51], s75 offen nt
    s_add_u32 s75, s75, 7168
    buffer_load_dwordx4 v[128:131], v76, s[48:51], s75 offen nt
    s_add_u32 s75, s75, 7168
    buffer_load_dwordx4 v[132:135], v76, s[48:51], s75 offen nt
    s_add_u32 s75, s75, 7168
    buffer_load_dwordx4 v[136:139], v76, s[48:51], s75 offen nt
    s_add_u32 s75, s75, 7168
    buffer_load_dwordx4 v[140:143], v76, s[48:51], s75 offen nt
    s_add_u32 s75, s75, 7168
    buffer_load_dwordx4 v[112:115], v76, s[48:51], s75 offen nt
    s_add_u32 s75, s75, 7168
    buffer_load_dwordx4 v[116:119], v76, s[48:51], s75 offen nt
    s_add_u32 s75, s75, 7168
    buffer_load_dwordx4 v[120:123], v76, s[48:51], s75 offen nt
    s_add_u32 s75, s75, 7168
    buffer_load_dwordx4 v[124:127], v76, s[48:51], s75 offen nt
    s_add_u32 s75, s75, 7168
    buffer_load_dwordx4 v[144:147], v76, s[48:51], s75 offen nt
    s_add_u32 s75, s75, 7168
    buffer_load_dwordx4 v[148:151], v76, s[48:51], s75 offen nt
    s_add_u32 s75, s75, 7168
    buffer_load_dwordx4 v[152:155], v76, s[48:51], s75 offen nt
    s_add_u32 s75, s75, 7168
    buffer_load_dwordx4 v[156:159], v76, s[48:51], s75 offen nt
    s_add_u32 s75, s75, 7168
    buffer_load_dwordx2 v[32:33], v77, s[52:55], s96 offen nt
    s_add_u32 s96, s96, 2048
    buffer_load_dwordx2 v[34:35], v77, s[52:55], s96 offen nt
    s_add_u32 s96, s96, 2048
    buffer_load_dwordx2 v[36:37], v77, s[52:55], s96 offen nt
    s_add_u32 s96, s96, 2048
    buffer_load_dwordx2 v[38:39], v77, s[52:55], s96 offen nt
    s_add_u32 s96, s96, 2048
    buffer_load_dwordx2 v[40:41], v77, s[52:55], s96 offen nt
    s_add_u32 s96, s96, 2048
    buffer_load_dwordx2 v[42:43], v77, s[52:55], s96 offen nt
    s_add_u32 s96, s96, 2048
    buffer_load_dwordx2 v[44:45], v77, s[52:55], s96 offen nt
    s_add_u32 s96, s96, 2048
    buffer_load_dwordx2 v[46:47], v77, s[52:55], s96 offen nt
    s_add_u32 s96, s96, 2048
    buffer_load_dwordx2 v[48:49], v77, s[52:55], s96 offen nt
    s_add_u32 s96, s96, 2048
    buffer_load_dwordx2 v[50:51], v77, s[52:55], s96 offen nt
    s_add_u32 s96, s96, 2048
    buffer_load_dwordx2 v[52:53], v77, s[52:55], s96 offen nt
    s_add_u32 s96, s96, 2048
    buffer_load_dwordx2 v[54:55], v77, s[52:55], s96 offen nt
    s_add_u32 s96, s96, 2048
    buffer_load_dwordx2 v[56:57], v77, s[52:55], s96 offen nt
    s_add_u32 s96, s96, 2048
    buffer_load_dwordx2 v[58:59], v77, s[52:55], s96 offen nt
    s_add_u32 s96, s96, 2048
    buffer_load_dwordx2 v[60:61], v77, s[52:55], s96 offen nt
    s_add_u32 s96, s96, 2048
    buffer_load_dwordx2 v[62:63], v77, s[52:55], s96 offen nt
    s_add_u32 s96, s96, 2048
    s_barrier
    s_waitcnt vmcnt(16)
    s_mov_b32 s78, 0x05040100
    s_mov_b32 s79, 0x07060302
    v_perm_b32 v160, v100, v96, s78
    v_perm_b32 v164, v100, v96, s79
    v_perm_b32 v168, v101, v97, s78
    v_perm_b32 v172, v101, v97, s79
    v_perm_b32 v176, v102, v98, s78
    v_perm_b32 v180, v102, v98, s79
    v_perm_b32 v184, v103, v99, s78
    v_perm_b32 v188, v103, v99, s79
    v_perm_b32 v161, v108, v104, s78
    v_perm_b32 v165, v108, v104, s79
    v_perm_b32 v169, v109, v105, s78
    v_perm_b32 v173, v109, v105, s79
    v_perm_b32 v177, v110, v106, s78
    v_perm_b32 v181, v110, v106, s79
    v_perm_b32 v185, v111, v107, s78
    v_perm_b32 v189, v111, v107, s79
    v_perm_b32 v162, v116, v112, s78
    v_perm_b32 v166, v116, v112, s79
    v_perm_b32 v170, v117, v113, s78
    v_perm_b32 v174, v117, v113, s79
    v_perm_b32 v178, v118, v114, s78
    v_perm_b32 v182, v118, v114, s79
    v_perm_b32 v186, v119, v115, s78
    v_perm_b32 v190, v119, v115, s79
    v_perm_b32 v163, v124, v120, s78
    v_perm_b32 v167, v124, v120, s79
    v_perm_b32 v171, v125, v121, s78
    v_perm_b32 v175, v125, v121, s79
    v_perm_b32 v179, v126, v122, s78
    v_perm_b32 v183, v126, v122, s79
    v_perm_b32 v187, v127, v123, s78
    v_perm_b32 v191, v127, v123, s79
    v_perm_b32 v192, v132, v128, s78
    v_perm_b32 v196, v132, v128, s79
    v_perm_b32 v200, v133, v129, s78
    v_perm_b32 v204, v133, v129, s79
    v_perm_b32 v208, v134, v130, s78
    v_perm_b32 v212, v134, v130, s79
    v_perm_b32 v216, v135, v131, s78
    v_perm_b32 v220, v135, v131, s79
    v_perm_b32 v193, v140, v136, s78
    v_perm_b32 v197, v140, v136, s79
    v_perm_b32 v201, v141, v137, s78
    v_perm_b32 v205, v141, v137, s79
    v_perm_b32 v209, v142, v138, s78
    v_perm_b32 v213, v142, v138, s79
    v_perm_b32 v217, v143, v139, s78
    v_perm_b32 v221, v143, v139, s79
    v_perm_b32 v194, v148, v144, s78
    v_perm_b32 v198, v148, v144, s79
    v_perm_b32 v202, v149, v145, s78
    v_perm_b32 v206, v149, v145, s79
    v_perm_b32 v210, v150, v146, s78
    v_perm_b32 v214, v150, v146, s79
    v_perm_b32 v218, v151, v147, s78
    v_perm_b32 v222, v151, v147, s79
    v_perm_b32 v195, v156, v152, s78
    v_perm_b32 v199, v156, v152, s79
    v_perm_b32 v203, v157, v153, s78
    v_perm_b32 v207, v157, v153, s79
    v_perm_b32 v211, v158, v154, s78
    v_perm_b32 v215, v158, v154, s79
    v_perm_b32 v219, v159, v155, s78
    v_perm_b32 v223, v159, v155, s79
    v_mov_b32 v5, 0
    s_lshl_b32 s76, s63, 10
    s_lshl_b32 s77, s64, 6
    s_add_u32 s76, s76, s77
    s_add_u32 s76, s76, s99
    s_mov_b64 s[80:81], 0xffff
    s_barrier
    ds_read_b128 v[64:67], v12 offset:28672
    ds_read_b128 v[68:71], v12 offset:29696
    ds_read_b128 v[8:11], v5 offset:25632
    s_waitcnt lgkmcnt(2)
    v_mfma_f32_16x16x32_bf16 v[96:99], v[64:67], v[160:163], 0
    v_mfma_f32_16x16x32_bf16 v[100:103], v[64:67], v[164:167], 0
    v_mfma_f32_16x16x32_bf16 v[104:107], v[64:67], v[168:171], 0
    s_waitcnt lgkmcnt(0)
    v_mfma_f32_16x16x32_bf16 v[108:111], v[64:67], v[172:175], 0
    v_readfirstlane_b32 s92, v8
    v_mfma_f32_16x16x32_bf16 v[112:115], v[64:67], v[176:179], 0
    v_readfirstlane_b32 s91, v9
    v_mfma_f32_16x16x32_bf16 v[116:119], v[64:67], v[180:183], 0
    v_readfirstlane_b32 s93, v10
    v_mfma_f32_16x16x32_bf16 v[120:123], v[64:67], v[184:187], 0
    v_mfma_f32_16x16x32_bf16 v[124:127], v[64:67], v[188:191], 0
    s_lshr_b32 s78, s92, 2
    s_lshl_b32 s78, s78, 4
    v_mfma_f32_16x16x32_bf16 v[96:99], v[68:71], v[192:195], v[96:99]
    s_and_b32 s77, s92, 3
    v_mfma_f32_16x16x32_bf16 v[100:103], v[68:71], v[196:199], v[100:103]
    v_mfma_f32_16x16x32_bf16 v[104:107], v[68:71], v[200:203], v[104:107]
    v_mfma_f32_16x16x32_bf16 v[108:111], v[68:71], v[204:207], v[108:111]
    v_mfma_f32_16x16x32_bf16 v[112:115], v[68:71], v[208:211], v[112:115]
    v_mfma_f32_16x16x32_bf16 v[116:119], v[68:71], v[212:215], v[116:119]
    v_mfma_f32_16x16x32_bf16 v[120:123], v[68:71], v[216:219], v[120:123]
    v_mfma_f32_16x16x32_bf16 v[124:127], v[68:71], v[220:223], v[124:127]
    s_cmp_ge_u32 s97, 14
    s_cbranch_scc1 L_final
    s_cmp_eq_u32 s77, 0
    s_cbranch_scc0 L_sel_25
    v_mov_b32 v64, v96
    v_mov_b32 v65, v100
    v_mov_b32 v66, v104
    v_mov_b32 v67, v108
    v_mov_b32 v68, v112
    v_mov_b32 v69, v116
    v_mov_b32 v70, v120
    v_mov_b32 v71, v124
    s_branch L_seldone_24
L_sel_25:
    s_cmp_eq_u32 s77, 1
    s_cbranch_scc0 L_sel_26
    v_mov_b32 v64, v97
    v_mov_b32 v65, v101
    v_mov_b32 v66, v105
    v_mov_b32 v67, v109
    v_mov_b32 v68, v113
    v_mov_b32 v69, v117
    v_mov_b32 v70, v121
    v_mov_b32 v71, v125
    s_branch L_seldone_24
L_sel_26:
    s_cmp_eq_u32 s77, 2
    s_cbranch_scc0 L_sel_27
    v_mov_b32 v64, v98
    v_mov_b32 v65, v102
    v_mov_b32 v66, v106
    v_mov_b32 v67, v110
    v_mov_b32 v68, v114
    v_mov_b32 v69, v118
    v_mov_b32 v70, v122
    v_mov_b32 v71, v126
    s_branch L_seldone_24
L_sel_27:
    v_mov_b32 v64, v99
    v_mov_b32 v65, v103
    v_mov_b32 v66, v107
    v_mov_b32 v67, v111
    v_mov_b32 v68, v115
    v_mov_b32 v69, v119
    v_mov_b32 v70, v123
    v_mov_b32_e64 v71, v127
L_seldone_24:
    s_lshl_b64 exec, s[80:81], s78
    s_bitcmp1_b32 s100, 1
    s_cbranch_scc1 L_loc_29
    buffer_store_dwordx4 v[64:67], v16, s[40:43], s76 offen offset:3072 sc1
    buffer_store_dwordx4 v[68:71], v16, s[40:43], s76 offen offset:3088 sc1
    s_branch L_pubd_30
L_loc_29:
    buffer_store_dwordx4 v[64:67], v16, s[40:43], s76 offen offset:3072
    buffer_store_dwordx4 v[68:71], v16, s[40:43], s76 offen offset:3088
L_pubd_30:
    s_mov_b64 exec, -1
    s_waitcnt vmcnt(2)
    s_mov_b32 s78, 0x05040100
    s_mov_b32 s79, 0x07060302
    v_perm_b32 v224, v34, v32, s78
    v_perm_b32 v225, v34, v32, s79
    v_perm_b32 v226, v35, v33, s78
    v_perm_b32 v227, v35, v33, s79
    v_perm_b32 v228, v38, v36, s78
    v_perm_b32 v229, v38, v36, s79
    v_perm_b32 v230, v39, v37, s78
    v_perm_b32 v231, v39, v37, s79
    v_perm_b32 v232, v42, v40, s78
    v_perm_b32 v233, v42, v40, s79
    v_perm_b32 v234, v43, v41, s78
    v_perm_b32 v235, v43, v41, s79
    v_perm_b32 v236, v46, v44, s78
    v_perm_b32 v237, v46, v44, s79
    v_perm_b32 v238, v47, v45, s78
    v_perm_b32 v239, v47, v45, s79
    v_perm_b32 v240, v50, v48, s78
    v_perm_b32 v241, v50, v48, s79
    v_perm_b32 v242, v51, v49, s78
    v_perm_b32 v243, v51, v49, s79
    v_perm_b32 v244, v54, v52, s78
    v_perm_b32 v245, v54, v52, s79
    v_perm_b32 v246, v55, v53, s78
    v_perm_b32 v247, v55, v53, s79
    v_perm_b32 v248, v58, v56, s78
    v_perm_b32 v249, v58, v56, s79
    v_perm_b32 v250, v59, v57, s78
    v_perm_b32 v251, v59, v57, s79
    v_perm_b32 v252, v62, v60, s78
    v_perm_b32 v253, v62, v60, s79
    v_perm_b32 v254, v63, v61, s78
    v_perm_b32 v255, v63, v61, s79
    s_mov_b32 s88, 0
L_spin_31:
    s_mov_b32 s76, s84
    buffer_load_dword v32, v17, s[40:43], s76 offen offset:3072 sc1
    s_add_u32 s76, s76, 18688
    buffer_load_dword v33, v17, s[40:43], s76 offen offset:3072 sc1
    s_add_u32 s76, s76, 18688
    buffer_load_dword v34, v17, s[40:43], s76 offen offset:3072 sc1
    s_add_u32 s76, s76, 18688
    buffer_load_dword v35, v17, s[40:43], s76 offen offset:3072 sc1
    s_add_u32 s76, s76, 18688
    buffer_load_dword v36, v17, s[40:43], s76 offen offset:3072 sc1
    s_add_u32 s76, s76, 18688
    buffer_load_dword v37, v17, s[40:43], s76 offen offset:3072 sc1
    s_add_u32 s76, s76, 18688
    buffer_load_dword v38, v17, s[40:43], s76 offen offset:3072 sc1
    s_add_u32 s76, s76, 18688
    buffer_load_dword v39, v17, s[40:43], s76 offen offset:3072 sc1
    s_waitcnt vmcnt(0)
    v_max3_u32 v4, v32, v33, v34
    v_max3_u32 v4, v4, v35, v36
    v_max3_u32 v4, v4, v37, v38
    v_max_u32 v4, v4, v39
    v_cmp_eq_u32_e64 vcc, -1, v4
    s_nop 0
    s_cbranch_vccz L_ok_32
    s_add_u32 s88, s88, 1
    s_cmp_lt_u32 s88, 65536
    s_cbranch_scc1 L_spin_31
L_ok_32:
    v_pk_add_f32 v[32:33], v[32:33], v[36:37]
    v_pk_add_f32 v[34:35], v[34:35], v[38:39]
    v_pk_add_f32 v[32:33], v[32:33], v[34:35]
    v_add_f32 v32, v32, v33
    v_mov_b32 v33, v32
    s_nop 1
    v_permlane32_swap_b32 v32, v33
    v_add_f32 v32, v32, v33
    v_cvt_pk_bf16_f32 v32, v32, v32
    v_and_b32 v32, s90, v32
    v_mov_b32 v33, v32
    v_mul_f32 v4, 0xbfb8aa3b, v32
    v_exp_f32 v4, v4
    v_permlane16_swap_b32 v32, v33
    v_add_f32 v4, 1.0, v4
    v_rcp_f32 v4, v4
    s_nop 0
    v_mul_f32 v4, v4, v32
    v_cvt_pk_bf16_f32 v4, v4, v4
    v_and_b32 v4, s90, v4
    v_mul_f32_e64 v4, v4, v33
    s_nop 1
    v_mov_b32_dpp v5, v4 quad_perm:[1,0,3,2] row_mask:0xf bank_mask:0xf
    v_cvt_pk_bf16_f32 v4, v4, v5
    s_nop 0
    v_readlane_b32 s76, v4, 0
    v_readlane_b32 s77, v4, 2
    v_readlane_b32 s78, v4, 4
    v_readlane_b32 s79, v4, 6
    v_readlane_b32 s80, v4, 8
    v_readlane_b32 s81, v4, 10
    v_readlane_b32 s82, v4, 12
    v_readlane_b32 s83, v4, 14
    v_dot2_f32_bf16 v40, v224, s76, 0
    v_dot2_f32_bf16 v41, v225, s76, 0
    v_dot2_f32_bf16 v42, v226, s76, 0
    v_dot2_f32_bf16 v43, v227, s76, 0
    v_dot2_f32_bf16 v40, v228, s77, v40
    v_dot2_f32_bf16 v41, v229, s77, v41
    v_dot2_f32_bf16 v42, v230, s77, v42
    v_dot2_f32_bf16 v43, v231, s77, v43
    v_dot2_f32_bf16 v40, v232, s78, v40
    v_dot2_f32_bf16 v41, v233, s78, v41
    v_dot2_f32_bf16 v42, v234, s78, v42
    v_dot2_f32_bf16 v43, v235, s78, v43
    v_dot2_f32_bf16 v40, v236, s79, v40
    v_dot2_f32_bf16 v41, v237, s79, v41
    v_dot2_f32_bf16 v42, v238, s79, v42
    v_dot2_f32_bf16 v43, v239, s79, v43
    v_dot2_f32_bf16 v40, v240, s80, v40
    v_dot2_f32_bf16 v41, v241, s80, v41
    v_dot2_f32_bf16 v42, v242, s80, v42
    v_dot2_f32_bf16 v43, v243, s80, v43
    v_dot2_f32_bf16 v40, v244, s81, v40
    v_dot2_f32_bf16 v41, v245, s81, v41
    v_dot2_f32_bf16 v42, v246, s81, v42
    v_dot2_f32_bf16 v43, v247, s81, v43
    v_dot2_f32_bf16 v40, v248, s82, v40
    v_dot2_f32_bf16 v41, v249, s82, v41
    v_dot2_f32_bf16 v42, v250, s82, v42
    v_dot2_f32_bf16 v43, v251, s82, v43
    v_dot2_f32_bf16 v40, v252, s83, v40
    v_dot2_f32_bf16 v41, v253, s83, v41
    v_dot2_f32_bf16 v42, v254, s83, v42
    v_dot2_f32_bf16 v43, v255, s83, v43
    s_bitcmp1_b32 s100, 1
    s_cbranch_scc1 L_loc_33
    s_nop 0
    buffer_store_dwordx4 v[40:43], v12, s[40:43], s85 offen sc1
    s_branch L_pubd_34
L_loc_33:
    s_nop 0
    buffer_store_dwordx4 v[40:43], v12, s[40:43], s85 offen
L_pubd_34:
    s_cmp_eq_u32 s62, 0
    s_cbranch_scc0 L_hby
    s_mov_b32 s88, 0
L_spin_35:
    s_mov_b32 s76, s86
    buffer_load_dwordx4 v[48:51], v18, s[40:43], s76 offen sc1
    s_add_u32 s76, s76, 74752
    buffer_load_dwordx4 v[52:55], v18, s[40:43], s76 offen sc1
    s_add_u32 s76, s76, 74752
    buffer_load_dwordx4 v[56:59], v18, s[40:43], s76 offen sc1
    s_add_u32 s76, s76, 74752
    buffer_load_dwordx4 v[60:63], v18, s[40:43], s76 offen sc1
    s_waitcnt vmcnt(0)
    v_max3_u32 v4, v48, v52, v56
    v_max_u32 v4, v4, v60
    v_cmp_eq_u32 vcc, -1, v4
    s_nop 0
    s_cbranch_vccz L_ok_36
    s_add_u32 s88, s88, 1
    s_cmp_lt_u32 s88, 65536
    s_cbranch_scc1 L_spin_35
L_ok_36:
    v_pk_add_f32 v[48:49], v[48:49], v[56:57]
    v_pk_add_f32 v[50:51], v[50:51], v[58:59]
    v_pk_add_f32 v[52:53], v[52:53], v[60:61]
    v_pk_add_f32 v[54:55], v[54:55], v[62:63]
    v_pk_add_f32 v[48:49], v[48:49], v[52:53]
    v_pk_add_f32 v[50:51], v[50:51], v[54:55]
    s_nop 0
    v_permlane32_swap_b32 v48, v49
    v_permlane32_swap_b32 v50, v51
    v_add_f32 v48, v48, v49
    v_add_f32 v50, v50, v51
    s_nop 1
    v_permlane16_swap_b32 v48, v50
    v_add_f32 v48, v48, v50
    s_nop 1
    v_add_f32_dpp v48, v48, v48 row_ror:8 row_mask:0xf bank_mask:0xf
    buffer_store_dword v48, v19, s[40:43], s99 offen offset:512 sc1
L_hby:
    s_barrier
    s_branch L_hfin
L_final:
    s_barrier
    s_cmp_eq_u32 s62, 1
    s_cbranch_scc0 L_noep_37
    s_cmp_eq_u32 s87, 0
    s_cbranch_scc0 L_noep_37
    v_mov_b32 v4, 13631488
    s_mov_b64 exec, 1
    buffer_store_dwordx2 v[88:89], v4, s[40:43], 0 offen sc1
    s_mov_b64 exec, -1
L_noep_37:
    s_cmp_eq_u32 s62, 0
    s_cbranch_scc0 L_hfin
    v_mov_b32 v8, s93
    v_cvt_pk_bf16_f32 v8, v8, v8
    v_and_b32_e64 v8, s90, v8
    v_mul_f32 v8, 0xbfb8aa3b, v8
    v_exp_f32 v8, v8
    s_nop 0
    v_add_f32 v8, 1.0, v8
    v_rcp_f32_e64 v8, v8
    s_nop 0
    v_cvt_pk_bf16_f32 v8, v8, v8
    v_and_b32 v8, s90, v8
    s_lshl_b32 s76, s92, 4
    s_lshr_b32 s77, s87, 1
    s_add_u32 s76, s76, s77
    s_mul_i32 s76, s76, 9344
    s_add_u32 s76, s76, 8388608
    s_and_b32 s77, s87, 1
    s_lshl_b32 s77, s77, 5
    s_add_u32 s76, s76, s77
    v_and_b32 v10, 1, v1
    v_lshlrev_b32_e64 v10, 6, v10
    v_bfe_u32 v4, v1, 1, 2
    v_lshl_add_u32 v10, v4, 3, v10
    v_bfe_u32 v4, v1, 4, 1
    v_lshl_add_u32 v10, v4, 2, v10
    v_lshrrev_b32_e64 v4, 3, v1
    v_mul_u32_u24 v6, 299008, v4
    v_and_b32_e64 v5, 7, v1
    v_lshl_add_u32 v6, v5, 4, v6
    v_mov_b32 v7, 2146435072
    v_cmp_gt_u32 vcc, 56, v1
    s_nop 1
    v_cndmask_b32_e64 v6, v7, v6, vcc
    s_mul_i32 s79, s87, 9344
    s_add_u32 s79, s79, 8388608
    s_lshl_b32 s80, s91, 11
    s_lshl_b32 s77, s87, 6
    s_add_u32 s80, s80, s77
    s_sleep 16
    s_mov_b32 s88, 0
L_spin_38:
    buffer_load_dword v64, v10, s[40:43], s76 offen offset:0 sc1
    buffer_load_dword v65, v10, s[40:43], s76 offen offset:128 sc1
    s_waitcnt vmcnt(0)
    v_max_u32 v4, v64, v65
    v_cmp_eq_u32_e64 vcc, -1, v4
    s_nop 0
    s_cbranch_vccz L_ok_39
    s_add_u32 s88, s88, 1
    s_cmp_lt_u32 s88, 65536
    s_cbranch_scc1 L_spin_38
L_ok_39:
    v_lshlrev_b32 v4, 4, v3
    v_lshrrev_b32 v64, v4, v64
    v_lshrrev_b32 v65, v4, v65
    v_lshlrev_b32 v64, 16, v64
    v_lshlrev_b32 v65, 16, v65
    v_lshrrev_b32 v9, 1, v19
    s_mov_b32 s88, 0
L_spin_40:
    buffer_load_dwordx4 v[48:51], v6, s[40:43], s79 offen offset:512 sc1
    s_waitcnt vmcnt(0)
    v_max3_u32 v4, v48, v49, v50
    v_max_u32 v4, v4, v51
    v_cmp_eq_u32 vcc, -1, v4
    s_nop 0
    s_cbranch_vccz L_ok_41
    s_add_u32 s88, s88, 1
    s_cmp_lt_u32 s88, 65536
    s_cbranch_scc1 L_spin_40
L_ok_41:
    v_permlane32_swap_b32 v48, v49
    v_permlane32_swap_b32 v50, v51
    v_add_f32 v48, v48, v49
    v_add_f32 v50, v50, v51
    s_nop 1
    v_permlane16_swap_b32 v48, v50
    v_add_f32_e64 v48, v48, v50
    s_nop 1
    v_add_f32_dpp v48, v48, v48 row_ror:8 row_mask:0xf bank_mask:0xf
    v_cvt_pk_bf16_f32 v48, v48, v48
    v_and_b32 v48, s90, v48
    v_mul_f32 v48, v48, v8
    v_cvt_pk_bf16_f32 v48, v48, v48
    v_and_b32 v48, s90, v48
    v_add_f32 v48, v48, v64
    v_cvt_pk_bf16_f32 v48, v48, v48
    v_and_b32 v48, s90, v48
    v_add_f32 v48, v48, v65
    v_cvt_pk_bf16_f32 v48, v48, v48
    s_mov_b32 exec_lo, 0x00ff00ff
    s_mov_b32 exec_hi, 0x00ff00ff
    buffer_store_short v48, v9, s[44:47], s80 offen sc1
    s_mov_b64 exec, -1
L_hfin:
    s_endpgm
L_special:
    s_mul_i32 s78, s63, 2048
    s_mul_i32 s79, s63, 20480
    v_xor_b32 v5, 32, v72
    v_xor_b32 v6, 64, v72
    v_xor_b32 v7, 96, v72
    v_add_u32 v8, s78, v73
    v_add_u32_e64 v9, s79, v73
    s_and_b32 s72, s66, 15
    s_mov_b32 m0, s70
    s_lshl_b32 s71, s72, 7
    buffer_load_dwordx4 v16, s[28:31], s71 offen offset:0 lds
    s_mul_i32 s72, s72, 393216
    s_lshr_b64 s[66:67], s[66:67], 4
    ds_read_b128 v[32:35], v72
    ds_read_b128 v[36:39], v5
    ds_read_b128 v[40:43], v6
    ds_read_b128 v[44:47], v7
    ds_read_b64_tr_b16 v[48:49], v8 offset:0
    ds_read_b64_tr_b16 v[50:51], v8 offset:512
    ds_read_b64_tr_b16 v[52:53], v8 offset:10240
    ds_read_b64_tr_b16 v[54:55], v8 offset:10752
    ds_read_b64_tr_b16 v[56:57], v8 offset:20480
    ds_read_b64_tr_b16 v[58:59], v8 offset:20992
    ds_read_b64_tr_b16 v[60:61], v8 offset:30720
    ds_read_b64_tr_b16 v[62:63], v8 offset:31232
    buffer_load_dwordx4 v17, s[28:31], s71 offen offset:1024 lds
    ds_read_b64_tr_b16 v[64:65], v9 offset:4096
    ds_read_b64_tr_b16 v[66:67], v9 offset:4608
    ds_read_b64_tr_b16 v[68:69], v9 offset:14336
    ds_read_b64_tr_b16 v[70:71], v9 offset:14848
    buffer_load_dwordx4 v18, s[28:31], s71 offen offset:2048 lds
    s_waitcnt lgkmcnt(0)
    v_lshlrev_b32 v4, 16, v32
    v_and_b32 v5, s90, v32
    v_mov_b32 v80, v4
    v_mov_b32 v84, v5
    v_mul_f32 v81, v4, v4
    v_mul_f32 v85, v5, v5
    v_lshlrev_b32 v6, 16, v33
    v_and_b32 v7, s90, v33
    v_add_f32 v80, v80, v6
    v_add_f32 v84, v84, v7
    v_fmac_f32_e64 v81, v6, v6
    buffer_load_dwordx4 v19, s[28:31], s71 offen offset:3072 lds
    v_fmac_f32 v85, v7, v7
    v_lshlrev_b32 v4, 16, v34
    v_and_b32 v5, s90, v34
    v_add_f32 v80, v80, v4
    v_add_f32 v84, v84, v5
    v_fmac_f32 v81, v4, v4
    v_fmac_f32 v85, v5, v5
    v_lshlrev_b32 v6, 16, v35
    v_and_b32 v7, s90, v35
    v_add_f32 v80, v80, v6
    v_add_f32_e64 v84, v84, v7
    s_add_u32 m0, s70, 4096
    s_nop 0
    buffer_load_dwordx4 v20, s[32:35], s72 offen offset:0 lds
    v_fmac_f32 v81, v6, v6
    v_fmac_f32 v85, v7, v7
    v_lshlrev_b32 v4, 16, v36
    v_and_b32 v5, s90, v36
    v_add_f32 v80, v80, v4
    v_add_f32 v84, v84, v5
    v_fmac_f32 v81, v4, v4
    v_fmac_f32 v85, v5, v5
    v_lshlrev_b32 v6, 16, v37
    v_and_b32 v7, s90, v37
    v_add_f32 v80, v80, v6
    buffer_load_dwordx4 v21, s[32:35], s72 offen offset:1024 lds
    v_add_f32 v84, v84, v7
    v_fmac_f32 v81, v6, v6
    v_fmac_f32 v85, v7, v7
    v_lshlrev_b32 v4, 16, v38
    v_and_b32 v5, s90, v38
    v_add_f32 v80, v80, v4
    v_add_f32 v84, v84, v5
    v_fmac_f32 v81, v4, v4
    v_fmac_f32 v85, v5, v5
    v_lshlrev_b32 v6, 16, v39
    v_and_b32_e64 v7, s90, v39
    buffer_load_dwordx4 v22, s[32:35], s72 offen offset:2048 lds
    v_add_f32 v80, v80, v6
    v_add_f32 v84, v84, v7
    v_fmac_f32 v81, v6, v6
    v_fmac_f32 v85, v7, v7
    v_lshlrev_b32 v4, 16, v40
    v_and_b32 v5, s90, v40
    v_add_f32 v80, v80, v4
    v_add_f32 v84, v84, v5
    v_fmac_f32 v81, v4, v4
    v_fmac_f32 v85, v5, v5
    v_lshlrev_b32_e64 v6, 16, v41
    buffer_load_dwordx4 v23, s[32:35], s72 offen offset:3072 lds
    v_and_b32 v7, s90, v41
    v_add_f32 v80, v80, v6
    v_add_f32 v84, v84, v7
    v_fmac_f32 v81, v6, v6
    v_fmac_f32 v85, v7, v7
    v_lshlrev_b32 v4, 16, v42
    v_and_b32 v5, s90, v42
    v_add_f32 v80, v80, v4
    v_add_f32 v84, v84, v5
    v_fmac_f32 v81, v4, v4
    v_fmac_f32_e64 v85, v5, v5
    s_add_u32 m0, s70, 8192
    s_nop 0
    buffer_load_dwordx4 v24, s[32:35], s72 offen offset:0 lds
    v_lshlrev_b32 v6, 16, v43
    v_and_b32 v7, s90, v43
    v_add_f32 v80, v80, v6
    v_add_f32 v84, v84, v7
    v_fmac_f32 v81, v6, v6
    v_fmac_f32 v85, v7, v7
    v_lshlrev_b32 v4, 16, v44
    v_and_b32 v5, s90, v44
    v_add_f32 v80, v80, v4
    v_add_f32 v84, v84, v5
    v_fmac_f32 v81, v4, v4
    buffer_load_dwordx4 v25, s[32:35], s72 offen offset:1024 lds
    s_add_u32 s70, s70, 40960
    s_cmp_ge_u32 s70, 122880
    s_cselect_b32 s76, 122880, 0
    s_sub_u32 s70, s70, s76
    s_waitcnt vmcnt(10)
    s_barrier
    s_and_b32 s72, s66, 15
    s_mov_b32 m0, s70
    s_lshl_b32 s71, s72, 7
    buffer_load_dwordx4 v16, s[28:31], s71 offen offset:0 lds
    s_mul_i32 s72, s72, 393216
    s_lshr_b64 s[66:67], s[66:67], 4
    v_fmac_f32 v85, v5, v5
    v_lshlrev_b32 v6, 16, v45
    v_and_b32 v7, s90, v45
    v_add_f32 v80, v80, v6
    v_add_f32 v84, v84, v7
    v_fmac_f32 v81, v6, v6
    v_fmac_f32 v85, v7, v7
    v_lshlrev_b32 v4, 16, v46
    v_and_b32 v5, s90, v46
    v_add_f32 v80, v80, v4
    v_add_f32 v84, v84, v5
    v_fmac_f32 v81, v4, v4
    v_fmac_f32 v85, v5, v5
    buffer_load_dwordx4 v17, s[28:31], s71 offen offset:1024 lds
    v_lshlrev_b32 v6, 16, v47
    v_and_b32 v7, s90, v47
    v_add_f32 v80, v80, v6
    v_add_f32 v84, v84, v7
    v_fmac_f32 v81, v6, v6
    v_fmac_f32 v85, v7, v7
    v_lshlrev_b32 v82, 16, v48
    v_and_b32 v86, s90, v48
    v_lshlrev_b32 v6, 16, v49
    v_and_b32 v7, s90, v49
    v_add_f32 v82, v82, v6
    v_add_f32 v86, v86, v7
    v_lshlrev_b32_e64 v4, 16, v50
    buffer_load_dwordx4 v18, s[28:31], s71 offen offset:2048 lds
    v_and_b32 v5, s90, v50
    v_add_f32 v82, v82, v4
    v_add_f32 v86, v86, v5
    v_lshlrev_b32 v6, 16, v51
    v_and_b32 v7, s90, v51
    v_add_f32 v82, v82, v6
    v_add_f32 v86, v86, v7
    v_lshlrev_b32 v4, 16, v52
    v_and_b32 v5, s90, v52
    v_add_f32 v82, v82, v4
    v_add_f32 v86, v86, v5
    v_lshlrev_b32 v6, 16, v53
    v_and_b32_e64 v7, s90, v53
    buffer_load_dwordx4 v19, s[28:31], s71 offen offset:3072 lds
    v_add_f32 v82, v82, v6
    v_add_f32 v86, v86, v7
    v_lshlrev_b32 v4, 16, v54
    v_and_b32 v5, s90, v54
    v_add_f32 v82, v82, v4
    v_add_f32 v86, v86, v5
    v_lshlrev_b32 v6, 16, v55
    v_and_b32 v7, s90, v55
    v_add_f32 v82, v82, v6
    v_add_f32 v86, v86, v7
    v_lshlrev_b32 v4, 16, v56
    v_and_b32 v5, s90, v56
    v_add_f32_e64 v82, v82, v4
    s_add_u32 m0, s70, 4096
    s_nop 0
    buffer_load_dwordx4 v20, s[32:35], s72 offen offset:0 lds
    v_add_f32 v86, v86, v5
    v_lshlrev_b32 v6, 16, v57
    v_and_b32 v7, s90, v57
    v_add_f32 v82, v82, v6
    v_add_f32 v86, v86, v7
    v_lshlrev_b32 v4, 16, v58
    v_and_b32 v5, s90, v58
    v_add_f32 v82, v82, v4
    v_add_f32 v86, v86, v5
    v_lshlrev_b32 v6, 16, v59
    v_and_b32 v7, s90, v59
    v_add_f32 v82, v82, v6
    v_add_f32 v86, v86, v7
    buffer_load_dwordx4 v21, s[32:35], s72 offen offset:1024 lds
    v_lshlrev_b32 v4, 16, v60
    v_and_b32 v5, s90, v60
    v_add_f32 v82, v82, v4
    v_add_f32 v86, v86, v5
    v_lshlrev_b32 v6, 16, v61
    v_and_b32 v7, s90, v61
    v_add_f32 v82, v82, v6
    v_add_f32 v86, v86, v7
    v_lshlrev_b32 v4, 16, v62
    v_and_b32 v5, s90, v62
    v_add_f32 v82, v82, v4
    v_add_f32 v86, v86, v5
    v_lshlrev_b32_e64 v6, 16, v63
    buffer_load_dwordx4 v22, s[32:35], s72 offen offset:2048 lds
    v_and_b32 v7, s90, v63
    v_add_f32 v82, v82, v6
    v_add_f32 v86, v86, v7
    v_lshlrev_b32 v83, 16, v64
    v_and_b32 v87, s90, v64
    v_lshlrev_b32 v6, 16, v65
    v_and_b32 v7, s90, v65
    v_add_f32 v83, v83, v6
    v_add_f32 v87, v87, v7
    v_lshlrev_b32 v4, 16, v66
    v_and_b32 v5, s90, v66
    v_add_f32 v83, v83, v4
    v_add_f32_e64 v87, v87, v5
    buffer_load_dwordx4 v23, s[32:35], s72 offen offset:3072 lds
    v_lshlrev_b32 v6, 16, v67
    v_and_b32 v7, s90, v67
    v_add_f32 v83, v83, v6
    v_add_f32 v87, v87, v7
    v_lshlrev_b32 v4, 16, v68
    v_and_b32 v5, s90, v68
    v_add_f32 v83, v83, v4
    v_add_f32 v87, v87, v5
    v_lshlrev_b32 v6, 16, v69
    v_and_b32 v7, s90, v69
    v_add_f32 v83, v83, v6
    v_add_f32 v87, v87, v7
    v_lshlrev_b32_e64 v4, 16, v70
    s_add_u32 m0, s70, 8192
    s_nop 0
    buffer_load_dwordx4 v24, s[32:35], s72 offen offset:0 lds
    v_and_b32 v5, s90, v70
    v_add_f32 v83, v83, v4
    v_add_f32 v87, v87, v5
    v_lshlrev_b32 v6, 16, v71
    v_and_b32 v7, s90, v71
    v_add_f32 v83, v83, v6
    v_add_f32 v87, v87, v7
    buffer_load_dwordx4 v25, s[32:35], s72 offen offset:1024 lds
    s_add_u32 s70, s70, 40960
    s_cmp_ge_u32 s70, 122880
    s_cselect_b32 s76, 122880, 0
    s_sub_u32 s70, s70, s76
    v_add_f32 v80, v80, v84
    v_add_f32 v81, v81, v85
    v_add_f32 v82, v82, v86
    v_add_f32 v83, v83, v87
    v_mov_b32 v84, v80
    v_mov_b32 v85, v81
    v_mov_b32 v86, v82
    v_mov_b32 v87, v83
    v_permlane32_swap_b32 v80, v84
    v_permlane32_swap_b32 v81, v85
    v_permlane32_swap_b32 v82, v86
    v_permlane32_swap_b32 v83, v87
    v_add_f32 v80, v80, v84
    v_add_f32 v81, v81, v85
    v_add_f32 v82, v82, v86
    v_add_f32 v83, v83, v87
    s_lshl_b32 s78, s62, 8
    s_add_u32 s78, s78, s73
    s_lshl_b32 s79, s64, 9
    s_lshl_b32 s80, s63, 3
    s_add_u32 s79, s79, s80
    s_add_u32 s79, s79, s73
    s_mov_b32 exec_hi, 0
    buffer_store_dwordx2 v[80:81], v74, s[40:43], s78 offen offset:0 sc1
    buffer_store_dwordx2 v[82:83], v12, s[40:43], s79 offen offset:1024 sc1
    s_mov_b64 exec, -1
    s_add_u32 s68, s68, 2
    s_cmp_lt_u32 s68, 14
    s_waitcnt vmcnt(12)
    s_branch L_hbar
L_compute:
    s_setprio 2
    s_and_b32 s63, s62, 1
    s_lshr_b32 s64, s62, 1
    s_lshl_b32 s73, s60, 4
    s_add_u32 s73, s73, s61
    s_mul_i32 s73, s73, 28800
    s_and_b32 s76, s2, 7
    s_lshr_b32 s77, s2, 3
    s_and_b32 s97, s76, 7
    s_lshl_b32 s97, s97, 1
    s_and_b32 s78, s77, 1
    s_add_u32 s97, s97, s78
    s_lshr_b32 s98, s76, 3
    s_lshl_b32 s98, s98, 4
    s_lshr_b32 s78, s77, 1
    s_add_u32 s98, s98, s78
    s_lshl_b32 s99, s97, 4
    s_add_u32 s99, s99, s98
    s_mul_i32 s99, s99, 9344
    s_add_u32 s99, s99, 8388608
    s_add_u32 s65, s97, s98
    s_and_b32 s65, s65, 1
    s_mul_i32 s65, s65, 8
    s_mov_b32 s89, 0x3f803f80
    s_mov_b32 s90, 0xffff0000
    v_and_b32 v2, 31, v1
    v_lshrrev_b32 v3, 5, v1
    v_lshlrev_b32 v12, 4, v1
    v_lshrrev_b32_e64 v4, 3, v1
    v_mul_u32_u24 v13, 460800, v4
    v_and_b32_e64 v4, 7, v1
    v_lshl_add_u32 v13, v4, 4, v13
    v_and_b32 v10, 15, v1
    v_lshrrev_b32 v11, 4, v1
    s_mul_i32 s76, s63, 20480
    v_lshrrev_b32 v4, 1, v10
    v_xor_b32 v4, v4, v11
    v_lshlrev_b32_e64 v4, 4, v4
    v_lshl_add_u32 v4, v10, 7, v4
    v_add_u32 v192, s76, v4
    v_xor_b32 v193, 64, v192
    v_bfe_u32 v4, v1, 2, 2
    v_and_b32_e64 v6, 1, v11
    v_lshl_add_u32 v5, v6, 3, v4
    v_lshlrev_b32 v5, 7, v5
    v_lshrrev_b32 v4, 1, v4
    v_xor_b32_e64 v4, s64, v4
    v_lshl_add_u32 v5, v4, 6, v5
    v_lshl_add_u32 v5, v6, 5, v5
    v_and_b32_e64 v4, 3, v1
    v_lshl_add_u32 v5, v4, 3, v5
    v_mul_u32_u24 v4, 10240, v3
    v_add_u32_e64 v5, v5, v4
    v_add_u32 v194, 4096, v5
    v_xor_b32_e64 v195, 32, v194
    v_add_u32 v196, 40960, v192
    v_add_u32 v197, 40960, v193
    v_add_u32 v198, 40960, v194
    v_add_u32 v199, 40960, v195
    v_add_u32 v200, 81920, v192
    v_add_u32 v201, 81920, v193
    v_add_u32 v202, 81920, v194
    v_add_u32 v203, 81920, v195
    v_bfe_u32 v4, v1, 2, 2
    v_lshl_add_u32 v4, v3, 3, v4
    v_lshlrev_b32 v4, 6, v4
    v_and_b32 v5, 1, v11
    v_lshl_add_u32 v4, v5, 5, v4
    v_and_b32_e64 v5, 3, v1
    v_lshl_add_u32 v4, v5, 3, v4
    s_lshl_b32 s76, s64, 11
    s_add_u32 s76, s76, 122880
    v_add_u32_e64 v212, s76, v4
    s_lshl_b32 s76, s63, 9
    v_lshl_add_u32 v213, v10, 3, s76
    v_lshl_add_u32 v214, v2, 3, s76
    s_lshl_b32 s76, s64, 8
    v_lshl_add_u32 v215, v10, 3, s76
    v_bfe_u32 v4, v10, 1, 1
    v_xor_b32 v4, s64, v4
    v_lshrrev_b32 v5, 2, v10
    v_xor_b32 v5, v5, v3
    v_xor_b32 v6, v10, v11
    v_and_b32 v6, 1, v6
    v_lshlrev_b32_e64 v4, 6, v4
    v_lshl_add_u32 v4, v5, 4, v4
    v_lshl_add_u32 v4, v6, 3, v4
    v_lshl_add_u32 v4, v10, 7, v4
    s_lshl_b32 s76, s63, 13
    v_add_u32 v216, s76, v4
    v_bfe_u32 v4, v2, 1, 1
    v_bfe_u32 v5, v2, 2, 2
    v_and_b32 v6, 1, v2
    v_xor_b32 v6, v6, v3
    v_lshlrev_b32_e64 v4, 6, v4
    v_lshl_add_u32 v4, v5, 4, v4
    v_lshl_add_u32 v4, v6, 3, v4
    v_lshl_add_u32 v4, v2, 7, v4
    s_lshl_b32 s77, s64, 14
    s_add_u32 s76, s76, s77
    v_add_u32_e64 v217, s76, v4
    v_bfe_u32 v4, v1, 2, 2
    v_lshl_add_u32 v5, v3, 3, v4
    v_lshlrev_b32 v5, 7, v5
    v_lshrrev_b32 v6, 1, v4
    v_lshl_add_u32 v5, v6, 6, v5
    v_bfe_u32 v6, v1, 4, 1
    v_xor_b32_e64 v6, v6, v3
    v_lshl_add_u32 v5, v6, 5, v5
    v_bfe_u32 v6, v1, 1, 1
    v_lshl_add_u32 v5, v6, 4, v5
    v_xor_b32 v6, v1, v4
    v_and_b32 v6, 1, v6
    v_lshl_add_u32 v5, v6, 3, v5
    s_lshl_b32 s76, s63, 6
    s_or_b32 s76, s76, s77
    v_xor_b32 v218, s76, v5
    s_lshl_b32 s76, s64, 6
    v_xor_b32_e64 v220, s76, v5
    v_xor_b32 v219, 528, v218
    v_xor_b32 v221, 528, v220
    v_cmp_gt_u32 s[86:87], 16, v1
    s_waitcnt lgkmcnt(0)
    s_mov_b32 s40, s26
    s_and_b32 s41, s27, 0xffff
    s_mov_b32 s42, 16777216
    s_mov_b32 s43, 0x20000
    s_mov_b32 s44, s22
    s_and_b32 s45, s23, 0xffff
    s_mov_b32 s46, 4194304
    s_mov_b32 s47, 0x20000
    s_mov_b32 s68, 0
    s_getreg_b32 s101, hwreg(HW_REG_XCC_ID, 0, 4)
    v_mov_b32 v9, 13631488
    s_add_u32 s76, s73, 28672
    s_add_u32 s77, s99, 9216
    v_mov_b32 v8, s76
    v_writelane_b32 v8, s77, 1
    v_mov_b32 v6, s101
    v_mov_b32 v7, 0
    v_mov_b32_e64 v10, 0
    s_cmp_eq_u32 s62, 0
    s_cbranch_scc0 L_noep
    buffer_load_dwordx2 v[4:5], v9, s[40:43], 0 offen
L_noep:
    s_barrier
    ds_read_b128 v[112:115], v192 offset:0
    ds_read_b64_tr_b16 v[128:129], v194 offset:0
    ds_read_b64_tr_b16 v[130:131], v194 offset:512
    ds_read_b128 v[116:119], v192 offset:2048
    ds_read_b128 v[120:123], v192 offset:10240
    ds_read_b128 v[124:127], v192 offset:12288
    ds_read_b64_tr_b16 v[132:133], v195 offset:0
    ds_read_b64_tr_b16 v[134:135], v195 offset:512
    ds_read_b64_tr_b16 v[136:137], v194 offset:2048
    ds_read_b64_tr_b16 v[138:139], v194 offset:2560
    ds_read_b64_tr_b16 v[140:141], v195 offset:2048
    ds_read_b64_tr_b16 v[142:143], v195 offset:2560
    ds_read_b64_tr_b16 v[144:145], v194 offset:4096
    ds_read_b64_tr_b16 v[146:147], v194 offset:4608
    s_waitcnt lgkmcnt(8)
    ds_read_b64_tr_b16 v[148:149], v195 offset:4096
    ds_read_b64_tr_b16 v[150:151], v195 offset:4608
    v_mfma_f32_16x16x32_bf16 v[16:19], v[128:131], v[112:115], 0
    ds_read_b128 v[152:155], v193 offset:0
    v_mfma_f32_16x16x32_bf16 v[20:23], v[128:131], v[116:119], 0
    ds_read_b64_tr_b16 v[168:169], v194 offset:20480
    v_mfma_f32_16x16x32_bf16 v[24:27], v[128:131], v[120:123], 0
    ds_read_b64_tr_b16 v[170:171], v194 offset:20992
    v_mfma_f32_16x16x32_bf16 v[28:31], v[128:131], v[124:127], 0
    ds_read_b128 v[156:159], v193 offset:2048
    s_waitcnt lgkmcnt(4)
    v_mfma_f32_16x16x32_bf16 v[32:35], v[132:135], v[112:115], 0
    ds_read_b128 v[160:163], v193 offset:10240
    v_mfma_f32_16x16x32_bf16 v[36:39], v[132:135], v[116:119], 0
    ds_read_b128 v[164:167], v193 offset:12288
    v_mfma_f32_16x16x32_bf16 v[40:43], v[132:135], v[120:123], 0
    ds_read_b64_tr_b16 v[172:173], v195 offset:20480
    v_mfma_f32_16x16x32_bf16 v[44:47], v[132:135], v[124:127], 0
    ds_read_b64_tr_b16 v[174:175], v195 offset:20992
    v_mfma_f32_16x16x32_bf16 v[48:51], v[136:139], v[112:115], 0
    ds_read_b64_tr_b16 v[176:177], v194 offset:22528
    v_mfma_f32_16x16x32_bf16 v[52:55], v[136:139], v[116:119], 0
    ds_read_b64_tr_b16 v[178:179], v194 offset:23040
    v_mfma_f32_16x16x32_bf16 v[56:59], v[136:139], v[120:123], 0
    ds_read_b64_tr_b16 v[180:181], v195 offset:22528
    v_mfma_f32_16x16x32_bf16 v[60:63], v[136:139], v[124:127], 0
    ds_read_b64_tr_b16 v[182:183], v195 offset:23040
    v_mfma_f32_16x16x32_bf16 v[64:67], v[140:143], v[112:115], 0
    ds_read_b64_tr_b16 v[184:185], v194 offset:24576
    v_mfma_f32_16x16x32_bf16 v[68:71], v[140:143], v[116:119], 0
    ds_read_b64_tr_b16 v[186:187], v194 offset:25088
    v_mfma_f32_16x16x32_bf16 v[72:75], v[140:143], v[120:123], 0
    ds_read_b64_tr_b16 v[188:189], v195 offset:24576
    v_mfma_f32_16x16x32_bf16 v[76:79], v[140:143], v[124:127], 0
    ds_read_b64_tr_b16 v[190:191], v195 offset:25088
    v_mfma_f32_16x16x32_bf16 v[80:83], v[144:147], v[112:115], 0
    v_mfma_f32_16x16x32_bf16 v[84:87], v[144:147], v[116:119], 0
    v_mfma_f32_16x16x32_bf16 v[88:91], v[144:147], v[120:123], 0
    v_mfma_f32_16x16x32_bf16 v[92:95], v[144:147], v[124:127], 0
    v_mfma_f32_16x16x32_bf16 v[96:99], v[148:151], v[112:115], 0
    v_mfma_f32_16x16x32_bf16 v[100:103], v[148:151], v[116:119], 0
    v_mfma_f32_16x16x32_bf16 v[104:107], v[148:151], v[120:123], 0
    v_mfma_f32_16x16x32_bf16 v[108:111], v[148:151], v[124:127], 0
    s_waitcnt lgkmcnt(0)
    v_mfma_f32_16x16x32_bf16 v[16:19], v[168:171], v[152:155], v[16:19]
    s_barrier
    v_mfma_f32_16x16x32_bf16 v[20:23], v[168:171], v[156:159], v[20:23]
    ds_read_b128 v[112:115], v196 offset:0
    ds_read_b64_tr_b16 v[204:205], v212 offset:0
    ds_read_b64_tr_b16 v[206:207], v212 offset:256
    ds_read_b64_tr_b16 v[208:209], v212 offset:1024
    ds_read_b64_tr_b16 v[210:211], v212 offset:1280
    v_mfma_f32_16x16x32_bf16 v[24:27], v[168:171], v[160:163], v[24:27]
    ds_read_b64_tr_b16 v[128:129], v198 offset:0
    s_cmp_eq_u32 s62, 0
    s_cbranch_scc0 L_cloop
    s_waitcnt vmcnt(0)
    v_add_co_u32 v4, vcc, 1, v4
    s_nop 1
    v_addc_co_u32 v5, vcc, 0, v5, vcc
    s_mov_b64 exec, 3
    buffer_store_dwordx4 v[4:7], v8, s[40:43], 0 offen sc1
    s_mov_b64 exec, -1
.p2align 3
L_cloop:
    v_mfma_f32_16x16x32_bf16 v[28:31], v[168:171], v[164:167], v[28:31]
    ds_read_b64_tr_b16 v[130:131], v198 offset:512
    v_mfma_f32_16x16x32_bf16 v[32:35], v[172:175], v[152:155], v[32:35]
    ds_read_b128 v[116:119], v196 offset:2048
    v_mfma_f32_16x16x32_bf16 v[36:39], v[172:175], v[156:159], v[36:39]
    ds_read_b128 v[120:123], v196 offset:10240
    v_mfma_f32_16x16x32_bf16 v[40:43], v[172:175], v[160:163], v[40:43]
    ds_read_b128 v[124:127], v196 offset:12288
    v_mfma_f32_16x16x32_bf16 v[44:47], v[172:175], v[164:167], v[44:47]
    ds_read_b64_tr_b16 v[132:133], v199 offset:0
    v_mfma_f32_16x16x32_bf16 v[48:51], v[176:179], v[152:155], v[48:51]
    ds_read_b64_tr_b16 v[134:135], v199 offset:512
    v_mfma_f32_16x16x32_bf16 v[52:55], v[176:179], v[156:159], v[52:55]
    ds_read_b64_tr_b16 v[136:137], v198 offset:2048
    v_mfma_f32_16x16x32_bf16 v[56:59], v[176:179], v[160:163], v[56:59]
    ds_read_b64_tr_b16 v[138:139], v198 offset:2560
    v_mfma_f32_16x16x32_bf16 v[60:63], v[176:179], v[164:167], v[60:63]
    ds_read_b64_tr_b16 v[140:141], v199 offset:2048
    v_mfma_f32_16x16x32_bf16 v[64:67], v[180:183], v[152:155], v[64:67]
    ds_read_b64_tr_b16 v[142:143], v199 offset:2560
    v_mfma_f32_16x16x32_bf16 v[68:71], v[180:183], v[156:159], v[68:71]
    ds_read_b64_tr_b16 v[144:145], v198 offset:4096
    v_mfma_f32_16x16x32_bf16 v[72:75], v[180:183], v[160:163], v[72:75]
    ds_read_b64_tr_b16 v[146:147], v198 offset:4608
    v_mfma_f32_16x16x32_bf16 v[76:79], v[180:183], v[164:167], v[76:79]
    ds_read_b64_tr_b16 v[148:149], v199 offset:4096
    v_mfma_f32_16x16x32_bf16 v[80:83], v[184:187], v[152:155], v[80:83]
    ds_read_b64_tr_b16 v[150:151], v199 offset:4608
    v_mfma_f32_16x16x32_bf16 v[84:87], v[184:187], v[156:159], v[84:87]
    v_mfma_f32_16x16x32_bf16 v[88:91], v[184:187], v[160:163], v[88:91]
    v_mfma_f32_16x16x32_bf16 v[92:95], v[184:187], v[164:167], v[92:95]
    v_mfma_f32_16x16x32_bf16 v[96:99], v[188:191], v[152:155], v[96:99]
    v_mfma_f32_16x16x32_bf16 v[100:103], v[188:191], v[156:159], v[100:103]
    v_mfma_f32_16x16x32_bf16 v[104:107], v[188:191], v[160:163], v[104:107]
    v_mfma_f32_16x16x32_bf16 v[108:111], v[188:191], v[164:167], v[108:111]
    s_waitcnt lgkmcnt(0)
    v_mfma_f32_16x16x32_bf16 v[16:19], v[128:131], v[112:115], v[16:19]
    ds_read_b128 v[152:155], v197 offset:0
    v_mfma_f32_16x16x32_bf16 v[20:23], v[128:131], v[116:119], v[20:23]
    ds_read_b64_tr_b16 v[168:169], v198 offset:20480
    v_mfma_f32_16x16x32_bf16 v[24:27], v[128:131], v[120:123], v[24:27]
    ds_read_b64_tr_b16 v[170:171], v198 offset:20992
    v_mfma_f32_16x16x32_bf16 v[28:31], v[128:131], v[124:127], v[28:31]
    ds_read_b128 v[156:159], v197 offset:2048
    v_mfma_f32_16x16x32_bf16 v[32:35], v[132:135], v[112:115], v[32:35]
    ds_read_b128 v[160:163], v197 offset:10240
    v_mfma_f32_16x16x32_bf16 v[36:39], v[132:135], v[116:119], v[36:39]
    ds_read_b128 v[164:167], v197 offset:12288
    v_mfma_f32_16x16x32_bf16 v[40:43], v[132:135], v[120:123], v[40:43]
    ds_read_b64_tr_b16 v[172:173], v199 offset:20480
    v_mfma_f32_16x16x32_bf16 v[44:47], v[132:135], v[124:127], v[44:47]
    ds_read_b64_tr_b16 v[174:175], v199 offset:20992
    v_mfma_f32_16x16x32_bf16 v[48:51], v[136:139], v[112:115], v[48:51]
    ds_read_b64_tr_b16 v[176:177], v198 offset:22528
    v_mfma_f32_16x16x32_bf16 v[52:55], v[136:139], v[116:119], v[52:55]
    ds_read_b64_tr_b16 v[178:179], v198 offset:23040
    v_mfma_f32_16x16x32_bf16 v[56:59], v[136:139], v[120:123], v[56:59]
    ds_read_b64_tr_b16 v[180:181], v199 offset:22528
    v_mfma_f32_16x16x32_bf16 v[60:63], v[136:139], v[124:127], v[60:63]
    ds_read_b64_tr_b16 v[182:183], v199 offset:23040
    v_mfma_f32_16x16x32_bf16 v[64:67], v[140:143], v[112:115], v[64:67]
    ds_read_b64_tr_b16 v[184:185], v198 offset:24576
    v_mfma_f32_16x16x32_bf16 v[68:71], v[140:143], v[116:119], v[68:71]
    ds_read_b64_tr_b16 v[186:187], v198 offset:25088
    v_mfma_f32_16x16x32_bf16 v[72:75], v[140:143], v[120:123], v[72:75]
    ds_read_b64_tr_b16 v[188:189], v199 offset:24576
    v_mfma_f32_16x16x32_bf16 v[76:79], v[140:143], v[124:127], v[76:79]
    ds_read_b64_tr_b16 v[190:191], v199 offset:25088
    v_mfma_f32_16x16x32_bf16 v[80:83], v[144:147], v[112:115], v[80:83]
    v_mfma_f32_16x16x32_bf16 v[84:87], v[144:147], v[116:119], v[84:87]
    v_mfma_f32_16x16x32_bf16 v[88:91], v[144:147], v[120:123], v[88:91]
    v_mfma_f32_16x16x32_bf16 v[92:95], v[144:147], v[124:127], v[92:95]
    v_mfma_f32_16x16x32_bf16 v[96:99], v[148:151], v[112:115], v[96:99]
    v_mfma_f32_16x16x32_bf16 v[100:103], v[148:151], v[116:119], v[100:103]
    v_mfma_f32_16x16x32_bf16 v[104:107], v[148:151], v[120:123], v[104:107]
    v_mfma_f32_16x16x32_bf16 v[108:111], v[148:151], v[124:127], v[108:111]
    s_waitcnt lgkmcnt(0)
    v_mfma_f32_16x16x32_bf16 v[16:19], v[168:171], v[152:155], v[16:19]
    s_barrier
    v_mfma_f32_16x16x32_bf16 v[20:23], v[168:171], v[156:159], v[20:23]
    ds_read_b128 v[112:115], v200 offset:0
    v_mfma_f32_16x16x32_bf16 v[24:27], v[168:171], v[160:163], v[24:27]
    ds_read_b64_tr_b16 v[128:129], v202 offset:0
    v_mfma_f32_16x16x32_bf16 v[28:31], v[168:171], v[164:167], v[28:31]
    ds_read_b64_tr_b16 v[130:131], v202 offset:512
    v_mfma_f32_16x16x32_bf16 v[32:35], v[172:175], v[152:155], v[32:35]
    ds_read_b128 v[116:119], v200 offset:2048
    v_mfma_f32_16x16x32_bf16 v[36:39], v[172:175], v[156:159], v[36:39]
    ds_read_b128 v[120:123], v200 offset:10240
    v_mfma_f32_16x16x32_bf16 v[40:43], v[172:175], v[160:163], v[40:43]
    ds_read_b128 v[124:127], v200 offset:12288
    v_mfma_f32_16x16x32_bf16 v[44:47], v[172:175], v[164:167], v[44:47]
    ds_read_b64_tr_b16 v[132:133], v203 offset:0
    v_mfma_f32_16x16x32_bf16 v[48:51], v[176:179], v[152:155], v[48:51]
    ds_read_b64_tr_b16 v[134:135], v203 offset:512
    v_mfma_f32_16x16x32_bf16 v[52:55], v[176:179], v[156:159], v[52:55]
    ds_read_b64_tr_b16 v[136:137], v202 offset:2048
    v_mfma_f32_16x16x32_bf16 v[56:59], v[176:179], v[160:163], v[56:59]
    ds_read_b64_tr_b16 v[138:139], v202 offset:2560
    v_mfma_f32_16x16x32_bf16 v[60:63], v[176:179], v[164:167], v[60:63]
    ds_read_b64_tr_b16 v[140:141], v203 offset:2048
    v_mfma_f32_16x16x32_bf16 v[64:67], v[180:183], v[152:155], v[64:67]
    ds_read_b64_tr_b16 v[142:143], v203 offset:2560
    v_mfma_f32_16x16x32_bf16 v[68:71], v[180:183], v[156:159], v[68:71]
    ds_read_b64_tr_b16 v[144:145], v202 offset:4096
    v_mfma_f32_16x16x32_bf16 v[72:75], v[180:183], v[160:163], v[72:75]
    ds_read_b64_tr_b16 v[146:147], v202 offset:4608
    v_mfma_f32_16x16x32_bf16 v[76:79], v[180:183], v[164:167], v[76:79]
    ds_read_b64_tr_b16 v[148:149], v203 offset:4096
    v_mfma_f32_16x16x32_bf16 v[80:83], v[184:187], v[152:155], v[80:83]
    ds_read_b64_tr_b16 v[150:151], v203 offset:4608
    v_mfma_f32_16x16x32_bf16 v[84:87], v[184:187], v[156:159], v[84:87]
    v_mfma_f32_16x16x32_bf16 v[88:91], v[184:187], v[160:163], v[88:91]
    v_mfma_f32_16x16x32_bf16 v[92:95], v[184:187], v[164:167], v[92:95]
    v_mfma_f32_16x16x32_bf16 v[96:99], v[188:191], v[152:155], v[96:99]
    v_mfma_f32_16x16x32_bf16 v[100:103], v[188:191], v[156:159], v[100:103]
    v_mfma_f32_16x16x32_bf16 v[104:107], v[188:191], v[160:163], v[104:107]
    v_mfma_f32_16x16x32_bf16 v[108:111], v[188:191], v[164:167], v[108:111]
    s_waitcnt lgkmcnt(0)
    v_mfma_f32_16x16x32_bf16 v[16:19], v[128:131], v[112:115], v[16:19]
    ds_read_b128 v[152:155], v201 offset:0
    v_mfma_f32_16x16x32_bf16 v[20:23], v[128:131], v[116:119], v[20:23]
    ds_read_b64_tr_b16 v[168:169], v202 offset:20480
    v_mfma_f32_16x16x32_bf16 v[24:27], v[128:131], v[120:123], v[24:27]
    ds_read_b64_tr_b16 v[170:171], v202 offset:20992
    v_mfma_f32_16x16x32_bf16 v[28:31], v[128:131], v[124:127], v[28:31]
    ds_read_b128 v[156:159], v201 offset:2048
    v_mfma_f32_16x16x32_bf16 v[32:35], v[132:135], v[112:115], v[32:35]
    ds_read_b128 v[160:163], v201 offset:10240
    v_mfma_f32_16x16x32_bf16 v[36:39], v[132:135], v[116:119], v[36:39]
    ds_read_b128 v[164:167], v201 offset:12288
    v_mfma_f32_16x16x32_bf16 v[40:43], v[132:135], v[120:123], v[40:43]
    ds_read_b64_tr_b16 v[172:173], v203 offset:20480
    v_mfma_f32_16x16x32_bf16 v[44:47], v[132:135], v[124:127], v[44:47]
    ds_read_b64_tr_b16 v[174:175], v203 offset:20992
    v_mfma_f32_16x16x32_bf16 v[48:51], v[136:139], v[112:115], v[48:51]
    ds_read_b64_tr_b16 v[176:177], v202 offset:22528
    v_mfma_f32_16x16x32_bf16 v[52:55], v[136:139], v[116:119], v[52:55]
    ds_read_b64_tr_b16 v[178:179], v202 offset:23040
    v_mfma_f32_16x16x32_bf16 v[56:59], v[136:139], v[120:123], v[56:59]
    ds_read_b64_tr_b16 v[180:181], v203 offset:22528
    v_mfma_f32_16x16x32_bf16 v[60:63], v[136:139], v[124:127], v[60:63]
    ds_read_b64_tr_b16 v[182:183], v203 offset:23040
    v_mfma_f32_16x16x32_bf16 v[64:67], v[140:143], v[112:115], v[64:67]
    ds_read_b64_tr_b16 v[184:185], v202 offset:24576
    v_mfma_f32_16x16x32_bf16 v[68:71], v[140:143], v[116:119], v[68:71]
    ds_read_b64_tr_b16 v[186:187], v202 offset:25088
    v_mfma_f32_16x16x32_bf16 v[72:75], v[140:143], v[120:123], v[72:75]
    ds_read_b64_tr_b16 v[188:189], v203 offset:24576
    v_mfma_f32_16x16x32_bf16 v[76:79], v[140:143], v[124:127], v[76:79]
    ds_read_b64_tr_b16 v[190:191], v203 offset:25088
    v_mfma_f32_16x16x32_bf16 v[80:83], v[144:147], v[112:115], v[80:83]
    v_mfma_f32_16x16x32_bf16 v[84:87], v[144:147], v[116:119], v[84:87]
    v_mfma_f32_16x16x32_bf16 v[88:91], v[144:147], v[120:123], v[88:91]
    v_mfma_f32_16x16x32_bf16 v[92:95], v[144:147], v[124:127], v[92:95]
    v_mfma_f32_16x16x32_bf16 v[96:99], v[148:151], v[112:115], v[96:99]
    v_mfma_f32_16x16x32_bf16 v[100:103], v[148:151], v[116:119], v[100:103]
    v_mfma_f32_16x16x32_bf16 v[104:107], v[148:151], v[120:123], v[104:107]
    v_mfma_f32_16x16x32_bf16 v[108:111], v[148:151], v[124:127], v[108:111]
    s_waitcnt lgkmcnt(0)
    v_mfma_f32_16x16x32_bf16 v[16:19], v[168:171], v[152:155], v[16:19]
    s_barrier
    v_mfma_f32_16x16x32_bf16 v[20:23], v[168:171], v[156:159], v[20:23]
    ds_read_b128 v[112:115], v192 offset:0
    v_mfma_f32_16x16x32_bf16 v[24:27], v[168:171], v[160:163], v[24:27]
    ds_read_b64_tr_b16 v[128:129], v194 offset:0
    v_mfma_f32_16x16x32_bf16 v[28:31], v[168:171], v[164:167], v[28:31]
    ds_read_b64_tr_b16 v[130:131], v194 offset:512
    v_mfma_f32_16x16x32_bf16 v[32:35], v[172:175], v[152:155], v[32:35]
    ds_read_b128 v[116:119], v192 offset:2048
    v_mfma_f32_16x16x32_bf16 v[36:39], v[172:175], v[156:159], v[36:39]
    ds_read_b128 v[120:123], v192 offset:10240
    v_mfma_f32_16x16x32_bf16 v[40:43], v[172:175], v[160:163], v[40:43]
    ds_read_b128 v[124:127], v192 offset:12288
    v_mfma_f32_16x16x32_bf16 v[44:47], v[172:175], v[164:167], v[44:47]
    ds_read_b64_tr_b16 v[132:133], v195 offset:0
    v_mfma_f32_16x16x32_bf16 v[48:51], v[176:179], v[152:155], v[48:51]
    ds_read_b64_tr_b16 v[134:135], v195 offset:512
    v_mfma_f32_16x16x32_bf16 v[52:55], v[176:179], v[156:159], v[52:55]
    ds_read_b64_tr_b16 v[136:137], v194 offset:2048
    v_mfma_f32_16x16x32_bf16 v[56:59], v[176:179], v[160:163], v[56:59]
    ds_read_b64_tr_b16 v[138:139], v194 offset:2560
    v_mfma_f32_16x16x32_bf16 v[60:63], v[176:179], v[164:167], v[60:63]
    ds_read_b64_tr_b16 v[140:141], v195 offset:2048
    v_mfma_f32_16x16x32_bf16 v[64:67], v[180:183], v[152:155], v[64:67]
    ds_read_b64_tr_b16 v[142:143], v195 offset:2560
    v_mfma_f32_16x16x32_bf16 v[68:71], v[180:183], v[156:159], v[68:71]
    ds_read_b64_tr_b16 v[144:145], v194 offset:4096
    v_mfma_f32_16x16x32_bf16 v[72:75], v[180:183], v[160:163], v[72:75]
    ds_read_b64_tr_b16 v[146:147], v194 offset:4608
    v_mfma_f32_16x16x32_bf16 v[76:79], v[180:183], v[164:167], v[76:79]
    ds_read_b64_tr_b16 v[148:149], v195 offset:4096
    v_mfma_f32_16x16x32_bf16 v[80:83], v[184:187], v[152:155], v[80:83]
    ds_read_b64_tr_b16 v[150:151], v195 offset:4608
    v_mfma_f32_16x16x32_bf16 v[84:87], v[184:187], v[156:159], v[84:87]
    v_mfma_f32_16x16x32_bf16 v[88:91], v[184:187], v[160:163], v[88:91]
    v_mfma_f32_16x16x32_bf16 v[92:95], v[184:187], v[164:167], v[92:95]
    v_mfma_f32_16x16x32_bf16 v[96:99], v[188:191], v[152:155], v[96:99]
    v_mfma_f32_16x16x32_bf16 v[100:103], v[188:191], v[156:159], v[100:103]
    v_mfma_f32_16x16x32_bf16 v[104:107], v[188:191], v[160:163], v[104:107]
    v_mfma_f32_16x16x32_bf16 v[108:111], v[188:191], v[164:167], v[108:111]
    s_waitcnt lgkmcnt(0)
    v_mfma_f32_16x16x32_bf16 v[16:19], v[128:131], v[112:115], v[16:19]
    ds_read_b128 v[152:155], v193 offset:0
    v_mfma_f32_16x16x32_bf16 v[20:23], v[128:131], v[116:119], v[20:23]
    ds_read_b64_tr_b16 v[168:169], v194 offset:20480
    v_mfma_f32_16x16x32_bf16 v[24:27], v[128:131], v[120:123], v[24:27]
    ds_read_b64_tr_b16 v[170:171], v194 offset:20992
    v_mfma_f32_16x16x32_bf16 v[28:31], v[128:131], v[124:127], v[28:31]
    ds_read_b128 v[156:159], v193 offset:2048
    v_mfma_f32_16x16x32_bf16 v[32:35], v[132:135], v[112:115], v[32:35]
    ds_read_b128 v[160:163], v193 offset:10240
    v_mfma_f32_16x16x32_bf16 v[36:39], v[132:135], v[116:119], v[36:39]
    ds_read_b128 v[164:167], v193 offset:12288
    v_mfma_f32_16x16x32_bf16 v[40:43], v[132:135], v[120:123], v[40:43]
    ds_read_b64_tr_b16 v[172:173], v195 offset:20480
    v_mfma_f32_16x16x32_bf16 v[44:47], v[132:135], v[124:127], v[44:47]
    ds_read_b64_tr_b16 v[174:175], v195 offset:20992
    v_mfma_f32_16x16x32_bf16 v[48:51], v[136:139], v[112:115], v[48:51]
    ds_read_b64_tr_b16 v[176:177], v194 offset:22528
    v_mfma_f32_16x16x32_bf16 v[52:55], v[136:139], v[116:119], v[52:55]
    ds_read_b64_tr_b16 v[178:179], v194 offset:23040
    v_mfma_f32_16x16x32_bf16 v[56:59], v[136:139], v[120:123], v[56:59]
    ds_read_b64_tr_b16 v[180:181], v195 offset:22528
    v_mfma_f32_16x16x32_bf16 v[60:63], v[136:139], v[124:127], v[60:63]
    ds_read_b64_tr_b16 v[182:183], v195 offset:23040
    v_mfma_f32_16x16x32_bf16 v[64:67], v[140:143], v[112:115], v[64:67]
    ds_read_b64_tr_b16 v[184:185], v194 offset:24576
    v_mfma_f32_16x16x32_bf16 v[68:71], v[140:143], v[116:119], v[68:71]
    ds_read_b64_tr_b16 v[186:187], v194 offset:25088
    v_mfma_f32_16x16x32_bf16 v[72:75], v[140:143], v[120:123], v[72:75]
    ds_read_b64_tr_b16 v[188:189], v195 offset:24576
    v_mfma_f32_16x16x32_bf16 v[76:79], v[140:143], v[124:127], v[76:79]
    ds_read_b64_tr_b16 v[190:191], v195 offset:25088
    v_mfma_f32_16x16x32_bf16 v[80:83], v[144:147], v[112:115], v[80:83]
    v_mfma_f32_16x16x32_bf16 v[84:87], v[144:147], v[116:119], v[84:87]
    v_mfma_f32_16x16x32_bf16 v[88:91], v[144:147], v[120:123], v[88:91]
    v_mfma_f32_16x16x32_bf16 v[92:95], v[144:147], v[124:127], v[92:95]
    v_mfma_f32_16x16x32_bf16 v[96:99], v[148:151], v[112:115], v[96:99]
    s_add_u32 s68, s68, 1
    s_cmp_lt_u32 s68, 5
    v_mfma_f32_16x16x32_bf16 v[100:103], v[148:151], v[116:119], v[100:103]
    v_mfma_f32_16x16x32_bf16 v[104:107], v[148:151], v[120:123], v[104:107]
    v_mfma_f32_16x16x32_bf16 v[108:111], v[148:151], v[124:127], v[108:111]
    s_waitcnt lgkmcnt(0)
    v_mfma_f32_16x16x32_bf16 v[16:19], v[168:171], v[152:155], v[16:19]
    s_barrier
    v_mfma_f32_16x16x32_bf16 v[20:23], v[168:171], v[156:159], v[20:23]
    ds_read_b128 v[112:115], v196 offset:0
    v_mfma_f32_16x16x32_bf16 v[24:27], v[168:171], v[160:163], v[24:27]
    ds_read_b64_tr_b16 v[128:129], v198 offset:0
    s_cbranch_scc1 L_cloop
    v_mfma_f32_16x16x32_bf16 v[28:31], v[168:171], v[164:167], v[28:31]
    ds_read_b32 v11, v10 offset:53248
    ds_read_b64 v[222:223], v213 offset:49152
    v_mfma_f32_16x16x32_bf16 v[32:35], v[172:175], v[152:155], v[32:35]
    ds_read_b64 v[224:225], v213 offset:49280
    v_mfma_f32_16x16x32_bf16 v[36:39], v[172:175], v[156:159], v[36:39]
    ds_read_b64 v[226:227], v213 offset:49408
    v_mfma_f32_16x16x32_bf16 v[40:43], v[172:175], v[160:163], v[40:43]
    ds_read_b64 v[228:229], v213 offset:49536
    v_mfma_f32_16x16x32_bf16 v[44:47], v[172:175], v[164:167], v[44:47]
    ds_read_b64 v[238:239], v215 offset:50176
    v_mfma_f32_16x16x32_bf16 v[48:51], v[176:179], v[152:155], v[48:51]
    ds_read_b64 v[240:241], v215 offset:50304
    v_mfma_f32_16x16x32_bf16 v[52:55], v[176:179], v[156:159], v[52:55]
    ds_read_b64 v[242:243], v215 offset:50688
    v_mfma_f32_16x16x32_bf16 v[56:59], v[176:179], v[160:163], v[56:59]
    ds_read_b64 v[244:245], v215 offset:50816
    v_mfma_f32_16x16x32_bf16 v[60:63], v[176:179], v[164:167], v[60:63]
    ds_read_b64 v[246:247], v215 offset:51200
    v_mfma_f32_16x16x32_bf16 v[64:67], v[180:183], v[152:155], v[64:67]
    ds_read_b64 v[248:249], v215 offset:51328
    v_mfma_f32_16x16x32_bf16 v[68:71], v[180:183], v[156:159], v[68:71]
    ds_read_b32 v250, v214 offset:49156
    v_mfma_f32_16x16x32_bf16 v[72:75], v[180:183], v[160:163], v[72:75]
    ds_read_b32 v252, v214 offset:49412
    v_mfma_f32_16x16x32_bf16 v[76:79], v[180:183], v[164:167], v[76:79]
    s_waitcnt lgkmcnt(8)
    v_readfirstlane_b32 s100, v11
    v_mfma_f32_16x16x32_bf16 v[80:83], v[184:187], v[152:155], v[80:83]
    v_mov_b32_e64 v230, v223
    v_cndmask_b32 v222, 0, v222, s[86:87]
    v_mfma_f32_16x16x32_bf16 v[84:87], v[184:187], v[156:159], v[84:87]
    v_mov_b32_e64 v232, v225
    v_cndmask_b32 v224, 0, v224, s[86:87]
    v_mfma_f32_16x16x32_bf16 v[88:91], v[184:187], v[160:163], v[88:91]
    v_mov_b32_e64 v234, v227
    v_cndmask_b32 v226, 0, v226, s[86:87]
    v_mfma_f32_16x16x32_bf16 v[92:95], v[184:187], v[164:167], v[92:95]
    v_mov_b32_e64 v236, v229
    v_cndmask_b32 v228, 0, v228, s[86:87]
    v_mfma_f32_16x16x32_bf16 v[96:99], v[188:191], v[152:155], v[96:99]
    v_mov_b32 v223, v222
    v_mov_b32 v225, v224
    v_mfma_f32_16x16x32_bf16 v[100:103], v[188:191], v[156:159], v[100:103]
    v_mov_b32 v227, v226
    v_mov_b32 v229, v228
    v_mfma_f32_16x16x32_bf16 v[104:107], v[188:191], v[160:163], v[104:107]
    s_waitcnt lgkmcnt(0)
    v_mul_f32 v251, 0x3fb8aa3b, v250
    v_mfma_f32_16x16x32_bf16 v[108:111], v[188:191], v[164:167], v[108:111]
    v_mul_f32 v253, 0x3fb8aa3b, v252
    v_mfma_f32_16x16x16_bf16 v[48:51], v[242:243], v[222:223], v[48:51]
    v_mfma_f32_16x16x16_bf16 v[52:55], v[242:243], v[224:225], v[52:55]
    v_mfma_f32_16x16x16_bf16 v[56:59], v[242:243], v[226:227], v[56:59]
    v_mfma_f32_16x16x16_bf16 v[60:63], v[242:243], v[228:229], v[60:63]
    v_mfma_f32_16x16x16_bf16 v[64:67], v[244:245], v[222:223], v[64:67]
    v_mfma_f32_16x16x16_bf16 v[68:71], v[244:245], v[224:225], v[68:71]
    v_mfma_f32_16x16x16_bf16 v[72:75], v[244:245], v[226:227], v[72:75]
    v_mfma_f32_16x16x16_bf16 v[76:79], v[244:245], v[228:229], v[76:79]
    v_mfma_f32_16x16x16_bf16 v[80:83], v[246:247], v[222:223], v[80:83]
    v_mfma_f32_16x16x16_bf16 v[84:87], v[246:247], v[224:225], v[84:87]
    v_mfma_f32_16x16x16_bf16 v[88:91], v[246:247], v[226:227], v[88:91]
    v_mfma_f32_16x16x16_bf16 v[92:95], v[246:247], v[228:229], v[92:95]
    v_mfma_f32_16x16x16_bf16 v[96:99], v[248:249], v[222:223], v[96:99]
    v_cvt_pk_bf16_f32 v112, v48, v49
    v_cvt_pk_bf16_f32 v113, v50, v51
    v_mfma_f32_16x16x16_bf16 v[100:103], v[248:249], v[224:225], v[100:103]
    v_cvt_pk_bf16_f32 v114, v52, v53
    v_cvt_pk_bf16_f32 v115, v54, v55
    v_mfma_f32_16x16x16_bf16 v[104:107], v[248:249], v[226:227], v[104:107]
    v_cvt_pk_bf16_f32 v116, v64, v65
    v_cvt_pk_bf16_f32 v117, v66, v67
    v_mfma_f32_16x16x16_bf16 v[108:111], v[248:249], v[228:229], v[108:111]
    v_cvt_pk_bf16_f32 v118, v68, v69
    v_cvt_pk_bf16_f32 v119, v70, v71
    v_mfma_f32_16x16x16_bf16 v[16:19], v[238:239], v[222:223], v[16:19]
    v_cvt_pk_bf16_f32 v120, v56, v57
    v_cvt_pk_bf16_f32 v121, v58, v59
    v_mfma_f32_16x16x16_bf16 v[20:23], v[238:239], v[224:225], v[20:23]
    v_cvt_pk_bf16_f32 v122, v60, v61
    v_cvt_pk_bf16_f32 v123, v62, v63
    v_mfma_f32_16x16x16_bf16 v[24:27], v[238:239], v[226:227], v[24:27]
    v_cvt_pk_bf16_f32 v124, v72, v73
    v_cvt_pk_bf16_f32 v125, v74, v75
    v_mfma_f32_16x16x16_bf16 v[28:31], v[238:239], v[228:229], v[28:31]
    v_cvt_pk_bf16_f32 v126, v76, v77
    v_cvt_pk_bf16_f32 v127, v78, v79
    v_mfma_f32_16x16x16_bf16 v[32:35], v[240:241], v[222:223], v[32:35]
    v_mfma_f32_16x16x16_bf16 v[36:39], v[240:241], v[224:225], v[36:39]
    v_mfma_f32_16x16x16_bf16 v[40:43], v[240:241], v[226:227], v[40:43]
    v_mfma_f32_16x16x16_bf16 v[44:47], v[240:241], v[228:229], v[44:47]
    v_permlane16_swap_b32 v112, v114
    v_permlane16_swap_b32 v113, v115
    v_permlane16_swap_b32 v116, v118
    v_permlane16_swap_b32 v117, v119
    v_permlane16_swap_b32 v120, v122
    v_permlane16_swap_b32 v121, v123
    v_permlane16_swap_b32 v124, v126
    v_permlane16_swap_b32 v125, v127
    v_xor_b32 v168, 0, v217
    v_xor_b32 v169, 16, v217
    v_xor_b32 v170, 32, v217
    v_xor_b32 v171, 48, v217
    v_xor_b32 v172, 64, v217
    v_xor_b32 v173, 80, v217
    v_xor_b32 v174, 96, v217
    v_xor_b32 v175, 112, v217
    v_xor_b32_e64 v4, 32, v216
    v_mfma_f32_32x32x16_bf16 v[48:63], v[204:207], v[112:115], 0
    v_mul_f32 v80, v80, v230
    v_mul_f32 v81, v81, v230
    v_mul_f32 v82, v82, v230
    v_mul_f32 v83, v83, v230
    v_cvt_pk_bf16_f32 v80, v80, v81
    v_cvt_pk_bf16_f32 v81, v82, v83
    ds_write_b64 v216, v[80:81] offset:32768
    v_mfma_f32_32x32x16_bf16 v[64:79], v[204:207], v[120:123], 0
    v_mul_f32 v96, v96, v230
    v_mul_f32 v97, v97, v230
    v_mul_f32 v98, v98, v230
    v_mul_f32 v99, v99, v230
    v_cvt_pk_bf16_f32 v96, v96, v97
    v_cvt_pk_bf16_f32 v97, v98, v99
    ds_write_b64 v4, v[96:97] offset:32768
    v_mfma_f32_32x32x16_bf16 v[48:63], v[208:211], v[116:119], v[48:63]
    v_mul_f32 v84, v84, v232
    v_mul_f32 v85, v85, v232
    v_mul_f32 v86, v86, v232
    v_mul_f32 v87, v87, v232
    v_cvt_pk_bf16_f32 v84, v84, v85
    v_cvt_pk_bf16_f32 v85, v86, v87
    ds_write_b64 v216, v[84:85] offset:34816
    v_mfma_f32_32x32x16_bf16 v[64:79], v[208:211], v[124:127], v[64:79]
    v_mul_f32 v100, v100, v232
    v_mul_f32 v101, v101, v232
    v_mul_f32 v102, v102, v232
    v_mul_f32 v103, v103, v232
    v_cvt_pk_bf16_f32 v100, v100, v101
    v_cvt_pk_bf16_f32 v101, v102, v103
    ds_write_b64 v4, v[100:101] offset:34816
    v_mul_f32 v88, v88, v234
    v_mul_f32 v89, v89, v234
    v_mul_f32 v90, v90, v234
    v_mul_f32 v91, v91, v234
    v_cvt_pk_bf16_f32 v88, v88, v89
    v_cvt_pk_bf16_f32 v89, v90, v91
    ds_write_b64 v216, v[88:89] offset:36864
    v_mul_f32 v104, v104, v234
    v_mul_f32 v105, v105, v234
    v_mul_f32 v106, v106, v234
    v_mul_f32 v107, v107, v234
    v_cvt_pk_bf16_f32 v104, v104, v105
    v_cvt_pk_bf16_f32 v105, v106, v107
    ds_write_b64 v4, v[104:105] offset:36864
    v_mul_f32 v92, v92, v236
    v_mul_f32 v93, v93, v236
    v_mul_f32 v94, v94, v236
    v_mul_f32 v95, v95, v236
    v_cvt_pk_bf16_f32 v92, v92, v93
    v_cvt_pk_bf16_f32 v93, v94, v95
    ds_write_b64 v216, v[92:93] offset:38912
    v_mul_f32 v108, v108, v236
    v_mul_f32 v109, v109, v236
    v_mul_f32 v110, v110, v236
    v_mul_f32 v111, v111, v236
    v_cvt_pk_bf16_f32 v108, v108, v109
    v_cvt_pk_bf16_f32 v109, v110, v111
    ds_write_b64 v4, v[108:109] offset:38912
    v_max3_f32 v160, v48, v49, v50
    v_min3_f32 v162, v48, v49, v50
    v_max3_f32 v160, v160, v51, v52
    v_min3_f32 v162, v162, v51, v52
    v_max3_f32 v160, v160, v53, v54
    v_min3_f32 v162, v162, v53, v54
    v_max3_f32 v160, v160, v55, v56
    v_min3_f32 v162, v162, v55, v56
    v_max3_f32 v160, v160, v57, v58
    v_min3_f32 v162, v162, v57, v58
    v_max3_f32 v160, v160, v59, v60
    v_min3_f32 v162, v162, v59, v60
    v_max3_f32 v160, v160, v61, v62
    v_min3_f32 v162, v162, v61, v62
    v_max_f32 v160, v160, v63
    v_min_f32 v162, v162, v63
    v_max3_f32 v164, v64, v65, v66
    v_min3_f32 v166, v64, v65, v66
    v_max3_f32 v164, v164, v67, v68
    v_min3_f32 v166, v166, v67, v68
    v_max3_f32 v164, v164, v69, v70
    v_min3_f32 v166, v166, v69, v70
    v_max3_f32 v164, v164, v71, v72
    v_min3_f32 v166, v166, v71, v72
    v_max3_f32 v164, v164, v73, v74
    v_min3_f32 v166, v166, v73, v74
    v_max3_f32 v164, v164, v75, v76
    v_min3_f32 v166, v166, v75, v76
    v_max3_f32 v164, v164, v77, v78
    v_min3_f32 v166, v166, v77, v78
    v_max_f32 v164, v164, v79
    v_min_f32 v166, v166, v79
    v_mov_b32 v161, v160
    v_mov_b32 v163, v162
    v_mov_b32 v165, v164
    v_mov_b32 v167, v166
    v_permlane32_swap_b32 v160, v161
    v_permlane32_swap_b32 v162, v163
    v_permlane32_swap_b32 v164, v165
    v_permlane32_swap_b32 v166, v167
    v_max_f32 v160, v160, v161
    v_min_f32 v162, v162, v163
    v_max_f32 v164, v164, v165
    v_min_f32 v166, v166, v167
    v_mul_f32 v160, v160, v251
    v_mul_f32 v162, v162, v251
    v_mul_f32 v164, v164, v253
    v_mul_f32 v166, v166, v253
    v_pk_fma_f32 v[128:129], v[48:49], v[250:251], v[160:161] op_sel:[0,1,0] op_sel_hi:[1,1,0] neg_lo:[0,0,1] neg_hi:[0,0,1]
    v_pk_fma_f32 v[48:49], v[48:49], v[250:251], v[162:163] op_sel:[0,1,0] op_sel_hi:[1,1,0] neg_lo:[0,1,0] neg_hi:[0,1,0]
    v_pk_fma_f32 v[130:131], v[50:51], v[250:251], v[160:161] op_sel:[0,1,0] op_sel_hi:[1,1,0] neg_lo:[0,0,1] neg_hi:[0,0,1]
    v_pk_fma_f32 v[50:51], v[50:51], v[250:251], v[162:163] op_sel:[0,1,0] op_sel_hi:[1,1,0] neg_lo:[0,1,0] neg_hi:[0,1,0]
    v_pk_fma_f32 v[132:133], v[52:53], v[250:251], v[160:161] op_sel:[0,1,0] op_sel_hi:[1,1,0] neg_lo:[0,0,1] neg_hi:[0,0,1]
    v_pk_fma_f32 v[52:53], v[52:53], v[250:251], v[162:163] op_sel:[0,1,0] op_sel_hi:[1,1,0] neg_lo:[0,1,0] neg_hi:[0,1,0]
    v_pk_fma_f32 v[134:135], v[54:55], v[250:251], v[160:161] op_sel:[0,1,0] op_sel_hi:[1,1,0] neg_lo:[0,0,1] neg_hi:[0,0,1]
    v_pk_fma_f32 v[54:55], v[54:55], v[250:251], v[162:163] op_sel:[0,1,0] op_sel_hi:[1,1,0] neg_lo:[0,1,0] neg_hi:[0,1,0]
    v_pk_fma_f32 v[136:137], v[56:57], v[250:251], v[160:161] op_sel:[0,1,0] op_sel_hi:[1,1,0] neg_lo:[0,0,1] neg_hi:[0,0,1]
    v_pk_fma_f32 v[56:57], v[56:57], v[250:251], v[162:163] op_sel:[0,1,0] op_sel_hi:[1,1,0] neg_lo:[0,1,0] neg_hi:[0,1,0]
    v_pk_fma_f32 v[138:139], v[58:59], v[250:251], v[160:161] op_sel:[0,1,0] op_sel_hi:[1,1,0] neg_lo:[0,0,1] neg_hi:[0,0,1]
    v_pk_fma_f32 v[58:59], v[58:59], v[250:251], v[162:163] op_sel:[0,1,0] op_sel_hi:[1,1,0] neg_lo:[0,1,0] neg_hi:[0,1,0]
    v_pk_fma_f32 v[140:141], v[60:61], v[250:251], v[160:161] op_sel:[0,1,0] op_sel_hi:[1,1,0] neg_lo:[0,0,1] neg_hi:[0,0,1]
    v_pk_fma_f32 v[60:61], v[60:61], v[250:251], v[162:163] op_sel:[0,1,0] op_sel_hi:[1,1,0] neg_lo:[0,1,0] neg_hi:[0,1,0]
    v_pk_fma_f32 v[142:143], v[62:63], v[250:251], v[160:161] op_sel:[0,1,0] op_sel_hi:[1,1,0] neg_lo:[0,0,1] neg_hi:[0,0,1]
    v_pk_fma_f32 v[62:63], v[62:63], v[250:251], v[162:163] op_sel:[0,1,0] op_sel_hi:[1,1,0] neg_lo:[0,1,0] neg_hi:[0,1,0]
    v_exp_f32 v128, v128
    v_exp_f32 v48, v48
    v_exp_f32 v129, v129
    v_exp_f32 v49, v49
    v_exp_f32 v130, v130
    v_exp_f32 v50, v50
    v_exp_f32 v131, v131
    v_exp_f32 v51, v51
    v_exp_f32 v132, v132
    v_exp_f32 v52, v52
    v_exp_f32 v133, v133
    v_exp_f32 v53, v53
    v_exp_f32 v134, v134
    v_exp_f32 v54, v54
    v_exp_f32 v135, v135
    v_exp_f32 v55, v55
    v_exp_f32 v136, v136
    v_exp_f32 v56, v56
    v_exp_f32 v137, v137
    v_exp_f32 v57, v57
    v_exp_f32 v138, v138
    v_exp_f32 v58, v58
    v_exp_f32 v139, v139
    v_exp_f32 v59, v59
    v_exp_f32 v140, v140
    v_exp_f32 v60, v60
    v_exp_f32 v141, v141
    v_exp_f32 v61, v61
    v_exp_f32 v142, v142
    v_exp_f32 v62, v62
    v_exp_f32 v143, v143
    v_exp_f32 v63, v63
    v_pk_fma_f32 v[144:145], v[64:65], v[252:253], v[164:165] op_sel:[0,1,0] op_sel_hi:[1,1,0] neg_lo:[0,0,1] neg_hi:[0,0,1]
    v_pk_fma_f32 v[64:65], v[64:65], v[252:253], v[166:167] op_sel:[0,1,0] op_sel_hi:[1,1,0] neg_lo:[0,1,0] neg_hi:[0,1,0]
    v_pk_fma_f32 v[146:147], v[66:67], v[252:253], v[164:165] op_sel:[0,1,0] op_sel_hi:[1,1,0] neg_lo:[0,0,1] neg_hi:[0,0,1]
    v_pk_fma_f32 v[66:67], v[66:67], v[252:253], v[166:167] op_sel:[0,1,0] op_sel_hi:[1,1,0] neg_lo:[0,1,0] neg_hi:[0,1,0]
    v_pk_fma_f32 v[148:149], v[68:69], v[252:253], v[164:165] op_sel:[0,1,0] op_sel_hi:[1,1,0] neg_lo:[0,0,1] neg_hi:[0,0,1]
    v_pk_fma_f32 v[68:69], v[68:69], v[252:253], v[166:167] op_sel:[0,1,0] op_sel_hi:[1,1,0] neg_lo:[0,1,0] neg_hi:[0,1,0]
    v_pk_fma_f32 v[150:151], v[70:71], v[252:253], v[164:165] op_sel:[0,1,0] op_sel_hi:[1,1,0] neg_lo:[0,0,1] neg_hi:[0,0,1]
    v_pk_fma_f32 v[70:71], v[70:71], v[252:253], v[166:167] op_sel:[0,1,0] op_sel_hi:[1,1,0] neg_lo:[0,1,0] neg_hi:[0,1,0]
    v_pk_fma_f32 v[152:153], v[72:73], v[252:253], v[164:165] op_sel:[0,1,0] op_sel_hi:[1,1,0] neg_lo:[0,0,1] neg_hi:[0,0,1]
    v_pk_fma_f32 v[72:73], v[72:73], v[252:253], v[166:167] op_sel:[0,1,0] op_sel_hi:[1,1,0] neg_lo:[0,1,0] neg_hi:[0,1,0]
    v_pk_fma_f32 v[154:155], v[74:75], v[252:253], v[164:165] op_sel:[0,1,0] op_sel_hi:[1,1,0] neg_lo:[0,0,1] neg_hi:[0,0,1]
    v_pk_fma_f32 v[74:75], v[74:75], v[252:253], v[166:167] op_sel:[0,1,0] op_sel_hi:[1,1,0] neg_lo:[0,1,0] neg_hi:[0,1,0]
    v_pk_fma_f32 v[156:157], v[76:77], v[252:253], v[164:165] op_sel:[0,1,0] op_sel_hi:[1,1,0] neg_lo:[0,0,1] neg_hi:[0,0,1]
    v_pk_fma_f32 v[76:77], v[76:77], v[252:253], v[166:167] op_sel:[0,1,0] op_sel_hi:[1,1,0] neg_lo:[0,1,0] neg_hi:[0,1,0]
    v_pk_fma_f32 v[158:159], v[78:79], v[252:253], v[164:165] op_sel:[0,1,0] op_sel_hi:[1,1,0] neg_lo:[0,0,1] neg_hi:[0,0,1]
    v_pk_fma_f32 v[78:79], v[78:79], v[252:253], v[166:167] op_sel:[0,1,0] op_sel_hi:[1,1,0] neg_lo:[0,1,0] neg_hi:[0,1,0]
    v_exp_f32 v144, v144
    v_exp_f32 v64, v64
    v_exp_f32 v145, v145
    v_exp_f32 v65, v65
    v_exp_f32 v146, v146
    v_exp_f32 v66, v66
    v_exp_f32 v147, v147
    v_exp_f32 v67, v67
    v_exp_f32 v148, v148
    v_exp_f32 v68, v68
    v_exp_f32 v149, v149
    v_exp_f32 v69, v69
    v_exp_f32 v150, v150
    v_exp_f32 v70, v70
    v_exp_f32 v151, v151
    v_exp_f32 v71, v71
    v_exp_f32 v152, v152
    v_exp_f32 v72, v72
    v_exp_f32 v153, v153
    v_exp_f32 v73, v73
    v_exp_f32 v154, v154
    v_exp_f32 v74, v74
    v_exp_f32 v155, v155
    v_exp_f32 v75, v75
    v_exp_f32 v156, v156
    v_exp_f32 v76, v76
    v_exp_f32 v157, v157
    v_exp_f32 v77, v77
    v_exp_f32 v158, v158
    v_exp_f32 v78, v78
    v_exp_f32 v159, v159
    v_exp_f32 v79, v79
    v_pk_add_f32 v[176:177], v[128:129], v[130:131]
    v_pk_add_f32 v[176:177], v[176:177], v[132:133]
    v_pk_add_f32 v[176:177], v[176:177], v[134:135]
    v_pk_add_f32 v[176:177], v[176:177], v[136:137]
    v_pk_add_f32 v[176:177], v[176:177], v[138:139]
    v_pk_add_f32 v[176:177], v[176:177], v[140:141]
    v_pk_add_f32 v[176:177], v[176:177], v[142:143]
    v_pk_add_f32 v[178:179], v[48:49], v[50:51]
    v_pk_add_f32 v[178:179], v[178:179], v[52:53]
    v_pk_add_f32 v[178:179], v[178:179], v[54:55]
    v_pk_add_f32 v[178:179], v[178:179], v[56:57]
    v_pk_add_f32 v[178:179], v[178:179], v[58:59]
    v_pk_add_f32 v[178:179], v[178:179], v[60:61]
    v_pk_add_f32 v[178:179], v[178:179], v[62:63]
    v_pk_add_f32 v[180:181], v[144:145], v[146:147]
    v_pk_add_f32 v[180:181], v[180:181], v[148:149]
    v_pk_add_f32 v[180:181], v[180:181], v[150:151]
    v_pk_add_f32 v[180:181], v[180:181], v[152:153]
    v_pk_add_f32 v[180:181], v[180:181], v[154:155]
    v_pk_add_f32 v[180:181], v[180:181], v[156:157]
    v_pk_add_f32 v[180:181], v[180:181], v[158:159]
    v_pk_add_f32 v[182:183], v[64:65], v[66:67]
    v_pk_add_f32 v[182:183], v[182:183], v[68:69]
    v_pk_add_f32 v[182:183], v[182:183], v[70:71]
    v_pk_add_f32 v[182:183], v[182:183], v[72:73]
    v_pk_add_f32 v[182:183], v[182:183], v[74:75]
    v_pk_add_f32 v[182:183], v[182:183], v[76:77]
    v_pk_add_f32 v[182:183], v[182:183], v[78:79]
    v_add_f32 v176, v176, v177
    v_add_f32 v178, v178, v179
    v_add_f32 v180, v180, v181
    v_add_f32 v182, v182, v183
    v_mov_b32 v177, v176
    v_mov_b32 v179, v178
    v_mov_b32 v181, v180
    v_mov_b32 v183, v182
    v_permlane32_swap_b32 v176, v177
    v_permlane32_swap_b32 v178, v179
    v_permlane32_swap_b32 v180, v181
    v_permlane32_swap_b32 v182, v183
    v_add_f32 v176, v176, v177
    v_add_f32 v178, v178, v179
    v_add_f32 v180, v180, v181
    v_add_f32 v182, v182, v183
    v_rcp_f32 v176, v176
    v_rcp_f32 v178, v178
    v_rcp_f32 v180, v180
    v_rcp_f32 v182, v182
    v_pk_mul_f32 v[128:129], v[128:129], v[176:177] op_sel_hi:[1,0]
    v_pk_mul_f32 v[130:131], v[130:131], v[176:177] op_sel_hi:[1,0]
    v_pk_mul_f32 v[132:133], v[132:133], v[176:177] op_sel_hi:[1,0]
    v_pk_mul_f32 v[134:135], v[134:135], v[176:177] op_sel_hi:[1,0]
    v_pk_mul_f32 v[136:137], v[136:137], v[176:177] op_sel_hi:[1,0]
    v_pk_mul_f32 v[138:139], v[138:139], v[176:177] op_sel_hi:[1,0]
    v_pk_mul_f32 v[140:141], v[140:141], v[176:177] op_sel_hi:[1,0]
    v_pk_mul_f32 v[142:143], v[142:143], v[176:177] op_sel_hi:[1,0]
    v_cvt_pk_bf16_f32 v128, v128, v129
    v_cvt_pk_bf16_f32 v129, v130, v131
    ds_write_b64 v168, v[128:129] offset:0
    v_cvt_pk_bf16_f32 v130, v132, v133
    v_cvt_pk_bf16_f32 v131, v134, v135
    ds_write_b64 v169, v[130:131] offset:0
    v_cvt_pk_bf16_f32 v132, v136, v137
    v_cvt_pk_bf16_f32 v133, v138, v139
    ds_write_b64 v170, v[132:133] offset:0
    v_cvt_pk_bf16_f32 v134, v140, v141
    v_cvt_pk_bf16_f32 v135, v142, v143
    ds_write_b64 v171, v[134:135] offset:0
    v_pk_mul_f32 v[48:49], v[48:49], v[178:179] op_sel_hi:[1,0]
    v_pk_mul_f32 v[50:51], v[50:51], v[178:179] op_sel_hi:[1,0]
    v_pk_mul_f32 v[52:53], v[52:53], v[178:179] op_sel_hi:[1,0]
    v_pk_mul_f32 v[54:55], v[54:55], v[178:179] op_sel_hi:[1,0]
    v_pk_mul_f32 v[56:57], v[56:57], v[178:179] op_sel_hi:[1,0]
    v_pk_mul_f32 v[58:59], v[58:59], v[178:179] op_sel_hi:[1,0]
    v_pk_mul_f32 v[60:61], v[60:61], v[178:179] op_sel_hi:[1,0]
    v_pk_mul_f32 v[62:63], v[62:63], v[178:179] op_sel_hi:[1,0]
    v_cvt_pk_bf16_f32 v48, v48, v49
    v_cvt_pk_bf16_f32 v49, v50, v51
    ds_write_b64 v172, v[48:49] offset:0
    v_cvt_pk_bf16_f32 v50, v52, v53
    v_cvt_pk_bf16_f32 v51, v54, v55
    ds_write_b64 v173, v[50:51] offset:0
    v_cvt_pk_bf16_f32 v52, v56, v57
    v_cvt_pk_bf16_f32 v53, v58, v59
    ds_write_b64 v174, v[52:53] offset:0
    v_cvt_pk_bf16_f32 v54, v60, v61
    v_cvt_pk_bf16_f32 v55, v62, v63
    ds_write_b64 v175, v[54:55] offset:0
    v_pk_mul_f32 v[144:145], v[144:145], v[180:181] op_sel_hi:[1,0]
    v_pk_mul_f32 v[146:147], v[146:147], v[180:181] op_sel_hi:[1,0]
    v_pk_mul_f32 v[148:149], v[148:149], v[180:181] op_sel_hi:[1,0]
    v_pk_mul_f32 v[150:151], v[150:151], v[180:181] op_sel_hi:[1,0]
    v_pk_mul_f32 v[152:153], v[152:153], v[180:181] op_sel_hi:[1,0]
    v_pk_mul_f32 v[154:155], v[154:155], v[180:181] op_sel_hi:[1,0]
    v_pk_mul_f32 v[156:157], v[156:157], v[180:181] op_sel_hi:[1,0]
    v_pk_mul_f32 v[158:159], v[158:159], v[180:181] op_sel_hi:[1,0]
    v_cvt_pk_bf16_f32 v144, v144, v145
    v_cvt_pk_bf16_f32 v145, v146, v147
    ds_write_b64 v168, v[144:145] offset:4096
    v_cvt_pk_bf16_f32 v146, v148, v149
    v_cvt_pk_bf16_f32 v147, v150, v151
    ds_write_b64 v169, v[146:147] offset:4096
    v_cvt_pk_bf16_f32 v148, v152, v153
    v_cvt_pk_bf16_f32 v149, v154, v155
    ds_write_b64 v170, v[148:149] offset:4096
    v_cvt_pk_bf16_f32 v150, v156, v157
    v_cvt_pk_bf16_f32 v151, v158, v159
    ds_write_b64 v171, v[150:151] offset:4096
    v_pk_mul_f32 v[64:65], v[64:65], v[182:183] op_sel_hi:[1,0]
    v_pk_mul_f32 v[66:67], v[66:67], v[182:183] op_sel_hi:[1,0]
    v_pk_mul_f32 v[68:69], v[68:69], v[182:183] op_sel_hi:[1,0]
    v_pk_mul_f32 v[70:71], v[70:71], v[182:183] op_sel_hi:[1,0]
    v_pk_mul_f32 v[72:73], v[72:73], v[182:183] op_sel_hi:[1,0]
    v_pk_mul_f32 v[74:75], v[74:75], v[182:183] op_sel_hi:[1,0]
    v_pk_mul_f32 v[76:77], v[76:77], v[182:183] op_sel_hi:[1,0]
    v_pk_mul_f32 v[78:79], v[78:79], v[182:183] op_sel_hi:[1,0]
    v_cvt_pk_bf16_f32 v64, v64, v65
    v_cvt_pk_bf16_f32 v65, v66, v67
    ds_write_b64 v172, v[64:65] offset:4096
    v_cvt_pk_bf16_f32 v66, v68, v69
    v_cvt_pk_bf16_f32 v67, v70, v71
    ds_write_b64 v173, v[66:67] offset:4096
    v_cvt_pk_bf16_f32 v68, v72, v73
    v_cvt_pk_bf16_f32 v69, v74, v75
    ds_write_b64 v174, v[68:69] offset:4096
    v_cvt_pk_bf16_f32 v70, v76, v77
    v_cvt_pk_bf16_f32 v71, v78, v79
    ds_write_b64 v175, v[70:71] offset:4096
    s_waitcnt lgkmcnt(0)
    s_barrier
    ds_read_b64_tr_b16 v[112:113], v218 offset:0
    ds_read_b64_tr_b16 v[114:115], v219 offset:0
    ds_read_b64_tr_b16 v[144:145], v220 offset:32768
    ds_read_b64_tr_b16 v[146:147], v221 offset:32768
    ds_read_b64_tr_b16 v[116:117], v218 offset:2048
    ds_read_b64_tr_b16 v[118:119], v219 offset:2048
    ds_read_b64_tr_b16 v[148:149], v220 offset:34816
    ds_read_b64_tr_b16 v[150:151], v221 offset:34816
    ds_read_b64_tr_b16 v[120:121], v218 offset:4096
    ds_read_b64_tr_b16 v[122:123], v219 offset:4096
    ds_read_b64_tr_b16 v[152:153], v220 offset:36864
    ds_read_b64_tr_b16 v[154:155], v221 offset:36864
    v_cvt_pk_bf16_f32 v176, v16, v17
    v_cvt_pk_bf16_f32 v177, v18, v19
    v_cvt_pk_bf16_f32 v178, v20, v21
    v_cvt_pk_bf16_f32 v179, v22, v23
    v_cvt_pk_bf16_f32 v180, v32, v33
    v_cvt_pk_bf16_f32 v181, v34, v35
    v_cvt_pk_bf16_f32 v182, v36, v37
    v_cvt_pk_bf16_f32 v183, v38, v39
    s_waitcnt lgkmcnt(8)
    v_mfma_f32_32x32x16_bf16 v[48:63], v[112:115], v[144:147], 0
    ds_read_b64_tr_b16 v[124:125], v218 offset:6144
    ds_read_b64_tr_b16 v[126:127], v219 offset:6144
    ds_read_b64_tr_b16 v[156:157], v220 offset:38912
    ds_read_b64_tr_b16 v[158:159], v221 offset:38912
    s_waitcnt lgkmcnt(8)
    v_mfma_f32_32x32x16_bf16 v[48:63], v[116:119], v[148:151], v[48:63]
    ds_read_b64_tr_b16 v[128:129], v218 offset:8192
    ds_read_b64_tr_b16 v[130:131], v219 offset:8192
    ds_read_b64_tr_b16 v[160:161], v220 offset:40960
    ds_read_b64_tr_b16 v[162:163], v221 offset:40960
    s_waitcnt lgkmcnt(8)
    v_mfma_f32_32x32x16_bf16 v[48:63], v[120:123], v[152:155], v[48:63]
    ds_read_b64_tr_b16 v[132:133], v218 offset:10240
    ds_read_b64_tr_b16 v[134:135], v219 offset:10240
    ds_read_b64_tr_b16 v[164:165], v220 offset:43008
    ds_read_b64_tr_b16 v[166:167], v221 offset:43008
    s_waitcnt lgkmcnt(8)
    v_mfma_f32_32x32x16_bf16 v[48:63], v[124:127], v[156:159], v[48:63]
    ds_read_b64_tr_b16 v[136:137], v218 offset:12288
    ds_read_b64_tr_b16 v[138:139], v219 offset:12288
    ds_read_b64_tr_b16 v[168:169], v220 offset:45056
    ds_read_b64_tr_b16 v[170:171], v221 offset:45056
    s_waitcnt lgkmcnt(8)
    v_mfma_f32_32x32x16_bf16 v[48:63], v[128:131], v[160:163], v[48:63]
    ds_read_b64_tr_b16 v[140:141], v218 offset:14336
    ds_read_b64_tr_b16 v[142:143], v219 offset:14336
    ds_read_b64_tr_b16 v[172:173], v220 offset:47104
    ds_read_b64_tr_b16 v[174:175], v221 offset:47104
    s_waitcnt lgkmcnt(8)
    v_mfma_f32_32x32x16_bf16 v[48:63], v[132:135], v[164:167], v[48:63]
    s_lshl_b32 s76, s62, 11
    s_add_u32 s76, s76, s73
    s_add_u32 s76, s76, 4096
    s_waitcnt lgkmcnt(4)
    v_mfma_f32_32x32x16_bf16 v[48:63], v[136:139], v[168:171], v[48:63]
    v_cvt_pk_bf16_f32 v184, v24, v25
    v_cvt_pk_bf16_f32 v185, v26, v27
    v_cvt_pk_bf16_f32 v186, v28, v29
    v_cvt_pk_bf16_f32 v187, v30, v31
    s_waitcnt lgkmcnt(0)
    v_mfma_f32_32x32x16_bf16 v[48:63], v[140:143], v[172:175], v[48:63]
    v_cvt_pk_bf16_f32 v188, v40, v41
    v_cvt_pk_bf16_f32 v189, v42, v43
    v_cvt_pk_bf16_f32 v190, v44, v45
    v_cvt_pk_bf16_f32 v191, v46, v47
    s_barrier
    s_lshl_b32 s77, s62, 7
    s_add_u32 s77, s77, s73
    v_lshlrev_b32 v4, 2, v2
    v_permlane16_swap_b32 v176, v178
    v_permlane16_swap_b32 v177, v179
    v_permlane16_swap_b32 v180, v182
    v_permlane16_swap_b32 v181, v183
    v_cvt_pk_bf16_f32 v64, v48, v49
    v_cvt_pk_bf16_f32 v65, v50, v51
    v_cvt_pk_bf16_f32 v66, v52, v53
    v_cvt_pk_bf16_f32 v67, v54, v55
    v_cvt_pk_bf16_f32 v68, v56, v57
    v_cvt_pk_bf16_f32 v69, v58, v59
    v_cvt_pk_bf16_f32 v70, v60, v61
    v_cvt_pk_bf16_f32 v71, v62, v63
    s_bitcmp1_b32 s100, 0
    s_cbranch_scc1 L_loc_42
    buffer_store_dwordx4 v[64:67], v12, s[40:43], s76 offen offset:0 sc1
    buffer_store_dwordx4 v[68:71], v12, s[40:43], s76 offen offset:1024 sc1
    s_branch L_pubd_43
L_loc_42:
    buffer_store_dwordx4 v[64:67], v12, s[40:43], s76 offen offset:0
    buffer_store_dwordx4 v[68:71], v12, s[40:43], s76 offen offset:1024
L_pubd_43:
    v_dot2_f32_bf16 v72, v112, s89, 0
    v_dot2_f32_bf16 v73, v113, s89, 0
    v_dot2_f32_bf16 v72, v114, s89, v72
    v_dot2_f32_bf16 v73, v115, s89, v73
    v_dot2_f32_bf16 v72, v116, s89, v72
    v_dot2_f32_bf16 v73, v117, s89, v73
    v_dot2_f32_bf16 v72, v118, s89, v72
    v_dot2_f32_bf16 v73, v119, s89, v73
    v_dot2_f32_bf16 v72, v120, s89, v72
    v_dot2_f32_bf16 v73, v121, s89, v73
    v_dot2_f32_bf16 v72, v122, s89, v72
    v_dot2_f32_bf16 v73, v123, s89, v73
    v_dot2_f32_bf16 v72, v124, s89, v72
    v_dot2_f32_bf16 v73, v125, s89, v73
    v_dot2_f32_bf16 v72, v126, s89, v72
    v_dot2_f32_bf16 v73, v127, s89, v73
    v_dot2_f32_bf16 v72, v128, s89, v72
    v_dot2_f32_bf16 v73, v129, s89, v73
    v_dot2_f32_bf16 v72, v130, s89, v72
    v_dot2_f32_bf16 v73, v131, s89, v73
    v_dot2_f32_bf16 v72, v132, s89, v72
    v_dot2_f32_bf16 v73, v133, s89, v73
    v_dot2_f32_bf16 v72, v134, s89, v72
    v_dot2_f32_bf16 v73, v135, s89, v73
    v_dot2_f32_bf16 v72, v136, s89, v72
    v_dot2_f32_bf16 v73, v137, s89, v73
    v_dot2_f32_bf16 v72, v138, s89, v72
    v_dot2_f32_bf16 v73, v139, s89, v73
    v_dot2_f32_bf16 v72, v140, s89, v72
    v_dot2_f32_bf16 v73, v141, s89, v73
    v_dot2_f32_bf16 v72, v142, s89, v72
    v_dot2_f32_bf16 v73, v143, s89, v73
    v_permlane16_swap_b32 v184, v186
    v_permlane16_swap_b32 v185, v187
    v_permlane16_swap_b32 v188, v190
    v_permlane16_swap_b32 v189, v191
    v_add_f32 v72, v72, v73
    v_mfma_f32_32x32x16_bf16 v[16:31], v[204:207], v[176:179], 0
    v_mov_b32 v73, v72
    s_nop 1
    v_permlane32_swap_b32 v72, v73
    v_add_f32 v72, v72, v73
    v_mfma_f32_32x32x16_bf16 v[32:47], v[204:207], v[184:187], 0
    s_mov_b32 exec_hi, 0
    s_bitcmp1_b32 s100, 0
    s_cbranch_scc1 L_loc_44
    buffer_store_dword v72, v4, s[40:43], s77 offen offset:2048 sc1
    s_branch L_pubd_45
L_loc_44:
    buffer_store_dword v72, v4, s[40:43], s77 offen offset:2048
L_pubd_45:
    s_mov_b64 exec, -1
    v_mfma_f32_32x32x16_bf16 v[16:31], v[208:211], v[180:183], v[16:31]
    s_lshl_b32 s76, s98, 7
    v_lshl_add_u32 v4, v3, 3, s76
    v_lshlrev_b32_e64 v5, 5, v1
    v_mfma_f32_32x32x16_bf16 v[32:47], v[208:211], v[188:191], v[32:47]
    v_and_b32 v216, 1, v1
    v_lshlrev_b32 v216, 8, v216
    v_lshl_add_u32 v216, v3, 4, v216
    s_lshl_b32 s76, s64, 7
    v_add_u32 v216, s76, v216
    s_mul_i32 s78, s61, 28800
    s_lshl_b32 s79, s64, 8
    s_add_u32 s78, s78, s79
    s_add_u32 s79, s78, 3686400
    v_max3_f32 v160, v16, v17, v18
    v_min3_f32 v162, v16, v17, v18
    v_max3_f32 v160, v160, v19, v20
    v_min3_f32 v162, v162, v19, v20
    v_max3_f32 v160, v160, v21, v22
    v_min3_f32 v162, v162, v21, v22
    v_max3_f32 v160, v160, v23, v24
    v_min3_f32 v162, v162, v23, v24
    v_max3_f32 v160, v160, v25, v26
    v_min3_f32 v162, v162, v25, v26
    v_max3_f32 v160, v160, v27, v28
    v_min3_f32 v162, v162, v27, v28
    v_max3_f32 v160, v160, v29, v30
    v_min3_f32 v162, v162, v29, v30
    v_max_f32 v160, v160, v31
    v_min_f32 v162, v162, v31
    v_max3_f32 v164, v32, v33, v34
    v_min3_f32 v166, v32, v33, v34
    v_max3_f32 v164, v164, v35, v36
    v_min3_f32 v166, v166, v35, v36
    v_max3_f32 v164, v164, v37, v38
    v_min3_f32 v166, v166, v37, v38
    v_max3_f32 v164, v164, v39, v40
    v_min3_f32 v166, v166, v39, v40
    v_max3_f32 v164, v164, v41, v42
    v_min3_f32 v166, v166, v41, v42
    v_max3_f32 v164, v164, v43, v44
    v_min3_f32 v166, v166, v43, v44
    v_max3_f32 v164, v164, v45, v46
    v_min3_f32 v166, v166, v45, v46
    v_max_f32 v164, v164, v47
    v_min_f32 v166, v166, v47
    v_mov_b32 v161, v160
    v_mov_b32 v163, v162
    v_mov_b32 v165, v164
    v_mov_b32 v167, v166
    v_permlane32_swap_b32 v160, v161
    v_permlane32_swap_b32 v162, v163
    v_permlane32_swap_b32 v164, v165
    v_permlane32_swap_b32 v166, v167
    v_max_f32 v160, v160, v161
    v_min_f32 v162, v162, v163
    v_max_f32 v164, v164, v165
    v_min_f32 v166, v166, v167
    v_mul_f32 v160, v160, v251
    v_mul_f32 v162, v162, v251
    v_mul_f32 v164, v164, v253
    v_mul_f32 v166, v166, v253
    v_pk_fma_f32 v[128:129], v[16:17], v[250:251], v[160:161] op_sel:[0,1,0] op_sel_hi:[1,1,0] neg_lo:[0,0,1] neg_hi:[0,0,1]
    v_pk_fma_f32 v[16:17], v[16:17], v[250:251], v[162:163] op_sel:[0,1,0] op_sel_hi:[1,1,0] neg_lo:[0,1,0] neg_hi:[0,1,0]
    v_pk_fma_f32 v[130:131], v[18:19], v[250:251], v[160:161] op_sel:[0,1,0] op_sel_hi:[1,1,0] neg_lo:[0,0,1] neg_hi:[0,0,1]
    v_pk_fma_f32 v[18:19], v[18:19], v[250:251], v[162:163] op_sel:[0,1,0] op_sel_hi:[1,1,0] neg_lo:[0,1,0] neg_hi:[0,1,0]
    v_pk_fma_f32 v[132:133], v[20:21], v[250:251], v[160:161] op_sel:[0,1,0] op_sel_hi:[1,1,0] neg_lo:[0,0,1] neg_hi:[0,0,1]
    v_pk_fma_f32 v[20:21], v[20:21], v[250:251], v[162:163] op_sel:[0,1,0] op_sel_hi:[1,1,0] neg_lo:[0,1,0] neg_hi:[0,1,0]
    v_pk_fma_f32 v[134:135], v[22:23], v[250:251], v[160:161] op_sel:[0,1,0] op_sel_hi:[1,1,0] neg_lo:[0,0,1] neg_hi:[0,0,1]
    v_pk_fma_f32 v[22:23], v[22:23], v[250:251], v[162:163] op_sel:[0,1,0] op_sel_hi:[1,1,0] neg_lo:[0,1,0] neg_hi:[0,1,0]
    v_pk_fma_f32 v[136:137], v[24:25], v[250:251], v[160:161] op_sel:[0,1,0] op_sel_hi:[1,1,0] neg_lo:[0,0,1] neg_hi:[0,0,1]
    v_pk_fma_f32 v[24:25], v[24:25], v[250:251], v[162:163] op_sel:[0,1,0] op_sel_hi:[1,1,0] neg_lo:[0,1,0] neg_hi:[0,1,0]
    v_pk_fma_f32 v[138:139], v[26:27], v[250:251], v[160:161] op_sel:[0,1,0] op_sel_hi:[1,1,0] neg_lo:[0,0,1] neg_hi:[0,0,1]
    v_pk_fma_f32 v[26:27], v[26:27], v[250:251], v[162:163] op_sel:[0,1,0] op_sel_hi:[1,1,0] neg_lo:[0,1,0] neg_hi:[0,1,0]
    v_pk_fma_f32 v[140:141], v[28:29], v[250:251], v[160:161] op_sel:[0,1,0] op_sel_hi:[1,1,0] neg_lo:[0,0,1] neg_hi:[0,0,1]
    v_pk_fma_f32 v[28:29], v[28:29], v[250:251], v[162:163] op_sel:[0,1,0] op_sel_hi:[1,1,0] neg_lo:[0,1,0] neg_hi:[0,1,0]
    v_pk_fma_f32 v[142:143], v[30:31], v[250:251], v[160:161] op_sel:[0,1,0] op_sel_hi:[1,1,0] neg_lo:[0,0,1] neg_hi:[0,0,1]
    v_pk_fma_f32 v[30:31], v[30:31], v[250:251], v[162:163] op_sel:[0,1,0] op_sel_hi:[1,1,0] neg_lo:[0,1,0] neg_hi:[0,1,0]
    v_exp_f32 v128, v128
    v_exp_f32 v16, v16
    v_exp_f32 v129, v129
    v_exp_f32 v17, v17
    v_exp_f32 v130, v130
    v_exp_f32 v18, v18
    v_exp_f32 v131, v131
    v_exp_f32 v19, v19
    v_exp_f32 v132, v132
    v_exp_f32 v20, v20
    v_exp_f32 v133, v133
    v_exp_f32 v21, v21
    v_exp_f32 v134, v134
    v_exp_f32 v22, v22
    v_exp_f32 v135, v135
    v_exp_f32 v23, v23
    v_exp_f32 v136, v136
    v_exp_f32 v24, v24
    v_exp_f32 v137, v137
    v_exp_f32 v25, v25
    v_exp_f32 v138, v138
    v_exp_f32 v26, v26
    v_exp_f32 v139, v139
    v_exp_f32 v27, v27
    v_exp_f32 v140, v140
    v_exp_f32 v28, v28
    v_exp_f32 v141, v141
    v_exp_f32 v29, v29
    v_exp_f32 v142, v142
    v_exp_f32 v30, v30
    v_exp_f32 v143, v143
    v_exp_f32 v31, v31
    v_pk_fma_f32 v[144:145], v[32:33], v[252:253], v[164:165] op_sel:[0,1,0] op_sel_hi:[1,1,0] neg_lo:[0,0,1] neg_hi:[0,0,1]
    v_pk_fma_f32 v[32:33], v[32:33], v[252:253], v[166:167] op_sel:[0,1,0] op_sel_hi:[1,1,0] neg_lo:[0,1,0] neg_hi:[0,1,0]
    v_pk_fma_f32 v[146:147], v[34:35], v[252:253], v[164:165] op_sel:[0,1,0] op_sel_hi:[1,1,0] neg_lo:[0,0,1] neg_hi:[0,0,1]
    v_pk_fma_f32 v[34:35], v[34:35], v[252:253], v[166:167] op_sel:[0,1,0] op_sel_hi:[1,1,0] neg_lo:[0,1,0] neg_hi:[0,1,0]
    v_pk_fma_f32 v[148:149], v[36:37], v[252:253], v[164:165] op_sel:[0,1,0] op_sel_hi:[1,1,0] neg_lo:[0,0,1] neg_hi:[0,0,1]
    v_pk_fma_f32 v[36:37], v[36:37], v[252:253], v[166:167] op_sel:[0,1,0] op_sel_hi:[1,1,0] neg_lo:[0,1,0] neg_hi:[0,1,0]
    v_pk_fma_f32 v[150:151], v[38:39], v[252:253], v[164:165] op_sel:[0,1,0] op_sel_hi:[1,1,0] neg_lo:[0,0,1] neg_hi:[0,0,1]
    v_pk_fma_f32 v[38:39], v[38:39], v[252:253], v[166:167] op_sel:[0,1,0] op_sel_hi:[1,1,0] neg_lo:[0,1,0] neg_hi:[0,1,0]
    v_pk_fma_f32 v[152:153], v[40:41], v[252:253], v[164:165] op_sel:[0,1,0] op_sel_hi:[1,1,0] neg_lo:[0,0,1] neg_hi:[0,0,1]
    v_pk_fma_f32 v[40:41], v[40:41], v[252:253], v[166:167] op_sel:[0,1,0] op_sel_hi:[1,1,0] neg_lo:[0,1,0] neg_hi:[0,1,0]
    v_pk_fma_f32 v[154:155], v[42:43], v[252:253], v[164:165] op_sel:[0,1,0] op_sel_hi:[1,1,0] neg_lo:[0,0,1] neg_hi:[0,0,1]
    v_pk_fma_f32 v[42:43], v[42:43], v[252:253], v[166:167] op_sel:[0,1,0] op_sel_hi:[1,1,0] neg_lo:[0,1,0] neg_hi:[0,1,0]
    v_pk_fma_f32 v[156:157], v[44:45], v[252:253], v[164:165] op_sel:[0,1,0] op_sel_hi:[1,1,0] neg_lo:[0,0,1] neg_hi:[0,0,1]
    v_pk_fma_f32 v[44:45], v[44:45], v[252:253], v[166:167] op_sel:[0,1,0] op_sel_hi:[1,1,0] neg_lo:[0,1,0] neg_hi:[0,1,0]
    v_pk_fma_f32 v[158:159], v[46:47], v[252:253], v[164:165] op_sel:[0,1,0] op_sel_hi:[1,1,0] neg_lo:[0,0,1] neg_hi:[0,0,1]
    v_pk_fma_f32 v[46:47], v[46:47], v[252:253], v[166:167] op_sel:[0,1,0] op_sel_hi:[1,1,0] neg_lo:[0,1,0] neg_hi:[0,1,0]
    v_exp_f32 v144, v144
    v_exp_f32 v32, v32
    v_exp_f32 v145, v145
    v_exp_f32 v33, v33
    v_exp_f32 v146, v146
    v_exp_f32 v34, v34
    v_exp_f32 v147, v147
    v_exp_f32 v35, v35
    v_exp_f32 v148, v148
    v_exp_f32 v36, v36
    v_exp_f32 v149, v149
    v_exp_f32 v37, v37
    v_exp_f32 v150, v150
    v_exp_f32 v38, v38
    v_exp_f32 v151, v151
    v_exp_f32 v39, v39
    v_exp_f32 v152, v152
    v_exp_f32 v40, v40
    v_exp_f32 v153, v153
    v_exp_f32 v41, v41
    v_exp_f32 v154, v154
    v_exp_f32 v42, v42
    v_exp_f32 v155, v155
    v_exp_f32 v43, v43
    v_exp_f32 v156, v156
    v_exp_f32 v44, v44
    v_exp_f32 v157, v157
    v_exp_f32 v45, v45
    v_exp_f32 v158, v158
    v_exp_f32 v46, v46
    v_exp_f32 v159, v159
    v_exp_f32 v47, v47
    v_cvt_pk_bf16_f32 v218, v128, v129
    v_cvt_pk_bf16_f32 v219, v130, v131
    v_cvt_pk_bf16_f32 v220, v132, v133
    v_cvt_pk_bf16_f32 v221, v134, v135
    v_cvt_pk_bf16_f32 v222, v136, v137
    v_cvt_pk_bf16_f32 v223, v138, v139
    v_cvt_pk_bf16_f32 v224, v140, v141
    v_cvt_pk_bf16_f32 v225, v142, v143
    v_cvt_pk_bf16_f32 v226, v16, v17
    v_cvt_pk_bf16_f32 v227, v18, v19
    v_cvt_pk_bf16_f32 v228, v20, v21
    v_cvt_pk_bf16_f32 v229, v22, v23
    v_cvt_pk_bf16_f32 v230, v24, v25
    v_cvt_pk_bf16_f32 v231, v26, v27
    v_cvt_pk_bf16_f32 v232, v28, v29
    v_cvt_pk_bf16_f32 v233, v30, v31
    v_cvt_pk_bf16_f32 v234, v144, v145
    v_cvt_pk_bf16_f32 v235, v146, v147
    v_cvt_pk_bf16_f32 v236, v148, v149
    v_cvt_pk_bf16_f32 v237, v150, v151
    v_cvt_pk_bf16_f32 v238, v152, v153
    v_cvt_pk_bf16_f32 v239, v154, v155
    v_cvt_pk_bf16_f32 v240, v156, v157
    v_cvt_pk_bf16_f32 v241, v158, v159
    v_cvt_pk_bf16_f32 v242, v32, v33
    v_cvt_pk_bf16_f32 v243, v34, v35
    v_cvt_pk_bf16_f32 v244, v36, v37
    v_cvt_pk_bf16_f32 v245, v38, v39
    v_cvt_pk_bf16_f32 v246, v40, v41
    v_cvt_pk_bf16_f32 v247, v42, v43
    v_cvt_pk_bf16_f32 v248, v44, v45
    v_cvt_pk_bf16_f32 v249, v46, v47
    s_barrier
    buffer_load_dwordx4 v[32:35], v13, s[40:43], s78 offen offset:3072 sc1
    buffer_load_dwordx4 v[36:39], v13, s[40:43], s79 offen offset:3072 sc1
    buffer_load_dwordx4 v[40:43], v13, s[40:43], s78 offen offset:3200 sc1
    buffer_load_dwordx4 v[44:47], v13, s[40:43], s79 offen offset:3200 sc1
    ds_read_b128 v[16:19], v216 offset:24576
    ds_read_b128 v[20:23], v216 offset:24608
    ds_read_b128 v[24:27], v216 offset:24640
    ds_read_b128 v[28:31], v216 offset:24672
    s_waitcnt lgkmcnt(0)
    v_mfma_f32_32x32x16_bf16 v[48:63], v[16:19], v[218:221], 0
    v_mfma_f32_32x32x16_bf16 v[64:79], v[24:27], v[226:229], 0
    v_mfma_f32_32x32x16_bf16 v[80:95], v[16:19], v[234:237], 0
    v_mfma_f32_32x32x16_bf16 v[96:111], v[24:27], v[242:245], 0
    v_mfma_f32_32x32x16_bf16 v[48:63], v[20:23], v[222:225], v[48:63]
    v_mfma_f32_32x32x16_bf16 v[64:79], v[28:31], v[230:233], v[64:79]
    v_mfma_f32_32x32x16_bf16 v[80:95], v[20:23], v[238:241], v[80:95]
    v_mfma_f32_32x32x16_bf16 v[96:111], v[28:31], v[246:249], v[96:111]
    s_lshl_b32 s76, s63, 13
    s_lshl_b32 s77, s64, 11
    s_add_u32 s76, s76, s77
    s_add_u32 s76, s76, s73
    s_add_u32 s76, s76, 12288
    s_add_u32 s77, s76, 4096
    s_lshl_b32 s80, s62, 7
    s_add_u32 s80, s80, s73
    v_mov_b32 v8, 0
    v_rcp_f32 v176, v49
    v_rcp_f32 v177, v65
    v_rcp_f32 v178, v81
    v_rcp_f32 v179, v97
    v_mul_f32 v6, v48, v176
    v_fmac_f32_e64 v6, v64, v177
    v_add_f32 v6, 0x358637bd, v6
    v_mul_f32 v7, v80, v178
    v_fmac_f32 v7, v96, v179
    v_add_f32 v7, 0x358637bd, v7
    v_rcp_f32 v6, v6
    v_rcp_f32 v7, v7
    v_mul_f32 v176, v176, v6
    v_mul_f32 v177, v177, v6
    v_mul_f32 v178, v178, v7
    v_mul_f32 v179, v179, v7
    s_mov_b32 s88, 0
    s_branch L_kfirst_46
L_kr_47:
    buffer_load_dwordx4 v[32:35], v13, s[40:43], s78 offen offset:3072 sc1
    buffer_load_dwordx4 v[36:39], v13, s[40:43], s79 offen offset:3072 sc1
    buffer_load_dwordx4 v[40:43], v13, s[40:43], s78 offen offset:3200 sc1
    buffer_load_dwordx4 v[44:47], v13, s[40:43], s79 offen offset:3200 sc1
L_kfirst_46:
    s_waitcnt vmcnt(0)
    v_max3_u32 v9, v32, v33, v34
    v_max3_u32 v9, v9, v35, v36
    v_max3_u32 v9, v9, v37, v38
    v_max3_u32 v9, v9, v39, v40
    v_max3_u32 v9, v9, v41, v42
    v_max3_u32 v9, v9, v43, v44
    v_max3_u32 v9, v9, v45, v46
    v_max_u32 v9, v9, v47
    v_cmp_eq_u32 vcc, -1, v9
    s_nop 0
    s_cbranch_vccz L_ok_48
    s_add_u32 s88, s88, 1
    s_cmp_lt_u32 s88, 65536
    s_cbranch_scc1 L_kr_47
L_ok_48:
    v_mfma_f32_32x32x16_bf16 v[112:127], v[32:35], v[218:221], 0
    s_barrier
    v_mfma_f32_32x32x16_bf16 v[128:143], v[40:43], v[226:229], 0
    v_mfma_f32_32x32x16_bf16 v[112:127], v[36:39], v[222:225], v[112:127]
    v_mfma_f32_32x32x16_bf16 v[128:143], v[44:47], v[230:233], v[128:143]
    v_mfma_f32_32x32x16_bf16 v[144:159], v[32:35], v[234:237], 0
    v_mfma_f32_32x32x16_bf16 v[160:175], v[40:43], v[242:245], 0
    v_mfma_f32_32x32x16_bf16 v[144:159], v[36:39], v[238:241], v[144:159]
    v_mfma_f32_32x32x16_bf16 v[160:175], v[44:47], v[246:249], v[160:175]
    s_nop 6
    v_pk_mul_f32 v[112:113], v[112:113], v[176:177] op_sel_hi:[1,0]
    v_pk_fma_f32 v[112:113], v[128:129], v[176:177], v[112:113] op_sel:[0,1,0] op_sel_hi:[1,1,1]
    v_cvt_pk_bf16_f32 v48, v112, v113
    v_pk_mul_f32 v[114:115], v[114:115], v[176:177] op_sel_hi:[1,0]
    v_pk_fma_f32 v[114:115], v[130:131], v[176:177], v[114:115] op_sel:[0,1,0] op_sel_hi:[1,1,1]
    v_cvt_pk_bf16_f32 v49, v114, v115
    v_pk_mul_f32 v[116:117], v[116:117], v[176:177] op_sel_hi:[1,0]
    v_pk_fma_f32 v[116:117], v[132:133], v[176:177], v[116:117] op_sel:[0,1,0] op_sel_hi:[1,1,1]
    v_cvt_pk_bf16_f32 v50, v116, v117
    v_pk_mul_f32 v[118:119], v[118:119], v[176:177] op_sel_hi:[1,0]
    v_pk_fma_f32 v[118:119], v[134:135], v[176:177], v[118:119] op_sel:[0,1,0] op_sel_hi:[1,1,1]
    v_cvt_pk_bf16_f32 v51, v118, v119
    buffer_store_dwordx4 v[48:51], v12, s[40:43], s76 offen offset:0 sc1
    v_pk_mul_f32 v[120:121], v[120:121], v[176:177] op_sel_hi:[1,0]
    v_pk_fma_f32 v[120:121], v[136:137], v[176:177], v[120:121] op_sel:[0,1,0] op_sel_hi:[1,1,1]
    v_cvt_pk_bf16_f32 v52, v120, v121
    v_pk_mul_f32 v[122:123], v[122:123], v[176:177] op_sel_hi:[1,0]
    v_pk_fma_f32 v[122:123], v[138:139], v[176:177], v[122:123] op_sel:[0,1,0] op_sel_hi:[1,1,1]
    v_cvt_pk_bf16_f32 v53, v122, v123
    v_pk_mul_f32 v[124:125], v[124:125], v[176:177] op_sel_hi:[1,0]
    v_pk_fma_f32 v[124:125], v[140:141], v[176:177], v[124:125] op_sel:[0,1,0] op_sel_hi:[1,1,1]
    v_cvt_pk_bf16_f32 v54, v124, v125
    v_pk_mul_f32 v[126:127], v[126:127], v[176:177] op_sel_hi:[1,0]
    v_pk_fma_f32 v[126:127], v[142:143], v[176:177], v[126:127] op_sel:[0,1,0] op_sel_hi:[1,1,1]
    v_cvt_pk_bf16_f32 v55, v126, v127
    buffer_store_dwordx4 v[52:55], v12, s[40:43], s76 offen offset:1024 sc1
    v_pk_mul_f32 v[144:145], v[144:145], v[178:179] op_sel_hi:[1,0]
    v_pk_fma_f32 v[144:145], v[160:161], v[178:179], v[144:145] op_sel:[0,1,0] op_sel_hi:[1,1,1]
    v_cvt_pk_bf16_f32 v56, v144, v145
    v_pk_mul_f32 v[146:147], v[146:147], v[178:179] op_sel_hi:[1,0]
    v_pk_fma_f32 v[146:147], v[162:163], v[178:179], v[146:147] op_sel:[0,1,0] op_sel_hi:[1,1,1]
    v_cvt_pk_bf16_f32 v57, v146, v147
    v_pk_mul_f32 v[148:149], v[148:149], v[178:179] op_sel_hi:[1,0]
    v_pk_fma_f32 v[148:149], v[164:165], v[178:179], v[148:149] op_sel:[0,1,0] op_sel_hi:[1,1,1]
    v_cvt_pk_bf16_f32 v58, v148, v149
    v_pk_mul_f32 v[150:151], v[150:151], v[178:179] op_sel_hi:[1,0]
    v_pk_fma_f32 v[150:151], v[166:167], v[178:179], v[150:151] op_sel:[0,1,0] op_sel_hi:[1,1,1]
    v_cvt_pk_bf16_f32 v59, v150, v151
    buffer_store_dwordx4 v[56:59], v12, s[40:43], s77 offen offset:0 sc1
    v_pk_mul_f32 v[152:153], v[152:153], v[178:179] op_sel_hi:[1,0]
    v_pk_fma_f32 v[152:153], v[168:169], v[178:179], v[152:153] op_sel:[0,1,0] op_sel_hi:[1,1,1]
    v_cvt_pk_bf16_f32 v60, v152, v153
    v_pk_mul_f32 v[154:155], v[154:155], v[178:179] op_sel_hi:[1,0]
    v_pk_fma_f32 v[154:155], v[170:171], v[178:179], v[154:155] op_sel:[0,1,0] op_sel_hi:[1,1,1]
    v_cvt_pk_bf16_f32 v61, v154, v155
    v_pk_mul_f32 v[156:157], v[156:157], v[178:179] op_sel_hi:[1,0]
    v_pk_fma_f32 v[156:157], v[172:173], v[178:179], v[156:157] op_sel:[0,1,0] op_sel_hi:[1,1,1]
    v_cvt_pk_bf16_f32 v62, v156, v157
    v_pk_mul_f32 v[158:159], v[158:159], v[178:179] op_sel_hi:[1,0]
    v_pk_fma_f32 v[158:159], v[174:175], v[178:179], v[158:159] op_sel:[0,1,0] op_sel_hi:[1,1,1]
    v_cvt_pk_bf16_f32 v63, v158, v159
    buffer_store_dwordx4 v[60:63], v12, s[40:43], s77 offen offset:1024 sc1
    s_mov_b64 exec, 1
    buffer_store_dword v8, v8, s[40:43], s80 offen offset:3584 sc1
    s_mov_b64 exec, -1
    global_load_dwordx2 v[192:193], v4, s[14:15] offset:0
    global_load_dwordx2 v[194:195], v4, s[14:15] offset:16
    global_load_dwordx2 v[196:197], v4, s[14:15] offset:32
    global_load_dwordx2 v[198:199], v4, s[14:15] offset:48
    global_load_dwordx2 v[200:201], v4, s[14:15] offset:64
    global_load_dwordx2 v[202:203], v4, s[14:15] offset:80
    global_load_dwordx2 v[204:205], v4, s[14:15] offset:96
    global_load_dwordx2 v[206:207], v4, s[14:15] offset:112
    global_load_dwordx4 v[80:83], v5, s[14:15] offset:0
    global_load_dwordx4 v[84:87], v5, s[14:15] offset:16
    v_bfe_u32 v4, v2, 1, 3
    v_lshlrev_b32 v4, 4, v4
    v_lshl_add_u32 v4, v3, 3, v4
    v_lshl_add_u32 v4, v2, 7, v4
    s_lshl_b32 s76, s62, 12
    s_add_u32 s77, s76, 0
    v_add_u32 v64, s77, v4
    v_xor_b32 v65, 16, v64
    v_xor_b32 v66, 32, v64
    v_xor_b32 v67, 48, v64
    v_xor_b32_e64 v68, 64, v64
    v_xor_b32 v69, 80, v64
    v_xor_b32 v70, 96, v64
    v_xor_b32 v71, 112, v64
    v_bfe_u32 v4, v1, 2, 2
    v_lshl_add_u32 v5, v3, 2, v4
    v_lshlrev_b32 v5, 7, v5
    v_lshrrev_b32 v4, 1, v4
    v_lshl_add_u32 v5, v4, 6, v5
    v_bfe_u32 v4, v1, 4, 1
    v_lshl_add_u32 v5, v4, 5, v5
    v_and_b32_e64 v4, 3, v1
    v_lshl_add_u32 v5, v4, 3, v5
    v_add_u32 v72, 32768, v5
    v_xor_b32_e64 v73, 64, v72
    v_add_u32 v74, 65536, v72
    v_add_u32 v75, 65536, v73
    s_mul_i32 s80, s97, 460800
    s_add_u32 s80, s80, s76
    s_add_u32 s80, s80, 12288
    s_waitcnt vmcnt(0)
    v_dot2_f32_bf16 v76, v80, s89, 0
    v_dot2_f32_bf16 v76, v81, s89, v76
    v_dot2_f32_bf16 v76, v82, s89, v76
    v_dot2_f32_bf16 v76, v83, s89, v76
    v_dot2_f32_bf16 v76, v84, s89, v76
    v_dot2_f32_bf16 v76, v85, s89, v76
    v_dot2_f32_bf16 v76, v86, s89, v76
    v_dot2_f32_bf16 v76, v87, s89, v76
    s_nop 2
    v_add_f32_dpp v76, v76, v76 row_ror:8 row_mask:0xf bank_mask:0xf
    s_nop 1
    v_add_f32_dpp v76, v76, v76 row_ror:4 row_mask:0xf bank_mask:0xf
    s_nop 1
    v_add_f32_dpp v76, v76, v76 row_ror:2 row_mask:0xf bank_mask:0xf
    s_nop 1
    v_add_f32_dpp v76, v76, v76 row_ror:1 row_mask:0xf bank_mask:0xf
    v_mov_b32 v4, v76
    s_nop 1
    v_permlane16_swap_b32 v76, v4
    v_add_f32 v76, v76, v4
    v_mov_b32 v4, v76
    s_nop 1
    v_permlane32_swap_b32 v76, v4
    v_add_f32 v76, v76, v4
    s_barrier
    s_mov_b32 s88, 0
L_g2:
    s_add_u32 s76, s65, 0
    s_and_b32 s76, s76, 15
    s_mul_i32 s76, s76, 28800
    s_add_u32 s76, s76, s80
    buffer_load_dwordx4 v[128:131], v12, s[40:43], s76 offen offset:0 sc1
    buffer_load_dwordx4 v[132:135], v12, s[40:43], s76 offen offset:1024 sc1
    buffer_load_dwordx4 v[136:139], v12, s[40:43], s76 offen offset:2048 sc1
    buffer_load_dwordx4 v[140:143], v12, s[40:43], s76 offen offset:3072 sc1
    ds_read_b64 v[88:89], v64
    ds_read_b64 v[90:91], v65
    ds_read_b64 v[92:93], v66
    ds_read_b64 v[94:95], v67
    ds_read_b64 v[96:97], v68
    ds_read_b64 v[98:99], v69
    ds_read_b64 v[100:101], v70
    ds_read_b64 v[102:103], v71
    s_add_u32 s76, s65, 1
    s_and_b32 s76, s76, 15
    s_mul_i32 s76, s76, 28800
    s_add_u32 s76, s76, s80
    buffer_load_dwordx4 v[144:147], v12, s[40:43], s76 offen offset:0 sc1
    buffer_load_dwordx4 v[148:151], v12, s[40:43], s76 offen offset:1024 sc1
    buffer_load_dwordx4 v[152:155], v12, s[40:43], s76 offen offset:2048 sc1
    buffer_load_dwordx4 v[156:159], v12, s[40:43], s76 offen offset:3072 sc1
    s_add_u32 s76, s65, 2
    s_and_b32 s76, s76, 15
    s_mul_i32 s76, s76, 28800
    s_add_u32 s76, s76, s80
    buffer_load_dwordx4 v[160:163], v12, s[40:43], s76 offen offset:0 sc1
    buffer_load_dwordx4 v[164:167], v12, s[40:43], s76 offen offset:1024 sc1
    buffer_load_dwordx4 v[168:171], v12, s[40:43], s76 offen offset:2048 sc1
    buffer_load_dwordx4 v[172:175], v12, s[40:43], s76 offen offset:3072 sc1
    s_waitcnt lgkmcnt(0)
    ds_read_b64_tr_b16 v[104:105], v72 offset:24576
    ds_read_b64_tr_b16 v[106:107], v72 offset:25600
    ds_read_b64_tr_b16 v[108:109], v73 offset:24576
    ds_read_b64_tr_b16 v[110:111], v73 offset:25600
    ds_read_b64_tr_b16 v[112:113], v72 offset:26624
    ds_read_b64_tr_b16 v[114:115], v72 offset:27648
    ds_read_b64_tr_b16 v[116:117], v73 offset:26624
    ds_read_b64_tr_b16 v[118:119], v73 offset:27648
    v_lshlrev_b32 v16, 16, v88
    v_and_b32 v17, s90, v88
    v_lshlrev_b32 v18, 16, v89
    v_and_b32 v19, s90, v89
    v_lshlrev_b32 v20, 16, v90
    v_and_b32 v21, s90, v90
    v_lshlrev_b32 v22, 16, v91
    v_and_b32 v23, s90, v91
    v_lshlrev_b32 v24, 16, v92
    v_and_b32 v25, s90, v92
    v_lshlrev_b32 v26, 16, v93
    v_and_b32 v27, s90, v93
    v_lshlrev_b32 v28, 16, v94
    v_and_b32 v29, s90, v94
    v_lshlrev_b32 v30, 16, v95
    v_and_b32 v31, s90, v95
    v_lshlrev_b32 v32, 16, v96
    v_and_b32 v33, s90, v96
    v_lshlrev_b32 v34, 16, v97
    v_and_b32 v35, s90, v97
    v_lshlrev_b32 v36, 16, v98
    v_and_b32 v37, s90, v98
    v_lshlrev_b32 v38, 16, v99
    v_and_b32 v39, s90, v99
    v_lshlrev_b32 v40, 16, v100
    v_and_b32 v41, s90, v100
    v_lshlrev_b32 v42, 16, v101
    v_and_b32 v43, s90, v101
    v_lshlrev_b32 v44, 16, v102
    v_and_b32 v45, s90, v102
    v_lshlrev_b32 v46, 16, v103
    v_and_b32 v47, s90, v103
    v_mov_b32 v77, 0
    s_waitcnt vmcnt(11) lgkmcnt(4)
    v_mfma_f32_32x32x16_bf16 v[16:31], v[104:107], v[128:131], v[16:31]
    ds_read_b64_tr_b16 v[120:121], v72 offset:28672
    ds_read_b64_tr_b16 v[122:123], v72 offset:29696
    s_add_u32 s76, s65, 3
    s_and_b32 s76, s76, 15
    s_mul_i32 s76, s76, 28800
    s_add_u32 s76, s76, s80
    buffer_load_dwordx4 v[176:179], v12, s[40:43], s76 offen offset:0 sc1
    v_mfma_f32_32x32x16_bf16 v[32:47], v[108:111], v[128:131], v[32:47]
    ds_read_b64_tr_b16 v[124:125], v73 offset:28672
    ds_read_b64_tr_b16 v[126:127], v73 offset:29696
    v_max_u32_e64 v77, v77, v128
    s_waitcnt vmcnt(11) lgkmcnt(4)
    v_mfma_f32_32x32x16_bf16 v[16:31], v[112:115], v[132:135], v[16:31]
    ds_read_b64_tr_b16 v[104:105], v72 offset:30720
    ds_read_b64_tr_b16 v[106:107], v72 offset:31744
    buffer_load_dwordx4 v[180:183], v12, s[40:43], s76 offen offset:1024 sc1
    v_mfma_f32_32x32x16_bf16 v[32:47], v[116:119], v[132:135], v[32:47]
    ds_read_b64_tr_b16 v[108:109], v73 offset:30720
    ds_read_b64_tr_b16 v[110:111], v73 offset:31744
    v_max_u32 v77, v77, v132
    s_waitcnt vmcnt(11) lgkmcnt(4)
    v_mfma_f32_32x32x16_bf16 v[16:31], v[120:123], v[136:139], v[16:31]
    ds_read_b64_tr_b16 v[112:113], v72 offset:32768
    ds_read_b64_tr_b16 v[114:115], v72 offset:33792
    buffer_load_dwordx4 v[184:187], v12, s[40:43], s76 offen offset:2048 sc1
    v_mfma_f32_32x32x16_bf16 v[32:47], v[124:127], v[136:139], v[32:47]
    ds_read_b64_tr_b16 v[116:117], v73 offset:32768
    ds_read_b64_tr_b16 v[118:119], v73 offset:33792
    v_max_u32 v77, v77, v136
    s_waitcnt vmcnt(11) lgkmcnt(4)
    v_mfma_f32_32x32x16_bf16 v[16:31], v[104:107], v[140:143], v[16:31]
    ds_read_b64_tr_b16 v[120:121], v72 offset:34816
    ds_read_b64_tr_b16 v[122:123], v72 offset:35840
    buffer_load_dwordx4 v[188:191], v12, s[40:43], s76 offen offset:3072 sc1
    v_mfma_f32_32x32x16_bf16 v[32:47], v[108:111], v[140:143], v[32:47]
    ds_read_b64_tr_b16 v[124:125], v73 offset:34816
    ds_read_b64_tr_b16 v[126:127], v73 offset:35840
    v_max_u32 v77, v77, v140
    s_waitcnt vmcnt(11) lgkmcnt(4)
    v_mfma_f32_32x32x16_bf16 v[16:31], v[112:115], v[144:147], v[16:31]
    ds_read_b64_tr_b16 v[104:105], v72 offset:36864
    ds_read_b64_tr_b16 v[106:107], v72 offset:37888
    s_add_u32 s76, s65, 4
    s_and_b32 s76, s76, 15
    s_mul_i32 s76, s76, 28800
    s_add_u32 s76, s76, s80
    buffer_load_dwordx4 v[128:131], v12, s[40:43], s76 offen offset:0 sc1
    v_mfma_f32_32x32x16_bf16 v[32:47], v[116:119], v[144:147], v[32:47]
    ds_read_b64_tr_b16 v[108:109], v73 offset:36864
    ds_read_b64_tr_b16 v[110:111], v73 offset:37888
    v_max_u32_e64 v77, v77, v144
    s_waitcnt vmcnt(11) lgkmcnt(4)
    v_mfma_f32_32x32x16_bf16 v[16:31], v[120:123], v[148:151], v[16:31]
    ds_read_b64_tr_b16 v[112:113], v72 offset:38912
    ds_read_b64_tr_b16 v[114:115], v72 offset:39936
    buffer_load_dwordx4 v[132:135], v12, s[40:43], s76 offen offset:1024 sc1
    v_mfma_f32_32x32x16_bf16 v[32:47], v[124:127], v[148:151], v[32:47]
    ds_read_b64_tr_b16 v[116:117], v73 offset:38912
    ds_read_b64_tr_b16 v[118:119], v73 offset:39936
    v_max_u32 v77, v77, v148
    s_waitcnt vmcnt(11) lgkmcnt(4)
    v_mfma_f32_32x32x16_bf16 v[16:31], v[104:107], v[152:155], v[16:31]
    ds_read_b64_tr_b16 v[120:121], v72 offset:40960
    ds_read_b64_tr_b16 v[122:123], v72 offset:41984
    buffer_load_dwordx4 v[136:139], v12, s[40:43], s76 offen offset:2048 sc1
    v_mfma_f32_32x32x16_bf16 v[32:47], v[108:111], v[152:155], v[32:47]
    ds_read_b64_tr_b16 v[124:125], v73 offset:40960
    ds_read_b64_tr_b16 v[126:127], v73 offset:41984
    v_max_u32 v77, v77, v152
    s_waitcnt vmcnt(11) lgkmcnt(4)
    v_mfma_f32_32x32x16_bf16 v[16:31], v[112:115], v[156:159], v[16:31]
    ds_read_b64_tr_b16 v[104:105], v72 offset:43008
    ds_read_b64_tr_b16 v[106:107], v72 offset:44032
    buffer_load_dwordx4 v[140:143], v12, s[40:43], s76 offen offset:3072 sc1
    v_mfma_f32_32x32x16_bf16 v[32:47], v[116:119], v[156:159], v[32:47]
    ds_read_b64_tr_b16 v[108:109], v73 offset:43008
    ds_read_b64_tr_b16 v[110:111], v73 offset:44032
    v_max_u32 v77, v77, v156
    s_waitcnt vmcnt(11) lgkmcnt(4)
    v_mfma_f32_32x32x16_bf16 v[16:31], v[120:123], v[160:163], v[16:31]
    ds_read_b64_tr_b16 v[112:113], v72 offset:45056
    ds_read_b64_tr_b16 v[114:115], v72 offset:46080
    s_add_u32 s76, s65, 5
    s_and_b32 s76, s76, 15
    s_mul_i32 s76, s76, 28800
    s_add_u32 s76, s76, s80
    buffer_load_dwordx4 v[144:147], v12, s[40:43], s76 offen offset:0 sc1
    v_mfma_f32_32x32x16_bf16 v[32:47], v[124:127], v[160:163], v[32:47]
    ds_read_b64_tr_b16 v[116:117], v73 offset:45056
    ds_read_b64_tr_b16 v[118:119], v73 offset:46080
    v_max_u32_e64 v77, v77, v160
    s_waitcnt vmcnt(11) lgkmcnt(4)
    v_mfma_f32_32x32x16_bf16 v[16:31], v[104:107], v[164:167], v[16:31]
    ds_read_b64_tr_b16 v[120:121], v72 offset:47104
    ds_read_b64_tr_b16 v[122:123], v72 offset:48128
    buffer_load_dwordx4 v[148:151], v12, s[40:43], s76 offen offset:1024 sc1
    v_mfma_f32_32x32x16_bf16 v[32:47], v[108:111], v[164:167], v[32:47]
    ds_read_b64_tr_b16 v[124:125], v73 offset:47104
    ds_read_b64_tr_b16 v[126:127], v73 offset:48128
    v_max_u32 v77, v77, v164
    s_waitcnt vmcnt(11) lgkmcnt(4)
    v_mfma_f32_32x32x16_bf16 v[16:31], v[112:115], v[168:171], v[16:31]
    ds_read_b64_tr_b16 v[104:105], v72 offset:49152
    ds_read_b64_tr_b16 v[106:107], v72 offset:50176
    buffer_load_dwordx4 v[152:155], v12, s[40:43], s76 offen offset:2048 sc1
    v_mfma_f32_32x32x16_bf16 v[32:47], v[116:119], v[168:171], v[32:47]
    ds_read_b64_tr_b16 v[108:109], v73 offset:49152
    ds_read_b64_tr_b16 v[110:111], v73 offset:50176
    v_max_u32 v77, v77, v168
    s_waitcnt vmcnt(11) lgkmcnt(4)
    v_mfma_f32_32x32x16_bf16 v[16:31], v[120:123], v[172:175], v[16:31]
    ds_read_b64_tr_b16 v[112:113], v72 offset:51200
    ds_read_b64_tr_b16 v[114:115], v72 offset:52224
    buffer_load_dwordx4 v[156:159], v12, s[40:43], s76 offen offset:3072 sc1
    v_mfma_f32_32x32x16_bf16 v[32:47], v[124:127], v[172:175], v[32:47]
    ds_read_b64_tr_b16 v[116:117], v73 offset:51200
    ds_read_b64_tr_b16 v[118:119], v73 offset:52224
    v_max_u32 v77, v77, v172
    s_waitcnt vmcnt(11) lgkmcnt(4)
    v_mfma_f32_32x32x16_bf16 v[16:31], v[104:107], v[176:179], v[16:31]
    ds_read_b64_tr_b16 v[120:121], v72 offset:53248
    ds_read_b64_tr_b16 v[122:123], v72 offset:54272
    s_add_u32 s76, s65, 6
    s_and_b32 s76, s76, 15
    s_mul_i32 s76, s76, 28800
    s_add_u32 s76, s76, s80
    buffer_load_dwordx4 v[160:163], v12, s[40:43], s76 offen offset:0 sc1
    v_mfma_f32_32x32x16_bf16 v[32:47], v[108:111], v[176:179], v[32:47]
    ds_read_b64_tr_b16 v[124:125], v73 offset:53248
    ds_read_b64_tr_b16 v[126:127], v73 offset:54272
    v_max_u32_e64 v77, v77, v176
    s_waitcnt vmcnt(11) lgkmcnt(4)
    v_mfma_f32_32x32x16_bf16 v[16:31], v[112:115], v[180:183], v[16:31]
    ds_read_b64_tr_b16 v[104:105], v72 offset:55296
    ds_read_b64_tr_b16 v[106:107], v72 offset:56320
    buffer_load_dwordx4 v[164:167], v12, s[40:43], s76 offen offset:1024 sc1
    v_mfma_f32_32x32x16_bf16 v[32:47], v[116:119], v[180:183], v[32:47]
    ds_read_b64_tr_b16 v[108:109], v73 offset:55296
    ds_read_b64_tr_b16 v[110:111], v73 offset:56320
    v_max_u32 v77, v77, v180
    s_waitcnt vmcnt(11) lgkmcnt(4)
    v_mfma_f32_32x32x16_bf16 v[16:31], v[120:123], v[184:187], v[16:31]
    ds_read_b64_tr_b16 v[112:113], v72 offset:57344
    ds_read_b64_tr_b16 v[114:115], v72 offset:58368
    buffer_load_dwordx4 v[168:171], v12, s[40:43], s76 offen offset:2048 sc1
    v_mfma_f32_32x32x16_bf16 v[32:47], v[124:127], v[184:187], v[32:47]
    ds_read_b64_tr_b16 v[116:117], v73 offset:57344
    ds_read_b64_tr_b16 v[118:119], v73 offset:58368
    v_max_u32 v77, v77, v184
    s_waitcnt vmcnt(11) lgkmcnt(4)
    v_mfma_f32_32x32x16_bf16 v[16:31], v[104:107], v[188:191], v[16:31]
    ds_read_b64_tr_b16 v[120:121], v72 offset:59392
    ds_read_b64_tr_b16 v[122:123], v72 offset:60416
    buffer_load_dwordx4 v[172:175], v12, s[40:43], s76 offen offset:3072 sc1
    v_mfma_f32_32x32x16_bf16 v[32:47], v[108:111], v[188:191], v[32:47]
    ds_read_b64_tr_b16 v[124:125], v73 offset:59392
    ds_read_b64_tr_b16 v[126:127], v73 offset:60416
    v_max_u32 v77, v77, v188
    s_waitcnt vmcnt(11) lgkmcnt(4)
    v_mfma_f32_32x32x16_bf16 v[16:31], v[112:115], v[128:131], v[16:31]
    ds_read_b64_tr_b16 v[104:105], v72 offset:61440
    ds_read_b64_tr_b16 v[106:107], v72 offset:62464
    s_add_u32 s76, s65, 7
    s_and_b32 s76, s76, 15
    s_mul_i32 s76, s76, 28800
    s_add_u32 s76, s76, s80
    buffer_load_dwordx4 v[176:179], v12, s[40:43], s76 offen offset:0 sc1
    v_mfma_f32_32x32x16_bf16 v[32:47], v[116:119], v[128:131], v[32:47]
    ds_read_b64_tr_b16 v[108:109], v73 offset:61440
    ds_read_b64_tr_b16 v[110:111], v73 offset:62464
    v_max_u32_e64 v77, v77, v128
    s_waitcnt vmcnt(11) lgkmcnt(4)
    v_mfma_f32_32x32x16_bf16 v[16:31], v[120:123], v[132:135], v[16:31]
    ds_read_b64_tr_b16 v[112:113], v72 offset:63488
    ds_read_b64_tr_b16 v[114:115], v72 offset:64512
    buffer_load_dwordx4 v[180:183], v12, s[40:43], s76 offen offset:1024 sc1
    v_mfma_f32_32x32x16_bf16 v[32:47], v[124:127], v[132:135], v[32:47]
    ds_read_b64_tr_b16 v[116:117], v73 offset:63488
    ds_read_b64_tr_b16 v[118:119], v73 offset:64512
    v_max_u32 v77, v77, v132
    s_waitcnt vmcnt(11) lgkmcnt(4)
    v_mfma_f32_32x32x16_bf16 v[16:31], v[104:107], v[136:139], v[16:31]
    ds_read_b64_tr_b16 v[120:121], v74 offset:0
    ds_read_b64_tr_b16 v[122:123], v74 offset:1024
    buffer_load_dwordx4 v[184:187], v12, s[40:43], s76 offen offset:2048 sc1
    v_mfma_f32_32x32x16_bf16 v[32:47], v[108:111], v[136:139], v[32:47]
    ds_read_b64_tr_b16 v[124:125], v75 offset:0
    ds_read_b64_tr_b16 v[126:127], v75 offset:1024
    v_max_u32 v77, v77, v136
    s_waitcnt vmcnt(11) lgkmcnt(4)
    v_mfma_f32_32x32x16_bf16 v[16:31], v[112:115], v[140:143], v[16:31]
    ds_read_b64_tr_b16 v[104:105], v74 offset:2048
    ds_read_b64_tr_b16 v[106:107], v74 offset:3072
    buffer_load_dwordx4 v[188:191], v12, s[40:43], s76 offen offset:3072 sc1
    v_mfma_f32_32x32x16_bf16 v[32:47], v[116:119], v[140:143], v[32:47]
    ds_read_b64_tr_b16 v[108:109], v75 offset:2048
    ds_read_b64_tr_b16 v[110:111], v75 offset:3072
    v_max_u32 v77, v77, v140
    s_waitcnt vmcnt(11) lgkmcnt(4)
    v_mfma_f32_32x32x16_bf16 v[16:31], v[120:123], v[144:147], v[16:31]
    ds_read_b64_tr_b16 v[112:113], v74 offset:4096
    ds_read_b64_tr_b16 v[114:115], v74 offset:5120
    s_add_u32 s76, s65, 8
    s_and_b32 s76, s76, 15
    s_mul_i32 s76, s76, 28800
    s_add_u32 s76, s76, s80
    buffer_load_dwordx4 v[128:131], v12, s[40:43], s76 offen offset:0 sc1
    v_mfma_f32_32x32x16_bf16 v[32:47], v[124:127], v[144:147], v[32:47]
    ds_read_b64_tr_b16 v[116:117], v75 offset:4096
    ds_read_b64_tr_b16 v[118:119], v75 offset:5120
    v_max_u32_e64 v77, v77, v144
    s_waitcnt vmcnt(11) lgkmcnt(4)
    v_mfma_f32_32x32x16_bf16 v[16:31], v[104:107], v[148:151], v[16:31]
    ds_read_b64_tr_b16 v[120:121], v74 offset:6144
    ds_read_b64_tr_b16 v[122:123], v74 offset:7168
    buffer_load_dwordx4 v[132:135], v12, s[40:43], s76 offen offset:1024 sc1
    v_mfma_f32_32x32x16_bf16 v[32:47], v[108:111], v[148:151], v[32:47]
    ds_read_b64_tr_b16 v[124:125], v75 offset:6144
    ds_read_b64_tr_b16 v[126:127], v75 offset:7168
    v_max_u32 v77, v77, v148
    s_waitcnt vmcnt(11) lgkmcnt(4)
    v_mfma_f32_32x32x16_bf16 v[16:31], v[112:115], v[152:155], v[16:31]
    ds_read_b64_tr_b16 v[104:105], v74 offset:8192
    ds_read_b64_tr_b16 v[106:107], v74 offset:9216
    buffer_load_dwordx4 v[136:139], v12, s[40:43], s76 offen offset:2048 sc1
    v_mfma_f32_32x32x16_bf16 v[32:47], v[116:119], v[152:155], v[32:47]
    ds_read_b64_tr_b16 v[108:109], v75 offset:8192
    ds_read_b64_tr_b16 v[110:111], v75 offset:9216
    v_max_u32 v77, v77, v152
    s_waitcnt vmcnt(11) lgkmcnt(4)
    v_mfma_f32_32x32x16_bf16 v[16:31], v[120:123], v[156:159], v[16:31]
    ds_read_b64_tr_b16 v[112:113], v74 offset:10240
    ds_read_b64_tr_b16 v[114:115], v74 offset:11264
    buffer_load_dwordx4 v[140:143], v12, s[40:43], s76 offen offset:3072 sc1
    v_mfma_f32_32x32x16_bf16 v[32:47], v[124:127], v[156:159], v[32:47]
    ds_read_b64_tr_b16 v[116:117], v75 offset:10240
    ds_read_b64_tr_b16 v[118:119], v75 offset:11264
    v_max_u32 v77, v77, v156
    s_waitcnt vmcnt(11) lgkmcnt(4)
    v_mfma_f32_32x32x16_bf16 v[16:31], v[104:107], v[160:163], v[16:31]
    ds_read_b64_tr_b16 v[120:121], v74 offset:12288
    ds_read_b64_tr_b16 v[122:123], v74 offset:13312
    s_add_u32 s76, s65, 9
    s_and_b32 s76, s76, 15
    s_mul_i32 s76, s76, 28800
    s_add_u32 s76, s76, s80
    buffer_load_dwordx4 v[144:147], v12, s[40:43], s76 offen offset:0 sc1
    v_mfma_f32_32x32x16_bf16 v[32:47], v[108:111], v[160:163], v[32:47]
    ds_read_b64_tr_b16 v[124:125], v75 offset:12288
    ds_read_b64_tr_b16 v[126:127], v75 offset:13312
    v_max_u32_e64 v77, v77, v160
    s_waitcnt vmcnt(11) lgkmcnt(4)
    v_mfma_f32_32x32x16_bf16 v[16:31], v[112:115], v[164:167], v[16:31]
    ds_read_b64_tr_b16 v[104:105], v74 offset:14336
    ds_read_b64_tr_b16 v[106:107], v74 offset:15360
    buffer_load_dwordx4 v[148:151], v12, s[40:43], s76 offen offset:1024 sc1
    v_mfma_f32_32x32x16_bf16 v[32:47], v[116:119], v[164:167], v[32:47]
    ds_read_b64_tr_b16 v[108:109], v75 offset:14336
    ds_read_b64_tr_b16 v[110:111], v75 offset:15360
    v_max_u32 v77, v77, v164
    s_waitcnt vmcnt(11) lgkmcnt(4)
    v_mfma_f32_32x32x16_bf16 v[16:31], v[120:123], v[168:171], v[16:31]
    ds_read_b64_tr_b16 v[112:113], v74 offset:16384
    ds_read_b64_tr_b16 v[114:115], v74 offset:17408
    buffer_load_dwordx4 v[152:155], v12, s[40:43], s76 offen offset:2048 sc1
    v_mfma_f32_32x32x16_bf16 v[32:47], v[124:127], v[168:171], v[32:47]
    ds_read_b64_tr_b16 v[116:117], v75 offset:16384
    ds_read_b64_tr_b16 v[118:119], v75 offset:17408
    v_max_u32 v77, v77, v168
    s_waitcnt vmcnt(11) lgkmcnt(4)
    v_mfma_f32_32x32x16_bf16 v[16:31], v[104:107], v[172:175], v[16:31]
    ds_read_b64_tr_b16 v[120:121], v74 offset:18432
    ds_read_b64_tr_b16 v[122:123], v74 offset:19456
    buffer_load_dwordx4 v[156:159], v12, s[40:43], s76 offen offset:3072 sc1
    v_mfma_f32_32x32x16_bf16 v[32:47], v[108:111], v[172:175], v[32:47]
    ds_read_b64_tr_b16 v[124:125], v75 offset:18432
    ds_read_b64_tr_b16 v[126:127], v75 offset:19456
    v_max_u32 v77, v77, v172
    s_waitcnt vmcnt(11) lgkmcnt(4)
    v_mfma_f32_32x32x16_bf16 v[16:31], v[112:115], v[176:179], v[16:31]
    ds_read_b64_tr_b16 v[104:105], v74 offset:20480
    ds_read_b64_tr_b16 v[106:107], v74 offset:21504
    s_add_u32 s76, s65, 10
    s_and_b32 s76, s76, 15
    s_mul_i32 s76, s76, 28800
    s_add_u32 s76, s76, s80
    buffer_load_dwordx4 v[160:163], v12, s[40:43], s76 offen offset:0 sc1
    v_mfma_f32_32x32x16_bf16 v[32:47], v[116:119], v[176:179], v[32:47]
    ds_read_b64_tr_b16 v[108:109], v75 offset:20480
    ds_read_b64_tr_b16 v[110:111], v75 offset:21504
    v_max_u32_e64 v77, v77, v176
    s_waitcnt vmcnt(11) lgkmcnt(4)
    v_mfma_f32_32x32x16_bf16 v[16:31], v[120:123], v[180:183], v[16:31]
    ds_read_b64_tr_b16 v[112:113], v74 offset:22528
    ds_read_b64_tr_b16 v[114:115], v74 offset:23552
    buffer_load_dwordx4 v[164:167], v12, s[40:43], s76 offen offset:1024 sc1
    v_mfma_f32_32x32x16_bf16 v[32:47], v[124:127], v[180:183], v[32:47]
    ds_read_b64_tr_b16 v[116:117], v75 offset:22528
    ds_read_b64_tr_b16 v[118:119], v75 offset:23552
    v_max_u32 v77, v77, v180
    s_waitcnt vmcnt(11) lgkmcnt(4)
    v_mfma_f32_32x32x16_bf16 v[16:31], v[104:107], v[184:187], v[16:31]
    ds_read_b64_tr_b16 v[120:121], v74 offset:24576
    ds_read_b64_tr_b16 v[122:123], v74 offset:25600
    buffer_load_dwordx4 v[168:171], v12, s[40:43], s76 offen offset:2048 sc1
    v_mfma_f32_32x32x16_bf16 v[32:47], v[108:111], v[184:187], v[32:47]
    ds_read_b64_tr_b16 v[124:125], v75 offset:24576
    ds_read_b64_tr_b16 v[126:127], v75 offset:25600
    v_max_u32 v77, v77, v184
    s_waitcnt vmcnt(11) lgkmcnt(4)
    v_mfma_f32_32x32x16_bf16 v[16:31], v[112:115], v[188:191], v[16:31]
    ds_read_b64_tr_b16 v[104:105], v74 offset:26624
    ds_read_b64_tr_b16 v[106:107], v74 offset:27648
    buffer_load_dwordx4 v[172:175], v12, s[40:43], s76 offen offset:3072 sc1
    v_mfma_f32_32x32x16_bf16 v[32:47], v[116:119], v[188:191], v[32:47]
    ds_read_b64_tr_b16 v[108:109], v75 offset:26624
    ds_read_b64_tr_b16 v[110:111], v75 offset:27648
    v_max_u32 v77, v77, v188
    s_waitcnt vmcnt(11) lgkmcnt(4)
    v_mfma_f32_32x32x16_bf16 v[16:31], v[120:123], v[128:131], v[16:31]
    ds_read_b64_tr_b16 v[112:113], v74 offset:28672
    ds_read_b64_tr_b16 v[114:115], v74 offset:29696
    s_add_u32 s76, s65, 11
    s_and_b32 s76, s76, 15
    s_mul_i32 s76, s76, 28800
    s_add_u32 s76, s76, s80
    buffer_load_dwordx4 v[176:179], v12, s[40:43], s76 offen offset:0 sc1
    v_mfma_f32_32x32x16_bf16 v[32:47], v[124:127], v[128:131], v[32:47]
    ds_read_b64_tr_b16 v[116:117], v75 offset:28672
    ds_read_b64_tr_b16 v[118:119], v75 offset:29696
    v_max_u32_e64 v77, v77, v128
    s_waitcnt vmcnt(11) lgkmcnt(4)
    v_mfma_f32_32x32x16_bf16 v[16:31], v[104:107], v[132:135], v[16:31]
    ds_read_b64_tr_b16 v[120:121], v74 offset:30720
    ds_read_b64_tr_b16 v[122:123], v74 offset:31744
    buffer_load_dwordx4 v[180:183], v12, s[40:43], s76 offen offset:1024 sc1
    v_mfma_f32_32x32x16_bf16 v[32:47], v[108:111], v[132:135], v[32:47]
    ds_read_b64_tr_b16 v[124:125], v75 offset:30720
    ds_read_b64_tr_b16 v[126:127], v75 offset:31744
    v_max_u32 v77, v77, v132
    s_waitcnt vmcnt(11) lgkmcnt(4)
    v_mfma_f32_32x32x16_bf16 v[16:31], v[112:115], v[136:139], v[16:31]
    ds_read_b64_tr_b16 v[104:105], v74 offset:32768
    ds_read_b64_tr_b16 v[106:107], v74 offset:33792
    buffer_load_dwordx4 v[184:187], v12, s[40:43], s76 offen offset:2048 sc1
    v_mfma_f32_32x32x16_bf16 v[32:47], v[116:119], v[136:139], v[32:47]
    ds_read_b64_tr_b16 v[108:109], v75 offset:32768
    ds_read_b64_tr_b16 v[110:111], v75 offset:33792
    v_max_u32 v77, v77, v136
    s_waitcnt vmcnt(11) lgkmcnt(4)
    v_mfma_f32_32x32x16_bf16 v[16:31], v[120:123], v[140:143], v[16:31]
    ds_read_b64_tr_b16 v[112:113], v74 offset:34816
    ds_read_b64_tr_b16 v[114:115], v74 offset:35840
    buffer_load_dwordx4 v[188:191], v12, s[40:43], s76 offen offset:3072 sc1
    v_mfma_f32_32x32x16_bf16 v[32:47], v[124:127], v[140:143], v[32:47]
    ds_read_b64_tr_b16 v[116:117], v75 offset:34816
    ds_read_b64_tr_b16 v[118:119], v75 offset:35840
    v_max_u32 v77, v77, v140
    s_waitcnt vmcnt(11) lgkmcnt(4)
    v_mfma_f32_32x32x16_bf16 v[16:31], v[104:107], v[144:147], v[16:31]
    ds_read_b64_tr_b16 v[120:121], v74 offset:36864
    ds_read_b64_tr_b16 v[122:123], v74 offset:37888
    s_add_u32 s76, s65, 12
    s_and_b32 s76, s76, 15
    s_mul_i32 s76, s76, 28800
    s_add_u32 s76, s76, s80
    buffer_load_dwordx4 v[128:131], v12, s[40:43], s76 offen offset:0 sc1
    v_mfma_f32_32x32x16_bf16 v[32:47], v[108:111], v[144:147], v[32:47]
    ds_read_b64_tr_b16 v[124:125], v75 offset:36864
    ds_read_b64_tr_b16 v[126:127], v75 offset:37888
    v_max_u32_e64 v77, v77, v144
    s_waitcnt vmcnt(11) lgkmcnt(4)
    v_mfma_f32_32x32x16_bf16 v[16:31], v[112:115], v[148:151], v[16:31]
    ds_read_b64_tr_b16 v[104:105], v74 offset:38912
    ds_read_b64_tr_b16 v[106:107], v74 offset:39936
    buffer_load_dwordx4 v[132:135], v12, s[40:43], s76 offen offset:1024 sc1
    v_mfma_f32_32x32x16_bf16 v[32:47], v[116:119], v[148:151], v[32:47]
    ds_read_b64_tr_b16 v[108:109], v75 offset:38912
    ds_read_b64_tr_b16 v[110:111], v75 offset:39936
    v_max_u32 v77, v77, v148
    s_waitcnt vmcnt(11) lgkmcnt(4)
    v_mfma_f32_32x32x16_bf16 v[16:31], v[120:123], v[152:155], v[16:31]
    ds_read_b64_tr_b16 v[112:113], v74 offset:40960
    ds_read_b64_tr_b16 v[114:115], v74 offset:41984
    buffer_load_dwordx4 v[136:139], v12, s[40:43], s76 offen offset:2048 sc1
    v_mfma_f32_32x32x16_bf16 v[32:47], v[124:127], v[152:155], v[32:47]
    ds_read_b64_tr_b16 v[116:117], v75 offset:40960
    ds_read_b64_tr_b16 v[118:119], v75 offset:41984
    v_max_u32 v77, v77, v152
    s_waitcnt vmcnt(11) lgkmcnt(4)
    v_mfma_f32_32x32x16_bf16 v[16:31], v[104:107], v[156:159], v[16:31]
    ds_read_b64_tr_b16 v[120:121], v74 offset:43008
    ds_read_b64_tr_b16 v[122:123], v74 offset:44032
    buffer_load_dwordx4 v[140:143], v12, s[40:43], s76 offen offset:3072 sc1
    v_mfma_f32_32x32x16_bf16 v[32:47], v[108:111], v[156:159], v[32:47]
    ds_read_b64_tr_b16 v[124:125], v75 offset:43008
    ds_read_b64_tr_b16 v[126:127], v75 offset:44032
    v_max_u32 v77, v77, v156
    s_waitcnt vmcnt(11) lgkmcnt(4)
    v_mfma_f32_32x32x16_bf16 v[16:31], v[112:115], v[160:163], v[16:31]
    ds_read_b64_tr_b16 v[104:105], v74 offset:45056
    ds_read_b64_tr_b16 v[106:107], v74 offset:46080
    s_add_u32 s76, s65, 13
    s_and_b32 s76, s76, 15
    s_mul_i32 s76, s76, 28800
    s_add_u32 s76, s76, s80
    buffer_load_dwordx4 v[144:147], v12, s[40:43], s76 offen offset:0 sc1
    v_mfma_f32_32x32x16_bf16 v[32:47], v[116:119], v[160:163], v[32:47]
    ds_read_b64_tr_b16 v[108:109], v75 offset:45056
    ds_read_b64_tr_b16 v[110:111], v75 offset:46080
    v_max_u32_e64 v77, v77, v160
    s_waitcnt vmcnt(11) lgkmcnt(4)
    v_mfma_f32_32x32x16_bf16 v[16:31], v[120:123], v[164:167], v[16:31]
    ds_read_b64_tr_b16 v[112:113], v74 offset:47104
    ds_read_b64_tr_b16 v[114:115], v74 offset:48128
    buffer_load_dwordx4 v[148:151], v12, s[40:43], s76 offen offset:1024 sc1
    v_mfma_f32_32x32x16_bf16 v[32:47], v[124:127], v[164:167], v[32:47]
    ds_read_b64_tr_b16 v[116:117], v75 offset:47104
    ds_read_b64_tr_b16 v[118:119], v75 offset:48128
    v_max_u32 v77, v77, v164
    s_waitcnt vmcnt(11) lgkmcnt(4)
    v_mfma_f32_32x32x16_bf16 v[16:31], v[104:107], v[168:171], v[16:31]
    ds_read_b64_tr_b16 v[120:121], v74 offset:49152
    ds_read_b64_tr_b16 v[122:123], v74 offset:50176
    buffer_load_dwordx4 v[152:155], v12, s[40:43], s76 offen offset:2048 sc1
    v_mfma_f32_32x32x16_bf16 v[32:47], v[108:111], v[168:171], v[32:47]
    ds_read_b64_tr_b16 v[124:125], v75 offset:49152
    ds_read_b64_tr_b16 v[126:127], v75 offset:50176
    v_max_u32 v77, v77, v168
    s_waitcnt vmcnt(11) lgkmcnt(4)
    v_mfma_f32_32x32x16_bf16 v[16:31], v[112:115], v[172:175], v[16:31]
    ds_read_b64_tr_b16 v[104:105], v74 offset:51200
    ds_read_b64_tr_b16 v[106:107], v74 offset:52224
    buffer_load_dwordx4 v[156:159], v12, s[40:43], s76 offen offset:3072 sc1
    v_mfma_f32_32x32x16_bf16 v[32:47], v[116:119], v[172:175], v[32:47]
    ds_read_b64_tr_b16 v[108:109], v75 offset:51200
    ds_read_b64_tr_b16 v[110:111], v75 offset:52224
    v_max_u32 v77, v77, v172
    s_waitcnt vmcnt(11) lgkmcnt(4)
    v_mfma_f32_32x32x16_bf16 v[16:31], v[120:123], v[176:179], v[16:31]
    ds_read_b64_tr_b16 v[112:113], v74 offset:53248
    ds_read_b64_tr_b16 v[114:115], v74 offset:54272
    s_add_u32 s76, s65, 14
    s_and_b32 s76, s76, 15
    s_mul_i32 s76, s76, 28800
    s_add_u32 s76, s76, s80
    buffer_load_dwordx4 v[160:163], v12, s[40:43], s76 offen offset:0 sc1
    v_mfma_f32_32x32x16_bf16 v[32:47], v[124:127], v[176:179], v[32:47]
    ds_read_b64_tr_b16 v[116:117], v75 offset:53248
    ds_read_b64_tr_b16 v[118:119], v75 offset:54272
    v_max_u32_e64 v77, v77, v176
    s_waitcnt vmcnt(11) lgkmcnt(4)
    v_mfma_f32_32x32x16_bf16 v[16:31], v[104:107], v[180:183], v[16:31]
    ds_read_b64_tr_b16 v[120:121], v74 offset:55296
    ds_read_b64_tr_b16 v[122:123], v74 offset:56320
    buffer_load_dwordx4 v[164:167], v12, s[40:43], s76 offen offset:1024 sc1
    v_mfma_f32_32x32x16_bf16 v[32:47], v[108:111], v[180:183], v[32:47]
    ds_read_b64_tr_b16 v[124:125], v75 offset:55296
    ds_read_b64_tr_b16 v[126:127], v75 offset:56320
    v_max_u32 v77, v77, v180
    s_waitcnt vmcnt(11) lgkmcnt(4)
    v_mfma_f32_32x32x16_bf16 v[16:31], v[112:115], v[184:187], v[16:31]
    ds_read_b64_tr_b16 v[104:105], v74 offset:57344
    ds_read_b64_tr_b16 v[106:107], v74 offset:58368
    buffer_load_dwordx4 v[168:171], v12, s[40:43], s76 offen offset:2048 sc1
    v_mfma_f32_32x32x16_bf16 v[32:47], v[116:119], v[184:187], v[32:47]
    ds_read_b64_tr_b16 v[108:109], v75 offset:57344
    ds_read_b64_tr_b16 v[110:111], v75 offset:58368
    v_max_u32 v77, v77, v184
    s_waitcnt vmcnt(11) lgkmcnt(4)
    v_mfma_f32_32x32x16_bf16 v[16:31], v[120:123], v[188:191], v[16:31]
    ds_read_b64_tr_b16 v[112:113], v74 offset:59392
    ds_read_b64_tr_b16 v[114:115], v74 offset:60416
    buffer_load_dwordx4 v[172:175], v12, s[40:43], s76 offen offset:3072 sc1
    v_mfma_f32_32x32x16_bf16 v[32:47], v[124:127], v[188:191], v[32:47]
    ds_read_b64_tr_b16 v[116:117], v75 offset:59392
    ds_read_b64_tr_b16 v[118:119], v75 offset:60416
    v_max_u32 v77, v77, v188
    s_waitcnt vmcnt(11) lgkmcnt(4)
    v_mfma_f32_32x32x16_bf16 v[16:31], v[104:107], v[128:131], v[16:31]
    ds_read_b64_tr_b16 v[120:121], v74 offset:61440
    ds_read_b64_tr_b16 v[122:123], v74 offset:62464
    s_add_u32 s76, s65, 15
    s_and_b32 s76, s76, 15
    s_mul_i32 s76, s76, 28800
    s_add_u32 s76, s76, s80
    buffer_load_dwordx4 v[176:179], v12, s[40:43], s76 offen offset:0 sc1
    v_mfma_f32_32x32x16_bf16 v[32:47], v[108:111], v[128:131], v[32:47]
    ds_read_b64_tr_b16 v[124:125], v75 offset:61440
    ds_read_b64_tr_b16 v[126:127], v75 offset:62464
    v_max_u32_e64 v77, v77, v128
    s_waitcnt vmcnt(11) lgkmcnt(4)
    v_mfma_f32_32x32x16_bf16 v[16:31], v[112:115], v[132:135], v[16:31]
    ds_read_b64_tr_b16 v[104:105], v74 offset:63488
    ds_read_b64_tr_b16 v[106:107], v74 offset:64512
    buffer_load_dwordx4 v[180:183], v12, s[40:43], s76 offen offset:1024 sc1
    v_mfma_f32_32x32x16_bf16 v[32:47], v[116:119], v[132:135], v[32:47]
    ds_read_b64_tr_b16 v[108:109], v75 offset:63488
    ds_read_b64_tr_b16 v[110:111], v75 offset:64512
    v_max_u32 v77, v77, v132
    s_waitcnt vmcnt(11) lgkmcnt(4)
    v_mfma_f32_32x32x16_bf16 v[16:31], v[120:123], v[136:139], v[16:31]
    ds_read_b64_tr_b16 v[112:113], v72 offset:0
    ds_read_b64_tr_b16 v[114:115], v72 offset:1024
    buffer_load_dwordx4 v[184:187], v12, s[40:43], s76 offen offset:2048 sc1
    v_mfma_f32_32x32x16_bf16 v[32:47], v[124:127], v[136:139], v[32:47]
    ds_read_b64_tr_b16 v[116:117], v73 offset:0
    ds_read_b64_tr_b16 v[118:119], v73 offset:1024
    v_max_u32 v77, v77, v136
    s_waitcnt vmcnt(11) lgkmcnt(4)
    v_mfma_f32_32x32x16_bf16 v[16:31], v[104:107], v[140:143], v[16:31]
    ds_read_b64_tr_b16 v[120:121], v72 offset:2048
    ds_read_b64_tr_b16 v[122:123], v72 offset:3072
    buffer_load_dwordx4 v[188:191], v12, s[40:43], s76 offen offset:3072 sc1
    v_mfma_f32_32x32x16_bf16 v[32:47], v[108:111], v[140:143], v[32:47]
    ds_read_b64_tr_b16 v[124:125], v73 offset:2048
    ds_read_b64_tr_b16 v[126:127], v73 offset:3072
    v_max_u32_e64 v77, v77, v140
    s_cmp_eq_u32 s88, 0
    s_cbranch_scc0 L_nobg_49
    s_barrier
L_nobg_49:
    s_waitcnt vmcnt(11) lgkmcnt(4)
    v_mfma_f32_32x32x16_bf16 v[16:31], v[112:115], v[144:147], v[16:31]
    ds_read_b64_tr_b16 v[104:105], v72 offset:4096
    ds_read_b64_tr_b16 v[106:107], v72 offset:5120
    v_mfma_f32_32x32x16_bf16 v[32:47], v[116:119], v[144:147], v[32:47]
    ds_read_b64_tr_b16 v[108:109], v73 offset:4096
    ds_read_b64_tr_b16 v[110:111], v73 offset:5120
    v_max_u32 v77, v77, v144
    s_waitcnt vmcnt(10) lgkmcnt(4)
    v_mfma_f32_32x32x16_bf16 v[16:31], v[120:123], v[148:151], v[16:31]
    ds_read_b64_tr_b16 v[112:113], v72 offset:6144
    ds_read_b64_tr_b16 v[114:115], v72 offset:7168
    v_mfma_f32_32x32x16_bf16 v[32:47], v[124:127], v[148:151], v[32:47]
    ds_read_b64_tr_b16 v[116:117], v73 offset:6144
    ds_read_b64_tr_b16 v[118:119], v73 offset:7168
    v_max_u32 v77, v77, v148
    s_waitcnt vmcnt(9) lgkmcnt(4)
    v_mfma_f32_32x32x16_bf16 v[16:31], v[104:107], v[152:155], v[16:31]
    ds_read_b64_tr_b16 v[120:121], v72 offset:8192
    ds_read_b64_tr_b16 v[122:123], v72 offset:9216
    v_mfma_f32_32x32x16_bf16 v[32:47], v[108:111], v[152:155], v[32:47]
    ds_read_b64_tr_b16 v[124:125], v73 offset:8192
    ds_read_b64_tr_b16 v[126:127], v73 offset:9216
    v_max_u32 v77, v77, v152
    s_waitcnt vmcnt(8) lgkmcnt(4)
    v_mfma_f32_32x32x16_bf16 v[16:31], v[112:115], v[156:159], v[16:31]
    ds_read_b64_tr_b16 v[104:105], v72 offset:10240
    ds_read_b64_tr_b16 v[106:107], v72 offset:11264
    v_mfma_f32_32x32x16_bf16 v[32:47], v[116:119], v[156:159], v[32:47]
    ds_read_b64_tr_b16 v[108:109], v73 offset:10240
    ds_read_b64_tr_b16 v[110:111], v73 offset:11264
    v_max_u32 v77, v77, v156
    s_waitcnt vmcnt(7) lgkmcnt(4)
    v_mfma_f32_32x32x16_bf16 v[16:31], v[120:123], v[160:163], v[16:31]
    ds_read_b64_tr_b16 v[112:113], v72 offset:12288
    ds_read_b64_tr_b16 v[114:115], v72 offset:13312
    v_mfma_f32_32x32x16_bf16 v[32:47], v[124:127], v[160:163], v[32:47]
    ds_read_b64_tr_b16 v[116:117], v73 offset:12288
    ds_read_b64_tr_b16 v[118:119], v73 offset:13312
    v_max_u32 v77, v77, v160
    s_waitcnt vmcnt(6) lgkmcnt(4)
    v_mfma_f32_32x32x16_bf16 v[16:31], v[104:107], v[164:167], v[16:31]
    ds_read_b64_tr_b16 v[120:121], v72 offset:14336
    ds_read_b64_tr_b16 v[122:123], v72 offset:15360
    v_mfma_f32_32x32x16_bf16 v[32:47], v[108:111], v[164:167], v[32:47]
    ds_read_b64_tr_b16 v[124:125], v73 offset:14336
    ds_read_b64_tr_b16 v[126:127], v73 offset:15360
    v_max_u32 v77, v77, v164
    s_waitcnt vmcnt(5) lgkmcnt(4)
    v_mfma_f32_32x32x16_bf16 v[16:31], v[112:115], v[168:171], v[16:31]
    ds_read_b64_tr_b16 v[104:105], v72 offset:16384
    ds_read_b64_tr_b16 v[106:107], v72 offset:17408
    v_mfma_f32_32x32x16_bf16 v[32:47], v[116:119], v[168:171], v[32:47]
    ds_read_b64_tr_b16 v[108:109], v73 offset:16384
    ds_read_b64_tr_b16 v[110:111], v73 offset:17408
    v_max_u32 v77, v77, v168
    s_waitcnt vmcnt(4) lgkmcnt(4)
    v_mfma_f32_32x32x16_bf16 v[16:31], v[120:123], v[172:175], v[16:31]
    ds_read_b64_tr_b16 v[112:113], v72 offset:18432
    ds_read_b64_tr_b16 v[114:115], v72 offset:19456
    v_mfma_f32_32x32x16_bf16 v[32:47], v[124:127], v[172:175], v[32:47]
    ds_read_b64_tr_b16 v[116:117], v73 offset:18432
    ds_read_b64_tr_b16 v[118:119], v73 offset:19456
    v_max_u32 v77, v77, v172
    s_waitcnt vmcnt(3) lgkmcnt(4)
    v_mfma_f32_32x32x16_bf16 v[16:31], v[104:107], v[176:179], v[16:31]
    ds_read_b64_tr_b16 v[120:121], v72 offset:20480
    ds_read_b64_tr_b16 v[122:123], v72 offset:21504
    v_mfma_f32_32x32x16_bf16 v[32:47], v[108:111], v[176:179], v[32:47]
    ds_read_b64_tr_b16 v[124:125], v73 offset:20480
    ds_read_b64_tr_b16 v[126:127], v73 offset:21504
    v_max_u32 v77, v77, v176
    s_waitcnt vmcnt(2) lgkmcnt(4)
    v_mfma_f32_32x32x16_bf16 v[16:31], v[112:115], v[180:183], v[16:31]
    ds_read_b64_tr_b16 v[104:105], v72 offset:22528
    ds_read_b64_tr_b16 v[106:107], v72 offset:23552
    v_mfma_f32_32x32x16_bf16 v[32:47], v[116:119], v[180:183], v[32:47]
    ds_read_b64_tr_b16 v[108:109], v73 offset:22528
    ds_read_b64_tr_b16 v[110:111], v73 offset:23552
    v_max_u32 v77, v77, v180
    s_waitcnt vmcnt(1) lgkmcnt(4)
    v_mfma_f32_32x32x16_bf16 v[16:31], v[120:123], v[184:187], v[16:31]
    v_mfma_f32_32x32x16_bf16 v[32:47], v[124:127], v[184:187], v[32:47]
    v_max_u32 v77, v77, v184
    s_waitcnt vmcnt(0) lgkmcnt(0)
    v_mfma_f32_32x32x16_bf16 v[16:31], v[104:107], v[188:191], v[16:31]
    v_mfma_f32_32x32x16_bf16 v[32:47], v[108:111], v[188:191], v[32:47]
    v_max_u32 v77, v77, v188
    v_cmp_eq_u32_e64 vcc, -1, v77
    s_nop 0
    s_cbranch_vccz L_ok_50
    s_add_u32 s88, s88, 1
    s_cmp_lt_u32 s88, 65536
    s_cbranch_scc1 L_g2
L_ok_50:
    s_nop 6
    v_cvt_pk_bf16_f32 v88, v16, v17
    v_cvt_pk_bf16_f32 v89, v18, v19
    v_cvt_pk_bf16_f32 v90, v20, v21
    v_cvt_pk_bf16_f32 v91, v22, v23
    v_cvt_pk_bf16_f32 v92, v24, v25
    v_cvt_pk_bf16_f32 v93, v26, v27
    v_cvt_pk_bf16_f32 v94, v28, v29
    v_cvt_pk_bf16_f32 v95, v30, v31
    v_cvt_pk_bf16_f32 v96, v32, v33
    v_cvt_pk_bf16_f32 v97, v34, v35
    v_cvt_pk_bf16_f32 v98, v36, v37
    v_cvt_pk_bf16_f32 v99, v38, v39
    v_cvt_pk_bf16_f32 v100, v40, v41
    v_cvt_pk_bf16_f32 v101, v42, v43
    v_cvt_pk_bf16_f32 v102, v44, v45
    v_cvt_pk_bf16_f32 v103, v46, v47
    v_dot2_f32_bf16 v104, v88, s89, 0
    v_dot2_f32_bf16 v105, v88, v88, 0
    v_dot2_f32_bf16 v106, v88, v192, 0
    v_dot2_f32_bf16 v104, v89, s89, v104
    v_dot2_f32_bf16 v105, v89, v89, v105
    v_dot2_f32_bf16 v106, v89, v193, v106
    v_dot2_f32_bf16 v104, v90, s89, v104
    v_dot2_f32_bf16 v105, v90, v90, v105
    v_dot2_f32_bf16 v106, v90, v194, v106
    v_dot2_f32_bf16 v104, v91, s89, v104
    v_dot2_f32_bf16 v105, v91, v91, v105
    v_dot2_f32_bf16 v106, v91, v195, v106
    v_dot2_f32_bf16 v104, v92, s89, v104
    v_dot2_f32_bf16 v105, v92, v92, v105
    v_dot2_f32_bf16 v106, v92, v196, v106
    v_dot2_f32_bf16 v104, v93, s89, v104
    v_dot2_f32_bf16 v105, v93, v93, v105
    v_dot2_f32_bf16 v106, v93, v197, v106
    v_dot2_f32_bf16 v104, v94, s89, v104
    v_dot2_f32_bf16 v105, v94, v94, v105
    v_dot2_f32_bf16 v106, v94, v198, v106
    v_dot2_f32_bf16 v104, v95, s89, v104
    v_dot2_f32_bf16 v105, v95, v95, v105
    v_dot2_f32_bf16 v106, v95, v199, v106
    v_dot2_f32_bf16 v104, v96, s89, v104
    v_dot2_f32_bf16 v105, v96, v96, v105
    v_dot2_f32_bf16 v106, v96, v200, v106
    v_dot2_f32_bf16 v104, v97, s89, v104
    v_dot2_f32_bf16 v105, v97, v97, v105
    v_dot2_f32_bf16 v106, v97, v201, v106
    v_dot2_f32_bf16 v104, v98, s89, v104
    v_dot2_f32_bf16 v105, v98, v98, v105
    v_dot2_f32_bf16 v106, v98, v202, v106
    v_dot2_f32_bf16 v104, v99, s89, v104
    v_dot2_f32_bf16 v105, v99, v99, v105
    v_dot2_f32_bf16 v106, v99, v203, v106
    v_dot2_f32_bf16 v104, v100, s89, v104
    v_dot2_f32_bf16 v105, v100, v100, v105
    v_dot2_f32_bf16 v106, v100, v204, v106
    v_dot2_f32_bf16 v104, v101, s89, v104
    v_dot2_f32_bf16 v105, v101, v101, v105
    v_dot2_f32_bf16 v106, v101, v205, v106
    v_dot2_f32_bf16 v104, v102, s89, v104
    v_dot2_f32_bf16 v105, v102, v102, v105
    v_dot2_f32_bf16 v106, v102, v206, v106
    v_dot2_f32_bf16 v104, v103, s89, v104
    v_dot2_f32_bf16 v105, v103, v103, v105
    v_dot2_f32_bf16 v106, v103, v207, v106
    s_lshl_b32 s76, s62, 9
    s_add_u32 s77, s76, s99
    v_mov_b32 v107, 0
    v_mov_b32 v4, v104
    v_mov_b32 v5, v105
    v_mov_b32 v6, v106
    v_permlane32_swap_b32 v104, v4
    v_permlane32_swap_b32 v105, v5
    v_permlane32_swap_b32 v106, v6
    v_add_f32 v104, v104, v4
    v_add_f32 v105, v105, v5
    v_add_f32_e64 v106, v106, v6
    s_mov_b32 exec_hi, 0
    s_bitcmp1_b32 s100, 1
    s_cbranch_scc1 L_loc_51
    buffer_store_dwordx4 v[104:107], v12, s[40:43], s77 offen offset:1024 sc1
    s_branch L_pubd_52
L_loc_51:
    buffer_store_dwordx4 v[104:107], v12, s[40:43], s77 offen offset:1024
L_pubd_52:
    s_mov_b64 exec, -1
    v_lshlrev_b32 v16, 16, v88
    v_and_b32 v17, s90, v88
    v_lshlrev_b32 v18, 16, v89
    v_and_b32 v19, s90, v89
    v_lshlrev_b32 v20, 16, v90
    v_and_b32 v21, s90, v90
    v_lshlrev_b32 v22, 16, v91
    v_and_b32 v23, s90, v91
    v_lshlrev_b32 v24, 16, v92
    v_and_b32 v25, s90, v92
    v_lshlrev_b32 v26, 16, v93
    v_and_b32 v27, s90, v93
    v_lshlrev_b32 v28, 16, v94
    v_and_b32 v29, s90, v94
    v_lshlrev_b32 v30, 16, v95
    v_and_b32 v31, s90, v95
    v_lshlrev_b32 v32, 16, v96
    v_and_b32 v33, s90, v96
    v_lshlrev_b32 v34, 16, v97
    v_and_b32 v35, s90, v97
    v_lshlrev_b32 v36, 16, v98
    v_and_b32 v37, s90, v98
    v_lshlrev_b32 v38, 16, v99
    v_and_b32 v39, s90, v99
    v_lshlrev_b32 v40, 16, v100
    v_and_b32 v41, s90, v100
    v_lshlrev_b32 v42, 16, v101
    v_and_b32 v43, s90, v101
    v_lshlrev_b32 v44, 16, v102
    v_and_b32 v45, s90, v102
    v_lshlrev_b32 v46, 16, v103
    v_and_b32 v47, s90, v103
    v_lshl_add_u32 v176, v3, 6, s76
    v_and_b32 v4, 15, v1
    v_lshlrev_b32 v178, 4, v4
    v_cmp_gt_u32_e64 vcc, 8, v4
    v_mov_b32 v5, 256
    s_nop 0
    v_cndmask_b32 v178, v5, v178, vcc
    v_lshrrev_b32_e64 v5, 4, v1
    v_lshl_add_u32 v177, v5, 9, v178
    v_mul_u32_u24 v179, 149504, v4
    v_lshl_add_u32 v180, v5, 4, v179
    v_mul_u32_u24 v6, 9344, v3
    v_lshl_add_u32 v6, v2, 4, v6
    s_mul_i32 s78, s97, 149504
    s_add_u32 s78, s78, s76
    s_add_u32 s78, s78, 8388608
    s_mov_b32 s88, 0
L_spin_53:
    s_mov_b32 s77, s78
    buffer_load_dwordx4 v[112:115], v6, s[40:43], s77 offen offset:1024 sc1
    s_add_u32 s77, s77, 18688
    buffer_load_dwordx4 v[116:119], v6, s[40:43], s77 offen offset:1024 sc1
    s_add_u32 s77, s77, 18688
    buffer_load_dwordx4 v[120:123], v6, s[40:43], s77 offen offset:1024 sc1
    s_add_u32 s77, s77, 18688
    buffer_load_dwordx4 v[124:127], v6, s[40:43], s77 offen offset:1024 sc1
    s_add_u32 s77, s77, 18688
    buffer_load_dwordx4 v[128:131], v6, s[40:43], s77 offen offset:1024 sc1
    s_add_u32 s77, s77, 18688
    buffer_load_dwordx4 v[132:135], v6, s[40:43], s77 offen offset:1024 sc1
    s_add_u32 s77, s77, 18688
    buffer_load_dwordx4 v[136:139], v6, s[40:43], s77 offen offset:1024 sc1
    s_add_u32 s77, s77, 18688
    buffer_load_dwordx4 v[140:143], v6, s[40:43], s77 offen offset:1024 sc1
    s_waitcnt vmcnt(0)
    v_max3_u32 v4, v112, v116, v120
    v_max3_u32 v4, v4, v124, v128
    v_max3_u32 v4, v4, v132, v136
    v_max_u32 v4, v4, v140
    v_cmp_eq_u32_e64 vcc, -1, v4
    s_nop 0
    s_cbranch_vccz L_ok_54
    s_add_u32 s88, s88, 1
    s_cmp_lt_u32 s88, 65536
    s_cbranch_scc1 L_spin_53
L_ok_54:
    v_pk_add_f32 v[112:113], v[112:113], v[128:129]
    v_pk_add_f32 v[114:115], v[114:115], v[130:131]
    v_pk_add_f32 v[116:117], v[116:117], v[132:133]
    v_pk_add_f32 v[118:119], v[118:119], v[134:135]
    v_pk_add_f32 v[120:121], v[120:121], v[136:137]
    v_pk_add_f32 v[122:123], v[122:123], v[138:139]
    v_pk_add_f32 v[124:125], v[124:125], v[140:141]
    v_pk_add_f32 v[126:127], v[126:127], v[142:143]
    v_pk_add_f32 v[112:113], v[112:113], v[120:121]
    v_pk_add_f32 v[114:115], v[114:115], v[122:123]
    v_pk_add_f32 v[116:117], v[116:117], v[124:125]
    v_pk_add_f32 v[118:119], v[118:119], v[126:127]
    v_pk_add_f32 v[112:113], v[112:113], v[116:117]
    v_pk_add_f32 v[114:115], v[114:115], v[118:119]
    v_mov_b32 v4, v112
    v_mov_b32 v5, v113
    v_mov_b32 v6, v114
    v_permlane32_swap_b32 v112, v4
    v_permlane32_swap_b32 v113, v5
    v_permlane32_swap_b32 v114, v6
    v_add_f32 v112, v112, v4
    v_add_f32 v113, v113, v5
    v_add_f32 v114, v114, v6
    v_mul_f32 v112, 0x3a800000, v112
    v_mul_f32 v113, 0x3a800000, v113
    v_fma_f32 v4, -v112, v112, v113
    v_max_f32_e64 v4, 0, v4
    v_cvt_pk_bf16_f32 v116, v112, v112
    v_and_b32_e64 v116, s90, v116
    v_cvt_pk_bf16_f32 v4, v4, v4
    v_and_b32_e64 v4, s90, v4
    v_add_f32 v4, 0x3727c5ac, v4
    v_cvt_pk_bf16_f32 v4, v4, v4
    v_and_b32 v4, s90, v4
    v_sqrt_f32_e64 v4, v4
    s_nop 0
    v_cvt_pk_bf16_f32 v4, v4, v4
    v_and_b32 v4, s90, v4
    v_rcp_f32 v118, v4
    v_fma_f32 v120, -v116, v76, v114
    v_mul_f32 v119, v116, v118
    v_mul_f32 v120, v120, v118
    v_pk_fma_f32 v[144:145], v[16:17], v[118:119], v[118:119] op_sel:[0,0,1] op_sel_hi:[1,0,1] neg_lo:[0,0,1] neg_hi:[0,0,1]
    v_cvt_pk_bf16_f32 v124, v144, v145
    v_max_f32_dpp v4, v120, v120 row_ror:8 row_mask:0xf bank_mask:0xf
    v_pk_fma_f32 v[146:147], v[18:19], v[118:119], v[118:119] op_sel:[0,0,1] op_sel_hi:[1,0,1] neg_lo:[0,0,1] neg_hi:[0,0,1]
    v_cvt_pk_bf16_f32 v125, v146, v147
    v_max_f32_dpp v4, v4, v4 row_ror:4 row_mask:0xf bank_mask:0xf
    v_pk_fma_f32 v[148:149], v[20:21], v[118:119], v[118:119] op_sel:[0,0,1] op_sel_hi:[1,0,1] neg_lo:[0,0,1] neg_hi:[0,0,1]
    v_cvt_pk_bf16_f32 v126, v148, v149
    v_max_f32_dpp v4, v4, v4 row_ror:2 row_mask:0xf bank_mask:0xf
    v_pk_fma_f32 v[150:151], v[22:23], v[118:119], v[118:119] op_sel:[0,0,1] op_sel_hi:[1,0,1] neg_lo:[0,0,1] neg_hi:[0,0,1]
    v_cvt_pk_bf16_f32 v127, v150, v151
    v_max_f32_dpp v4, v4, v4 row_ror:1 row_mask:0xf bank_mask:0xf
    v_mov_b32_e64 v5, v4
    v_pk_fma_f32 v[152:153], v[24:25], v[118:119], v[118:119] op_sel:[0,0,1] op_sel_hi:[1,0,1] neg_lo:[0,0,1] neg_hi:[0,0,1]
    v_cvt_pk_bf16_f32 v128, v152, v153
    v_permlane16_swap_b32 v4, v5
    s_lshl_b32 s78, s62, 2
    v_mov_b32 v6, s78
    v_max_f32 v4, v4, v5
    ds_write_b32 v6, v4 offset:25600
    v_cmp_eq_f32 vcc, v4, v120
    v_mov_b32 v6, 0
    v_pk_fma_f32 v[154:155], v[26:27], v[118:119], v[118:119] op_sel:[0,0,1] op_sel_hi:[1,0,1] neg_lo:[0,0,1] neg_hi:[0,0,1]
    v_cvt_pk_bf16_f32 v129, v154, v155
    s_ff1_i32_b32 s77, vcc_lo
    s_and_b32 s77, s77, 31
    s_lshl_b32 s78, s97, 7
    s_lshl_b32 s79, s62, 5
    s_add_u32 s78, s78, s79
    s_add_u32 s79, s78, s77
    s_mov_b32 s80, 1
    s_mov_b32 s81, 1
    s_lshl_b64 s[80:81], s[80:81], s77
    v_mov_b32 v121, s79
    v_mov_b32_e64 v7, s76
    v_pk_fma_f32 v[156:157], v[28:29], v[118:119], v[118:119] op_sel:[0,0,1] op_sel_hi:[1,0,1] neg_lo:[0,0,1] neg_hi:[0,0,1]
    v_cvt_pk_bf16_f32 v130, v156, v157
    v_pk_fma_f32 v[158:159], v[30:31], v[118:119], v[118:119] op_sel:[0,0,1] op_sel_hi:[1,0,1] neg_lo:[0,0,1] neg_hi:[0,0,1]
    v_cvt_pk_bf16_f32 v131, v158, v159
    v_pk_fma_f32 v[160:161], v[32:33], v[118:119], v[118:119] op_sel:[0,0,1] op_sel_hi:[1,0,1] neg_lo:[0,0,1] neg_hi:[0,0,1]
    v_cvt_pk_bf16_f32 v132, v160, v161
    v_pk_fma_f32 v[162:163], v[34:35], v[118:119], v[118:119] op_sel:[0,0,1] op_sel_hi:[1,0,1] neg_lo:[0,0,1] neg_hi:[0,0,1]
    v_cvt_pk_bf16_f32 v133, v162, v163
    v_pk_fma_f32 v[164:165], v[36:37], v[118:119], v[118:119] op_sel:[0,0,1] op_sel_hi:[1,0,1] neg_lo:[0,0,1] neg_hi:[0,0,1]
    v_cvt_pk_bf16_f32 v134, v164, v165
    v_pk_fma_f32 v[166:167], v[38:39], v[118:119], v[118:119] op_sel:[0,0,1] op_sel_hi:[1,0,1] neg_lo:[0,0,1] neg_hi:[0,0,1]
    v_cvt_pk_bf16_f32 v135, v166, v167
    v_pk_fma_f32 v[168:169], v[40:41], v[118:119], v[118:119] op_sel:[0,0,1] op_sel_hi:[1,0,1] neg_lo:[0,0,1] neg_hi:[0,0,1]
    v_cvt_pk_bf16_f32 v136, v168, v169
    v_pk_fma_f32 v[170:171], v[42:43], v[118:119], v[118:119] op_sel:[0,0,1] op_sel_hi:[1,0,1] neg_lo:[0,0,1] neg_hi:[0,0,1]
    v_cvt_pk_bf16_f32 v137, v170, v171
    v_pk_fma_f32 v[172:173], v[44:45], v[118:119], v[118:119] op_sel:[0,0,1] op_sel_hi:[1,0,1] neg_lo:[0,0,1] neg_hi:[0,0,1]
    v_cvt_pk_bf16_f32 v138, v172, v173
    v_pk_fma_f32 v[174:175], v[46:47], v[118:119], v[118:119] op_sel:[0,0,1] op_sel_hi:[1,0,1] neg_lo:[0,0,1] neg_hi:[0,0,1]
    v_cvt_pk_bf16_f32 v139, v174, v175
    s_mov_b64 exec, s[80:81]
    ds_write_b64 v7, v[120:121] offset:26880
    ds_write_b128 v176, v[124:127] offset:26624
    ds_write_b128 v176, v[128:131] offset:26640
    ds_write_b128 v176, v[132:135] offset:26656
    ds_write_b128 v176, v[136:139] offset:26672
    s_waitcnt lgkmcnt(0)
    s_barrier
    s_cmp_eq_u32 s62, 0
    s_cbranch_scc0 L_nopub_55
    s_mov_b64 exec, -1
    ds_read_b128 v[8:11], v6 offset:25600
    ds_read_b128 v[184:187], v177 offset:26624
    s_mov_b32 s82, 48
    s_mov_b64 s[84:85], 0x1ff
    s_waitcnt lgkmcnt(1)
    v_max3_f32 v5, v8, v9, v10
    v_max_f32 v5, v5, v11
    v_cmp_eq_f32 vcc, v5, v10
    s_nop 0
    s_cmp_lg_u32 vcc_lo, 0
    s_cselect_b32 s82, 32, s82
    v_cmp_eq_f32 vcc, v5, v9
    s_nop 0
    s_cmp_lg_u32 vcc_lo, 0
    s_cselect_b32 s82, 16, s82
    v_cmp_eq_f32_e64 vcc, v5, v8
    s_nop 0
    s_cmp_lg_u32 vcc_lo, 0
    s_cselect_b32 s82, 0, s82
    s_lshl_b64 exec, s[84:85], s82
    s_waitcnt lgkmcnt(0)
    buffer_store_dwordx4 v[184:187], v178, s[40:43], s99 offen offset:0 sc1
    s_mov_b64 exec, s[80:81]
L_nopub_55:
    ds_write_b128 v176, v[88:91] offset:26752
    ds_write_b128 v176, v[92:95] offset:26768
    ds_write_b128 v176, v[96:99] offset:26784
    ds_write_b128 v176, v[100:103] offset:26800
    s_mov_b64 exec, -1
    v_lshlrev_b32 v144, 16, v124
    v_and_b32 v145, s90, v124
    v_pk_add_f32 v[144:145], v[144:145], v[16:17]
    v_cvt_pk_bf16_f32 v16, v144, v145
    v_lshlrev_b32 v144, 16, v125
    v_and_b32 v145, s90, v125
    v_pk_add_f32 v[144:145], v[144:145], v[18:19]
    v_cvt_pk_bf16_f32 v17, v144, v145
    ds_write_b64 v64, v[16:17]
    v_lshlrev_b32 v144, 16, v126
    v_and_b32 v145, s90, v126
    v_pk_add_f32 v[144:145], v[144:145], v[20:21]
    v_cvt_pk_bf16_f32 v18, v144, v145
    v_lshlrev_b32 v144, 16, v127
    v_and_b32 v145, s90, v127
    v_pk_add_f32 v[144:145], v[144:145], v[22:23]
    v_cvt_pk_bf16_f32 v19, v144, v145
    ds_write_b64 v65, v[18:19]
    v_lshlrev_b32 v144, 16, v128
    v_and_b32 v145, s90, v128
    v_pk_add_f32 v[144:145], v[144:145], v[24:25]
    v_cvt_pk_bf16_f32 v20, v144, v145
    v_lshlrev_b32 v144, 16, v129
    v_and_b32 v145, s90, v129
    v_pk_add_f32 v[144:145], v[144:145], v[26:27]
    v_cvt_pk_bf16_f32 v21, v144, v145
    ds_write_b64 v66, v[20:21]
    v_lshlrev_b32 v144, 16, v130
    v_and_b32 v145, s90, v130
    v_pk_add_f32 v[144:145], v[144:145], v[28:29]
    v_cvt_pk_bf16_f32 v22, v144, v145
    v_lshlrev_b32 v144, 16, v131
    v_and_b32 v145, s90, v131
    v_pk_add_f32 v[144:145], v[144:145], v[30:31]
    v_cvt_pk_bf16_f32 v23, v144, v145
    ds_write_b64 v67, v[22:23]
    v_lshlrev_b32 v144, 16, v132
    v_and_b32 v145, s90, v132
    v_pk_add_f32 v[144:145], v[144:145], v[32:33]
    v_cvt_pk_bf16_f32 v24, v144, v145
    v_lshlrev_b32 v144, 16, v133
    v_and_b32 v145, s90, v133
    v_pk_add_f32 v[144:145], v[144:145], v[34:35]
    v_cvt_pk_bf16_f32 v25, v144, v145
    ds_write_b64 v68, v[24:25]
    v_lshlrev_b32 v144, 16, v134
    v_and_b32 v145, s90, v134
    v_pk_add_f32 v[144:145], v[144:145], v[36:37]
    v_cvt_pk_bf16_f32 v26, v144, v145
    v_lshlrev_b32 v144, 16, v135
    v_and_b32 v145, s90, v135
    v_pk_add_f32 v[144:145], v[144:145], v[38:39]
    v_cvt_pk_bf16_f32 v27, v144, v145
    ds_write_b64 v69, v[26:27]
    v_lshlrev_b32 v144, 16, v136
    v_and_b32 v145, s90, v136
    v_pk_add_f32 v[144:145], v[144:145], v[40:41]
    v_cvt_pk_bf16_f32 v28, v144, v145
    v_lshlrev_b32 v144, 16, v137
    v_and_b32 v145, s90, v137
    v_pk_add_f32 v[144:145], v[144:145], v[42:43]
    v_cvt_pk_bf16_f32 v29, v144, v145
    ds_write_b64 v70, v[28:29]
    v_lshlrev_b32 v144, 16, v138
    v_and_b32 v145, s90, v138
    v_pk_add_f32 v[144:145], v[144:145], v[44:45]
    v_cvt_pk_bf16_f32 v30, v144, v145
    v_lshlrev_b32 v144, 16, v139
    v_and_b32 v145, s90, v139
    v_pk_add_f32 v[144:145], v[144:145], v[46:47]
    v_cvt_pk_bf16_f32 v31, v144, v145
    ds_write_b64 v71, v[30:31]
    s_lshl_b32 s76, s62, 12
    s_add_u32 s76, s76, 0
    v_add_u32 v4, s76, v12
    s_waitcnt lgkmcnt(0)
    ds_read_b128 v[48:51], v4 offset:0
    ds_read_b128 v[52:55], v4 offset:1024
    ds_read_b128 v[56:59], v4 offset:2048
    ds_read_b128 v[60:63], v4 offset:3072
    s_cmp_eq_u32 s62, 0
    s_cbranch_scc0 L_nos4_56
    s_mul_i32 s76, s98, 9344
    s_add_u32 s76, s76, 8388608
    s_sleep 6
    s_mov_b32 s88, 0
L_spin_57:
    buffer_load_dwordx2 v[40:41], v179, s[40:43], s76 offen offset:256 sc1
    buffer_load_dwordx4 v[32:35], v180, s[40:43], s76 offen offset:0 sc1
    buffer_load_dwordx4 v[36:39], v180, s[40:43], s76 offen offset:64 sc1
    s_waitcnt vmcnt(0)
    v_max3_u32 v4, v41, v32, v36
    v_cmp_eq_u32_e64 vcc, -1, v4
    s_nop 0
    s_cbranch_vccz L_ok_58
    s_add_u32 s88, s88, 1
    s_cmp_lt_u32 s88, 65536
    s_cbranch_scc1 L_spin_57
L_ok_58:
    v_max_f32_dpp v4, v40, v40 row_ror:8 row_mask:0xf bank_mask:0xf
    ds_write_b128 v12, v[32:35] offset:28672
    ds_write_b128 v12, v[36:39] offset:29696
    v_max_f32_dpp v4, v4, v4 row_ror:4 row_mask:0xf bank_mask:0xf
    s_nop 1
    v_max_f32_dpp v4, v4, v4 row_ror:2 row_mask:0xf bank_mask:0xf
    s_nop 1
    v_max_f32_dpp v4, v4, v4 row_ror:1 row_mask:0xf bank_mask:0xf
    v_cmp_eq_f32 vcc, v4, v40
    v_mov_b32 v44, v1
    v_mov_b32 v45, v41
    v_mov_b32 v46, v40
    s_ff1_i32_b32 s92, vcc_lo
    s_and_b32 s92, s92, 15
    s_lshl_b64 exec, 1, s92
    ds_write_b128 v6, v[44:47] offset:25632
    s_mov_b64 exec, -1
L_nos4_56:
    s_waitcnt lgkmcnt(0)
    s_barrier
    ds_read_b32 v9, v6 offset:25636
    s_cmp_eq_u32 s62, 0
    s_cbranch_scc0 L_noh_59
    s_cmp_eq_u32 s92, s97
    s_cbranch_scc0 L_noh_59
    ds_read_b128 v[184:187], v177 offset:26752
    s_mov_b64 s[84:85], 0xff
    s_lshl_b64 exec, s[84:85], s82
    s_waitcnt lgkmcnt(0)
    buffer_store_dwordx4 v[184:187], v178, s[40:43], s99 offen offset:128 sc1
    s_mov_b64 exec, -1
L_noh_59:
    s_waitcnt lgkmcnt(0)
    v_readfirstlane_b32 s91, v9
    s_nop 0
    s_sub_u32 s77, s91, s78
    v_lshrrev_b32 v7, 3, v1
    v_sub_u32 v5, s77, v7
    v_mov_b32 v6, 2146435072
    v_and_b32 v8, 7, v1
    v_lshrrev_b32 v9, 4, v1
    v_xor_b32 v8, v8, v9
    v_lshlrev_b32 v8, 4, v8
    v_lshl_add_u32 v7, v7, 11, v8
    v_xor_b32 v8, 64, v7
    s_lshl_b32 s76, s78, 11
    s_lshl_b32 s79, s98, 7
    s_add_u32 s76, s76, s79
    v_cmp_eq_u32 vcc, 0, v5
    s_nop 1
    v_cndmask_b32 v64, v7, v6, vcc
    v_cmp_eq_u32 vcc, 8, v5
    s_nop 1
    v_cndmask_b32 v65, v8, v6, vcc
    v_cmp_eq_u32 vcc, 16, v5
    s_nop 1
    v_cndmask_b32 v66, v7, v6, vcc
    v_cmp_eq_u32 vcc, 24, v5
    s_nop 1
    v_cndmask_b32_e64 v67, v8, v6, vcc
    s_barrier
    buffer_store_dwordx4 v[48:51], v64, s[44:47], s76 offen sc1
    s_add_u32 s76, s76, 16384
    buffer_store_dwordx4 v[52:55], v65, s[44:47], s76 offen sc1
    s_add_u32 s76, s76, 16384
    buffer_store_dwordx4 v[56:59], v66, s[44:47], s76 offen sc1
    s_add_u32 s76, s76, 16384
    buffer_store_dwordx4 v[60:63], v67, s[44:47], s76 offen sc1
L_cfin:
L_end:
    s_endpgm
L_code_end:
s_endpgm
.fill 1056, 4, 0xbf800000
.section .rodata,"a"
.p2align 6
.amdhsa_kernel sequential_preLN__linear_kernel_hedgehog__moe_arch_mod__prompt_kernel
  .amdhsa_next_free_vgpr 256
  .amdhsa_next_free_sgpr 102
  .amdhsa_accum_offset 256
  .amdhsa_group_segment_fixed_size 0
  .amdhsa_kernarg_size 96
  .amdhsa_user_sgpr_count 2
  .amdhsa_user_sgpr_kernarg_segment_ptr 1
  .amdhsa_system_sgpr_workgroup_id_x 1
  .amdhsa_float_denorm_mode_32 3
.end_amdhsa_kernel
```

```asm
; @launch grid=(256,1,1) block=(512,1,1) lds=163840
.amdgcn_target "amdgcn-amd-amdhsa--gfx950"
.text
.globl sequential_preLN__linear_kernel_hedgehog__moe_arch_mod__prompt_kernel
.p2align 8
.type sequential_preLN__linear_kernel_hedgehog__moe_arch_mod__prompt_kernel,@function
sequential_preLN__linear_kernel_hedgehog__moe_arch_mod__prompt_kernel:
    s_cmp_ge_u32 s2, 256
    s_cbranch_scc1 L_end
    s_load_dwordx8 s[4:11], s[0:1], 0
    s_load_dwordx8 s[12:19], s[0:1], 32
    s_load_dwordx8 s[20:27], s[0:1], 64
    v_lshrrev_b32 v4, 6, v0
    v_and_b32 v1, 63, v0
    v_readfirstlane_b32 s79, v4
    s_and_b32 s76, s2, 7
    s_lshr_b32 s77, s2, 3
    s_and_b32 s60, s77, 15
    s_lshl_b32 s76, s76, 3
    s_bfe_u32 s77, s2, 0x10007
    s_lshl2_add_u32 s76, s77, s76
    s_mov_b32 s80, 0x654210b3
    s_mov_b32 s81, 0xfedca987
    s_lshr_b64 s[80:81], s[80:81], s76
    s_and_b32 s61, s80, 15
    s_and_b32 s62, s79, 3
    s_cmp_ge_u32 s79, 4
    s_cbranch_scc1 L_compute
    s_getpc_b64 s[66:67]
L_pc:
    s_lshr_b32 s76, s2, 3
    s_lshl2_add_u32 s76, s76, s62
    s_mul_i32 s76, s76, 256
    v_lshl_add_u32 v91, v1, 7, s76
    s_mov_b64 exec, 3
    global_load_dword v27, v91, s[66:67]
    s_mov_b64 exec, -1
    s_add_u32 s84, s60, s61
    s_and_b32 s84, s84, 3
    s_and_b32 s76, s60, 7
    s_and_b32 s77, s61, 7
    s_cmp_eq_u32 s77, 3
    s_cselect_b32 s84, s76, s84
    v_lshrrev_b32 v4, 3, v1
    v_and_b32 v5, 7, v1
    v_lshrrev_b32 v6, 4, v1
    s_lshl_b32 s76, s60, 18
    s_lshl_b32 s77, s62, 16
    s_add_u32 s76, s76, s77
    v_xor_b32 v7, v5, v6
    v_lshlrev_b32_e64 v7, 4, v7
    v_lshl_add_u32 v78, v4, 11, v7
    v_add_u32 v16, s76, v78
    v_xor_b32 v7, 64, v16
    v_add_u32 v17, 15360, v7
    v_add_u32 v18, 30720, v16
    v_add_u32 v19, 46080, v7
    v_and_b32 v6, 1, v6
    v_lshlrev_b32 v6, 2, v6
    v_xor_b32 v8, v5, v6
    v_lshlrev_b32_e64 v8, 4, v8
    s_lshl_b32 s76, s61, 7
    s_mul_i32 s77, s62, 98304
    s_add_u32 s76, s76, s77
    v_mul_u32_u24 v7, 6144, v4
    v_add3_u32 v20, v7, v8, s76
    v_xor_b32 v7, 32, v20
    v_add_u32 v21, 48128, v7
    v_add_u32_e64 v22, 0, v20
    v_add_u32 v23, 48128, v7
    v_add_u32 v24, 4096, v20
    v_add_u32 v25, 52224, v7
    s_mul_i32 s70, s62, 10240
    s_waitcnt lgkmcnt(0)
    s_mov_b32 s28, s4
    s_and_b32 s29, s5, 0xffff
    s_mov_b32 s30, 4194304
    s_mov_b32 s31, 0x20000
    s_mov_b32 s32, s6
    s_and_b32 s33, s7, 0xffff
    s_mov_b32 s34, 6291456
    s_mov_b32 s35, 0x20000
    s_and_b32 s72, s84, 15
    s_mov_b32 m0, s70
    s_lshl_b32 s71, s72, 7
    buffer_load_dwordx4 v16, s[28:31], s71 offen offset:0 lds
    s_mul_i32 s72, s72, 393216
    s_lshr_b64 s[84:85], s[84:85], 4
    buffer_load_dwordx4 v17, s[28:31], s71 offen offset:1024 lds
    buffer_load_dwordx4 v18, s[28:31], s71 offen offset:2048 lds
    buffer_load_dwordx4 v19, s[28:31], s71 offen offset:3072 lds
    s_add_u32 m0, s70, 4096
    s_nop 0
    buffer_load_dwordx4 v20, s[32:35], s72 offen offset:0 lds
    buffer_load_dwordx4 v21, s[32:35], s72 offen offset:1024 lds
    buffer_load_dwordx4 v22, s[32:35], s72 offen offset:2048 lds
    buffer_load_dwordx4 v23, s[32:35], s72 offen offset:3072 lds
    s_add_u32 m0, s70, 8192
    s_nop 0
    buffer_load_dwordx4 v24, s[32:35], s72 offen offset:0 lds
    buffer_load_dwordx4 v25, s[32:35], s72 offen offset:1024 lds
    s_add_u32 s70, s70, 40960
    s_cmp_ge_u32 s70, 122880
    s_cselect_b32 s76, 122880, 0
    s_sub_u32 s70, s70, s76
    s_lshl_b32 s76, s60, 8
    s_lshl_b32 s77, s61, 4
    s_add_u32 s76, s76, s77
    s_add_u32 s76, s76, 28940
    s_load_dwordx4 s[84:87], s[66:67], s76
    v_lshl_add_u32 v26, v4, 11, v8
    v_xor_b32 v79, 64, v78
    s_and_b32 s63, s62, 1
    s_lshr_b32 s64, s62, 1
    s_lshl_b32 s73, s60, 4
    s_add_u32 s73, s73, s61
    s_mul_i32 s73, s73, 28800
    s_add_u32 s76, s2, 7
    s_and_b32 s76, s76, 7
    s_bfe_u32 s77, s2, 0x10003
    s_lshl1_add_u32 s97, s76, s77
    s_lshr_b32 s98, s2, 4
    s_lshl_b32 s99, s97, 4
    s_add_u32 s99, s99, s98
    s_mul_i32 s99, s99, 9344
    s_add_u32 s99, s99, 8388608
    s_lshr_b32 s65, s97, 1
    s_lshl_b32 s76, s97, 3
    s_add_u32 s65, s65, s76
    s_mul_i32 s76, s98, 1
    s_add_u32 s65, s65, s76
    s_and_b32 s65, s65, 15
    s_mov_b32 s89, 0x3f803f80
    s_mov_b32 s90, 0xffff0000
    v_and_b32 v2, 31, v1
    v_lshrrev_b32 v3, 5, v1
    v_lshlrev_b32 v12, 4, v1
    v_lshrrev_b32 v4, 3, v1
    v_mul_u32_u24 v13, 460800, v4
    v_and_b32_e64 v4, 7, v1
    v_lshl_add_u32 v13, v4, 4, v13
    s_lshl_b32 s76, s98, 7
    s_lshl_b32 s77, s62, 15
    s_add_u32 s76, s76, s77
    v_add_u32_e64 v26, s76, v26
    s_mov_b32 s40, s26
    s_and_b32 s41, s27, 0xffff
    s_mov_b32 s42, 33554432
    s_mov_b32 s43, 0x20000
    s_mov_b32 s56, s8
    s_and_b32 s57, s9, 0xffff
    s_mov_b32 s58, 65536
    s_mov_b32 s59, 0x20000
    v_mov_b32 v28, -1
    v_mov_b32 v29, -1
    v_mov_b32 v30, -1
    v_mov_b32_e64 v31, -1
    s_waitcnt lgkmcnt(0)
    s_and_b32 s72, s84, 15
    s_mov_b32 m0, s70
    s_lshl_b32 s71, s72, 7
    buffer_load_dwordx4 v16, s[28:31], s71 offen offset:0 lds
    s_mul_i32 s72, s72, 393216
    s_lshr_b64 s[84:85], s[84:85], 4
    buffer_load_dwordx4 v17, s[28:31], s71 offen offset:1024 lds
    buffer_load_dwordx4 v18, s[28:31], s71 offen offset:2048 lds
    buffer_load_dwordx4 v19, s[28:31], s71 offen offset:3072 lds
    s_add_u32 m0, s70, 4096
    s_nop 0
    buffer_load_dwordx4 v20, s[32:35], s72 offen offset:0 lds
    buffer_load_dwordx4 v21, s[32:35], s72 offen offset:1024 lds
    buffer_load_dwordx4 v22, s[32:35], s72 offen offset:2048 lds
    buffer_load_dwordx4 v23, s[32:35], s72 offen offset:3072 lds
    s_add_u32 m0, s70, 8192
    s_nop 0
    buffer_load_dwordx4 v24, s[32:35], s72 offen offset:0 lds
    buffer_load_dwordx4 v25, s[32:35], s72 offen offset:1024 lds
    s_add_u32 s70, s70, 40960
    s_cmp_ge_u32 s70, 122880
    s_cselect_b32 s76, 122880, 0
    s_sub_u32 s70, s70, s76
    s_lshl_b32 s77, s62, 10
    s_add_u32 s76, s77, s73
    buffer_store_dwordx4 v[28:31], v12, s[40:43], s76 offen sc1
    s_lshl_b32 s76, s61, 12
    s_add_u32 s76, s76, s77
    s_add_u32 m0, s77, 122880
    s_nop 0
    buffer_load_dwordx4 v12, s[56:59], s76 offen lds
    v_mov_b32 v4, 13631488
    buffer_load_dwordx2 v[88:89], v4, s[40:43], 0 offen
    s_waitcnt vmcnt(13)
    s_barrier
    s_and_b32 s72, s84, 15
    s_mov_b32 m0, s70
    s_lshl_b32 s71, s72, 7
    buffer_load_dwordx4 v16, s[28:31], s71 offen offset:0 lds
    s_mul_i32 s72, s72, 393216
    s_lshr_b64 s[84:85], s[84:85], 4
    buffer_load_dwordx4 v17, s[28:31], s71 offen offset:1024 lds
    buffer_load_dwordx4 v18, s[28:31], s71 offen offset:2048 lds
    buffer_load_dwordx4 v19, s[28:31], s71 offen offset:3072 lds
    s_add_u32 m0, s70, 4096
    s_nop 0
    buffer_load_dwordx4 v20, s[32:35], s72 offen offset:0 lds
    buffer_load_dwordx4 v21, s[32:35], s72 offen offset:1024 lds
    buffer_load_dwordx4 v22, s[32:35], s72 offen offset:2048 lds
    buffer_load_dwordx4 v23, s[32:35], s72 offen offset:3072 lds
    s_add_u32 m0, s70, 8192
    s_nop 0
    buffer_load_dwordx4 v24, s[32:35], s72 offen offset:0 lds
    buffer_load_dwordx4 v25, s[32:35], s72 offen offset:1024 lds
    s_add_u32 s70, s70, 40960
    s_cmp_ge_u32 s70, 122880
    s_cselect_b32 s76, 122880, 0
    s_sub_u32 s70, s70, s76
    s_mov_b32 s36, s10
    s_and_b32 s37, s11, 0xffff
    s_mov_b32 s38, 2097152
    s_mov_b32 s39, 0x20000
    s_mov_b32 s44, s22
    s_and_b32 s45, s23, 0xffff
    s_mov_b32 s46, 4194304
    s_mov_b32 s47, 0x20000
    s_mov_b32 s52, s20
    s_and_b32 s53, s21, 0xffff
    s_mov_b32 s54, 7340032
    s_mov_b32 s55, 0x20000
    s_cmp_eq_u32 s64, 0
    s_cselect_b32 s48, s16, s18
    s_cselect_b32 s49, s17, s19
    s_and_b32 s49, s49, 0xffff
    s_mov_b32 s51, 0x20000
    s_cmp_lt_u32 s97, 14
    s_cselect_b32 s50, 7340032, 0
    s_cselect_b32 s54, 7340032, 0
    v_bfe_u32 v4, v2, 1, 3
    v_xor_b32 v4, v4, v3
    v_lshlrev_b32_e64 v4, 4, v4
    v_lshl_add_u32 v72, v2, 7, v4
    v_bfe_u32 v4, v1, 2, 2
    v_lshl_add_u32 v5, v3, 3, v4
    v_lshlrev_b32 v5, 7, v5
    v_lshrrev_b32 v4, 1, v4
    v_xor_b32_e64 v4, s64, v4
    v_lshl_add_u32 v5, v4, 6, v5
    v_bfe_u32 v4, v1, 4, 1
    v_xor_b32_e64 v4, v4, v3
    v_lshl_add_u32 v5, v4, 5, v5
    v_and_b32_e64 v4, 3, v1
    v_lshl_add_u32 v5, v4, 3, v5
    s_mul_i32 s76, s62, 10240
    s_sub_u32 s76, 4096, s76
    v_add_u32_e64 v73, s76, v5
    v_mul_u32_u24 v74, 28800, v3
    v_lshl_add_u32 v74, v2, 3, v74
    v_lshrrev_b32 v4, 4, v1
    v_and_b32 v5, 15, v1
    v_mul_u32_u24 v75, 460800, v4
    v_lshl_add_u32 v75, v5, 4, v75
    v_mul_u32_u24 v76, 114688, v4
    v_lshl_add_u32 v76, v5, 4, v76
    v_lshlrev_b32_e64 v77, 4, v2
    v_lshl_add_u32 v77, v3, 11, v77
    s_mul_i32 s75, s98, 458752
    s_lshl_b32 s77, s97, 9
    s_add_u32 s75, s75, s77
    s_lshl_b32 s77, s63, 8
    s_add_u32 s75, s75, s77
    s_lshl_b32 s96, s97, 19
    s_lshl_b32 s77, s98, 15
    s_add_u32 s96, s96, s77
    s_lshl_b32 s77, s62, 9
    s_add_u32 s96, s96, s77
    s_mov_b32 s68, 1
    s_getreg_b32 s101, hwreg(HW_REG_XCC_ID, 0, 4)
    s_lshl_b32 s76, s61, 8
    s_add_u32 s76, s76, 12582912
    s_lshl_b32 s77, s60, 8
    s_add_u32 s77, s77, 12586752
    s_lshr_b32 s78, s97, 1
    s_lshl_b32 s78, s78, 9
    s_add_u32 s78, s78, 12590592
    v_mov_b32 v4, s76
    v_mov_b32 v5, s77
    v_mov_b32 v6, s78
    v_cmp_gt_u32 vcc, 16, v1
    s_nop 1
    v_cndmask_b32 v4, v5, v4, vcc
    v_cmp_gt_u32 vcc, 32, v1
    s_nop 1
    v_cndmask_b32 v4, v6, v4, vcc
    v_add_u32 v90, v4, v12
    s_waitcnt vmcnt(10)
    s_barrier
L_hloop:
    s_and_b32 s77, s86, 15
    s_cbranch_scc1 L_event
L_evret:
    s_and_b32 s72, s84, 15
    s_mov_b32 m0, s70
    s_lshl_b32 s71, s72, 7
    buffer_load_dwordx4 v16, s[28:31], s71 offen offset:0 lds
    s_mul_i32 s72, s72, 393216
    s_lshr_b64 s[84:85], s[84:85], 4
    buffer_load_dwordx4 v17, s[28:31], s71 offen offset:1024 lds
    buffer_load_dwordx4 v18, s[28:31], s71 offen offset:2048 lds
    buffer_load_dwordx4 v19, s[28:31], s71 offen offset:3072 lds
    s_add_u32 m0, s70, 4096
    s_nop 0
    buffer_load_dwordx4 v20, s[32:35], s72 offen offset:0 lds
    buffer_load_dwordx4 v21, s[32:35], s72 offen offset:1024 lds
    buffer_load_dwordx4 v22, s[32:35], s72 offen offset:2048 lds
    buffer_load_dwordx4 v23, s[32:35], s72 offen offset:3072 lds
    s_add_u32 m0, s70, 8192
    s_nop 0
    buffer_load_dwordx4 v24, s[32:35], s72 offen offset:0 lds
    buffer_load_dwordx4 v25, s[32:35], s72 offen offset:1024 lds
    s_add_u32 s70, s70, 40960
    s_cmp_ge_u32 s70, 122880
    s_cselect_b32 s76, 122880, 0
    s_sub_u32 s70, s70, s76
    s_waitcnt vmcnt(10)
L_hbar:
    s_lshr_b64 s[86:87], s[86:87], 4
    s_add_u32 s68, s68, 1
    s_cmp_lt_u32 s68, 14
    s_barrier
    s_cbranch_scc1 L_hloop
    v_add_co_u32 v88, vcc, 1, v88
    s_nop 1
    v_addc_co_u32 v89, vcc, 0, v89, vcc
    v_cmp_ne_u64 vcc, v[92:93], v[88:89]
    s_nop 0
    s_cbranch_vccz L_hello_ok_1
    s_mov_b32 s88, 0
L_spin_2:
    buffer_load_dwordx4 v[92:95], v90, s[40:43], 0 offen sc1
    s_waitcnt vmcnt(0)
    v_cmp_ne_u64 vcc, v[92:93], v[88:89]
    s_nop 0
    s_cbranch_vccz L_hello_ok_1
    s_add_u32 s88, s88, 1
    s_cmp_lt_u32 s88, 65536
    s_cbranch_scc1 L_spin_2
L_hello_ok_1:
    v_cmp_ne_u32_e64 vcc, s101, v94
    s_nop 0
    s_and_b32 s76, vcc_lo, 0xffff
    s_cselect_b32 s100, 0, 1
    s_cmp_eq_u32 vcc_hi, 0
    s_cselect_b32 s76, 2, 0
    s_or_b32 s100, s100, s76
    v_mov_b32 v4, s100
    v_mov_b32 v5, 0
    ds_write_b32 v5, v4 offset:53248
    s_mul_i32 s80, s60, 460800
    s_lshl_b32 s81, s62, 8
    s_add_u32 s80, s80, s81
    buffer_load_dwordx2 v[32:33], v74, s[40:43], s80 offen offset:0 sc1
    s_add_u32 s80, s80, 57600
    buffer_load_dwordx2 v[34:35], v74, s[40:43], s80 offen offset:0 sc1
    s_add_u32 s80, s80, 57600
    buffer_load_dwordx2 v[36:37], v74, s[40:43], s80 offen offset:0 sc1
    s_add_u32 s80, s80, 57600
    buffer_load_dwordx2 v[38:39], v74, s[40:43], s80 offen offset:0 sc1
    s_add_u32 s80, s80, 57600
    buffer_load_dwordx2 v[40:41], v74, s[40:43], s80 offen offset:0 sc1
    s_add_u32 s80, s80, 57600
    buffer_load_dwordx2 v[42:43], v74, s[40:43], s80 offen offset:0 sc1
    s_add_u32 s80, s80, 57600
    buffer_load_dwordx2 v[44:45], v74, s[40:43], s80 offen offset:0 sc1
    s_add_u32 s80, s80, 57600
    buffer_load_dwordx2 v[46:47], v74, s[40:43], s80 offen offset:0 sc1
    s_mul_i32 s80, s61, 28800
    s_add_u32 s80, s80, s81
    buffer_load_dwordx4 v[48:51], v75, s[40:43], s80 offen offset:1024 sc1
    s_add_u32 s80, s80, 1843200
    buffer_load_dwordx4 v[52:55], v75, s[40:43], s80 offen offset:1024 sc1
    s_add_u32 s80, s80, 1843200
    buffer_load_dwordx4 v[56:59], v75, s[40:43], s80 offen offset:1024 sc1
    s_add_u32 s80, s80, 1843200
    buffer_load_dwordx4 v[60:63], v75, s[40:43], s80 offen offset:1024 sc1
    s_waitcnt vmcnt(12)
    s_barrier
    s_mul_i32 s78, s62, 2048
    s_add_u32 s78, s78, s73
    s_add_u32 s78, s78, 4096
    v_lshlrev_b32_e64 v11, 7, v1
    s_mov_b64 exec, 65535
    buffer_load_dword v27, v11, s[40:43], s78 offen sc1
    s_mov_b64 exec, -1
    buffer_load_dwordx4 v[152:155], v76, s[48:51], s75 offen nt
    s_add_u32 s75, s75, 7168
    buffer_load_dwordx4 v[156:159], v76, s[48:51], s75 offen nt
    s_add_u32 s75, s75, 7168
    s_add_u32 s78, s65, 0
    s_and_b32 s78, s78, 15
    s_lshl_b32 s78, s78, 17
    s_lshl_b32 s79, s62, 11
    s_add_u32 m0, s79, 57344
    s_add_u32 s79, s78, 15360
    buffer_load_dwordx4 v26, s[36:39], s78 offen lds
    buffer_load_dwordx4 v26, s[36:39], s79 offen offset:1024 lds
    s_add_u32 s78, s65, 1
    s_and_b32 s78, s78, 15
    s_lshl_b32 s78, s78, 17
    s_lshl_b32 s79, s62, 11
    s_add_u32 m0, s79, 65536
    s_add_u32 s79, s78, 15360
    buffer_load_dwordx4 v26, s[36:39], s78 offen lds
    buffer_load_dwordx4 v26, s[36:39], s79 offen offset:1024 lds
    s_waitcnt vmcnt(7)
    s_mov_b32 s88, 0
    s_branch L_g1first_3
L_g1_4:
    s_mul_i32 s80, s60, 460800
    s_lshl_b32 s81, s62, 8
    s_add_u32 s80, s80, s81
    buffer_load_dwordx2 v[32:33], v74, s[40:43], s80 offen offset:0 sc1
    s_add_u32 s80, s80, 57600
    buffer_load_dwordx2 v[34:35], v74, s[40:43], s80 offen offset:0 sc1
    s_add_u32 s80, s80, 57600
    buffer_load_dwordx2 v[36:37], v74, s[40:43], s80 offen offset:0 sc1
    s_add_u32 s80, s80, 57600
    buffer_load_dwordx2 v[38:39], v74, s[40:43], s80 offen offset:0 sc1
    s_add_u32 s80, s80, 57600
    buffer_load_dwordx2 v[40:41], v74, s[40:43], s80 offen offset:0 sc1
    s_add_u32 s80, s80, 57600
    buffer_load_dwordx2 v[42:43], v74, s[40:43], s80 offen offset:0 sc1
    s_add_u32 s80, s80, 57600
    buffer_load_dwordx2 v[44:45], v74, s[40:43], s80 offen offset:0 sc1
    s_add_u32 s80, s80, 57600
    buffer_load_dwordx2 v[46:47], v74, s[40:43], s80 offen offset:0 sc1
    s_mul_i32 s80, s61, 28800
    s_add_u32 s80, s80, s81
    buffer_load_dwordx4 v[48:51], v75, s[40:43], s80 offen offset:1024 sc1
    s_add_u32 s80, s80, 1843200
    buffer_load_dwordx4 v[52:55], v75, s[40:43], s80 offen offset:1024 sc1
    s_add_u32 s80, s80, 1843200
    buffer_load_dwordx4 v[56:59], v75, s[40:43], s80 offen offset:1024 sc1
    s_add_u32 s80, s80, 1843200
    buffer_load_dwordx4 v[60:63], v75, s[40:43], s80 offen offset:1024 sc1
    s_waitcnt vmcnt(0)
L_g1first_3:
    v_max3_u32 v4, v32, v34, v36
    v_max3_u32 v4, v4, v38, v40
    v_max3_u32 v4, v4, v42, v44
    v_max3_u32 v4, v4, v46, v48
    v_max3_u32 v4, v4, v50, v52
    v_max3_u32 v4, v4, v54, v56
    v_max3_u32 v4, v4, v58, v60
    v_max_u32 v4, v4, v62
    v_cmp_eq_u32_e64 vcc, -1, v4
    s_nop 0
    s_cbranch_vccz L_ok_5
    s_add_u32 s88, s88, 1
    s_cmp_lt_u32 s88, 65536
    s_cbranch_scc1 L_g1_4
L_ok_5:
    s_setprio 3
    v_add_f32 v32, v32, v40
    v_add_f32 v33, v33, v41
    v_add_f32 v34, v34, v42
    v_add_f32 v35, v35, v43
    v_add_f32 v36, v36, v44
    v_add_f32 v37, v37, v45
    v_add_f32 v38, v38, v46
    v_add_f32 v39, v39, v47
    v_add_f32 v32, v32, v36
    v_add_f32 v33, v33, v37
    v_add_f32 v34, v34, v38
    v_add_f32 v35, v35, v39
    v_add_f32 v32, v32, v34
    v_add_f32 v33, v33, v35
    v_add_f32 v48, v48, v56
    v_add_f32 v49, v49, v57
    v_add_f32 v50, v50, v58
    v_add_f32 v51, v51, v59
    v_add_f32 v52, v52, v60
    v_add_f32 v53, v53, v61
    v_add_f32 v54, v54, v62
    v_add_f32 v55, v55, v63
    v_add_f32 v48, v48, v52
    v_add_f32 v49, v49, v53
    v_add_f32 v50, v50, v54
    v_add_f32 v51, v51, v55
    v_add_f32 v49, v49, v51
    v_mov_b32 v5, v32
    v_mov_b32 v6, v33
    v_mov_b32 v51, v49
    v_permlane32_swap_b32 v48, v50
    v_permlane32_swap_b32 v32, v5
    v_permlane32_swap_b32 v33, v6
    v_permlane32_swap_b32 v49, v51
    v_add_f32 v48, v48, v50
    v_add_f32 v49, v49, v51
    v_add_f32 v32, v32, v5
    v_add_f32 v33, v33, v6
    v_permlane16_swap_b32 v48, v49
    v_add_f32 v48, v48, v49
    v_cvt_pk_bf16_f32 v49, v48, v48
    v_and_b32 v49, s90, v49
    v_sub_f32 v49, v48, v49
    v_cvt_pk_bf16_f32 v50, v48, v49
    v_and_b32 v51, s90, v50
    v_sub_f32 v49, v49, v51
    v_cvt_pk_bf16_f32 v51, v49, 0
    v_bfe_u32 v4, v1, 4, 1
    v_lshl_add_u32 v4, v4, 1, v3
    v_min_u32 v4, 2, v4
    v_and_b32 v7, 15, v1
    v_lshlrev_b32 v7, 3, v7
    s_lshl_b32 s76, s62, 7
    v_lshl_add_u32 v4, v4, 9, v7
    v_add_u32_e64 v4, s76, v4
    ds_write_b64 v4, v[50:51] offset:50176
    v_mul_f32 v32, 0x3a800000, v32
    v_mul_f32 v33, 0x3a800000, v33
    v_fma_f32 v7, -v32, v32, v33
    v_max_f32_e64 v7, 0, v7
    v_cvt_pk_bf16_f32 v5, v32, v32
    v_and_b32_e64 v5, s90, v5
    v_cvt_pk_bf16_f32 v7, v7, v7
    v_and_b32_e64 v7, s90, v7
    v_add_f32 v7, 0x3727c5ac, v7
    v_cvt_pk_bf16_f32 v7, v7, v7
    v_and_b32 v7, s90, v7
    v_sqrt_f32_e64 v7, v7
    s_nop 0
    v_cvt_pk_bf16_f32 v7, v7, v7
    v_and_b32 v7, s90, v7
    v_rcp_f32 v9, v7
    v_xor_b32 v5, 0x80000000, v5
    v_cvt_pk_bf16_f32 v8, v5, v5
    s_lshl_b32 s76, s62, 8
    v_lshl_add_u32 v6, v2, 3, s76
    ds_write_b64 v6, v[8:9] offset:49152
    s_setprio 0
    s_waitcnt lgkmcnt(0)
    s_barrier
    s_lshl_b32 s78, s62, 11
    s_add_u32 s79, s78, s73
    s_add_u32 s79, s79, 4096
    s_bitcmp1_b32 s100, 0
    s_cbranch_scc1 L_loc_6
    buffer_store_dwordx4 v[28:31], v12, s[40:43], s79 offen offset:0 sc1
    buffer_store_dwordx4 v[28:31], v12, s[40:43], s79 offen offset:1024 sc1
    s_branch L_pubd_7
L_loc_6:
    buffer_store_dwordx4 v[28:31], v12, s[40:43], s79 offen offset:0
    buffer_store_dwordx4 v[28:31], v12, s[40:43], s79 offen offset:1024
L_pubd_7:
    s_add_u32 s79, s78, s99
    s_bitcmp1_b32 s100, 1
    s_cbranch_scc1 L_loc_8
    buffer_store_dwordx4 v[28:31], v12, s[40:43], s79 offen offset:1024 sc1
    buffer_store_dwordx4 v[28:31], v12, s[40:43], s79 offen offset:2048 sc1
    s_branch L_pubd_9
L_loc_8:
    buffer_store_dwordx4 v[28:31], v12, s[40:43], s79 offen offset:1024
    buffer_store_dwordx4 v[28:31], v12, s[40:43], s79 offen offset:2048
L_pubd_9:
    s_lshl_b32 s79, s62, 8
    s_add_u32 s79, s79, s99
    s_mov_b64 exec, 0xffff
    buffer_store_dwordx4 v[28:31], v12, s[40:43], s79 offen sc1
    s_mov_b64 exec, -1
    s_add_u32 s78, s65, 2
    s_and_b32 s78, s78, 15
    s_lshl_b32 s78, s78, 17
    s_lshl_b32 s79, s62, 11
    s_add_u32 m0, s79, 73728
    s_add_u32 s79, s78, 15360
    buffer_load_dwordx4 v26, s[36:39], s78 offen lds
    buffer_load_dwordx4 v26, s[36:39], s79 offen offset:1024 lds
    s_add_u32 s78, s65, 3
    s_and_b32 s78, s78, 15
    s_lshl_b32 s78, s78, 17
    s_lshl_b32 s79, s62, 11
    s_add_u32 m0, s79, 81920
    s_add_u32 s79, s78, 15360
    buffer_load_dwordx4 v26, s[36:39], s78 offen lds
    buffer_load_dwordx4 v26, s[36:39], s79 offen offset:1024 lds
    s_add_u32 s78, s65, 4
    s_and_b32 s78, s78, 15
    s_lshl_b32 s78, s78, 17
    s_lshl_b32 s79, s62, 11
    s_add_u32 m0, s79, 90112
    s_add_u32 s79, s78, 15360
    buffer_load_dwordx4 v26, s[36:39], s78 offen lds
    buffer_load_dwordx4 v26, s[36:39], s79 offen offset:1024 lds
    s_add_u32 s78, s65, 5
    s_and_b32 s78, s78, 15
    s_lshl_b32 s78, s78, 17
    s_lshl_b32 s79, s62, 11
    s_add_u32 m0, s79, 98304
    s_add_u32 s79, s78, 15360
    buffer_load_dwordx4 v26, s[36:39], s78 offen lds
    buffer_load_dwordx4 v26, s[36:39], s79 offen offset:1024 lds
    s_mul_i32 s78, s62, 384
    s_add_u32 s78, s78, s73
    s_add_u32 s78, s78, 2048
    v_lshlrev_b32_e64 v11, 7, v1
    s_mov_b64 exec, 7
    buffer_load_dword v27, v11, s[40:43], s78 offen sc1
    s_mov_b64 exec, -1
    s_waitcnt vmcnt(9)
    s_lshl_b32 s76, s62, 2
    s_add_u32 s76, s76, s73
    v_mov_b32 v4, 0
    s_mov_b64 exec, 1
    s_bitcmp1_b32 s100, 0
    s_cbranch_scc1 L_loc_10
    buffer_store_dword v4, v4, s[40:43], s76 offen offset:2560 sc1
    s_branch L_pubd_11
L_loc_10:
    buffer_store_dword v4, v4, s[40:43], s76 offen offset:2560
L_pubd_11:
    s_mov_b64 exec, -1
    s_add_u32 s78, s65, 6
    s_and_b32 s78, s78, 15
    s_lshl_b32 s78, s78, 17
    s_lshl_b32 s79, s62, 11
    s_add_u32 m0, s79, 106496
    s_add_u32 s79, s78, 15360
    buffer_load_dwordx4 v26, s[36:39], s78 offen lds
    buffer_load_dwordx4 v26, s[36:39], s79 offen offset:1024 lds
    s_add_u32 s78, s65, 7
    s_and_b32 s78, s78, 15
    s_lshl_b32 s78, s78, 17
    s_lshl_b32 s79, s62, 11
    s_add_u32 m0, s79, 114688
    s_add_u32 s79, s78, 15360
    buffer_load_dwordx4 v26, s[36:39], s78 offen lds
    buffer_load_dwordx4 v26, s[36:39], s79 offen offset:1024 lds
    s_add_u32 s78, s65, 8
    s_and_b32 s78, s78, 15
    s_lshl_b32 s78, s78, 17
    s_lshl_b32 s79, s62, 11
    s_add_u32 m0, s79, 122880
    s_add_u32 s79, s78, 15360
    buffer_load_dwordx4 v26, s[36:39], s78 offen lds
    buffer_load_dwordx4 v26, s[36:39], s79 offen offset:1024 lds
    s_add_u32 s78, s65, 9
    s_and_b32 s78, s78, 15
    s_lshl_b32 s78, s78, 17
    s_lshl_b32 s79, s62, 11
    s_add_u32 m0, s79, 131072
    s_add_u32 s79, s78, 15360
    buffer_load_dwordx4 v26, s[36:39], s78 offen lds
    buffer_load_dwordx4 v26, s[36:39], s79 offen offset:1024 lds
    s_add_u32 s78, s65, 10
    s_and_b32 s78, s78, 15
    s_lshl_b32 s78, s78, 17
    s_lshl_b32 s79, s62, 11
    s_add_u32 m0, s79, 139264
    s_add_u32 s79, s78, 15360
    buffer_load_dwordx4 v26, s[36:39], s78 offen lds
    buffer_load_dwordx4 v26, s[36:39], s79 offen offset:1024 lds
    s_add_u32 s78, s65, 11
    s_and_b32 s78, s78, 15
    s_lshl_b32 s78, s78, 17
    s_lshl_b32 s79, s62, 11
    s_add_u32 m0, s79, 147456
    s_add_u32 s79, s78, 15360
    buffer_load_dwordx4 v26, s[36:39], s78 offen lds
    buffer_load_dwordx4 v26, s[36:39], s79 offen offset:1024 lds
    s_add_u32 s78, s65, 12
    s_and_b32 s78, s78, 15
    s_lshl_b32 s78, s78, 17
    s_lshl_b32 s79, s62, 11
    s_add_u32 m0, s79, 155648
    s_add_u32 s79, s78, 15360
    buffer_load_dwordx4 v26, s[36:39], s78 offen lds
    buffer_load_dwordx4 v26, s[36:39], s79 offen offset:1024 lds
    v_and_b32_e64 v65, 15, v1
    v_mul_u32_u24 v65, 460800, v65
    s_mul_i32 s80, s61, 28800
    s_lshl_b32 s82, s62, 2
    s_add_u32 s82, s82, s80
    v_bfe_u32 v4, v1, 4, 1
    v_lshl_add_u32 v4, v4, 1, v3
    s_lshl_b32 s77, s62, 6
    v_lshl_add_u32 v66, v4, 1, s77
    v_bfe_u32 v4, v1, 2, 1
    v_lshl_add_u32 v66, v4, 5, v66
    v_bfe_u32 v4, v1, 0, 1
    v_lshl_add_u32 v66, v4, 4, v66
    v_bfe_u32 v4, v1, 1, 1
    v_lshl_add_u32 v66, v4, 3, v66
    s_lshl_b32 s83, s62, 7
    s_add_u32 s81, s83, s80
    s_add_u32 s68, s81, 3686400
    s_add_u32 s83, s83, s73
    v_and_b32 v4, 7, v1
    v_lshrrev_b32 v5, 4, v1
    v_lshlrev_b32_e64 v5, 2, v5
    v_lshl_add_u32 v67, v4, 4, v5
    s_barrier
    buffer_load_dword v64, v65, s[40:43], s82 offen offset:2560 sc1
    s_barrier
    s_setprio 3
    v_mov_b32 v4, s89
    v_lshlrev_b32_e64 v5, 2, v1
    ds_write_b32 v5, v4 offset:24832
    v_mov_b32 v70, 0
    v_mov_b32 v71, 0
    ds_write_b64 v70, v[70:71] offset:25984
    s_mov_b32 s88, 0
    s_branch L_p2first_12
L_p2_13:
    buffer_load_dword v64, v65, s[40:43], s82 offen offset:2560 sc1
L_p2first_12:
    s_waitcnt vmcnt(0)
    v_cmp_eq_u32_e64 vcc, -1, v64
    s_nop 0
    s_cbranch_vccz L_ok_14
    s_add_u32 s88, s88, 1
    s_cmp_lt_u32 s88, 65536
    s_cbranch_scc1 L_p2_13
L_ok_14:
    s_add_u32 s78, s65, 13
    s_and_b32 s78, s78, 15
    s_lshl_b32 s78, s78, 17
    s_lshl_b32 s79, s62, 11
    s_add_u32 m0, s79, 32768
    s_add_u32 s79, s78, 15360
    buffer_load_dwordx4 v26, s[36:39], s78 offen lds
    buffer_load_dwordx4 v26, s[36:39], s79 offen offset:1024 lds
    s_add_u32 s78, s65, 14
    s_and_b32 s78, s78, 15
    s_lshl_b32 s78, s78, 17
    s_lshl_b32 s79, s62, 11
    s_add_u32 m0, s79, 40960
    s_add_u32 s79, s78, 15360
    buffer_load_dwordx4 v26, s[36:39], s78 offen lds
    buffer_load_dwordx4 v26, s[36:39], s79 offen offset:1024 lds
    s_add_u32 s78, s65, 15
    s_and_b32 s78, s78, 15
    s_lshl_b32 s78, s78, 17
    s_lshl_b32 s79, s62, 11
    s_add_u32 m0, s79, 49152
    s_add_u32 s79, s78, 15360
    buffer_load_dwordx4 v26, s[36:39], s78 offen lds
    buffer_load_dwordx4 v26, s[36:39], s79 offen offset:1024 lds
    s_lshl_b32 s76, s62, 11
    s_lshl_b32 s77, s60, 7
    s_add_u32 s76, s76, s77
    s_add_u32 s76, s76, s80
    s_add_u32 s76, s76, 4096
    s_add_u32 s77, s76, 3686400
    s_mov_b32 s78, 0x00003f80
    s_mov_b32 s79, 0x3f800000
    s_mov_b32 s88, 0
L_poll_15:
    buffer_load_dwordx4 v[32:35], v13, s[40:43], s76 offen sc1
    buffer_load_dwordx4 v[36:39], v13, s[40:43], s77 offen sc1
    s_waitcnt vmcnt(0)
    v_max_u32 v4, v32, v36
    v_cmp_eq_u32_e64 vcc, -1, v4
    s_nop 0
    s_cbranch_vccz L_ok_16
    s_add_u32 s88, s88, 1
    s_cmp_lt_u32 s88, 65536
    s_cbranch_scc1 L_poll_15
L_ok_16:
    v_dot2_f32_bf16 v48, v32, s78, 0
    v_dot2_f32_bf16 v49, v32, s79, 0
    v_dot2_f32_bf16 v50, v33, s78, 0
    v_dot2_f32_bf16 v51, v33, s79, 0
    v_dot2_f32_bf16 v52, v34, s78, 0
    v_dot2_f32_bf16 v53, v34, s79, 0
    v_dot2_f32_bf16 v54, v35, s78, 0
    v_dot2_f32_bf16 v55, v35, s79, 0
    v_dot2_f32_bf16 v48, v36, s78, v48
    v_dot2_f32_bf16 v49, v36, s79, v49
    v_dot2_f32_bf16 v50, v37, s78, v50
    v_dot2_f32_bf16 v51, v37, s79, v51
    v_dot2_f32_bf16 v52, v38, s78, v52
    v_dot2_f32_bf16 v53, v38, s79, v53
    v_dot2_f32_bf16 v54, v39, s78, v54
    v_dot2_f32_bf16 v55, v39, s79, v55
    buffer_load_dwordx4 v[40:43], v13, s[40:43], s81 offen offset:2048 sc1
    buffer_load_dwordx4 v[44:47], v13, s[40:43], s68 offen offset:2048 sc1
    v_permlane32_swap_b32 v48, v52
    v_permlane32_swap_b32 v49, v53
    v_permlane32_swap_b32 v50, v54
    v_permlane32_swap_b32 v51, v55
    v_add_f32 v48, v48, v52
    v_add_f32 v49, v49, v53
    v_add_f32 v50, v50, v54
    v_add_f32 v51, v51, v55
    s_nop 0
    v_permlane16_swap_b32 v48, v50
    v_permlane16_swap_b32 v49, v51
    v_add_f32 v48, v48, v50
    v_add_f32_e64 v49, v49, v51
    s_nop 0
    v_add_f32_dpp v48, v48, v48 row_ror:8 row_mask:0xf bank_mask:0xf
    v_add_f32_dpp v49, v49, v49 row_ror:8 row_mask:0xf bank_mask:0xf
    v_cvt_pk_bf16_f32 v48, v48, v49
    s_bitcmp1_b32 s100, 0
    s_cbranch_scc1 L_loc_17
    buffer_store_dword v48, v67, s[40:43], s83 offen offset:3072 sc1
    s_branch L_pubd_18
L_loc_17:
    buffer_store_dword v48, v67, s[40:43], s83 offen offset:3072
L_pubd_18:
    s_mov_b32 s88, 0
    s_waitcnt vmcnt(1)
    s_branch L_zfirst_19
L_z_20:
    buffer_load_dwordx4 v[40:43], v13, s[40:43], s81 offen offset:2048 sc1
    buffer_load_dwordx4 v[44:47], v13, s[40:43], s68 offen offset:2048 sc1
    s_waitcnt vmcnt(0)
L_zfirst_19:
    v_max3_u32 v4, v40, v41, v42
    v_max3_u32 v4, v4, v43, v44
    v_max3_u32 v4, v4, v45, v46
    v_max_u32 v4, v4, v47
    v_cmp_eq_u32 vcc, -1, v4
    s_nop 0
    s_cbranch_vccz L_ok_21
    s_add_u32 s88, s88, 1
    s_cmp_lt_u32 s88, 65536
    s_cbranch_scc1 L_z_20
L_ok_21:
    v_add_f32 v40, v40, v44
    v_add_f32 v41, v41, v45
    v_add_f32 v42, v42, v46
    v_add_f32 v43, v43, v47
    v_permlane32_swap_b32 v40, v41
    s_nop 0
    v_permlane32_swap_b32 v42, v43
    v_add_f32 v40, v40, v41
    v_add_f32 v42, v42, v43
    s_nop 1
    v_permlane16_swap_b32 v40, v42
    v_add_f32 v40, v40, v42
    s_nop 1
    v_add_f32_dpp v40, v40, v40 row_ror:8 row_mask:0xf bank_mask:0xf
    v_cvt_pk_bf16_f32 v40, v40, v40
    ds_write_b16 v66, v40 offset:24576
    s_waitcnt lgkmcnt(0)
    s_barrier
    s_setprio 0
    s_lshl_b32 s78, s97, 18
    s_lshl_b32 s79, s62, 16
    s_add_u32 s78, s78, s79
    s_lshl_b32 s79, s98, 7
    s_add_u32 s78, s78, s79
    s_lshl_b32 s79, s62, 12
    s_add_u32 m0, s79, 0
    s_nop 0
    buffer_load_dwordx4 v78, s[28:31], s78 offen offset:0 lds
    s_add_u32 s78, s78, 15360
    buffer_load_dwordx4 v79, s[28:31], s78 offen offset:1024 lds
    s_add_u32 s78, s78, 15360
    buffer_load_dwordx4 v78, s[28:31], s78 offen offset:2048 lds
    s_add_u32 s78, s78, 15360
    buffer_load_dwordx4 v79, s[28:31], s78 offen offset:3072 lds
    s_barrier
    s_mov_b64 exec, 3
    global_load_dword v27, v91, s[66:67]
    s_mov_b64 exec, -1
    v_add_u32 v6, s65, v1
    v_and_b32 v6, 15, v6
    v_mul_u32_u24 v6, 28800, v6
    s_mul_i32 s76, s97, 460800
    s_mov_b32 s77, 0
    s_cmp_eq_u32 s62, 0
    s_cbranch_scc0 L_now0_22
    buffer_load_dword v68, v6, s[40:43], s76 offen offset:3584 sc1
    s_waitcnt vmcnt(0)
    v_cmp_ne_u32 vcc, -1, v68
    s_nop 0
    s_and_b32 s77, vcc_lo, 0xffff
    v_mov_b32_e64 v69, s77
    ds_write_b32 v70, v69 offset:25984
L_now0_22:
    s_waitcnt vmcnt(0) lgkmcnt(0)
    s_barrier
    s_cmp_eq_u32 s62, 0
    s_cbranch_scc0 L_now1_23
    s_mov_b32 s88, 0
L_spin_25:
    s_cmp_eq_u32 s77, 0xffff
    s_cbranch_scc1 L_s2done_24
    buffer_load_dword v68, v6, s[40:43], s76 offen offset:3584 sc1
    s_waitcnt vmcnt(0)
    v_cmp_ne_u32_e64 vcc, -1, v68
    s_nop 0
    s_and_b32 s77, vcc_lo, 0xffff
    v_mov_b32_e64 v69, s77
    ds_write_b32 v70, v69 offset:25984
    s_add_u32 s88, s88, 1
    s_cmp_lt_u32 s88, 65536
    s_cbranch_scc1 L_spin_25
    s_branch L_s2done_24
L_now1_23:
    s_cmp_eq_u32 s62, 1
    s_cbranch_scc0 L_s2done_24
    v_lshlrev_b32_e64 v4, 2, v2
    s_mov_b32 s88, 0
L_spin_26:
    ds_read_b32 v69, v70 offset:25988
    s_waitcnt lgkmcnt(0)
    v_cmp_eq_u32_e64 vcc, 4, v69
    s_nop 0
    s_cbranch_vccnz L_drained_27
    s_add_u32 s88, s88, 1
    s_cmp_lt_u32 s88, 1048576
    s_cbranch_scc1 L_spin_26
L_drained_27:
    s_mov_b32 exec_hi, 0
    buffer_store_dword v70, v4, s[40:43], s73 offen offset:3584 sc1
    s_mov_b64 exec, -1
L_s2done_24:
    s_waitcnt vmcnt(0)
    s_mov_b32 s78, 0x05040100
    s_mov_b32 s79, 0x07060302
    v_perm_b32 v160, v100, v96, s78
    v_perm_b32 v164, v100, v96, s79
    v_perm_b32 v168, v101, v97, s78
    v_perm_b32 v172, v101, v97, s79
    v_perm_b32 v176, v102, v98, s78
    v_perm_b32 v180, v102, v98, s79
    v_perm_b32 v184, v103, v99, s78
    v_perm_b32 v188, v103, v99, s79
    v_perm_b32 v161, v108, v104, s78
    v_perm_b32 v165, v108, v104, s79
    v_perm_b32 v169, v109, v105, s78
    v_perm_b32 v173, v109, v105, s79
    v_perm_b32 v177, v110, v106, s78
    v_perm_b32 v181, v110, v106, s79
    v_perm_b32 v185, v111, v107, s78
    v_perm_b32 v189, v111, v107, s79
    v_perm_b32 v162, v116, v112, s78
    v_perm_b32 v166, v116, v112, s79
    v_perm_b32 v170, v117, v113, s78
    v_perm_b32 v174, v117, v113, s79
    v_perm_b32 v178, v118, v114, s78
    v_perm_b32 v182, v118, v114, s79
    v_perm_b32 v186, v119, v115, s78
    v_perm_b32 v190, v119, v115, s79
    v_perm_b32 v163, v124, v120, s78
    v_perm_b32 v167, v124, v120, s79
    v_perm_b32 v171, v125, v121, s78
    v_perm_b32 v175, v125, v121, s79
    v_perm_b32 v179, v126, v122, s78
    v_perm_b32 v183, v126, v122, s79
    v_perm_b32 v187, v127, v123, s78
    v_perm_b32 v191, v127, v123, s79
    v_perm_b32 v192, v132, v128, s78
    v_perm_b32 v196, v132, v128, s79
    v_perm_b32 v200, v133, v129, s78
    v_perm_b32 v204, v133, v129, s79
    v_perm_b32 v208, v134, v130, s78
    v_perm_b32 v212, v134, v130, s79
    v_perm_b32 v216, v135, v131, s78
    v_perm_b32 v220, v135, v131, s79
    v_perm_b32 v193, v140, v136, s78
    v_perm_b32 v197, v140, v136, s79
    v_perm_b32 v201, v141, v137, s78
    v_perm_b32 v205, v141, v137, s79
    v_perm_b32 v209, v142, v138, s78
    v_perm_b32 v213, v142, v138, s79
    v_perm_b32 v217, v143, v139, s78
    v_perm_b32 v221, v143, v139, s79
    v_perm_b32 v194, v148, v144, s78
    v_perm_b32 v198, v148, v144, s79
    v_perm_b32 v202, v149, v145, s78
    v_perm_b32 v206, v149, v145, s79
    v_perm_b32 v210, v150, v146, s78
    v_perm_b32 v214, v150, v146, s79
    v_perm_b32 v218, v151, v147, s78
    v_perm_b32 v222, v151, v147, s79
    v_perm_b32 v195, v156, v152, s78
    v_perm_b32 v199, v156, v152, s79
    v_perm_b32 v203, v157, v153, s78
    v_perm_b32 v207, v157, v153, s79
    v_perm_b32 v211, v158, v154, s78
    v_perm_b32 v215, v158, v154, s79
    v_perm_b32 v219, v159, v155, s78
    v_perm_b32 v223, v159, v155, s79
    v_lshlrev_b32_e64 v17, 5, v2
    v_lshl_add_u32 v17, v3, 4, v17
    v_and_b32 v4, 15, v1
    v_lshrrev_b32 v5, 1, v4
    v_and_b32 v4, 1, v4
    v_lshlrev_b32 v4, 5, v4
    v_lshl_add_u32 v16, v5, 7, v4
    v_lshrrev_b32 v4, 3, v1
    v_and_b32 v5, 7, v1
    v_lshlrev_b32_e64 v5, 4, v5
    v_mul_u32_u24 v18, 9344, v4
    v_add_u32_e64 v18, v18, v5
    v_bfe_u32 v6, v1, 4, 1
    v_lshl_add_u32 v6, v6, 1, v3
    v_lshl_add_u32 v19, v6, 2, v5
    s_mul_i32 s84, s97, 149504
    s_lshl_b32 s77, s98, 7
    s_add_u32 s84, s84, s77
    s_add_u32 s84, s84, 8388608
    s_lshl_b32 s85, s62, 10
    s_add_u32 s85, s85, s99
    s_add_u32 s85, s85, 5120
    s_and_b32 s87, s97, 1
    s_lshl_b32 s87, s87, 4
    s_add_u32 s87, s87, s98
    s_lshr_b32 s86, s97, 1
    s_mul_i32 s86, s86, 299008
    s_lshl_b32 s77, s87, 7
    s_add_u32 s86, s86, s77
    s_add_u32 s86, s86, 8393728
    s_barrier
    s_mul_i32 s78, s62, 2048
    s_add_u32 s78, s78, s99
    s_add_u32 s78, s78, 1024
    v_lshlrev_b32_e64 v11, 7, v1
    s_mov_b64 exec, 65535
    buffer_load_dword v27, v11, s[40:43], s78 offen sc1
    s_mov_b64 exec, -1
    buffer_load_dwordx4 v[32:35], v77, s[52:55], s96 offen nt
    s_add_u32 s96, s96, 4096
    buffer_load_dwordx4 v[36:39], v77, s[52:55], s96 offen nt
    s_add_u32 s96, s96, 4096
    buffer_load_dwordx4 v[40:43], v77, s[52:55], s96 offen nt
    s_add_u32 s96, s96, 4096
    buffer_load_dwordx4 v[44:47], v77, s[52:55], s96 offen nt
    s_add_u32 s96, s96, 4096
    s_barrier
    buffer_load_dwordx4 v[48:51], v77, s[52:55], s96 offen nt
    s_add_u32 s96, s96, 4096
    buffer_load_dwordx4 v[52:55], v77, s[52:55], s96 offen nt
    s_add_u32 s96, s96, 4096
    buffer_load_dwordx4 v[56:59], v77, s[52:55], s96 offen nt
    s_add_u32 s96, s96, 4096
    buffer_load_dwordx4 v[60:63], v77, s[52:55], s96 offen nt
    s_add_u32 s96, s96, 4096
    s_barrier
    s_waitcnt vmcnt(0)
    s_mov_b32 s78, 0x05040100
    s_mov_b32 s79, 0x07060302
    v_permlane32_swap_b32 v32, v34
    v_permlane32_swap_b32 v33, v35
    v_permlane32_swap_b32 v36, v38
    v_permlane32_swap_b32 v37, v39
    v_permlane32_swap_b32 v40, v42
    v_permlane32_swap_b32 v41, v43
    v_permlane32_swap_b32 v44, v46
    v_permlane32_swap_b32 v45, v47
    v_permlane32_swap_b32 v48, v50
    v_permlane32_swap_b32 v49, v51
    v_permlane32_swap_b32 v52, v54
    v_permlane32_swap_b32 v53, v55
    v_permlane32_swap_b32 v56, v58
    v_permlane32_swap_b32 v57, v59
    v_permlane32_swap_b32 v60, v62
    v_permlane32_swap_b32 v61, v63
    v_perm_b32 v224, v34, v32, s78
    v_perm_b32 v225, v34, v32, s79
    v_perm_b32 v226, v35, v33, s78
    v_perm_b32 v227, v35, v33, s79
    v_perm_b32 v228, v38, v36, s78
    v_perm_b32 v229, v38, v36, s79
    v_perm_b32 v230, v39, v37, s78
    v_perm_b32 v231, v39, v37, s79
    v_perm_b32 v232, v42, v40, s78
    v_perm_b32 v233, v42, v40, s79
    v_perm_b32 v234, v43, v41, s78
    v_perm_b32 v235, v43, v41, s79
    v_perm_b32 v236, v46, v44, s78
    v_perm_b32 v237, v46, v44, s79
    v_perm_b32 v238, v47, v45, s78
    v_perm_b32 v239, v47, v45, s79
    v_perm_b32 v240, v50, v48, s78
    v_perm_b32 v241, v50, v48, s79
    v_perm_b32 v242, v51, v49, s78
    v_perm_b32 v243, v51, v49, s79
    v_perm_b32 v244, v54, v52, s78
    v_perm_b32 v245, v54, v52, s79
    v_perm_b32 v246, v55, v53, s78
    v_perm_b32 v247, v55, v53, s79
    v_perm_b32 v248, v58, v56, s78
    v_perm_b32 v249, v58, v56, s79
    v_perm_b32 v250, v59, v57, s78
    v_perm_b32 v251, v59, v57, s79
    v_perm_b32 v252, v62, v60, s78
    v_perm_b32 v253, v62, v60, s79
    v_perm_b32 v254, v63, v61, s78
    v_perm_b32 v255, v63, v61, s79
    v_and_b32 v5, 15, v1
    v_lshlrev_b32 v5, 3, v5
    s_lshl_b32 s76, s63, 10
    s_lshl_b32 s77, s64, 6
    s_add_u32 s76, s76, s77
    s_add_u32 s76, s76, s99
    s_mov_b64 s[80:81], 0xffff
    s_add_u32 s68, s84, 74752
    s_add_u32 s69, s86, 74752
    s_add_u32 s70, s86, 149504
    s_add_u32 s71, s86, 224256
    s_setprio 3
    s_barrier
    ds_read_b128 v[64:67], v12 offset:28672
    ds_read_b128 v[68:71], v12 offset:29696
    ds_read_b64 v[8:9], v5 offset:25728
    s_waitcnt lgkmcnt(2)
    v_mfma_f32_16x16x32_bf16 v[96:99], v[64:67], v[160:163], 0
    v_mfma_f32_16x16x32_bf16 v[100:103], v[64:67], v[164:167], 0
    s_waitcnt lgkmcnt(0)
    v_max_f32_dpp v4, v8, v8 row_ror:8 row_mask:0xf bank_mask:0xf
    v_mfma_f32_16x16x32_bf16 v[104:107], v[64:67], v[168:171], 0
    v_mfma_f32_16x16x32_bf16 v[108:111], v[64:67], v[172:175], 0
    v_max_f32_dpp v4, v4, v4 row_ror:4 row_mask:0xf bank_mask:0xf
    v_mfma_f32_16x16x32_bf16 v[112:115], v[64:67], v[176:179], 0
    v_mfma_f32_16x16x32_bf16 v[116:119], v[64:67], v[180:183], 0
    v_max_f32_dpp v4, v4, v4 row_ror:2 row_mask:0xf bank_mask:0xf
    v_mfma_f32_16x16x32_bf16 v[120:123], v[64:67], v[184:187], 0
    v_mfma_f32_16x16x32_bf16 v[124:127], v[64:67], v[188:191], 0
    v_max_f32_dpp v4, v4, v4 row_ror:1 row_mask:0xf bank_mask:0xf
    v_mfma_f32_16x16x32_bf16 v[96:99], v[68:71], v[192:195], v[96:99]
    v_cmp_eq_f32_e64 vcc, v4, v8
    v_mfma_f32_16x16x32_bf16 v[100:103], v[68:71], v[196:199], v[100:103]
    s_ff1_i32_b32 s92, vcc_lo
    s_and_b32 s92, s92, 15
    v_mfma_f32_16x16x32_bf16 v[104:107], v[68:71], v[200:203], v[104:107]
    s_lshr_b32 s78, s92, 2
    s_lshl_b32 s78, s78, 4
    v_mfma_f32_16x16x32_bf16 v[108:111], v[68:71], v[204:207], v[108:111]
    s_and_b32 s77, s92, 3
    v_mfma_f32_16x16x32_bf16 v[112:115], v[68:71], v[208:211], v[112:115]
    v_readlane_b32 s91, v9, s92
    v_readlane_b32 s93, v8, s92
    v_mfma_f32_16x16x32_bf16 v[116:119], v[68:71], v[212:215], v[116:119]
    v_mfma_f32_16x16x32_bf16 v[120:123], v[68:71], v[216:219], v[120:123]
    v_mfma_f32_16x16x32_bf16 v[124:127], v[68:71], v[220:223], v[124:127]
    s_cmp_ge_u32 s97, 14
    s_cbranch_scc1 L_final
    s_cmp_eq_u32 s77, 0
    s_cbranch_scc0 L_sel_29
    v_mov_b32 v64, v96
    v_mov_b32 v65, v100
    v_mov_b32 v66, v104
    v_mov_b32 v67, v108
    v_mov_b32 v68, v112
    v_mov_b32 v69, v116
    v_mov_b32 v70, v120
    v_mov_b32 v71, v124
    s_branch L_seldone_28
L_sel_29:
    s_cmp_eq_u32 s77, 1
    s_cbranch_scc0 L_sel_30
    v_mov_b32 v64, v97
    v_mov_b32 v65, v101
    v_mov_b32 v66, v105
    v_mov_b32 v67, v109
    v_mov_b32 v68, v113
    v_mov_b32 v69, v117
    v_mov_b32 v70, v121
    v_mov_b32 v71, v125
    s_branch L_seldone_28
L_sel_30:
    s_cmp_eq_u32 s77, 2
    s_cbranch_scc0 L_sel_31
    v_mov_b32 v64, v98
    v_mov_b32 v65, v102
    v_mov_b32 v66, v106
    v_mov_b32 v67, v110
    v_mov_b32 v68, v114
    v_mov_b32 v69, v118
    v_mov_b32 v70, v122
    v_mov_b32 v71, v126
    s_branch L_seldone_28
L_sel_31:
    v_mov_b32 v64, v99
    v_mov_b32 v65, v103
    v_mov_b32 v66, v107
    v_mov_b32 v67, v111
    v_mov_b32 v68, v115
    v_mov_b32 v69, v119
    v_mov_b32 v70, v123
    v_mov_b32_e64 v71, v127
L_seldone_28:
    s_lshl_b64 exec, s[80:81], s78
    s_bitcmp1_b32 s100, 1
    s_cbranch_scc1 L_loc_33
    buffer_store_dwordx4 v[64:67], v16, s[40:43], s76 offen offset:3072 sc1
    buffer_store_dwordx4 v[68:71], v16, s[40:43], s76 offen offset:3088 sc1
    s_branch L_pubd_34
L_loc_33:
    buffer_store_dwordx4 v[64:67], v16, s[40:43], s76 offen offset:3072
    buffer_store_dwordx4 v[68:71], v16, s[40:43], s76 offen offset:3088
L_pubd_34:
    s_mov_b64 exec, -1
    s_mov_b32 s88, 0
L_poll_35:
    buffer_load_dwordx4 v[128:131], v18, s[40:43], s84 offen offset:3072 sc1
    buffer_load_dwordx4 v[132:135], v18, s[40:43], s68 offen offset:3072 sc1
    s_waitcnt vmcnt(0)
    v_max_u32 v4, v128, v132
    v_cmp_eq_u32_e64 vcc, -1, v4
    s_nop 0
    s_cbranch_vccz L_ok_36
    s_add_u32 s88, s88, 1
    s_cmp_lt_u32 s88, 65536
    s_cbranch_scc1 L_poll_35
L_ok_36:
    v_pk_add_f32 v[48:49], v[128:129], v[132:133]
    v_pk_add_f32 v[50:51], v[130:131], v[134:135]
    s_nop 0
    v_permlane32_swap_b32 v48, v49
    v_permlane32_swap_b32 v50, v51
    v_add_f32 v48, v48, v49
    v_add_f32 v50, v50, v51
    s_nop 1
    v_permlane16_swap_b32 v48, v50
    v_add_f32 v48, v48, v50
    s_nop 1
    v_add_f32_dpp v48, v48, v48 row_ror:8 row_mask:0xf bank_mask:0xf
    v_cvt_pk_bf16_f32 v48, v48, v48
    v_and_b32_e64 v48, s90, v48
    v_mul_f32 v4, 0xbfb8aa3b, v48
    v_exp_f32_e64 v4, v4
    v_mov_b32_dpp v49, v48 row_ror:12 row_mask:0xf bank_mask:0xf
    v_add_f32 v4, 1.0, v4
    v_rcp_f32 v4, v4
    s_nop 0
    v_mul_f32 v4, v4, v48
    v_cvt_pk_bf16_f32 v4, v4, v4
    v_and_b32 v4, s90, v4
    v_mul_f32 v4, v4, v49
    v_mov_b32 v5, v4
    s_nop 1
    v_permlane32_swap_b32_e64 v4, v5
    v_cvt_pk_bf16_f32 v4, v4, v5
    s_nop 0
    v_readlane_b32 s76, v4, 0
    v_readlane_b32 s77, v4, 16
    v_readlane_b32 s78, v4, 1
    v_readlane_b32 s79, v4, 17
    v_readlane_b32 s80, v4, 2
    v_readlane_b32 s81, v4, 18
    v_readlane_b32 s82, v4, 3
    v_readlane_b32 s83, v4, 19
    v_dot2_f32_bf16 v40, v224, s76, 0
    v_dot2_f32_bf16 v41, v225, s76, 0
    v_dot2_f32_bf16 v42, v226, s76, 0
    v_dot2_f32_bf16 v43, v227, s76, 0
    v_dot2_f32_bf16 v40, v228, s77, v40
    v_dot2_f32_bf16 v41, v229, s77, v41
    v_dot2_f32_bf16 v42, v230, s77, v42
    v_dot2_f32_bf16 v43, v231, s77, v43
    v_dot2_f32_bf16 v40, v232, s78, v40
    v_dot2_f32_bf16 v41, v233, s78, v41
    v_dot2_f32_bf16 v42, v234, s78, v42
    v_dot2_f32_bf16 v43, v235, s78, v43
    v_dot2_f32_bf16 v40, v236, s79, v40
    v_dot2_f32_bf16 v41, v237, s79, v41
    v_dot2_f32_bf16 v42, v238, s79, v42
    v_dot2_f32_bf16 v43, v239, s79, v43
    v_dot2_f32_bf16 v40, v240, s80, v40
    v_dot2_f32_bf16 v41, v241, s80, v41
    v_dot2_f32_bf16 v42, v242, s80, v42
    v_dot2_f32_bf16 v43, v243, s80, v43
    v_dot2_f32_bf16 v40, v244, s81, v40
    v_dot2_f32_bf16 v41, v245, s81, v41
    v_dot2_f32_bf16 v42, v246, s81, v42
    v_dot2_f32_bf16 v43, v247, s81, v43
    v_dot2_f32_bf16 v40, v248, s82, v40
    v_dot2_f32_bf16 v41, v249, s82, v41
    v_dot2_f32_bf16 v42, v250, s82, v42
    v_dot2_f32_bf16 v43, v251, s82, v43
    v_dot2_f32_bf16 v40, v252, s83, v40
    v_dot2_f32_bf16 v41, v253, s83, v41
    v_dot2_f32_bf16 v42, v254, s83, v42
    v_dot2_f32_bf16 v43, v255, s83, v43
    s_bitcmp1_b32 s100, 1
    s_cbranch_scc1 L_loc_37
    s_nop 0
    buffer_store_dwordx4 v[40:43], v17, s[40:43], s85 offen sc1
    s_branch L_pubd_38
L_loc_37:
    s_nop 0
    buffer_store_dwordx4 v[40:43], v17, s[40:43], s85 offen
L_pubd_38:
    s_cmp_eq_u32 s62, 0
    s_cbranch_scc0 L_hby
    s_mov_b32 s88, 0
L_poll_39:
    buffer_load_dwordx4 v[136:139], v18, s[40:43], s86 offen sc1
    buffer_load_dwordx4 v[140:143], v18, s[40:43], s69 offen sc1
    buffer_load_dwordx4 v[144:147], v18, s[40:43], s70 offen sc1
    buffer_load_dwordx4 v[148:151], v18, s[40:43], s71 offen sc1
    s_waitcnt vmcnt(0)
    v_max3_u32 v4, v136, v140, v144
    v_max_u32 v4, v4, v148
    v_cmp_eq_u32_e64 vcc, -1, v4
    s_nop 0
    s_cbranch_vccz L_ok_40
    s_add_u32 s88, s88, 1
    s_cmp_lt_u32 s88, 65536
    s_cbranch_scc1 L_poll_39
L_ok_40:
    v_pk_add_f32 v[48:49], v[136:137], v[144:145]
    v_pk_add_f32 v[50:51], v[138:139], v[146:147]
    v_pk_add_f32 v[52:53], v[140:141], v[148:149]
    v_pk_add_f32 v[54:55], v[142:143], v[150:151]
    v_pk_add_f32 v[48:49], v[48:49], v[52:53]
    v_pk_add_f32 v[50:51], v[50:51], v[54:55]
    s_nop 0
    v_permlane32_swap_b32 v48, v49
    v_permlane32_swap_b32 v50, v51
    v_add_f32 v48, v48, v49
    v_add_f32 v50, v50, v51
    s_nop 1
    v_permlane16_swap_b32 v48, v50
    v_add_f32 v48, v48, v50
    s_nop 1
    v_add_f32_dpp v48, v48, v48 row_ror:8 row_mask:0xf bank_mask:0xf
    buffer_store_dword v48, v19, s[40:43], s99 offen offset:512 sc1
L_hby:
    s_barrier
    s_branch L_hfin
L_final:
    s_barrier
    s_cmp_eq_u32 s62, 1
    s_cbranch_scc0 L_noep_41
    s_cmp_eq_u32 s87, 0
    s_cbranch_scc0 L_noep_41
    v_mov_b32 v4, 13631488
    s_mov_b64 exec, 1
    buffer_store_dwordx2 v[88:89], v4, s[40:43], 0 offen sc1
    s_mov_b64 exec, -1
L_noep_41:
    s_cmp_eq_u32 s62, 0
    s_cbranch_scc0 L_hfin
    v_mov_b32 v8, s93
    v_cvt_pk_bf16_f32 v8, v8, v8
    v_and_b32_e64 v8, s90, v8
    v_mul_f32 v8, 0xbfb8aa3b, v8
    v_exp_f32 v8, v8
    s_nop 0
    v_add_f32 v8, 1.0, v8
    v_rcp_f32_e64 v8, v8
    s_nop 0
    v_cvt_pk_bf16_f32 v8, v8, v8
    v_and_b32 v8, s90, v8
    s_lshl_b32 s76, s92, 4
    s_lshr_b32 s77, s87, 1
    s_add_u32 s76, s76, s77
    s_mul_i32 s76, s76, 9344
    s_add_u32 s76, s76, 8388608
    s_and_b32 s77, s87, 1
    s_lshl_b32 s77, s77, 5
    s_add_u32 s76, s76, s77
    v_and_b32 v10, 1, v1
    v_lshlrev_b32_e64 v10, 6, v10
    v_bfe_u32 v4, v1, 1, 2
    v_lshl_add_u32 v10, v4, 3, v10
    v_bfe_u32 v4, v1, 4, 1
    v_lshl_add_u32 v10, v4, 2, v10
    v_lshrrev_b32_e64 v4, 3, v1
    v_mul_u32_u24 v6, 299008, v4
    v_and_b32_e64 v5, 7, v1
    v_lshl_add_u32 v6, v5, 4, v6
    v_mov_b32 v7, 2146435072
    v_cmp_gt_u32 vcc, 56, v1
    s_nop 1
    v_cndmask_b32_e64 v6, v7, v6, vcc
    s_mul_i32 s79, s87, 9344
    s_add_u32 s79, s79, 8388608
    s_lshl_b32 s80, s91, 11
    s_lshl_b32 s77, s87, 6
    s_add_u32 s80, s80, s77
    s_sleep 16
    s_mov_b32 s88, 0
L_spin_42:
    buffer_load_dword v64, v10, s[40:43], s76 offen offset:0 sc1
    buffer_load_dword v65, v10, s[40:43], s76 offen offset:128 sc1
    s_waitcnt vmcnt(0)
    v_max_u32 v4, v64, v65
    v_cmp_eq_u32_e64 vcc, -1, v4
    s_nop 0
    s_cbranch_vccz L_ok_43
    s_add_u32 s88, s88, 1
    s_cmp_lt_u32 s88, 65536
    s_cbranch_scc1 L_spin_42
L_ok_43:
    v_lshlrev_b32 v4, 4, v3
    v_lshrrev_b32 v64, v4, v64
    v_lshrrev_b32 v65, v4, v65
    v_lshlrev_b32 v64, 16, v64
    v_lshlrev_b32 v65, 16, v65
    v_lshrrev_b32 v9, 1, v19
    s_mov_b32 s88, 0
    buffer_load_dwordx4 v[128:131], v6, s[40:43], s79 offen offset:512 sc1
    s_sleep 3
    buffer_load_dwordx4 v[128:131], v6, s[40:43], s79 offen offset:512 sc1
    s_sleep 3
L_poll_44:
    buffer_load_dwordx4 v[128:131], v6, s[40:43], s79 offen offset:512 sc1
    s_waitcnt vmcnt(2)
    v_max3_u32 v4, v128, v129, v130
    v_max_u32 v4, v4, v131
    v_cmp_eq_u32 vcc, -1, v4
    s_nop 0
    s_cbranch_vccz L_ok_45
    s_add_u32 s88, s88, 1
    s_cmp_lt_u32 s88, 65536
    s_cbranch_scc1 L_poll_44
L_ok_45:
    v_mov_b32 v48, v128
    v_mov_b32 v49, v129
    v_mov_b32 v50, v130
    v_mov_b32 v51, v131
    v_permlane32_swap_b32 v48, v49
    s_nop 0
    v_permlane32_swap_b32 v50, v51
    v_add_f32 v48, v48, v49
    v_add_f32 v50, v50, v51
    s_nop 1
    v_permlane16_swap_b32 v48, v50
    v_add_f32 v48, v48, v50
    s_nop 1
    v_add_f32_dpp v48, v48, v48 row_ror:8 row_mask:0xf bank_mask:0xf
    v_cvt_pk_bf16_f32 v48, v48, v48
    v_and_b32 v48, s90, v48
    v_mul_f32 v48, v48, v8
    v_cvt_pk_bf16_f32 v48, v48, v48
    v_and_b32 v48, s90, v48
    v_add_f32 v48, v48, v64
    v_cvt_pk_bf16_f32 v48, v48, v48
    v_and_b32 v48, s90, v48
    v_add_f32 v48, v48, v65
    v_cvt_pk_bf16_f32 v48, v48, v48
    s_mov_b32 exec_lo, 0x00ff00ff
    s_mov_b32 exec_hi, 0x00ff00ff
    buffer_store_short v48, v9, s[44:47], s80 offen sc1
    s_mov_b64 exec, -1
L_hfin:
    s_endpgm
L_event:
    s_cmp_eq_u32 s77, 3
    s_cbranch_scc0 L_ev1
    buffer_load_dwordx4 v[92:95], v90, s[40:43], 0 offen sc1
    s_mov_b64 exec, 3
    global_load_dword v27, v91, s[66:67]
    s_mov_b64 exec, -1
    s_branch L_evret
L_ev1:
    s_cmp_eq_u32 s77, 4
    s_cbranch_scc0 L_ev_46
    s_and_b32 s72, s84, 15
    s_mov_b32 m0, s70
    s_lshl_b32 s71, s72, 7
    buffer_load_dwordx4 v16, s[28:31], s71 offen offset:0 lds
    s_mul_i32 s72, s72, 393216
    s_lshr_b64 s[84:85], s[84:85], 4
    buffer_load_dwordx4 v17, s[28:31], s71 offen offset:1024 lds
    buffer_load_dwordx4 v18, s[28:31], s71 offen offset:2048 lds
    buffer_load_dwordx4 v19, s[28:31], s71 offen offset:3072 lds
    s_add_u32 m0, s70, 4096
    s_nop 0
    buffer_load_dwordx4 v20, s[32:35], s72 offen offset:0 lds
    buffer_load_dwordx4 v21, s[32:35], s72 offen offset:1024 lds
    buffer_load_dwordx4 v22, s[32:35], s72 offen offset:2048 lds
    buffer_load_dwordx4 v23, s[32:35], s72 offen offset:3072 lds
    s_add_u32 m0, s70, 8192
    s_nop 0
    buffer_load_dwordx4 v24, s[32:35], s72 offen offset:0 lds
    buffer_load_dwordx4 v25, s[32:35], s72 offen offset:1024 lds
    s_add_u32 s70, s70, 40960
    s_cmp_ge_u32 s70, 122880
    s_cselect_b32 s76, 122880, 0
    s_sub_u32 s70, s70, s76
    buffer_load_dwordx4 v[96:99], v76, s[48:51], s75 offen nt
    s_add_u32 s75, s75, 7168
    buffer_load_dwordx4 v[100:103], v76, s[48:51], s75 offen nt
    s_add_u32 s75, s75, 7168
    buffer_load_dwordx4 v[104:107], v76, s[48:51], s75 offen nt
    s_add_u32 s75, s75, 7168
    buffer_load_dwordx4 v[108:111], v76, s[48:51], s75 offen nt
    s_add_u32 s75, s75, 7168
    buffer_load_dwordx4 v[128:131], v76, s[48:51], s75 offen nt
    s_add_u32 s75, s75, 7168
    buffer_load_dwordx4 v[132:135], v76, s[48:51], s75 offen nt
    s_add_u32 s75, s75, 7168
    buffer_load_dwordx4 v[136:139], v76, s[48:51], s75 offen nt
    s_add_u32 s75, s75, 7168
    buffer_load_dwordx4 v[140:143], v76, s[48:51], s75 offen nt
    s_add_u32 s75, s75, 7168
    s_waitcnt vmcnt(18)
    s_branch L_hbar
L_ev_46:
    s_cmp_eq_u32 s77, 5
    s_cbranch_scc0 L_ev_47
    s_and_b32 s72, s84, 15
    s_mov_b32 m0, s70
    s_lshl_b32 s71, s72, 7
    buffer_load_dwordx4 v16, s[28:31], s71 offen offset:0 lds
    s_mul_i32 s72, s72, 393216
    s_lshr_b64 s[84:85], s[84:85], 4
    buffer_load_dwordx4 v17, s[28:31], s71 offen offset:1024 lds
    buffer_load_dwordx4 v18, s[28:31], s71 offen offset:2048 lds
    buffer_load_dwordx4 v19, s[28:31], s71 offen offset:3072 lds
    s_add_u32 m0, s70, 4096
    s_nop 0
    buffer_load_dwordx4 v20, s[32:35], s72 offen offset:0 lds
    buffer_load_dwordx4 v21, s[32:35], s72 offen offset:1024 lds
    buffer_load_dwordx4 v22, s[32:35], s72 offen offset:2048 lds
    buffer_load_dwordx4 v23, s[32:35], s72 offen offset:3072 lds
    s_add_u32 m0, s70, 8192
    s_nop 0
    buffer_load_dwordx4 v24, s[32:35], s72 offen offset:0 lds
    buffer_load_dwordx4 v25, s[32:35], s72 offen offset:1024 lds
    s_add_u32 s70, s70, 40960
    s_cmp_ge_u32 s70, 122880
    s_cselect_b32 s76, 122880, 0
    s_sub_u32 s70, s70, s76
    s_lshr_b32 s78, s2, 3
    s_lshl2_add_u32 s78, s78, s62
    s_lshl_b32 s78, s78, 14
    v_lshlrev_b32_e64 v11, 10, v1
    s_mov_b64 exec, 65535
    buffer_load_dword v27, v11, s[36:39], s78 offen offset:384
    s_mov_b64 exec, -1
    s_lshl_b32 s78, s62, 9
    v_lshl_add_u32 v11, v1, 7, s78
    s_mov_b64 exec, 15
    global_load_dword v27, v11, s[14:15]
    s_mov_b64 exec, -1
    buffer_load_dwordx4 v[112:115], v76, s[48:51], s75 offen nt
    s_add_u32 s75, s75, 7168
    buffer_load_dwordx4 v[116:119], v76, s[48:51], s75 offen nt
    s_add_u32 s75, s75, 7168
    buffer_load_dwordx4 v[120:123], v76, s[48:51], s75 offen nt
    s_add_u32 s75, s75, 7168
    buffer_load_dwordx4 v[124:127], v76, s[48:51], s75 offen nt
    s_add_u32 s75, s75, 7168
    buffer_load_dwordx4 v[144:147], v76, s[48:51], s75 offen nt
    s_add_u32 s75, s75, 7168
    buffer_load_dwordx4 v[148:151], v76, s[48:51], s75 offen nt
    s_add_u32 s75, s75, 7168
    s_waitcnt vmcnt(18)
    s_branch L_hbar
L_ev_47:
    s_add_u32 s78, s70, 40960
    s_cmp_ge_u32 s78, 122880
    s_cselect_b32 s76, 122880, 0
    s_sub_u32 s78, s78, s76
    s_cmp_eq_u32 s77, 2
    s_cbranch_scc1 L_evw
    v_add_u32 v4, s78, v72
    v_xor_b32 v5, 32, v4
    v_xor_b32 v6, 64, v4
    v_xor_b32 v7, 96, v4
    s_and_b32 s72, s84, 15
    s_mov_b32 m0, s70
    s_lshl_b32 s71, s72, 7
    buffer_load_dwordx4 v16, s[28:31], s71 offen offset:0 lds
    s_mul_i32 s72, s72, 393216
    s_lshr_b64 s[84:85], s[84:85], 4
    ds_read_b128 v[32:35], v4
    ds_read_b128 v[36:39], v5
    ds_read_b128 v[40:43], v6
    ds_read_b128 v[44:47], v7
    buffer_load_dwordx4 v17, s[28:31], s71 offen offset:1024 lds
    s_lshl_b32 s79, s62, 8
    s_add_u32 s79, s79, s73
    s_waitcnt lgkmcnt(0)
    v_lshlrev_b32 v80, 16, v32
    v_and_b32 v82, s90, v32
    v_mul_f32 v81, v80, v80
    v_mul_f32 v83, v82, v82
    v_lshlrev_b32 v10, 16, v33
    v_and_b32 v11, s90, v33
    v_add_f32 v80, v80, v10
    v_add_f32 v82, v82, v11
    v_fmac_f32 v81, v10, v10
    v_fmac_f32 v83, v11, v11
    v_lshlrev_b32 v8, 16, v34
    v_and_b32_e64 v9, s90, v34
    buffer_load_dwordx4 v18, s[28:31], s71 offen offset:2048 lds
    v_add_f32 v80, v80, v8
    v_add_f32 v82, v82, v9
    v_fmac_f32 v81, v8, v8
    v_fmac_f32 v83, v9, v9
    v_lshlrev_b32 v10, 16, v35
    v_and_b32 v11, s90, v35
    v_add_f32 v80, v80, v10
    v_add_f32 v82, v82, v11
    v_fmac_f32 v81, v10, v10
    v_fmac_f32 v83, v11, v11
    v_lshlrev_b32 v8, 16, v36
    v_and_b32 v9, s90, v36
    buffer_load_dwordx4 v19, s[28:31], s71 offen offset:3072 lds
    v_add_f32 v80, v80, v8
    v_add_f32 v82, v82, v9
    v_fmac_f32 v81, v8, v8
    v_fmac_f32 v83, v9, v9
    v_lshlrev_b32 v10, 16, v37
    v_and_b32 v11, s90, v37
    v_add_f32 v80, v80, v10
    v_add_f32 v82, v82, v11
    v_fmac_f32 v81, v10, v10
    v_fmac_f32 v83, v11, v11
    v_lshlrev_b32 v8, 16, v38
    v_and_b32 v9, s90, v38
    s_add_u32 m0, s70, 4096
    s_nop 0
    buffer_load_dwordx4 v20, s[32:35], s72 offen offset:0 lds
    v_add_f32 v80, v80, v8
    v_add_f32 v82, v82, v9
    v_fmac_f32 v81, v8, v8
    v_fmac_f32 v83, v9, v9
    v_lshlrev_b32 v10, 16, v39
    v_and_b32 v11, s90, v39
    v_add_f32 v80, v80, v10
    v_add_f32 v82, v82, v11
    v_fmac_f32 v81, v10, v10
    v_fmac_f32 v83, v11, v11
    v_lshlrev_b32 v8, 16, v40
    v_and_b32_e64 v9, s90, v40
    buffer_load_dwordx4 v21, s[32:35], s72 offen offset:1024 lds
    v_add_f32 v80, v80, v8
    v_add_f32 v82, v82, v9
    v_fmac_f32 v81, v8, v8
    v_fmac_f32 v83, v9, v9
    v_lshlrev_b32 v10, 16, v41
    v_and_b32 v11, s90, v41
    v_add_f32 v80, v80, v10
    v_add_f32 v82, v82, v11
    v_fmac_f32 v81, v10, v10
    v_fmac_f32 v83, v11, v11
    v_lshlrev_b32 v8, 16, v42
    v_and_b32 v9, s90, v42
    buffer_load_dwordx4 v22, s[32:35], s72 offen offset:2048 lds
    v_add_f32 v80, v80, v8
    v_add_f32 v82, v82, v9
    v_fmac_f32 v81, v8, v8
    v_fmac_f32 v83, v9, v9
    v_lshlrev_b32 v10, 16, v43
    v_and_b32 v11, s90, v43
    v_add_f32 v80, v80, v10
    v_add_f32 v82, v82, v11
    v_fmac_f32 v81, v10, v10
    v_fmac_f32 v83, v11, v11
    v_lshlrev_b32 v8, 16, v44
    v_and_b32 v9, s90, v44
    buffer_load_dwordx4 v23, s[32:35], s72 offen offset:3072 lds
    v_add_f32 v80, v80, v8
    v_add_f32 v82, v82, v9
    v_fmac_f32 v81, v8, v8
    v_fmac_f32 v83, v9, v9
    v_lshlrev_b32 v10, 16, v45
    v_and_b32 v11, s90, v45
    v_add_f32 v80, v80, v10
    v_add_f32 v82, v82, v11
    v_fmac_f32 v81, v10, v10
    v_fmac_f32 v83, v11, v11
    v_lshlrev_b32 v8, 16, v46
    v_and_b32 v9, s90, v46
    s_add_u32 m0, s70, 8192
    s_nop 0
    buffer_load_dwordx4 v24, s[32:35], s72 offen offset:0 lds
    v_add_f32 v80, v80, v8
    v_add_f32 v82, v82, v9
    v_fmac_f32 v81, v8, v8
    v_fmac_f32 v83, v9, v9
    v_lshlrev_b32 v10, 16, v47
    v_and_b32 v11, s90, v47
    v_add_f32 v80, v80, v10
    v_add_f32 v82, v82, v11
    v_fmac_f32 v81, v10, v10
    v_fmac_f32_e64 v83, v11, v11
    buffer_load_dwordx4 v25, s[32:35], s72 offen offset:1024 lds
    s_add_u32 s70, s70, 40960
    s_cmp_ge_u32 s70, 122880
    s_cselect_b32 s76, 122880, 0
    s_sub_u32 s70, s70, s76
    v_add_f32 v80, v80, v82
    v_add_f32 v81, v81, v83
    v_mov_b32 v82, v80
    v_mov_b32 v83, v81
    s_nop 0
    v_permlane32_swap_b32 v80, v82
    v_permlane32_swap_b32 v81, v83
    v_add_f32 v80, v80, v82
    v_add_f32_e64 v81, v81, v83
    s_mov_b32 exec_hi, 0
    buffer_store_dwordx2 v[80:81], v74, s[40:43], s79 offen offset:0 sc1
    s_mov_b64 exec, -1
    s_waitcnt vmcnt(11)
    s_branch L_hbar
L_evw:
    s_mul_i32 s79, s63, 2048
    s_add_u32 s79, s79, s78
    v_add_u32_e64 v4, s79, v73
    s_mul_i32 s79, s63, 20480
    s_add_u32 s79, s79, s78
    v_add_u32_e64 v5, s79, v73
    s_and_b32 s72, s84, 15
    s_mov_b32 m0, s70
    s_lshl_b32 s71, s72, 7
    buffer_load_dwordx4 v16, s[28:31], s71 offen offset:0 lds
    s_mul_i32 s72, s72, 393216
    s_lshr_b64 s[84:85], s[84:85], 4
    ds_read_b64_tr_b16 v[32:33], v4 offset:0
    ds_read_b64_tr_b16 v[34:35], v4 offset:512
    ds_read_b64_tr_b16 v[36:37], v4 offset:10240
    ds_read_b64_tr_b16 v[38:39], v4 offset:10752
    ds_read_b64_tr_b16 v[40:41], v4 offset:20480
    ds_read_b64_tr_b16 v[42:43], v4 offset:20992
    ds_read_b64_tr_b16 v[44:45], v4 offset:30720
    ds_read_b64_tr_b16 v[46:47], v4 offset:31232
    ds_read_b64_tr_b16 v[48:49], v5 offset:4096
    ds_read_b64_tr_b16 v[50:51], v5 offset:4608
    ds_read_b64_tr_b16 v[52:53], v5 offset:14336
    ds_read_b64_tr_b16 v[54:55], v5 offset:14848
    buffer_load_dwordx4 v17, s[28:31], s71 offen offset:1024 lds
    s_lshl_b32 s79, s64, 9
    s_lshl_b32 s80, s63, 3
    s_add_u32 s79, s79, s80
    s_add_u32 s79, s79, s73
    s_waitcnt lgkmcnt(0)
    v_lshlrev_b32 v80, 16, v32
    v_and_b32 v82, s90, v32
    v_lshlrev_b32 v10, 16, v33
    v_and_b32 v11, s90, v33
    v_add_f32 v80, v80, v10
    v_add_f32 v82, v82, v11
    v_lshlrev_b32 v8, 16, v34
    v_and_b32 v9, s90, v34
    v_add_f32 v80, v80, v8
    v_add_f32 v82, v82, v9
    v_lshlrev_b32 v10, 16, v35
    v_and_b32 v11, s90, v35
    buffer_load_dwordx4 v18, s[28:31], s71 offen offset:2048 lds
    v_add_f32 v80, v80, v10
    v_add_f32 v82, v82, v11
    v_lshlrev_b32 v8, 16, v36
    v_and_b32 v9, s90, v36
    v_add_f32 v80, v80, v8
    v_add_f32 v82, v82, v9
    v_lshlrev_b32 v10, 16, v37
    v_and_b32 v11, s90, v37
    v_add_f32 v80, v80, v10
    v_add_f32 v82, v82, v11
    v_lshlrev_b32 v8, 16, v38
    v_and_b32 v9, s90, v38
    buffer_load_dwordx4 v19, s[28:31], s71 offen offset:3072 lds
    v_add_f32 v80, v80, v8
    v_add_f32 v82, v82, v9
    v_lshlrev_b32 v10, 16, v39
    v_and_b32 v11, s90, v39
    v_add_f32 v80, v80, v10
    v_add_f32 v82, v82, v11
    v_lshlrev_b32 v8, 16, v40
    v_and_b32 v9, s90, v40
    v_add_f32 v80, v80, v8
    v_add_f32 v82, v82, v9
    v_lshlrev_b32 v10, 16, v41
    v_and_b32 v11, s90, v41
    s_add_u32 m0, s70, 4096
    s_nop 0
    buffer_load_dwordx4 v20, s[32:35], s72 offen offset:0 lds
    v_add_f32 v80, v80, v10
    v_add_f32 v82, v82, v11
    v_lshlrev_b32 v8, 16, v42
    v_and_b32 v9, s90, v42
    v_add_f32 v80, v80, v8
    v_add_f32 v82, v82, v9
    v_lshlrev_b32 v10, 16, v43
    v_and_b32 v11, s90, v43
    v_add_f32 v80, v80, v10
    v_add_f32 v82, v82, v11
    v_lshlrev_b32 v8, 16, v44
    v_and_b32_e64 v9, s90, v44
    buffer_load_dwordx4 v21, s[32:35], s72 offen offset:1024 lds
    v_add_f32 v80, v80, v8
    v_add_f32 v82, v82, v9
    v_lshlrev_b32 v10, 16, v45
    v_and_b32 v11, s90, v45
    v_add_f32 v80, v80, v10
    v_add_f32 v82, v82, v11
    v_lshlrev_b32 v8, 16, v46
    v_and_b32 v9, s90, v46
    v_add_f32 v80, v80, v8
    v_add_f32 v82, v82, v9
    v_lshlrev_b32 v10, 16, v47
    v_and_b32 v11, s90, v47
    buffer_load_dwordx4 v22, s[32:35], s72 offen offset:2048 lds
    v_add_f32 v80, v80, v10
    v_add_f32 v82, v82, v11
    v_lshlrev_b32 v81, 16, v48
    v_and_b32 v83, s90, v48
    v_lshlrev_b32 v10, 16, v49
    v_and_b32 v11, s90, v49
    v_add_f32 v81, v81, v10
    v_add_f32 v83, v83, v11
    v_lshlrev_b32 v8, 16, v50
    v_and_b32 v9, s90, v50
    v_add_f32 v81, v81, v8
    v_add_f32 v83, v83, v9
    buffer_load_dwordx4 v23, s[32:35], s72 offen offset:3072 lds
    v_lshlrev_b32 v10, 16, v51
    v_and_b32 v11, s90, v51
    v_add_f32 v81, v81, v10
    v_add_f32 v83, v83, v11
    v_lshlrev_b32 v8, 16, v52
    v_and_b32 v9, s90, v52
    v_add_f32 v81, v81, v8
    v_add_f32 v83, v83, v9
    v_lshlrev_b32 v10, 16, v53
    v_and_b32 v11, s90, v53
    v_add_f32 v81, v81, v10
    v_add_f32 v83, v83, v11
    s_add_u32 m0, s70, 8192
    s_nop 0
    buffer_load_dwordx4 v24, s[32:35], s72 offen offset:0 lds
    v_lshlrev_b32 v8, 16, v54
    v_and_b32 v9, s90, v54
    v_add_f32 v81, v81, v8
    v_add_f32 v83, v83, v9
    v_lshlrev_b32 v10, 16, v55
    v_and_b32 v11, s90, v55
    v_add_f32 v81, v81, v10
    v_add_f32_e64 v83, v83, v11
    buffer_load_dwordx4 v25, s[32:35], s72 offen offset:1024 lds
    s_add_u32 s70, s70, 40960
    s_cmp_ge_u32 s70, 122880
    s_cselect_b32 s76, 122880, 0
    s_sub_u32 s70, s70, s76
    v_add_f32 v80, v80, v82
    v_add_f32 v81, v81, v83
    v_mov_b32 v82, v80
    v_mov_b32 v83, v81
    s_nop 0
    v_permlane32_swap_b32 v80, v82
    v_permlane32_swap_b32 v81, v83
    v_add_f32 v80, v80, v82
    v_add_f32_e64 v81, v81, v83
    s_mov_b32 exec_hi, 0
    buffer_store_dwordx2 v[80:81], v12, s[40:43], s79 offen offset:1024 sc1
    s_mov_b64 exec, -1
    s_waitcnt vmcnt(11)
    s_branch L_hbar
L_compute:
    s_setprio 2
    s_and_b32 s63, s62, 1
    s_lshr_b32 s64, s62, 1
    s_lshl_b32 s73, s60, 4
    s_add_u32 s73, s73, s61
    s_mul_i32 s73, s73, 28800
    s_add_u32 s76, s2, 7
    s_and_b32 s76, s76, 7
    s_bfe_u32 s77, s2, 0x10003
    s_lshl1_add_u32 s97, s76, s77
    s_lshr_b32 s98, s2, 4
    s_lshl_b32 s99, s97, 4
    s_add_u32 s99, s99, s98
    s_mul_i32 s99, s99, 9344
    s_add_u32 s99, s99, 8388608
    s_lshr_b32 s65, s97, 1
    s_lshl_b32 s76, s97, 3
    s_add_u32 s65, s65, s76
    s_mul_i32 s76, s98, 1
    s_add_u32 s65, s65, s76
    s_and_b32 s65, s65, 15
    s_mov_b32 s89, 0x3f803f80
    s_mov_b32 s90, 0xffff0000
    v_and_b32 v2, 31, v1
    v_lshrrev_b32 v3, 5, v1
    v_lshlrev_b32 v12, 4, v1
    v_lshrrev_b32 v4, 3, v1
    v_mul_u32_u24 v13, 460800, v4
    v_and_b32_e64 v4, 7, v1
    v_lshl_add_u32 v13, v4, 4, v13
    v_and_b32 v10, 15, v1
    v_lshrrev_b32 v11, 4, v1
    s_mul_i32 s76, s63, 20480
    v_lshrrev_b32 v4, 1, v10
    v_xor_b32 v4, v4, v11
    v_lshlrev_b32_e64 v4, 4, v4
    v_lshl_add_u32 v4, v10, 7, v4
    v_add_u32 v192, s76, v4
    v_xor_b32 v193, 64, v192
    v_bfe_u32 v4, v1, 2, 2
    v_and_b32_e64 v6, 1, v11
    v_lshl_add_u32 v5, v6, 3, v4
    v_lshlrev_b32 v5, 7, v5
    v_lshrrev_b32 v4, 1, v4
    v_xor_b32_e64 v4, s64, v4
    v_lshl_add_u32 v5, v4, 6, v5
    v_lshl_add_u32 v5, v6, 5, v5
    v_and_b32_e64 v4, 3, v1
    v_lshl_add_u32 v5, v4, 3, v5
    v_mul_u32_u24 v4, 10240, v3
    v_add_u32_e64 v5, v5, v4
    v_add_u32 v194, 4096, v5
    v_xor_b32_e64 v195, 32, v194
    v_add_u32 v196, 40960, v192
    v_add_u32 v197, 40960, v193
    v_add_u32 v198, 40960, v194
    v_add_u32 v199, 40960, v195
    v_add_u32 v200, 81920, v192
    v_add_u32 v201, 81920, v193
    v_add_u32 v202, 81920, v194
    v_add_u32 v203, 81920, v195
    v_bfe_u32 v4, v1, 2, 2
    v_lshl_add_u32 v4, v3, 3, v4
    v_lshlrev_b32 v4, 6, v4
    v_and_b32 v5, 1, v11
    v_lshl_add_u32 v4, v5, 5, v4
    v_and_b32_e64 v5, 3, v1
    v_lshl_add_u32 v4, v5, 3, v4
    s_lshl_b32 s76, s64, 11
    s_add_u32 s76, s76, 122880
    v_add_u32_e64 v212, s76, v4
    s_lshl_b32 s76, s63, 9
    v_lshl_add_u32 v213, v10, 3, s76
    v_lshl_add_u32 v214, v2, 3, s76
    s_lshl_b32 s76, s64, 8
    v_lshl_add_u32 v215, v10, 3, s76
    v_bfe_u32 v4, v10, 1, 1
    v_xor_b32 v4, s64, v4
    v_lshrrev_b32 v5, 2, v10
    v_xor_b32 v5, v5, v3
    v_xor_b32 v6, v10, v11
    v_and_b32 v6, 1, v6
    v_lshlrev_b32_e64 v4, 6, v4
    v_lshl_add_u32 v4, v5, 4, v4
    v_lshl_add_u32 v4, v6, 3, v4
    v_lshl_add_u32 v4, v10, 7, v4
    s_lshl_b32 s76, s63, 13
    v_add_u32 v216, s76, v4
    v_bfe_u32 v4, v2, 1, 1
    v_bfe_u32 v5, v2, 2, 2
    v_and_b32 v6, 1, v2
    v_xor_b32 v6, v6, v3
    v_lshlrev_b32_e64 v4, 6, v4
    v_lshl_add_u32 v4, v5, 4, v4
    v_lshl_add_u32 v4, v6, 3, v4
    v_lshl_add_u32 v4, v2, 7, v4
    s_lshl_b32 s77, s64, 14
    s_add_u32 s76, s76, s77
    v_add_u32_e64 v217, s76, v4
    v_bfe_u32 v4, v1, 2, 2
    v_lshl_add_u32 v5, v3, 3, v4
    v_lshlrev_b32 v5, 7, v5
    v_lshrrev_b32 v6, 1, v4
    v_lshl_add_u32 v5, v6, 6, v5
    v_bfe_u32 v6, v1, 4, 1
    v_xor_b32_e64 v6, v6, v3
    v_lshl_add_u32 v5, v6, 5, v5
    v_bfe_u32 v6, v1, 1, 1
    v_lshl_add_u32 v5, v6, 4, v5
    v_xor_b32 v6, v1, v4
    v_and_b32 v6, 1, v6
    v_lshl_add_u32 v5, v6, 3, v5
    s_lshl_b32 s76, s63, 6
    s_or_b32 s76, s76, s77
    v_xor_b32 v218, s76, v5
    s_lshl_b32 s76, s64, 6
    v_xor_b32_e64 v220, s76, v5
    v_xor_b32 v219, 528, v218
    v_xor_b32 v221, 528, v220
    v_cmp_gt_u32 s[86:87], 16, v1
    s_waitcnt lgkmcnt(0)
    s_mov_b32 s40, s26
    s_and_b32 s41, s27, 0xffff
    s_mov_b32 s42, 33554432
    s_mov_b32 s43, 0x20000
    s_mov_b32 s44, s22
    s_and_b32 s45, s23, 0xffff
    s_mov_b32 s46, 4194304
    s_mov_b32 s47, 0x20000
    s_mov_b32 s68, 0
    s_getreg_b32 s101, hwreg(HW_REG_XCC_ID, 0, 4)
    v_mov_b32 v9, 13631488
    s_lshl_b32 s76, s61, 8
    s_lshl4_add_u32 s76, s60, s76
    s_add_u32 s76, s76, 12582912
    v_mov_b32 v8, s76
    s_lshl_b32 s76, s60, 8
    s_lshl4_add_u32 s76, s61, s76
    s_add_u32 s76, s76, 12587008
    v_writelane_b32 v8, s76, 1
    s_lshl_b32 s76, s97, 8
    s_lshl4_add_u32 s76, s98, s76
    s_add_u32 s76, s76, 12591104
    v_writelane_b32 v8, s76, 2
    v_mov_b32 v6, s101
    v_mov_b32 v7, 0
    v_mov_b32_e64 v10, 0
    s_cmp_eq_u32 s62, 0
    s_cbranch_scc0 L_noep
    buffer_load_dwordx2 v[4:5], v9, s[40:43], 0 offen
L_noep:
    s_barrier
    ds_read_b128 v[112:115], v192 offset:0
    ds_read_b64_tr_b16 v[128:129], v194 offset:0
    ds_read_b64_tr_b16 v[130:131], v194 offset:512
    ds_read_b128 v[116:119], v192 offset:2048
    ds_read_b128 v[120:123], v192 offset:10240
    ds_read_b128 v[124:127], v192 offset:12288
    ds_read_b64_tr_b16 v[132:133], v195 offset:0
    ds_read_b64_tr_b16 v[134:135], v195 offset:512
    ds_read_b64_tr_b16 v[136:137], v194 offset:2048
    ds_read_b64_tr_b16 v[138:139], v194 offset:2560
    ds_read_b64_tr_b16 v[140:141], v195 offset:2048
    ds_read_b64_tr_b16 v[142:143], v195 offset:2560
    ds_read_b64_tr_b16 v[144:145], v194 offset:4096
    ds_read_b64_tr_b16 v[146:147], v194 offset:4608
    s_waitcnt lgkmcnt(8)
    ds_read_b64_tr_b16 v[148:149], v195 offset:4096
    ds_read_b64_tr_b16 v[150:151], v195 offset:4608
    v_mfma_f32_16x16x32_bf16 v[16:19], v[128:131], v[112:115], 0
    ds_read_b128 v[152:155], v193 offset:0
    v_mfma_f32_16x16x32_bf16 v[20:23], v[128:131], v[116:119], 0
    ds_read_b64_tr_b16 v[168:169], v194 offset:20480
    v_mfma_f32_16x16x32_bf16 v[24:27], v[128:131], v[120:123], 0
    ds_read_b64_tr_b16 v[170:171], v194 offset:20992
    v_mfma_f32_16x16x32_bf16 v[28:31], v[128:131], v[124:127], 0
    ds_read_b128 v[156:159], v193 offset:2048
    s_waitcnt lgkmcnt(4)
    v_mfma_f32_16x16x32_bf16 v[32:35], v[132:135], v[112:115], 0
    ds_read_b128 v[160:163], v193 offset:10240
    v_mfma_f32_16x16x32_bf16 v[36:39], v[132:135], v[116:119], 0
    ds_read_b128 v[164:167], v193 offset:12288
    v_mfma_f32_16x16x32_bf16 v[40:43], v[132:135], v[120:123], 0
    ds_read_b64_tr_b16 v[172:173], v195 offset:20480
    v_mfma_f32_16x16x32_bf16 v[44:47], v[132:135], v[124:127], 0
    ds_read_b64_tr_b16 v[174:175], v195 offset:20992
    v_mfma_f32_16x16x32_bf16 v[48:51], v[136:139], v[112:115], 0
    ds_read_b64_tr_b16 v[176:177], v194 offset:22528
    v_mfma_f32_16x16x32_bf16 v[52:55], v[136:139], v[116:119], 0
    ds_read_b64_tr_b16 v[178:179], v194 offset:23040
    v_mfma_f32_16x16x32_bf16 v[56:59], v[136:139], v[120:123], 0
    ds_read_b64_tr_b16 v[180:181], v195 offset:22528
    v_mfma_f32_16x16x32_bf16 v[60:63], v[136:139], v[124:127], 0
    ds_read_b64_tr_b16 v[182:183], v195 offset:23040
    v_mfma_f32_16x16x32_bf16 v[64:67], v[140:143], v[112:115], 0
    ds_read_b64_tr_b16 v[184:185], v194 offset:24576
    v_mfma_f32_16x16x32_bf16 v[68:71], v[140:143], v[116:119], 0
    ds_read_b64_tr_b16 v[186:187], v194 offset:25088
    v_mfma_f32_16x16x32_bf16 v[72:75], v[140:143], v[120:123], 0
    ds_read_b64_tr_b16 v[188:189], v195 offset:24576
    v_mfma_f32_16x16x32_bf16 v[76:79], v[140:143], v[124:127], 0
    ds_read_b64_tr_b16 v[190:191], v195 offset:25088
    v_mfma_f32_16x16x32_bf16 v[80:83], v[144:147], v[112:115], 0
    v_mfma_f32_16x16x32_bf16 v[84:87], v[144:147], v[116:119], 0
    v_mfma_f32_16x16x32_bf16 v[88:91], v[144:147], v[120:123], 0
    v_mfma_f32_16x16x32_bf16 v[92:95], v[144:147], v[124:127], 0
    v_mfma_f32_16x16x32_bf16 v[96:99], v[148:151], v[112:115], 0
    v_mfma_f32_16x16x32_bf16 v[100:103], v[148:151], v[116:119], 0
    v_mfma_f32_16x16x32_bf16 v[104:107], v[148:151], v[120:123], 0
    v_mfma_f32_16x16x32_bf16 v[108:111], v[148:151], v[124:127], 0
    s_waitcnt lgkmcnt(0)
    v_mfma_f32_16x16x32_bf16 v[16:19], v[168:171], v[152:155], v[16:19]
    s_barrier
    v_mfma_f32_16x16x32_bf16 v[20:23], v[168:171], v[156:159], v[20:23]
    ds_read_b128 v[112:115], v196 offset:0
    ds_read_b64_tr_b16 v[204:205], v212 offset:0
    ds_read_b64_tr_b16 v[206:207], v212 offset:256
    ds_read_b64_tr_b16 v[208:209], v212 offset:1024
    ds_read_b64_tr_b16 v[210:211], v212 offset:1280
    v_mfma_f32_16x16x32_bf16 v[24:27], v[168:171], v[160:163], v[24:27]
    ds_read_b64_tr_b16 v[128:129], v198 offset:0
    s_cmp_eq_u32 s62, 0
    s_cbranch_scc0 L_cloop
    s_waitcnt vmcnt(0)
    v_add_co_u32 v4, vcc, 1, v4
    s_nop 1
    v_addc_co_u32 v5, vcc, 0, v5, vcc
    s_mov_b64 exec, 7
    buffer_store_dwordx4 v[4:7], v8, s[40:43], 0 offen sc1
    s_mov_b64 exec, -1
.p2align 3
L_cloop:
    v_mfma_f32_16x16x32_bf16 v[28:31], v[168:171], v[164:167], v[28:31]
    ds_read_b64_tr_b16 v[130:131], v198 offset:512
    v_mfma_f32_16x16x32_bf16 v[32:35], v[172:175], v[152:155], v[32:35]
    ds_read_b128 v[116:119], v196 offset:2048
    v_mfma_f32_16x16x32_bf16 v[36:39], v[172:175], v[156:159], v[36:39]
    ds_read_b128 v[120:123], v196 offset:10240
    v_mfma_f32_16x16x32_bf16 v[40:43], v[172:175], v[160:163], v[40:43]
    ds_read_b128 v[124:127], v196 offset:12288
    v_mfma_f32_16x16x32_bf16 v[44:47], v[172:175], v[164:167], v[44:47]
    ds_read_b64_tr_b16 v[132:133], v199 offset:0
    v_mfma_f32_16x16x32_bf16 v[48:51], v[176:179], v[152:155], v[48:51]
    ds_read_b64_tr_b16 v[134:135], v199 offset:512
    v_mfma_f32_16x16x32_bf16 v[52:55], v[176:179], v[156:159], v[52:55]
    ds_read_b64_tr_b16 v[136:137], v198 offset:2048
    v_mfma_f32_16x16x32_bf16 v[56:59], v[176:179], v[160:163], v[56:59]
    ds_read_b64_tr_b16 v[138:139], v198 offset:2560
    v_mfma_f32_16x16x32_bf16 v[60:63], v[176:179], v[164:167], v[60:63]
    ds_read_b64_tr_b16 v[140:141], v199 offset:2048
    v_mfma_f32_16x16x32_bf16 v[64:67], v[180:183], v[152:155], v[64:67]
    ds_read_b64_tr_b16 v[142:143], v199 offset:2560
    v_mfma_f32_16x16x32_bf16 v[68:71], v[180:183], v[156:159], v[68:71]
    ds_read_b64_tr_b16 v[144:145], v198 offset:4096
    v_mfma_f32_16x16x32_bf16 v[72:75], v[180:183], v[160:163], v[72:75]
    ds_read_b64_tr_b16 v[146:147], v198 offset:4608
    v_mfma_f32_16x16x32_bf16 v[76:79], v[180:183], v[164:167], v[76:79]
    ds_read_b64_tr_b16 v[148:149], v199 offset:4096
    v_mfma_f32_16x16x32_bf16 v[80:83], v[184:187], v[152:155], v[80:83]
    ds_read_b64_tr_b16 v[150:151], v199 offset:4608
    v_mfma_f32_16x16x32_bf16 v[84:87], v[184:187], v[156:159], v[84:87]
    v_mfma_f32_16x16x32_bf16 v[88:91], v[184:187], v[160:163], v[88:91]
    v_mfma_f32_16x16x32_bf16 v[92:95], v[184:187], v[164:167], v[92:95]
    v_mfma_f32_16x16x32_bf16 v[96:99], v[188:191], v[152:155], v[96:99]
    v_mfma_f32_16x16x32_bf16 v[100:103], v[188:191], v[156:159], v[100:103]
    v_mfma_f32_16x16x32_bf16 v[104:107], v[188:191], v[160:163], v[104:107]
    v_mfma_f32_16x16x32_bf16 v[108:111], v[188:191], v[164:167], v[108:111]
    s_waitcnt lgkmcnt(0)
    v_mfma_f32_16x16x32_bf16 v[16:19], v[128:131], v[112:115], v[16:19]
    ds_read_b128 v[152:155], v197 offset:0
    v_mfma_f32_16x16x32_bf16 v[20:23], v[128:131], v[116:119], v[20:23]
    ds_read_b64_tr_b16 v[168:169], v198 offset:20480
    v_mfma_f32_16x16x32_bf16 v[24:27], v[128:131], v[120:123], v[24:27]
    ds_read_b64_tr_b16 v[170:171], v198 offset:20992
    v_mfma_f32_16x16x32_bf16 v[28:31], v[128:131], v[124:127], v[28:31]
    ds_read_b128 v[156:159], v197 offset:2048
    v_mfma_f32_16x16x32_bf16 v[32:35], v[132:135], v[112:115], v[32:35]
    ds_read_b128 v[160:163], v197 offset:10240
    v_mfma_f32_16x16x32_bf16 v[36:39], v[132:135], v[116:119], v[36:39]
    ds_read_b128 v[164:167], v197 offset:12288
    v_mfma_f32_16x16x32_bf16 v[40:43], v[132:135], v[120:123], v[40:43]
    ds_read_b64_tr_b16 v[172:173], v199 offset:20480
    v_mfma_f32_16x16x32_bf16 v[44:47], v[132:135], v[124:127], v[44:47]
    ds_read_b64_tr_b16 v[174:175], v199 offset:20992
    v_mfma_f32_16x16x32_bf16 v[48:51], v[136:139], v[112:115], v[48:51]
    ds_read_b64_tr_b16 v[176:177], v198 offset:22528
    v_mfma_f32_16x16x32_bf16 v[52:55], v[136:139], v[116:119], v[52:55]
    ds_read_b64_tr_b16 v[178:179], v198 offset:23040
    v_mfma_f32_16x16x32_bf16 v[56:59], v[136:139], v[120:123], v[56:59]
    ds_read_b64_tr_b16 v[180:181], v199 offset:22528
    v_mfma_f32_16x16x32_bf16 v[60:63], v[136:139], v[124:127], v[60:63]
    ds_read_b64_tr_b16 v[182:183], v199 offset:23040
    v_mfma_f32_16x16x32_bf16 v[64:67], v[140:143], v[112:115], v[64:67]
    ds_read_b64_tr_b16 v[184:185], v198 offset:24576
    v_mfma_f32_16x16x32_bf16 v[68:71], v[140:143], v[116:119], v[68:71]
    ds_read_b64_tr_b16 v[186:187], v198 offset:25088
    v_mfma_f32_16x16x32_bf16 v[72:75], v[140:143], v[120:123], v[72:75]
    ds_read_b64_tr_b16 v[188:189], v199 offset:24576
    v_mfma_f32_16x16x32_bf16 v[76:79], v[140:143], v[124:127], v[76:79]
    ds_read_b64_tr_b16 v[190:191], v199 offset:25088
    v_mfma_f32_16x16x32_bf16 v[80:83], v[144:147], v[112:115], v[80:83]
    v_mfma_f32_16x16x32_bf16 v[84:87], v[144:147], v[116:119], v[84:87]
    v_mfma_f32_16x16x32_bf16 v[88:91], v[144:147], v[120:123], v[88:91]
    v_mfma_f32_16x16x32_bf16 v[92:95], v[144:147], v[124:127], v[92:95]
    v_mfma_f32_16x16x32_bf16 v[96:99], v[148:151], v[112:115], v[96:99]
    v_mfma_f32_16x16x32_bf16 v[100:103], v[148:151], v[116:119], v[100:103]
    v_mfma_f32_16x16x32_bf16 v[104:107], v[148:151], v[120:123], v[104:107]
    v_mfma_f32_16x16x32_bf16 v[108:111], v[148:151], v[124:127], v[108:111]
    s_waitcnt lgkmcnt(0)
    v_mfma_f32_16x16x32_bf16 v[16:19], v[168:171], v[152:155], v[16:19]
    s_barrier
    v_mfma_f32_16x16x32_bf16 v[20:23], v[168:171], v[156:159], v[20:23]
    ds_read_b128 v[112:115], v200 offset:0
    v_mfma_f32_16x16x32_bf16 v[24:27], v[168:171], v[160:163], v[24:27]
    ds_read_b64_tr_b16 v[128:129], v202 offset:0
    v_mfma_f32_16x16x32_bf16 v[28:31], v[168:171], v[164:167], v[28:31]
    ds_read_b64_tr_b16 v[130:131], v202 offset:512
    v_mfma_f32_16x16x32_bf16 v[32:35], v[172:175], v[152:155], v[32:35]
    ds_read_b128 v[116:119], v200 offset:2048
    v_mfma_f32_16x16x32_bf16 v[36:39], v[172:175], v[156:159], v[36:39]
    ds_read_b128 v[120:123], v200 offset:10240
    v_mfma_f32_16x16x32_bf16 v[40:43], v[172:175], v[160:163], v[40:43]
    ds_read_b128 v[124:127], v200 offset:12288
    v_mfma_f32_16x16x32_bf16 v[44:47], v[172:175], v[164:167], v[44:47]
    ds_read_b64_tr_b16 v[132:133], v203 offset:0
    v_mfma_f32_16x16x32_bf16 v[48:51], v[176:179], v[152:155], v[48:51]
    ds_read_b64_tr_b16 v[134:135], v203 offset:512
    v_mfma_f32_16x16x32_bf16 v[52:55], v[176:179], v[156:159], v[52:55]
    ds_read_b64_tr_b16 v[136:137], v202 offset:2048
    v_mfma_f32_16x16x32_bf16 v[56:59], v[176:179], v[160:163], v[56:59]
    ds_read_b64_tr_b16 v[138:139], v202 offset:2560
    v_mfma_f32_16x16x32_bf16 v[60:63], v[176:179], v[164:167], v[60:63]
    ds_read_b64_tr_b16 v[140:141], v203 offset:2048
    v_mfma_f32_16x16x32_bf16 v[64:67], v[180:183], v[152:155], v[64:67]
    ds_read_b64_tr_b16 v[142:143], v203 offset:2560
    v_mfma_f32_16x16x32_bf16 v[68:71], v[180:183], v[156:159], v[68:71]
    ds_read_b64_tr_b16 v[144:145], v202 offset:4096
    v_mfma_f32_16x16x32_bf16 v[72:75], v[180:183], v[160:163], v[72:75]
    ds_read_b64_tr_b16 v[146:147], v202 offset:4608
    v_mfma_f32_16x16x32_bf16 v[76:79], v[180:183], v[164:167], v[76:79]
    ds_read_b64_tr_b16 v[148:149], v203 offset:4096
    v_mfma_f32_16x16x32_bf16 v[80:83], v[184:187], v[152:155], v[80:83]
    ds_read_b64_tr_b16 v[150:151], v203 offset:4608
    v_mfma_f32_16x16x32_bf16 v[84:87], v[184:187], v[156:159], v[84:87]
    v_mfma_f32_16x16x32_bf16 v[88:91], v[184:187], v[160:163], v[88:91]
    v_mfma_f32_16x16x32_bf16 v[92:95], v[184:187], v[164:167], v[92:95]
    v_mfma_f32_16x16x32_bf16 v[96:99], v[188:191], v[152:155], v[96:99]
    v_mfma_f32_16x16x32_bf16 v[100:103], v[188:191], v[156:159], v[100:103]
    v_mfma_f32_16x16x32_bf16 v[104:107], v[188:191], v[160:163], v[104:107]
    v_mfma_f32_16x16x32_bf16 v[108:111], v[188:191], v[164:167], v[108:111]
    s_waitcnt lgkmcnt(0)
    v_mfma_f32_16x16x32_bf16 v[16:19], v[128:131], v[112:115], v[16:19]
    ds_read_b128 v[152:155], v201 offset:0
    v_mfma_f32_16x16x32_bf16 v[20:23], v[128:131], v[116:119], v[20:23]
    ds_read_b64_tr_b16 v[168:169], v202 offset:20480
    v_mfma_f32_16x16x32_bf16 v[24:27], v[128:131], v[120:123], v[24:27]
    ds_read_b64_tr_b16 v[170:171], v202 offset:20992
    v_mfma_f32_16x16x32_bf16 v[28:31], v[128:131], v[124:127], v[28:31]
    ds_read_b128 v[156:159], v201 offset:2048
    v_mfma_f32_16x16x32_bf16 v[32:35], v[132:135], v[112:115], v[32:35]
    ds_read_b128 v[160:163], v201 offset:10240
    v_mfma_f32_16x16x32_bf16 v[36:39], v[132:135], v[116:119], v[36:39]
    ds_read_b128 v[164:167], v201 offset:12288
    v_mfma_f32_16x16x32_bf16 v[40:43], v[132:135], v[120:123], v[40:43]
    ds_read_b64_tr_b16 v[172:173], v203 offset:20480
    v_mfma_f32_16x16x32_bf16 v[44:47], v[132:135], v[124:127], v[44:47]
    ds_read_b64_tr_b16 v[174:175], v203 offset:20992
    v_mfma_f32_16x16x32_bf16 v[48:51], v[136:139], v[112:115], v[48:51]
    ds_read_b64_tr_b16 v[176:177], v202 offset:22528
    v_mfma_f32_16x16x32_bf16 v[52:55], v[136:139], v[116:119], v[52:55]
    ds_read_b64_tr_b16 v[178:179], v202 offset:23040
    v_mfma_f32_16x16x32_bf16 v[56:59], v[136:139], v[120:123], v[56:59]
    ds_read_b64_tr_b16 v[180:181], v203 offset:22528
    v_mfma_f32_16x16x32_bf16 v[60:63], v[136:139], v[124:127], v[60:63]
    ds_read_b64_tr_b16 v[182:183], v203 offset:23040
    v_mfma_f32_16x16x32_bf16 v[64:67], v[140:143], v[112:115], v[64:67]
    ds_read_b64_tr_b16 v[184:185], v202 offset:24576
    v_mfma_f32_16x16x32_bf16 v[68:71], v[140:143], v[116:119], v[68:71]
    ds_read_b64_tr_b16 v[186:187], v202 offset:25088
    v_mfma_f32_16x16x32_bf16 v[72:75], v[140:143], v[120:123], v[72:75]
    ds_read_b64_tr_b16 v[188:189], v203 offset:24576
    v_mfma_f32_16x16x32_bf16 v[76:79], v[140:143], v[124:127], v[76:79]
    ds_read_b64_tr_b16 v[190:191], v203 offset:25088
    v_mfma_f32_16x16x32_bf16 v[80:83], v[144:147], v[112:115], v[80:83]
    v_mfma_f32_16x16x32_bf16 v[84:87], v[144:147], v[116:119], v[84:87]
    v_mfma_f32_16x16x32_bf16 v[88:91], v[144:147], v[120:123], v[88:91]
    v_mfma_f32_16x16x32_bf16 v[92:95], v[144:147], v[124:127], v[92:95]
    v_mfma_f32_16x16x32_bf16 v[96:99], v[148:151], v[112:115], v[96:99]
    v_mfma_f32_16x16x32_bf16 v[100:103], v[148:151], v[116:119], v[100:103]
    v_mfma_f32_16x16x32_bf16 v[104:107], v[148:151], v[120:123], v[104:107]
    v_mfma_f32_16x16x32_bf16 v[108:111], v[148:151], v[124:127], v[108:111]
    s_waitcnt lgkmcnt(0)
    v_mfma_f32_16x16x32_bf16 v[16:19], v[168:171], v[152:155], v[16:19]
    s_barrier
    v_mfma_f32_16x16x32_bf16 v[20:23], v[168:171], v[156:159], v[20:23]
    ds_read_b128 v[112:115], v192 offset:0
    v_mfma_f32_16x16x32_bf16 v[24:27], v[168:171], v[160:163], v[24:27]
    ds_read_b64_tr_b16 v[128:129], v194 offset:0
    v_mfma_f32_16x16x32_bf16 v[28:31], v[168:171], v[164:167], v[28:31]
    ds_read_b64_tr_b16 v[130:131], v194 offset:512
    v_mfma_f32_16x16x32_bf16 v[32:35], v[172:175], v[152:155], v[32:35]
    ds_read_b128 v[116:119], v192 offset:2048
    v_mfma_f32_16x16x32_bf16 v[36:39], v[172:175], v[156:159], v[36:39]
    ds_read_b128 v[120:123], v192 offset:10240
    v_mfma_f32_16x16x32_bf16 v[40:43], v[172:175], v[160:163], v[40:43]
    ds_read_b128 v[124:127], v192 offset:12288
    v_mfma_f32_16x16x32_bf16 v[44:47], v[172:175], v[164:167], v[44:47]
    ds_read_b64_tr_b16 v[132:133], v195 offset:0
    v_mfma_f32_16x16x32_bf16 v[48:51], v[176:179], v[152:155], v[48:51]
    ds_read_b64_tr_b16 v[134:135], v195 offset:512
    v_mfma_f32_16x16x32_bf16 v[52:55], v[176:179], v[156:159], v[52:55]
    ds_read_b64_tr_b16 v[136:137], v194 offset:2048
    v_mfma_f32_16x16x32_bf16 v[56:59], v[176:179], v[160:163], v[56:59]
    ds_read_b64_tr_b16 v[138:139], v194 offset:2560
    v_mfma_f32_16x16x32_bf16 v[60:63], v[176:179], v[164:167], v[60:63]
    ds_read_b64_tr_b16 v[140:141], v195 offset:2048
    v_mfma_f32_16x16x32_bf16 v[64:67], v[180:183], v[152:155], v[64:67]
    ds_read_b64_tr_b16 v[142:143], v195 offset:2560
    v_mfma_f32_16x16x32_bf16 v[68:71], v[180:183], v[156:159], v[68:71]
    ds_read_b64_tr_b16 v[144:145], v194 offset:4096
    v_mfma_f32_16x16x32_bf16 v[72:75], v[180:183], v[160:163], v[72:75]
    ds_read_b64_tr_b16 v[146:147], v194 offset:4608
    v_mfma_f32_16x16x32_bf16 v[76:79], v[180:183], v[164:167], v[76:79]
    ds_read_b64_tr_b16 v[148:149], v195 offset:4096
    v_mfma_f32_16x16x32_bf16 v[80:83], v[184:187], v[152:155], v[80:83]
    ds_read_b64_tr_b16 v[150:151], v195 offset:4608
    v_mfma_f32_16x16x32_bf16 v[84:87], v[184:187], v[156:159], v[84:87]
    v_mfma_f32_16x16x32_bf16 v[88:91], v[184:187], v[160:163], v[88:91]
    v_mfma_f32_16x16x32_bf16 v[92:95], v[184:187], v[164:167], v[92:95]
    v_mfma_f32_16x16x32_bf16 v[96:99], v[188:191], v[152:155], v[96:99]
    v_mfma_f32_16x16x32_bf16 v[100:103], v[188:191], v[156:159], v[100:103]
    v_mfma_f32_16x16x32_bf16 v[104:107], v[188:191], v[160:163], v[104:107]
    v_mfma_f32_16x16x32_bf16 v[108:111], v[188:191], v[164:167], v[108:111]
    s_waitcnt lgkmcnt(0)
    v_mfma_f32_16x16x32_bf16 v[16:19], v[128:131], v[112:115], v[16:19]
    ds_read_b128 v[152:155], v193 offset:0
    v_mfma_f32_16x16x32_bf16 v[20:23], v[128:131], v[116:119], v[20:23]
    ds_read_b64_tr_b16 v[168:169], v194 offset:20480
    v_mfma_f32_16x16x32_bf16 v[24:27], v[128:131], v[120:123], v[24:27]
    ds_read_b64_tr_b16 v[170:171], v194 offset:20992
    v_mfma_f32_16x16x32_bf16 v[28:31], v[128:131], v[124:127], v[28:31]
    ds_read_b128 v[156:159], v193 offset:2048
    v_mfma_f32_16x16x32_bf16 v[32:35], v[132:135], v[112:115], v[32:35]
    ds_read_b128 v[160:163], v193 offset:10240
    v_mfma_f32_16x16x32_bf16 v[36:39], v[132:135], v[116:119], v[36:39]
    ds_read_b128 v[164:167], v193 offset:12288
    v_mfma_f32_16x16x32_bf16 v[40:43], v[132:135], v[120:123], v[40:43]
    ds_read_b64_tr_b16 v[172:173], v195 offset:20480
    v_mfma_f32_16x16x32_bf16 v[44:47], v[132:135], v[124:127], v[44:47]
    ds_read_b64_tr_b16 v[174:175], v195 offset:20992
    v_mfma_f32_16x16x32_bf16 v[48:51], v[136:139], v[112:115], v[48:51]
    ds_read_b64_tr_b16 v[176:177], v194 offset:22528
    v_mfma_f32_16x16x32_bf16 v[52:55], v[136:139], v[116:119], v[52:55]
    ds_read_b64_tr_b16 v[178:179], v194 offset:23040
    v_mfma_f32_16x16x32_bf16 v[56:59], v[136:139], v[120:123], v[56:59]
    ds_read_b64_tr_b16 v[180:181], v195 offset:22528
    v_mfma_f32_16x16x32_bf16 v[60:63], v[136:139], v[124:127], v[60:63]
    ds_read_b64_tr_b16 v[182:183], v195 offset:23040
    v_mfma_f32_16x16x32_bf16 v[64:67], v[140:143], v[112:115], v[64:67]
    ds_read_b64_tr_b16 v[184:185], v194 offset:24576
    v_mfma_f32_16x16x32_bf16 v[68:71], v[140:143], v[116:119], v[68:71]
    ds_read_b64_tr_b16 v[186:187], v194 offset:25088
    v_mfma_f32_16x16x32_bf16 v[72:75], v[140:143], v[120:123], v[72:75]
    ds_read_b64_tr_b16 v[188:189], v195 offset:24576
    v_mfma_f32_16x16x32_bf16 v[76:79], v[140:143], v[124:127], v[76:79]
    ds_read_b64_tr_b16 v[190:191], v195 offset:25088
    v_mfma_f32_16x16x32_bf16 v[80:83], v[144:147], v[112:115], v[80:83]
    v_mfma_f32_16x16x32_bf16 v[84:87], v[144:147], v[116:119], v[84:87]
    v_mfma_f32_16x16x32_bf16 v[88:91], v[144:147], v[120:123], v[88:91]
    v_mfma_f32_16x16x32_bf16 v[92:95], v[144:147], v[124:127], v[92:95]
    v_mfma_f32_16x16x32_bf16 v[96:99], v[148:151], v[112:115], v[96:99]
    s_add_u32 s68, s68, 1
    s_cmp_lt_u32 s68, 5
    v_mfma_f32_16x16x32_bf16 v[100:103], v[148:151], v[116:119], v[100:103]
    v_mfma_f32_16x16x32_bf16 v[104:107], v[148:151], v[120:123], v[104:107]
    v_mfma_f32_16x16x32_bf16 v[108:111], v[148:151], v[124:127], v[108:111]
    s_waitcnt lgkmcnt(0)
    v_mfma_f32_16x16x32_bf16 v[16:19], v[168:171], v[152:155], v[16:19]
    s_cbranch_scc0 L_cexit
    s_barrier
    v_mfma_f32_16x16x32_bf16 v[20:23], v[168:171], v[156:159], v[20:23]
    ds_read_b128 v[112:115], v196 offset:0
    v_mfma_f32_16x16x32_bf16 v[24:27], v[168:171], v[160:163], v[24:27]
    ds_read_b64_tr_b16 v[128:129], v198 offset:0
    s_branch L_cloop
L_cexit:
    v_mfma_f32_16x16x32_bf16 v[20:23], v[168:171], v[156:159], v[20:23]
    v_mfma_f32_16x16x32_bf16 v[24:27], v[168:171], v[160:163], v[24:27]
    v_mfma_f32_16x16x32_bf16 v[28:31], v[168:171], v[164:167], v[28:31]
    v_mfma_f32_16x16x32_bf16 v[32:35], v[172:175], v[152:155], v[32:35]
    v_mfma_f32_16x16x32_bf16 v[36:39], v[172:175], v[156:159], v[36:39]
    v_mfma_f32_16x16x32_bf16 v[40:43], v[172:175], v[160:163], v[40:43]
    v_mfma_f32_16x16x32_bf16 v[44:47], v[172:175], v[164:167], v[44:47]
    v_mfma_f32_16x16x32_bf16 v[48:51], v[176:179], v[152:155], v[48:51]
    v_mfma_f32_16x16x32_bf16 v[52:55], v[176:179], v[156:159], v[52:55]
    v_mfma_f32_16x16x32_bf16 v[56:59], v[176:179], v[160:163], v[56:59]
    v_mfma_f32_16x16x32_bf16 v[60:63], v[176:179], v[164:167], v[60:63]
    v_mfma_f32_16x16x32_bf16 v[64:67], v[180:183], v[152:155], v[64:67]
    v_mfma_f32_16x16x32_bf16 v[68:71], v[180:183], v[156:159], v[68:71]
    v_mfma_f32_16x16x32_bf16 v[72:75], v[180:183], v[160:163], v[72:75]
    s_barrier
    ds_read_b32 v11, v10 offset:53248
    ds_read_b64 v[222:223], v213 offset:49152
    ds_read_b64 v[224:225], v213 offset:49280
    ds_read_b64 v[226:227], v213 offset:49408
    v_mfma_f32_16x16x32_bf16 v[76:79], v[180:183], v[164:167], v[76:79]
    ds_read_b64 v[228:229], v213 offset:49536
    ds_read_b64 v[238:239], v215 offset:50176
    ds_read_b64 v[240:241], v215 offset:50304
    v_mfma_f32_16x16x32_bf16 v[80:83], v[184:187], v[152:155], v[80:83]
    ds_read_b64 v[242:243], v215 offset:50688
    ds_read_b64 v[244:245], v215 offset:50816
    ds_read_b64 v[246:247], v215 offset:51200
    v_mfma_f32_16x16x32_bf16 v[84:87], v[184:187], v[156:159], v[84:87]
    ds_read_b64 v[248:249], v215 offset:51328
    ds_read_b32 v250, v214 offset:49156
    ds_read_b32 v252, v214 offset:49412
    v_mfma_f32_16x16x32_bf16 v[88:91], v[184:187], v[160:163], v[88:91]
    s_waitcnt lgkmcnt(8)
    v_readfirstlane_b32 s100, v11
    v_mov_b32_e64 v230, v223
    v_cndmask_b32 v222, 0, v222, s[86:87]
    v_mov_b32_e64 v232, v225
    v_cndmask_b32 v224, 0, v224, s[86:87]
    v_mfma_f32_16x16x32_bf16 v[92:95], v[184:187], v[164:167], v[92:95]
    v_mov_b32_e64 v234, v227
    v_cndmask_b32 v226, 0, v226, s[86:87]
    v_mov_b32_e64 v236, v229
    v_cndmask_b32 v228, 0, v228, s[86:87]
    v_mov_b32 v223, v222
    v_mov_b32 v225, v224
    v_mfma_f32_16x16x32_bf16 v[96:99], v[188:191], v[152:155], v[96:99]
    v_mov_b32 v227, v226
    v_mov_b32_e64 v229, v228
    s_waitcnt lgkmcnt(0)
    v_mul_f32 v251, 0x3fb8aa3b, v250
    v_mul_f32 v253, 0x3fb8aa3b, v252
    v_mfma_f32_16x16x32_bf16 v[100:103], v[188:191], v[156:159], v[100:103]
    v_mfma_f32_16x16x32_bf16 v[104:107], v[188:191], v[160:163], v[104:107]
    v_mfma_f32_16x16x32_bf16 v[108:111], v[188:191], v[164:167], v[108:111]
    v_mfma_f32_16x16x16_bf16 v[48:51], v[242:243], v[222:223], v[48:51]
    v_mfma_f32_16x16x16_bf16 v[52:55], v[242:243], v[224:225], v[52:55]
    v_mfma_f32_16x16x16_bf16 v[56:59], v[242:243], v[226:227], v[56:59]
    v_mfma_f32_16x16x16_bf16 v[60:63], v[242:243], v[228:229], v[60:63]
    v_mfma_f32_16x16x16_bf16 v[64:67], v[244:245], v[222:223], v[64:67]
    v_mfma_f32_16x16x16_bf16 v[68:71], v[244:245], v[224:225], v[68:71]
    v_mfma_f32_16x16x16_bf16 v[72:75], v[244:245], v[226:227], v[72:75]
    v_mfma_f32_16x16x16_bf16 v[76:79], v[244:245], v[228:229], v[76:79]
    v_mfma_f32_16x16x16_bf16 v[80:83], v[246:247], v[222:223], v[80:83]
    v_mfma_f32_16x16x16_bf16 v[84:87], v[246:247], v[224:225], v[84:87]
    v_mfma_f32_16x16x16_bf16 v[88:91], v[246:247], v[226:227], v[88:91]
    v_mfma_f32_16x16x16_bf16 v[92:95], v[246:247], v[228:229], v[92:95]
    v_mfma_f32_16x16x16_bf16 v[96:99], v[248:249], v[222:223], v[96:99]
    v_cvt_pk_bf16_f32 v112, v48, v49
    v_cvt_pk_bf16_f32 v113, v50, v51
    v_mfma_f32_16x16x16_bf16 v[100:103], v[248:249], v[224:225], v[100:103]
    v_cvt_pk_bf16_f32 v114, v52, v53
    v_cvt_pk_bf16_f32 v115, v54, v55
    v_mfma_f32_16x16x16_bf16 v[104:107], v[248:249], v[226:227], v[104:107]
    v_cvt_pk_bf16_f32 v116, v64, v65
    v_cvt_pk_bf16_f32 v117, v66, v67
    v_mfma_f32_16x16x16_bf16 v[108:111], v[248:249], v[228:229], v[108:111]
    v_cvt_pk_bf16_f32 v118, v68, v69
    v_cvt_pk_bf16_f32 v119, v70, v71
    v_mfma_f32_16x16x16_bf16 v[16:19], v[238:239], v[222:223], v[16:19]
    v_cvt_pk_bf16_f32 v120, v56, v57
    v_cvt_pk_bf16_f32 v121, v58, v59
    v_mfma_f32_16x16x16_bf16 v[20:23], v[238:239], v[224:225], v[20:23]
    v_cvt_pk_bf16_f32 v122, v60, v61
    v_cvt_pk_bf16_f32 v123, v62, v63
    v_mfma_f32_16x16x16_bf16 v[24:27], v[238:239], v[226:227], v[24:27]
    v_cvt_pk_bf16_f32 v124, v72, v73
    v_cvt_pk_bf16_f32 v125, v74, v75
    v_mfma_f32_16x16x16_bf16 v[28:31], v[238:239], v[228:229], v[28:31]
    v_cvt_pk_bf16_f32 v126, v76, v77
    v_cvt_pk_bf16_f32 v127, v78, v79
    v_mfma_f32_16x16x16_bf16 v[32:35], v[240:241], v[222:223], v[32:35]
    v_mfma_f32_16x16x16_bf16 v[36:39], v[240:241], v[224:225], v[36:39]
    v_mfma_f32_16x16x16_bf16 v[40:43], v[240:241], v[226:227], v[40:43]
    v_mfma_f32_16x16x16_bf16 v[44:47], v[240:241], v[228:229], v[44:47]
    v_permlane16_swap_b32 v112, v114
    v_permlane16_swap_b32 v113, v115
    v_permlane16_swap_b32 v116, v118
    v_permlane16_swap_b32 v117, v119
    v_permlane16_swap_b32 v120, v122
    v_permlane16_swap_b32 v121, v123
    v_permlane16_swap_b32 v124, v126
    v_permlane16_swap_b32 v125, v127
    v_xor_b32 v168, 0, v217
    v_xor_b32 v169, 16, v217
    v_xor_b32 v170, 32, v217
    v_xor_b32 v171, 48, v217
    v_xor_b32_e64 v172, 64, v217
    v_xor_b32 v173, 80, v217
    v_xor_b32 v174, 96, v217
    v_xor_b32 v175, 112, v217
    v_xor_b32_e64 v4, 32, v216
    v_mfma_f32_32x32x16_bf16 v[48:63], v[204:207], v[112:115], 0
    v_mul_f32 v80, v80, v230
    v_mul_f32 v81, v81, v230
    v_mul_f32 v82, v82, v230
    v_mul_f32 v83, v83, v230
    v_cvt_pk_bf16_f32 v80, v80, v81
    v_cvt_pk_bf16_f32 v81, v82, v83
    ds_write_b64 v216, v[80:81] offset:32768
    v_mfma_f32_32x32x16_bf16 v[64:79], v[204:207], v[120:123], 0
    v_mul_f32 v96, v96, v230
    v_mul_f32 v97, v97, v230
    v_mul_f32 v98, v98, v230
    v_mul_f32 v99, v99, v230
    v_cvt_pk_bf16_f32 v96, v96, v97
    v_cvt_pk_bf16_f32 v97, v98, v99
    ds_write_b64 v4, v[96:97] offset:32768
    v_mfma_f32_32x32x16_bf16 v[48:63], v[208:211], v[116:119], v[48:63]
    v_mul_f32 v84, v84, v232
    v_mul_f32 v85, v85, v232
    v_mul_f32 v86, v86, v232
    v_mul_f32 v87, v87, v232
    v_cvt_pk_bf16_f32 v84, v84, v85
    v_cvt_pk_bf16_f32 v85, v86, v87
    ds_write_b64 v216, v[84:85] offset:34816
    v_mfma_f32_32x32x16_bf16 v[64:79], v[208:211], v[124:127], v[64:79]
    v_mul_f32 v100, v100, v232
    v_mul_f32 v101, v101, v232
    v_mul_f32 v102, v102, v232
    v_mul_f32 v103, v103, v232
    v_cvt_pk_bf16_f32 v100, v100, v101
    v_cvt_pk_bf16_f32 v101, v102, v103
    ds_write_b64 v4, v[100:101] offset:34816
    v_mul_f32 v88, v88, v234
    v_mul_f32 v89, v89, v234
    v_mul_f32 v90, v90, v234
    v_mul_f32 v91, v91, v234
    v_cvt_pk_bf16_f32 v88, v88, v89
    v_cvt_pk_bf16_f32 v89, v90, v91
    ds_write_b64 v216, v[88:89] offset:36864
    v_mul_f32 v104, v104, v234
    v_mul_f32 v105, v105, v234
    v_mul_f32 v106, v106, v234
    v_mul_f32 v107, v107, v234
    v_cvt_pk_bf16_f32 v104, v104, v105
    v_cvt_pk_bf16_f32 v105, v106, v107
    ds_write_b64 v4, v[104:105] offset:36864
    v_mul_f32 v92, v92, v236
    v_mul_f32 v93, v93, v236
    v_mul_f32 v94, v94, v236
    v_mul_f32 v95, v95, v236
    v_cvt_pk_bf16_f32 v92, v92, v93
    v_cvt_pk_bf16_f32 v93, v94, v95
    ds_write_b64 v216, v[92:93] offset:38912
    v_mul_f32 v108, v108, v236
    v_mul_f32 v109, v109, v236
    v_mul_f32 v110, v110, v236
    v_mul_f32 v111, v111, v236
    v_cvt_pk_bf16_f32 v108, v108, v109
    v_cvt_pk_bf16_f32 v109, v110, v111
    ds_write_b64 v4, v[108:109] offset:38912
    v_max3_f32 v160, v48, v49, v50
    v_min3_f32 v162, v48, v49, v50
    v_max3_f32 v160, v160, v51, v52
    v_min3_f32 v162, v162, v51, v52
    v_max3_f32 v160, v160, v53, v54
    v_min3_f32 v162, v162, v53, v54
    v_max3_f32 v160, v160, v55, v56
    v_min3_f32 v162, v162, v55, v56
    v_max3_f32 v160, v160, v57, v58
    v_min3_f32 v162, v162, v57, v58
    v_max3_f32 v160, v160, v59, v60
    v_min3_f32 v162, v162, v59, v60
    v_max3_f32 v160, v160, v61, v62
    v_min3_f32 v162, v162, v61, v62
    v_max_f32 v160, v160, v63
    v_min_f32 v162, v162, v63
    v_max3_f32 v164, v64, v65, v66
    v_min3_f32 v166, v64, v65, v66
    v_max3_f32 v164, v164, v67, v68
    v_min3_f32 v166, v166, v67, v68
    v_max3_f32 v164, v164, v69, v70
    v_min3_f32 v166, v166, v69, v70
    v_max3_f32 v164, v164, v71, v72
    v_min3_f32 v166, v166, v71, v72
    v_max3_f32 v164, v164, v73, v74
    v_min3_f32 v166, v166, v73, v74
    v_max3_f32 v164, v164, v75, v76
    v_min3_f32 v166, v166, v75, v76
    v_max3_f32 v164, v164, v77, v78
    v_min3_f32 v166, v166, v77, v78
    v_max_f32 v164, v164, v79
    v_min_f32 v166, v166, v79
    v_mov_b32 v161, v160
    v_mov_b32 v163, v162
    v_mov_b32 v165, v164
    v_mov_b32 v167, v166
    v_permlane32_swap_b32 v160, v161
    v_permlane32_swap_b32 v162, v163
    v_permlane32_swap_b32 v164, v165
    v_permlane32_swap_b32 v166, v167
    v_max_f32 v160, v160, v161
    v_min_f32 v162, v162, v163
    v_max_f32 v164, v164, v165
    v_min_f32 v166, v166, v167
    v_mul_f32 v160, v160, v251
    v_mul_f32 v162, v162, v251
    v_mul_f32 v164, v164, v253
    v_mul_f32 v166, v166, v253
    v_pk_fma_f32 v[128:129], v[48:49], v[250:251], v[160:161] op_sel:[0,1,0] op_sel_hi:[1,1,0] neg_lo:[0,0,1] neg_hi:[0,0,1]
    v_pk_fma_f32 v[48:49], v[48:49], v[250:251], v[162:163] op_sel:[0,1,0] op_sel_hi:[1,1,0] neg_lo:[0,1,0] neg_hi:[0,1,0]
    v_pk_fma_f32 v[130:131], v[50:51], v[250:251], v[160:161] op_sel:[0,1,0] op_sel_hi:[1,1,0] neg_lo:[0,0,1] neg_hi:[0,0,1]
    v_pk_fma_f32 v[50:51], v[50:51], v[250:251], v[162:163] op_sel:[0,1,0] op_sel_hi:[1,1,0] neg_lo:[0,1,0] neg_hi:[0,1,0]
    v_pk_fma_f32 v[132:133], v[52:53], v[250:251], v[160:161] op_sel:[0,1,0] op_sel_hi:[1,1,0] neg_lo:[0,0,1] neg_hi:[0,0,1]
    v_pk_fma_f32 v[52:53], v[52:53], v[250:251], v[162:163] op_sel:[0,1,0] op_sel_hi:[1,1,0] neg_lo:[0,1,0] neg_hi:[0,1,0]
    v_pk_fma_f32 v[134:135], v[54:55], v[250:251], v[160:161] op_sel:[0,1,0] op_sel_hi:[1,1,0] neg_lo:[0,0,1] neg_hi:[0,0,1]
    v_pk_fma_f32 v[54:55], v[54:55], v[250:251], v[162:163] op_sel:[0,1,0] op_sel_hi:[1,1,0] neg_lo:[0,1,0] neg_hi:[0,1,0]
    v_pk_fma_f32 v[136:137], v[56:57], v[250:251], v[160:161] op_sel:[0,1,0] op_sel_hi:[1,1,0] neg_lo:[0,0,1] neg_hi:[0,0,1]
    v_pk_fma_f32 v[56:57], v[56:57], v[250:251], v[162:163] op_sel:[0,1,0] op_sel_hi:[1,1,0] neg_lo:[0,1,0] neg_hi:[0,1,0]
    v_pk_fma_f32 v[138:139], v[58:59], v[250:251], v[160:161] op_sel:[0,1,0] op_sel_hi:[1,1,0] neg_lo:[0,0,1] neg_hi:[0,0,1]
    v_pk_fma_f32 v[58:59], v[58:59], v[250:251], v[162:163] op_sel:[0,1,0] op_sel_hi:[1,1,0] neg_lo:[0,1,0] neg_hi:[0,1,0]
    v_pk_fma_f32 v[140:141], v[60:61], v[250:251], v[160:161] op_sel:[0,1,0] op_sel_hi:[1,1,0] neg_lo:[0,0,1] neg_hi:[0,0,1]
    v_pk_fma_f32 v[60:61], v[60:61], v[250:251], v[162:163] op_sel:[0,1,0] op_sel_hi:[1,1,0] neg_lo:[0,1,0] neg_hi:[0,1,0]
    v_pk_fma_f32 v[142:143], v[62:63], v[250:251], v[160:161] op_sel:[0,1,0] op_sel_hi:[1,1,0] neg_lo:[0,0,1] neg_hi:[0,0,1]
    v_pk_fma_f32 v[62:63], v[62:63], v[250:251], v[162:163] op_sel:[0,1,0] op_sel_hi:[1,1,0] neg_lo:[0,1,0] neg_hi:[0,1,0]
    v_exp_f32 v128, v128
    v_exp_f32 v48, v48
    v_exp_f32 v129, v129
    v_exp_f32 v49, v49
    v_exp_f32 v130, v130
    v_exp_f32 v50, v50
    v_exp_f32 v131, v131
    v_exp_f32 v51, v51
    v_exp_f32 v132, v132
    v_exp_f32 v52, v52
    v_exp_f32 v133, v133
    v_exp_f32 v53, v53
    v_exp_f32 v134, v134
    v_exp_f32 v54, v54
    v_exp_f32 v135, v135
    v_exp_f32 v55, v55
    v_exp_f32 v136, v136
    v_exp_f32 v56, v56
    v_exp_f32 v137, v137
    v_exp_f32 v57, v57
    v_exp_f32 v138, v138
    v_exp_f32 v58, v58
    v_exp_f32 v139, v139
    v_exp_f32 v59, v59
    v_exp_f32 v140, v140
    v_exp_f32 v60, v60
    v_exp_f32 v141, v141
    v_exp_f32 v61, v61
    v_exp_f32 v142, v142
    v_exp_f32 v62, v62
    v_exp_f32 v143, v143
    v_exp_f32 v63, v63
    v_pk_fma_f32 v[144:145], v[64:65], v[252:253], v[164:165] op_sel:[0,1,0] op_sel_hi:[1,1,0] neg_lo:[0,0,1] neg_hi:[0,0,1]
    v_pk_fma_f32 v[64:65], v[64:65], v[252:253], v[166:167] op_sel:[0,1,0] op_sel_hi:[1,1,0] neg_lo:[0,1,0] neg_hi:[0,1,0]
    v_pk_fma_f32 v[146:147], v[66:67], v[252:253], v[164:165] op_sel:[0,1,0] op_sel_hi:[1,1,0] neg_lo:[0,0,1] neg_hi:[0,0,1]
    v_pk_fma_f32 v[66:67], v[66:67], v[252:253], v[166:167] op_sel:[0,1,0] op_sel_hi:[1,1,0] neg_lo:[0,1,0] neg_hi:[0,1,0]
    v_pk_fma_f32 v[148:149], v[68:69], v[252:253], v[164:165] op_sel:[0,1,0] op_sel_hi:[1,1,0] neg_lo:[0,0,1] neg_hi:[0,0,1]
    v_pk_fma_f32 v[68:69], v[68:69], v[252:253], v[166:167] op_sel:[0,1,0] op_sel_hi:[1,1,0] neg_lo:[0,1,0] neg_hi:[0,1,0]
    v_pk_fma_f32 v[150:151], v[70:71], v[252:253], v[164:165] op_sel:[0,1,0] op_sel_hi:[1,1,0] neg_lo:[0,0,1] neg_hi:[0,0,1]
    v_pk_fma_f32 v[70:71], v[70:71], v[252:253], v[166:167] op_sel:[0,1,0] op_sel_hi:[1,1,0] neg_lo:[0,1,0] neg_hi:[0,1,0]
    v_pk_fma_f32 v[152:153], v[72:73], v[252:253], v[164:165] op_sel:[0,1,0] op_sel_hi:[1,1,0] neg_lo:[0,0,1] neg_hi:[0,0,1]
    v_pk_fma_f32 v[72:73], v[72:73], v[252:253], v[166:167] op_sel:[0,1,0] op_sel_hi:[1,1,0] neg_lo:[0,1,0] neg_hi:[0,1,0]
    v_pk_fma_f32 v[154:155], v[74:75], v[252:253], v[164:165] op_sel:[0,1,0] op_sel_hi:[1,1,0] neg_lo:[0,0,1] neg_hi:[0,0,1]
    v_pk_fma_f32 v[74:75], v[74:75], v[252:253], v[166:167] op_sel:[0,1,0] op_sel_hi:[1,1,0] neg_lo:[0,1,0] neg_hi:[0,1,0]
    v_pk_fma_f32 v[156:157], v[76:77], v[252:253], v[164:165] op_sel:[0,1,0] op_sel_hi:[1,1,0] neg_lo:[0,0,1] neg_hi:[0,0,1]
    v_pk_fma_f32 v[76:77], v[76:77], v[252:253], v[166:167] op_sel:[0,1,0] op_sel_hi:[1,1,0] neg_lo:[0,1,0] neg_hi:[0,1,0]
    v_pk_fma_f32 v[158:159], v[78:79], v[252:253], v[164:165] op_sel:[0,1,0] op_sel_hi:[1,1,0] neg_lo:[0,0,1] neg_hi:[0,0,1]
    v_pk_fma_f32 v[78:79], v[78:79], v[252:253], v[166:167] op_sel:[0,1,0] op_sel_hi:[1,1,0] neg_lo:[0,1,0] neg_hi:[0,1,0]
    v_exp_f32 v144, v144
    v_exp_f32 v64, v64
    v_exp_f32 v145, v145
    v_exp_f32 v65, v65
    v_exp_f32 v146, v146
    v_exp_f32 v66, v66
    v_exp_f32 v147, v147
    v_exp_f32 v67, v67
    v_exp_f32 v148, v148
    v_exp_f32 v68, v68
    v_exp_f32 v149, v149
    v_exp_f32 v69, v69
    v_exp_f32 v150, v150
    v_exp_f32 v70, v70
    v_exp_f32 v151, v151
    v_exp_f32 v71, v71
    v_exp_f32 v152, v152
    v_exp_f32 v72, v72
    v_exp_f32 v153, v153
    v_exp_f32 v73, v73
    v_exp_f32 v154, v154
    v_exp_f32 v74, v74
    v_exp_f32 v155, v155
    v_exp_f32 v75, v75
    v_exp_f32 v156, v156
    v_exp_f32 v76, v76
    v_exp_f32 v157, v157
    v_exp_f32 v77, v77
    v_exp_f32 v158, v158
    v_exp_f32 v78, v78
    v_exp_f32 v159, v159
    v_exp_f32 v79, v79
    v_pk_add_f32 v[176:177], v[128:129], v[130:131]
    v_pk_add_f32 v[176:177], v[176:177], v[132:133]
    v_pk_add_f32 v[176:177], v[176:177], v[134:135]
    v_pk_add_f32 v[176:177], v[176:177], v[136:137]
    v_pk_add_f32 v[176:177], v[176:177], v[138:139]
    v_pk_add_f32 v[176:177], v[176:177], v[140:141]
    v_pk_add_f32 v[176:177], v[176:177], v[142:143]
    v_pk_add_f32 v[178:179], v[48:49], v[50:51]
    v_pk_add_f32 v[178:179], v[178:179], v[52:53]
    v_pk_add_f32 v[178:179], v[178:179], v[54:55]
    v_pk_add_f32 v[178:179], v[178:179], v[56:57]
    v_pk_add_f32 v[178:179], v[178:179], v[58:59]
    v_pk_add_f32 v[178:179], v[178:179], v[60:61]
    v_pk_add_f32 v[178:179], v[178:179], v[62:63]
    v_pk_add_f32 v[180:181], v[144:145], v[146:147]
    v_pk_add_f32 v[180:181], v[180:181], v[148:149]
    v_pk_add_f32 v[180:181], v[180:181], v[150:151]
    v_pk_add_f32 v[180:181], v[180:181], v[152:153]
    v_pk_add_f32 v[180:181], v[180:181], v[154:155]
    v_pk_add_f32 v[180:181], v[180:181], v[156:157]
    v_pk_add_f32 v[180:181], v[180:181], v[158:159]
    v_pk_add_f32 v[182:183], v[64:65], v[66:67]
    v_pk_add_f32 v[182:183], v[182:183], v[68:69]
    v_pk_add_f32 v[182:183], v[182:183], v[70:71]
    v_pk_add_f32 v[182:183], v[182:183], v[72:73]
    v_pk_add_f32 v[182:183], v[182:183], v[74:75]
    v_pk_add_f32 v[182:183], v[182:183], v[76:77]
    v_pk_add_f32 v[182:183], v[182:183], v[78:79]
    v_add_f32 v176, v176, v177
    v_add_f32 v178, v178, v179
    v_add_f32 v180, v180, v181
    v_add_f32 v182, v182, v183
    v_mov_b32 v177, v176
    v_mov_b32 v179, v178
    v_mov_b32 v181, v180
    v_mov_b32 v183, v182
    v_permlane32_swap_b32 v176, v177
    v_permlane32_swap_b32 v178, v179
    v_permlane32_swap_b32 v180, v181
    v_permlane32_swap_b32 v182, v183
    v_add_f32 v176, v176, v177
    v_add_f32 v178, v178, v179
    v_add_f32 v180, v180, v181
    v_add_f32 v182, v182, v183
    v_rcp_f32 v176, v176
    v_rcp_f32 v178, v178
    v_rcp_f32 v180, v180
    v_rcp_f32 v182, v182
    v_pk_mul_f32 v[128:129], v[128:129], v[176:177] op_sel_hi:[1,0]
    v_pk_mul_f32 v[130:131], v[130:131], v[176:177] op_sel_hi:[1,0]
    v_pk_mul_f32 v[132:133], v[132:133], v[176:177] op_sel_hi:[1,0]
    v_pk_mul_f32 v[134:135], v[134:135], v[176:177] op_sel_hi:[1,0]
    v_pk_mul_f32 v[136:137], v[136:137], v[176:177] op_sel_hi:[1,0]
    v_pk_mul_f32 v[138:139], v[138:139], v[176:177] op_sel_hi:[1,0]
    v_pk_mul_f32 v[140:141], v[140:141], v[176:177] op_sel_hi:[1,0]
    v_pk_mul_f32 v[142:143], v[142:143], v[176:177] op_sel_hi:[1,0]
    v_cvt_pk_bf16_f32 v128, v128, v129
    v_cvt_pk_bf16_f32 v129, v130, v131
    ds_write_b64 v168, v[128:129] offset:0
    v_cvt_pk_bf16_f32 v130, v132, v133
    v_cvt_pk_bf16_f32 v131, v134, v135
    ds_write_b64 v169, v[130:131] offset:0
    v_cvt_pk_bf16_f32 v132, v136, v137
    v_cvt_pk_bf16_f32 v133, v138, v139
    ds_write_b64 v170, v[132:133] offset:0
    v_cvt_pk_bf16_f32 v134, v140, v141
    v_cvt_pk_bf16_f32 v135, v142, v143
    ds_write_b64 v171, v[134:135] offset:0
    v_pk_mul_f32 v[48:49], v[48:49], v[178:179] op_sel_hi:[1,0]
    v_pk_mul_f32 v[50:51], v[50:51], v[178:179] op_sel_hi:[1,0]
    v_pk_mul_f32 v[52:53], v[52:53], v[178:179] op_sel_hi:[1,0]
    v_pk_mul_f32 v[54:55], v[54:55], v[178:179] op_sel_hi:[1,0]
    v_pk_mul_f32 v[56:57], v[56:57], v[178:179] op_sel_hi:[1,0]
    v_pk_mul_f32 v[58:59], v[58:59], v[178:179] op_sel_hi:[1,0]
    v_pk_mul_f32 v[60:61], v[60:61], v[178:179] op_sel_hi:[1,0]
    v_pk_mul_f32 v[62:63], v[62:63], v[178:179] op_sel_hi:[1,0]
    v_cvt_pk_bf16_f32 v48, v48, v49
    v_cvt_pk_bf16_f32 v49, v50, v51
    ds_write_b64 v172, v[48:49] offset:0
    v_cvt_pk_bf16_f32 v50, v52, v53
    v_cvt_pk_bf16_f32 v51, v54, v55
    ds_write_b64 v173, v[50:51] offset:0
    v_cvt_pk_bf16_f32 v52, v56, v57
    v_cvt_pk_bf16_f32 v53, v58, v59
    ds_write_b64 v174, v[52:53] offset:0
    v_cvt_pk_bf16_f32 v54, v60, v61
    v_cvt_pk_bf16_f32 v55, v62, v63
    ds_write_b64 v175, v[54:55] offset:0
    v_pk_mul_f32 v[144:145], v[144:145], v[180:181] op_sel_hi:[1,0]
    v_pk_mul_f32 v[146:147], v[146:147], v[180:181] op_sel_hi:[1,0]
    v_pk_mul_f32 v[148:149], v[148:149], v[180:181] op_sel_hi:[1,0]
    v_pk_mul_f32 v[150:151], v[150:151], v[180:181] op_sel_hi:[1,0]
    v_pk_mul_f32 v[152:153], v[152:153], v[180:181] op_sel_hi:[1,0]
    v_pk_mul_f32 v[154:155], v[154:155], v[180:181] op_sel_hi:[1,0]
    v_pk_mul_f32 v[156:157], v[156:157], v[180:181] op_sel_hi:[1,0]
    v_pk_mul_f32 v[158:159], v[158:159], v[180:181] op_sel_hi:[1,0]
    v_cvt_pk_bf16_f32 v144, v144, v145
    v_cvt_pk_bf16_f32 v145, v146, v147
    ds_write_b64 v168, v[144:145] offset:4096
    v_cvt_pk_bf16_f32 v146, v148, v149
    v_cvt_pk_bf16_f32 v147, v150, v151
    ds_write_b64 v169, v[146:147] offset:4096
    v_cvt_pk_bf16_f32 v148, v152, v153
    v_cvt_pk_bf16_f32 v149, v154, v155
    ds_write_b64 v170, v[148:149] offset:4096
    v_cvt_pk_bf16_f32 v150, v156, v157
    v_cvt_pk_bf16_f32 v151, v158, v159
    ds_write_b64 v171, v[150:151] offset:4096
    v_pk_mul_f32 v[64:65], v[64:65], v[182:183] op_sel_hi:[1,0]
    v_pk_mul_f32 v[66:67], v[66:67], v[182:183] op_sel_hi:[1,0]
    v_pk_mul_f32 v[68:69], v[68:69], v[182:183] op_sel_hi:[1,0]
    v_pk_mul_f32 v[70:71], v[70:71], v[182:183] op_sel_hi:[1,0]
    v_pk_mul_f32 v[72:73], v[72:73], v[182:183] op_sel_hi:[1,0]
    v_pk_mul_f32 v[74:75], v[74:75], v[182:183] op_sel_hi:[1,0]
    v_pk_mul_f32 v[76:77], v[76:77], v[182:183] op_sel_hi:[1,0]
    v_pk_mul_f32 v[78:79], v[78:79], v[182:183] op_sel_hi:[1,0]
    v_cvt_pk_bf16_f32 v64, v64, v65
    v_cvt_pk_bf16_f32 v65, v66, v67
    ds_write_b64 v172, v[64:65] offset:4096
    v_cvt_pk_bf16_f32 v66, v68, v69
    v_cvt_pk_bf16_f32 v67, v70, v71
    ds_write_b64 v173, v[66:67] offset:4096
    v_cvt_pk_bf16_f32 v68, v72, v73
    v_cvt_pk_bf16_f32 v69, v74, v75
    ds_write_b64 v174, v[68:69] offset:4096
    v_cvt_pk_bf16_f32 v70, v76, v77
    v_cvt_pk_bf16_f32 v71, v78, v79
    ds_write_b64 v175, v[70:71] offset:4096
    s_waitcnt lgkmcnt(0)
    s_barrier
    ds_read_b64_tr_b16 v[112:113], v218 offset:0
    ds_read_b64_tr_b16 v[114:115], v219 offset:0
    ds_read_b64_tr_b16 v[144:145], v220 offset:32768
    ds_read_b64_tr_b16 v[146:147], v221 offset:32768
    ds_read_b64_tr_b16 v[116:117], v218 offset:2048
    ds_read_b64_tr_b16 v[118:119], v219 offset:2048
    ds_read_b64_tr_b16 v[148:149], v220 offset:34816
    ds_read_b64_tr_b16 v[150:151], v221 offset:34816
    ds_read_b64_tr_b16 v[120:121], v218 offset:4096
    ds_read_b64_tr_b16 v[122:123], v219 offset:4096
    ds_read_b64_tr_b16 v[152:153], v220 offset:36864
    ds_read_b64_tr_b16 v[154:155], v221 offset:36864
    v_cvt_pk_bf16_f32 v176, v16, v17
    v_cvt_pk_bf16_f32 v177, v18, v19
    v_cvt_pk_bf16_f32 v178, v20, v21
    v_cvt_pk_bf16_f32 v179, v22, v23
    v_cvt_pk_bf16_f32 v180, v32, v33
    v_cvt_pk_bf16_f32 v181, v34, v35
    v_cvt_pk_bf16_f32 v182, v36, v37
    v_cvt_pk_bf16_f32 v183, v38, v39
    v_cvt_pk_bf16_f32 v184, v24, v25
    v_cvt_pk_bf16_f32 v185, v26, v27
    v_cvt_pk_bf16_f32 v186, v28, v29
    v_cvt_pk_bf16_f32 v187, v30, v31
    v_cvt_pk_bf16_f32 v188, v40, v41
    v_cvt_pk_bf16_f32 v189, v42, v43
    v_cvt_pk_bf16_f32 v190, v44, v45
    v_cvt_pk_bf16_f32 v191, v46, v47
    s_waitcnt lgkmcnt(8)
    v_mfma_f32_32x32x16_bf16 v[48:63], v[112:115], v[144:147], 0
    ds_read_b64_tr_b16 v[124:125], v218 offset:6144
    ds_read_b64_tr_b16 v[126:127], v219 offset:6144
    ds_read_b64_tr_b16 v[156:157], v220 offset:38912
    ds_read_b64_tr_b16 v[158:159], v221 offset:38912
    s_waitcnt lgkmcnt(8)
    v_mfma_f32_32x32x16_bf16 v[48:63], v[116:119], v[148:151], v[48:63]
    ds_read_b64_tr_b16 v[128:129], v218 offset:8192
    ds_read_b64_tr_b16 v[130:131], v219 offset:8192
    ds_read_b64_tr_b16 v[160:161], v220 offset:40960
    ds_read_b64_tr_b16 v[162:163], v221 offset:40960
    s_waitcnt lgkmcnt(8)
    v_mfma_f32_32x32x16_bf16 v[48:63], v[120:123], v[152:155], v[48:63]
    ds_read_b64_tr_b16 v[132:133], v218 offset:10240
    ds_read_b64_tr_b16 v[134:135], v219 offset:10240
    ds_read_b64_tr_b16 v[164:165], v220 offset:43008
    ds_read_b64_tr_b16 v[166:167], v221 offset:43008
    s_waitcnt lgkmcnt(8)
    v_mfma_f32_32x32x16_bf16 v[48:63], v[124:127], v[156:159], v[48:63]
    ds_read_b64_tr_b16 v[136:137], v218 offset:12288
    ds_read_b64_tr_b16 v[138:139], v219 offset:12288
    ds_read_b64_tr_b16 v[168:169], v220 offset:45056
    ds_read_b64_tr_b16 v[170:171], v221 offset:45056
    s_waitcnt lgkmcnt(8)
    v_mfma_f32_32x32x16_bf16 v[48:63], v[128:131], v[160:163], v[48:63]
    ds_read_b64_tr_b16 v[140:141], v218 offset:14336
    ds_read_b64_tr_b16 v[142:143], v219 offset:14336
    ds_read_b64_tr_b16 v[172:173], v220 offset:47104
    ds_read_b64_tr_b16 v[174:175], v221 offset:47104
    s_waitcnt lgkmcnt(8)
    v_mfma_f32_32x32x16_bf16 v[48:63], v[132:135], v[164:167], v[48:63]
    v_permlane16_swap_b32 v176, v178
    v_permlane16_swap_b32_e64 v177, v179
    s_waitcnt lgkmcnt(4)
    v_mfma_f32_32x32x16_bf16 v[48:63], v[136:139], v[168:171], v[48:63]
    v_permlane16_swap_b32 v180, v182
    v_permlane16_swap_b32 v181, v183
    v_permlane16_swap_b32 v184, v186
    s_waitcnt lgkmcnt(0)
    v_mfma_f32_32x32x16_bf16 v[48:63], v[140:143], v[172:175], v[48:63]
    s_barrier
    v_permlane16_swap_b32 v185, v187
    v_permlane16_swap_b32 v188, v190
    v_permlane16_swap_b32 v189, v191
    s_lshl_b32 s76, s62, 11
    s_add_u32 s76, s76, s73
    v_mfma_f32_32x32x16_bf16 v[16:31], v[204:207], v[176:179], 0
    s_add_u32 s76, s76, 4096
    s_lshl_b32 s77, s62, 7
    s_add_u32 s77, s77, s73
    v_lshlrev_b32_e64 v4, 2, v2
    v_mfma_f32_32x32x16_bf16 v[32:47], v[204:207], v[184:187], 0
    v_cvt_pk_bf16_f32 v64, v48, v49
    v_cvt_pk_bf16_f32 v65, v50, v51
    v_cvt_pk_bf16_f32 v66, v52, v53
    v_cvt_pk_bf16_f32 v67, v54, v55
    v_cvt_pk_bf16_f32 v68, v56, v57
    v_mfma_f32_32x32x16_bf16 v[16:31], v[208:211], v[180:183], v[16:31]
    v_cvt_pk_bf16_f32 v69, v58, v59
    v_cvt_pk_bf16_f32 v70, v60, v61
    v_cvt_pk_bf16_f32 v71, v62, v63
    s_bitcmp1_b32 s100, 0
    s_cbranch_scc1 L_loc_48
    buffer_store_dwordx4 v[64:67], v12, s[40:43], s76 offen offset:0 sc1
    buffer_store_dwordx4 v[68:71], v12, s[40:43], s76 offen offset:1024 sc1
    s_branch L_pubd_49
L_loc_48:
    buffer_store_dwordx4 v[64:67], v12, s[40:43], s76 offen offset:0
    buffer_store_dwordx4 v[68:71], v12, s[40:43], s76 offen offset:1024
L_pubd_49:
    v_mfma_f32_32x32x16_bf16 v[32:47], v[208:211], v[188:191], v[32:47]
    v_and_b32 v216, 1, v1
    v_lshlrev_b32_e64 v216, 8, v216
    v_lshl_add_u32 v216, v3, 4, v216
    s_lshl_b32 s76, s64, 7
    v_add_u32 v216, s76, v216
    s_mul_i32 s78, s61, 28800
    s_lshl_b32 s79, s64, 8
    s_add_u32 s78, s78, s79
    s_add_u32 s79, s78, 3686400
    v_dot2_f32_bf16 v72, v112, s89, 0
    v_dot2_f32_bf16 v73, v113, s89, 0
    v_dot2_f32_bf16 v72, v114, s89, v72
    v_dot2_f32_bf16 v73, v115, s89, v73
    v_dot2_f32_bf16 v72, v116, s89, v72
    v_dot2_f32_bf16 v73, v117, s89, v73
    v_dot2_f32_bf16 v72, v118, s89, v72
    v_dot2_f32_bf16 v73, v119, s89, v73
    v_dot2_f32_bf16 v72, v120, s89, v72
    v_dot2_f32_bf16 v73, v121, s89, v73
    v_dot2_f32_bf16 v72, v122, s89, v72
    v_dot2_f32_bf16 v73, v123, s89, v73
    v_dot2_f32_bf16 v72, v124, s89, v72
    v_dot2_f32_bf16 v73, v125, s89, v73
    v_dot2_f32_bf16 v72, v126, s89, v72
    v_dot2_f32_bf16 v73, v127, s89, v73
    v_dot2_f32_bf16 v72, v128, s89, v72
    v_dot2_f32_bf16 v73, v129, s89, v73
    v_dot2_f32_bf16 v72, v130, s89, v72
    v_dot2_f32_bf16 v73, v131, s89, v73
    v_dot2_f32_bf16 v72, v132, s89, v72
    v_dot2_f32_bf16 v73, v133, s89, v73
    v_dot2_f32_bf16 v72, v134, s89, v72
    v_dot2_f32_bf16 v73, v135, s89, v73
    v_dot2_f32_bf16 v72, v136, s89, v72
    v_dot2_f32_bf16 v73, v137, s89, v73
    v_dot2_f32_bf16 v72, v138, s89, v72
    v_dot2_f32_bf16 v73, v139, s89, v73
    v_dot2_f32_bf16 v72, v140, s89, v72
    v_dot2_f32_bf16 v73, v141, s89, v73
    v_dot2_f32_bf16 v72, v142, s89, v72
    v_dot2_f32_bf16 v73, v143, s89, v73
    s_lshl_b32 s76, s98, 7
    v_lshl_add_u32 v10, v3, 3, s76
    v_lshlrev_b32 v11, 5, v1
    v_add_f32 v72, v72, v73
    v_mov_b32 v73, v72
    s_nop 1
    v_permlane32_swap_b32 v72, v73
    v_add_f32 v72, v72, v73
    s_mov_b32 exec_hi, 0
    s_bitcmp1_b32 s100, 0
    s_cbranch_scc1 L_loc_50
    buffer_store_dword v72, v4, s[40:43], s77 offen offset:2048 sc1
    s_branch L_pubd_51
L_loc_50:
    buffer_store_dword v72, v4, s[40:43], s77 offen offset:2048
L_pubd_51:
    s_mov_b64 exec, -1
    v_max3_f32 v160, v16, v17, v18
    v_min3_f32 v162, v16, v17, v18
    v_max3_f32 v160, v160, v19, v20
    v_min3_f32 v162, v162, v19, v20
    v_max3_f32 v160, v160, v21, v22
    v_min3_f32 v162, v162, v21, v22
    v_max3_f32 v160, v160, v23, v24
    v_min3_f32 v162, v162, v23, v24
    v_max3_f32 v160, v160, v25, v26
    v_min3_f32 v162, v162, v25, v26
    v_max3_f32 v160, v160, v27, v28
    v_min3_f32 v162, v162, v27, v28
    v_max3_f32 v160, v160, v29, v30
    v_min3_f32 v162, v162, v29, v30
    v_max_f32 v160, v160, v31
    v_min_f32 v162, v162, v31
    v_max3_f32 v164, v32, v33, v34
    v_min3_f32 v166, v32, v33, v34
    v_max3_f32 v164, v164, v35, v36
    v_min3_f32 v166, v166, v35, v36
    v_max3_f32 v164, v164, v37, v38
    v_min3_f32 v166, v166, v37, v38
    v_max3_f32 v164, v164, v39, v40
    v_min3_f32 v166, v166, v39, v40
    v_max3_f32 v164, v164, v41, v42
    v_min3_f32 v166, v166, v41, v42
    v_max3_f32 v164, v164, v43, v44
    v_min3_f32 v166, v166, v43, v44
    v_max3_f32 v164, v164, v45, v46
    v_min3_f32 v166, v166, v45, v46
    v_max_f32 v164, v164, v47
    v_min_f32 v166, v166, v47
    v_mov_b32 v161, v160
    v_mov_b32 v163, v162
    v_mov_b32 v165, v164
    v_mov_b32 v167, v166
    v_permlane32_swap_b32 v160, v161
    v_permlane32_swap_b32 v162, v163
    v_permlane32_swap_b32 v164, v165
    v_permlane32_swap_b32 v166, v167
    v_max_f32 v160, v160, v161
    v_min_f32 v162, v162, v163
    v_max_f32 v164, v164, v165
    v_min_f32 v166, v166, v167
    v_mul_f32 v160, v160, v251
    v_mul_f32 v162, v162, v251
    v_mul_f32 v164, v164, v253
    v_mul_f32 v166, v166, v253
    v_pk_fma_f32 v[128:129], v[16:17], v[250:251], v[160:161] op_sel:[0,1,0] op_sel_hi:[1,1,0] neg_lo:[0,0,1] neg_hi:[0,0,1]
    v_pk_fma_f32 v[16:17], v[16:17], v[250:251], v[162:163] op_sel:[0,1,0] op_sel_hi:[1,1,0] neg_lo:[0,1,0] neg_hi:[0,1,0]
    v_pk_fma_f32 v[130:131], v[18:19], v[250:251], v[160:161] op_sel:[0,1,0] op_sel_hi:[1,1,0] neg_lo:[0,0,1] neg_hi:[0,0,1]
    v_pk_fma_f32 v[18:19], v[18:19], v[250:251], v[162:163] op_sel:[0,1,0] op_sel_hi:[1,1,0] neg_lo:[0,1,0] neg_hi:[0,1,0]
    v_pk_fma_f32 v[132:133], v[20:21], v[250:251], v[160:161] op_sel:[0,1,0] op_sel_hi:[1,1,0] neg_lo:[0,0,1] neg_hi:[0,0,1]
    v_pk_fma_f32 v[20:21], v[20:21], v[250:251], v[162:163] op_sel:[0,1,0] op_sel_hi:[1,1,0] neg_lo:[0,1,0] neg_hi:[0,1,0]
    v_pk_fma_f32 v[134:135], v[22:23], v[250:251], v[160:161] op_sel:[0,1,0] op_sel_hi:[1,1,0] neg_lo:[0,0,1] neg_hi:[0,0,1]
    v_pk_fma_f32 v[22:23], v[22:23], v[250:251], v[162:163] op_sel:[0,1,0] op_sel_hi:[1,1,0] neg_lo:[0,1,0] neg_hi:[0,1,0]
    v_pk_fma_f32 v[136:137], v[24:25], v[250:251], v[160:161] op_sel:[0,1,0] op_sel_hi:[1,1,0] neg_lo:[0,0,1] neg_hi:[0,0,1]
    v_pk_fma_f32 v[24:25], v[24:25], v[250:251], v[162:163] op_sel:[0,1,0] op_sel_hi:[1,1,0] neg_lo:[0,1,0] neg_hi:[0,1,0]
    v_pk_fma_f32 v[138:139], v[26:27], v[250:251], v[160:161] op_sel:[0,1,0] op_sel_hi:[1,1,0] neg_lo:[0,0,1] neg_hi:[0,0,1]
    v_pk_fma_f32 v[26:27], v[26:27], v[250:251], v[162:163] op_sel:[0,1,0] op_sel_hi:[1,1,0] neg_lo:[0,1,0] neg_hi:[0,1,0]
    v_pk_fma_f32 v[140:141], v[28:29], v[250:251], v[160:161] op_sel:[0,1,0] op_sel_hi:[1,1,0] neg_lo:[0,0,1] neg_hi:[0,0,1]
    v_pk_fma_f32 v[28:29], v[28:29], v[250:251], v[162:163] op_sel:[0,1,0] op_sel_hi:[1,1,0] neg_lo:[0,1,0] neg_hi:[0,1,0]
    v_pk_fma_f32 v[142:143], v[30:31], v[250:251], v[160:161] op_sel:[0,1,0] op_sel_hi:[1,1,0] neg_lo:[0,0,1] neg_hi:[0,0,1]
    v_pk_fma_f32 v[30:31], v[30:31], v[250:251], v[162:163] op_sel:[0,1,0] op_sel_hi:[1,1,0] neg_lo:[0,1,0] neg_hi:[0,1,0]
    v_pk_fma_f32 v[144:145], v[32:33], v[252:253], v[164:165] op_sel:[0,1,0] op_sel_hi:[1,1,0] neg_lo:[0,0,1] neg_hi:[0,0,1]
    v_pk_fma_f32 v[32:33], v[32:33], v[252:253], v[166:167] op_sel:[0,1,0] op_sel_hi:[1,1,0] neg_lo:[0,1,0] neg_hi:[0,1,0]
    v_pk_fma_f32 v[146:147], v[34:35], v[252:253], v[164:165] op_sel:[0,1,0] op_sel_hi:[1,1,0] neg_lo:[0,0,1] neg_hi:[0,0,1]
    v_pk_fma_f32 v[34:35], v[34:35], v[252:253], v[166:167] op_sel:[0,1,0] op_sel_hi:[1,1,0] neg_lo:[0,1,0] neg_hi:[0,1,0]
    v_pk_fma_f32 v[148:149], v[36:37], v[252:253], v[164:165] op_sel:[0,1,0] op_sel_hi:[1,1,0] neg_lo:[0,0,1] neg_hi:[0,0,1]
    v_pk_fma_f32 v[36:37], v[36:37], v[252:253], v[166:167] op_sel:[0,1,0] op_sel_hi:[1,1,0] neg_lo:[0,1,0] neg_hi:[0,1,0]
    v_pk_fma_f32 v[150:151], v[38:39], v[252:253], v[164:165] op_sel:[0,1,0] op_sel_hi:[1,1,0] neg_lo:[0,0,1] neg_hi:[0,0,1]
    v_pk_fma_f32 v[38:39], v[38:39], v[252:253], v[166:167] op_sel:[0,1,0] op_sel_hi:[1,1,0] neg_lo:[0,1,0] neg_hi:[0,1,0]
    v_pk_fma_f32 v[152:153], v[40:41], v[252:253], v[164:165] op_sel:[0,1,0] op_sel_hi:[1,1,0] neg_lo:[0,0,1] neg_hi:[0,0,1]
    v_pk_fma_f32 v[40:41], v[40:41], v[252:253], v[166:167] op_sel:[0,1,0] op_sel_hi:[1,1,0] neg_lo:[0,1,0] neg_hi:[0,1,0]
    v_pk_fma_f32 v[154:155], v[42:43], v[252:253], v[164:165] op_sel:[0,1,0] op_sel_hi:[1,1,0] neg_lo:[0,0,1] neg_hi:[0,0,1]
    v_pk_fma_f32 v[42:43], v[42:43], v[252:253], v[166:167] op_sel:[0,1,0] op_sel_hi:[1,1,0] neg_lo:[0,1,0] neg_hi:[0,1,0]
    v_pk_fma_f32 v[156:157], v[44:45], v[252:253], v[164:165] op_sel:[0,1,0] op_sel_hi:[1,1,0] neg_lo:[0,0,1] neg_hi:[0,0,1]
    v_pk_fma_f32 v[44:45], v[44:45], v[252:253], v[166:167] op_sel:[0,1,0] op_sel_hi:[1,1,0] neg_lo:[0,1,0] neg_hi:[0,1,0]
    v_pk_fma_f32 v[158:159], v[46:47], v[252:253], v[164:165] op_sel:[0,1,0] op_sel_hi:[1,1,0] neg_lo:[0,0,1] neg_hi:[0,0,1]
    v_pk_fma_f32 v[46:47], v[46:47], v[252:253], v[166:167] op_sel:[0,1,0] op_sel_hi:[1,1,0] neg_lo:[0,1,0] neg_hi:[0,1,0]
    v_exp_f32 v128, v128
    v_exp_f32 v16, v16
    v_exp_f32 v129, v129
    v_exp_f32 v17, v17
    v_exp_f32 v130, v130
    v_exp_f32 v18, v18
    v_exp_f32 v131, v131
    v_exp_f32 v19, v19
    v_exp_f32 v132, v132
    v_exp_f32 v20, v20
    v_exp_f32 v133, v133
    v_exp_f32 v21, v21
    v_exp_f32 v134, v134
    v_exp_f32 v22, v22
    v_exp_f32 v135, v135
    v_exp_f32 v23, v23
    v_exp_f32 v136, v136
    v_exp_f32 v24, v24
    v_exp_f32 v137, v137
    v_exp_f32 v25, v25
    v_exp_f32 v138, v138
    v_exp_f32 v26, v26
    v_exp_f32 v139, v139
    v_exp_f32 v27, v27
    v_exp_f32 v140, v140
    v_exp_f32 v28, v28
    v_exp_f32 v141, v141
    v_exp_f32 v29, v29
    v_exp_f32 v142, v142
    v_exp_f32 v30, v30
    v_exp_f32 v143, v143
    v_exp_f32 v31, v31
    v_cvt_pk_bf16_f32 v218, v128, v129
    v_cvt_pk_bf16_f32 v219, v130, v131
    v_cvt_pk_bf16_f32 v220, v132, v133
    v_cvt_pk_bf16_f32 v221, v134, v135
    v_cvt_pk_bf16_f32 v222, v136, v137
    v_cvt_pk_bf16_f32 v223, v138, v139
    v_cvt_pk_bf16_f32 v224, v140, v141
    v_cvt_pk_bf16_f32 v225, v142, v143
    v_cvt_pk_bf16_f32 v226, v16, v17
    v_cvt_pk_bf16_f32 v227, v18, v19
    v_cvt_pk_bf16_f32 v228, v20, v21
    v_cvt_pk_bf16_f32 v229, v22, v23
    v_cvt_pk_bf16_f32 v230, v24, v25
    v_cvt_pk_bf16_f32 v231, v26, v27
    v_cvt_pk_bf16_f32 v232, v28, v29
    v_cvt_pk_bf16_f32 v233, v30, v31
    v_exp_f32 v144, v144
    v_exp_f32 v32, v32
    v_exp_f32 v145, v145
    v_exp_f32 v33, v33
    v_exp_f32 v146, v146
    v_exp_f32 v34, v34
    v_exp_f32 v147, v147
    v_exp_f32_e64 v35, v35
    s_barrier
    buffer_load_dwordx4 v[48:51], v13, s[40:43], s78 offen offset:3072 sc1
    buffer_load_dwordx4 v[52:55], v13, s[40:43], s79 offen offset:3072 sc1
    buffer_load_dwordx4 v[56:59], v13, s[40:43], s78 offen offset:3200 sc1
    buffer_load_dwordx4 v[60:63], v13, s[40:43], s79 offen offset:3200 sc1
    ds_read_b128 v[168:171], v216 offset:24576
    ds_read_b128 v[172:175], v216 offset:24608
    ds_read_b128 v[176:179], v216 offset:24640
    ds_read_b128 v[180:183], v216 offset:24672
    v_exp_f32 v148, v148
    v_exp_f32 v36, v36
    v_exp_f32 v149, v149
    v_exp_f32 v37, v37
    v_exp_f32 v150, v150
    v_exp_f32 v38, v38
    v_exp_f32 v151, v151
    v_exp_f32 v39, v39
    v_exp_f32 v152, v152
    v_exp_f32_e64 v40, v40
    s_waitcnt lgkmcnt(0)
    v_mfma_f32_32x32x16_bf16 v[64:79], v[168:171], v[218:221], 0
    v_exp_f32 v153, v153
    v_exp_f32 v41, v41
    v_exp_f32_e64 v154, v154
    v_mfma_f32_32x32x16_bf16 v[80:95], v[176:179], v[226:229], 0
    v_exp_f32 v42, v42
    v_exp_f32 v155, v155
    v_exp_f32_e64 v43, v43
    v_mfma_f32_32x32x16_bf16 v[64:79], v[172:175], v[222:225], v[64:79]
    v_exp_f32 v156, v156
    v_exp_f32 v44, v44
    v_exp_f32_e64 v157, v157
    v_mfma_f32_32x32x16_bf16 v[80:95], v[180:183], v[230:233], v[80:95]
    v_exp_f32 v45, v45
    v_exp_f32 v158, v158
    v_exp_f32 v46, v46
    v_exp_f32 v159, v159
    v_exp_f32_e64 v47, v47
    v_cvt_pk_bf16_f32 v234, v144, v145
    v_cvt_pk_bf16_f32 v235, v146, v147
    v_cvt_pk_bf16_f32 v236, v148, v149
    v_cvt_pk_bf16_f32 v237, v150, v151
    v_cvt_pk_bf16_f32 v238, v152, v153
    v_cvt_pk_bf16_f32 v239, v154, v155
    v_cvt_pk_bf16_f32 v240, v156, v157
    v_cvt_pk_bf16_f32 v241, v158, v159
    v_cvt_pk_bf16_f32 v242, v32, v33
    v_cvt_pk_bf16_f32 v243, v34, v35
    v_cvt_pk_bf16_f32 v244, v36, v37
    v_cvt_pk_bf16_f32 v245, v38, v39
    v_cvt_pk_bf16_f32 v246, v40, v41
    v_cvt_pk_bf16_f32 v247, v42, v43
    v_cvt_pk_bf16_f32 v248, v44, v45
    v_cvt_pk_bf16_f32 v249, v46, v47
    v_mfma_f32_32x32x16_bf16 v[96:111], v[168:171], v[234:237], 0
    v_rcp_f32 v184, v65
    v_rcp_f32 v185, v81
    v_mul_f32 v6, v64, v184
    v_fmac_f32 v6, v80, v185
    v_add_f32 v6, 0x358637bd, v6
    v_mfma_f32_32x32x16_bf16 v[112:127], v[176:179], v[242:245], 0
    v_rcp_f32 v6, v6
    v_mov_b32 v8, 0
    v_mul_f32 v184, v184, v6
    v_mul_f32_e64 v185, v185, v6
    s_lshl4_add_u32 s76, s60, s61
    v_mfma_f32_32x32x16_bf16 v[96:111], v[172:175], v[238:241], v[96:111]
    s_mul_i32 s76, s76, 32768
    s_lshl2_add_u32 s77, s63, s64
    s_lshl_b32 s77, s77, 12
    s_add_u32 s76, s76, s77
    s_add_u32 s76, s76, 16777216
    v_mfma_f32_32x32x16_bf16 v[112:127], v[180:183], v[246:249], v[112:127]
    s_add_u32 s77, s76, 8192
    v_add_u32 v14, 128, v12
    v_cmp_gt_u32 vcc, 24, v1
    s_nop 0
    s_nop 0
    v_cndmask_b32_e64 v14, v14, v12, vcc
    s_mov_b32 s88, 0
    s_branch L_pfirst_53
L_poll_52:
    buffer_load_dwordx4 v[48:51], v13, s[40:43], s78 offen offset:3072 sc1
    buffer_load_dwordx4 v[52:55], v13, s[40:43], s79 offen offset:3072 sc1
    buffer_load_dwordx4 v[56:59], v13, s[40:43], s78 offen offset:3200 sc1
    buffer_load_dwordx4 v[60:63], v13, s[40:43], s79 offen offset:3200 sc1
L_pfirst_53:
    s_waitcnt vmcnt(0)
    v_max3_u32 v9, v48, v49, v50
    v_max3_u32 v9, v9, v51, v52
    v_max3_u32 v9, v9, v53, v54
    v_max3_u32 v9, v9, v55, v56
    v_max3_u32 v9, v9, v57, v58
    v_max3_u32 v9, v9, v59, v60
    v_max3_u32 v9, v9, v61, v62
    v_max_u32 v9, v9, v63
    v_cmp_eq_u32 vcc, -1, v9
    s_nop 0
    s_cbranch_vccz L_ok_54
    s_add_u32 s88, s88, 1
    s_cmp_lt_u32 s88, 65536
    s_cbranch_scc1 L_poll_52
L_ok_54:
    v_mfma_f32_32x32x16_bf16 v[16:31], v[48:51], v[218:221], 0
    s_barrier
    v_rcp_f32 v186, v97
    v_rcp_f32 v187, v113
    v_mul_f32 v7, v96, v186
    v_fmac_f32 v7, v112, v187
    v_mfma_f32_32x32x16_bf16 v[128:143], v[56:59], v[226:229], 0
    v_add_f32 v7, 0x358637bd, v7
    v_rcp_f32 v7, v7
    v_mov_b32 v8, 0
    v_mul_f32_e64 v186, v186, v7
    v_mfma_f32_32x32x16_bf16 v[16:31], v[52:55], v[222:225], v[16:31]
    v_mul_f32_e64 v187, v187, v7
    global_load_dwordx2 v[192:193], v10, s[14:15] offset:0
    global_load_dwordx2 v[194:195], v10, s[14:15] offset:16
    global_load_dwordx2 v[196:197], v10, s[14:15] offset:32
    v_mfma_f32_32x32x16_bf16 v[128:143], v[60:63], v[230:233], v[128:143]
    global_load_dwordx2 v[198:199], v10, s[14:15] offset:48
    global_load_dwordx2 v[200:201], v10, s[14:15] offset:64
    global_load_dwordx2 v[202:203], v10, s[14:15] offset:80
    global_load_dwordx2 v[204:205], v10, s[14:15] offset:96
    v_mfma_f32_32x32x16_bf16 v[32:47], v[48:51], v[234:237], 0
    global_load_dwordx2 v[206:207], v10, s[14:15] offset:112
    global_load_dwordx4 v[208:211], v11, s[14:15] offset:0
    global_load_dwordx4 v[212:215], v11, s[14:15] offset:16
    v_mfma_f32_32x32x16_bf16 v[144:159], v[56:59], v[242:245], 0
    v_mul_f32 v16, v16, v184
    v_mul_f32 v17, v17, v184
    v_mul_f32 v18, v18, v184
    v_mul_f32 v19, v19, v184
    v_mul_f32 v20, v20, v184
    v_mul_f32 v21, v21, v184
    v_mfma_f32_32x32x16_bf16 v[32:47], v[52:55], v[238:241], v[32:47]
    v_mul_f32 v22, v22, v184
    v_mul_f32 v23, v23, v184
    v_mul_f32 v24, v24, v184
    v_mul_f32 v25, v25, v184
    v_mul_f32 v26, v26, v184
    v_mul_f32 v27, v27, v184
    v_mfma_f32_32x32x16_bf16 v[144:159], v[60:63], v[246:249], v[144:159]
    v_mul_f32 v28, v28, v184
    v_mul_f32 v29, v29, v184
    v_mul_f32 v30, v30, v184
    v_mul_f32 v31, v31, v184
    v_fmac_f32 v16, v128, v185
    v_fmac_f32 v17, v129, v185
    v_cvt_pk_bf16_f32 v64, v16, v17
    v_fmac_f32 v18, v130, v185
    v_fmac_f32 v19, v131, v185
    v_cvt_pk_bf16_f32 v65, v18, v19
    v_fmac_f32 v20, v132, v185
    v_fmac_f32 v21, v133, v185
    v_cvt_pk_bf16_f32 v66, v20, v21
    v_fmac_f32 v22, v134, v185
    v_fmac_f32 v23, v135, v185
    v_cvt_pk_bf16_f32 v67, v22, v23
    buffer_store_dwordx4 v[64:67], v14, s[40:43], s76 offen offset:0 sc1
    v_fmac_f32 v24, v136, v185
    v_fmac_f32 v25, v137, v185
    v_cvt_pk_bf16_f32 v68, v24, v25
    v_fmac_f32 v26, v138, v185
    v_fmac_f32 v27, v139, v185
    v_cvt_pk_bf16_f32 v69, v26, v27
    v_fmac_f32 v28, v140, v185
    v_fmac_f32 v29, v141, v185
    v_cvt_pk_bf16_f32 v70, v28, v29
    v_fmac_f32 v30, v142, v185
    v_fmac_f32 v31, v143, v185
    v_cvt_pk_bf16_f32 v71, v30, v31
    buffer_store_dwordx4 v[68:71], v14, s[40:43], s76 offen offset:2048 sc1
    v_pk_mul_f32 v[32:33], v[32:33], v[186:187] op_sel_hi:[1,0]
    v_pk_fma_f32 v[32:33], v[144:145], v[186:187], v[32:33] op_sel:[0,1,0] op_sel_hi:[1,1,1]
    v_cvt_pk_bf16_f32 v72, v32, v33
    v_pk_mul_f32 v[34:35], v[34:35], v[186:187] op_sel_hi:[1,0]
    v_pk_fma_f32 v[34:35], v[146:147], v[186:187], v[34:35] op_sel:[0,1,0] op_sel_hi:[1,1,1]
    v_cvt_pk_bf16_f32 v73, v34, v35
    v_pk_mul_f32 v[36:37], v[36:37], v[186:187] op_sel_hi:[1,0]
    v_pk_fma_f32 v[36:37], v[148:149], v[186:187], v[36:37] op_sel:[0,1,0] op_sel_hi:[1,1,1]
    v_cvt_pk_bf16_f32 v74, v36, v37
    v_pk_mul_f32 v[38:39], v[38:39], v[186:187] op_sel_hi:[1,0]
    v_pk_fma_f32 v[38:39], v[150:151], v[186:187], v[38:39] op_sel:[0,1,0] op_sel_hi:[1,1,1]
    v_cvt_pk_bf16_f32 v75, v38, v39
    buffer_store_dwordx4 v[72:75], v14, s[40:43], s77 offen offset:0 sc1
    v_pk_mul_f32 v[40:41], v[40:41], v[186:187] op_sel_hi:[1,0]
    v_pk_fma_f32 v[40:41], v[152:153], v[186:187], v[40:41] op_sel:[0,1,0] op_sel_hi:[1,1,1]
    v_cvt_pk_bf16_f32 v76, v40, v41
    v_pk_mul_f32 v[42:43], v[42:43], v[186:187] op_sel_hi:[1,0]
    v_pk_fma_f32 v[42:43], v[154:155], v[186:187], v[42:43] op_sel:[0,1,0] op_sel_hi:[1,1,1]
    v_cvt_pk_bf16_f32 v77, v42, v43
    v_pk_mul_f32 v[44:45], v[44:45], v[186:187] op_sel_hi:[1,0]
    v_pk_fma_f32 v[44:45], v[156:157], v[186:187], v[44:45] op_sel:[0,1,0] op_sel_hi:[1,1,1]
    v_cvt_pk_bf16_f32 v78, v44, v45
    v_pk_mul_f32 v[46:47], v[46:47], v[186:187] op_sel_hi:[1,0]
    v_pk_fma_f32 v[46:47], v[158:159], v[186:187], v[46:47] op_sel:[0,1,0] op_sel_hi:[1,1,1]
    v_cvt_pk_bf16_f32 v79, v46, v47
    buffer_store_dwordx4 v[76:79], v14, s[40:43], s77 offen offset:2048 sc1
    v_bfe_u32 v4, v2, 1, 3
    v_lshlrev_b32_e64 v4, 4, v4
    v_lshl_add_u32 v4, v3, 3, v4
    v_lshl_add_u32 v4, v2, 7, v4
    s_lshl_b32 s76, s62, 12
    s_add_u32 s77, s76, 0
    v_add_u32 v64, s77, v4
    v_xor_b32 v65, 16, v64
    v_xor_b32 v66, 32, v64
    v_xor_b32 v67, 48, v64
    v_xor_b32_e64 v68, 64, v64
    v_xor_b32 v69, 80, v64
    v_xor_b32 v70, 96, v64
    v_xor_b32 v71, 112, v64
    v_bfe_u32 v4, v1, 2, 2
    v_lshl_add_u32 v5, v3, 2, v4
    v_lshlrev_b32 v5, 7, v5
    v_lshrrev_b32 v4, 1, v4
    v_lshl_add_u32 v5, v4, 6, v5
    v_bfe_u32 v4, v1, 4, 1
    v_lshl_add_u32 v5, v4, 5, v5
    v_and_b32_e64 v4, 3, v1
    v_lshl_add_u32 v5, v4, 3, v5
    v_add_u32 v72, 32768, v5
    v_xor_b32_e64 v73, 64, v72
    s_mul_i32 s80, s97, 524288
    s_mul_i32 s76, s62, 8192
    s_add_u32 s80, s80, s76
    s_add_u32 s80, s80, 16777216
    v_add_u32 v78, 4096, v14
    v_mov_b32 v74, 1
    s_mov_b32 s52, 0xffff
    s_mov_b32 s53, 0
    s_barrier
    ds_read_b32 v79, v8 offset:25984
    ds_read_b64 v[88:89], v64
    ds_read_b64 v[90:91], v65
    ds_read_b64 v[92:93], v66
    ds_read_b64 v[94:95], v67
    ds_read_b64 v[96:97], v68
    ds_read_b64 v[98:99], v69
    ds_read_b64 v[100:101], v70
    ds_read_b64 v[102:103], v71
    s_waitcnt lgkmcnt(8)
    v_readfirstlane_b32 s76, v79
    s_nop 0
    s_and_b32 s76, s76, s52
    s_cbranch_scc0 L_tr0
L_bk0:
    s_ff1_i32_b32 s76, s76
    s_bitset0_b32 s52, s76
    s_add_u32 s77, s76, s65
    s_and_b32 s77, s77, 15
    s_mul_i32 s77, s77, 32768
    s_add_u32 s28, s77, s80
    s_add_u32 s76, s76, 3
    s_and_b32 s76, s76, 15
    s_lshl_b32 s4, s76, 13
    buffer_load_dwordx4 v[128:131], v14, s[40:43], s28 offen offset:0 sc1
    buffer_load_dwordx4 v[132:135], v14, s[40:43], s28 offen offset:2048 sc1
    buffer_load_dwordx4 v[136:139], v78, s[40:43], s28 offen offset:0 sc1
    buffer_load_dwordx4 v[140:143], v78, s[40:43], s28 offen offset:2048 sc1
    v_readfirstlane_b32 s76, v79
    s_nop 0
    s_and_b32 s76, s76, s52
    s_cbranch_scc0 L_tr1
L_bk1:
    s_ff1_i32_b32 s76, s76
    s_bitset0_b32 s52, s76
    s_add_u32 s77, s76, s65
    s_and_b32 s77, s77, 15
    s_mul_i32 s77, s77, 32768
    s_add_u32 s29, s77, s80
    s_add_u32 s76, s76, 3
    s_and_b32 s76, s76, 15
    s_lshl_b32 s5, s76, 13
    buffer_load_dwordx4 v[144:147], v14, s[40:43], s29 offen offset:0 sc1
    buffer_load_dwordx4 v[148:151], v14, s[40:43], s29 offen offset:2048 sc1
    v_add_u32 v80, s4, v72
    v_add_u32 v81, s4, v73
    s_waitcnt lgkmcnt(0)
    v_lshlrev_b32 v16, 16, v88
    v_and_b32 v17, s90, v88
    v_lshlrev_b32 v18, 16, v89
    v_and_b32 v19, s90, v89
    v_lshlrev_b32 v20, 16, v90
    v_and_b32 v21, s90, v90
    v_lshlrev_b32 v22, 16, v91
    v_and_b32 v23, s90, v91
    v_lshlrev_b32 v24, 16, v92
    v_and_b32 v25, s90, v92
    v_lshlrev_b32 v26, 16, v93
    v_and_b32 v27, s90, v93
    v_lshlrev_b32 v28, 16, v94
    v_and_b32 v29, s90, v94
    v_lshlrev_b32 v30, 16, v95
    v_and_b32 v31, s90, v95
    v_lshlrev_b32 v32, 16, v96
    v_and_b32 v33, s90, v96
    v_lshlrev_b32 v34, 16, v97
    v_and_b32 v35, s90, v97
    v_lshlrev_b32 v36, 16, v98
    v_and_b32 v37, s90, v98
    v_lshlrev_b32 v38, 16, v99
    v_and_b32 v39, s90, v99
    v_lshlrev_b32 v40, 16, v100
    v_and_b32 v41, s90, v100
    v_lshlrev_b32 v42, 16, v101
    v_and_b32 v43, s90, v101
    v_lshlrev_b32 v44, 16, v102
    v_and_b32 v45, s90, v102
    v_lshlrev_b32 v46, 16, v103
    v_and_b32 v47, s90, v103
    s_cmp_eq_u32 s53, 0
    s_cbranch_scc0 L_sent_55
    s_waitcnt vmcnt(6)
    s_mov_b64 exec, 1
    ds_add_u32 v8, v74 offset:25988
    s_mov_b64 exec, -1
    s_mov_b32 s53, 1
L_sent_55:
    ds_read_b32 v79, v8 offset:25984
    ds_read_b64_tr_b16 v[104:105], v80 offset:0
    ds_read_b64_tr_b16 v[106:107], v80 offset:1024
    ds_read_b64_tr_b16 v[108:109], v81 offset:0
    ds_read_b64_tr_b16 v[110:111], v81 offset:1024
    ds_read_b64_tr_b16 v[112:113], v80 offset:2048
    ds_read_b64_tr_b16 v[114:115], v80 offset:3072
    ds_read_b64_tr_b16 v[116:117], v81 offset:2048
    ds_read_b64_tr_b16 v[118:119], v81 offset:3072
    s_waitcnt vmcnt(5) lgkmcnt(4)
    v_mfma_f32_32x32x16_bf16 v[16:31], v[104:107], v[128:131], v[16:31]
    ds_read_b64_tr_b16 v[120:121], v80 offset:4096
    ds_read_b64_tr_b16 v[122:123], v80 offset:5120
    buffer_load_dwordx4 v[152:155], v78, s[40:43], s29 offen offset:0 sc1
    v_mfma_f32_32x32x16_bf16 v[32:47], v[108:111], v[128:131], v[32:47]
    ds_read_b64_tr_b16 v[124:125], v81 offset:4096
    ds_read_b64_tr_b16 v[126:127], v81 offset:5120
    buffer_load_dwordx4 v[156:159], v78, s[40:43], s29 offen offset:2048 sc1
    v_readfirstlane_b32 s76, v79
    s_nop 0
    s_and_b32 s76, s76, s52
    s_cbranch_scc0 L_tr2
L_bk2:
    s_ff1_i32_b32 s76, s76
    s_bitset0_b32 s52, s76
    s_add_u32 s77, s76, s65
    s_and_b32 s77, s77, 15
    s_mul_i32 s77, s77, 32768
    s_add_u32 s30, s77, s80
    s_waitcnt vmcnt(6) lgkmcnt(4)
    v_mfma_f32_32x32x16_bf16 v[16:31], v[112:115], v[132:135], v[16:31]
    ds_read_b32 v79, v8 offset:25984
    ds_read_b64_tr_b16 v[104:105], v80 offset:6144
    ds_read_b64_tr_b16 v[106:107], v80 offset:7168
    buffer_load_dwordx4 v[160:163], v14, s[40:43], s30 offen offset:0 sc1
    s_add_u32 s76, s76, 3
    s_and_b32 s76, s76, 15
    s_lshl_b32 s6, s76, 13
    v_mfma_f32_32x32x16_bf16 v[32:47], v[116:119], v[132:135], v[32:47]
    ds_read_b64_tr_b16 v[108:109], v81 offset:6144
    ds_read_b64_tr_b16 v[110:111], v81 offset:7168
    buffer_load_dwordx4 v[164:167], v14, s[40:43], s30 offen offset:2048 sc1
    v_add_u32 v82, s5, v72
    v_add_u32_e64 v83, s5, v73
    s_waitcnt vmcnt(7) lgkmcnt(4)
    v_mfma_f32_32x32x16_bf16 v[16:31], v[120:123], v[136:139], v[16:31]
    ds_read_b64_tr_b16 v[112:113], v82 offset:0
    ds_read_b64_tr_b16 v[114:115], v82 offset:1024
    buffer_load_dwordx4 v[168:171], v78, s[40:43], s30 offen offset:0 sc1
    v_mfma_f32_32x32x16_bf16 v[32:47], v[124:127], v[136:139], v[32:47]
    ds_read_b64_tr_b16 v[116:117], v83 offset:0
    ds_read_b64_tr_b16 v[118:119], v83 offset:1024
    buffer_load_dwordx4 v[172:175], v78, s[40:43], s30 offen offset:2048 sc1
    v_readfirstlane_b32 s76, v79
    s_nop 0
    s_and_b32 s76, s76, s52
    s_cbranch_scc0 L_tr3
L_bk3:
    s_ff1_i32_b32 s76, s76
    s_bitset0_b32 s52, s76
    s_add_u32 s77, s76, s65
    s_and_b32 s77, s77, 15
    s_mul_i32 s77, s77, 32768
    s_add_u32 s31, s77, s80
    s_waitcnt vmcnt(8) lgkmcnt(4)
    v_mfma_f32_32x32x16_bf16 v[16:31], v[104:107], v[140:143], v[16:31]
    ds_read_b32 v79, v8 offset:25984
    ds_read_b64_tr_b16 v[120:121], v82 offset:2048
    ds_read_b64_tr_b16 v[122:123], v82 offset:3072
    buffer_load_dwordx4 v[176:179], v14, s[40:43], s31 offen offset:0 sc1
    s_add_u32 s76, s76, 3
    s_and_b32 s76, s76, 15
    s_lshl_b32 s7, s76, 13
    v_mfma_f32_32x32x16_bf16 v[32:47], v[108:111], v[140:143], v[32:47]
    ds_read_b64_tr_b16 v[124:125], v83 offset:2048
    ds_read_b64_tr_b16 v[126:127], v83 offset:3072
    buffer_load_dwordx4 v[180:183], v14, s[40:43], s31 offen offset:2048 sc1
    s_waitcnt vmcnt(9) lgkmcnt(4)
    v_mfma_f32_32x32x16_bf16 v[16:31], v[112:115], v[144:147], v[16:31]
    ds_read_b64_tr_b16 v[104:105], v82 offset:4096
    ds_read_b64_tr_b16 v[106:107], v82 offset:5120
    buffer_load_dwordx4 v[184:187], v78, s[40:43], s31 offen offset:0 sc1
    v_mfma_f32_32x32x16_bf16 v[32:47], v[116:119], v[144:147], v[32:47]
    ds_read_b64_tr_b16 v[108:109], v83 offset:4096
    ds_read_b64_tr_b16 v[110:111], v83 offset:5120
    buffer_load_dwordx4 v[188:191], v78, s[40:43], s31 offen offset:2048 sc1
    v_readfirstlane_b32 s76, v79
    s_nop 0
    s_and_b32 s76, s76, s52
    s_cbranch_scc0 L_tr4
L_bk4:
    s_ff1_i32_b32 s76, s76
    s_bitset0_b32 s52, s76
    s_add_u32 s77, s76, s65
    s_and_b32 s77, s77, 15
    s_mul_i32 s77, s77, 32768
    s_add_u32 s32, s77, s80
    s_waitcnt vmcnt(10) lgkmcnt(4)
    v_mfma_f32_32x32x16_bf16 v[16:31], v[120:123], v[148:151], v[16:31]
    ds_read_b64_tr_b16 v[112:113], v82 offset:6144
    ds_read_b64_tr_b16 v[114:115], v82 offset:7168
    buffer_load_dwordx4 v[128:131], v14, s[40:43], s32 offen offset:0 sc1
    s_add_u32 s76, s76, 3
    s_and_b32 s76, s76, 15
    s_lshl_b32 s8, s76, 13
    v_mfma_f32_32x32x16_bf16 v[32:47], v[124:127], v[148:151], v[32:47]
    ds_read_b64_tr_b16 v[116:117], v83 offset:6144
    ds_read_b64_tr_b16 v[118:119], v83 offset:7168
    buffer_load_dwordx4 v[132:135], v14, s[40:43], s32 offen offset:2048 sc1
    v_add_u32 v80, s6, v72
    v_add_u32 v81, s6, v73
    s_waitcnt vmcnt(11) lgkmcnt(4)
    v_mfma_f32_32x32x16_bf16 v[16:31], v[104:107], v[152:155], v[16:31]
    ds_read_b32 v79, v8 offset:25984
    ds_read_b64_tr_b16 v[120:121], v80 offset:0
    ds_read_b64_tr_b16 v[122:123], v80 offset:1024
    buffer_load_dwordx4 v[136:139], v78, s[40:43], s32 offen offset:0 sc1
    v_mfma_f32_32x32x16_bf16 v[32:47], v[108:111], v[152:155], v[32:47]
    ds_read_b64_tr_b16 v[124:125], v81 offset:0
    ds_read_b64_tr_b16 v[126:127], v81 offset:1024
    s_waitcnt vmcnt(11) lgkmcnt(4)
    v_mfma_f32_32x32x16_bf16 v[16:31], v[112:115], v[156:159], v[16:31]
    ds_read_b64_tr_b16 v[104:105], v80 offset:2048
    ds_read_b64_tr_b16 v[106:107], v80 offset:3072
    buffer_load_dwordx4 v[140:143], v78, s[40:43], s32 offen offset:2048 sc1
    v_mfma_f32_32x32x16_bf16 v[32:47], v[116:119], v[156:159], v[32:47]
    ds_read_b64_tr_b16 v[108:109], v81 offset:2048
    ds_read_b64_tr_b16 v[110:111], v81 offset:3072
    v_readfirstlane_b32 s76, v79
    s_nop 0
    s_and_b32 s76, s76, s52
    s_cbranch_scc0 L_tr5
L_bk5:
    s_ff1_i32_b32 s76, s76
    s_bitset0_b32 s52, s76
    s_add_u32 s77, s76, s65
    s_and_b32 s77, s77, 15
    s_mul_i32 s77, s77, 32768
    s_add_u32 s33, s77, s80
    s_waitcnt vmcnt(11) lgkmcnt(4)
    v_mfma_f32_32x32x16_bf16 v[16:31], v[120:123], v[160:163], v[16:31]
    ds_read_b64_tr_b16 v[112:113], v80 offset:4096
    ds_read_b64_tr_b16 v[114:115], v80 offset:5120
    buffer_load_dwordx4 v[144:147], v14, s[40:43], s33 offen offset:0 sc1
    s_add_u32 s76, s76, 3
    s_and_b32 s76, s76, 15
    s_lshl_b32 s9, s76, 13
    v_mfma_f32_32x32x16_bf16 v[32:47], v[124:127], v[160:163], v[32:47]
    ds_read_b64_tr_b16 v[116:117], v81 offset:4096
    ds_read_b64_tr_b16 v[118:119], v81 offset:5120
    s_waitcnt vmcnt(11) lgkmcnt(4)
    v_mfma_f32_32x32x16_bf16 v[16:31], v[104:107], v[164:167], v[16:31]
    ds_read_b64_tr_b16 v[120:121], v80 offset:6144
    ds_read_b64_tr_b16 v[122:123], v80 offset:7168
    buffer_load_dwordx4 v[148:151], v14, s[40:43], s33 offen offset:2048 sc1
    v_mfma_f32_32x32x16_bf16 v[32:47], v[108:111], v[164:167], v[32:47]
    ds_read_b64_tr_b16 v[124:125], v81 offset:6144
    ds_read_b64_tr_b16 v[126:127], v81 offset:7168
    v_add_u32 v82, s7, v72
    v_add_u32 v83, s7, v73
    s_waitcnt vmcnt(11) lgkmcnt(4)
    v_mfma_f32_32x32x16_bf16 v[16:31], v[112:115], v[168:171], v[16:31]
    ds_read_b32 v79, v8 offset:25984
    ds_read_b64_tr_b16 v[104:105], v82 offset:0
    ds_read_b64_tr_b16 v[106:107], v82 offset:1024
    buffer_load_dwordx4 v[152:155], v78, s[40:43], s33 offen offset:0 sc1
    v_mfma_f32_32x32x16_bf16 v[32:47], v[116:119], v[168:171], v[32:47]
    ds_read_b64_tr_b16 v[108:109], v83 offset:0
    ds_read_b64_tr_b16 v[110:111], v83 offset:1024
    s_waitcnt vmcnt(11) lgkmcnt(4)
    v_mfma_f32_32x32x16_bf16 v[16:31], v[120:123], v[172:175], v[16:31]
    ds_read_b64_tr_b16 v[112:113], v82 offset:2048
    ds_read_b64_tr_b16 v[114:115], v82 offset:3072
    buffer_load_dwordx4 v[156:159], v78, s[40:43], s33 offen offset:2048 sc1
    v_mfma_f32_32x32x16_bf16 v[32:47], v[124:127], v[172:175], v[32:47]
    ds_read_b64_tr_b16 v[116:117], v83 offset:2048
    ds_read_b64_tr_b16 v[118:119], v83 offset:3072
    v_readfirstlane_b32 s76, v79
    s_nop 0
    s_and_b32 s76, s76, s52
    s_cbranch_scc0 L_tr6
L_bk6:
    s_ff1_i32_b32 s76, s76
    s_bitset0_b32 s52, s76
    s_add_u32 s77, s76, s65
    s_and_b32 s77, s77, 15
    s_mul_i32 s77, s77, 32768
    s_add_u32 s34, s77, s80
    s_waitcnt vmcnt(11) lgkmcnt(4)
    v_mfma_f32_32x32x16_bf16 v[16:31], v[104:107], v[176:179], v[16:31]
    ds_read_b64_tr_b16 v[120:121], v82 offset:4096
    ds_read_b64_tr_b16 v[122:123], v82 offset:5120
    buffer_load_dwordx4 v[160:163], v14, s[40:43], s34 offen offset:0 sc1
    s_add_u32 s76, s76, 3
    s_and_b32 s76, s76, 15
    s_lshl_b32 s10, s76, 13
    v_mfma_f32_32x32x16_bf16 v[32:47], v[108:111], v[176:179], v[32:47]
    ds_read_b64_tr_b16 v[124:125], v83 offset:4096
    ds_read_b64_tr_b16 v[126:127], v83 offset:5120
    s_waitcnt vmcnt(11) lgkmcnt(4)
    v_mfma_f32_32x32x16_bf16 v[16:31], v[112:115], v[180:183], v[16:31]
    ds_read_b64_tr_b16 v[104:105], v82 offset:6144
    ds_read_b64_tr_b16 v[106:107], v82 offset:7168
    buffer_load_dwordx4 v[164:167], v14, s[40:43], s34 offen offset:2048 sc1
    v_mfma_f32_32x32x16_bf16 v[32:47], v[116:119], v[180:183], v[32:47]
    ds_read_b64_tr_b16 v[108:109], v83 offset:6144
    ds_read_b64_tr_b16 v[110:111], v83 offset:7168
    v_add_u32 v80, s8, v72
    v_add_u32 v81, s8, v73
    s_waitcnt vmcnt(11) lgkmcnt(4)
    v_mfma_f32_32x32x16_bf16 v[16:31], v[120:123], v[184:187], v[16:31]
    ds_read_b32 v79, v8 offset:25984
    ds_read_b64_tr_b16 v[112:113], v80 offset:0
    ds_read_b64_tr_b16 v[114:115], v80 offset:1024
    buffer_load_dwordx4 v[168:171], v78, s[40:43], s34 offen offset:0 sc1
    v_mfma_f32_32x32x16_bf16 v[32:47], v[124:127], v[184:187], v[32:47]
    ds_read_b64_tr_b16 v[116:117], v81 offset:0
    ds_read_b64_tr_b16 v[118:119], v81 offset:1024
    s_waitcnt vmcnt(11) lgkmcnt(4)
    v_mfma_f32_32x32x16_bf16 v[16:31], v[104:107], v[188:191], v[16:31]
    ds_read_b64_tr_b16 v[120:121], v80 offset:2048
    ds_read_b64_tr_b16 v[122:123], v80 offset:3072
    buffer_load_dwordx4 v[172:175], v78, s[40:43], s34 offen offset:2048 sc1
    v_mfma_f32_32x32x16_bf16 v[32:47], v[108:111], v[188:191], v[32:47]
    ds_read_b64_tr_b16 v[124:125], v81 offset:2048
    ds_read_b64_tr_b16 v[126:127], v81 offset:3072
    v_readfirstlane_b32 s76, v79
    s_nop 0
    s_and_b32 s76, s76, s52
    s_cbranch_scc0 L_tr7
L_bk7:
    s_ff1_i32_b32 s76, s76
    s_bitset0_b32 s52, s76
    s_add_u32 s77, s76, s65
    s_and_b32 s77, s77, 15
    s_mul_i32 s77, s77, 32768
    s_add_u32 s35, s77, s80
    s_waitcnt vmcnt(11) lgkmcnt(4)
    v_mfma_f32_32x32x16_bf16 v[16:31], v[112:115], v[128:131], v[16:31]
    ds_read_b64_tr_b16 v[104:105], v80 offset:4096
    ds_read_b64_tr_b16 v[106:107], v80 offset:5120
    buffer_load_dwordx4 v[176:179], v14, s[40:43], s35 offen offset:0 sc1
    s_add_u32 s76, s76, 3
    s_and_b32 s76, s76, 15
    s_lshl_b32 s11, s76, 13
    v_mfma_f32_32x32x16_bf16 v[32:47], v[116:119], v[128:131], v[32:47]
    ds_read_b64_tr_b16 v[108:109], v81 offset:4096
    ds_read_b64_tr_b16 v[110:111], v81 offset:5120
    s_waitcnt vmcnt(11) lgkmcnt(4)
    v_mfma_f32_32x32x16_bf16 v[16:31], v[120:123], v[132:135], v[16:31]
    ds_read_b64_tr_b16 v[112:113], v80 offset:6144
    ds_read_b64_tr_b16 v[114:115], v80 offset:7168
    buffer_load_dwordx4 v[180:183], v14, s[40:43], s35 offen offset:2048 sc1
    v_mfma_f32_32x32x16_bf16 v[32:47], v[124:127], v[132:135], v[32:47]
    ds_read_b64_tr_b16 v[116:117], v81 offset:6144
    ds_read_b64_tr_b16 v[118:119], v81 offset:7168
    v_add_u32 v82, s9, v72
    v_add_u32 v83, s9, v73
    s_waitcnt vmcnt(11) lgkmcnt(4)
    v_mfma_f32_32x32x16_bf16 v[16:31], v[104:107], v[136:139], v[16:31]
    ds_read_b32 v79, v8 offset:25984
    ds_read_b64_tr_b16 v[120:121], v82 offset:0
    ds_read_b64_tr_b16 v[122:123], v82 offset:1024
    buffer_load_dwordx4 v[184:187], v78, s[40:43], s35 offen offset:0 sc1
    v_mfma_f32_32x32x16_bf16 v[32:47], v[108:111], v[136:139], v[32:47]
    ds_read_b64_tr_b16 v[124:125], v83 offset:0
    ds_read_b64_tr_b16 v[126:127], v83 offset:1024
    s_waitcnt vmcnt(11) lgkmcnt(4)
    v_mfma_f32_32x32x16_bf16 v[16:31], v[112:115], v[140:143], v[16:31]
    ds_read_b64_tr_b16 v[104:105], v82 offset:2048
    ds_read_b64_tr_b16 v[106:107], v82 offset:3072
    buffer_load_dwordx4 v[188:191], v78, s[40:43], s35 offen offset:2048 sc1
    v_mfma_f32_32x32x16_bf16 v[32:47], v[116:119], v[140:143], v[32:47]
    ds_read_b64_tr_b16 v[108:109], v83 offset:2048
    ds_read_b64_tr_b16 v[110:111], v83 offset:3072
    v_readfirstlane_b32 s76, v79
    s_nop 0
    s_and_b32 s76, s76, s52
    s_cbranch_scc0 L_tr8
L_bk8:
    s_ff1_i32_b32 s76, s76
    s_bitset0_b32 s52, s76
    s_add_u32 s77, s76, s65
    s_and_b32 s77, s77, 15
    s_mul_i32 s77, s77, 32768
    s_add_u32 s36, s77, s80
    s_waitcnt vmcnt(11) lgkmcnt(4)
    v_mfma_f32_32x32x16_bf16 v[16:31], v[120:123], v[144:147], v[16:31]
    ds_read_b64_tr_b16 v[112:113], v82 offset:4096
    ds_read_b64_tr_b16 v[114:115], v82 offset:5120
    buffer_load_dwordx4 v[128:131], v14, s[40:43], s36 offen offset:0 sc1
    s_add_u32 s76, s76, 3
    s_and_b32 s76, s76, 15
    s_lshl_b32 s12, s76, 13
    v_mfma_f32_32x32x16_bf16 v[32:47], v[124:127], v[144:147], v[32:47]
    ds_read_b64_tr_b16 v[116:117], v83 offset:4096
    ds_read_b64_tr_b16 v[118:119], v83 offset:5120
    s_waitcnt vmcnt(11) lgkmcnt(4)
    v_mfma_f32_32x32x16_bf16 v[16:31], v[104:107], v[148:151], v[16:31]
    ds_read_b64_tr_b16 v[120:121], v82 offset:6144
    ds_read_b64_tr_b16 v[122:123], v82 offset:7168
    buffer_load_dwordx4 v[132:135], v14, s[40:43], s36 offen offset:2048 sc1
    v_mfma_f32_32x32x16_bf16 v[32:47], v[108:111], v[148:151], v[32:47]
    ds_read_b64_tr_b16 v[124:125], v83 offset:6144
    ds_read_b64_tr_b16 v[126:127], v83 offset:7168
    v_add_u32 v80, s10, v72
    v_add_u32 v81, s10, v73
    s_waitcnt vmcnt(11) lgkmcnt(4)
    v_mfma_f32_32x32x16_bf16 v[16:31], v[112:115], v[152:155], v[16:31]
    ds_read_b32 v79, v8 offset:25984
    ds_read_b64_tr_b16 v[104:105], v80 offset:0
    ds_read_b64_tr_b16 v[106:107], v80 offset:1024
    buffer_load_dwordx4 v[136:139], v78, s[40:43], s36 offen offset:0 sc1
    v_mfma_f32_32x32x16_bf16 v[32:47], v[116:119], v[152:155], v[32:47]
    ds_read_b64_tr_b16 v[108:109], v81 offset:0
    ds_read_b64_tr_b16 v[110:111], v81 offset:1024
    s_waitcnt vmcnt(11) lgkmcnt(4)
    v_mfma_f32_32x32x16_bf16 v[16:31], v[120:123], v[156:159], v[16:31]
    ds_read_b64_tr_b16 v[112:113], v80 offset:2048
    ds_read_b64_tr_b16 v[114:115], v80 offset:3072
    buffer_load_dwordx4 v[140:143], v78, s[40:43], s36 offen offset:2048 sc1
    v_mfma_f32_32x32x16_bf16 v[32:47], v[124:127], v[156:159], v[32:47]
    ds_read_b64_tr_b16 v[116:117], v81 offset:2048
    ds_read_b64_tr_b16 v[118:119], v81 offset:3072
    v_readfirstlane_b32 s76, v79
    s_nop 0
    s_and_b32 s76, s76, s52
    s_cbranch_scc0 L_tr9
L_bk9:
    s_ff1_i32_b32 s76, s76
    s_bitset0_b32 s52, s76
    s_add_u32 s77, s76, s65
    s_and_b32 s77, s77, 15
    s_mul_i32 s77, s77, 32768
    s_add_u32 s37, s77, s80
    s_waitcnt vmcnt(11) lgkmcnt(4)
    v_mfma_f32_32x32x16_bf16 v[16:31], v[104:107], v[160:163], v[16:31]
    ds_read_b64_tr_b16 v[120:121], v80 offset:4096
    ds_read_b64_tr_b16 v[122:123], v80 offset:5120
    buffer_load_dwordx4 v[144:147], v14, s[40:43], s37 offen offset:0 sc1
    s_add_u32 s76, s76, 3
    s_and_b32 s76, s76, 15
    s_lshl_b32 s13, s76, 13
    v_mfma_f32_32x32x16_bf16 v[32:47], v[108:111], v[160:163], v[32:47]
    ds_read_b64_tr_b16 v[124:125], v81 offset:4096
    ds_read_b64_tr_b16 v[126:127], v81 offset:5120
    s_waitcnt vmcnt(11) lgkmcnt(4)
    v_mfma_f32_32x32x16_bf16 v[16:31], v[112:115], v[164:167], v[16:31]
    ds_read_b64_tr_b16 v[104:105], v80 offset:6144
    ds_read_b64_tr_b16 v[106:107], v80 offset:7168
    buffer_load_dwordx4 v[148:151], v14, s[40:43], s37 offen offset:2048 sc1
    v_mfma_f32_32x32x16_bf16 v[32:47], v[116:119], v[164:167], v[32:47]
    ds_read_b64_tr_b16 v[108:109], v81 offset:6144
    ds_read_b64_tr_b16 v[110:111], v81 offset:7168
    v_add_u32 v82, s11, v72
    v_add_u32 v83, s11, v73
    s_waitcnt vmcnt(11) lgkmcnt(4)
    v_mfma_f32_32x32x16_bf16 v[16:31], v[120:123], v[168:171], v[16:31]
    ds_read_b32 v79, v8 offset:25984
    ds_read_b64_tr_b16 v[112:113], v82 offset:0
    ds_read_b64_tr_b16 v[114:115], v82 offset:1024
    buffer_load_dwordx4 v[152:155], v78, s[40:43], s37 offen offset:0 sc1
    v_mfma_f32_32x32x16_bf16 v[32:47], v[124:127], v[168:171], v[32:47]
    ds_read_b64_tr_b16 v[116:117], v83 offset:0
    ds_read_b64_tr_b16 v[118:119], v83 offset:1024
    s_waitcnt vmcnt(11) lgkmcnt(4)
    v_mfma_f32_32x32x16_bf16 v[16:31], v[104:107], v[172:175], v[16:31]
    ds_read_b64_tr_b16 v[120:121], v82 offset:2048
    ds_read_b64_tr_b16 v[122:123], v82 offset:3072
    buffer_load_dwordx4 v[156:159], v78, s[40:43], s37 offen offset:2048 sc1
    v_mfma_f32_32x32x16_bf16 v[32:47], v[108:111], v[172:175], v[32:47]
    ds_read_b64_tr_b16 v[124:125], v83 offset:2048
    ds_read_b64_tr_b16 v[126:127], v83 offset:3072
    v_readfirstlane_b32 s76, v79
    s_nop 0
    s_and_b32 s76, s76, s52
    s_cbranch_scc0 L_tr10
L_bk10:
    s_ff1_i32_b32 s76, s76
    s_bitset0_b32 s52, s76
    s_add_u32 s77, s76, s65
    s_and_b32 s77, s77, 15
    s_mul_i32 s77, s77, 32768
    s_add_u32 s38, s77, s80
    s_waitcnt vmcnt(11) lgkmcnt(4)
    v_mfma_f32_32x32x16_bf16 v[16:31], v[112:115], v[176:179], v[16:31]
    ds_read_b64_tr_b16 v[104:105], v82 offset:4096
    ds_read_b64_tr_b16 v[106:107], v82 offset:5120
    buffer_load_dwordx4 v[160:163], v14, s[40:43], s38 offen offset:0 sc1
    s_add_u32 s76, s76, 3
    s_and_b32 s76, s76, 15
    s_lshl_b32 s14, s76, 13
    v_mfma_f32_32x32x16_bf16 v[32:47], v[116:119], v[176:179], v[32:47]
    ds_read_b64_tr_b16 v[108:109], v83 offset:4096
    ds_read_b64_tr_b16 v[110:111], v83 offset:5120
    s_waitcnt vmcnt(11) lgkmcnt(4)
    v_mfma_f32_32x32x16_bf16 v[16:31], v[120:123], v[180:183], v[16:31]
    ds_read_b64_tr_b16 v[112:113], v82 offset:6144
    ds_read_b64_tr_b16 v[114:115], v82 offset:7168
    buffer_load_dwordx4 v[164:167], v14, s[40:43], s38 offen offset:2048 sc1
    v_mfma_f32_32x32x16_bf16 v[32:47], v[124:127], v[180:183], v[32:47]
    ds_read_b64_tr_b16 v[116:117], v83 offset:6144
    ds_read_b64_tr_b16 v[118:119], v83 offset:7168
    v_add_u32 v80, s12, v72
    v_add_u32 v81, s12, v73
    s_waitcnt vmcnt(11) lgkmcnt(4)
    v_mfma_f32_32x32x16_bf16 v[16:31], v[104:107], v[184:187], v[16:31]
    ds_read_b32 v79, v8 offset:25984
    ds_read_b64_tr_b16 v[120:121], v80 offset:0
    ds_read_b64_tr_b16 v[122:123], v80 offset:1024
    buffer_load_dwordx4 v[168:171], v78, s[40:43], s38 offen offset:0 sc1
    v_mfma_f32_32x32x16_bf16 v[32:47], v[108:111], v[184:187], v[32:47]
    ds_read_b64_tr_b16 v[124:125], v81 offset:0
    ds_read_b64_tr_b16 v[126:127], v81 offset:1024
    s_waitcnt vmcnt(11) lgkmcnt(4)
    v_mfma_f32_32x32x16_bf16 v[16:31], v[112:115], v[188:191], v[16:31]
    ds_read_b64_tr_b16 v[104:105], v80 offset:2048
    ds_read_b64_tr_b16 v[106:107], v80 offset:3072
    buffer_load_dwordx4 v[172:175], v78, s[40:43], s38 offen offset:2048 sc1
    v_mfma_f32_32x32x16_bf16 v[32:47], v[116:119], v[188:191], v[32:47]
    ds_read_b64_tr_b16 v[108:109], v81 offset:2048
    ds_read_b64_tr_b16 v[110:111], v81 offset:3072
    v_readfirstlane_b32 s76, v79
    s_nop 0
    s_and_b32 s76, s76, s52
    s_cbranch_scc0 L_tr11
L_bk11:
    s_ff1_i32_b32 s76, s76
    s_bitset0_b32 s52, s76
    s_add_u32 s77, s76, s65
    s_and_b32 s77, s77, 15
    s_mul_i32 s77, s77, 32768
    s_add_u32 s39, s77, s80
    s_waitcnt vmcnt(11) lgkmcnt(4)
    v_mfma_f32_32x32x16_bf16 v[16:31], v[120:123], v[128:131], v[16:31]
    ds_read_b64_tr_b16 v[112:113], v80 offset:4096
    ds_read_b64_tr_b16 v[114:115], v80 offset:5120
    buffer_load_dwordx4 v[176:179], v14, s[40:43], s39 offen offset:0 sc1
    s_add_u32 s76, s76, 3
    s_and_b32 s76, s76, 15
    s_lshl_b32 s15, s76, 13
    v_mfma_f32_32x32x16_bf16 v[32:47], v[124:127], v[128:131], v[32:47]
    ds_read_b64_tr_b16 v[116:117], v81 offset:4096
    ds_read_b64_tr_b16 v[118:119], v81 offset:5120
    s_waitcnt vmcnt(11) lgkmcnt(4)
    v_mfma_f32_32x32x16_bf16 v[16:31], v[104:107], v[132:135], v[16:31]
    ds_read_b64_tr_b16 v[120:121], v80 offset:6144
    ds_read_b64_tr_b16 v[122:123], v80 offset:7168
    buffer_load_dwordx4 v[180:183], v14, s[40:43], s39 offen offset:2048 sc1
    v_mfma_f32_32x32x16_bf16 v[32:47], v[108:111], v[132:135], v[32:47]
    ds_read_b64_tr_b16 v[124:125], v81 offset:6144
    ds_read_b64_tr_b16 v[126:127], v81 offset:7168
    v_add_u32 v82, s13, v72
    v_add_u32 v83, s13, v73
    s_waitcnt vmcnt(11) lgkmcnt(4)
    v_mfma_f32_32x32x16_bf16 v[16:31], v[112:115], v[136:139], v[16:31]
    ds_read_b32 v79, v8 offset:25984
    ds_read_b64_tr_b16 v[104:105], v82 offset:0
    ds_read_b64_tr_b16 v[106:107], v82 offset:1024
    buffer_load_dwordx4 v[184:187], v78, s[40:43], s39 offen offset:0 sc1
    v_mfma_f32_32x32x16_bf16 v[32:47], v[116:119], v[136:139], v[32:47]
    ds_read_b64_tr_b16 v[108:109], v83 offset:0
    ds_read_b64_tr_b16 v[110:111], v83 offset:1024
    s_waitcnt vmcnt(11) lgkmcnt(4)
    v_mfma_f32_32x32x16_bf16 v[16:31], v[120:123], v[140:143], v[16:31]
    ds_read_b64_tr_b16 v[112:113], v82 offset:2048
    ds_read_b64_tr_b16 v[114:115], v82 offset:3072
    buffer_load_dwordx4 v[188:191], v78, s[40:43], s39 offen offset:2048 sc1
    v_mfma_f32_32x32x16_bf16 v[32:47], v[124:127], v[140:143], v[32:47]
    ds_read_b64_tr_b16 v[116:117], v83 offset:2048
    ds_read_b64_tr_b16 v[118:119], v83 offset:3072
    v_readfirstlane_b32 s76, v79
    s_nop 0
    s_and_b32 s76, s76, s52
    s_cbranch_scc0 L_tr12
L_bk12:
    s_ff1_i32_b32 s76, s76
    s_bitset0_b32 s52, s76
    s_add_u32 s77, s76, s65
    s_and_b32 s77, s77, 15
    s_mul_i32 s77, s77, 32768
    s_add_u32 s48, s77, s80
    s_waitcnt vmcnt(11) lgkmcnt(4)
    v_mfma_f32_32x32x16_bf16 v[16:31], v[104:107], v[144:147], v[16:31]
    ds_read_b64_tr_b16 v[120:121], v82 offset:4096
    ds_read_b64_tr_b16 v[122:123], v82 offset:5120
    buffer_load_dwordx4 v[128:131], v14, s[40:43], s48 offen offset:0 sc1
    s_add_u32 s76, s76, 3
    s_and_b32 s76, s76, 15
    s_lshl_b32 s16, s76, 13
    v_mfma_f32_32x32x16_bf16 v[32:47], v[108:111], v[144:147], v[32:47]
    ds_read_b64_tr_b16 v[124:125], v83 offset:4096
    ds_read_b64_tr_b16 v[126:127], v83 offset:5120
    s_waitcnt vmcnt(11) lgkmcnt(4)
    v_mfma_f32_32x32x16_bf16 v[16:31], v[112:115], v[148:151], v[16:31]
    ds_read_b64_tr_b16 v[104:105], v82 offset:6144
    ds_read_b64_tr_b16 v[106:107], v82 offset:7168
    buffer_load_dwordx4 v[132:135], v14, s[40:43], s48 offen offset:2048 sc1
    v_mfma_f32_32x32x16_bf16 v[32:47], v[116:119], v[148:151], v[32:47]
    ds_read_b64_tr_b16 v[108:109], v83 offset:6144
    ds_read_b64_tr_b16 v[110:111], v83 offset:7168
    v_add_u32 v80, s14, v72
    v_add_u32 v81, s14, v73
    s_waitcnt vmcnt(11) lgkmcnt(4)
    v_mfma_f32_32x32x16_bf16 v[16:31], v[120:123], v[152:155], v[16:31]
    ds_read_b32 v79, v8 offset:25984
    ds_read_b64_tr_b16 v[112:113], v80 offset:0
    ds_read_b64_tr_b16 v[114:115], v80 offset:1024
    buffer_load_dwordx4 v[136:139], v78, s[40:43], s48 offen offset:0 sc1
    v_mfma_f32_32x32x16_bf16 v[32:47], v[124:127], v[152:155], v[32:47]
    ds_read_b64_tr_b16 v[116:117], v81 offset:0
    ds_read_b64_tr_b16 v[118:119], v81 offset:1024
    s_waitcnt vmcnt(11) lgkmcnt(4)
    v_mfma_f32_32x32x16_bf16 v[16:31], v[104:107], v[156:159], v[16:31]
    ds_read_b64_tr_b16 v[120:121], v80 offset:2048
    ds_read_b64_tr_b16 v[122:123], v80 offset:3072
    buffer_load_dwordx4 v[140:143], v78, s[40:43], s48 offen offset:2048 sc1
    v_mfma_f32_32x32x16_bf16 v[32:47], v[108:111], v[156:159], v[32:47]
    ds_read_b64_tr_b16 v[124:125], v81 offset:2048
    ds_read_b64_tr_b16 v[126:127], v81 offset:3072
    v_readfirstlane_b32 s76, v79
    s_nop 0
    s_and_b32 s76, s76, s52
    s_cbranch_scc0 L_tr13
L_bk13:
    s_ff1_i32_b32 s76, s76
    s_bitset0_b32 s52, s76
    s_add_u32 s77, s76, s65
    s_and_b32 s77, s77, 15
    s_mul_i32 s77, s77, 32768
    s_add_u32 s49, s77, s80
    s_waitcnt vmcnt(11) lgkmcnt(4)
    v_mfma_f32_32x32x16_bf16 v[16:31], v[112:115], v[160:163], v[16:31]
    ds_read_b64_tr_b16 v[104:105], v80 offset:4096
    ds_read_b64_tr_b16 v[106:107], v80 offset:5120
    buffer_load_dwordx4 v[144:147], v14, s[40:43], s49 offen offset:0 sc1
    s_add_u32 s76, s76, 3
    s_and_b32 s76, s76, 15
    s_lshl_b32 s17, s76, 13
    v_mfma_f32_32x32x16_bf16 v[32:47], v[116:119], v[160:163], v[32:47]
    ds_read_b64_tr_b16 v[108:109], v81 offset:4096
    ds_read_b64_tr_b16 v[110:111], v81 offset:5120
    s_waitcnt vmcnt(11) lgkmcnt(4)
    v_mfma_f32_32x32x16_bf16 v[16:31], v[120:123], v[164:167], v[16:31]
    ds_read_b64_tr_b16 v[112:113], v80 offset:6144
    ds_read_b64_tr_b16 v[114:115], v80 offset:7168
    buffer_load_dwordx4 v[148:151], v14, s[40:43], s49 offen offset:2048 sc1
    v_mfma_f32_32x32x16_bf16 v[32:47], v[124:127], v[164:167], v[32:47]
    ds_read_b64_tr_b16 v[116:117], v81 offset:6144
    ds_read_b64_tr_b16 v[118:119], v81 offset:7168
    v_add_u32 v82, s15, v72
    v_add_u32 v83, s15, v73
    s_waitcnt vmcnt(11) lgkmcnt(4)
    v_mfma_f32_32x32x16_bf16 v[16:31], v[104:107], v[168:171], v[16:31]
    ds_read_b32 v79, v8 offset:25984
    ds_read_b64_tr_b16 v[120:121], v82 offset:0
    ds_read_b64_tr_b16 v[122:123], v82 offset:1024
    buffer_load_dwordx4 v[152:155], v78, s[40:43], s49 offen offset:0 sc1
    v_mfma_f32_32x32x16_bf16 v[32:47], v[108:111], v[168:171], v[32:47]
    ds_read_b64_tr_b16 v[124:125], v83 offset:0
    ds_read_b64_tr_b16 v[126:127], v83 offset:1024
    s_waitcnt vmcnt(11) lgkmcnt(4)
    v_mfma_f32_32x32x16_bf16 v[16:31], v[112:115], v[172:175], v[16:31]
    ds_read_b64_tr_b16 v[104:105], v82 offset:2048
    ds_read_b64_tr_b16 v[106:107], v82 offset:3072
    buffer_load_dwordx4 v[156:159], v78, s[40:43], s49 offen offset:2048 sc1
    v_mfma_f32_32x32x16_bf16 v[32:47], v[116:119], v[172:175], v[32:47]
    ds_read_b64_tr_b16 v[108:109], v83 offset:2048
    ds_read_b64_tr_b16 v[110:111], v83 offset:3072
    v_readfirstlane_b32 s76, v79
    s_nop 0
    s_and_b32 s76, s76, s52
    s_cbranch_scc0 L_tr14
L_bk14:
    s_ff1_i32_b32 s76, s76
    s_bitset0_b32 s52, s76
    s_add_u32 s77, s76, s65
    s_and_b32 s77, s77, 15
    s_mul_i32 s77, s77, 32768
    s_add_u32 s50, s77, s80
    s_waitcnt vmcnt(11) lgkmcnt(4)
    v_mfma_f32_32x32x16_bf16 v[16:31], v[120:123], v[176:179], v[16:31]
    ds_read_b64_tr_b16 v[112:113], v82 offset:4096
    ds_read_b64_tr_b16 v[114:115], v82 offset:5120
    buffer_load_dwordx4 v[160:163], v14, s[40:43], s50 offen offset:0 sc1
    s_add_u32 s76, s76, 3
    s_and_b32 s76, s76, 15
    s_lshl_b32 s18, s76, 13
    v_mfma_f32_32x32x16_bf16 v[32:47], v[124:127], v[176:179], v[32:47]
    ds_read_b64_tr_b16 v[116:117], v83 offset:4096
    ds_read_b64_tr_b16 v[118:119], v83 offset:5120
    s_waitcnt vmcnt(11) lgkmcnt(4)
    v_mfma_f32_32x32x16_bf16 v[16:31], v[104:107], v[180:183], v[16:31]
    ds_read_b64_tr_b16 v[120:121], v82 offset:6144
    ds_read_b64_tr_b16 v[122:123], v82 offset:7168
    buffer_load_dwordx4 v[164:167], v14, s[40:43], s50 offen offset:2048 sc1
    v_mfma_f32_32x32x16_bf16 v[32:47], v[108:111], v[180:183], v[32:47]
    ds_read_b64_tr_b16 v[124:125], v83 offset:6144
    ds_read_b64_tr_b16 v[126:127], v83 offset:7168
    v_add_u32 v80, s16, v72
    v_add_u32 v81, s16, v73
    s_waitcnt vmcnt(11) lgkmcnt(4)
    v_mfma_f32_32x32x16_bf16 v[16:31], v[112:115], v[184:187], v[16:31]
    ds_read_b32 v79, v8 offset:25984
    ds_read_b64_tr_b16 v[104:105], v80 offset:0
    ds_read_b64_tr_b16 v[106:107], v80 offset:1024
    buffer_load_dwordx4 v[168:171], v78, s[40:43], s50 offen offset:0 sc1
    v_mfma_f32_32x32x16_bf16 v[32:47], v[116:119], v[184:187], v[32:47]
    ds_read_b64_tr_b16 v[108:109], v81 offset:0
    ds_read_b64_tr_b16 v[110:111], v81 offset:1024
    s_waitcnt vmcnt(11) lgkmcnt(4)
    v_mfma_f32_32x32x16_bf16 v[16:31], v[120:123], v[188:191], v[16:31]
    ds_read_b64_tr_b16 v[112:113], v80 offset:2048
    ds_read_b64_tr_b16 v[114:115], v80 offset:3072
    buffer_load_dwordx4 v[172:175], v78, s[40:43], s50 offen offset:2048 sc1
    v_mfma_f32_32x32x16_bf16 v[32:47], v[124:127], v[188:191], v[32:47]
    ds_read_b64_tr_b16 v[116:117], v81 offset:2048
    ds_read_b64_tr_b16 v[118:119], v81 offset:3072
    v_readfirstlane_b32 s76, v79
    s_nop 0
    s_and_b32 s76, s76, s52
    s_cbranch_scc0 L_tr15
L_bk15:
    s_ff1_i32_b32 s76, s76
    s_bitset0_b32 s52, s76
    s_add_u32 s77, s76, s65
    s_and_b32 s77, s77, 15
    s_mul_i32 s77, s77, 32768
    s_add_u32 s51, s77, s80
    s_waitcnt vmcnt(11) lgkmcnt(4)
    v_mfma_f32_32x32x16_bf16 v[16:31], v[104:107], v[128:131], v[16:31]
    ds_read_b64_tr_b16 v[120:121], v80 offset:4096
    ds_read_b64_tr_b16 v[122:123], v80 offset:5120
    buffer_load_dwordx4 v[176:179], v14, s[40:43], s51 offen offset:0 sc1
    s_add_u32 s76, s76, 3
    s_and_b32 s76, s76, 15
    s_lshl_b32 s19, s76, 13
    v_mfma_f32_32x32x16_bf16 v[32:47], v[108:111], v[128:131], v[32:47]
    ds_read_b64_tr_b16 v[124:125], v81 offset:4096
    ds_read_b64_tr_b16 v[126:127], v81 offset:5120
    s_waitcnt vmcnt(11) lgkmcnt(4)
    v_mfma_f32_32x32x16_bf16 v[16:31], v[112:115], v[132:135], v[16:31]
    ds_read_b64_tr_b16 v[104:105], v80 offset:6144
    ds_read_b64_tr_b16 v[106:107], v80 offset:7168
    buffer_load_dwordx4 v[180:183], v14, s[40:43], s51 offen offset:2048 sc1
    v_mfma_f32_32x32x16_bf16 v[32:47], v[116:119], v[132:135], v[32:47]
    ds_read_b64_tr_b16 v[108:109], v81 offset:6144
    ds_read_b64_tr_b16 v[110:111], v81 offset:7168
    v_add_u32 v82, s17, v72
    v_add_u32 v83, s17, v73
    s_waitcnt vmcnt(11) lgkmcnt(4)
    v_mfma_f32_32x32x16_bf16 v[16:31], v[120:123], v[136:139], v[16:31]
    ds_read_b64_tr_b16 v[112:113], v82 offset:0
    ds_read_b64_tr_b16 v[114:115], v82 offset:1024
    buffer_load_dwordx4 v[184:187], v78, s[40:43], s51 offen offset:0 sc1
    v_mfma_f32_32x32x16_bf16 v[32:47], v[124:127], v[136:139], v[32:47]
    ds_read_b64_tr_b16 v[116:117], v83 offset:0
    ds_read_b64_tr_b16 v[118:119], v83 offset:1024
    s_waitcnt vmcnt(11) lgkmcnt(4)
    v_mfma_f32_32x32x16_bf16 v[16:31], v[104:107], v[140:143], v[16:31]
    ds_read_b64_tr_b16 v[120:121], v82 offset:2048
    ds_read_b64_tr_b16 v[122:123], v82 offset:3072
    buffer_load_dwordx4 v[188:191], v78, s[40:43], s51 offen offset:2048 sc1
    s_barrier
    v_mfma_f32_32x32x16_bf16 v[32:47], v[108:111], v[140:143], v[32:47]
    ds_read_b64_tr_b16 v[124:125], v83 offset:2048
    ds_read_b64_tr_b16 v[126:127], v83 offset:3072
    s_waitcnt vmcnt(11) lgkmcnt(4)
    v_mfma_f32_32x32x16_bf16 v[16:31], v[112:115], v[144:147], v[16:31]
    ds_read_b64_tr_b16 v[104:105], v82 offset:4096
    ds_read_b64_tr_b16 v[106:107], v82 offset:5120
    v_mfma_f32_32x32x16_bf16 v[32:47], v[116:119], v[144:147], v[32:47]
    ds_read_b64_tr_b16 v[108:109], v83 offset:4096
    ds_read_b64_tr_b16 v[110:111], v83 offset:5120
    s_waitcnt vmcnt(10) lgkmcnt(4)
    v_mfma_f32_32x32x16_bf16 v[16:31], v[120:123], v[148:151], v[16:31]
    ds_read_b64_tr_b16 v[112:113], v82 offset:6144
    ds_read_b64_tr_b16 v[114:115], v82 offset:7168
    v_mfma_f32_32x32x16_bf16 v[32:47], v[124:127], v[148:151], v[32:47]
    ds_read_b64_tr_b16 v[116:117], v83 offset:6144
    ds_read_b64_tr_b16 v[118:119], v83 offset:7168
    v_add_u32 v80, s18, v72
    v_add_u32_e64 v81, s18, v73
    s_waitcnt vmcnt(9) lgkmcnt(4)
    v_mfma_f32_32x32x16_bf16 v[16:31], v[104:107], v[152:155], v[16:31]
    ds_read_b64_tr_b16 v[120:121], v80 offset:0
    ds_read_b64_tr_b16 v[122:123], v80 offset:1024
    v_mfma_f32_32x32x16_bf16 v[32:47], v[108:111], v[152:155], v[32:47]
    ds_read_b64_tr_b16 v[124:125], v81 offset:0
    ds_read_b64_tr_b16 v[126:127], v81 offset:1024
    s_waitcnt vmcnt(8) lgkmcnt(4)
    v_mfma_f32_32x32x16_bf16 v[16:31], v[112:115], v[156:159], v[16:31]
    ds_read_b64_tr_b16 v[104:105], v80 offset:2048
    ds_read_b64_tr_b16 v[106:107], v80 offset:3072
    v_mfma_f32_32x32x16_bf16 v[32:47], v[116:119], v[156:159], v[32:47]
    ds_read_b64_tr_b16 v[108:109], v81 offset:2048
    ds_read_b64_tr_b16 v[110:111], v81 offset:3072
    s_waitcnt vmcnt(7) lgkmcnt(4)
    v_mfma_f32_32x32x16_bf16 v[16:31], v[120:123], v[160:163], v[16:31]
    ds_read_b64_tr_b16 v[112:113], v80 offset:4096
    ds_read_b64_tr_b16 v[114:115], v80 offset:5120
    v_mfma_f32_32x32x16_bf16 v[32:47], v[124:127], v[160:163], v[32:47]
    ds_read_b64_tr_b16 v[116:117], v81 offset:4096
    ds_read_b64_tr_b16 v[118:119], v81 offset:5120
    s_waitcnt vmcnt(6) lgkmcnt(4)
    v_mfma_f32_32x32x16_bf16 v[16:31], v[104:107], v[164:167], v[16:31]
    ds_read_b64_tr_b16 v[120:121], v80 offset:6144
    ds_read_b64_tr_b16 v[122:123], v80 offset:7168
    v_mfma_f32_32x32x16_bf16 v[32:47], v[108:111], v[164:167], v[32:47]
    ds_read_b64_tr_b16 v[124:125], v81 offset:6144
    ds_read_b64_tr_b16 v[126:127], v81 offset:7168
    v_add_u32 v82, s19, v72
    v_add_u32 v83, s19, v73
    s_waitcnt vmcnt(5) lgkmcnt(4)
    v_mfma_f32_32x32x16_bf16 v[16:31], v[112:115], v[168:171], v[16:31]
    ds_read_b64_tr_b16 v[104:105], v82 offset:0
    ds_read_b64_tr_b16 v[106:107], v82 offset:1024
    v_mfma_f32_32x32x16_bf16 v[32:47], v[116:119], v[168:171], v[32:47]
    ds_read_b64_tr_b16 v[108:109], v83 offset:0
    ds_read_b64_tr_b16 v[110:111], v83 offset:1024
    s_waitcnt vmcnt(4) lgkmcnt(4)
    v_mfma_f32_32x32x16_bf16 v[16:31], v[120:123], v[172:175], v[16:31]
    ds_read_b64_tr_b16 v[112:113], v82 offset:2048
    ds_read_b64_tr_b16 v[114:115], v82 offset:3072
    v_mfma_f32_32x32x16_bf16 v[32:47], v[124:127], v[172:175], v[32:47]
    ds_read_b64_tr_b16 v[116:117], v83 offset:2048
    ds_read_b64_tr_b16 v[118:119], v83 offset:3072
    s_waitcnt vmcnt(3) lgkmcnt(4)
    v_mfma_f32_32x32x16_bf16 v[16:31], v[104:107], v[176:179], v[16:31]
    ds_read_b64_tr_b16 v[120:121], v82 offset:4096
    ds_read_b64_tr_b16 v[122:123], v82 offset:5120
    v_mfma_f32_32x32x16_bf16 v[32:47], v[108:111], v[176:179], v[32:47]
    ds_read_b64_tr_b16 v[124:125], v83 offset:4096
    ds_read_b64_tr_b16 v[126:127], v83 offset:5120
    s_waitcnt vmcnt(2) lgkmcnt(4)
    v_mfma_f32_32x32x16_bf16 v[16:31], v[112:115], v[180:183], v[16:31]
    ds_read_b64_tr_b16 v[104:105], v82 offset:6144
    ds_read_b64_tr_b16 v[106:107], v82 offset:7168
    v_mfma_f32_32x32x16_bf16 v[32:47], v[116:119], v[180:183], v[32:47]
    ds_read_b64_tr_b16 v[108:109], v83 offset:6144
    ds_read_b64_tr_b16 v[110:111], v83 offset:7168
    s_waitcnt vmcnt(1) lgkmcnt(4)
    v_mfma_f32_32x32x16_bf16 v[16:31], v[120:123], v[184:187], v[16:31]
    v_mfma_f32_32x32x16_bf16 v[32:47], v[124:127], v[184:187], v[32:47]
    s_waitcnt vmcnt(0) lgkmcnt(0)
    v_mfma_f32_32x32x16_bf16 v[16:31], v[104:107], v[188:191], v[16:31]
    v_mfma_f32_32x32x16_bf16 v[32:47], v[108:111], v[188:191], v[32:47]
    s_nop 10
    v_cvt_pk_bf16_f32 v88, v16, v17
    v_cvt_pk_bf16_f32 v89, v18, v19
    v_cvt_pk_bf16_f32 v90, v20, v21
    v_cvt_pk_bf16_f32 v91, v22, v23
    v_cvt_pk_bf16_f32 v92, v24, v25
    v_cvt_pk_bf16_f32 v93, v26, v27
    v_cvt_pk_bf16_f32 v94, v28, v29
    v_cvt_pk_bf16_f32 v95, v30, v31
    v_cvt_pk_bf16_f32 v96, v32, v33
    v_cvt_pk_bf16_f32 v97, v34, v35
    v_cvt_pk_bf16_f32 v98, v36, v37
    v_cvt_pk_bf16_f32 v99, v38, v39
    v_cvt_pk_bf16_f32 v100, v40, v41
    v_cvt_pk_bf16_f32 v101, v42, v43
    v_cvt_pk_bf16_f32 v102, v44, v45
    v_cvt_pk_bf16_f32 v103, v46, v47
    v_dot2_f32_bf16 v104, v88, s89, 0
    v_dot2_f32_bf16 v105, v88, v88, 0
    v_dot2_f32_bf16 v106, v88, v192, 0
    v_dot2_f32_bf16 v104, v89, s89, v104
    v_dot2_f32_bf16 v105, v89, v89, v105
    v_dot2_f32_bf16 v106, v89, v193, v106
    v_dot2_f32_bf16 v104, v90, s89, v104
    v_dot2_f32_bf16 v105, v90, v90, v105
    v_dot2_f32_bf16 v106, v90, v194, v106
    v_dot2_f32_bf16 v104, v91, s89, v104
    v_dot2_f32_bf16 v105, v91, v91, v105
    v_dot2_f32_bf16 v106, v91, v195, v106
    v_dot2_f32_bf16 v104, v92, s89, v104
    v_dot2_f32_bf16 v105, v92, v92, v105
    v_dot2_f32_bf16 v106, v92, v196, v106
    v_dot2_f32_bf16 v104, v93, s89, v104
    v_dot2_f32_bf16 v105, v93, v93, v105
    v_dot2_f32_bf16 v106, v93, v197, v106
    v_dot2_f32_bf16 v104, v94, s89, v104
    v_dot2_f32_bf16 v105, v94, v94, v105
    v_dot2_f32_bf16 v106, v94, v198, v106
    v_dot2_f32_bf16 v104, v95, s89, v104
    v_dot2_f32_bf16 v105, v95, v95, v105
    v_dot2_f32_bf16 v106, v95, v199, v106
    v_dot2_f32_bf16 v104, v96, s89, v104
    v_dot2_f32_bf16 v105, v96, v96, v105
    v_dot2_f32_bf16 v106, v96, v200, v106
    v_dot2_f32_bf16 v104, v97, s89, v104
    v_dot2_f32_bf16 v105, v97, v97, v105
    v_dot2_f32_bf16 v106, v97, v201, v106
    v_dot2_f32_bf16 v104, v98, s89, v104
    v_dot2_f32_bf16 v105, v98, v98, v105
    v_dot2_f32_bf16 v106, v98, v202, v106
    v_dot2_f32_bf16 v104, v99, s89, v104
    v_dot2_f32_bf16 v105, v99, v99, v105
    v_dot2_f32_bf16 v106, v99, v203, v106
    v_dot2_f32_bf16 v104, v100, s89, v104
    v_dot2_f32_bf16 v105, v100, v100, v105
    v_dot2_f32_bf16 v106, v100, v204, v106
    v_dot2_f32_bf16 v104, v101, s89, v104
    v_dot2_f32_bf16 v105, v101, v101, v105
    v_dot2_f32_bf16 v106, v101, v205, v106
    v_dot2_f32_bf16 v104, v102, s89, v104
    v_dot2_f32_bf16 v105, v102, v102, v105
    v_dot2_f32_bf16 v106, v102, v206, v106
    v_dot2_f32_bf16 v104, v103, s89, v104
    v_dot2_f32_bf16 v105, v103, v103, v105
    v_dot2_f32_bf16 v106, v103, v207, v106
    s_lshl_b32 s76, s62, 9
    s_add_u32 s77, s76, s99
    v_mov_b32 v107, 0
    v_mov_b32 v4, v104
    v_mov_b32 v5, v105
    v_mov_b32 v6, v106
    v_permlane32_swap_b32 v104, v4
    v_permlane32_swap_b32 v105, v5
    v_permlane32_swap_b32 v106, v6
    v_add_f32 v104, v104, v4
    v_add_f32 v105, v105, v5
    v_add_f32_e64 v106, v106, v6
    s_mov_b32 exec_hi, 0
    s_bitcmp1_b32 s100, 1
    s_cbranch_scc1 L_loc_57
    buffer_store_dwordx4 v[104:107], v12, s[40:43], s77 offen offset:1024 sc1
    s_branch L_pubd_58
L_loc_57:
    buffer_store_dwordx4 v[104:107], v12, s[40:43], s77 offen offset:1024
L_pubd_58:
    s_mov_b64 exec, -1
    ds_write_b64 v64, v[88:89]
    ds_write_b64 v65, v[90:91]
    ds_write_b64 v66, v[92:93]
    ds_write_b64 v67, v[94:95]
    ds_write_b64 v68, v[96:97]
    ds_write_b64 v69, v[98:99]
    ds_write_b64 v70, v[100:101]
    ds_write_b64 v71, v[102:103]
    v_bfe_u32 v4, v1, 1, 3
    v_bfe_u32 v5, v1, 4, 1
    v_lshlrev_b32_e64 v176, 4, v4
    v_lshl_add_u32 v176, v5, 3, v176
    v_and_b32_e64 v5, 1, v1
    v_lshl_add_u32 v176, v5, 2, v176
    v_lshlrev_b32_e64 v177, 2, v2
    v_lshl_add_u32 v177, v3, 8, v177
    v_and_b32 v4, 15, v1
    v_lshrrev_b32 v5, 4, v1
    v_mul_u32_u24 v179, 149504, v4
    v_lshl_add_u32 v180, v5, 4, v179
    s_lshl_b32 s82, s97, 7
    s_lshl_b32 s79, s62, 5
    s_add_u32 s82, s82, s79
    s_lshl_b32 s79, s62, 2
    v_mov_b32_e64 v7, s79
    v_mul_u32_u24 v6, 9344, v3
    v_lshl_add_u32 v6, v2, 4, v6
    s_mul_i32 s78, s97, 149504
    s_add_u32 s78, s78, s76
    s_add_u32 s78, s78, 8388608
    s_add_u32 s48, s78, 18688
    s_add_u32 s49, s48, 18688
    s_add_u32 s50, s49, 18688
    s_add_u32 s51, s50, 18688
    s_add_u32 s52, s51, 18688
    s_add_u32 s53, s52, 18688
    s_add_u32 s54, s53, 18688
    buffer_load_dwordx4 v[112:115], v6, s[40:43], s78 offen offset:1024 sc1
    buffer_load_dwordx4 v[116:119], v6, s[40:43], s48 offen offset:1024 sc1
    buffer_load_dwordx4 v[120:123], v6, s[40:43], s49 offen offset:1024 sc1
    buffer_load_dwordx4 v[124:127], v6, s[40:43], s50 offen offset:1024 sc1
    buffer_load_dwordx4 v[128:131], v6, s[40:43], s51 offen offset:1024 sc1
    buffer_load_dwordx4 v[132:135], v6, s[40:43], s52 offen offset:1024 sc1
    buffer_load_dwordx4 v[136:139], v6, s[40:43], s53 offen offset:1024 sc1
    buffer_load_dwordx4 v[140:143], v6, s[40:43], s54 offen offset:1024 sc1
    v_dot2_f32_bf16 v76, v208, s89, 0
    v_dot2_f32_bf16 v76, v209, s89, v76
    v_dot2_f32_bf16 v76, v210, s89, v76
    v_dot2_f32_bf16 v76, v211, s89, v76
    v_dot2_f32_bf16 v76, v212, s89, v76
    v_dot2_f32_bf16 v76, v213, s89, v76
    v_dot2_f32_bf16 v76, v214, s89, v76
    v_dot2_f32_bf16 v76, v215, s89, v76
    s_nop 2
    v_add_f32_dpp v76, v76, v76 row_ror:8 row_mask:0xf bank_mask:0xf
    s_nop 1
    v_add_f32_dpp v76, v76, v76 row_ror:4 row_mask:0xf bank_mask:0xf
    s_nop 1
    v_add_f32_dpp v76, v76, v76 row_ror:2 row_mask:0xf bank_mask:0xf
    s_nop 1
    v_add_f32_dpp v76, v76, v76 row_ror:1 row_mask:0xf bank_mask:0xf
    v_mov_b32 v4, v76
    s_nop 1
    v_permlane16_swap_b32 v76, v4
    v_add_f32 v76, v76, v4
    v_mov_b32 v4, v76
    s_nop 1
    v_permlane32_swap_b32 v76, v4
    v_add_f32 v76, v76, v4
    s_mov_b32 s88, 0
    s_branch L_s3first_59
L_s3_60:
    v_cmp_eq_u32 vcc, -1, v112
    s_nop 0
    s_cbranch_vccz L_s3skip_61
    buffer_load_dwordx4 v[112:115], v6, s[40:43], s78 offen offset:1024 sc1
L_s3skip_61:
    v_cmp_eq_u32_e64 vcc, -1, v116
    s_nop 0
    s_cbranch_vccz L_s3skip_62
    buffer_load_dwordx4 v[116:119], v6, s[40:43], s48 offen offset:1024 sc1
L_s3skip_62:
    v_cmp_eq_u32_e64 vcc, -1, v120
    s_nop 0
    s_cbranch_vccz L_s3skip_63
    buffer_load_dwordx4 v[120:123], v6, s[40:43], s49 offen offset:1024 sc1
L_s3skip_63:
    v_cmp_eq_u32_e64 vcc, -1, v124
    s_nop 0
    s_cbranch_vccz L_s3skip_64
    buffer_load_dwordx4 v[124:127], v6, s[40:43], s50 offen offset:1024 sc1
L_s3skip_64:
    v_cmp_eq_u32_e64 vcc, -1, v128
    s_nop 0
    s_cbranch_vccz L_s3skip_65
    buffer_load_dwordx4 v[128:131], v6, s[40:43], s51 offen offset:1024 sc1
L_s3skip_65:
    v_cmp_eq_u32_e64 vcc, -1, v132
    s_nop 0
    s_cbranch_vccz L_s3skip_66
    buffer_load_dwordx4 v[132:135], v6, s[40:43], s52 offen offset:1024 sc1
L_s3skip_66:
    v_cmp_eq_u32_e64 vcc, -1, v136
    s_nop 0
    s_cbranch_vccz L_s3skip_67
    buffer_load_dwordx4 v[136:139], v6, s[40:43], s53 offen offset:1024 sc1
L_s3skip_67:
    v_cmp_eq_u32_e64 vcc, -1, v140
    s_nop 0
    s_cbranch_vccz L_s3skip_68
    buffer_load_dwordx4 v[140:143], v6, s[40:43], s54 offen offset:1024 sc1
L_s3skip_68:
L_s3first_59:
    s_waitcnt vmcnt(0)
    v_max3_u32 v4, v112, v116, v120
    v_max3_u32 v4, v4, v124, v128
    v_max3_u32 v4, v4, v132, v136
    v_max_u32 v4, v4, v140
    v_cmp_eq_u32 vcc, -1, v4
    s_nop 0
    s_cbranch_vccz L_ok_69
    s_add_u32 s88, s88, 1
    s_cmp_lt_u32 s88, 65536
    s_cbranch_scc1 L_s3_60
L_ok_69:
    s_barrier
    v_pk_add_f32 v[112:113], v[112:113], v[128:129]
    v_pk_add_f32 v[114:115], v[114:115], v[130:131]
    v_pk_add_f32 v[116:117], v[116:117], v[132:133]
    v_pk_add_f32 v[118:119], v[118:119], v[134:135]
    v_pk_add_f32 v[120:121], v[120:121], v[136:137]
    v_pk_add_f32 v[122:123], v[122:123], v[138:139]
    v_pk_add_f32 v[124:125], v[124:125], v[140:141]
    v_pk_add_f32 v[126:127], v[126:127], v[142:143]
    v_pk_add_f32 v[112:113], v[112:113], v[120:121]
    v_pk_add_f32 v[114:115], v[114:115], v[122:123]
    v_pk_add_f32 v[116:117], v[116:117], v[124:125]
    v_pk_add_f32 v[118:119], v[118:119], v[126:127]
    v_pk_add_f32 v[112:113], v[112:113], v[116:117]
    v_pk_add_f32 v[114:115], v[114:115], v[118:119]
    v_mov_b32 v4, v112
    v_mov_b32 v5, v113
    v_mov_b32 v6, v114
    v_permlane32_swap_b32 v112, v4
    v_permlane32_swap_b32 v113, v5
    v_permlane32_swap_b32 v114, v6
    v_add_f32 v112, v112, v4
    v_add_f32 v113, v113, v5
    v_add_f32_e64 v114, v114, v6
    v_mul_f32 v112, 0x3a800000, v112
    v_mul_f32 v113, 0x3a800000, v113
    v_fma_f32 v4, -v112, v112, v113
    v_max_f32_e64 v4, 0, v4
    v_cvt_pk_bf16_f32 v116, v112, v112
    v_and_b32_e64 v116, s90, v116
    v_cvt_pk_bf16_f32 v4, v4, v4
    v_and_b32_e64 v4, s90, v4
    v_add_f32 v4, 0x3727c5ac, v4
    v_cvt_pk_bf16_f32 v4, v4, v4
    v_and_b32 v4, s90, v4
    v_sqrt_f32_e64 v4, v4
    s_nop 0
    v_cvt_pk_bf16_f32 v4, v4, v4
    v_and_b32 v4, s90, v4
    v_rcp_f32 v118, v4
    v_fma_f32 v120, -v116, v76, v114
    v_mul_f32 v119, v116, v118
    v_mul_f32 v120, v120, v118
    v_mov_b32 v6, 0
    s_lshl_b32 s83, s62, 12
    v_max_f32_dpp v4, v120, v120 row_ror:8 row_mask:0xf bank_mask:0xf
    s_nop 1
    v_max_f32_dpp v4, v4, v4 row_ror:4 row_mask:0xf bank_mask:0xf
    s_nop 1
    v_max_f32_dpp v4, v4, v4 row_ror:2 row_mask:0xf bank_mask:0xf
    s_nop 1
    v_max_f32_dpp v4, v4, v4 row_ror:1 row_mask:0xf bank_mask:0xf
    v_mov_b32 v5, v4
    s_nop 1
    v_permlane16_swap_b32 v4, v5
    v_max_f32_e64 v4, v4, v5
    ds_write_b32 v7, v4 offset:25600
    v_cmp_eq_f32 vcc, v4, v120
    s_nop 0
    s_ff1_i32_b32 s77, vcc_lo
    s_and_b32 s77, s77, 31
    s_bfe_u32 s79, s77, 0x30001
    s_lshl_b32 s79, s79, 4
    s_lshl_b32 s80, s77, 7
    s_add_u32 s80, s80, s83
    s_or_b32 s79, s79, s80
    v_xor_b32_e64 v176, s79, v176
    s_waitcnt lgkmcnt(0)
    s_barrier
    ds_read_b32 v182, v176 offset:0
    ds_read_b128 v[8:11], v6 offset:25600
    v_readlane_b32 s80, v118, s77
    v_readlane_b32 s81, v119, s77
    s_add_u32 s79, s82, s77
    v_writelane_b32 v4, s79, 33
    v_mov_b32 v5, s81
    v_cmp_gt_u32 s[84:85], 32, v1
    s_mov_b32 s83, 3
    s_waitcnt lgkmcnt(1)
    v_lshlrev_b32 v184, 16, v182
    v_and_b32 v185, s90, v182
    v_fma_f32 v184, v184, s80, -v5
    v_fma_f32 v185, v185, s80, -v5
    v_cvt_pk_bf16_f32 v184, v184, v185
    s_waitcnt lgkmcnt(0)
    v_max3_f32 v5, v8, v9, v10
    v_max_f32 v5, v5, v11
    v_cndmask_b32 v184, v4, v184, s[84:85]
    v_cmp_eq_f32 vcc, v5, v10
    s_nop 0
    s_cmp_lg_u32 vcc_lo, 0
    s_cselect_b32 s83, 2, s83
    v_cmp_eq_f32 vcc, v5, v9
    s_nop 0
    s_cmp_lg_u32 vcc_lo, 0
    s_cselect_b32 s83, 1, s83
    v_cmp_eq_f32_e64 vcc, v5, v8
    s_nop 0
    s_cmp_lg_u32 vcc_lo, 0
    s_cselect_b32 s83, 0, s83
    s_cmp_eq_u32 s83, s62
    s_cbranch_scc0 L_nopub_70
    s_mov_b32 exec_hi, -1
    buffer_store_dword v184, v177, s[40:43], s99 offen offset:0 sc1
    s_mov_b64 exec, -1
L_nopub_70:
    v_lshlrev_b32 v16, 16, v88
    v_and_b32_e64 v17, s90, v88
    v_pk_fma_f32 v[144:145], v[16:17], v[118:119], v[118:119] op_sel:[0,0,1] op_sel_hi:[1,0,1] neg_lo:[0,0,1] neg_hi:[0,0,1]
    v_cvt_pk_bf16_f32 v124, v144, v145
    v_lshlrev_b32 v144, 16, v124
    v_and_b32 v145, s90, v124
    v_pk_add_f32 v[144:145], v[144:145], v[16:17]
    v_cvt_pk_bf16_f32 v124, v144, v145
    v_lshlrev_b32 v18, 16, v89
    v_and_b32 v19, s90, v89
    v_pk_fma_f32 v[146:147], v[18:19], v[118:119], v[118:119] op_sel:[0,0,1] op_sel_hi:[1,0,1] neg_lo:[0,0,1] neg_hi:[0,0,1]
    v_cvt_pk_bf16_f32 v125, v146, v147
    v_lshlrev_b32 v146, 16, v125
    v_and_b32 v147, s90, v125
    v_pk_add_f32 v[146:147], v[146:147], v[18:19]
    v_cvt_pk_bf16_f32 v125, v146, v147
    ds_write_b64 v64, v[124:125]
    v_lshlrev_b32 v20, 16, v90
    v_and_b32 v21, s90, v90
    v_pk_fma_f32 v[148:149], v[20:21], v[118:119], v[118:119] op_sel:[0,0,1] op_sel_hi:[1,0,1] neg_lo:[0,0,1] neg_hi:[0,0,1]
    v_cvt_pk_bf16_f32 v126, v148, v149
    v_lshlrev_b32 v148, 16, v126
    v_and_b32 v149, s90, v126
    v_pk_add_f32 v[148:149], v[148:149], v[20:21]
    v_cvt_pk_bf16_f32 v126, v148, v149
    v_lshlrev_b32 v22, 16, v91
    v_and_b32 v23, s90, v91
    v_pk_fma_f32 v[150:151], v[22:23], v[118:119], v[118:119] op_sel:[0,0,1] op_sel_hi:[1,0,1] neg_lo:[0,0,1] neg_hi:[0,0,1]
    v_cvt_pk_bf16_f32 v127, v150, v151
    v_lshlrev_b32 v150, 16, v127
    v_and_b32 v151, s90, v127
    v_pk_add_f32 v[150:151], v[150:151], v[22:23]
    v_cvt_pk_bf16_f32 v127, v150, v151
    ds_write_b64 v65, v[126:127]
    v_lshlrev_b32 v24, 16, v92
    v_and_b32 v25, s90, v92
    v_pk_fma_f32 v[152:153], v[24:25], v[118:119], v[118:119] op_sel:[0,0,1] op_sel_hi:[1,0,1] neg_lo:[0,0,1] neg_hi:[0,0,1]
    v_cvt_pk_bf16_f32 v128, v152, v153
    v_lshlrev_b32 v152, 16, v128
    v_and_b32 v153, s90, v128
    v_pk_add_f32 v[152:153], v[152:153], v[24:25]
    v_cvt_pk_bf16_f32 v128, v152, v153
    v_lshlrev_b32 v26, 16, v93
    v_and_b32 v27, s90, v93
    v_pk_fma_f32 v[154:155], v[26:27], v[118:119], v[118:119] op_sel:[0,0,1] op_sel_hi:[1,0,1] neg_lo:[0,0,1] neg_hi:[0,0,1]
    v_cvt_pk_bf16_f32 v129, v154, v155
    v_lshlrev_b32 v154, 16, v129
    v_and_b32 v155, s90, v129
    v_pk_add_f32 v[154:155], v[154:155], v[26:27]
    v_cvt_pk_bf16_f32 v129, v154, v155
    ds_write_b64 v66, v[128:129]
    v_lshlrev_b32 v28, 16, v94
    v_and_b32 v29, s90, v94
    v_pk_fma_f32 v[156:157], v[28:29], v[118:119], v[118:119] op_sel:[0,0,1] op_sel_hi:[1,0,1] neg_lo:[0,0,1] neg_hi:[0,0,1]
    v_cvt_pk_bf16_f32 v130, v156, v157
    v_lshlrev_b32 v156, 16, v130
    v_and_b32 v157, s90, v130
    v_pk_add_f32 v[156:157], v[156:157], v[28:29]
    v_cvt_pk_bf16_f32 v130, v156, v157
    v_lshlrev_b32 v30, 16, v95
    v_and_b32 v31, s90, v95
    v_pk_fma_f32 v[158:159], v[30:31], v[118:119], v[118:119] op_sel:[0,0,1] op_sel_hi:[1,0,1] neg_lo:[0,0,1] neg_hi:[0,0,1]
    v_cvt_pk_bf16_f32 v131, v158, v159
    v_lshlrev_b32 v158, 16, v131
    v_and_b32 v159, s90, v131
    v_pk_add_f32 v[158:159], v[158:159], v[30:31]
    v_cvt_pk_bf16_f32 v131, v158, v159
    ds_write_b64 v67, v[130:131]
    v_and_b32 v7, 15, v1
    v_lshlrev_b32 v7, 3, v7
    s_cmp_eq_u32 s62, 0
    s_cbranch_scc0 L_nos4_71
    s_mul_i32 s76, s98, 9344
    s_add_u32 s76, s76, 8388608
    s_mov_b32 s88, 0
L_poll_72:
    buffer_load_dwordx2 v[196:197], v179, s[40:43], s76 offen offset:256 sc1
    buffer_load_dwordx4 v[188:191], v180, s[40:43], s76 offen offset:0 sc1
    buffer_load_dwordx4 v[192:195], v180, s[40:43], s76 offen offset:64 sc1
    s_waitcnt vmcnt(0)
    v_max3_u32 v4, v196, v197, v188
    v_max3_u32 v4, v4, v189, v190
    v_max3_u32 v4, v4, v191, v192
    v_max3_u32 v4, v4, v193, v194
    v_max_u32 v4, v4, v195
    v_cmp_eq_u32_e64 vcc, -1, v4
    s_nop 0
    s_cbranch_vccz L_ok_73
    s_add_u32 s88, s88, 1
    s_cmp_lt_u32 s88, 65536
    s_cbranch_scc1 L_poll_72
L_ok_73:
    ds_write_b128 v12, v[188:191] offset:28672
    ds_write_b128 v12, v[192:195] offset:29696
    ds_write_b64 v7, v[196:197] offset:25728
L_nos4_71:
    s_waitcnt lgkmcnt(0)
    s_barrier
    ds_read_b64 v[8:9], v7 offset:25728
    s_waitcnt lgkmcnt(0)
    v_max_f32_dpp v4, v8, v8 row_ror:8 row_mask:0xf bank_mask:0xf
    s_nop 1
    v_max_f32_dpp v4, v4, v4 row_ror:4 row_mask:0xf bank_mask:0xf
    s_nop 1
    v_max_f32_dpp v4, v4, v4 row_ror:2 row_mask:0xf bank_mask:0xf
    s_nop 1
    v_max_f32_dpp v4, v4, v4 row_ror:1 row_mask:0xf bank_mask:0xf
    v_cmp_eq_f32 vcc, v4, v8
    s_nop 0
    s_ff1_i32_b32 s92, vcc_lo
    s_and_b32 s92, s92, 15
    s_nop 3
    v_readlane_b32 s91, v9, s92
    s_nop 0
    s_cmp_eq_u32 s91, s79
    s_cbranch_scc0 L_noh_74
    s_mov_b32 exec_hi, 0
    buffer_store_dword v182, v177, s[40:43], s99 offen offset:128 sc1
    s_mov_b64 exec, -1
L_noh_74:
    s_sub_u32 s77, s91, s82
    v_lshrrev_b32 v7, 3, v1
    v_sub_u32 v5, s77, v7
    v_mov_b32 v6, 2146435072
    v_and_b32 v8, 7, v1
    v_lshrrev_b32 v9, 4, v1
    v_xor_b32 v8, v8, v9
    v_lshlrev_b32 v8, 4, v8
    v_lshl_add_u32 v7, v7, 11, v8
    v_xor_b32 v8, 64, v7
    s_lshl_b32 s76, s82, 11
    s_lshl_b32 s79, s98, 7
    s_add_u32 s76, s76, s79
    v_cmp_eq_u32 vcc, 0, v5
    s_nop 1
    v_cndmask_b32 v200, v7, v6, vcc
    v_cmp_eq_u32 vcc, 8, v5
    s_nop 1
    v_cndmask_b32 v201, v8, v6, vcc
    v_cmp_eq_u32 vcc, 16, v5
    s_nop 1
    v_cndmask_b32 v202, v7, v6, vcc
    v_cmp_eq_u32 vcc, 24, v5
    s_nop 1
    v_cndmask_b32 v203, v8, v6, vcc
    v_lshlrev_b32 v32, 16, v96
    v_and_b32 v33, s90, v96
    v_pk_fma_f32 v[160:161], v[32:33], v[118:119], v[118:119] op_sel:[0,0,1] op_sel_hi:[1,0,1] neg_lo:[0,0,1] neg_hi:[0,0,1]
    v_cvt_pk_bf16_f32 v132, v160, v161
    v_lshlrev_b32 v160, 16, v132
    v_and_b32 v161, s90, v132
    v_pk_add_f32 v[160:161], v[160:161], v[32:33]
    v_cvt_pk_bf16_f32 v132, v160, v161
    v_lshlrev_b32 v34, 16, v97
    v_and_b32 v35, s90, v97
    v_pk_fma_f32 v[162:163], v[34:35], v[118:119], v[118:119] op_sel:[0,0,1] op_sel_hi:[1,0,1] neg_lo:[0,0,1] neg_hi:[0,0,1]
    v_cvt_pk_bf16_f32 v133, v162, v163
    v_lshlrev_b32 v162, 16, v133
    v_and_b32 v163, s90, v133
    v_pk_add_f32 v[162:163], v[162:163], v[34:35]
    v_cvt_pk_bf16_f32 v133, v162, v163
    ds_write_b64 v68, v[132:133]
    v_lshlrev_b32 v36, 16, v98
    v_and_b32 v37, s90, v98
    v_pk_fma_f32 v[164:165], v[36:37], v[118:119], v[118:119] op_sel:[0,0,1] op_sel_hi:[1,0,1] neg_lo:[0,0,1] neg_hi:[0,0,1]
    v_cvt_pk_bf16_f32 v134, v164, v165
    v_lshlrev_b32 v164, 16, v134
    v_and_b32 v165, s90, v134
    v_pk_add_f32 v[164:165], v[164:165], v[36:37]
    v_cvt_pk_bf16_f32 v134, v164, v165
    v_lshlrev_b32 v38, 16, v99
    v_and_b32 v39, s90, v99
    v_pk_fma_f32 v[166:167], v[38:39], v[118:119], v[118:119] op_sel:[0,0,1] op_sel_hi:[1,0,1] neg_lo:[0,0,1] neg_hi:[0,0,1]
    v_cvt_pk_bf16_f32 v135, v166, v167
    v_lshlrev_b32 v166, 16, v135
    v_and_b32 v167, s90, v135
    v_pk_add_f32 v[166:167], v[166:167], v[38:39]
    v_cvt_pk_bf16_f32 v135, v166, v167
    ds_write_b64 v69, v[134:135]
    s_lshl_b32 s77, s62, 12
    s_add_u32 s77, s77, 0
    v_add_u32 v4, s77, v12
    s_barrier
    v_lshlrev_b32 v40, 16, v100
    v_and_b32 v41, s90, v100
    v_pk_fma_f32 v[168:169], v[40:41], v[118:119], v[118:119] op_sel:[0,0,1] op_sel_hi:[1,0,1] neg_lo:[0,0,1] neg_hi:[0,0,1]
    v_cvt_pk_bf16_f32 v136, v168, v169
    v_lshlrev_b32 v168, 16, v136
    v_and_b32 v169, s90, v136
    v_pk_add_f32 v[168:169], v[168:169], v[40:41]
    v_cvt_pk_bf16_f32 v136, v168, v169
    v_lshlrev_b32 v42, 16, v101
    v_and_b32 v43, s90, v101
    v_pk_fma_f32 v[170:171], v[42:43], v[118:119], v[118:119] op_sel:[0,0,1] op_sel_hi:[1,0,1] neg_lo:[0,0,1] neg_hi:[0,0,1]
    v_cvt_pk_bf16_f32 v137, v170, v171
    v_lshlrev_b32 v170, 16, v137
    v_and_b32 v171, s90, v137
    v_pk_add_f32 v[170:171], v[170:171], v[42:43]
    v_cvt_pk_bf16_f32 v137, v170, v171
    ds_write_b64 v70, v[136:137]
    v_lshlrev_b32 v44, 16, v102
    v_and_b32 v45, s90, v102
    v_pk_fma_f32 v[172:173], v[44:45], v[118:119], v[118:119] op_sel:[0,0,1] op_sel_hi:[1,0,1] neg_lo:[0,0,1] neg_hi:[0,0,1]
    v_cvt_pk_bf16_f32 v138, v172, v173
    v_lshlrev_b32 v172, 16, v138
    v_and_b32 v173, s90, v138
    v_pk_add_f32 v[172:173], v[172:173], v[44:45]
    v_cvt_pk_bf16_f32 v138, v172, v173
    v_lshlrev_b32 v46, 16, v103
    v_and_b32 v47, s90, v103
    v_pk_fma_f32 v[174:175], v[46:47], v[118:119], v[118:119] op_sel:[0,0,1] op_sel_hi:[1,0,1] neg_lo:[0,0,1] neg_hi:[0,0,1]
    v_cvt_pk_bf16_f32 v139, v174, v175
    v_lshlrev_b32 v174, 16, v139
    v_and_b32 v175, s90, v139
    v_pk_add_f32 v[174:175], v[174:175], v[46:47]
    v_cvt_pk_bf16_f32 v139, v174, v175
    ds_write_b64 v71, v[138:139]
    s_waitcnt lgkmcnt(0)
    ds_read_b128 v[48:51], v4 offset:0
    ds_read_b128 v[52:55], v4 offset:1024
    ds_read_b128 v[56:59], v4 offset:2048
    ds_read_b128 v[60:63], v4 offset:3072
    s_waitcnt lgkmcnt(3)
    buffer_store_dwordx4 v[48:51], v200, s[44:47], s76 offen sc1
    s_add_u32 s76, s76, 16384
    s_waitcnt lgkmcnt(2)
    buffer_store_dwordx4 v[52:55], v201, s[44:47], s76 offen sc1
    s_add_u32 s76, s76, 16384
    s_waitcnt lgkmcnt(1)
    buffer_store_dwordx4 v[56:59], v202, s[44:47], s76 offen sc1
    s_add_u32 s76, s76, 16384
    s_waitcnt lgkmcnt(0)
    buffer_store_dwordx4 v[60:63], v203, s[44:47], s76 offen sc1
L_cfin:
L_end:
    s_endpgm
L_tr0:
    s_call_b64 s[54:55], L_stall
    s_branch L_bk0
L_tr1:
    s_call_b64 s[54:55], L_stall
    s_branch L_bk1
L_tr2:
    s_call_b64 s[54:55], L_stall
    s_branch L_bk2
L_tr3:
    s_call_b64 s[54:55], L_stall
    s_branch L_bk3
L_tr4:
    s_call_b64 s[54:55], L_stall
    s_branch L_bk4
L_tr5:
    s_call_b64 s[54:55], L_stall
    s_branch L_bk5
L_tr6:
    s_call_b64 s[54:55], L_stall
    s_branch L_bk6
L_tr7:
    s_call_b64 s[54:55], L_stall
    s_branch L_bk7
L_tr8:
    s_call_b64 s[54:55], L_stall
    s_branch L_bk8
L_tr9:
    s_call_b64 s[54:55], L_stall
    s_branch L_bk9
L_tr10:
    s_call_b64 s[54:55], L_stall
    s_branch L_bk10
L_tr11:
    s_call_b64 s[54:55], L_stall
    s_branch L_bk11
L_tr12:
    s_call_b64 s[54:55], L_stall
    s_branch L_bk12
L_tr13:
    s_call_b64 s[54:55], L_stall
    s_branch L_bk13
L_tr14:
    s_call_b64 s[54:55], L_stall
    s_branch L_bk14
L_tr15:
    s_call_b64 s[54:55], L_stall
    s_branch L_bk15
L_stall:
    s_cmp_eq_u32 s53, 0
    s_cbranch_scc0 L_sent_56
    s_waitcnt vmcnt(0)
    s_mov_b64 exec, 1
    ds_add_u32 v8, v74 offset:25988
    s_mov_b64 exec, -1
    s_mov_b32 s53, 1
L_sent_56:
    s_mov_b32 s88, 0
L_stall1:
    ds_read_b32 v79, v8 offset:25984
    s_waitcnt lgkmcnt(0)
    v_readfirstlane_b32 s76, v79
    s_nop 0
    s_and_b32 s76, s76, s52
    s_cbranch_scc1 L_stall2
    s_add_u32 s88, s88, 1
    s_cmp_lt_u32 s88, 1048576
    s_cbranch_scc1 L_stall1
    s_mov_b32 s76, s52
L_stall2:
    s_setpc_b64 s[54:55]
L_code_end:
s_endpgm
.p2align 7
.type L_table,@object
L_table:
.long 0xf54b3721, 0xedca986, 0x40102, 0x3005
.long 0x65c03824, 0xfedba97, 0x400201, 0x3050
.long 0x6d419035, 0xfecba87, 0x4000120, 0x3500
.long 0x76543218, 0xfedcba9, 0x40000012, 0x5300
.long 0xf54b3721, 0xedca986, 0x14002, 0x3005
.long 0x65c03824, 0xfedba97, 0x400120, 0x3050
.long 0x6d419035, 0xfecba87, 0x4002001, 0x3500
.long 0x5e4a2160, 0xfdcb987, 0x41020000, 0x5300
.long 0xf54b3721, 0xedca986, 0x10040200, 0x3005
.long 0x65c03824, 0xfedba97, 0x400012, 0x3050
.long 0x6d419035, 0xfecba87, 0x1402000, 0x3500
.long 0x76543218, 0xfedcba9, 0x41000200, 0x5300
.long 0xf54b3721, 0xedca986, 0x41200, 0x3005
.long 0x65c03824, 0xfedba97, 0x140002, 0x3050
.long 0x6d419035, 0xfecba87, 0x4001020, 0x3500
.long 0x5e4a2160, 0xfdcb987, 0x42010000, 0x5300
.long 0x65c03824, 0xfedba97, 0x400021, 0x3050
.long 0x6d419035, 0xfecba87, 0x2400010, 0x3500
.long 0x5e4a2160, 0xfdcb987, 0x42000010, 0x5300
.long 0x76543209, 0xfedcba8, 0x10040002, 0x3005
.long 0x65c03824, 0xfedba97, 0x400102, 0x3050
.long 0x6d419035, 0xfecba87, 0x4010020, 0x3500
.long 0x5e4a2160, 0xfdcb987, 0x40000021, 0x5300
.long 0xf54b3721, 0xedca986, 0x20014000, 0x3005
.long 0x65c03824, 0xfedba97, 0x140002, 0x3050
.long 0x6d419035, 0xfecba87, 0x2400001, 0x3500
.long 0x5e4a2160, 0xfdcb987, 0x40010020, 0x5300
.long 0x76543209, 0xfedcba8, 0x24001, 0x3005
.long 0x65c03824, 0xfedba97, 0x400012, 0x3050
.long 0x6d419035, 0xfecba87, 0x1400002, 0x3500
.long 0x5e4a2160, 0xfdcb987, 0x41020000, 0x5300
.long 0xf54b3721, 0xedca986, 0x10024000, 0x3005
.long 0x6d419035, 0xfecba87, 0x1400002, 0x3500
.long 0x5e4a2160, 0xfdcb987, 0x40020010, 0x5300
.long 0xf54b3721, 0xedca986, 0x14002, 0x3005
.long 0x765431a0, 0xfedcb98, 0x400021, 0x3050
.long 0x6d419035, 0xfecba87, 0x4001020, 0x3500
.long 0x5e4a2160, 0xfdcb987, 0x41000002, 0x5300
.long 0xf54b3721, 0xedca986, 0x20040001, 0x3005
.long 0x65c03824, 0xfedba97, 0x240100, 0x3050
.long 0x6d419035, 0xfecba87, 0x4002001, 0x3500
.long 0x5e4a2160, 0xfdcb987, 0x42001000, 0x5300
.long 0xf54b3721, 0xedca986, 0x20040100, 0x3005
.long 0x765431a0, 0xfedcb98, 0x410020, 0x3050
.long 0x6d419035, 0xfecba87, 0x2400010, 0x3500
.long 0x5e4a2160, 0xfdcb987, 0x42010000, 0x5300
.long 0xf54b3721, 0xedca986, 0x10024000, 0x3005
.long 0x65c03824, 0xfedba97, 0x140002, 0x3050
.long 0x5e4a2160, 0xfdcb987, 0x42000010, 0x5300
.long 0xf54b3721, 0xedca986, 0x10024000, 0x3005
.long 0x65c03824, 0xfedba97, 0x140200, 0x3050
.long 0x765421b0, 0xfedca98, 0x4200010, 0x3500
.long 0x5e4a2160, 0xfdcb987, 0x40000120, 0x5300
.long 0xf54b3721, 0xedca986, 0x20040010, 0x3005
.long 0x65c03824, 0xfedba97, 0x1400020, 0x3050
.long 0x6d419035, 0xfecba87, 0x1400020, 0x3500
.long 0x5e4a2160, 0xfdcb987, 0x40010020, 0x5300
.long 0xf54b3721, 0xedca986, 0x20040100, 0x3005
.long 0x65c03824, 0xfedba97, 0x400102, 0x3050
.long 0x765421b0, 0xfedca98, 0x4000021, 0x3500
.long 0x5e4a2160, 0xfdcb987, 0x41020000, 0x5300
.long 0xf54b3721, 0xedca986, 0x124000, 0x3005
.long 0x65c03824, 0xfedba97, 0x401002, 0x3050
.long 0x6d419035, 0xfecba87, 0x4001020, 0x3500
.long 0xf54b3721, 0xedca986, 0x10040200, 0x3005
.long 0x65c03824, 0xfedba97, 0x240001, 0x3050
.long 0x6d419035, 0xfecba87, 0x1402000, 0x3500
.long 0x76532c10, 0xfedba98, 0x40000201, 0x5300
.long 0xf54b3721, 0xedca986, 0x41200, 0x3005
.long 0x65c03824, 0xfedba97, 0x400102, 0x3050
.long 0x6d419035, 0xfecba87, 0x14000020, 0x3500
.long 0x5e4a2160, 0xfdcb987, 0x41000002, 0x5300
.long 0xf54b3721, 0xedca986, 0x24001, 0x3005
.long 0x65c03824, 0xfedba97, 0x140200, 0x3050
.long 0x6d419035, 0xfecba87, 0x4001002, 0x3500
.long 0x76532c10, 0xfedba98, 0x14000200, 0x5300
.long 0xf54b3721, 0xedca986, 0x20014000, 0x3005
.long 0x65c03824, 0xfedba97, 0x240010, 0x3050
.long 0x6d419035, 0xfecba87, 0x4002001, 0x3500
.long 0x5e4a2160, 0xfdcb987, 0x40010020, 0x5300
.long 0x65c03824, 0xfedba97, 0x140200, 0x3050
.long 0x6d419035, 0xfecba87, 0x4001020, 0x3500
.long 0x5e4a2160, 0xfdcb987, 0x40010002, 0x5300
.long 0x76432d10, 0xfecba98, 0x40201, 0x3005
.long 0x65c03824, 0xfedba97, 0x400201, 0x3050
.long 0x6d419035, 0xfecba87, 0x1400002, 0x3500
.long 0x5e4a2160, 0xfdcb987, 0x41020000, 0x5300
.long 0xf54b3721, 0xedca986, 0x10040002, 0x3005
.long 0x65c03824, 0xfedba97, 0x400120, 0x3050
.long 0x6d419035, 0xfecba87, 0x4000012, 0x3500
.long 0x5e4a2160, 0xfdcb987, 0x40000012, 0x5300
.long 0x76432d10, 0xfecba98, 0x10040200, 0x3005
.long 0x65c03824, 0xfedba97, 0x400210, 0x3050
.long 0x6d419035, 0xfecba87, 0x2400001, 0x3500
.long 0x5e4a2160, 0xfdcb987, 0x40000102, 0x5300
.long 0xf54b3721, 0xedca986, 0x14002, 0x3005
.long 0x6d419035, 0xfecba87, 0x2401000, 0x3500
.long 0x5e4a2160, 0xfdcb987, 0x42100000, 0x5300
.long 0xf54b3721, 0xedca986, 0x20014000, 0x3005
.long 0x7543e210, 0xfdcba98, 0x20401000, 0x3050
.long 0x6d419035, 0xfecba87, 0x2400010, 0x3500
.long 0x5e4a2160, 0xfdcb987, 0x42000010, 0x5300
.long 0xf54b3721, 0xedca986, 0x24001, 0x3005
.long 0x65c03824, 0xfedba97, 0x400102, 0x3050
.long 0x6d419035, 0xfecba87, 0x4000021, 0x3500
.long 0x5e4a2160, 0xfdcb987, 0x40000021, 0x5300
.long 0xf54b3721, 0xedca986, 0x40102, 0x3005
.long 0x7543e210, 0xfdcba98, 0x402100, 0x3050
.long 0x6d419035, 0xfecba87, 0x1400020, 0x3500
.long 0x5e4a2160, 0xfdcb987, 0x40010002, 0x5300
.long 0xf54b3721, 0xedca986, 0x10040002, 0x3005
.long 0x65c03824, 0xfedba97, 0x140200, 0x3050
.long 0x5e4a2160, 0xfdcb987, 0x40001002, 0x5300
.long 0xf54b3721, 0xedca986, 0x41002, 0x3005
.long 0x65c03824, 0xfedba97, 0x240001, 0x3050
.long 0x6543f210, 0xedcba98, 0x4002001, 0x3500
.long 0x5e4a2160, 0xfdcb987, 0x40000012, 0x5300
.long 0xf54b3721, 0xedca986, 0x40201, 0x3005
.long 0x65c03824, 0xfedba97, 0x1400200, 0x3050
.long 0x6d419035, 0xfecba87, 0x1402000, 0x3500
.long 0x5e4a2160, 0xfdcb987, 0x41000002, 0x5300
.long 0xf54b3721, 0xedca986, 0x14200, 0x3005
.long 0x65c03824, 0xfedba97, 0x240100, 0x3050
.long 0x6543f210, 0xedcba98, 0x2401000, 0x3500
.long 0x5e4a2160, 0xfdcb987, 0x40010020, 0x5300
.long 0xf54b3721, 0xedca986, 0x20040100, 0x3005
.long 0x65c03824, 0xfedba97, 0x140200, 0x3050
.long 0x6d419035, 0xfecba87, 0x2401000, 0x3500
.long 0xf54b3721, 0xedca986, 0x20040100, 0x3005
.long 0x65c03824, 0xfedba97, 0x140002, 0x3050
.long 0x6d419035, 0xfecba87, 0x1400002, 0x3500
.long 0x76543218, 0xfedcba9, 0x42001000, 0x5300
.long 0xf54b3721, 0xedca986, 0x10024000, 0x3005
.long 0x65c03824, 0xfedba97, 0x240001, 0x3050
.long 0x6d419035, 0xfecba87, 0x4001002, 0x3500
.long 0x5e4a2160, 0xfdcb987, 0x40010020, 0x5300
.long 0xf54b3721, 0xedca986, 0x20014000, 0x3005
.long 0x65c03824, 0xfedba97, 0x400120, 0x3050
.long 0x6d419035, 0xfecba87, 0x2400100, 0x3500
.long 0x76543218, 0xfedcba9, 0x40000102, 0x5300
.long 0xf54b3721, 0xedca986, 0x24001, 0x3005
.long 0x65c03824, 0xfedba97, 0x10400200, 0x3050
.long 0x6d419035, 0xfecba87, 0x2400001, 0x3500
.long 0x5e4a2160, 0xfdcb987, 0x41020000, 0x5300
.long 0x65c03824, 0xfedba97, 0x140002, 0x3050
.long 0x6d419035, 0xfecba87, 0x4002001, 0x3500
.long 0x5e4a2160, 0xfdcb987, 0x40000021, 0x5300
.long 0x76543209, 0xfedcba8, 0x10040020, 0x3005
.long 0x65c03824, 0xfedba97, 0x240001, 0x3050
.long 0x6d419035, 0xfecba87, 0x2410000, 0x3500
.long 0x5e4a2160, 0xfdcb987, 0x40010002, 0x5300
.long 0xf54b3721, 0xedca986, 0x10024000, 0x3005
.long 0x65c03824, 0xfedba97, 0x241000, 0x3050
.long 0x6d419035, 0xfecba87, 0x4001020, 0x3500
.long 0x5e4a2160, 0xfdcb987, 0x41020000, 0x5300
.long 0x76543209, 0xfedcba8, 0x40102, 0x3005
.long 0x65c03824, 0xfedba97, 0x240100, 0x3050
.long 0x6d419035, 0xfecba87, 0x1400020, 0x3500
.long 0x5e4a2160, 0xfdcb987, 0x42000010, 0x5300
.long 0xf54b3721, 0xedca986, 0x14200, 0x3005
.long 0x6d419035, 0xfecba87, 0x4000120, 0x3500
.long 0x5e4a2160, 0xfdcb987, 0x40000120, 0x5300
.long 0xf54b3721, 0xedca986, 0x24010, 0x3005
.long 0x765431a0, 0xfedcb98, 0x10400200, 0x3050
.long 0x6d419035, 0xfecba87, 0x1400002, 0x3500
.long 0x5e4a2160, 0xfdcb987, 0x40120000, 0x5300
.long 0xf54b3721, 0xedca986, 0x14002, 0x3005
.long 0x65c03824, 0xfedba97, 0x140020, 0x3050
.long 0x6d419035, 0xfecba87, 0x4001002, 0x3500
.long 0x5e4a2160, 0xfdcb987, 0x41020000, 0x5300
.long 0xf54b3721, 0xedca986, 0x10024000, 0x3005
.long 0x765431a0, 0xfedcb98, 0x400012, 0x3050
.long 0x6d419035, 0xfecba87, 0x4002001, 0x3500
.long 0x5e4a2160, 0xfdcb987, 0x40020010, 0x5300
.long 0xf54b3721, 0xedca986, 0x41200, 0x3005
.long 0x65c03824, 0xfedba97, 0x400120, 0x3050
.long 0x5e4a2160, 0xfdcb987, 0x41020000, 0x5300
.long 0xf54b3721, 0xedca986, 0x20040100, 0x3005
.long 0x65c03824, 0xfedba97, 0x140020, 0x3050
.long 0x765421b0, 0xfedca98, 0x4000021, 0x3500
.long 0x5e4a2160, 0xfdcb987, 0x42010000, 0x5300
.long 0xf54b3721, 0xedca986, 0x24010, 0x3005
.long 0x65c03824, 0xfedba97, 0x400102, 0x3050
.long 0x6d419035, 0xfecba87, 0x1400002, 0x3500
.long 0x5e4a2160, 0xfdcb987, 0x42000010, 0x5300
.long 0xf54b3721, 0xedca986, 0x24001, 0x3005
.long 0x65c03824, 0xfedba97, 0x401020, 0x3050
.long 0x765421b0, 0xfedca98, 0x24000010, 0x3500
.long 0x5e4a2160, 0xfdcb987, 0x12000000, 0x5304
.long 0xf54b3721, 0xedca986, 0x10040002, 0x3005
.long 0x65c03824, 0xfedba97, 0x400021, 0x3050
.long 0x6d419035, 0xfecba87, 0x4001002, 0x3500
.long 0xf54b3721, 0xedca986, 0x10024000, 0x3005
.long 0x65c03824, 0xfedba97, 0x400120, 0x3050
.long 0x6d419035, 0xfecba87, 0x2401000, 0x3500
.long 0x76532c10, 0xfedba98, 0x40002001, 0x5300
.long 0xf54b3721, 0xedca986, 0x20040001, 0x3005
.long 0x65c03824, 0xfedba97, 0x400201, 0x3050
.long 0x6d419035, 0xfecba87, 0x2400001, 0x3500
.long 0x5e4a2160, 0xfdcb987, 0x42010000, 0x5300
.long 0xf54b3721, 0xedca986, 0x40102, 0x3005
.long 0x65c03824, 0xfedba97, 0x240010, 0x3050
.long 0x6d419035, 0xfecba87, 0x1400020, 0x3500
.long 0x76532c10, 0xfedba98, 0x40020100, 0x5300
.long 0xf54b3721, 0xedca986, 0x14002, 0x3005
.long 0x65c03824, 0xfedba97, 0x401020, 0x3050
.long 0x6d419035, 0xfecba87, 0x14000002, 0x3500
.long 0x5e4a2160, 0xfdcb987, 0x41000002, 0x5300
.long 0x65c03824, 0xfedba97, 0x240001, 0x3050
.long 0x6d419035, 0xfecba87, 0x4001002, 0x3500
.long 0x5e4a2160, 0xfdcb987, 0x40020001, 0x5300
.long 0x76432d10, 0xfecba98, 0x10240000, 0x3005
.long 0x65c03824, 0xfedba97, 0x400120, 0x3050
.long 0x6d419035, 0xfecba87, 0x4002010, 0x3500
.long 0x5e4a2160, 0xfdcb987, 0x42010000, 0x5300
.long 0xf54b3721, 0xedca986, 0x10040200, 0x3005
.long 0x65c03824, 0xfedba97, 0x400210, 0x3050
.long 0x6d419035, 0xfecba87, 0x4002001, 0x3500
.long 0x5e4a2160, 0xfdcb987, 0x42000010, 0x5300
.long 0x76432d10, 0xfecba98, 0x2040100, 0x3005
.long 0x65c03824, 0xfedba97, 0x140020, 0x3050
.long 0x6d419035, 0xfecba87, 0x4012000, 0x3500
.long 0x5e4a2160, 0xfdcb987, 0x41000020, 0x5300
.long 0xf54b3721, 0xedca986, 0x20014000, 0x3005
.long 0x6d419035, 0xfecba87, 0x1402000, 0x3500
.long 0x5e4a2160, 0xfdcb987, 0x40010002, 0x5300
.long 0xf54b3721, 0xedca986, 0x14200, 0x3005
.long 0x7543e210, 0xfdcba98, 0x402001, 0x3050
.long 0x6d419035, 0xfecba87, 0x4002010, 0x3500
.long 0x5e4a2160, 0xfdcb987, 0x41000020, 0x5300
.long 0xf54b3721, 0xedca986, 0x10040200, 0x3005
.long 0x65c03824, 0xfedba97, 0x140200, 0x3050
.long 0x6d419035, 0xfecba87, 0x2400001, 0x3500
.long 0x5e4a2160, 0xfdcb987, 0x40000012, 0x5300
.long 0xf54b3721, 0xedca986, 0x40201, 0x3005
.long 0x7543e210, 0xfdcba98, 0x400120, 0x3050
.long 0x6d419035, 0xfecba87, 0x4001002, 0x3500
.long 0x5e4a2160, 0xfdcb987, 0x40100020, 0x5300
.long 0xf54b3721, 0xedca986, 0x20040100, 0x3005
.long 0x65c03824, 0xfedba97, 0x240100, 0x3050
.long 0x5e4a2160, 0xfdcb987, 0x40010020, 0x5300
.long 0xf54b3721, 0xedca986, 0x14200, 0x3005
.long 0x65c03824, 0xfedba97, 0x400102, 0x3050
.long 0x6543f210, 0xedcba98, 0x4021000, 0x3500
.long 0x5e4a2160, 0xfdcb987, 0x40020001, 0x5300
.long 0xf54b3721, 0xedca986, 0x1040002, 0x3005
.long 0x65c03824, 0xfedba97, 0x240001, 0x3050
.long 0x6d419035, 0xfecba87, 0x2401000, 0x3500
.long 0x5e4a2160, 0xfdcb987, 0x41020000, 0x5300
.long 0xf54b3721, 0xedca986, 0x40102, 0x3005
.long 0x65c03824, 0xfedba97, 0x140200, 0x3050
.long 0x6543f210, 0xedcba98, 0x4002010, 0x3500
.long 0x5e4a2160, 0xfdcb987, 0x40000012, 0x5300
.long 0xf54b3721, 0xedca986, 0x41200, 0x3005
.long 0x65c03824, 0xfedba97, 0x240010, 0x3050
.long 0x6d419035, 0xfecba87, 0x1402000, 0x3500
.fill 1, 4, 0
.size L_table, .-L_table
.section .rodata,"a"
.p2align 6
.amdhsa_kernel sequential_preLN__linear_kernel_hedgehog__moe_arch_mod__prompt_kernel
  .amdhsa_next_free_vgpr 256
  .amdhsa_next_free_sgpr 102
  .amdhsa_accum_offset 256
  .amdhsa_group_segment_fixed_size 0
  .amdhsa_kernarg_size 96
  .amdhsa_user_sgpr_count 2
  .amdhsa_user_sgpr_kernarg_segment_ptr 1
  .amdhsa_system_sgpr_workgroup_id_x 1
  .amdhsa_float_denorm_mode_32 3
.end_amdhsa_kernel
```

```asm
; @launch grid=(256,1,1) block=(512,1,1) lds=163840
.amdgcn_target "amdgcn-amd-amdhsa--gfx950"
.text
.globl sequential_preLN__linear_kernel_hedgehog__moe_arch_mod__prompt_kernel
.p2align 8
.type sequential_preLN__linear_kernel_hedgehog__moe_arch_mod__prompt_kernel,@function
sequential_preLN__linear_kernel_hedgehog__moe_arch_mod__prompt_kernel:
    s_cmp_ge_u32 s2, 256
    s_cbranch_scc1 L_end
    s_load_dwordx8 s[4:11], s[0:1], 0
    s_load_dwordx8 s[12:19], s[0:1], 32
    s_load_dwordx8 s[20:27], s[0:1], 64
    v_lshrrev_b32 v4, 6, v0
    v_and_b32 v1, 63, v0
    v_readfirstlane_b32 s79, v4
    s_and_b32 s76, s2, 7
    s_lshr_b32 s77, s2, 3
    s_and_b32 s60, s77, 15
    s_lshl_b32 s76, s76, 3
    s_bfe_u32 s77, s2, 0x10007
    s_lshl2_add_u32 s76, s77, s76
    s_mov_b32 s80, 0x654210b3
    s_mov_b32 s81, 0xfedca987
    s_lshr_b64 s[80:81], s[80:81], s76
    s_and_b32 s61, s80, 15
    s_and_b32 s62, s79, 3
    s_cmp_ge_u32 s79, 4
    s_cbranch_scc1 L_compute
    s_getpc_b64 s[66:67]
L_pc:
    s_lshr_b32 s76, s2, 3
    s_lshl2_add_u32 s76, s76, s62
    s_mul_i32 s76, s76, 256
    v_lshl_add_u32 v91, v1, 7, s76
    s_mov_b64 exec, 3
    global_load_dword v27, v91, s[66:67]
    s_mov_b64 exec, -1
    s_add_u32 s84, s60, s61
    s_and_b32 s84, s84, 3
    s_and_b32 s76, s60, 7
    s_and_b32 s77, s61, 7
    s_cmp_eq_u32 s77, 3
    s_cselect_b32 s84, s76, s84
    v_lshrrev_b32 v4, 3, v1
    v_and_b32 v5, 7, v1
    v_lshrrev_b32 v6, 4, v1
    s_lshl_b32 s76, s60, 18
    s_lshl_b32 s77, s62, 16
    s_add_u32 s76, s76, s77
    v_xor_b32 v7, v5, v6
    v_lshlrev_b32_e64 v7, 4, v7
    v_lshl_add_u32 v78, v4, 11, v7
    v_add_u32 v16, s76, v78
    v_xor_b32 v7, 64, v16
    v_add_u32 v17, 15360, v7
    v_add_u32 v18, 30720, v16
    v_add_u32 v19, 46080, v7
    v_and_b32 v6, 1, v6
    v_lshlrev_b32 v6, 2, v6
    v_xor_b32 v8, v5, v6
    v_lshlrev_b32_e64 v8, 4, v8
    s_lshl_b32 s76, s61, 7
    s_mul_i32 s77, s62, 98304
    s_add_u32 s76, s76, s77
    v_mul_u32_u24 v7, 6144, v4
    v_add3_u32 v20, v7, v8, s76
    v_xor_b32 v7, 32, v20
    v_add_u32 v21, 48128, v7
    v_add_u32_e64 v22, 0, v20
    v_add_u32 v23, 48128, v7
    v_add_u32 v24, 4096, v20
    v_add_u32 v25, 52224, v7
    s_mul_i32 s70, s62, 10240
    s_waitcnt lgkmcnt(0)
    s_mov_b32 s28, s4
    s_and_b32 s29, s5, 0xffff
    s_mov_b32 s30, 4194304
    s_mov_b32 s31, 0x20000
    s_mov_b32 s32, s6
    s_and_b32 s33, s7, 0xffff
    s_mov_b32 s34, 6291456
    s_mov_b32 s35, 0x20000
    s_and_b32 s72, s84, 15
    s_mov_b32 m0, s70
    s_lshl_b32 s71, s72, 7
    buffer_load_dwordx4 v16, s[28:31], s71 offen offset:0 lds
    s_mul_i32 s72, s72, 393216
    s_lshr_b64 s[84:85], s[84:85], 4
    buffer_load_dwordx4 v17, s[28:31], s71 offen offset:1024 lds
    buffer_load_dwordx4 v18, s[28:31], s71 offen offset:2048 lds
    buffer_load_dwordx4 v19, s[28:31], s71 offen offset:3072 lds
    s_add_u32 m0, s70, 4096
    s_nop 0
    buffer_load_dwordx4 v20, s[32:35], s72 offen offset:0 lds
    buffer_load_dwordx4 v21, s[32:35], s72 offen offset:1024 lds
    buffer_load_dwordx4 v22, s[32:35], s72 offen offset:2048 lds
    buffer_load_dwordx4 v23, s[32:35], s72 offen offset:3072 lds
    s_add_u32 m0, s70, 8192
    s_nop 0
    buffer_load_dwordx4 v24, s[32:35], s72 offen offset:0 lds
    buffer_load_dwordx4 v25, s[32:35], s72 offen offset:1024 lds
    s_add_u32 s70, s70, 40960
    s_cmp_ge_u32 s70, 122880
    s_cselect_b32 s76, 122880, 0
    s_sub_u32 s70, s70, s76
    s_lshl_b32 s76, s60, 8
    s_lshl_b32 s77, s61, 4
    s_add_u32 s76, s76, s77
    s_add_u32 s76, s76, 29068
    s_load_dwordx4 s[84:87], s[66:67], s76
    v_lshl_add_u32 v26, v4, 11, v8
    v_xor_b32 v79, 64, v78
    s_and_b32 s63, s62, 1
    s_lshr_b32 s64, s62, 1
    s_lshl_b32 s73, s60, 4
    s_add_u32 s73, s73, s61
    s_mul_i32 s73, s73, 28800
    s_add_u32 s76, s2, 7
    s_and_b32 s76, s76, 7
    s_bfe_u32 s77, s2, 0x10003
    s_lshl1_add_u32 s97, s76, s77
    s_lshr_b32 s98, s2, 4
    s_lshl_b32 s99, s97, 4
    s_add_u32 s99, s99, s98
    s_mul_i32 s99, s99, 9344
    s_add_u32 s99, s99, 8388608
    s_lshr_b32 s65, s97, 1
    s_lshl_b32 s76, s97, 3
    s_add_u32 s65, s65, s76
    s_mul_i32 s76, s98, 4
    s_add_u32 s65, s65, s76
    s_and_b32 s65, s65, 15
    s_mov_b32 s89, 0x3f803f80
    s_mov_b32 s90, 0xffff0000
    v_and_b32 v2, 31, v1
    v_lshrrev_b32 v3, 5, v1
    v_lshlrev_b32 v12, 4, v1
    v_lshrrev_b32 v4, 3, v1
    v_mul_u32_u24 v13, 460800, v4
    v_and_b32_e64 v4, 7, v1
    v_lshl_add_u32 v13, v4, 4, v13
    s_lshl_b32 s76, s98, 7
    s_lshl_b32 s77, s62, 15
    s_add_u32 s76, s76, s77
    v_add_u32_e64 v26, s76, v26
    s_mov_b32 s40, s26
    s_and_b32 s41, s27, 0xffff
    s_mov_b32 s42, 33554432
    s_mov_b32 s43, 0x20000
    s_mov_b32 s56, s8
    s_and_b32 s57, s9, 0xffff
    s_mov_b32 s58, 65536
    s_mov_b32 s59, 0x20000
    v_mov_b32 v28, -1
    v_mov_b32 v29, -1
    v_mov_b32 v30, -1
    v_mov_b32_e64 v31, -1
    s_waitcnt lgkmcnt(0)
    s_and_b32 s72, s84, 15
    s_mov_b32 m0, s70
    s_lshl_b32 s71, s72, 7
    buffer_load_dwordx4 v16, s[28:31], s71 offen offset:0 lds
    s_mul_i32 s72, s72, 393216
    s_lshr_b64 s[84:85], s[84:85], 4
    buffer_load_dwordx4 v17, s[28:31], s71 offen offset:1024 lds
    buffer_load_dwordx4 v18, s[28:31], s71 offen offset:2048 lds
    buffer_load_dwordx4 v19, s[28:31], s71 offen offset:3072 lds
    s_add_u32 m0, s70, 4096
    s_nop 0
    buffer_load_dwordx4 v20, s[32:35], s72 offen offset:0 lds
    buffer_load_dwordx4 v21, s[32:35], s72 offen offset:1024 lds
    buffer_load_dwordx4 v22, s[32:35], s72 offen offset:2048 lds
    buffer_load_dwordx4 v23, s[32:35], s72 offen offset:3072 lds
    s_add_u32 m0, s70, 8192
    s_nop 0
    buffer_load_dwordx4 v24, s[32:35], s72 offen offset:0 lds
    buffer_load_dwordx4 v25, s[32:35], s72 offen offset:1024 lds
    s_add_u32 s70, s70, 40960
    s_cmp_ge_u32 s70, 122880
    s_cselect_b32 s76, 122880, 0
    s_sub_u32 s70, s70, s76
    s_lshl_b32 s77, s62, 10
    s_add_u32 s76, s77, s73
    buffer_store_dwordx4 v[28:31], v12, s[40:43], s76 offen sc1
    s_lshl_b32 s76, s61, 12
    s_add_u32 s76, s76, s77
    s_add_u32 m0, s77, 122880
    s_nop 0
    buffer_load_dwordx4 v12, s[56:59], s76 offen lds
    v_mov_b32 v4, 13631488
    buffer_load_dwordx2 v[88:89], v4, s[40:43], 0 offen
    s_waitcnt vmcnt(13)
    s_barrier
    s_and_b32 s72, s84, 15
    s_mov_b32 m0, s70
    s_lshl_b32 s71, s72, 7
    buffer_load_dwordx4 v16, s[28:31], s71 offen offset:0 lds
    s_mul_i32 s72, s72, 393216
    s_lshr_b64 s[84:85], s[84:85], 4
    buffer_load_dwordx4 v17, s[28:31], s71 offen offset:1024 lds
    buffer_load_dwordx4 v18, s[28:31], s71 offen offset:2048 lds
    buffer_load_dwordx4 v19, s[28:31], s71 offen offset:3072 lds
    s_add_u32 m0, s70, 4096
    s_nop 0
    buffer_load_dwordx4 v20, s[32:35], s72 offen offset:0 lds
    buffer_load_dwordx4 v21, s[32:35], s72 offen offset:1024 lds
    buffer_load_dwordx4 v22, s[32:35], s72 offen offset:2048 lds
    buffer_load_dwordx4 v23, s[32:35], s72 offen offset:3072 lds
    s_add_u32 m0, s70, 8192
    s_nop 0
    buffer_load_dwordx4 v24, s[32:35], s72 offen offset:0 lds
    buffer_load_dwordx4 v25, s[32:35], s72 offen offset:1024 lds
    s_add_u32 s70, s70, 40960
    s_cmp_ge_u32 s70, 122880
    s_cselect_b32 s76, 122880, 0
    s_sub_u32 s70, s70, s76
    s_mov_b32 s36, s10
    s_and_b32 s37, s11, 0xffff
    s_mov_b32 s38, 2097152
    s_mov_b32 s39, 0x20000
    s_mov_b32 s44, s22
    s_and_b32 s45, s23, 0xffff
    s_mov_b32 s46, 4194304
    s_mov_b32 s47, 0x20000
    s_mov_b32 s52, s20
    s_and_b32 s53, s21, 0xffff
    s_mov_b32 s54, 7340032
    s_mov_b32 s55, 0x20000
    s_cmp_eq_u32 s64, 0
    s_cselect_b32 s48, s16, s18
    s_cselect_b32 s49, s17, s19
    s_and_b32 s49, s49, 0xffff
    s_mov_b32 s51, 0x20000
    s_cmp_lt_u32 s97, 14
    s_cselect_b32 s50, 7340032, 0
    s_cselect_b32 s54, 7340032, 0
    v_bfe_u32 v4, v2, 1, 3
    v_xor_b32 v4, v4, v3
    v_lshlrev_b32_e64 v4, 4, v4
    v_lshl_add_u32 v72, v2, 7, v4
    v_bfe_u32 v4, v1, 2, 2
    v_lshl_add_u32 v5, v3, 3, v4
    v_lshlrev_b32 v5, 7, v5
    v_lshrrev_b32 v4, 1, v4
    v_xor_b32_e64 v4, s64, v4
    v_lshl_add_u32 v5, v4, 6, v5
    v_bfe_u32 v4, v1, 4, 1
    v_xor_b32_e64 v4, v4, v3
    v_lshl_add_u32 v5, v4, 5, v5
    v_and_b32_e64 v4, 3, v1
    v_lshl_add_u32 v5, v4, 3, v5
    s_mul_i32 s76, s62, 10240
    s_sub_u32 s76, 4096, s76
    v_add_u32_e64 v73, s76, v5
    v_mul_u32_u24 v74, 28800, v3
    v_lshl_add_u32 v74, v2, 3, v74
    v_lshrrev_b32 v4, 4, v1
    v_and_b32 v5, 15, v1
    v_mul_u32_u24 v75, 460800, v4
    v_lshl_add_u32 v75, v5, 4, v75
    v_mul_u32_u24 v76, 114688, v4
    v_lshl_add_u32 v76, v5, 4, v76
    v_lshlrev_b32_e64 v77, 4, v2
    v_lshl_add_u32 v77, v3, 11, v77
    s_mul_i32 s75, s98, 458752
    s_lshl_b32 s77, s97, 9
    s_add_u32 s75, s75, s77
    s_lshl_b32 s77, s63, 8
    s_add_u32 s75, s75, s77
    s_lshl_b32 s96, s97, 19
    s_lshl_b32 s77, s98, 15
    s_add_u32 s96, s96, s77
    s_lshl_b32 s77, s62, 9
    s_add_u32 s96, s96, s77
    s_mov_b32 s68, 1
    s_getreg_b32 s101, hwreg(HW_REG_XCC_ID, 0, 4)
    s_lshl_b32 s76, s61, 8
    s_add_u32 s76, s76, 12582912
    s_lshl_b32 s77, s60, 8
    s_add_u32 s77, s77, 12586752
    s_lshr_b32 s78, s97, 1
    s_lshl_b32 s78, s78, 9
    s_add_u32 s78, s78, 12590592
    v_mov_b32 v4, s76
    v_mov_b32 v5, s77
    v_mov_b32 v6, s78
    v_cmp_gt_u32 vcc, 16, v1
    s_nop 1
    v_cndmask_b32 v4, v5, v4, vcc
    v_cmp_gt_u32 vcc, 32, v1
    s_nop 1
    v_cndmask_b32 v4, v6, v4, vcc
    v_add_u32 v90, v4, v12
    s_waitcnt vmcnt(10)
    s_barrier
L_hloop:
    s_and_b32 s77, s86, 15
    s_cbranch_scc1 L_event
L_evret:
    s_and_b32 s72, s84, 15
    s_mov_b32 m0, s70
    s_lshl_b32 s71, s72, 7
    buffer_load_dwordx4 v16, s[28:31], s71 offen offset:0 lds
    s_mul_i32 s72, s72, 393216
    s_lshr_b64 s[84:85], s[84:85], 4
    buffer_load_dwordx4 v17, s[28:31], s71 offen offset:1024 lds
    buffer_load_dwordx4 v18, s[28:31], s71 offen offset:2048 lds
    buffer_load_dwordx4 v19, s[28:31], s71 offen offset:3072 lds
    s_add_u32 m0, s70, 4096
    s_nop 0
    buffer_load_dwordx4 v20, s[32:35], s72 offen offset:0 lds
    buffer_load_dwordx4 v21, s[32:35], s72 offen offset:1024 lds
    buffer_load_dwordx4 v22, s[32:35], s72 offen offset:2048 lds
    buffer_load_dwordx4 v23, s[32:35], s72 offen offset:3072 lds
    s_add_u32 m0, s70, 8192
    s_nop 0
    buffer_load_dwordx4 v24, s[32:35], s72 offen offset:0 lds
    buffer_load_dwordx4 v25, s[32:35], s72 offen offset:1024 lds
    s_add_u32 s70, s70, 40960
    s_cmp_ge_u32 s70, 122880
    s_cselect_b32 s76, 122880, 0
    s_sub_u32 s70, s70, s76
    s_waitcnt vmcnt(10)
L_hbar:
    s_lshr_b64 s[86:87], s[86:87], 4
    s_add_u32 s68, s68, 1
    s_cmp_lt_u32 s68, 14
    s_barrier
    s_cbranch_scc1 L_hloop
    v_add_co_u32 v88, vcc, 1, v88
    s_nop 1
    v_addc_co_u32 v89, vcc, 0, v89, vcc
    v_cmp_ne_u64 vcc, v[92:93], v[88:89]
    s_nop 0
    s_cbranch_vccz L_hello_ok_1
    s_mov_b32 s88, 0
L_spin_2:
    buffer_load_dwordx4 v[92:95], v90, s[40:43], 0 offen sc1
    s_waitcnt vmcnt(0)
    v_cmp_ne_u64 vcc, v[92:93], v[88:89]
    s_nop 0
    s_cbranch_vccz L_hello_ok_1
    s_add_u32 s88, s88, 1
    s_cmp_lt_u32 s88, 65536
    s_cbranch_scc1 L_spin_2
L_hello_ok_1:
    v_cmp_ne_u32_e64 vcc, s101, v94
    s_nop 0
    s_and_b32 s76, vcc_lo, 0xffff
    s_cselect_b32 s100, 0, 1
    s_cmp_eq_u32 vcc_hi, 0
    s_cselect_b32 s76, 2, 0
    s_or_b32 s100, s100, s76
    v_mov_b32 v4, s100
    v_mov_b32 v5, 0
    ds_write_b32 v5, v4 offset:53248
    s_mul_i32 s80, s60, 460800
    s_lshl_b32 s81, s62, 8
    s_add_u32 s80, s80, s81
    buffer_load_dwordx2 v[32:33], v74, s[40:43], s80 offen offset:0 sc1
    s_add_u32 s80, s80, 57600
    buffer_load_dwordx2 v[34:35], v74, s[40:43], s80 offen offset:0 sc1
    s_add_u32 s80, s80, 57600
    buffer_load_dwordx2 v[36:37], v74, s[40:43], s80 offen offset:0 sc1
    s_add_u32 s80, s80, 57600
    buffer_load_dwordx2 v[38:39], v74, s[40:43], s80 offen offset:0 sc1
    s_add_u32 s80, s80, 57600
    buffer_load_dwordx2 v[40:41], v74, s[40:43], s80 offen offset:0 sc1
    s_add_u32 s80, s80, 57600
    buffer_load_dwordx2 v[42:43], v74, s[40:43], s80 offen offset:0 sc1
    s_add_u32 s80, s80, 57600
    buffer_load_dwordx2 v[44:45], v74, s[40:43], s80 offen offset:0 sc1
    s_add_u32 s80, s80, 57600
    buffer_load_dwordx2 v[46:47], v74, s[40:43], s80 offen offset:0 sc1
    s_mul_i32 s80, s61, 28800
    s_add_u32 s80, s80, s81
    buffer_load_dwordx4 v[48:51], v75, s[40:43], s80 offen offset:1024 sc1
    s_add_u32 s80, s80, 1843200
    buffer_load_dwordx4 v[52:55], v75, s[40:43], s80 offen offset:1024 sc1
    s_add_u32 s80, s80, 1843200
    buffer_load_dwordx4 v[56:59], v75, s[40:43], s80 offen offset:1024 sc1
    s_add_u32 s80, s80, 1843200
    buffer_load_dwordx4 v[60:63], v75, s[40:43], s80 offen offset:1024 sc1
    s_waitcnt vmcnt(12)
    s_barrier
    s_mul_i32 s78, s62, 2048
    s_add_u32 s78, s78, s73
    s_add_u32 s78, s78, 4096
    v_lshlrev_b32_e64 v11, 7, v1
    s_mov_b64 exec, 65535
    buffer_load_dword v27, v11, s[40:43], s78 offen sc1
    s_mov_b64 exec, -1
    buffer_load_dwordx4 v[152:155], v76, s[48:51], s75 offen nt
    s_add_u32 s75, s75, 7168
    buffer_load_dwordx4 v[156:159], v76, s[48:51], s75 offen nt
    s_add_u32 s75, s75, 7168
    s_add_u32 s78, s65, 0
    s_and_b32 s78, s78, 15
    s_lshl_b32 s78, s78, 17
    s_lshl_b32 s79, s62, 11
    s_add_u32 m0, s79, 57344
    s_add_u32 s79, s78, 15360
    buffer_load_dwordx4 v26, s[36:39], s78 offen lds
    buffer_load_dwordx4 v26, s[36:39], s79 offen offset:1024 lds
    s_add_u32 s78, s65, 1
    s_and_b32 s78, s78, 15
    s_lshl_b32 s78, s78, 17
    s_lshl_b32 s79, s62, 11
    s_add_u32 m0, s79, 65536
    s_add_u32 s79, s78, 15360
    buffer_load_dwordx4 v26, s[36:39], s78 offen lds
    buffer_load_dwordx4 v26, s[36:39], s79 offen offset:1024 lds
    s_waitcnt vmcnt(7)
    s_mov_b32 s88, 0
    s_branch L_g1first_3
L_g1_4:
    s_mul_i32 s80, s60, 460800
    s_lshl_b32 s81, s62, 8
    s_add_u32 s80, s80, s81
    buffer_load_dwordx2 v[32:33], v74, s[40:43], s80 offen offset:0 sc1
    s_add_u32 s80, s80, 57600
    buffer_load_dwordx2 v[34:35], v74, s[40:43], s80 offen offset:0 sc1
    s_add_u32 s80, s80, 57600
    buffer_load_dwordx2 v[36:37], v74, s[40:43], s80 offen offset:0 sc1
    s_add_u32 s80, s80, 57600
    buffer_load_dwordx2 v[38:39], v74, s[40:43], s80 offen offset:0 sc1
    s_add_u32 s80, s80, 57600
    buffer_load_dwordx2 v[40:41], v74, s[40:43], s80 offen offset:0 sc1
    s_add_u32 s80, s80, 57600
    buffer_load_dwordx2 v[42:43], v74, s[40:43], s80 offen offset:0 sc1
    s_add_u32 s80, s80, 57600
    buffer_load_dwordx2 v[44:45], v74, s[40:43], s80 offen offset:0 sc1
    s_add_u32 s80, s80, 57600
    buffer_load_dwordx2 v[46:47], v74, s[40:43], s80 offen offset:0 sc1
    s_mul_i32 s80, s61, 28800
    s_add_u32 s80, s80, s81
    buffer_load_dwordx4 v[48:51], v75, s[40:43], s80 offen offset:1024 sc1
    s_add_u32 s80, s80, 1843200
    buffer_load_dwordx4 v[52:55], v75, s[40:43], s80 offen offset:1024 sc1
    s_add_u32 s80, s80, 1843200
    buffer_load_dwordx4 v[56:59], v75, s[40:43], s80 offen offset:1024 sc1
    s_add_u32 s80, s80, 1843200
    buffer_load_dwordx4 v[60:63], v75, s[40:43], s80 offen offset:1024 sc1
    s_waitcnt vmcnt(0)
L_g1first_3:
    v_max3_u32 v4, v32, v34, v36
    v_max3_u32 v4, v4, v38, v40
    v_max3_u32 v4, v4, v42, v44
    v_max3_u32 v4, v4, v46, v48
    v_max3_u32 v4, v4, v50, v52
    v_max3_u32 v4, v4, v54, v56
    v_max3_u32 v4, v4, v58, v60
    v_max_u32 v4, v4, v62
    v_cmp_eq_u32_e64 vcc, -1, v4
    s_nop 0
    s_cbranch_vccz L_ok_5
    s_add_u32 s88, s88, 1
    s_cmp_lt_u32 s88, 65536
    s_cbranch_scc1 L_g1_4
L_ok_5:
    s_setprio 3
    v_add_f32 v32, v32, v40
    v_add_f32 v33, v33, v41
    v_add_f32 v34, v34, v42
    v_add_f32 v35, v35, v43
    v_add_f32 v36, v36, v44
    v_add_f32 v37, v37, v45
    v_add_f32 v38, v38, v46
    v_add_f32 v39, v39, v47
    v_add_f32 v32, v32, v36
    v_add_f32 v33, v33, v37
    v_add_f32 v34, v34, v38
    v_add_f32 v35, v35, v39
    v_add_f32 v32, v32, v34
    v_add_f32 v33, v33, v35
    v_add_f32 v48, v48, v56
    v_add_f32 v49, v49, v57
    v_add_f32 v50, v50, v58
    v_add_f32 v51, v51, v59
    v_add_f32 v52, v52, v60
    v_add_f32 v53, v53, v61
    v_add_f32 v54, v54, v62
    v_add_f32 v55, v55, v63
    v_add_f32 v48, v48, v52
    v_add_f32 v49, v49, v53
    v_add_f32 v50, v50, v54
    v_add_f32 v51, v51, v55
    v_add_f32 v49, v49, v51
    v_mov_b32 v5, v32
    v_mov_b32 v6, v33
    v_mov_b32 v51, v49
    v_permlane32_swap_b32 v48, v50
    v_permlane32_swap_b32 v32, v5
    v_permlane32_swap_b32 v33, v6
    v_permlane32_swap_b32 v49, v51
    v_add_f32 v48, v48, v50
    v_add_f32 v49, v49, v51
    v_add_f32 v32, v32, v5
    v_add_f32 v33, v33, v6
    v_permlane16_swap_b32 v48, v49
    v_add_f32 v48, v48, v49
    v_cvt_pk_bf16_f32 v49, v48, v48
    v_and_b32 v49, s90, v49
    v_sub_f32 v49, v48, v49
    v_cvt_pk_bf16_f32 v50, v48, v49
    v_and_b32 v51, s90, v50
    v_sub_f32 v49, v49, v51
    v_cvt_pk_bf16_f32 v51, v49, 0
    v_bfe_u32 v4, v1, 4, 1
    v_lshl_add_u32 v4, v4, 1, v3
    v_min_u32 v4, 2, v4
    v_and_b32 v7, 15, v1
    v_lshlrev_b32 v7, 3, v7
    s_lshl_b32 s76, s62, 7
    v_lshl_add_u32 v4, v4, 9, v7
    v_add_u32_e64 v4, s76, v4
    ds_write_b64 v4, v[50:51] offset:50176
    v_mul_f32 v32, 0x3a800000, v32
    v_mul_f32 v33, 0x3a800000, v33
    v_fma_f32 v7, -v32, v32, v33
    v_max_f32_e64 v7, 0, v7
    v_cvt_pk_bf16_f32 v5, v32, v32
    v_and_b32_e64 v5, s90, v5
    v_cvt_pk_bf16_f32 v7, v7, v7
    v_and_b32_e64 v7, s90, v7
    v_add_f32 v7, 0x3727c5ac, v7
    v_cvt_pk_bf16_f32 v7, v7, v7
    v_and_b32 v7, s90, v7
    v_sqrt_f32_e64 v7, v7
    s_nop 0
    v_cvt_pk_bf16_f32 v7, v7, v7
    v_and_b32 v7, s90, v7
    v_rcp_f32 v9, v7
    v_xor_b32 v5, 0x80000000, v5
    v_cvt_pk_bf16_f32 v8, v5, v5
    s_lshl_b32 s76, s62, 8
    v_lshl_add_u32 v6, v2, 3, s76
    ds_write_b64 v6, v[8:9] offset:49152
    s_setprio 0
    s_waitcnt lgkmcnt(0)
    s_barrier
    s_lshl_b32 s78, s62, 11
    s_add_u32 s79, s78, s73
    s_add_u32 s79, s79, 4096
    s_bitcmp1_b32 s100, 0
    s_cbranch_scc1 L_loc_6
    buffer_store_dwordx4 v[28:31], v12, s[40:43], s79 offen offset:0 sc1
    buffer_store_dwordx4 v[28:31], v12, s[40:43], s79 offen offset:1024 sc1
    s_branch L_pubd_7
L_loc_6:
    buffer_store_dwordx4 v[28:31], v12, s[40:43], s79 offen offset:0
    buffer_store_dwordx4 v[28:31], v12, s[40:43], s79 offen offset:1024
L_pubd_7:
    s_add_u32 s79, s78, s99
    s_bitcmp1_b32 s100, 1
    s_cbranch_scc1 L_loc_8
    buffer_store_dwordx4 v[28:31], v12, s[40:43], s79 offen offset:1024 sc1
    buffer_store_dwordx4 v[28:31], v12, s[40:43], s79 offen offset:2048 sc1
    s_branch L_pubd_9
L_loc_8:
    buffer_store_dwordx4 v[28:31], v12, s[40:43], s79 offen offset:1024
    buffer_store_dwordx4 v[28:31], v12, s[40:43], s79 offen offset:2048
L_pubd_9:
    s_lshl_b32 s79, s62, 8
    s_add_u32 s79, s79, s99
    s_mov_b64 exec, 0xffff
    buffer_store_dwordx4 v[28:31], v12, s[40:43], s79 offen sc1
    s_mov_b64 exec, -1
    s_add_u32 s78, s65, 2
    s_and_b32 s78, s78, 15
    s_lshl_b32 s78, s78, 17
    s_lshl_b32 s79, s62, 11
    s_add_u32 m0, s79, 73728
    s_add_u32 s79, s78, 15360
    buffer_load_dwordx4 v26, s[36:39], s78 offen lds
    buffer_load_dwordx4 v26, s[36:39], s79 offen offset:1024 lds
    s_add_u32 s78, s65, 3
    s_and_b32 s78, s78, 15
    s_lshl_b32 s78, s78, 17
    s_lshl_b32 s79, s62, 11
    s_add_u32 m0, s79, 81920
    s_add_u32 s79, s78, 15360
    buffer_load_dwordx4 v26, s[36:39], s78 offen lds
    buffer_load_dwordx4 v26, s[36:39], s79 offen offset:1024 lds
    s_add_u32 s78, s65, 4
    s_and_b32 s78, s78, 15
    s_lshl_b32 s78, s78, 17
    s_lshl_b32 s79, s62, 11
    s_add_u32 m0, s79, 90112
    s_add_u32 s79, s78, 15360
    buffer_load_dwordx4 v26, s[36:39], s78 offen lds
    buffer_load_dwordx4 v26, s[36:39], s79 offen offset:1024 lds
    s_add_u32 s78, s65, 5
    s_and_b32 s78, s78, 15
    s_lshl_b32 s78, s78, 17
    s_lshl_b32 s79, s62, 11
    s_add_u32 m0, s79, 98304
    s_add_u32 s79, s78, 15360
    buffer_load_dwordx4 v26, s[36:39], s78 offen lds
    buffer_load_dwordx4 v26, s[36:39], s79 offen offset:1024 lds
    s_mul_i32 s78, s62, 384
    s_add_u32 s78, s78, s73
    s_add_u32 s78, s78, 2048
    v_lshlrev_b32_e64 v11, 7, v1
    s_mov_b64 exec, 7
    buffer_load_dword v27, v11, s[40:43], s78 offen sc1
    s_mov_b64 exec, -1
    s_waitcnt vmcnt(9)
    s_lshl_b32 s76, s62, 2
    s_add_u32 s76, s76, s73
    v_mov_b32 v4, 0
    s_mov_b64 exec, 1
    s_bitcmp1_b32 s100, 0
    s_cbranch_scc1 L_loc_10
    buffer_store_dword v4, v4, s[40:43], s76 offen offset:2560 sc1
    s_branch L_pubd_11
L_loc_10:
    buffer_store_dword v4, v4, s[40:43], s76 offen offset:2560
L_pubd_11:
    s_mov_b64 exec, -1
    s_add_u32 s78, s65, 6
    s_and_b32 s78, s78, 15
    s_lshl_b32 s78, s78, 17
    s_lshl_b32 s79, s62, 11
    s_add_u32 m0, s79, 106496
    s_add_u32 s79, s78, 15360
    buffer_load_dwordx4 v26, s[36:39], s78 offen lds
    buffer_load_dwordx4 v26, s[36:39], s79 offen offset:1024 lds
    s_add_u32 s78, s65, 7
    s_and_b32 s78, s78, 15
    s_lshl_b32 s78, s78, 17
    s_lshl_b32 s79, s62, 11
    s_add_u32 m0, s79, 114688
    s_add_u32 s79, s78, 15360
    buffer_load_dwordx4 v26, s[36:39], s78 offen lds
    buffer_load_dwordx4 v26, s[36:39], s79 offen offset:1024 lds
    s_add_u32 s78, s65, 8
    s_and_b32 s78, s78, 15
    s_lshl_b32 s78, s78, 17
    s_lshl_b32 s79, s62, 11
    s_add_u32 m0, s79, 122880
    s_add_u32 s79, s78, 15360
    buffer_load_dwordx4 v26, s[36:39], s78 offen lds
    buffer_load_dwordx4 v26, s[36:39], s79 offen offset:1024 lds
    s_add_u32 s78, s65, 9
    s_and_b32 s78, s78, 15
    s_lshl_b32 s78, s78, 17
    s_lshl_b32 s79, s62, 11
    s_add_u32 m0, s79, 131072
    s_add_u32 s79, s78, 15360
    buffer_load_dwordx4 v26, s[36:39], s78 offen lds
    buffer_load_dwordx4 v26, s[36:39], s79 offen offset:1024 lds
    s_add_u32 s78, s65, 10
    s_and_b32 s78, s78, 15
    s_lshl_b32 s78, s78, 17
    s_lshl_b32 s79, s62, 11
    s_add_u32 m0, s79, 139264
    s_add_u32 s79, s78, 15360
    buffer_load_dwordx4 v26, s[36:39], s78 offen lds
    buffer_load_dwordx4 v26, s[36:39], s79 offen offset:1024 lds
    s_add_u32 s78, s65, 11
    s_and_b32 s78, s78, 15
    s_lshl_b32 s78, s78, 17
    s_lshl_b32 s79, s62, 11
    s_add_u32 m0, s79, 147456
    s_add_u32 s79, s78, 15360
    buffer_load_dwordx4 v26, s[36:39], s78 offen lds
    buffer_load_dwordx4 v26, s[36:39], s79 offen offset:1024 lds
    s_add_u32 s78, s65, 12
    s_and_b32 s78, s78, 15
    s_lshl_b32 s78, s78, 17
    s_lshl_b32 s79, s62, 11
    s_add_u32 m0, s79, 155648
    s_add_u32 s79, s78, 15360
    buffer_load_dwordx4 v26, s[36:39], s78 offen lds
    buffer_load_dwordx4 v26, s[36:39], s79 offen offset:1024 lds
    v_and_b32_e64 v65, 15, v1
    v_mul_u32_u24 v65, 460800, v65
    s_mul_i32 s80, s61, 28800
    s_lshl_b32 s82, s62, 2
    s_add_u32 s82, s82, s80
    v_bfe_u32 v4, v1, 4, 1
    v_lshl_add_u32 v4, v4, 1, v3
    s_lshl_b32 s77, s62, 6
    v_lshl_add_u32 v66, v4, 1, s77
    v_bfe_u32 v4, v1, 2, 1
    v_lshl_add_u32 v66, v4, 5, v66
    v_bfe_u32 v4, v1, 0, 1
    v_lshl_add_u32 v66, v4, 4, v66
    v_bfe_u32 v4, v1, 1, 1
    v_lshl_add_u32 v66, v4, 3, v66
    s_lshl_b32 s83, s62, 7
    s_add_u32 s81, s83, s80
    s_add_u32 s68, s81, 3686400
    s_add_u32 s83, s83, s73
    v_and_b32 v4, 7, v1
    v_lshrrev_b32 v5, 4, v1
    v_lshlrev_b32_e64 v5, 2, v5
    v_lshl_add_u32 v67, v4, 4, v5
    s_barrier
    buffer_load_dword v64, v65, s[40:43], s82 offen offset:2560 sc1
    s_barrier
    s_setprio 3
    v_mov_b32 v4, s89
    v_lshlrev_b32_e64 v5, 2, v1
    ds_write_b32 v5, v4 offset:24832
    v_mov_b32 v70, 0
    v_mov_b32 v71, 0
    ds_write_b64 v70, v[70:71] offset:25984
    s_mov_b32 s88, 0
    s_branch L_p2first_12
L_p2_13:
    buffer_load_dword v64, v65, s[40:43], s82 offen offset:2560 sc1
L_p2first_12:
    s_waitcnt vmcnt(0)
    v_cmp_eq_u32_e64 vcc, -1, v64
    s_nop 0
    s_cbranch_vccz L_ok_14
    s_add_u32 s88, s88, 1
    s_cmp_lt_u32 s88, 65536
    s_cbranch_scc1 L_p2_13
L_ok_14:
    s_add_u32 s78, s65, 13
    s_and_b32 s78, s78, 15
    s_lshl_b32 s78, s78, 17
    s_lshl_b32 s79, s62, 11
    s_add_u32 m0, s79, 32768
    s_add_u32 s79, s78, 15360
    buffer_load_dwordx4 v26, s[36:39], s78 offen lds
    buffer_load_dwordx4 v26, s[36:39], s79 offen offset:1024 lds
    s_add_u32 s78, s65, 14
    s_and_b32 s78, s78, 15
    s_lshl_b32 s78, s78, 17
    s_lshl_b32 s79, s62, 11
    s_add_u32 m0, s79, 40960
    s_add_u32 s79, s78, 15360
    buffer_load_dwordx4 v26, s[36:39], s78 offen lds
    buffer_load_dwordx4 v26, s[36:39], s79 offen offset:1024 lds
    s_add_u32 s78, s65, 15
    s_and_b32 s78, s78, 15
    s_lshl_b32 s78, s78, 17
    s_lshl_b32 s79, s62, 11
    s_add_u32 m0, s79, 49152
    s_add_u32 s79, s78, 15360
    buffer_load_dwordx4 v26, s[36:39], s78 offen lds
    buffer_load_dwordx4 v26, s[36:39], s79 offen offset:1024 lds
    s_lshl_b32 s76, s62, 11
    s_lshl_b32 s77, s60, 7
    s_add_u32 s76, s76, s77
    s_add_u32 s76, s76, s80
    s_add_u32 s76, s76, 4096
    s_add_u32 s77, s76, 3686400
    s_mov_b32 s78, 0x00003f80
    s_mov_b32 s79, 0x3f800000
    s_mov_b32 s88, 0
L_poll_15:
    buffer_load_dwordx4 v[32:35], v13, s[40:43], s76 offen sc1
    buffer_load_dwordx4 v[36:39], v13, s[40:43], s77 offen sc1
    s_waitcnt vmcnt(0)
    v_max_u32 v4, v32, v36
    v_cmp_eq_u32_e64 vcc, -1, v4
    s_nop 0
    s_cbranch_vccz L_ok_16
    s_add_u32 s88, s88, 1
    s_cmp_lt_u32 s88, 65536
    s_cbranch_scc1 L_poll_15
L_ok_16:
    v_dot2_f32_bf16 v48, v32, s78, 0
    v_dot2_f32_bf16 v49, v32, s79, 0
    v_dot2_f32_bf16 v50, v33, s78, 0
    v_dot2_f32_bf16 v51, v33, s79, 0
    v_dot2_f32_bf16 v52, v34, s78, 0
    v_dot2_f32_bf16 v53, v34, s79, 0
    v_dot2_f32_bf16 v54, v35, s78, 0
    v_dot2_f32_bf16 v55, v35, s79, 0
    v_dot2_f32_bf16 v48, v36, s78, v48
    v_dot2_f32_bf16 v49, v36, s79, v49
    v_dot2_f32_bf16 v50, v37, s78, v50
    v_dot2_f32_bf16 v51, v37, s79, v51
    v_dot2_f32_bf16 v52, v38, s78, v52
    v_dot2_f32_bf16 v53, v38, s79, v53
    v_dot2_f32_bf16 v54, v39, s78, v54
    v_dot2_f32_bf16 v55, v39, s79, v55
    buffer_load_dwordx4 v[40:43], v13, s[40:43], s81 offen offset:2048 sc1
    buffer_load_dwordx4 v[44:47], v13, s[40:43], s68 offen offset:2048 sc1
    v_permlane32_swap_b32 v48, v52
    v_permlane32_swap_b32 v49, v53
    v_permlane32_swap_b32 v50, v54
    v_permlane32_swap_b32 v51, v55
    v_add_f32 v48, v48, v52
    v_add_f32 v49, v49, v53
    v_add_f32 v50, v50, v54
    v_add_f32 v51, v51, v55
    s_nop 0
    v_permlane16_swap_b32 v48, v50
    v_permlane16_swap_b32 v49, v51
    v_add_f32 v48, v48, v50
    v_add_f32_e64 v49, v49, v51
    s_nop 0
    v_add_f32_dpp v48, v48, v48 row_ror:8 row_mask:0xf bank_mask:0xf
    v_add_f32_dpp v49, v49, v49 row_ror:8 row_mask:0xf bank_mask:0xf
    v_cvt_pk_bf16_f32 v48, v48, v49
    s_bitcmp1_b32 s100, 0
    s_cbranch_scc1 L_loc_17
    buffer_store_dword v48, v67, s[40:43], s83 offen offset:3072 sc1
    s_branch L_pubd_18
L_loc_17:
    buffer_store_dword v48, v67, s[40:43], s83 offen offset:3072
L_pubd_18:
    s_mov_b32 s88, 0
    s_waitcnt vmcnt(1)
    s_branch L_zfirst_19
L_z_20:
    buffer_load_dwordx4 v[40:43], v13, s[40:43], s81 offen offset:2048 sc1
    buffer_load_dwordx4 v[44:47], v13, s[40:43], s68 offen offset:2048 sc1
    s_waitcnt vmcnt(0)
L_zfirst_19:
    v_max3_u32 v4, v40, v41, v42
    v_max3_u32 v4, v4, v43, v44
    v_max3_u32 v4, v4, v45, v46
    v_max_u32 v4, v4, v47
    v_cmp_eq_u32 vcc, -1, v4
    s_nop 0
    s_cbranch_vccz L_ok_21
    s_add_u32 s88, s88, 1
    s_cmp_lt_u32 s88, 65536
    s_cbranch_scc1 L_z_20
L_ok_21:
    v_add_f32 v40, v40, v44
    v_add_f32 v41, v41, v45
    v_add_f32 v42, v42, v46
    v_add_f32 v43, v43, v47
    v_permlane32_swap_b32 v40, v41
    s_nop 0
    v_permlane32_swap_b32 v42, v43
    v_add_f32 v40, v40, v41
    v_add_f32 v42, v42, v43
    s_nop 1
    v_permlane16_swap_b32 v40, v42
    v_add_f32 v40, v40, v42
    s_nop 1
    v_add_f32_dpp v40, v40, v40 row_ror:8 row_mask:0xf bank_mask:0xf
    v_cvt_pk_bf16_f32 v40, v40, v40
    ds_write_b16 v66, v40 offset:24576
    s_waitcnt lgkmcnt(0)
    s_barrier
    s_setprio 0
    s_mov_b64 exec, 3
    global_load_dword v27, v91, s[66:67]
    s_mov_b64 exec, -1
    s_lshl_b32 s78, s97, 18
    s_lshl_b32 s79, s62, 16
    s_add_u32 s78, s78, s79
    s_lshl_b32 s79, s98, 7
    s_add_u32 s78, s78, s79
    s_lshl_b32 s79, s62, 12
    s_add_u32 m0, s79, 0
    s_nop 0
    buffer_load_dwordx4 v78, s[28:31], s78 offen offset:0 lds
    s_add_u32 s78, s78, 15360
    buffer_load_dwordx4 v79, s[28:31], s78 offen offset:1024 lds
    s_add_u32 s78, s78, 15360
    buffer_load_dwordx4 v78, s[28:31], s78 offen offset:2048 lds
    s_add_u32 s78, s78, 15360
    buffer_load_dwordx4 v79, s[28:31], s78 offen offset:3072 lds
    s_barrier
    s_lshl4_add_u32 s76, s97, s98
    s_mul_i32 s76, s76, 28800
    s_add_u32 s20, s26, s76
    s_addc_u32 s21, s27, 0
    s_cmp_eq_u32 s62, 0
    s_cbranch_scc0 L_now0_24
    s_sleep 4
    s_load_dwordx16 s[4:19], s[20:21], 3584 glc
    s_waitcnt lgkmcnt(0)
    s_and_b64 s[4:5], s[4:5], s[6:7]
    s_and_b64 s[4:5], s[4:5], s[8:9]
    s_and_b64 s[4:5], s[4:5], s[10:11]
    s_and_b64 s[4:5], s[4:5], s[12:13]
    s_and_b64 s[4:5], s[4:5], s[14:15]
    s_and_b64 s[4:5], s[4:5], s[16:17]
    s_and_b64 s[4:5], s[4:5], s[18:19]
    s_nand_b32 s4, s4, s5
    s_and_b32 s4, s4, 0xffff
    s_mul_i32 s4, s4, 0x10001
    s_lshr_b32 s4, s4, s65
    s_and_b32 s77, s4, 0xffff
    v_mov_b32_e64 v69, s77
    ds_write_b32 v70, v69 offset:25984
L_now0_24:
    s_waitcnt vmcnt(0) lgkmcnt(0)
    s_barrier
    s_cmp_eq_u32 s62, 0
    s_cbranch_scc0 L_now1_22
    s_mov_b32 s88, 0
L_spin_25:
    s_load_dwordx16 s[4:19], s[20:21], 3584 glc
    s_waitcnt lgkmcnt(0)
    s_and_b64 s[4:5], s[4:5], s[6:7]
    s_and_b64 s[4:5], s[4:5], s[8:9]
    s_and_b64 s[4:5], s[4:5], s[10:11]
    s_and_b64 s[4:5], s[4:5], s[12:13]
    s_and_b64 s[4:5], s[4:5], s[14:15]
    s_and_b64 s[4:5], s[4:5], s[16:17]
    s_and_b64 s[4:5], s[4:5], s[18:19]
    s_nand_b32 s4, s4, s5
    s_and_b32 s4, s4, 0xffff
    s_mul_i32 s4, s4, 0x10001
    s_lshr_b32 s4, s4, s65
    s_and_b32 s77, s4, 0xffff
    v_mov_b32 v69, s77
    ds_write_b32 v70, v69 offset:25984
    s_cmp_eq_u32 s77, 0xffff
    s_cbranch_scc1 L_s2done_23
    s_add_u32 s88, s88, 1
    s_cmp_lt_u32 s88, 65536
    s_cbranch_scc1 L_spin_25
    s_branch L_s2done_23
L_now1_22:
    s_cmp_eq_u32 s62, 1
    s_cbranch_scc0 L_s2done_23
    s_lshl_b32 s77, 1, s61
    s_not_b32 s77, s77
    v_mov_b32_e64 v4, s77
    v_mul_u32_u24 v5, 28800, v1
    s_mul_i32 s76, s60, 460800
    s_lshl2_add_u32 s76, s61, s76
    s_mov_b32 s88, 0
L_spin_26:
    ds_read_b32 v69, v70 offset:25988
    s_waitcnt lgkmcnt(0)
    v_cmp_eq_u32_e64 vcc, 4, v69
    s_nop 0
    s_cbranch_vccnz L_drained_27
    s_add_u32 s88, s88, 1
    s_cmp_lt_u32 s88, 1048576
    s_cbranch_scc1 L_spin_26
L_drained_27:
    s_mov_b64 exec, 0xffff
    buffer_store_dword v4, v5, s[40:43], s76 offen offset:3584 sc1
    s_mov_b64 exec, -1
L_s2done_23:
    s_waitcnt vmcnt(0)
    s_mov_b32 s78, 0x05040100
    s_mov_b32 s79, 0x07060302
    v_perm_b32 v160, v100, v96, s78
    v_perm_b32 v164, v100, v96, s79
    v_perm_b32 v168, v101, v97, s78
    v_perm_b32 v172, v101, v97, s79
    v_perm_b32 v176, v102, v98, s78
    v_perm_b32 v180, v102, v98, s79
    v_perm_b32 v184, v103, v99, s78
    v_perm_b32 v188, v103, v99, s79
    v_perm_b32 v161, v108, v104, s78
    v_perm_b32 v165, v108, v104, s79
    v_perm_b32 v169, v109, v105, s78
    v_perm_b32 v173, v109, v105, s79
    v_perm_b32 v177, v110, v106, s78
    v_perm_b32 v181, v110, v106, s79
    v_perm_b32 v185, v111, v107, s78
    v_perm_b32 v189, v111, v107, s79
    v_perm_b32 v162, v116, v112, s78
    v_perm_b32 v166, v116, v112, s79
    v_perm_b32 v170, v117, v113, s78
    v_perm_b32 v174, v117, v113, s79
    v_perm_b32 v178, v118, v114, s78
    v_perm_b32 v182, v118, v114, s79
    v_perm_b32 v186, v119, v115, s78
    v_perm_b32 v190, v119, v115, s79
    v_perm_b32 v163, v124, v120, s78
    v_perm_b32 v167, v124, v120, s79
    v_perm_b32 v171, v125, v121, s78
    v_perm_b32 v175, v125, v121, s79
    v_perm_b32 v179, v126, v122, s78
    v_perm_b32 v183, v126, v122, s79
    v_perm_b32 v187, v127, v123, s78
    v_perm_b32 v191, v127, v123, s79
    v_perm_b32 v192, v132, v128, s78
    v_perm_b32 v196, v132, v128, s79
    v_perm_b32 v200, v133, v129, s78
    v_perm_b32 v204, v133, v129, s79
    v_perm_b32 v208, v134, v130, s78
    v_perm_b32 v212, v134, v130, s79
    v_perm_b32 v216, v135, v131, s78
    v_perm_b32 v220, v135, v131, s79
    v_perm_b32 v193, v140, v136, s78
    v_perm_b32 v197, v140, v136, s79
    v_perm_b32 v201, v141, v137, s78
    v_perm_b32 v205, v141, v137, s79
    v_perm_b32 v209, v142, v138, s78
    v_perm_b32 v213, v142, v138, s79
    v_perm_b32 v217, v143, v139, s78
    v_perm_b32 v221, v143, v139, s79
    v_perm_b32 v194, v148, v144, s78
    v_perm_b32 v198, v148, v144, s79
    v_perm_b32 v202, v149, v145, s78
    v_perm_b32 v206, v149, v145, s79
    v_perm_b32 v210, v150, v146, s78
    v_perm_b32 v214, v150, v146, s79
    v_perm_b32 v218, v151, v147, s78
    v_perm_b32 v222, v151, v147, s79
    v_perm_b32 v195, v156, v152, s78
    v_perm_b32 v199, v156, v152, s79
    v_perm_b32 v203, v157, v153, s78
    v_perm_b32 v207, v157, v153, s79
    v_perm_b32 v211, v158, v154, s78
    v_perm_b32 v215, v158, v154, s79
    v_perm_b32 v219, v159, v155, s78
    v_perm_b32 v223, v159, v155, s79
    v_lshlrev_b32 v17, 5, v2
    v_lshl_add_u32 v17, v3, 4, v17
    v_and_b32 v4, 15, v1
    v_lshrrev_b32 v5, 1, v4
    v_and_b32 v4, 1, v4
    v_lshlrev_b32 v4, 5, v4
    v_lshl_add_u32 v16, v5, 7, v4
    v_lshrrev_b32 v4, 3, v1
    v_and_b32 v5, 7, v1
    v_lshlrev_b32_e64 v5, 4, v5
    v_mul_u32_u24 v18, 9344, v4
    v_add_u32_e64 v18, v18, v5
    v_bfe_u32 v6, v1, 4, 1
    v_lshl_add_u32 v6, v6, 1, v3
    v_lshl_add_u32 v19, v6, 2, v5
    s_mul_i32 s84, s97, 149504
    s_lshl_b32 s77, s98, 7
    s_add_u32 s84, s84, s77
    s_add_u32 s84, s84, 8388608
    s_lshl_b32 s85, s62, 10
    s_add_u32 s85, s85, s99
    s_add_u32 s85, s85, 5120
    s_and_b32 s87, s97, 1
    s_lshl_b32 s87, s87, 4
    s_add_u32 s87, s87, s98
    s_lshr_b32 s86, s97, 1
    s_mul_i32 s86, s86, 299008
    s_lshl_b32 s77, s87, 7
    s_add_u32 s86, s86, s77
    s_add_u32 s86, s86, 8393728
    s_barrier
    s_mul_i32 s78, s62, 2048
    s_add_u32 s78, s78, s99
    s_add_u32 s78, s78, 1024
    v_lshlrev_b32_e64 v11, 7, v1
    s_mov_b64 exec, 65535
    buffer_load_dword v27, v11, s[40:43], s78 offen sc1
    s_mov_b64 exec, -1
    buffer_load_dwordx4 v[32:35], v77, s[52:55], s96 offen nt
    s_add_u32 s96, s96, 4096
    buffer_load_dwordx4 v[36:39], v77, s[52:55], s96 offen nt
    s_add_u32 s96, s96, 4096
    buffer_load_dwordx4 v[40:43], v77, s[52:55], s96 offen nt
    s_add_u32 s96, s96, 4096
    buffer_load_dwordx4 v[44:47], v77, s[52:55], s96 offen nt
    s_add_u32 s96, s96, 4096
    s_barrier
    buffer_load_dwordx4 v[48:51], v77, s[52:55], s96 offen nt
    s_add_u32 s96, s96, 4096
    buffer_load_dwordx4 v[52:55], v77, s[52:55], s96 offen nt
    s_add_u32 s96, s96, 4096
    buffer_load_dwordx4 v[56:59], v77, s[52:55], s96 offen nt
    s_add_u32 s96, s96, 4096
    buffer_load_dwordx4 v[60:63], v77, s[52:55], s96 offen nt
    s_add_u32 s96, s96, 4096
    s_barrier
    s_waitcnt vmcnt(0)
    s_mov_b32 s78, 0x05040100
    s_mov_b32 s79, 0x07060302
    v_permlane32_swap_b32 v32, v34
    v_permlane32_swap_b32 v33, v35
    v_permlane32_swap_b32 v36, v38
    v_permlane32_swap_b32 v37, v39
    v_permlane32_swap_b32 v40, v42
    v_permlane32_swap_b32 v41, v43
    v_permlane32_swap_b32 v44, v46
    v_permlane32_swap_b32 v45, v47
    v_permlane32_swap_b32 v48, v50
    v_permlane32_swap_b32 v49, v51
    v_permlane32_swap_b32 v52, v54
    v_permlane32_swap_b32 v53, v55
    v_permlane32_swap_b32 v56, v58
    v_permlane32_swap_b32 v57, v59
    v_permlane32_swap_b32 v60, v62
    v_permlane32_swap_b32 v61, v63
    v_perm_b32 v224, v34, v32, s78
    v_perm_b32 v225, v34, v32, s79
    v_perm_b32 v226, v35, v33, s78
    v_perm_b32 v227, v35, v33, s79
    v_perm_b32 v228, v38, v36, s78
    v_perm_b32 v229, v38, v36, s79
    v_perm_b32 v230, v39, v37, s78
    v_perm_b32 v231, v39, v37, s79
    v_perm_b32 v232, v42, v40, s78
    v_perm_b32 v233, v42, v40, s79
    v_perm_b32 v234, v43, v41, s78
    v_perm_b32 v235, v43, v41, s79
    v_perm_b32 v236, v46, v44, s78
    v_perm_b32 v237, v46, v44, s79
    v_perm_b32 v238, v47, v45, s78
    v_perm_b32 v239, v47, v45, s79
    v_perm_b32 v240, v50, v48, s78
    v_perm_b32 v241, v50, v48, s79
    v_perm_b32 v242, v51, v49, s78
    v_perm_b32 v243, v51, v49, s79
    v_perm_b32 v244, v54, v52, s78
    v_perm_b32 v245, v54, v52, s79
    v_perm_b32 v246, v55, v53, s78
    v_perm_b32 v247, v55, v53, s79
    v_perm_b32 v248, v58, v56, s78
    v_perm_b32 v249, v58, v56, s79
    v_perm_b32 v250, v59, v57, s78
    v_perm_b32 v251, v59, v57, s79
    v_perm_b32 v252, v62, v60, s78
    v_perm_b32 v253, v62, v60, s79
    v_perm_b32 v254, v63, v61, s78
    v_perm_b32 v255, v63, v61, s79
    v_and_b32 v5, 15, v1
    v_lshlrev_b32 v5, 3, v5
    s_lshl_b32 s76, s63, 10
    s_lshl_b32 s77, s64, 6
    s_add_u32 s76, s76, s77
    s_add_u32 s76, s76, s99
    s_mov_b64 s[80:81], 0xffff
    s_add_u32 s68, s84, 74752
    s_add_u32 s69, s86, 74752
    s_add_u32 s70, s86, 149504
    s_add_u32 s71, s86, 224256
    s_setprio 3
    s_barrier
    ds_read_b128 v[64:67], v12 offset:28672
    ds_read_b128 v[68:71], v12 offset:29696
    ds_read_b64 v[8:9], v5 offset:25728
    s_waitcnt lgkmcnt(2)
    v_mfma_f32_16x16x32_bf16 v[96:99], v[64:67], v[160:163], 0
    v_mfma_f32_16x16x32_bf16 v[100:103], v[64:67], v[164:167], 0
    s_waitcnt lgkmcnt(0)
    v_max_f32_dpp v4, v8, v8 row_ror:8 row_mask:0xf bank_mask:0xf
    v_mfma_f32_16x16x32_bf16 v[104:107], v[64:67], v[168:171], 0
    v_mfma_f32_16x16x32_bf16 v[108:111], v[64:67], v[172:175], 0
    v_max_f32_dpp v4, v4, v4 row_ror:4 row_mask:0xf bank_mask:0xf
    v_mfma_f32_16x16x32_bf16 v[112:115], v[64:67], v[176:179], 0
    v_mfma_f32_16x16x32_bf16 v[116:119], v[64:67], v[180:183], 0
    v_max_f32_dpp v4, v4, v4 row_ror:2 row_mask:0xf bank_mask:0xf
    v_mfma_f32_16x16x32_bf16 v[120:123], v[64:67], v[184:187], 0
    v_mfma_f32_16x16x32_bf16 v[124:127], v[64:67], v[188:191], 0
    v_max_f32_dpp v4, v4, v4 row_ror:1 row_mask:0xf bank_mask:0xf
    v_mfma_f32_16x16x32_bf16 v[96:99], v[68:71], v[192:195], v[96:99]
    v_cmp_eq_f32_e64 vcc, v4, v8
    v_mfma_f32_16x16x32_bf16 v[100:103], v[68:71], v[196:199], v[100:103]
    s_ff1_i32_b32 s92, vcc_lo
    s_and_b32 s92, s92, 15
    v_mfma_f32_16x16x32_bf16 v[104:107], v[68:71], v[200:203], v[104:107]
    s_lshr_b32 s78, s92, 2
    s_lshl_b32 s78, s78, 4
    v_mfma_f32_16x16x32_bf16 v[108:111], v[68:71], v[204:207], v[108:111]
    s_and_b32 s77, s92, 3
    v_mfma_f32_16x16x32_bf16 v[112:115], v[68:71], v[208:211], v[112:115]
    v_readlane_b32 s91, v9, s92
    v_readlane_b32 s93, v8, s92
    v_mfma_f32_16x16x32_bf16 v[116:119], v[68:71], v[212:215], v[116:119]
    v_mfma_f32_16x16x32_bf16 v[120:123], v[68:71], v[216:219], v[120:123]
    v_mfma_f32_16x16x32_bf16 v[124:127], v[68:71], v[220:223], v[124:127]
    s_cmp_ge_u32 s97, 14
    s_cbranch_scc1 L_final
    s_cmp_eq_u32 s77, 0
    s_cbranch_scc0 L_sel_29
    v_mov_b32 v64, v96
    v_mov_b32 v65, v100
    v_mov_b32 v66, v104
    v_mov_b32 v67, v108
    v_mov_b32 v68, v112
    v_mov_b32 v69, v116
    v_mov_b32 v70, v120
    v_mov_b32 v71, v124
    s_branch L_seldone_28
L_sel_29:
    s_cmp_eq_u32 s77, 1
    s_cbranch_scc0 L_sel_30
    v_mov_b32 v64, v97
    v_mov_b32 v65, v101
    v_mov_b32 v66, v105
    v_mov_b32 v67, v109
    v_mov_b32 v68, v113
    v_mov_b32 v69, v117
    v_mov_b32 v70, v121
    v_mov_b32 v71, v125
    s_branch L_seldone_28
L_sel_30:
    s_cmp_eq_u32 s77, 2
    s_cbranch_scc0 L_sel_31
    v_mov_b32 v64, v98
    v_mov_b32 v65, v102
    v_mov_b32 v66, v106
    v_mov_b32 v67, v110
    v_mov_b32 v68, v114
    v_mov_b32 v69, v118
    v_mov_b32 v70, v122
    v_mov_b32 v71, v126
    s_branch L_seldone_28
L_sel_31:
    v_mov_b32 v64, v99
    v_mov_b32 v65, v103
    v_mov_b32 v66, v107
    v_mov_b32 v67, v111
    v_mov_b32 v68, v115
    v_mov_b32 v69, v119
    v_mov_b32 v70, v123
    v_mov_b32_e64 v71, v127
L_seldone_28:
    s_lshl_b64 exec, s[80:81], s78
    s_bitcmp1_b32 s100, 1
    s_cbranch_scc1 L_loc_33
    buffer_store_dwordx4 v[64:67], v16, s[40:43], s76 offen offset:3072 sc1
    buffer_store_dwordx4 v[68:71], v16, s[40:43], s76 offen offset:3088 sc1
    s_branch L_pubd_34
L_loc_33:
    buffer_store_dwordx4 v[64:67], v16, s[40:43], s76 offen offset:3072
    buffer_store_dwordx4 v[68:71], v16, s[40:43], s76 offen offset:3088
L_pubd_34:
    s_mov_b64 exec, -1
    s_mov_b32 s88, 0
L_poll_35:
    buffer_load_dwordx4 v[128:131], v18, s[40:43], s84 offen offset:3072 sc1
    buffer_load_dwordx4 v[132:135], v18, s[40:43], s68 offen offset:3072 sc1
    s_waitcnt vmcnt(0)
    v_max_u32 v4, v128, v132
    v_cmp_eq_u32_e64 vcc, -1, v4
    s_nop 0
    s_cbranch_vccz L_ok_36
    s_add_u32 s88, s88, 1
    s_cmp_lt_u32 s88, 65536
    s_cbranch_scc1 L_poll_35
L_ok_36:
    v_pk_add_f32 v[48:49], v[128:129], v[132:133]
    v_pk_add_f32 v[50:51], v[130:131], v[134:135]
    s_nop 0
    v_permlane32_swap_b32 v48, v49
    v_permlane32_swap_b32 v50, v51
    v_add_f32 v48, v48, v49
    v_add_f32 v50, v50, v51
    s_nop 1
    v_permlane16_swap_b32 v48, v50
    v_add_f32 v48, v48, v50
    s_nop 1
    v_add_f32_dpp v48, v48, v48 row_ror:8 row_mask:0xf bank_mask:0xf
    v_cvt_pk_bf16_f32 v48, v48, v48
    v_and_b32_e64 v48, s90, v48
    v_mul_f32 v4, 0xbfb8aa3b, v48
    v_exp_f32_e64 v4, v4
    v_mov_b32_dpp v49, v48 row_ror:12 row_mask:0xf bank_mask:0xf
    v_add_f32 v4, 1.0, v4
    v_rcp_f32 v4, v4
    s_nop 0
    v_mul_f32 v4, v4, v48
    v_cvt_pk_bf16_f32 v4, v4, v4
    v_and_b32 v4, s90, v4
    v_mul_f32 v4, v4, v49
    v_mov_b32 v5, v4
    s_nop 1
    v_permlane32_swap_b32_e64 v4, v5
    v_cvt_pk_bf16_f32 v4, v4, v5
    s_nop 0
    v_readlane_b32 s76, v4, 0
    v_readlane_b32 s77, v4, 16
    v_readlane_b32 s78, v4, 1
    v_readlane_b32 s79, v4, 17
    v_readlane_b32 s80, v4, 2
    v_readlane_b32 s81, v4, 18
    v_readlane_b32 s82, v4, 3
    v_readlane_b32 s83, v4, 19
    v_dot2_f32_bf16 v40, v224, s76, 0
    v_dot2_f32_bf16 v41, v225, s76, 0
    v_dot2_f32_bf16 v42, v226, s76, 0
    v_dot2_f32_bf16 v43, v227, s76, 0
    v_dot2_f32_bf16 v40, v228, s77, v40
    v_dot2_f32_bf16 v41, v229, s77, v41
    v_dot2_f32_bf16 v42, v230, s77, v42
    v_dot2_f32_bf16 v43, v231, s77, v43
    v_dot2_f32_bf16 v40, v232, s78, v40
    v_dot2_f32_bf16 v41, v233, s78, v41
    v_dot2_f32_bf16 v42, v234, s78, v42
    v_dot2_f32_bf16 v43, v235, s78, v43
    v_dot2_f32_bf16 v40, v236, s79, v40
    v_dot2_f32_bf16 v41, v237, s79, v41
    v_dot2_f32_bf16 v42, v238, s79, v42
    v_dot2_f32_bf16 v43, v239, s79, v43
    v_dot2_f32_bf16 v40, v240, s80, v40
    v_dot2_f32_bf16 v41, v241, s80, v41
    v_dot2_f32_bf16 v42, v242, s80, v42
    v_dot2_f32_bf16 v43, v243, s80, v43
    v_dot2_f32_bf16 v40, v244, s81, v40
    v_dot2_f32_bf16 v41, v245, s81, v41
    v_dot2_f32_bf16 v42, v246, s81, v42
    v_dot2_f32_bf16 v43, v247, s81, v43
    v_dot2_f32_bf16 v40, v248, s82, v40
    v_dot2_f32_bf16 v41, v249, s82, v41
    v_dot2_f32_bf16 v42, v250, s82, v42
    v_dot2_f32_bf16 v43, v251, s82, v43
    v_dot2_f32_bf16 v40, v252, s83, v40
    v_dot2_f32_bf16 v41, v253, s83, v41
    v_dot2_f32_bf16 v42, v254, s83, v42
    v_dot2_f32_bf16 v43, v255, s83, v43
    s_bitcmp1_b32 s100, 1
    s_cbranch_scc1 L_loc_37
    s_nop 0
    buffer_store_dwordx4 v[40:43], v17, s[40:43], s85 offen sc1
    s_branch L_pubd_38
L_loc_37:
    s_nop 0
    buffer_store_dwordx4 v[40:43], v17, s[40:43], s85 offen
L_pubd_38:
    s_cmp_eq_u32 s62, 0
    s_cbranch_scc0 L_hby
    s_mov_b32 s88, 0
L_poll_39:
    buffer_load_dwordx4 v[136:139], v18, s[40:43], s86 offen sc1
    buffer_load_dwordx4 v[140:143], v18, s[40:43], s69 offen sc1
    buffer_load_dwordx4 v[144:147], v18, s[40:43], s70 offen sc1
    buffer_load_dwordx4 v[148:151], v18, s[40:43], s71 offen sc1
    s_waitcnt vmcnt(0)
    v_max3_u32 v4, v136, v140, v144
    v_max_u32 v4, v4, v148
    v_cmp_eq_u32_e64 vcc, -1, v4
    s_nop 0
    s_cbranch_vccz L_ok_40
    s_add_u32 s88, s88, 1
    s_cmp_lt_u32 s88, 65536
    s_cbranch_scc1 L_poll_39
L_ok_40:
    v_pk_add_f32 v[48:49], v[136:137], v[144:145]
    v_pk_add_f32 v[50:51], v[138:139], v[146:147]
    v_pk_add_f32 v[52:53], v[140:141], v[148:149]
    v_pk_add_f32 v[54:55], v[142:143], v[150:151]
    v_pk_add_f32 v[48:49], v[48:49], v[52:53]
    v_pk_add_f32 v[50:51], v[50:51], v[54:55]
    s_nop 0
    v_permlane32_swap_b32 v48, v49
    v_permlane32_swap_b32 v50, v51
    v_add_f32 v48, v48, v49
    v_add_f32 v50, v50, v51
    s_nop 1
    v_permlane16_swap_b32 v48, v50
    v_add_f32 v48, v48, v50
    s_nop 1
    v_add_f32_dpp v48, v48, v48 row_ror:8 row_mask:0xf bank_mask:0xf
    buffer_store_dword v48, v19, s[40:43], s99 offen offset:512 sc1
L_hby:
    s_barrier
    s_branch L_hfin
L_final:
    s_barrier
    s_cmp_eq_u32 s62, 1
    s_cbranch_scc0 L_noep_41
    s_cmp_eq_u32 s87, 0
    s_cbranch_scc0 L_noep_41
    v_mov_b32 v4, 13631488
    s_mov_b64 exec, 1
    buffer_store_dwordx2 v[88:89], v4, s[40:43], 0 offen sc1
    s_mov_b64 exec, -1
L_noep_41:
    s_cmp_eq_u32 s62, 0
    s_cbranch_scc0 L_hfin
    v_mov_b32 v8, s93
    v_cvt_pk_bf16_f32 v8, v8, v8
    v_and_b32_e64 v8, s90, v8
    v_mul_f32 v8, 0xbfb8aa3b, v8
    v_exp_f32 v8, v8
    s_nop 0
    v_add_f32 v8, 1.0, v8
    v_rcp_f32_e64 v8, v8
    s_nop 0
    v_cvt_pk_bf16_f32 v8, v8, v8
    v_and_b32 v8, s90, v8
    s_lshl_b32 s76, s92, 4
    s_lshr_b32 s77, s87, 1
    s_add_u32 s76, s76, s77
    s_mul_i32 s76, s76, 9344
    s_add_u32 s76, s76, 8388608
    s_and_b32 s77, s87, 1
    s_lshl_b32 s77, s77, 5
    s_add_u32 s76, s76, s77
    v_and_b32 v10, 1, v1
    v_lshlrev_b32_e64 v10, 6, v10
    v_bfe_u32 v4, v1, 1, 2
    v_lshl_add_u32 v10, v4, 3, v10
    v_bfe_u32 v4, v1, 4, 1
    v_lshl_add_u32 v10, v4, 2, v10
    v_lshrrev_b32_e64 v4, 3, v1
    v_mul_u32_u24 v6, 299008, v4
    v_and_b32_e64 v5, 7, v1
    v_lshl_add_u32 v6, v5, 4, v6
    v_mov_b32 v7, 2146435072
    v_cmp_gt_u32 vcc, 56, v1
    s_nop 1
    v_cndmask_b32_e64 v6, v7, v6, vcc
    s_mul_i32 s79, s87, 9344
    s_add_u32 s79, s79, 8388608
    s_lshl_b32 s80, s91, 11
    s_lshl_b32 s77, s87, 6
    s_add_u32 s80, s80, s77
    s_sleep 16
    s_mov_b32 s88, 0
L_spin_42:
    buffer_load_dword v64, v10, s[40:43], s76 offen offset:0 sc1
    buffer_load_dword v65, v10, s[40:43], s76 offen offset:128 sc1
    s_waitcnt vmcnt(0)
    v_max_u32 v4, v64, v65
    v_cmp_eq_u32_e64 vcc, -1, v4
    s_nop 0
    s_cbranch_vccz L_ok_43
    s_add_u32 s88, s88, 1
    s_cmp_lt_u32 s88, 65536
    s_cbranch_scc1 L_spin_42
L_ok_43:
    v_lshlrev_b32 v4, 4, v3
    v_lshrrev_b32 v64, v4, v64
    v_lshrrev_b32 v65, v4, v65
    v_lshlrev_b32 v64, 16, v64
    v_lshlrev_b32 v65, 16, v65
    v_lshrrev_b32 v9, 1, v19
    s_mov_b32 s88, 0
    buffer_load_dwordx4 v[128:131], v6, s[40:43], s79 offen offset:512 sc1
    s_sleep 3
    buffer_load_dwordx4 v[128:131], v6, s[40:43], s79 offen offset:512 sc1
    s_sleep 3
L_poll_44:
    buffer_load_dwordx4 v[128:131], v6, s[40:43], s79 offen offset:512 sc1
    s_waitcnt vmcnt(2)
    v_max3_u32 v4, v128, v129, v130
    v_max_u32 v4, v4, v131
    v_cmp_eq_u32 vcc, -1, v4
    s_nop 0
    s_cbranch_vccz L_ok_45
    s_add_u32 s88, s88, 1
    s_cmp_lt_u32 s88, 65536
    s_cbranch_scc1 L_poll_44
L_ok_45:
    v_mov_b32 v48, v128
    v_mov_b32 v49, v129
    v_mov_b32 v50, v130
    v_mov_b32 v51, v131
    v_permlane32_swap_b32 v48, v49
    s_nop 0
    v_permlane32_swap_b32 v50, v51
    v_add_f32 v48, v48, v49
    v_add_f32 v50, v50, v51
    s_nop 1
    v_permlane16_swap_b32 v48, v50
    v_add_f32 v48, v48, v50
    s_nop 1
    v_add_f32_dpp v48, v48, v48 row_ror:8 row_mask:0xf bank_mask:0xf
    v_cvt_pk_bf16_f32 v48, v48, v48
    v_and_b32 v48, s90, v48
    v_mul_f32 v48, v48, v8
    v_cvt_pk_bf16_f32 v48, v48, v48
    v_and_b32 v48, s90, v48
    v_add_f32 v48, v48, v64
    v_cvt_pk_bf16_f32 v48, v48, v48
    v_and_b32 v48, s90, v48
    v_add_f32 v48, v48, v65
    v_cvt_pk_bf16_f32 v48, v48, v48
    s_mov_b32 exec_lo, 0x00ff00ff
    s_mov_b32 exec_hi, 0x00ff00ff
    buffer_store_short v48, v9, s[44:47], s80 offen sc1
    s_mov_b64 exec, -1
L_hfin:
    s_endpgm
L_event:
    s_cmp_eq_u32 s77, 3
    s_cbranch_scc0 L_ev1
    buffer_load_dwordx4 v[92:95], v90, s[40:43], 0 offen sc1
    s_mov_b64 exec, 3
    global_load_dword v27, v91, s[66:67]
    s_mov_b64 exec, -1
    s_branch L_evret
L_ev1:
    s_cmp_eq_u32 s77, 4
    s_cbranch_scc0 L_ev_46
    s_and_b32 s72, s84, 15
    s_mov_b32 m0, s70
    s_lshl_b32 s71, s72, 7
    buffer_load_dwordx4 v16, s[28:31], s71 offen offset:0 lds
    s_mul_i32 s72, s72, 393216
    s_lshr_b64 s[84:85], s[84:85], 4
    buffer_load_dwordx4 v17, s[28:31], s71 offen offset:1024 lds
    buffer_load_dwordx4 v18, s[28:31], s71 offen offset:2048 lds
    buffer_load_dwordx4 v19, s[28:31], s71 offen offset:3072 lds
    s_add_u32 m0, s70, 4096
    s_nop 0
    buffer_load_dwordx4 v20, s[32:35], s72 offen offset:0 lds
    buffer_load_dwordx4 v21, s[32:35], s72 offen offset:1024 lds
    buffer_load_dwordx4 v22, s[32:35], s72 offen offset:2048 lds
    buffer_load_dwordx4 v23, s[32:35], s72 offen offset:3072 lds
    s_add_u32 m0, s70, 8192
    s_nop 0
    buffer_load_dwordx4 v24, s[32:35], s72 offen offset:0 lds
    buffer_load_dwordx4 v25, s[32:35], s72 offen offset:1024 lds
    s_add_u32 s70, s70, 40960
    s_cmp_ge_u32 s70, 122880
    s_cselect_b32 s76, 122880, 0
    s_sub_u32 s70, s70, s76
    buffer_load_dwordx4 v[96:99], v76, s[48:51], s75 offen nt
    s_add_u32 s75, s75, 7168
    buffer_load_dwordx4 v[100:103], v76, s[48:51], s75 offen nt
    s_add_u32 s75, s75, 7168
    buffer_load_dwordx4 v[104:107], v76, s[48:51], s75 offen nt
    s_add_u32 s75, s75, 7168
    buffer_load_dwordx4 v[108:111], v76, s[48:51], s75 offen nt
    s_add_u32 s75, s75, 7168
    buffer_load_dwordx4 v[128:131], v76, s[48:51], s75 offen nt
    s_add_u32 s75, s75, 7168
    buffer_load_dwordx4 v[132:135], v76, s[48:51], s75 offen nt
    s_add_u32 s75, s75, 7168
    buffer_load_dwordx4 v[136:139], v76, s[48:51], s75 offen nt
    s_add_u32 s75, s75, 7168
    buffer_load_dwordx4 v[140:143], v76, s[48:51], s75 offen nt
    s_add_u32 s75, s75, 7168
    s_waitcnt vmcnt(18)
    s_branch L_hbar
L_ev_46:
    s_cmp_eq_u32 s77, 5
    s_cbranch_scc0 L_ev_47
    s_and_b32 s72, s84, 15
    s_mov_b32 m0, s70
    s_lshl_b32 s71, s72, 7
    buffer_load_dwordx4 v16, s[28:31], s71 offen offset:0 lds
    s_mul_i32 s72, s72, 393216
    s_lshr_b64 s[84:85], s[84:85], 4
    buffer_load_dwordx4 v17, s[28:31], s71 offen offset:1024 lds
    buffer_load_dwordx4 v18, s[28:31], s71 offen offset:2048 lds
    buffer_load_dwordx4 v19, s[28:31], s71 offen offset:3072 lds
    s_add_u32 m0, s70, 4096
    s_nop 0
    buffer_load_dwordx4 v20, s[32:35], s72 offen offset:0 lds
    buffer_load_dwordx4 v21, s[32:35], s72 offen offset:1024 lds
    buffer_load_dwordx4 v22, s[32:35], s72 offen offset:2048 lds
    buffer_load_dwordx4 v23, s[32:35], s72 offen offset:3072 lds
    s_add_u32 m0, s70, 8192
    s_nop 0
    buffer_load_dwordx4 v24, s[32:35], s72 offen offset:0 lds
    buffer_load_dwordx4 v25, s[32:35], s72 offen offset:1024 lds
    s_add_u32 s70, s70, 40960
    s_cmp_ge_u32 s70, 122880
    s_cselect_b32 s76, 122880, 0
    s_sub_u32 s70, s70, s76
    s_lshr_b32 s78, s2, 3
    s_lshl2_add_u32 s78, s78, s62
    s_lshl_b32 s78, s78, 14
    v_lshlrev_b32_e64 v11, 10, v1
    s_mov_b64 exec, 65535
    buffer_load_dword v27, v11, s[36:39], s78 offen offset:384
    s_mov_b64 exec, -1
    s_lshl_b32 s78, s62, 9
    v_lshl_add_u32 v11, v1, 7, s78
    s_mov_b64 exec, 15
    global_load_dword v27, v11, s[14:15]
    s_mov_b64 exec, -1
    buffer_load_dwordx4 v[112:115], v76, s[48:51], s75 offen nt
    s_add_u32 s75, s75, 7168
    buffer_load_dwordx4 v[116:119], v76, s[48:51], s75 offen nt
    s_add_u32 s75, s75, 7168
    buffer_load_dwordx4 v[120:123], v76, s[48:51], s75 offen nt
    s_add_u32 s75, s75, 7168
    buffer_load_dwordx4 v[124:127], v76, s[48:51], s75 offen nt
    s_add_u32 s75, s75, 7168
    buffer_load_dwordx4 v[144:147], v76, s[48:51], s75 offen nt
    s_add_u32 s75, s75, 7168
    buffer_load_dwordx4 v[148:151], v76, s[48:51], s75 offen nt
    s_add_u32 s75, s75, 7168
    s_waitcnt vmcnt(18)
    s_branch L_hbar
L_ev_47:
    s_add_u32 s78, s70, 40960
    s_cmp_ge_u32 s78, 122880
    s_cselect_b32 s76, 122880, 0
    s_sub_u32 s78, s78, s76
    s_cmp_eq_u32 s77, 2
    s_cbranch_scc1 L_evw
    v_add_u32 v4, s78, v72
    v_xor_b32 v5, 32, v4
    v_xor_b32 v6, 64, v4
    v_xor_b32 v7, 96, v4
    s_and_b32 s72, s84, 15
    s_mov_b32 m0, s70
    s_lshl_b32 s71, s72, 7
    buffer_load_dwordx4 v16, s[28:31], s71 offen offset:0 lds
    s_mul_i32 s72, s72, 393216
    s_lshr_b64 s[84:85], s[84:85], 4
    ds_read_b128 v[32:35], v4
    ds_read_b128 v[36:39], v5
    ds_read_b128 v[40:43], v6
    ds_read_b128 v[44:47], v7
    buffer_load_dwordx4 v17, s[28:31], s71 offen offset:1024 lds
    s_lshl_b32 s79, s62, 8
    s_add_u32 s79, s79, s73
    s_waitcnt lgkmcnt(0)
    v_lshlrev_b32 v80, 16, v32
    v_and_b32 v82, s90, v32
    v_mul_f32 v81, v80, v80
    v_mul_f32 v83, v82, v82
    v_lshlrev_b32 v10, 16, v33
    v_and_b32 v11, s90, v33
    v_add_f32 v80, v80, v10
    v_add_f32 v82, v82, v11
    v_fmac_f32 v81, v10, v10
    v_fmac_f32 v83, v11, v11
    v_lshlrev_b32 v8, 16, v34
    v_and_b32_e64 v9, s90, v34
    buffer_load_dwordx4 v18, s[28:31], s71 offen offset:2048 lds
    v_add_f32 v80, v80, v8
    v_add_f32 v82, v82, v9
    v_fmac_f32 v81, v8, v8
    v_fmac_f32 v83, v9, v9
    v_lshlrev_b32 v10, 16, v35
    v_and_b32 v11, s90, v35
    v_add_f32 v80, v80, v10
    v_add_f32 v82, v82, v11
    v_fmac_f32 v81, v10, v10
    v_fmac_f32 v83, v11, v11
    v_lshlrev_b32 v8, 16, v36
    v_and_b32 v9, s90, v36
    buffer_load_dwordx4 v19, s[28:31], s71 offen offset:3072 lds
    v_add_f32 v80, v80, v8
    v_add_f32 v82, v82, v9
    v_fmac_f32 v81, v8, v8
    v_fmac_f32 v83, v9, v9
    v_lshlrev_b32 v10, 16, v37
    v_and_b32 v11, s90, v37
    v_add_f32 v80, v80, v10
    v_add_f32 v82, v82, v11
    v_fmac_f32 v81, v10, v10
    v_fmac_f32 v83, v11, v11
    v_lshlrev_b32 v8, 16, v38
    v_and_b32 v9, s90, v38
    s_add_u32 m0, s70, 4096
    s_nop 0
    buffer_load_dwordx4 v20, s[32:35], s72 offen offset:0 lds
    v_add_f32 v80, v80, v8
    v_add_f32 v82, v82, v9
    v_fmac_f32 v81, v8, v8
    v_fmac_f32 v83, v9, v9
    v_lshlrev_b32 v10, 16, v39
    v_and_b32 v11, s90, v39
    v_add_f32 v80, v80, v10
    v_add_f32 v82, v82, v11
    v_fmac_f32 v81, v10, v10
    v_fmac_f32 v83, v11, v11
    v_lshlrev_b32 v8, 16, v40
    v_and_b32_e64 v9, s90, v40
    buffer_load_dwordx4 v21, s[32:35], s72 offen offset:1024 lds
    v_add_f32 v80, v80, v8
    v_add_f32 v82, v82, v9
    v_fmac_f32 v81, v8, v8
    v_fmac_f32 v83, v9, v9
    v_lshlrev_b32 v10, 16, v41
    v_and_b32 v11, s90, v41
    v_add_f32 v80, v80, v10
    v_add_f32 v82, v82, v11
    v_fmac_f32 v81, v10, v10
    v_fmac_f32 v83, v11, v11
    v_lshlrev_b32 v8, 16, v42
    v_and_b32 v9, s90, v42
    buffer_load_dwordx4 v22, s[32:35], s72 offen offset:2048 lds
    v_add_f32 v80, v80, v8
    v_add_f32 v82, v82, v9
    v_fmac_f32 v81, v8, v8
    v_fmac_f32 v83, v9, v9
    v_lshlrev_b32 v10, 16, v43
    v_and_b32 v11, s90, v43
    v_add_f32 v80, v80, v10
    v_add_f32 v82, v82, v11
    v_fmac_f32 v81, v10, v10
    v_fmac_f32 v83, v11, v11
    v_lshlrev_b32 v8, 16, v44
    v_and_b32 v9, s90, v44
    buffer_load_dwordx4 v23, s[32:35], s72 offen offset:3072 lds
    v_add_f32 v80, v80, v8
    v_add_f32 v82, v82, v9
    v_fmac_f32 v81, v8, v8
    v_fmac_f32 v83, v9, v9
    v_lshlrev_b32 v10, 16, v45
    v_and_b32 v11, s90, v45
    v_add_f32 v80, v80, v10
    v_add_f32 v82, v82, v11
    v_fmac_f32 v81, v10, v10
    v_fmac_f32 v83, v11, v11
    v_lshlrev_b32 v8, 16, v46
    v_and_b32 v9, s90, v46
    s_add_u32 m0, s70, 8192
    s_nop 0
    buffer_load_dwordx4 v24, s[32:35], s72 offen offset:0 lds
    v_add_f32 v80, v80, v8
    v_add_f32 v82, v82, v9
    v_fmac_f32 v81, v8, v8
    v_fmac_f32 v83, v9, v9
    v_lshlrev_b32 v10, 16, v47
    v_and_b32 v11, s90, v47
    v_add_f32 v80, v80, v10
    v_add_f32 v82, v82, v11
    v_fmac_f32 v81, v10, v10
    v_fmac_f32_e64 v83, v11, v11
    buffer_load_dwordx4 v25, s[32:35], s72 offen offset:1024 lds
    s_add_u32 s70, s70, 40960
    s_cmp_ge_u32 s70, 122880
    s_cselect_b32 s76, 122880, 0
    s_sub_u32 s70, s70, s76
    v_add_f32 v80, v80, v82
    v_add_f32 v81, v81, v83
    v_mov_b32 v82, v80
    v_mov_b32 v83, v81
    s_nop 0
    v_permlane32_swap_b32 v80, v82
    v_permlane32_swap_b32 v81, v83
    v_add_f32 v80, v80, v82
    v_add_f32_e64 v81, v81, v83
    s_mov_b32 exec_hi, 0
    buffer_store_dwordx2 v[80:81], v74, s[40:43], s79 offen offset:0 sc1
    s_mov_b64 exec, -1
    s_waitcnt vmcnt(11)
    s_branch L_hbar
L_evw:
    s_mul_i32 s79, s63, 2048
    s_add_u32 s79, s79, s78
    v_add_u32_e64 v4, s79, v73
    s_mul_i32 s79, s63, 20480
    s_add_u32 s79, s79, s78
    v_add_u32_e64 v5, s79, v73
    s_and_b32 s72, s84, 15
    s_mov_b32 m0, s70
    s_lshl_b32 s71, s72, 7
    buffer_load_dwordx4 v16, s[28:31], s71 offen offset:0 lds
    s_mul_i32 s72, s72, 393216
    s_lshr_b64 s[84:85], s[84:85], 4
    ds_read_b64_tr_b16 v[32:33], v4 offset:0
    ds_read_b64_tr_b16 v[34:35], v4 offset:512
    ds_read_b64_tr_b16 v[36:37], v4 offset:10240
    ds_read_b64_tr_b16 v[38:39], v4 offset:10752
    ds_read_b64_tr_b16 v[40:41], v4 offset:20480
    ds_read_b64_tr_b16 v[42:43], v4 offset:20992
    ds_read_b64_tr_b16 v[44:45], v4 offset:30720
    ds_read_b64_tr_b16 v[46:47], v4 offset:31232
    ds_read_b64_tr_b16 v[48:49], v5 offset:4096
    ds_read_b64_tr_b16 v[50:51], v5 offset:4608
    ds_read_b64_tr_b16 v[52:53], v5 offset:14336
    ds_read_b64_tr_b16 v[54:55], v5 offset:14848
    buffer_load_dwordx4 v17, s[28:31], s71 offen offset:1024 lds
    s_lshl_b32 s79, s64, 9
    s_lshl_b32 s80, s63, 3
    s_add_u32 s79, s79, s80
    s_add_u32 s79, s79, s73
    s_waitcnt lgkmcnt(0)
    v_lshlrev_b32 v80, 16, v32
    v_and_b32 v82, s90, v32
    v_lshlrev_b32 v10, 16, v33
    v_and_b32 v11, s90, v33
    v_add_f32 v80, v80, v10
    v_add_f32 v82, v82, v11
    v_lshlrev_b32 v8, 16, v34
    v_and_b32 v9, s90, v34
    v_add_f32 v80, v80, v8
    v_add_f32 v82, v82, v9
    v_lshlrev_b32 v10, 16, v35
    v_and_b32 v11, s90, v35
    buffer_load_dwordx4 v18, s[28:31], s71 offen offset:2048 lds
    v_add_f32 v80, v80, v10
    v_add_f32 v82, v82, v11
    v_lshlrev_b32 v8, 16, v36
    v_and_b32 v9, s90, v36
    v_add_f32 v80, v80, v8
    v_add_f32 v82, v82, v9
    v_lshlrev_b32 v10, 16, v37
    v_and_b32 v11, s90, v37
    v_add_f32 v80, v80, v10
    v_add_f32 v82, v82, v11
    v_lshlrev_b32 v8, 16, v38
    v_and_b32 v9, s90, v38
    buffer_load_dwordx4 v19, s[28:31], s71 offen offset:3072 lds
    v_add_f32 v80, v80, v8
    v_add_f32 v82, v82, v9
    v_lshlrev_b32 v10, 16, v39
    v_and_b32 v11, s90, v39
    v_add_f32 v80, v80, v10
    v_add_f32 v82, v82, v11
    v_lshlrev_b32 v8, 16, v40
    v_and_b32 v9, s90, v40
    v_add_f32 v80, v80, v8
    v_add_f32 v82, v82, v9
    v_lshlrev_b32 v10, 16, v41
    v_and_b32 v11, s90, v41
    s_add_u32 m0, s70, 4096
    s_nop 0
    buffer_load_dwordx4 v20, s[32:35], s72 offen offset:0 lds
    v_add_f32 v80, v80, v10
    v_add_f32 v82, v82, v11
    v_lshlrev_b32 v8, 16, v42
    v_and_b32 v9, s90, v42
    v_add_f32 v80, v80, v8
    v_add_f32 v82, v82, v9
    v_lshlrev_b32 v10, 16, v43
    v_and_b32 v11, s90, v43
    v_add_f32 v80, v80, v10
    v_add_f32 v82, v82, v11
    v_lshlrev_b32 v8, 16, v44
    v_and_b32_e64 v9, s90, v44
    buffer_load_dwordx4 v21, s[32:35], s72 offen offset:1024 lds
    v_add_f32 v80, v80, v8
    v_add_f32 v82, v82, v9
    v_lshlrev_b32 v10, 16, v45
    v_and_b32 v11, s90, v45
    v_add_f32 v80, v80, v10
    v_add_f32 v82, v82, v11
    v_lshlrev_b32 v8, 16, v46
    v_and_b32 v9, s90, v46
    v_add_f32 v80, v80, v8
    v_add_f32 v82, v82, v9
    v_lshlrev_b32 v10, 16, v47
    v_and_b32 v11, s90, v47
    buffer_load_dwordx4 v22, s[32:35], s72 offen offset:2048 lds
    v_add_f32 v80, v80, v10
    v_add_f32 v82, v82, v11
    v_lshlrev_b32 v81, 16, v48
    v_and_b32 v83, s90, v48
    v_lshlrev_b32 v10, 16, v49
    v_and_b32 v11, s90, v49
    v_add_f32 v81, v81, v10
    v_add_f32 v83, v83, v11
    v_lshlrev_b32 v8, 16, v50
    v_and_b32 v9, s90, v50
    v_add_f32 v81, v81, v8
    v_add_f32 v83, v83, v9
    buffer_load_dwordx4 v23, s[32:35], s72 offen offset:3072 lds
    v_lshlrev_b32 v10, 16, v51
    v_and_b32 v11, s90, v51
    v_add_f32 v81, v81, v10
    v_add_f32 v83, v83, v11
    v_lshlrev_b32 v8, 16, v52
    v_and_b32 v9, s90, v52
    v_add_f32 v81, v81, v8
    v_add_f32 v83, v83, v9
    v_lshlrev_b32 v10, 16, v53
    v_and_b32 v11, s90, v53
    v_add_f32 v81, v81, v10
    v_add_f32 v83, v83, v11
    s_add_u32 m0, s70, 8192
    s_nop 0
    buffer_load_dwordx4 v24, s[32:35], s72 offen offset:0 lds
    v_lshlrev_b32 v8, 16, v54
    v_and_b32 v9, s90, v54
    v_add_f32 v81, v81, v8
    v_add_f32 v83, v83, v9
    v_lshlrev_b32 v10, 16, v55
    v_and_b32 v11, s90, v55
    v_add_f32 v81, v81, v10
    v_add_f32_e64 v83, v83, v11
    buffer_load_dwordx4 v25, s[32:35], s72 offen offset:1024 lds
    s_add_u32 s70, s70, 40960
    s_cmp_ge_u32 s70, 122880
    s_cselect_b32 s76, 122880, 0
    s_sub_u32 s70, s70, s76
    v_add_f32 v80, v80, v82
    v_add_f32 v81, v81, v83
    v_mov_b32 v82, v80
    v_mov_b32 v83, v81
    s_nop 0
    v_permlane32_swap_b32 v80, v82
    v_permlane32_swap_b32 v81, v83
    v_add_f32 v80, v80, v82
    v_add_f32_e64 v81, v81, v83
    s_mov_b32 exec_hi, 0
    buffer_store_dwordx2 v[80:81], v12, s[40:43], s79 offen offset:1024 sc1
    s_mov_b64 exec, -1
    s_waitcnt vmcnt(11)
    s_branch L_hbar
L_compute:
    s_setprio 2
    s_and_b32 s63, s62, 1
    s_lshr_b32 s64, s62, 1
    s_lshl_b32 s73, s60, 4
    s_add_u32 s73, s73, s61
    s_mul_i32 s73, s73, 28800
    s_add_u32 s76, s2, 7
    s_and_b32 s76, s76, 7
    s_bfe_u32 s77, s2, 0x10003
    s_lshl1_add_u32 s97, s76, s77
    s_lshr_b32 s98, s2, 4
    s_lshl_b32 s99, s97, 4
    s_add_u32 s99, s99, s98
    s_mul_i32 s99, s99, 9344
    s_add_u32 s99, s99, 8388608
    s_lshr_b32 s65, s97, 1
    s_lshl_b32 s76, s97, 3
    s_add_u32 s65, s65, s76
    s_mul_i32 s76, s98, 4
    s_add_u32 s65, s65, s76
    s_and_b32 s65, s65, 15
    s_mov_b32 s89, 0x3f803f80
    s_mov_b32 s90, 0xffff0000
    v_and_b32 v2, 31, v1
    v_lshrrev_b32 v3, 5, v1
    v_lshlrev_b32 v12, 4, v1
    v_lshrrev_b32 v4, 3, v1
    v_mul_u32_u24 v13, 460800, v4
    v_and_b32_e64 v4, 7, v1
    v_lshl_add_u32 v13, v4, 4, v13
    v_and_b32 v10, 15, v1
    v_lshrrev_b32 v11, 4, v1
    s_mul_i32 s76, s63, 20480
    v_lshrrev_b32 v4, 1, v10
    v_xor_b32 v4, v4, v11
    v_lshlrev_b32_e64 v4, 4, v4
    v_lshl_add_u32 v4, v10, 7, v4
    v_add_u32 v192, s76, v4
    v_xor_b32 v193, 64, v192
    v_bfe_u32 v4, v1, 2, 2
    v_and_b32_e64 v6, 1, v11
    v_lshl_add_u32 v5, v6, 3, v4
    v_lshlrev_b32 v5, 7, v5
    v_lshrrev_b32 v4, 1, v4
    v_xor_b32_e64 v4, s64, v4
    v_lshl_add_u32 v5, v4, 6, v5
    v_lshl_add_u32 v5, v6, 5, v5
    v_and_b32_e64 v4, 3, v1
    v_lshl_add_u32 v5, v4, 3, v5
    v_mul_u32_u24 v4, 10240, v3
    v_add_u32_e64 v5, v5, v4
    v_add_u32 v194, 4096, v5
    v_xor_b32_e64 v195, 32, v194
    v_add_u32 v196, 40960, v192
    v_add_u32 v197, 40960, v193
    v_add_u32 v198, 40960, v194
    v_add_u32 v199, 40960, v195
    v_add_u32 v200, 81920, v192
    v_add_u32 v201, 81920, v193
    v_add_u32 v202, 81920, v194
    v_add_u32 v203, 81920, v195
    v_bfe_u32 v4, v1, 2, 2
    v_lshl_add_u32 v4, v3, 3, v4
    v_lshlrev_b32 v4, 6, v4
    v_and_b32 v5, 1, v11
    v_lshl_add_u32 v4, v5, 5, v4
    v_and_b32_e64 v5, 3, v1
    v_lshl_add_u32 v4, v5, 3, v4
    s_lshl_b32 s76, s64, 11
    s_add_u32 s76, s76, 122880
    v_add_u32_e64 v212, s76, v4
    s_lshl_b32 s76, s63, 9
    v_lshl_add_u32 v213, v10, 3, s76
    v_lshl_add_u32 v214, v2, 3, s76
    s_lshl_b32 s76, s64, 8
    v_lshl_add_u32 v215, v10, 3, s76
    v_bfe_u32 v4, v10, 1, 1
    v_xor_b32 v4, s64, v4
    v_lshrrev_b32 v5, 2, v10
    v_xor_b32 v5, v5, v3
    v_xor_b32 v6, v10, v11
    v_and_b32 v6, 1, v6
    v_lshlrev_b32_e64 v4, 6, v4
    v_lshl_add_u32 v4, v5, 4, v4
    v_lshl_add_u32 v4, v6, 3, v4
    v_lshl_add_u32 v4, v10, 7, v4
    s_lshl_b32 s76, s63, 13
    v_add_u32 v216, s76, v4
    v_bfe_u32 v4, v2, 1, 1
    v_bfe_u32 v5, v2, 2, 2
    v_and_b32 v6, 1, v2
    v_xor_b32 v6, v6, v3
    v_lshlrev_b32_e64 v4, 6, v4
    v_lshl_add_u32 v4, v5, 4, v4
    v_lshl_add_u32 v4, v6, 3, v4
    v_lshl_add_u32 v4, v2, 7, v4
    s_lshl_b32 s77, s64, 14
    s_add_u32 s76, s76, s77
    v_add_u32_e64 v217, s76, v4
    v_bfe_u32 v4, v1, 2, 2
    v_lshl_add_u32 v5, v3, 3, v4
    v_lshlrev_b32 v5, 7, v5
    v_lshrrev_b32 v6, 1, v4
    v_lshl_add_u32 v5, v6, 6, v5
    v_bfe_u32 v6, v1, 4, 1
    v_xor_b32_e64 v6, v6, v3
    v_lshl_add_u32 v5, v6, 5, v5
    v_bfe_u32 v6, v1, 1, 1
    v_lshl_add_u32 v5, v6, 4, v5
    v_xor_b32 v6, v1, v4
    v_and_b32 v6, 1, v6
    v_lshl_add_u32 v5, v6, 3, v5
    s_lshl_b32 s76, s63, 6
    s_or_b32 s76, s76, s77
    v_xor_b32 v218, s76, v5
    s_lshl_b32 s76, s64, 6
    v_xor_b32_e64 v220, s76, v5
    v_xor_b32 v219, 528, v218
    v_xor_b32 v221, 528, v220
    v_cmp_gt_u32 s[86:87], 16, v1
    s_waitcnt lgkmcnt(0)
    s_mov_b32 s40, s26
    s_and_b32 s41, s27, 0xffff
    s_mov_b32 s42, 33554432
    s_mov_b32 s43, 0x20000
    s_mov_b32 s44, s22
    s_and_b32 s45, s23, 0xffff
    s_mov_b32 s46, 4194304
    s_mov_b32 s47, 0x20000
    s_mov_b32 s68, 0
    s_getreg_b32 s101, hwreg(HW_REG_XCC_ID, 0, 4)
    v_mov_b32 v9, 13631488
    s_lshl_b32 s76, s61, 8
    s_lshl4_add_u32 s76, s60, s76
    s_add_u32 s76, s76, 12582912
    v_mov_b32 v8, s76
    s_lshl_b32 s76, s60, 8
    s_lshl4_add_u32 s76, s61, s76
    s_add_u32 s76, s76, 12587008
    v_writelane_b32 v8, s76, 1
    s_lshl_b32 s76, s97, 8
    s_lshl4_add_u32 s76, s98, s76
    s_add_u32 s76, s76, 12591104
    v_writelane_b32 v8, s76, 2
    v_mov_b32 v6, s101
    v_mov_b32 v7, 0
    v_mov_b32_e64 v10, 0
    s_cmp_eq_u32 s62, 0
    s_cbranch_scc0 L_noep
    buffer_load_dwordx2 v[4:5], v9, s[40:43], 0 offen
L_noep:
    s_barrier
    ds_read_b128 v[112:115], v192 offset:0
    ds_read_b64_tr_b16 v[128:129], v194 offset:0
    ds_read_b64_tr_b16 v[130:131], v194 offset:512
    ds_read_b128 v[116:119], v192 offset:2048
    ds_read_b128 v[120:123], v192 offset:10240
    ds_read_b128 v[124:127], v192 offset:12288
    ds_read_b64_tr_b16 v[132:133], v195 offset:0
    ds_read_b64_tr_b16 v[134:135], v195 offset:512
    ds_read_b64_tr_b16 v[136:137], v194 offset:2048
    ds_read_b64_tr_b16 v[138:139], v194 offset:2560
    ds_read_b64_tr_b16 v[140:141], v195 offset:2048
    ds_read_b64_tr_b16 v[142:143], v195 offset:2560
    ds_read_b64_tr_b16 v[144:145], v194 offset:4096
    ds_read_b64_tr_b16 v[146:147], v194 offset:4608
    s_waitcnt lgkmcnt(8)
    ds_read_b64_tr_b16 v[148:149], v195 offset:4096
    ds_read_b64_tr_b16 v[150:151], v195 offset:4608
    v_mfma_f32_16x16x32_bf16 v[16:19], v[128:131], v[112:115], 0
    ds_read_b128 v[152:155], v193 offset:0
    v_mfma_f32_16x16x32_bf16 v[20:23], v[128:131], v[116:119], 0
    ds_read_b64_tr_b16 v[168:169], v194 offset:20480
    v_mfma_f32_16x16x32_bf16 v[24:27], v[128:131], v[120:123], 0
    ds_read_b64_tr_b16 v[170:171], v194 offset:20992
    v_mfma_f32_16x16x32_bf16 v[28:31], v[128:131], v[124:127], 0
    ds_read_b128 v[156:159], v193 offset:2048
    s_waitcnt lgkmcnt(4)
    v_mfma_f32_16x16x32_bf16 v[32:35], v[132:135], v[112:115], 0
    ds_read_b128 v[160:163], v193 offset:10240
    v_mfma_f32_16x16x32_bf16 v[36:39], v[132:135], v[116:119], 0
    ds_read_b128 v[164:167], v193 offset:12288
    v_mfma_f32_16x16x32_bf16 v[40:43], v[132:135], v[120:123], 0
    ds_read_b64_tr_b16 v[172:173], v195 offset:20480
    v_mfma_f32_16x16x32_bf16 v[44:47], v[132:135], v[124:127], 0
    ds_read_b64_tr_b16 v[174:175], v195 offset:20992
    v_mfma_f32_16x16x32_bf16 v[48:51], v[136:139], v[112:115], 0
    ds_read_b64_tr_b16 v[176:177], v194 offset:22528
    v_mfma_f32_16x16x32_bf16 v[52:55], v[136:139], v[116:119], 0
    ds_read_b64_tr_b16 v[178:179], v194 offset:23040
    v_mfma_f32_16x16x32_bf16 v[56:59], v[136:139], v[120:123], 0
    ds_read_b64_tr_b16 v[180:181], v195 offset:22528
    v_mfma_f32_16x16x32_bf16 v[60:63], v[136:139], v[124:127], 0
    ds_read_b64_tr_b16 v[182:183], v195 offset:23040
    v_mfma_f32_16x16x32_bf16 v[64:67], v[140:143], v[112:115], 0
    ds_read_b64_tr_b16 v[184:185], v194 offset:24576
    v_mfma_f32_16x16x32_bf16 v[68:71], v[140:143], v[116:119], 0
    ds_read_b64_tr_b16 v[186:187], v194 offset:25088
    v_mfma_f32_16x16x32_bf16 v[72:75], v[140:143], v[120:123], 0
    ds_read_b64_tr_b16 v[188:189], v195 offset:24576
    v_mfma_f32_16x16x32_bf16 v[76:79], v[140:143], v[124:127], 0
    ds_read_b64_tr_b16 v[190:191], v195 offset:25088
    v_mfma_f32_16x16x32_bf16 v[80:83], v[144:147], v[112:115], 0
    v_mfma_f32_16x16x32_bf16 v[84:87], v[144:147], v[116:119], 0
    v_mfma_f32_16x16x32_bf16 v[88:91], v[144:147], v[120:123], 0
    v_mfma_f32_16x16x32_bf16 v[92:95], v[144:147], v[124:127], 0
    v_mfma_f32_16x16x32_bf16 v[96:99], v[148:151], v[112:115], 0
    v_mfma_f32_16x16x32_bf16 v[100:103], v[148:151], v[116:119], 0
    v_mfma_f32_16x16x32_bf16 v[104:107], v[148:151], v[120:123], 0
    v_mfma_f32_16x16x32_bf16 v[108:111], v[148:151], v[124:127], 0
    s_waitcnt lgkmcnt(0)
    v_mfma_f32_16x16x32_bf16 v[16:19], v[168:171], v[152:155], v[16:19]
    s_barrier
    v_mfma_f32_16x16x32_bf16 v[20:23], v[168:171], v[156:159], v[20:23]
    ds_read_b128 v[112:115], v196 offset:0
    ds_read_b64_tr_b16 v[204:205], v212 offset:0
    ds_read_b64_tr_b16 v[206:207], v212 offset:256
    ds_read_b64_tr_b16 v[208:209], v212 offset:1024
    ds_read_b64_tr_b16 v[210:211], v212 offset:1280
    v_mfma_f32_16x16x32_bf16 v[24:27], v[168:171], v[160:163], v[24:27]
    ds_read_b64_tr_b16 v[128:129], v198 offset:0
    s_cmp_eq_u32 s62, 0
    s_cbranch_scc0 L_cloop
    s_waitcnt vmcnt(0)
    v_add_co_u32 v4, vcc, 1, v4
    s_nop 1
    v_addc_co_u32 v5, vcc, 0, v5, vcc
    s_mov_b64 exec, 7
    buffer_store_dwordx4 v[4:7], v8, s[40:43], 0 offen sc1
    s_mov_b64 exec, -1
.p2align 3
L_cloop:
    v_mfma_f32_16x16x32_bf16 v[28:31], v[168:171], v[164:167], v[28:31]
    ds_read_b64_tr_b16 v[130:131], v198 offset:512
    v_mfma_f32_16x16x32_bf16 v[32:35], v[172:175], v[152:155], v[32:35]
    ds_read_b128 v[116:119], v196 offset:2048
    v_mfma_f32_16x16x32_bf16 v[36:39], v[172:175], v[156:159], v[36:39]
    ds_read_b128 v[120:123], v196 offset:10240
    v_mfma_f32_16x16x32_bf16 v[40:43], v[172:175], v[160:163], v[40:43]
    ds_read_b128 v[124:127], v196 offset:12288
    v_mfma_f32_16x16x32_bf16 v[44:47], v[172:175], v[164:167], v[44:47]
    ds_read_b64_tr_b16 v[132:133], v199 offset:0
    v_mfma_f32_16x16x32_bf16 v[48:51], v[176:179], v[152:155], v[48:51]
    ds_read_b64_tr_b16 v[134:135], v199 offset:512
    v_mfma_f32_16x16x32_bf16 v[52:55], v[176:179], v[156:159], v[52:55]
    ds_read_b64_tr_b16 v[136:137], v198 offset:2048
    v_mfma_f32_16x16x32_bf16 v[56:59], v[176:179], v[160:163], v[56:59]
    ds_read_b64_tr_b16 v[138:139], v198 offset:2560
    v_mfma_f32_16x16x32_bf16 v[60:63], v[176:179], v[164:167], v[60:63]
    ds_read_b64_tr_b16 v[140:141], v199 offset:2048
    v_mfma_f32_16x16x32_bf16 v[64:67], v[180:183], v[152:155], v[64:67]
    ds_read_b64_tr_b16 v[142:143], v199 offset:2560
    v_mfma_f32_16x16x32_bf16 v[68:71], v[180:183], v[156:159], v[68:71]
    ds_read_b64_tr_b16 v[144:145], v198 offset:4096
    v_mfma_f32_16x16x32_bf16 v[72:75], v[180:183], v[160:163], v[72:75]
    ds_read_b64_tr_b16 v[146:147], v198 offset:4608
    v_mfma_f32_16x16x32_bf16 v[76:79], v[180:183], v[164:167], v[76:79]
    ds_read_b64_tr_b16 v[148:149], v199 offset:4096
    v_mfma_f32_16x16x32_bf16 v[80:83], v[184:187], v[152:155], v[80:83]
    ds_read_b64_tr_b16 v[150:151], v199 offset:4608
    v_mfma_f32_16x16x32_bf16 v[84:87], v[184:187], v[156:159], v[84:87]
    v_mfma_f32_16x16x32_bf16 v[88:91], v[184:187], v[160:163], v[88:91]
    v_mfma_f32_16x16x32_bf16 v[92:95], v[184:187], v[164:167], v[92:95]
    v_mfma_f32_16x16x32_bf16 v[96:99], v[188:191], v[152:155], v[96:99]
    v_mfma_f32_16x16x32_bf16 v[100:103], v[188:191], v[156:159], v[100:103]
    v_mfma_f32_16x16x32_bf16 v[104:107], v[188:191], v[160:163], v[104:107]
    v_mfma_f32_16x16x32_bf16 v[108:111], v[188:191], v[164:167], v[108:111]
    s_waitcnt lgkmcnt(0)
    v_mfma_f32_16x16x32_bf16 v[16:19], v[128:131], v[112:115], v[16:19]
    ds_read_b128 v[152:155], v197 offset:0
    v_mfma_f32_16x16x32_bf16 v[20:23], v[128:131], v[116:119], v[20:23]
    ds_read_b64_tr_b16 v[168:169], v198 offset:20480
    v_mfma_f32_16x16x32_bf16 v[24:27], v[128:131], v[120:123], v[24:27]
    ds_read_b64_tr_b16 v[170:171], v198 offset:20992
    v_mfma_f32_16x16x32_bf16 v[28:31], v[128:131], v[124:127], v[28:31]
    ds_read_b128 v[156:159], v197 offset:2048
    v_mfma_f32_16x16x32_bf16 v[32:35], v[132:135], v[112:115], v[32:35]
    ds_read_b128 v[160:163], v197 offset:10240
    v_mfma_f32_16x16x32_bf16 v[36:39], v[132:135], v[116:119], v[36:39]
    ds_read_b128 v[164:167], v197 offset:12288
    v_mfma_f32_16x16x32_bf16 v[40:43], v[132:135], v[120:123], v[40:43]
    ds_read_b64_tr_b16 v[172:173], v199 offset:20480
    v_mfma_f32_16x16x32_bf16 v[44:47], v[132:135], v[124:127], v[44:47]
    ds_read_b64_tr_b16 v[174:175], v199 offset:20992
    v_mfma_f32_16x16x32_bf16 v[48:51], v[136:139], v[112:115], v[48:51]
    ds_read_b64_tr_b16 v[176:177], v198 offset:22528
    v_mfma_f32_16x16x32_bf16 v[52:55], v[136:139], v[116:119], v[52:55]
    ds_read_b64_tr_b16 v[178:179], v198 offset:23040
    v_mfma_f32_16x16x32_bf16 v[56:59], v[136:139], v[120:123], v[56:59]
    ds_read_b64_tr_b16 v[180:181], v199 offset:22528
    v_mfma_f32_16x16x32_bf16 v[60:63], v[136:139], v[124:127], v[60:63]
    ds_read_b64_tr_b16 v[182:183], v199 offset:23040
    v_mfma_f32_16x16x32_bf16 v[64:67], v[140:143], v[112:115], v[64:67]
    ds_read_b64_tr_b16 v[184:185], v198 offset:24576
    v_mfma_f32_16x16x32_bf16 v[68:71], v[140:143], v[116:119], v[68:71]
    ds_read_b64_tr_b16 v[186:187], v198 offset:25088
    v_mfma_f32_16x16x32_bf16 v[72:75], v[140:143], v[120:123], v[72:75]
    ds_read_b64_tr_b16 v[188:189], v199 offset:24576
    v_mfma_f32_16x16x32_bf16 v[76:79], v[140:143], v[124:127], v[76:79]
    ds_read_b64_tr_b16 v[190:191], v199 offset:25088
    v_mfma_f32_16x16x32_bf16 v[80:83], v[144:147], v[112:115], v[80:83]
    v_mfma_f32_16x16x32_bf16 v[84:87], v[144:147], v[116:119], v[84:87]
    v_mfma_f32_16x16x32_bf16 v[88:91], v[144:147], v[120:123], v[88:91]
    v_mfma_f32_16x16x32_bf16 v[92:95], v[144:147], v[124:127], v[92:95]
    v_mfma_f32_16x16x32_bf16 v[96:99], v[148:151], v[112:115], v[96:99]
    v_mfma_f32_16x16x32_bf16 v[100:103], v[148:151], v[116:119], v[100:103]
    v_mfma_f32_16x16x32_bf16 v[104:107], v[148:151], v[120:123], v[104:107]
    v_mfma_f32_16x16x32_bf16 v[108:111], v[148:151], v[124:127], v[108:111]
    s_waitcnt lgkmcnt(0)
    v_mfma_f32_16x16x32_bf16 v[16:19], v[168:171], v[152:155], v[16:19]
    s_barrier
    v_mfma_f32_16x16x32_bf16 v[20:23], v[168:171], v[156:159], v[20:23]
    ds_read_b128 v[112:115], v200 offset:0
    v_mfma_f32_16x16x32_bf16 v[24:27], v[168:171], v[160:163], v[24:27]
    ds_read_b64_tr_b16 v[128:129], v202 offset:0
    v_mfma_f32_16x16x32_bf16 v[28:31], v[168:171], v[164:167], v[28:31]
    ds_read_b64_tr_b16 v[130:131], v202 offset:512
    v_mfma_f32_16x16x32_bf16 v[32:35], v[172:175], v[152:155], v[32:35]
    ds_read_b128 v[116:119], v200 offset:2048
    v_mfma_f32_16x16x32_bf16 v[36:39], v[172:175], v[156:159], v[36:39]
    ds_read_b128 v[120:123], v200 offset:10240
    v_mfma_f32_16x16x32_bf16 v[40:43], v[172:175], v[160:163], v[40:43]
    ds_read_b128 v[124:127], v200 offset:12288
    v_mfma_f32_16x16x32_bf16 v[44:47], v[172:175], v[164:167], v[44:47]
    ds_read_b64_tr_b16 v[132:133], v203 offset:0
    v_mfma_f32_16x16x32_bf16 v[48:51], v[176:179], v[152:155], v[48:51]
    ds_read_b64_tr_b16 v[134:135], v203 offset:512
    v_mfma_f32_16x16x32_bf16 v[52:55], v[176:179], v[156:159], v[52:55]
    ds_read_b64_tr_b16 v[136:137], v202 offset:2048
    v_mfma_f32_16x16x32_bf16 v[56:59], v[176:179], v[160:163], v[56:59]
    ds_read_b64_tr_b16 v[138:139], v202 offset:2560
    v_mfma_f32_16x16x32_bf16 v[60:63], v[176:179], v[164:167], v[60:63]
    ds_read_b64_tr_b16 v[140:141], v203 offset:2048
    v_mfma_f32_16x16x32_bf16 v[64:67], v[180:183], v[152:155], v[64:67]
    ds_read_b64_tr_b16 v[142:143], v203 offset:2560
    v_mfma_f32_16x16x32_bf16 v[68:71], v[180:183], v[156:159], v[68:71]
    ds_read_b64_tr_b16 v[144:145], v202 offset:4096
    v_mfma_f32_16x16x32_bf16 v[72:75], v[180:183], v[160:163], v[72:75]
    ds_read_b64_tr_b16 v[146:147], v202 offset:4608
    v_mfma_f32_16x16x32_bf16 v[76:79], v[180:183], v[164:167], v[76:79]
    ds_read_b64_tr_b16 v[148:149], v203 offset:4096
    v_mfma_f32_16x16x32_bf16 v[80:83], v[184:187], v[152:155], v[80:83]
    ds_read_b64_tr_b16 v[150:151], v203 offset:4608
    v_mfma_f32_16x16x32_bf16 v[84:87], v[184:187], v[156:159], v[84:87]
    v_mfma_f32_16x16x32_bf16 v[88:91], v[184:187], v[160:163], v[88:91]
    v_mfma_f32_16x16x32_bf16 v[92:95], v[184:187], v[164:167], v[92:95]
    v_mfma_f32_16x16x32_bf16 v[96:99], v[188:191], v[152:155], v[96:99]
    v_mfma_f32_16x16x32_bf16 v[100:103], v[188:191], v[156:159], v[100:103]
    v_mfma_f32_16x16x32_bf16 v[104:107], v[188:191], v[160:163], v[104:107]
    v_mfma_f32_16x16x32_bf16 v[108:111], v[188:191], v[164:167], v[108:111]
    s_waitcnt lgkmcnt(0)
    v_mfma_f32_16x16x32_bf16 v[16:19], v[128:131], v[112:115], v[16:19]
    ds_read_b128 v[152:155], v201 offset:0
    v_mfma_f32_16x16x32_bf16 v[20:23], v[128:131], v[116:119], v[20:23]
    ds_read_b64_tr_b16 v[168:169], v202 offset:20480
    v_mfma_f32_16x16x32_bf16 v[24:27], v[128:131], v[120:123], v[24:27]
    ds_read_b64_tr_b16 v[170:171], v202 offset:20992
    v_mfma_f32_16x16x32_bf16 v[28:31], v[128:131], v[124:127], v[28:31]
    ds_read_b128 v[156:159], v201 offset:2048
    v_mfma_f32_16x16x32_bf16 v[32:35], v[132:135], v[112:115], v[32:35]
    ds_read_b128 v[160:163], v201 offset:10240
    v_mfma_f32_16x16x32_bf16 v[36:39], v[132:135], v[116:119], v[36:39]
    ds_read_b128 v[164:167], v201 offset:12288
    v_mfma_f32_16x16x32_bf16 v[40:43], v[132:135], v[120:123], v[40:43]
    ds_read_b64_tr_b16 v[172:173], v203 offset:20480
    v_mfma_f32_16x16x32_bf16 v[44:47], v[132:135], v[124:127], v[44:47]
    ds_read_b64_tr_b16 v[174:175], v203 offset:20992
    v_mfma_f32_16x16x32_bf16 v[48:51], v[136:139], v[112:115], v[48:51]
    ds_read_b64_tr_b16 v[176:177], v202 offset:22528
    v_mfma_f32_16x16x32_bf16 v[52:55], v[136:139], v[116:119], v[52:55]
    ds_read_b64_tr_b16 v[178:179], v202 offset:23040
    v_mfma_f32_16x16x32_bf16 v[56:59], v[136:139], v[120:123], v[56:59]
    ds_read_b64_tr_b16 v[180:181], v203 offset:22528
    v_mfma_f32_16x16x32_bf16 v[60:63], v[136:139], v[124:127], v[60:63]
    ds_read_b64_tr_b16 v[182:183], v203 offset:23040
    v_mfma_f32_16x16x32_bf16 v[64:67], v[140:143], v[112:115], v[64:67]
    ds_read_b64_tr_b16 v[184:185], v202 offset:24576
    v_mfma_f32_16x16x32_bf16 v[68:71], v[140:143], v[116:119], v[68:71]
    ds_read_b64_tr_b16 v[186:187], v202 offset:25088
    v_mfma_f32_16x16x32_bf16 v[72:75], v[140:143], v[120:123], v[72:75]
    ds_read_b64_tr_b16 v[188:189], v203 offset:24576
    v_mfma_f32_16x16x32_bf16 v[76:79], v[140:143], v[124:127], v[76:79]
    ds_read_b64_tr_b16 v[190:191], v203 offset:25088
    v_mfma_f32_16x16x32_bf16 v[80:83], v[144:147], v[112:115], v[80:83]
    v_mfma_f32_16x16x32_bf16 v[84:87], v[144:147], v[116:119], v[84:87]
    v_mfma_f32_16x16x32_bf16 v[88:91], v[144:147], v[120:123], v[88:91]
    v_mfma_f32_16x16x32_bf16 v[92:95], v[144:147], v[124:127], v[92:95]
    v_mfma_f32_16x16x32_bf16 v[96:99], v[148:151], v[112:115], v[96:99]
    v_mfma_f32_16x16x32_bf16 v[100:103], v[148:151], v[116:119], v[100:103]
    v_mfma_f32_16x16x32_bf16 v[104:107], v[148:151], v[120:123], v[104:107]
    v_mfma_f32_16x16x32_bf16 v[108:111], v[148:151], v[124:127], v[108:111]
    s_waitcnt lgkmcnt(0)
    v_mfma_f32_16x16x32_bf16 v[16:19], v[168:171], v[152:155], v[16:19]
    s_barrier
    v_mfma_f32_16x16x32_bf16 v[20:23], v[168:171], v[156:159], v[20:23]
    ds_read_b128 v[112:115], v192 offset:0
    v_mfma_f32_16x16x32_bf16 v[24:27], v[168:171], v[160:163], v[24:27]
    ds_read_b64_tr_b16 v[128:129], v194 offset:0
    v_mfma_f32_16x16x32_bf16 v[28:31], v[168:171], v[164:167], v[28:31]
    ds_read_b64_tr_b16 v[130:131], v194 offset:512
    v_mfma_f32_16x16x32_bf16 v[32:35], v[172:175], v[152:155], v[32:35]
    ds_read_b128 v[116:119], v192 offset:2048
    v_mfma_f32_16x16x32_bf16 v[36:39], v[172:175], v[156:159], v[36:39]
    ds_read_b128 v[120:123], v192 offset:10240
    v_mfma_f32_16x16x32_bf16 v[40:43], v[172:175], v[160:163], v[40:43]
    ds_read_b128 v[124:127], v192 offset:12288
    v_mfma_f32_16x16x32_bf16 v[44:47], v[172:175], v[164:167], v[44:47]
    ds_read_b64_tr_b16 v[132:133], v195 offset:0
    v_mfma_f32_16x16x32_bf16 v[48:51], v[176:179], v[152:155], v[48:51]
    ds_read_b64_tr_b16 v[134:135], v195 offset:512
    v_mfma_f32_16x16x32_bf16 v[52:55], v[176:179], v[156:159], v[52:55]
    ds_read_b64_tr_b16 v[136:137], v194 offset:2048
    v_mfma_f32_16x16x32_bf16 v[56:59], v[176:179], v[160:163], v[56:59]
    ds_read_b64_tr_b16 v[138:139], v194 offset:2560
    v_mfma_f32_16x16x32_bf16 v[60:63], v[176:179], v[164:167], v[60:63]
    ds_read_b64_tr_b16 v[140:141], v195 offset:2048
    v_mfma_f32_16x16x32_bf16 v[64:67], v[180:183], v[152:155], v[64:67]
    ds_read_b64_tr_b16 v[142:143], v195 offset:2560
    v_mfma_f32_16x16x32_bf16 v[68:71], v[180:183], v[156:159], v[68:71]
    ds_read_b64_tr_b16 v[144:145], v194 offset:4096
    v_mfma_f32_16x16x32_bf16 v[72:75], v[180:183], v[160:163], v[72:75]
    ds_read_b64_tr_b16 v[146:147], v194 offset:4608
    v_mfma_f32_16x16x32_bf16 v[76:79], v[180:183], v[164:167], v[76:79]
    ds_read_b64_tr_b16 v[148:149], v195 offset:4096
    v_mfma_f32_16x16x32_bf16 v[80:83], v[184:187], v[152:155], v[80:83]
    ds_read_b64_tr_b16 v[150:151], v195 offset:4608
    v_mfma_f32_16x16x32_bf16 v[84:87], v[184:187], v[156:159], v[84:87]
    v_mfma_f32_16x16x32_bf16 v[88:91], v[184:187], v[160:163], v[88:91]
    v_mfma_f32_16x16x32_bf16 v[92:95], v[184:187], v[164:167], v[92:95]
    v_mfma_f32_16x16x32_bf16 v[96:99], v[188:191], v[152:155], v[96:99]
    v_mfma_f32_16x16x32_bf16 v[100:103], v[188:191], v[156:159], v[100:103]
    v_mfma_f32_16x16x32_bf16 v[104:107], v[188:191], v[160:163], v[104:107]
    v_mfma_f32_16x16x32_bf16 v[108:111], v[188:191], v[164:167], v[108:111]
    s_waitcnt lgkmcnt(0)
    v_mfma_f32_16x16x32_bf16 v[16:19], v[128:131], v[112:115], v[16:19]
    ds_read_b128 v[152:155], v193 offset:0
    v_mfma_f32_16x16x32_bf16 v[20:23], v[128:131], v[116:119], v[20:23]
    ds_read_b64_tr_b16 v[168:169], v194 offset:20480
    v_mfma_f32_16x16x32_bf16 v[24:27], v[128:131], v[120:123], v[24:27]
    ds_read_b64_tr_b16 v[170:171], v194 offset:20992
    v_mfma_f32_16x16x32_bf16 v[28:31], v[128:131], v[124:127], v[28:31]
    ds_read_b128 v[156:159], v193 offset:2048
    v_mfma_f32_16x16x32_bf16 v[32:35], v[132:135], v[112:115], v[32:35]
    ds_read_b128 v[160:163], v193 offset:10240
    v_mfma_f32_16x16x32_bf16 v[36:39], v[132:135], v[116:119], v[36:39]
    ds_read_b128 v[164:167], v193 offset:12288
    v_mfma_f32_16x16x32_bf16 v[40:43], v[132:135], v[120:123], v[40:43]
    ds_read_b64_tr_b16 v[172:173], v195 offset:20480
    v_mfma_f32_16x16x32_bf16 v[44:47], v[132:135], v[124:127], v[44:47]
    ds_read_b64_tr_b16 v[174:175], v195 offset:20992
    v_mfma_f32_16x16x32_bf16 v[48:51], v[136:139], v[112:115], v[48:51]
    ds_read_b64_tr_b16 v[176:177], v194 offset:22528
    v_mfma_f32_16x16x32_bf16 v[52:55], v[136:139], v[116:119], v[52:55]
    ds_read_b64_tr_b16 v[178:179], v194 offset:23040
    v_mfma_f32_16x16x32_bf16 v[56:59], v[136:139], v[120:123], v[56:59]
    ds_read_b64_tr_b16 v[180:181], v195 offset:22528
    v_mfma_f32_16x16x32_bf16 v[60:63], v[136:139], v[124:127], v[60:63]
    ds_read_b64_tr_b16 v[182:183], v195 offset:23040
    v_mfma_f32_16x16x32_bf16 v[64:67], v[140:143], v[112:115], v[64:67]
    ds_read_b64_tr_b16 v[184:185], v194 offset:24576
    v_mfma_f32_16x16x32_bf16 v[68:71], v[140:143], v[116:119], v[68:71]
    ds_read_b64_tr_b16 v[186:187], v194 offset:25088
    v_mfma_f32_16x16x32_bf16 v[72:75], v[140:143], v[120:123], v[72:75]
    ds_read_b64_tr_b16 v[188:189], v195 offset:24576
    v_mfma_f32_16x16x32_bf16 v[76:79], v[140:143], v[124:127], v[76:79]
    ds_read_b64_tr_b16 v[190:191], v195 offset:25088
    v_mfma_f32_16x16x32_bf16 v[80:83], v[144:147], v[112:115], v[80:83]
    v_mfma_f32_16x16x32_bf16 v[84:87], v[144:147], v[116:119], v[84:87]
    v_mfma_f32_16x16x32_bf16 v[88:91], v[144:147], v[120:123], v[88:91]
    v_mfma_f32_16x16x32_bf16 v[92:95], v[144:147], v[124:127], v[92:95]
    v_mfma_f32_16x16x32_bf16 v[96:99], v[148:151], v[112:115], v[96:99]
    s_add_u32 s68, s68, 1
    s_cmp_lt_u32 s68, 5
    v_mfma_f32_16x16x32_bf16 v[100:103], v[148:151], v[116:119], v[100:103]
    v_mfma_f32_16x16x32_bf16 v[104:107], v[148:151], v[120:123], v[104:107]
    v_mfma_f32_16x16x32_bf16 v[108:111], v[148:151], v[124:127], v[108:111]
    s_waitcnt lgkmcnt(0)
    v_mfma_f32_16x16x32_bf16 v[16:19], v[168:171], v[152:155], v[16:19]
    s_cbranch_scc0 L_cexit
    s_barrier
    v_mfma_f32_16x16x32_bf16 v[20:23], v[168:171], v[156:159], v[20:23]
    ds_read_b128 v[112:115], v196 offset:0
    v_mfma_f32_16x16x32_bf16 v[24:27], v[168:171], v[160:163], v[24:27]
    ds_read_b64_tr_b16 v[128:129], v198 offset:0
    s_branch L_cloop
L_cexit:
    v_mfma_f32_16x16x32_bf16 v[20:23], v[168:171], v[156:159], v[20:23]
    v_mfma_f32_16x16x32_bf16 v[24:27], v[168:171], v[160:163], v[24:27]
    v_mfma_f32_16x16x32_bf16 v[28:31], v[168:171], v[164:167], v[28:31]
    v_mfma_f32_16x16x32_bf16 v[32:35], v[172:175], v[152:155], v[32:35]
    v_mfma_f32_16x16x32_bf16 v[36:39], v[172:175], v[156:159], v[36:39]
    v_mfma_f32_16x16x32_bf16 v[40:43], v[172:175], v[160:163], v[40:43]
    v_mfma_f32_16x16x32_bf16 v[44:47], v[172:175], v[164:167], v[44:47]
    v_mfma_f32_16x16x32_bf16 v[48:51], v[176:179], v[152:155], v[48:51]
    v_mfma_f32_16x16x32_bf16 v[52:55], v[176:179], v[156:159], v[52:55]
    v_mfma_f32_16x16x32_bf16 v[56:59], v[176:179], v[160:163], v[56:59]
    v_mfma_f32_16x16x32_bf16 v[60:63], v[176:179], v[164:167], v[60:63]
    v_mfma_f32_16x16x32_bf16 v[64:67], v[180:183], v[152:155], v[64:67]
    v_mfma_f32_16x16x32_bf16 v[68:71], v[180:183], v[156:159], v[68:71]
    v_mfma_f32_16x16x32_bf16 v[72:75], v[180:183], v[160:163], v[72:75]
    s_barrier
    ds_read_b32 v11, v10 offset:53248
    ds_read_b64 v[222:223], v213 offset:49152
    ds_read_b64 v[224:225], v213 offset:49280
    ds_read_b64 v[226:227], v213 offset:49408
    v_mfma_f32_16x16x32_bf16 v[76:79], v[180:183], v[164:167], v[76:79]
    ds_read_b64 v[228:229], v213 offset:49536
    ds_read_b64 v[238:239], v215 offset:50176
    ds_read_b64 v[240:241], v215 offset:50304
    v_mfma_f32_16x16x32_bf16 v[80:83], v[184:187], v[152:155], v[80:83]
    ds_read_b64 v[242:243], v215 offset:50688
    ds_read_b64 v[244:245], v215 offset:50816
    ds_read_b64 v[246:247], v215 offset:51200
    v_mfma_f32_16x16x32_bf16 v[84:87], v[184:187], v[156:159], v[84:87]
    ds_read_b64 v[248:249], v215 offset:51328
    ds_read_b32 v250, v214 offset:49156
    ds_read_b32 v252, v214 offset:49412
    v_mfma_f32_16x16x32_bf16 v[88:91], v[184:187], v[160:163], v[88:91]
    s_waitcnt lgkmcnt(8)
    v_readfirstlane_b32 s100, v11
    v_mov_b32_e64 v230, v223
    v_cndmask_b32 v222, 0, v222, s[86:87]
    v_mov_b32_e64 v232, v225
    v_cndmask_b32 v224, 0, v224, s[86:87]
    v_mfma_f32_16x16x32_bf16 v[92:95], v[184:187], v[164:167], v[92:95]
    v_mov_b32_e64 v234, v227
    v_cndmask_b32 v226, 0, v226, s[86:87]
    v_mov_b32_e64 v236, v229
    v_cndmask_b32 v228, 0, v228, s[86:87]
    v_mov_b32 v223, v222
    v_mov_b32 v225, v224
    v_mfma_f32_16x16x32_bf16 v[96:99], v[188:191], v[152:155], v[96:99]
    v_mov_b32 v227, v226
    v_mov_b32_e64 v229, v228
    s_waitcnt lgkmcnt(0)
    v_mul_f32 v251, 0x3fb8aa3b, v250
    v_mul_f32 v253, 0x3fb8aa3b, v252
    v_mfma_f32_16x16x32_bf16 v[100:103], v[188:191], v[156:159], v[100:103]
    v_mfma_f32_16x16x32_bf16 v[104:107], v[188:191], v[160:163], v[104:107]
    v_mfma_f32_16x16x32_bf16 v[108:111], v[188:191], v[164:167], v[108:111]
    v_mfma_f32_16x16x16_bf16 v[48:51], v[242:243], v[222:223], v[48:51]
    v_mfma_f32_16x16x16_bf16 v[52:55], v[242:243], v[224:225], v[52:55]
    v_mfma_f32_16x16x16_bf16 v[56:59], v[242:243], v[226:227], v[56:59]
    v_mfma_f32_16x16x16_bf16 v[60:63], v[242:243], v[228:229], v[60:63]
    v_mfma_f32_16x16x16_bf16 v[64:67], v[244:245], v[222:223], v[64:67]
    v_mfma_f32_16x16x16_bf16 v[68:71], v[244:245], v[224:225], v[68:71]
    v_mfma_f32_16x16x16_bf16 v[72:75], v[244:245], v[226:227], v[72:75]
    v_mfma_f32_16x16x16_bf16 v[76:79], v[244:245], v[228:229], v[76:79]
    v_mfma_f32_16x16x16_bf16 v[80:83], v[246:247], v[222:223], v[80:83]
    v_mfma_f32_16x16x16_bf16 v[84:87], v[246:247], v[224:225], v[84:87]
    v_mfma_f32_16x16x16_bf16 v[88:91], v[246:247], v[226:227], v[88:91]
    v_mfma_f32_16x16x16_bf16 v[92:95], v[246:247], v[228:229], v[92:95]
    v_mfma_f32_16x16x16_bf16 v[96:99], v[248:249], v[222:223], v[96:99]
    v_cvt_pk_bf16_f32 v112, v48, v49
    v_cvt_pk_bf16_f32 v113, v50, v51
    v_mfma_f32_16x16x16_bf16 v[100:103], v[248:249], v[224:225], v[100:103]
    v_cvt_pk_bf16_f32 v114, v52, v53
    v_cvt_pk_bf16_f32 v115, v54, v55
    v_mfma_f32_16x16x16_bf16 v[104:107], v[248:249], v[226:227], v[104:107]
    v_cvt_pk_bf16_f32 v116, v64, v65
    v_cvt_pk_bf16_f32 v117, v66, v67
    v_mfma_f32_16x16x16_bf16 v[108:111], v[248:249], v[228:229], v[108:111]
    v_cvt_pk_bf16_f32 v118, v68, v69
    v_cvt_pk_bf16_f32 v119, v70, v71
    v_mfma_f32_16x16x16_bf16 v[16:19], v[238:239], v[222:223], v[16:19]
    v_cvt_pk_bf16_f32 v120, v56, v57
    v_cvt_pk_bf16_f32 v121, v58, v59
    v_mfma_f32_16x16x16_bf16 v[20:23], v[238:239], v[224:225], v[20:23]
    v_cvt_pk_bf16_f32 v122, v60, v61
    v_cvt_pk_bf16_f32 v123, v62, v63
    v_mfma_f32_16x16x16_bf16 v[24:27], v[238:239], v[226:227], v[24:27]
    v_cvt_pk_bf16_f32 v124, v72, v73
    v_cvt_pk_bf16_f32 v125, v74, v75
    v_mfma_f32_16x16x16_bf16 v[28:31], v[238:239], v[228:229], v[28:31]
    v_cvt_pk_bf16_f32 v126, v76, v77
    v_cvt_pk_bf16_f32 v127, v78, v79
    v_mfma_f32_16x16x16_bf16 v[32:35], v[240:241], v[222:223], v[32:35]
    v_mfma_f32_16x16x16_bf16 v[36:39], v[240:241], v[224:225], v[36:39]
    v_mfma_f32_16x16x16_bf16 v[40:43], v[240:241], v[226:227], v[40:43]
    v_mfma_f32_16x16x16_bf16 v[44:47], v[240:241], v[228:229], v[44:47]
    v_permlane16_swap_b32 v112, v114
    v_permlane16_swap_b32 v113, v115
    v_permlane16_swap_b32 v116, v118
    v_permlane16_swap_b32 v117, v119
    v_permlane16_swap_b32 v120, v122
    v_permlane16_swap_b32 v121, v123
    v_permlane16_swap_b32 v124, v126
    v_permlane16_swap_b32 v125, v127
    v_xor_b32 v168, 0, v217
    v_xor_b32 v169, 16, v217
    v_xor_b32 v170, 32, v217
    v_xor_b32 v171, 48, v217
    v_xor_b32_e64 v172, 64, v217
    v_xor_b32 v173, 80, v217
    v_xor_b32 v174, 96, v217
    v_xor_b32 v175, 112, v217
    v_xor_b32_e64 v4, 32, v216
    v_mfma_f32_32x32x16_bf16 v[48:63], v[204:207], v[112:115], 0
    v_mul_f32 v80, v80, v230
    v_mul_f32 v81, v81, v230
    v_mul_f32 v82, v82, v230
    v_mul_f32 v83, v83, v230
    v_cvt_pk_bf16_f32 v80, v80, v81
    v_cvt_pk_bf16_f32 v81, v82, v83
    ds_write_b64 v216, v[80:81] offset:32768
    v_mfma_f32_32x32x16_bf16 v[64:79], v[204:207], v[120:123], 0
    v_mul_f32 v96, v96, v230
    v_mul_f32 v97, v97, v230
    v_mul_f32 v98, v98, v230
    v_mul_f32 v99, v99, v230
    v_cvt_pk_bf16_f32 v96, v96, v97
    v_cvt_pk_bf16_f32 v97, v98, v99
    ds_write_b64 v4, v[96:97] offset:32768
    v_mfma_f32_32x32x16_bf16 v[48:63], v[208:211], v[116:119], v[48:63]
    v_mul_f32 v84, v84, v232
    v_mul_f32 v85, v85, v232
    v_mul_f32 v86, v86, v232
    v_mul_f32 v87, v87, v232
    v_cvt_pk_bf16_f32 v84, v84, v85
    v_cvt_pk_bf16_f32 v85, v86, v87
    ds_write_b64 v216, v[84:85] offset:34816
    v_mfma_f32_32x32x16_bf16 v[64:79], v[208:211], v[124:127], v[64:79]
    v_mul_f32 v100, v100, v232
    v_mul_f32 v101, v101, v232
    v_mul_f32 v102, v102, v232
    v_mul_f32 v103, v103, v232
    v_cvt_pk_bf16_f32 v100, v100, v101
    v_cvt_pk_bf16_f32 v101, v102, v103
    ds_write_b64 v4, v[100:101] offset:34816
    v_mul_f32 v88, v88, v234
    v_mul_f32 v89, v89, v234
    v_mul_f32 v90, v90, v234
    v_mul_f32 v91, v91, v234
    v_cvt_pk_bf16_f32 v88, v88, v89
    v_cvt_pk_bf16_f32 v89, v90, v91
    ds_write_b64 v216, v[88:89] offset:36864
    v_mul_f32 v104, v104, v234
    v_mul_f32 v105, v105, v234
    v_mul_f32 v106, v106, v234
    v_mul_f32 v107, v107, v234
    v_cvt_pk_bf16_f32 v104, v104, v105
    v_cvt_pk_bf16_f32 v105, v106, v107
    ds_write_b64 v4, v[104:105] offset:36864
    v_mul_f32 v92, v92, v236
    v_mul_f32 v93, v93, v236
    v_mul_f32 v94, v94, v236
    v_mul_f32 v95, v95, v236
    v_cvt_pk_bf16_f32 v92, v92, v93
    v_cvt_pk_bf16_f32 v93, v94, v95
    ds_write_b64 v216, v[92:93] offset:38912
    v_mul_f32 v108, v108, v236
    v_mul_f32 v109, v109, v236
    v_mul_f32 v110, v110, v236
    v_mul_f32 v111, v111, v236
    v_cvt_pk_bf16_f32 v108, v108, v109
    v_cvt_pk_bf16_f32 v109, v110, v111
    ds_write_b64 v4, v[108:109] offset:38912
    v_max3_f32 v160, v48, v49, v50
    v_min3_f32 v162, v48, v49, v50
    v_max3_f32 v160, v160, v51, v52
    v_min3_f32 v162, v162, v51, v52
    v_max3_f32 v160, v160, v53, v54
    v_min3_f32 v162, v162, v53, v54
    v_max3_f32 v160, v160, v55, v56
    v_min3_f32 v162, v162, v55, v56
    v_max3_f32 v160, v160, v57, v58
    v_min3_f32 v162, v162, v57, v58
    v_max3_f32 v160, v160, v59, v60
    v_min3_f32 v162, v162, v59, v60
    v_max3_f32 v160, v160, v61, v62
    v_min3_f32 v162, v162, v61, v62
    v_max_f32 v160, v160, v63
    v_min_f32 v162, v162, v63
    v_max3_f32 v164, v64, v65, v66
    v_min3_f32 v166, v64, v65, v66
    v_max3_f32 v164, v164, v67, v68
    v_min3_f32 v166, v166, v67, v68
    v_max3_f32 v164, v164, v69, v70
    v_min3_f32 v166, v166, v69, v70
    v_max3_f32 v164, v164, v71, v72
    v_min3_f32 v166, v166, v71, v72
    v_max3_f32 v164, v164, v73, v74
    v_min3_f32 v166, v166, v73, v74
    v_max3_f32 v164, v164, v75, v76
    v_min3_f32 v166, v166, v75, v76
    v_max3_f32 v164, v164, v77, v78
    v_min3_f32 v166, v166, v77, v78
    v_max_f32 v164, v164, v79
    v_min_f32 v166, v166, v79
    v_mov_b32 v161, v160
    v_mov_b32 v163, v162
    v_mov_b32 v165, v164
    v_mov_b32 v167, v166
    v_permlane32_swap_b32 v160, v161
    v_permlane32_swap_b32 v162, v163
    v_permlane32_swap_b32 v164, v165
    v_permlane32_swap_b32 v166, v167
    v_max_f32 v160, v160, v161
    v_min_f32 v162, v162, v163
    v_max_f32 v164, v164, v165
    v_min_f32 v166, v166, v167
    v_mul_f32 v160, v160, v251
    v_mul_f32 v162, v162, v251
    v_mul_f32 v164, v164, v253
    v_mul_f32 v166, v166, v253
    v_pk_fma_f32 v[128:129], v[48:49], v[250:251], v[160:161] op_sel:[0,1,0] op_sel_hi:[1,1,0] neg_lo:[0,0,1] neg_hi:[0,0,1]
    v_pk_fma_f32 v[48:49], v[48:49], v[250:251], v[162:163] op_sel:[0,1,0] op_sel_hi:[1,1,0] neg_lo:[0,1,0] neg_hi:[0,1,0]
    v_pk_fma_f32 v[130:131], v[50:51], v[250:251], v[160:161] op_sel:[0,1,0] op_sel_hi:[1,1,0] neg_lo:[0,0,1] neg_hi:[0,0,1]
    v_pk_fma_f32 v[50:51], v[50:51], v[250:251], v[162:163] op_sel:[0,1,0] op_sel_hi:[1,1,0] neg_lo:[0,1,0] neg_hi:[0,1,0]
    v_pk_fma_f32 v[132:133], v[52:53], v[250:251], v[160:161] op_sel:[0,1,0] op_sel_hi:[1,1,0] neg_lo:[0,0,1] neg_hi:[0,0,1]
    v_pk_fma_f32 v[52:53], v[52:53], v[250:251], v[162:163] op_sel:[0,1,0] op_sel_hi:[1,1,0] neg_lo:[0,1,0] neg_hi:[0,1,0]
    v_pk_fma_f32 v[134:135], v[54:55], v[250:251], v[160:161] op_sel:[0,1,0] op_sel_hi:[1,1,0] neg_lo:[0,0,1] neg_hi:[0,0,1]
    v_pk_fma_f32 v[54:55], v[54:55], v[250:251], v[162:163] op_sel:[0,1,0] op_sel_hi:[1,1,0] neg_lo:[0,1,0] neg_hi:[0,1,0]
    v_pk_fma_f32 v[136:137], v[56:57], v[250:251], v[160:161] op_sel:[0,1,0] op_sel_hi:[1,1,0] neg_lo:[0,0,1] neg_hi:[0,0,1]
    v_pk_fma_f32 v[56:57], v[56:57], v[250:251], v[162:163] op_sel:[0,1,0] op_sel_hi:[1,1,0] neg_lo:[0,1,0] neg_hi:[0,1,0]
    v_pk_fma_f32 v[138:139], v[58:59], v[250:251], v[160:161] op_sel:[0,1,0] op_sel_hi:[1,1,0] neg_lo:[0,0,1] neg_hi:[0,0,1]
    v_pk_fma_f32 v[58:59], v[58:59], v[250:251], v[162:163] op_sel:[0,1,0] op_sel_hi:[1,1,0] neg_lo:[0,1,0] neg_hi:[0,1,0]
    v_pk_fma_f32 v[140:141], v[60:61], v[250:251], v[160:161] op_sel:[0,1,0] op_sel_hi:[1,1,0] neg_lo:[0,0,1] neg_hi:[0,0,1]
    v_pk_fma_f32 v[60:61], v[60:61], v[250:251], v[162:163] op_sel:[0,1,0] op_sel_hi:[1,1,0] neg_lo:[0,1,0] neg_hi:[0,1,0]
    v_pk_fma_f32 v[142:143], v[62:63], v[250:251], v[160:161] op_sel:[0,1,0] op_sel_hi:[1,1,0] neg_lo:[0,0,1] neg_hi:[0,0,1]
    v_pk_fma_f32 v[62:63], v[62:63], v[250:251], v[162:163] op_sel:[0,1,0] op_sel_hi:[1,1,0] neg_lo:[0,1,0] neg_hi:[0,1,0]
    v_exp_f32 v128, v128
    v_exp_f32 v48, v48
    v_exp_f32 v129, v129
    v_exp_f32 v49, v49
    v_exp_f32 v130, v130
    v_exp_f32 v50, v50
    v_exp_f32 v131, v131
    v_exp_f32 v51, v51
    v_exp_f32 v132, v132
    v_exp_f32 v52, v52
    v_exp_f32 v133, v133
    v_exp_f32 v53, v53
    v_exp_f32 v134, v134
    v_exp_f32 v54, v54
    v_exp_f32 v135, v135
    v_exp_f32 v55, v55
    v_exp_f32 v136, v136
    v_exp_f32 v56, v56
    v_exp_f32 v137, v137
    v_exp_f32 v57, v57
    v_exp_f32 v138, v138
    v_exp_f32 v58, v58
    v_exp_f32 v139, v139
    v_exp_f32 v59, v59
    v_exp_f32 v140, v140
    v_exp_f32 v60, v60
    v_exp_f32 v141, v141
    v_exp_f32 v61, v61
    v_exp_f32 v142, v142
    v_exp_f32 v62, v62
    v_exp_f32 v143, v143
    v_exp_f32 v63, v63
    v_pk_fma_f32 v[144:145], v[64:65], v[252:253], v[164:165] op_sel:[0,1,0] op_sel_hi:[1,1,0] neg_lo:[0,0,1] neg_hi:[0,0,1]
    v_pk_fma_f32 v[64:65], v[64:65], v[252:253], v[166:167] op_sel:[0,1,0] op_sel_hi:[1,1,0] neg_lo:[0,1,0] neg_hi:[0,1,0]
    v_pk_fma_f32 v[146:147], v[66:67], v[252:253], v[164:165] op_sel:[0,1,0] op_sel_hi:[1,1,0] neg_lo:[0,0,1] neg_hi:[0,0,1]
    v_pk_fma_f32 v[66:67], v[66:67], v[252:253], v[166:167] op_sel:[0,1,0] op_sel_hi:[1,1,0] neg_lo:[0,1,0] neg_hi:[0,1,0]
    v_pk_fma_f32 v[148:149], v[68:69], v[252:253], v[164:165] op_sel:[0,1,0] op_sel_hi:[1,1,0] neg_lo:[0,0,1] neg_hi:[0,0,1]
    v_pk_fma_f32 v[68:69], v[68:69], v[252:253], v[166:167] op_sel:[0,1,0] op_sel_hi:[1,1,0] neg_lo:[0,1,0] neg_hi:[0,1,0]
    v_pk_fma_f32 v[150:151], v[70:71], v[252:253], v[164:165] op_sel:[0,1,0] op_sel_hi:[1,1,0] neg_lo:[0,0,1] neg_hi:[0,0,1]
    v_pk_fma_f32 v[70:71], v[70:71], v[252:253], v[166:167] op_sel:[0,1,0] op_sel_hi:[1,1,0] neg_lo:[0,1,0] neg_hi:[0,1,0]
    v_pk_fma_f32 v[152:153], v[72:73], v[252:253], v[164:165] op_sel:[0,1,0] op_sel_hi:[1,1,0] neg_lo:[0,0,1] neg_hi:[0,0,1]
    v_pk_fma_f32 v[72:73], v[72:73], v[252:253], v[166:167] op_sel:[0,1,0] op_sel_hi:[1,1,0] neg_lo:[0,1,0] neg_hi:[0,1,0]
    v_pk_fma_f32 v[154:155], v[74:75], v[252:253], v[164:165] op_sel:[0,1,0] op_sel_hi:[1,1,0] neg_lo:[0,0,1] neg_hi:[0,0,1]
    v_pk_fma_f32 v[74:75], v[74:75], v[252:253], v[166:167] op_sel:[0,1,0] op_sel_hi:[1,1,0] neg_lo:[0,1,0] neg_hi:[0,1,0]
    v_pk_fma_f32 v[156:157], v[76:77], v[252:253], v[164:165] op_sel:[0,1,0] op_sel_hi:[1,1,0] neg_lo:[0,0,1] neg_hi:[0,0,1]
    v_pk_fma_f32 v[76:77], v[76:77], v[252:253], v[166:167] op_sel:[0,1,0] op_sel_hi:[1,1,0] neg_lo:[0,1,0] neg_hi:[0,1,0]
    v_pk_fma_f32 v[158:159], v[78:79], v[252:253], v[164:165] op_sel:[0,1,0] op_sel_hi:[1,1,0] neg_lo:[0,0,1] neg_hi:[0,0,1]
    v_pk_fma_f32 v[78:79], v[78:79], v[252:253], v[166:167] op_sel:[0,1,0] op_sel_hi:[1,1,0] neg_lo:[0,1,0] neg_hi:[0,1,0]
    v_exp_f32 v144, v144
    v_exp_f32 v64, v64
    v_exp_f32 v145, v145
    v_exp_f32 v65, v65
    v_exp_f32 v146, v146
    v_exp_f32 v66, v66
    v_exp_f32 v147, v147
    v_exp_f32 v67, v67
    v_exp_f32 v148, v148
    v_exp_f32 v68, v68
    v_exp_f32 v149, v149
    v_exp_f32 v69, v69
    v_exp_f32 v150, v150
    v_exp_f32 v70, v70
    v_exp_f32 v151, v151
    v_exp_f32 v71, v71
    v_exp_f32 v152, v152
    v_exp_f32 v72, v72
    v_exp_f32 v153, v153
    v_exp_f32 v73, v73
    v_exp_f32 v154, v154
    v_exp_f32 v74, v74
    v_exp_f32 v155, v155
    v_exp_f32 v75, v75
    v_exp_f32 v156, v156
    v_exp_f32 v76, v76
    v_exp_f32 v157, v157
    v_exp_f32 v77, v77
    v_exp_f32 v158, v158
    v_exp_f32 v78, v78
    v_exp_f32 v159, v159
    v_exp_f32 v79, v79
    v_pk_add_f32 v[176:177], v[128:129], v[130:131]
    v_pk_add_f32 v[176:177], v[176:177], v[132:133]
    v_pk_add_f32 v[176:177], v[176:177], v[134:135]
    v_pk_add_f32 v[176:177], v[176:177], v[136:137]
    v_pk_add_f32 v[176:177], v[176:177], v[138:139]
    v_pk_add_f32 v[176:177], v[176:177], v[140:141]
    v_pk_add_f32 v[176:177], v[176:177], v[142:143]
    v_pk_add_f32 v[178:179], v[48:49], v[50:51]
    v_pk_add_f32 v[178:179], v[178:179], v[52:53]
    v_pk_add_f32 v[178:179], v[178:179], v[54:55]
    v_pk_add_f32 v[178:179], v[178:179], v[56:57]
    v_pk_add_f32 v[178:179], v[178:179], v[58:59]
    v_pk_add_f32 v[178:179], v[178:179], v[60:61]
    v_pk_add_f32 v[178:179], v[178:179], v[62:63]
    v_pk_add_f32 v[180:181], v[144:145], v[146:147]
    v_pk_add_f32 v[180:181], v[180:181], v[148:149]
    v_pk_add_f32 v[180:181], v[180:181], v[150:151]
    v_pk_add_f32 v[180:181], v[180:181], v[152:153]
    v_pk_add_f32 v[180:181], v[180:181], v[154:155]
    v_pk_add_f32 v[180:181], v[180:181], v[156:157]
    v_pk_add_f32 v[180:181], v[180:181], v[158:159]
    v_pk_add_f32 v[182:183], v[64:65], v[66:67]
    v_pk_add_f32 v[182:183], v[182:183], v[68:69]
    v_pk_add_f32 v[182:183], v[182:183], v[70:71]
    v_pk_add_f32 v[182:183], v[182:183], v[72:73]
    v_pk_add_f32 v[182:183], v[182:183], v[74:75]
    v_pk_add_f32 v[182:183], v[182:183], v[76:77]
    v_pk_add_f32 v[182:183], v[182:183], v[78:79]
    v_add_f32 v176, v176, v177
    v_add_f32 v178, v178, v179
    v_add_f32 v180, v180, v181
    v_add_f32 v182, v182, v183
    v_mov_b32 v177, v176
    v_mov_b32 v179, v178
    v_mov_b32 v181, v180
    v_mov_b32 v183, v182
    v_permlane32_swap_b32 v176, v177
    v_permlane32_swap_b32 v178, v179
    v_permlane32_swap_b32 v180, v181
    v_permlane32_swap_b32 v182, v183
    v_add_f32 v176, v176, v177
    v_add_f32 v178, v178, v179
    v_add_f32 v180, v180, v181
    v_add_f32 v182, v182, v183
    v_rcp_f32 v176, v176
    v_rcp_f32 v178, v178
    v_rcp_f32 v180, v180
    v_rcp_f32 v182, v182
    v_pk_mul_f32 v[128:129], v[128:129], v[176:177] op_sel_hi:[1,0]
    v_pk_mul_f32 v[130:131], v[130:131], v[176:177] op_sel_hi:[1,0]
    v_pk_mul_f32 v[132:133], v[132:133], v[176:177] op_sel_hi:[1,0]
    v_pk_mul_f32 v[134:135], v[134:135], v[176:177] op_sel_hi:[1,0]
    v_pk_mul_f32 v[136:137], v[136:137], v[176:177] op_sel_hi:[1,0]
    v_pk_mul_f32 v[138:139], v[138:139], v[176:177] op_sel_hi:[1,0]
    v_pk_mul_f32 v[140:141], v[140:141], v[176:177] op_sel_hi:[1,0]
    v_pk_mul_f32 v[142:143], v[142:143], v[176:177] op_sel_hi:[1,0]
    v_cvt_pk_bf16_f32 v128, v128, v129
    v_cvt_pk_bf16_f32 v129, v130, v131
    ds_write_b64 v168, v[128:129] offset:0
    v_cvt_pk_bf16_f32 v130, v132, v133
    v_cvt_pk_bf16_f32 v131, v134, v135
    ds_write_b64 v169, v[130:131] offset:0
    v_cvt_pk_bf16_f32 v132, v136, v137
    v_cvt_pk_bf16_f32 v133, v138, v139
    ds_write_b64 v170, v[132:133] offset:0
    v_cvt_pk_bf16_f32 v134, v140, v141
    v_cvt_pk_bf16_f32 v135, v142, v143
    ds_write_b64 v171, v[134:135] offset:0
    v_pk_mul_f32 v[48:49], v[48:49], v[178:179] op_sel_hi:[1,0]
    v_pk_mul_f32 v[50:51], v[50:51], v[178:179] op_sel_hi:[1,0]
    v_pk_mul_f32 v[52:53], v[52:53], v[178:179] op_sel_hi:[1,0]
    v_pk_mul_f32 v[54:55], v[54:55], v[178:179] op_sel_hi:[1,0]
    v_pk_mul_f32 v[56:57], v[56:57], v[178:179] op_sel_hi:[1,0]
    v_pk_mul_f32 v[58:59], v[58:59], v[178:179] op_sel_hi:[1,0]
    v_pk_mul_f32 v[60:61], v[60:61], v[178:179] op_sel_hi:[1,0]
    v_pk_mul_f32 v[62:63], v[62:63], v[178:179] op_sel_hi:[1,0]
    v_cvt_pk_bf16_f32 v48, v48, v49
    v_cvt_pk_bf16_f32 v49, v50, v51
    ds_write_b64 v172, v[48:49] offset:0
    v_cvt_pk_bf16_f32 v50, v52, v53
    v_cvt_pk_bf16_f32 v51, v54, v55
    ds_write_b64 v173, v[50:51] offset:0
    v_cvt_pk_bf16_f32 v52, v56, v57
    v_cvt_pk_bf16_f32 v53, v58, v59
    ds_write_b64 v174, v[52:53] offset:0
    v_cvt_pk_bf16_f32 v54, v60, v61
    v_cvt_pk_bf16_f32 v55, v62, v63
    ds_write_b64 v175, v[54:55] offset:0
    v_pk_mul_f32 v[144:145], v[144:145], v[180:181] op_sel_hi:[1,0]
    v_pk_mul_f32 v[146:147], v[146:147], v[180:181] op_sel_hi:[1,0]
    v_pk_mul_f32 v[148:149], v[148:149], v[180:181] op_sel_hi:[1,0]
    v_pk_mul_f32 v[150:151], v[150:151], v[180:181] op_sel_hi:[1,0]
    v_pk_mul_f32 v[152:153], v[152:153], v[180:181] op_sel_hi:[1,0]
    v_pk_mul_f32 v[154:155], v[154:155], v[180:181] op_sel_hi:[1,0]
    v_pk_mul_f32 v[156:157], v[156:157], v[180:181] op_sel_hi:[1,0]
    v_pk_mul_f32 v[158:159], v[158:159], v[180:181] op_sel_hi:[1,0]
    v_cvt_pk_bf16_f32 v144, v144, v145
    v_cvt_pk_bf16_f32 v145, v146, v147
    ds_write_b64 v168, v[144:145] offset:4096
    v_cvt_pk_bf16_f32 v146, v148, v149
    v_cvt_pk_bf16_f32 v147, v150, v151
    ds_write_b64 v169, v[146:147] offset:4096
    v_cvt_pk_bf16_f32 v148, v152, v153
    v_cvt_pk_bf16_f32 v149, v154, v155
    ds_write_b64 v170, v[148:149] offset:4096
    v_cvt_pk_bf16_f32 v150, v156, v157
    v_cvt_pk_bf16_f32 v151, v158, v159
    ds_write_b64 v171, v[150:151] offset:4096
    v_pk_mul_f32 v[64:65], v[64:65], v[182:183] op_sel_hi:[1,0]
    v_pk_mul_f32 v[66:67], v[66:67], v[182:183] op_sel_hi:[1,0]
    v_pk_mul_f32 v[68:69], v[68:69], v[182:183] op_sel_hi:[1,0]
    v_pk_mul_f32 v[70:71], v[70:71], v[182:183] op_sel_hi:[1,0]
    v_pk_mul_f32 v[72:73], v[72:73], v[182:183] op_sel_hi:[1,0]
    v_pk_mul_f32 v[74:75], v[74:75], v[182:183] op_sel_hi:[1,0]
    v_pk_mul_f32 v[76:77], v[76:77], v[182:183] op_sel_hi:[1,0]
    v_pk_mul_f32 v[78:79], v[78:79], v[182:183] op_sel_hi:[1,0]
    v_cvt_pk_bf16_f32 v64, v64, v65
    v_cvt_pk_bf16_f32 v65, v66, v67
    ds_write_b64 v172, v[64:65] offset:4096
    v_cvt_pk_bf16_f32 v66, v68, v69
    v_cvt_pk_bf16_f32 v67, v70, v71
    ds_write_b64 v173, v[66:67] offset:4096
    v_cvt_pk_bf16_f32 v68, v72, v73
    v_cvt_pk_bf16_f32 v69, v74, v75
    ds_write_b64 v174, v[68:69] offset:4096
    v_cvt_pk_bf16_f32 v70, v76, v77
    v_cvt_pk_bf16_f32 v71, v78, v79
    ds_write_b64 v175, v[70:71] offset:4096
    s_waitcnt lgkmcnt(0)
    s_barrier
    ds_read_b64_tr_b16 v[112:113], v218 offset:0
    ds_read_b64_tr_b16 v[114:115], v219 offset:0
    ds_read_b64_tr_b16 v[144:145], v220 offset:32768
    ds_read_b64_tr_b16 v[146:147], v221 offset:32768
    ds_read_b64_tr_b16 v[116:117], v218 offset:2048
    ds_read_b64_tr_b16 v[118:119], v219 offset:2048
    ds_read_b64_tr_b16 v[148:149], v220 offset:34816
    ds_read_b64_tr_b16 v[150:151], v221 offset:34816
    ds_read_b64_tr_b16 v[120:121], v218 offset:4096
    ds_read_b64_tr_b16 v[122:123], v219 offset:4096
    ds_read_b64_tr_b16 v[152:153], v220 offset:36864
    ds_read_b64_tr_b16 v[154:155], v221 offset:36864
    v_cvt_pk_bf16_f32 v176, v16, v17
    v_cvt_pk_bf16_f32 v177, v18, v19
    v_cvt_pk_bf16_f32 v178, v20, v21
    v_cvt_pk_bf16_f32 v179, v22, v23
    v_cvt_pk_bf16_f32 v180, v32, v33
    v_cvt_pk_bf16_f32 v181, v34, v35
    v_cvt_pk_bf16_f32 v182, v36, v37
    v_cvt_pk_bf16_f32 v183, v38, v39
    v_cvt_pk_bf16_f32 v184, v24, v25
    v_cvt_pk_bf16_f32 v185, v26, v27
    v_cvt_pk_bf16_f32 v186, v28, v29
    v_cvt_pk_bf16_f32 v187, v30, v31
    v_cvt_pk_bf16_f32 v188, v40, v41
    v_cvt_pk_bf16_f32 v189, v42, v43
    v_cvt_pk_bf16_f32 v190, v44, v45
    v_cvt_pk_bf16_f32 v191, v46, v47
    s_waitcnt lgkmcnt(8)
    v_mfma_f32_32x32x16_bf16 v[48:63], v[112:115], v[144:147], 0
    ds_read_b64_tr_b16 v[124:125], v218 offset:6144
    ds_read_b64_tr_b16 v[126:127], v219 offset:6144
    ds_read_b64_tr_b16 v[156:157], v220 offset:38912
    ds_read_b64_tr_b16 v[158:159], v221 offset:38912
    s_waitcnt lgkmcnt(8)
    v_mfma_f32_32x32x16_bf16 v[48:63], v[116:119], v[148:151], v[48:63]
    ds_read_b64_tr_b16 v[128:129], v218 offset:8192
    ds_read_b64_tr_b16 v[130:131], v219 offset:8192
    ds_read_b64_tr_b16 v[160:161], v220 offset:40960
    ds_read_b64_tr_b16 v[162:163], v221 offset:40960
    s_waitcnt lgkmcnt(8)
    v_mfma_f32_32x32x16_bf16 v[48:63], v[120:123], v[152:155], v[48:63]
    ds_read_b64_tr_b16 v[132:133], v218 offset:10240
    ds_read_b64_tr_b16 v[134:135], v219 offset:10240
    ds_read_b64_tr_b16 v[164:165], v220 offset:43008
    ds_read_b64_tr_b16 v[166:167], v221 offset:43008
    s_waitcnt lgkmcnt(8)
    v_mfma_f32_32x32x16_bf16 v[48:63], v[124:127], v[156:159], v[48:63]
    ds_read_b64_tr_b16 v[136:137], v218 offset:12288
    ds_read_b64_tr_b16 v[138:139], v219 offset:12288
    ds_read_b64_tr_b16 v[168:169], v220 offset:45056
    ds_read_b64_tr_b16 v[170:171], v221 offset:45056
    s_waitcnt lgkmcnt(8)
    v_mfma_f32_32x32x16_bf16 v[48:63], v[128:131], v[160:163], v[48:63]
    ds_read_b64_tr_b16 v[140:141], v218 offset:14336
    ds_read_b64_tr_b16 v[142:143], v219 offset:14336
    ds_read_b64_tr_b16 v[172:173], v220 offset:47104
    ds_read_b64_tr_b16 v[174:175], v221 offset:47104
    s_waitcnt lgkmcnt(8)
    v_mfma_f32_32x32x16_bf16 v[48:63], v[132:135], v[164:167], v[48:63]
    v_permlane16_swap_b32 v176, v178
    v_permlane16_swap_b32_e64 v177, v179
    s_waitcnt lgkmcnt(4)
    v_mfma_f32_32x32x16_bf16 v[48:63], v[136:139], v[168:171], v[48:63]
    v_permlane16_swap_b32 v180, v182
    v_permlane16_swap_b32 v181, v183
    v_permlane16_swap_b32 v184, v186
    s_waitcnt lgkmcnt(0)
    v_mfma_f32_32x32x16_bf16 v[48:63], v[140:143], v[172:175], v[48:63]
    s_barrier
    v_permlane16_swap_b32 v185, v187
    v_permlane16_swap_b32 v188, v190
    v_permlane16_swap_b32 v189, v191
    s_lshl_b32 s76, s62, 11
    s_add_u32 s76, s76, s73
    v_mfma_f32_32x32x16_bf16 v[16:31], v[204:207], v[176:179], 0
    s_add_u32 s76, s76, 4096
    s_lshl_b32 s77, s62, 7
    s_add_u32 s77, s77, s73
    v_lshlrev_b32_e64 v4, 2, v2
    v_mfma_f32_32x32x16_bf16 v[32:47], v[204:207], v[184:187], 0
    v_cvt_pk_bf16_f32 v64, v48, v49
    v_cvt_pk_bf16_f32 v65, v50, v51
    v_cvt_pk_bf16_f32 v66, v52, v53
    v_cvt_pk_bf16_f32 v67, v54, v55
    v_cvt_pk_bf16_f32 v68, v56, v57
    v_mfma_f32_32x32x16_bf16 v[16:31], v[208:211], v[180:183], v[16:31]
    v_cvt_pk_bf16_f32 v69, v58, v59
    v_cvt_pk_bf16_f32 v70, v60, v61
    v_cvt_pk_bf16_f32 v71, v62, v63
    s_bitcmp1_b32 s100, 0
    s_cbranch_scc1 L_loc_48
    buffer_store_dwordx4 v[64:67], v12, s[40:43], s76 offen offset:0 sc1
    buffer_store_dwordx4 v[68:71], v12, s[40:43], s76 offen offset:1024 sc1
    s_branch L_pubd_49
L_loc_48:
    buffer_store_dwordx4 v[64:67], v12, s[40:43], s76 offen offset:0
    buffer_store_dwordx4 v[68:71], v12, s[40:43], s76 offen offset:1024
L_pubd_49:
    v_mfma_f32_32x32x16_bf16 v[32:47], v[208:211], v[188:191], v[32:47]
    v_and_b32 v216, 1, v1
    v_lshlrev_b32_e64 v216, 8, v216
    v_lshl_add_u32 v216, v3, 4, v216
    s_lshl_b32 s76, s64, 7
    v_add_u32 v216, s76, v216
    s_mul_i32 s78, s61, 28800
    s_lshl_b32 s79, s64, 8
    s_add_u32 s78, s78, s79
    s_add_u32 s79, s78, 3686400
    v_dot2_f32_bf16 v72, v112, s89, 0
    v_dot2_f32_bf16 v73, v113, s89, 0
    v_dot2_f32_bf16 v72, v114, s89, v72
    v_dot2_f32_bf16 v73, v115, s89, v73
    v_dot2_f32_bf16 v72, v116, s89, v72
    v_dot2_f32_bf16 v73, v117, s89, v73
    v_dot2_f32_bf16 v72, v118, s89, v72
    v_dot2_f32_bf16 v73, v119, s89, v73
    v_dot2_f32_bf16 v72, v120, s89, v72
    v_dot2_f32_bf16 v73, v121, s89, v73
    v_dot2_f32_bf16 v72, v122, s89, v72
    v_dot2_f32_bf16 v73, v123, s89, v73
    v_dot2_f32_bf16 v72, v124, s89, v72
    v_dot2_f32_bf16 v73, v125, s89, v73
    v_dot2_f32_bf16 v72, v126, s89, v72
    v_dot2_f32_bf16 v73, v127, s89, v73
    v_dot2_f32_bf16 v72, v128, s89, v72
    v_dot2_f32_bf16 v73, v129, s89, v73
    v_dot2_f32_bf16 v72, v130, s89, v72
    v_dot2_f32_bf16 v73, v131, s89, v73
    v_dot2_f32_bf16 v72, v132, s89, v72
    v_dot2_f32_bf16 v73, v133, s89, v73
    v_dot2_f32_bf16 v72, v134, s89, v72
    v_dot2_f32_bf16 v73, v135, s89, v73
    v_dot2_f32_bf16 v72, v136, s89, v72
    v_dot2_f32_bf16 v73, v137, s89, v73
    v_dot2_f32_bf16 v72, v138, s89, v72
    v_dot2_f32_bf16 v73, v139, s89, v73
    v_dot2_f32_bf16 v72, v140, s89, v72
    v_dot2_f32_bf16 v73, v141, s89, v73
    v_dot2_f32_bf16 v72, v142, s89, v72
    v_dot2_f32_bf16 v73, v143, s89, v73
    s_lshl_b32 s76, s98, 7
    v_lshl_add_u32 v10, v3, 3, s76
    v_lshlrev_b32 v11, 5, v1
    v_add_f32 v72, v72, v73
    v_mov_b32 v73, v72
    s_nop 1
    v_permlane32_swap_b32 v72, v73
    v_add_f32 v72, v72, v73
    s_mov_b32 exec_hi, 0
    s_bitcmp1_b32 s100, 0
    s_cbranch_scc1 L_loc_50
    buffer_store_dword v72, v4, s[40:43], s77 offen offset:2048 sc1
    s_branch L_pubd_51
L_loc_50:
    buffer_store_dword v72, v4, s[40:43], s77 offen offset:2048
L_pubd_51:
    s_mov_b64 exec, -1
    v_max3_f32 v160, v16, v17, v18
    v_min3_f32 v162, v16, v17, v18
    v_max3_f32 v160, v160, v19, v20
    v_min3_f32 v162, v162, v19, v20
    v_max3_f32 v160, v160, v21, v22
    v_min3_f32 v162, v162, v21, v22
    v_max3_f32 v160, v160, v23, v24
    v_min3_f32 v162, v162, v23, v24
    v_max3_f32 v160, v160, v25, v26
    v_min3_f32 v162, v162, v25, v26
    v_max3_f32 v160, v160, v27, v28
    v_min3_f32 v162, v162, v27, v28
    v_max3_f32 v160, v160, v29, v30
    v_min3_f32 v162, v162, v29, v30
    v_max_f32 v160, v160, v31
    v_min_f32 v162, v162, v31
    v_max3_f32 v164, v32, v33, v34
    v_min3_f32 v166, v32, v33, v34
    v_max3_f32 v164, v164, v35, v36
    v_min3_f32 v166, v166, v35, v36
    v_max3_f32 v164, v164, v37, v38
    v_min3_f32 v166, v166, v37, v38
    v_max3_f32 v164, v164, v39, v40
    v_min3_f32 v166, v166, v39, v40
    v_max3_f32 v164, v164, v41, v42
    v_min3_f32 v166, v166, v41, v42
    v_max3_f32 v164, v164, v43, v44
    v_min3_f32 v166, v166, v43, v44
    v_max3_f32 v164, v164, v45, v46
    v_min3_f32 v166, v166, v45, v46
    v_max_f32 v164, v164, v47
    v_min_f32 v166, v166, v47
    v_mov_b32 v161, v160
    v_mov_b32 v163, v162
    v_mov_b32 v165, v164
    v_mov_b32 v167, v166
    v_permlane32_swap_b32 v160, v161
    v_permlane32_swap_b32 v162, v163
    v_permlane32_swap_b32 v164, v165
    v_permlane32_swap_b32 v166, v167
    v_max_f32 v160, v160, v161
    v_min_f32 v162, v162, v163
    v_max_f32 v164, v164, v165
    v_min_f32 v166, v166, v167
    v_mul_f32 v160, v160, v251
    v_mul_f32 v162, v162, v251
    v_mul_f32 v164, v164, v253
    v_mul_f32 v166, v166, v253
    v_pk_fma_f32 v[128:129], v[16:17], v[250:251], v[160:161] op_sel:[0,1,0] op_sel_hi:[1,1,0] neg_lo:[0,0,1] neg_hi:[0,0,1]
    v_pk_fma_f32 v[16:17], v[16:17], v[250:251], v[162:163] op_sel:[0,1,0] op_sel_hi:[1,1,0] neg_lo:[0,1,0] neg_hi:[0,1,0]
    v_pk_fma_f32 v[130:131], v[18:19], v[250:251], v[160:161] op_sel:[0,1,0] op_sel_hi:[1,1,0] neg_lo:[0,0,1] neg_hi:[0,0,1]
    v_pk_fma_f32 v[18:19], v[18:19], v[250:251], v[162:163] op_sel:[0,1,0] op_sel_hi:[1,1,0] neg_lo:[0,1,0] neg_hi:[0,1,0]
    v_pk_fma_f32 v[132:133], v[20:21], v[250:251], v[160:161] op_sel:[0,1,0] op_sel_hi:[1,1,0] neg_lo:[0,0,1] neg_hi:[0,0,1]
    v_pk_fma_f32 v[20:21], v[20:21], v[250:251], v[162:163] op_sel:[0,1,0] op_sel_hi:[1,1,0] neg_lo:[0,1,0] neg_hi:[0,1,0]
    v_pk_fma_f32 v[134:135], v[22:23], v[250:251], v[160:161] op_sel:[0,1,0] op_sel_hi:[1,1,0] neg_lo:[0,0,1] neg_hi:[0,0,1]
    v_pk_fma_f32 v[22:23], v[22:23], v[250:251], v[162:163] op_sel:[0,1,0] op_sel_hi:[1,1,0] neg_lo:[0,1,0] neg_hi:[0,1,0]
    v_pk_fma_f32 v[136:137], v[24:25], v[250:251], v[160:161] op_sel:[0,1,0] op_sel_hi:[1,1,0] neg_lo:[0,0,1] neg_hi:[0,0,1]
    v_pk_fma_f32 v[24:25], v[24:25], v[250:251], v[162:163] op_sel:[0,1,0] op_sel_hi:[1,1,0] neg_lo:[0,1,0] neg_hi:[0,1,0]
    v_pk_fma_f32 v[138:139], v[26:27], v[250:251], v[160:161] op_sel:[0,1,0] op_sel_hi:[1,1,0] neg_lo:[0,0,1] neg_hi:[0,0,1]
    v_pk_fma_f32 v[26:27], v[26:27], v[250:251], v[162:163] op_sel:[0,1,0] op_sel_hi:[1,1,0] neg_lo:[0,1,0] neg_hi:[0,1,0]
    v_pk_fma_f32 v[140:141], v[28:29], v[250:251], v[160:161] op_sel:[0,1,0] op_sel_hi:[1,1,0] neg_lo:[0,0,1] neg_hi:[0,0,1]
    v_pk_fma_f32 v[28:29], v[28:29], v[250:251], v[162:163] op_sel:[0,1,0] op_sel_hi:[1,1,0] neg_lo:[0,1,0] neg_hi:[0,1,0]
    v_pk_fma_f32 v[142:143], v[30:31], v[250:251], v[160:161] op_sel:[0,1,0] op_sel_hi:[1,1,0] neg_lo:[0,0,1] neg_hi:[0,0,1]
    v_pk_fma_f32 v[30:31], v[30:31], v[250:251], v[162:163] op_sel:[0,1,0] op_sel_hi:[1,1,0] neg_lo:[0,1,0] neg_hi:[0,1,0]
    v_pk_fma_f32 v[144:145], v[32:33], v[252:253], v[164:165] op_sel:[0,1,0] op_sel_hi:[1,1,0] neg_lo:[0,0,1] neg_hi:[0,0,1]
    v_pk_fma_f32 v[32:33], v[32:33], v[252:253], v[166:167] op_sel:[0,1,0] op_sel_hi:[1,1,0] neg_lo:[0,1,0] neg_hi:[0,1,0]
    v_pk_fma_f32 v[146:147], v[34:35], v[252:253], v[164:165] op_sel:[0,1,0] op_sel_hi:[1,1,0] neg_lo:[0,0,1] neg_hi:[0,0,1]
    v_pk_fma_f32 v[34:35], v[34:35], v[252:253], v[166:167] op_sel:[0,1,0] op_sel_hi:[1,1,0] neg_lo:[0,1,0] neg_hi:[0,1,0]
    v_pk_fma_f32 v[148:149], v[36:37], v[252:253], v[164:165] op_sel:[0,1,0] op_sel_hi:[1,1,0] neg_lo:[0,0,1] neg_hi:[0,0,1]
    v_pk_fma_f32 v[36:37], v[36:37], v[252:253], v[166:167] op_sel:[0,1,0] op_sel_hi:[1,1,0] neg_lo:[0,1,0] neg_hi:[0,1,0]
    v_pk_fma_f32 v[150:151], v[38:39], v[252:253], v[164:165] op_sel:[0,1,0] op_sel_hi:[1,1,0] neg_lo:[0,0,1] neg_hi:[0,0,1]
    v_pk_fma_f32 v[38:39], v[38:39], v[252:253], v[166:167] op_sel:[0,1,0] op_sel_hi:[1,1,0] neg_lo:[0,1,0] neg_hi:[0,1,0]
    v_pk_fma_f32 v[152:153], v[40:41], v[252:253], v[164:165] op_sel:[0,1,0] op_sel_hi:[1,1,0] neg_lo:[0,0,1] neg_hi:[0,0,1]
    v_pk_fma_f32 v[40:41], v[40:41], v[252:253], v[166:167] op_sel:[0,1,0] op_sel_hi:[1,1,0] neg_lo:[0,1,0] neg_hi:[0,1,0]
    v_pk_fma_f32 v[154:155], v[42:43], v[252:253], v[164:165] op_sel:[0,1,0] op_sel_hi:[1,1,0] neg_lo:[0,0,1] neg_hi:[0,0,1]
    v_pk_fma_f32 v[42:43], v[42:43], v[252:253], v[166:167] op_sel:[0,1,0] op_sel_hi:[1,1,0] neg_lo:[0,1,0] neg_hi:[0,1,0]
    v_pk_fma_f32 v[156:157], v[44:45], v[252:253], v[164:165] op_sel:[0,1,0] op_sel_hi:[1,1,0] neg_lo:[0,0,1] neg_hi:[0,0,1]
    v_pk_fma_f32 v[44:45], v[44:45], v[252:253], v[166:167] op_sel:[0,1,0] op_sel_hi:[1,1,0] neg_lo:[0,1,0] neg_hi:[0,1,0]
    v_pk_fma_f32 v[158:159], v[46:47], v[252:253], v[164:165] op_sel:[0,1,0] op_sel_hi:[1,1,0] neg_lo:[0,0,1] neg_hi:[0,0,1]
    v_pk_fma_f32 v[46:47], v[46:47], v[252:253], v[166:167] op_sel:[0,1,0] op_sel_hi:[1,1,0] neg_lo:[0,1,0] neg_hi:[0,1,0]
    v_exp_f32 v128, v128
    v_exp_f32 v16, v16
    v_exp_f32 v129, v129
    v_exp_f32 v17, v17
    v_exp_f32 v130, v130
    v_exp_f32 v18, v18
    v_exp_f32 v131, v131
    v_exp_f32 v19, v19
    v_exp_f32 v132, v132
    v_exp_f32 v20, v20
    v_exp_f32 v133, v133
    v_exp_f32 v21, v21
    v_exp_f32 v134, v134
    v_exp_f32 v22, v22
    v_exp_f32 v135, v135
    v_exp_f32 v23, v23
    v_exp_f32 v136, v136
    v_exp_f32 v24, v24
    v_exp_f32 v137, v137
    v_exp_f32 v25, v25
    v_exp_f32 v138, v138
    v_exp_f32 v26, v26
    v_exp_f32 v139, v139
    v_exp_f32 v27, v27
    v_exp_f32 v140, v140
    v_exp_f32 v28, v28
    v_exp_f32 v141, v141
    v_exp_f32 v29, v29
    v_exp_f32 v142, v142
    v_exp_f32 v30, v30
    v_exp_f32 v143, v143
    v_exp_f32 v31, v31
    v_cvt_pk_bf16_f32 v218, v128, v129
    v_cvt_pk_bf16_f32 v219, v130, v131
    v_cvt_pk_bf16_f32 v220, v132, v133
    v_cvt_pk_bf16_f32 v221, v134, v135
    v_cvt_pk_bf16_f32 v222, v136, v137
    v_cvt_pk_bf16_f32 v223, v138, v139
    v_cvt_pk_bf16_f32 v224, v140, v141
    v_cvt_pk_bf16_f32 v225, v142, v143
    v_cvt_pk_bf16_f32 v226, v16, v17
    v_cvt_pk_bf16_f32 v227, v18, v19
    v_cvt_pk_bf16_f32 v228, v20, v21
    v_cvt_pk_bf16_f32 v229, v22, v23
    v_cvt_pk_bf16_f32 v230, v24, v25
    v_cvt_pk_bf16_f32 v231, v26, v27
    v_cvt_pk_bf16_f32 v232, v28, v29
    v_cvt_pk_bf16_f32 v233, v30, v31
    v_exp_f32 v144, v144
    v_exp_f32 v32, v32
    v_exp_f32 v145, v145
    v_exp_f32 v33, v33
    v_exp_f32 v146, v146
    v_exp_f32 v34, v34
    v_exp_f32 v147, v147
    v_exp_f32_e64 v35, v35
    s_barrier
    buffer_load_dwordx4 v[48:51], v13, s[40:43], s78 offen offset:3072 sc1
    buffer_load_dwordx4 v[52:55], v13, s[40:43], s79 offen offset:3072 sc1
    buffer_load_dwordx4 v[56:59], v13, s[40:43], s78 offen offset:3200 sc1
    buffer_load_dwordx4 v[60:63], v13, s[40:43], s79 offen offset:3200 sc1
    ds_read_b128 v[168:171], v216 offset:24576
    ds_read_b128 v[172:175], v216 offset:24608
    ds_read_b128 v[176:179], v216 offset:24640
    ds_read_b128 v[180:183], v216 offset:24672
    v_exp_f32 v148, v148
    v_exp_f32 v36, v36
    v_exp_f32 v149, v149
    v_exp_f32 v37, v37
    v_exp_f32 v150, v150
    v_exp_f32 v38, v38
    v_exp_f32 v151, v151
    v_exp_f32 v39, v39
    v_exp_f32 v152, v152
    v_exp_f32_e64 v40, v40
    s_waitcnt lgkmcnt(0)
    v_mfma_f32_32x32x16_bf16 v[64:79], v[168:171], v[218:221], 0
    v_exp_f32 v153, v153
    v_exp_f32 v41, v41
    v_exp_f32_e64 v154, v154
    v_mfma_f32_32x32x16_bf16 v[80:95], v[176:179], v[226:229], 0
    v_exp_f32 v42, v42
    v_exp_f32 v155, v155
    v_exp_f32_e64 v43, v43
    v_mfma_f32_32x32x16_bf16 v[64:79], v[172:175], v[222:225], v[64:79]
    v_exp_f32 v156, v156
    v_exp_f32 v44, v44
    v_exp_f32_e64 v157, v157
    v_mfma_f32_32x32x16_bf16 v[80:95], v[180:183], v[230:233], v[80:95]
    v_exp_f32 v45, v45
    v_exp_f32 v158, v158
    v_exp_f32 v46, v46
    v_exp_f32 v159, v159
    v_exp_f32_e64 v47, v47
    v_cvt_pk_bf16_f32 v234, v144, v145
    v_cvt_pk_bf16_f32 v235, v146, v147
    v_cvt_pk_bf16_f32 v236, v148, v149
    v_cvt_pk_bf16_f32 v237, v150, v151
    v_cvt_pk_bf16_f32 v238, v152, v153
    v_cvt_pk_bf16_f32 v239, v154, v155
    v_cvt_pk_bf16_f32 v240, v156, v157
    v_cvt_pk_bf16_f32 v241, v158, v159
    v_cvt_pk_bf16_f32 v242, v32, v33
    v_cvt_pk_bf16_f32 v243, v34, v35
    v_cvt_pk_bf16_f32 v244, v36, v37
    v_cvt_pk_bf16_f32 v245, v38, v39
    v_cvt_pk_bf16_f32 v246, v40, v41
    v_cvt_pk_bf16_f32 v247, v42, v43
    v_cvt_pk_bf16_f32 v248, v44, v45
    v_cvt_pk_bf16_f32 v249, v46, v47
    v_mfma_f32_32x32x16_bf16 v[96:111], v[168:171], v[234:237], 0
    v_rcp_f32 v184, v65
    v_rcp_f32 v185, v81
    v_mul_f32 v6, v64, v184
    v_fmac_f32 v6, v80, v185
    v_add_f32 v6, 0x358637bd, v6
    v_mfma_f32_32x32x16_bf16 v[112:127], v[176:179], v[242:245], 0
    v_rcp_f32 v6, v6
    v_mov_b32 v8, 0
    v_mul_f32 v184, v184, v6
    v_mul_f32_e64 v185, v185, v6
    s_lshl4_add_u32 s76, s60, s61
    v_mfma_f32_32x32x16_bf16 v[96:111], v[172:175], v[238:241], v[96:111]
    s_mul_i32 s76, s76, 32768
    s_lshl2_add_u32 s77, s63, s64
    s_lshl_b32 s77, s77, 12
    s_add_u32 s76, s76, s77
    s_add_u32 s76, s76, 16777216
    v_mfma_f32_32x32x16_bf16 v[112:127], v[180:183], v[246:249], v[112:127]
    s_add_u32 s77, s76, 8192
    v_add_u32 v14, 128, v12
    v_cmp_gt_u32 vcc, 24, v1
    s_nop 0
    s_nop 0
    v_cndmask_b32_e64 v14, v14, v12, vcc
    s_mov_b32 s88, 0
    s_branch L_pfirst_53
L_poll_52:
    buffer_load_dwordx4 v[48:51], v13, s[40:43], s78 offen offset:3072 sc1
    buffer_load_dwordx4 v[52:55], v13, s[40:43], s79 offen offset:3072 sc1
    buffer_load_dwordx4 v[56:59], v13, s[40:43], s78 offen offset:3200 sc1
    buffer_load_dwordx4 v[60:63], v13, s[40:43], s79 offen offset:3200 sc1
L_pfirst_53:
    s_waitcnt vmcnt(0)
    v_max3_u32 v9, v48, v49, v50
    v_max3_u32 v9, v9, v51, v52
    v_max3_u32 v9, v9, v53, v54
    v_max3_u32 v9, v9, v55, v56
    v_max3_u32 v9, v9, v57, v58
    v_max3_u32 v9, v9, v59, v60
    v_max3_u32 v9, v9, v61, v62
    v_max_u32 v9, v9, v63
    v_cmp_eq_u32 vcc, -1, v9
    s_nop 0
    s_cbranch_vccz L_ok_54
    s_add_u32 s88, s88, 1
    s_cmp_lt_u32 s88, 65536
    s_cbranch_scc1 L_poll_52
L_ok_54:
    v_mfma_f32_32x32x16_bf16 v[16:31], v[48:51], v[218:221], 0
    s_barrier
    v_rcp_f32 v186, v97
    v_rcp_f32 v187, v113
    v_mul_f32 v7, v96, v186
    v_fmac_f32 v7, v112, v187
    v_mfma_f32_32x32x16_bf16 v[128:143], v[56:59], v[226:229], 0
    v_add_f32 v7, 0x358637bd, v7
    v_rcp_f32 v7, v7
    v_mov_b32 v8, 0
    v_mul_f32_e64 v186, v186, v7
    v_mfma_f32_32x32x16_bf16 v[16:31], v[52:55], v[222:225], v[16:31]
    v_mul_f32_e64 v187, v187, v7
    global_load_dwordx2 v[192:193], v10, s[14:15] offset:0
    global_load_dwordx2 v[194:195], v10, s[14:15] offset:16
    global_load_dwordx2 v[196:197], v10, s[14:15] offset:32
    v_mfma_f32_32x32x16_bf16 v[128:143], v[60:63], v[230:233], v[128:143]
    global_load_dwordx2 v[198:199], v10, s[14:15] offset:48
    global_load_dwordx2 v[200:201], v10, s[14:15] offset:64
    global_load_dwordx2 v[202:203], v10, s[14:15] offset:80
    global_load_dwordx2 v[204:205], v10, s[14:15] offset:96
    v_mfma_f32_32x32x16_bf16 v[32:47], v[48:51], v[234:237], 0
    global_load_dwordx2 v[206:207], v10, s[14:15] offset:112
    global_load_dwordx4 v[208:211], v11, s[14:15] offset:0
    global_load_dwordx4 v[212:215], v11, s[14:15] offset:16
    v_mfma_f32_32x32x16_bf16 v[144:159], v[56:59], v[242:245], 0
    v_mul_f32 v16, v16, v184
    v_mul_f32 v17, v17, v184
    v_mul_f32 v18, v18, v184
    v_mul_f32 v19, v19, v184
    v_mul_f32 v20, v20, v184
    v_mul_f32 v21, v21, v184
    v_mfma_f32_32x32x16_bf16 v[32:47], v[52:55], v[238:241], v[32:47]
    v_mul_f32 v22, v22, v184
    v_mul_f32 v23, v23, v184
    v_mul_f32 v24, v24, v184
    v_mul_f32 v25, v25, v184
    v_mul_f32 v26, v26, v184
    v_mul_f32 v27, v27, v184
    v_mfma_f32_32x32x16_bf16 v[144:159], v[60:63], v[246:249], v[144:159]
    v_mul_f32 v28, v28, v184
    v_mul_f32 v29, v29, v184
    v_mul_f32 v30, v30, v184
    v_mul_f32 v31, v31, v184
    v_fmac_f32 v16, v128, v185
    v_fmac_f32 v17, v129, v185
    v_cvt_pk_bf16_f32 v64, v16, v17
    v_fmac_f32 v18, v130, v185
    v_fmac_f32 v19, v131, v185
    v_cvt_pk_bf16_f32 v65, v18, v19
    v_fmac_f32 v20, v132, v185
    v_fmac_f32 v21, v133, v185
    v_cvt_pk_bf16_f32 v66, v20, v21
    v_fmac_f32 v22, v134, v185
    v_fmac_f32 v23, v135, v185
    v_cvt_pk_bf16_f32 v67, v22, v23
    buffer_store_dwordx4 v[64:67], v14, s[40:43], s76 offen offset:0 sc1
    v_fmac_f32 v24, v136, v185
    v_fmac_f32 v25, v137, v185
    v_cvt_pk_bf16_f32 v68, v24, v25
    v_fmac_f32 v26, v138, v185
    v_fmac_f32 v27, v139, v185
    v_cvt_pk_bf16_f32 v69, v26, v27
    v_fmac_f32 v28, v140, v185
    v_fmac_f32 v29, v141, v185
    v_cvt_pk_bf16_f32 v70, v28, v29
    v_fmac_f32 v30, v142, v185
    v_fmac_f32 v31, v143, v185
    v_cvt_pk_bf16_f32 v71, v30, v31
    buffer_store_dwordx4 v[68:71], v14, s[40:43], s76 offen offset:2048 sc1
    v_pk_mul_f32 v[32:33], v[32:33], v[186:187] op_sel_hi:[1,0]
    v_pk_fma_f32 v[32:33], v[144:145], v[186:187], v[32:33] op_sel:[0,1,0] op_sel_hi:[1,1,1]
    v_cvt_pk_bf16_f32 v72, v32, v33
    v_pk_mul_f32 v[34:35], v[34:35], v[186:187] op_sel_hi:[1,0]
    v_pk_fma_f32 v[34:35], v[146:147], v[186:187], v[34:35] op_sel:[0,1,0] op_sel_hi:[1,1,1]
    v_cvt_pk_bf16_f32 v73, v34, v35
    v_pk_mul_f32 v[36:37], v[36:37], v[186:187] op_sel_hi:[1,0]
    v_pk_fma_f32 v[36:37], v[148:149], v[186:187], v[36:37] op_sel:[0,1,0] op_sel_hi:[1,1,1]
    v_cvt_pk_bf16_f32 v74, v36, v37
    v_pk_mul_f32 v[38:39], v[38:39], v[186:187] op_sel_hi:[1,0]
    v_pk_fma_f32 v[38:39], v[150:151], v[186:187], v[38:39] op_sel:[0,1,0] op_sel_hi:[1,1,1]
    v_cvt_pk_bf16_f32 v75, v38, v39
    buffer_store_dwordx4 v[72:75], v14, s[40:43], s77 offen offset:0 sc1
    v_pk_mul_f32 v[40:41], v[40:41], v[186:187] op_sel_hi:[1,0]
    v_pk_fma_f32 v[40:41], v[152:153], v[186:187], v[40:41] op_sel:[0,1,0] op_sel_hi:[1,1,1]
    v_cvt_pk_bf16_f32 v76, v40, v41
    v_pk_mul_f32 v[42:43], v[42:43], v[186:187] op_sel_hi:[1,0]
    v_pk_fma_f32 v[42:43], v[154:155], v[186:187], v[42:43] op_sel:[0,1,0] op_sel_hi:[1,1,1]
    v_cvt_pk_bf16_f32 v77, v42, v43
    v_pk_mul_f32 v[44:45], v[44:45], v[186:187] op_sel_hi:[1,0]
    v_pk_fma_f32 v[44:45], v[156:157], v[186:187], v[44:45] op_sel:[0,1,0] op_sel_hi:[1,1,1]
    v_cvt_pk_bf16_f32 v78, v44, v45
    v_pk_mul_f32 v[46:47], v[46:47], v[186:187] op_sel_hi:[1,0]
    v_pk_fma_f32 v[46:47], v[158:159], v[186:187], v[46:47] op_sel:[0,1,0] op_sel_hi:[1,1,1]
    v_cvt_pk_bf16_f32 v79, v46, v47
    buffer_store_dwordx4 v[76:79], v14, s[40:43], s77 offen offset:2048 sc1
    v_bfe_u32 v4, v2, 1, 3
    v_lshlrev_b32_e64 v4, 4, v4
    v_lshl_add_u32 v4, v3, 3, v4
    v_lshl_add_u32 v4, v2, 7, v4
    s_lshl_b32 s76, s62, 12
    s_add_u32 s77, s76, 0
    v_add_u32 v64, s77, v4
    v_xor_b32 v65, 16, v64
    v_xor_b32 v66, 32, v64
    v_xor_b32 v67, 48, v64
    v_xor_b32_e64 v68, 64, v64
    v_xor_b32 v69, 80, v64
    v_xor_b32 v70, 96, v64
    v_xor_b32 v71, 112, v64
    v_bfe_u32 v4, v1, 2, 2
    v_lshl_add_u32 v5, v3, 2, v4
    v_lshlrev_b32 v5, 7, v5
    v_lshrrev_b32 v4, 1, v4
    v_lshl_add_u32 v5, v4, 6, v5
    v_bfe_u32 v4, v1, 4, 1
    v_lshl_add_u32 v5, v4, 5, v5
    v_and_b32_e64 v4, 3, v1
    v_lshl_add_u32 v5, v4, 3, v5
    v_add_u32 v72, 32768, v5
    v_xor_b32_e64 v73, 64, v72
    s_mul_i32 s80, s97, 524288
    s_mul_i32 s76, s62, 8192
    s_add_u32 s80, s80, s76
    s_add_u32 s80, s80, 16777216
    v_add_u32 v78, 4096, v14
    v_mov_b32 v74, 1
    s_mov_b32 s52, 0xffff
    s_mov_b32 s53, 0
    s_barrier
    ds_read_b32 v79, v8 offset:25984
    ds_read_b64 v[88:89], v64
    ds_read_b64 v[90:91], v65
    ds_read_b64 v[92:93], v66
    ds_read_b64 v[94:95], v67
    ds_read_b64 v[96:97], v68
    ds_read_b64 v[98:99], v69
    ds_read_b64 v[100:101], v70
    ds_read_b64 v[102:103], v71
    s_waitcnt lgkmcnt(8)
    v_readfirstlane_b32 s76, v79
    s_nop 0
    s_and_b32 s76, s76, s52
    s_cbranch_scc0 L_tr0
L_bk0:
    s_ff1_i32_b32 s76, s76
    s_bitset0_b32 s52, s76
    s_add_u32 s77, s76, s65
    s_and_b32 s77, s77, 15
    s_mul_i32 s77, s77, 32768
    s_add_u32 s28, s77, s80
    s_add_u32 s76, s76, 3
    s_and_b32 s76, s76, 15
    s_lshl_b32 s4, s76, 13
    buffer_load_dwordx4 v[128:131], v14, s[40:43], s28 offen offset:0 sc1
    buffer_load_dwordx4 v[132:135], v14, s[40:43], s28 offen offset:2048 sc1
    buffer_load_dwordx4 v[136:139], v78, s[40:43], s28 offen offset:0 sc1
    buffer_load_dwordx4 v[140:143], v78, s[40:43], s28 offen offset:2048 sc1
    v_readfirstlane_b32 s76, v79
    s_nop 0
    s_and_b32 s76, s76, s52
    s_cbranch_scc0 L_tr1
L_bk1:
    s_ff1_i32_b32 s76, s76
    s_bitset0_b32 s52, s76
    s_add_u32 s77, s76, s65
    s_and_b32 s77, s77, 15
    s_mul_i32 s77, s77, 32768
    s_add_u32 s29, s77, s80
    s_add_u32 s76, s76, 3
    s_and_b32 s76, s76, 15
    s_lshl_b32 s5, s76, 13
    buffer_load_dwordx4 v[144:147], v14, s[40:43], s29 offen offset:0 sc1
    buffer_load_dwordx4 v[148:151], v14, s[40:43], s29 offen offset:2048 sc1
    v_add_u32 v80, s4, v72
    v_add_u32 v81, s4, v73
    s_waitcnt lgkmcnt(0)
    v_lshlrev_b32 v16, 16, v88
    v_and_b32 v17, s90, v88
    v_lshlrev_b32 v18, 16, v89
    v_and_b32 v19, s90, v89
    v_lshlrev_b32 v20, 16, v90
    v_and_b32 v21, s90, v90
    v_lshlrev_b32 v22, 16, v91
    v_and_b32 v23, s90, v91
    v_lshlrev_b32 v24, 16, v92
    v_and_b32 v25, s90, v92
    v_lshlrev_b32 v26, 16, v93
    v_and_b32 v27, s90, v93
    v_lshlrev_b32 v28, 16, v94
    v_and_b32 v29, s90, v94
    v_lshlrev_b32 v30, 16, v95
    v_and_b32 v31, s90, v95
    v_lshlrev_b32 v32, 16, v96
    v_and_b32 v33, s90, v96
    v_lshlrev_b32 v34, 16, v97
    v_and_b32 v35, s90, v97
    v_lshlrev_b32 v36, 16, v98
    v_and_b32 v37, s90, v98
    v_lshlrev_b32 v38, 16, v99
    v_and_b32 v39, s90, v99
    v_lshlrev_b32 v40, 16, v100
    v_and_b32 v41, s90, v100
    v_lshlrev_b32 v42, 16, v101
    v_and_b32 v43, s90, v101
    v_lshlrev_b32 v44, 16, v102
    v_and_b32 v45, s90, v102
    v_lshlrev_b32 v46, 16, v103
    v_and_b32 v47, s90, v103
    s_cmp_eq_u32 s53, 0
    s_cbranch_scc0 L_sent_55
    s_waitcnt vmcnt(6)
    s_mov_b64 exec, 1
    ds_add_u32 v8, v74 offset:25988
    s_mov_b64 exec, -1
    s_mov_b32 s53, 1
L_sent_55:
    ds_read_b32 v79, v8 offset:25984
    ds_read_b64_tr_b16 v[104:105], v80 offset:0
    ds_read_b64_tr_b16 v[106:107], v80 offset:1024
    ds_read_b64_tr_b16 v[108:109], v81 offset:0
    ds_read_b64_tr_b16 v[110:111], v81 offset:1024
    ds_read_b64_tr_b16 v[112:113], v80 offset:2048
    ds_read_b64_tr_b16 v[114:115], v80 offset:3072
    ds_read_b64_tr_b16 v[116:117], v81 offset:2048
    ds_read_b64_tr_b16 v[118:119], v81 offset:3072
    s_waitcnt vmcnt(5) lgkmcnt(4)
    v_mfma_f32_32x32x16_bf16 v[16:31], v[104:107], v[128:131], v[16:31]
    ds_read_b64_tr_b16 v[120:121], v80 offset:4096
    ds_read_b64_tr_b16 v[122:123], v80 offset:5120
    buffer_load_dwordx4 v[152:155], v78, s[40:43], s29 offen offset:0 sc1
    v_mfma_f32_32x32x16_bf16 v[32:47], v[108:111], v[128:131], v[32:47]
    ds_read_b64_tr_b16 v[124:125], v81 offset:4096
    ds_read_b64_tr_b16 v[126:127], v81 offset:5120
    buffer_load_dwordx4 v[156:159], v78, s[40:43], s29 offen offset:2048 sc1
    v_readfirstlane_b32 s76, v79
    s_nop 0
    s_and_b32 s76, s76, s52
    s_cbranch_scc0 L_tr2
L_bk2:
    s_ff1_i32_b32 s76, s76
    s_bitset0_b32 s52, s76
    s_add_u32 s77, s76, s65
    s_and_b32 s77, s77, 15
    s_mul_i32 s77, s77, 32768
    s_add_u32 s30, s77, s80
    s_waitcnt vmcnt(6) lgkmcnt(4)
    v_mfma_f32_32x32x16_bf16 v[16:31], v[112:115], v[132:135], v[16:31]
    ds_read_b32 v79, v8 offset:25984
    ds_read_b64_tr_b16 v[104:105], v80 offset:6144
    ds_read_b64_tr_b16 v[106:107], v80 offset:7168
    buffer_load_dwordx4 v[160:163], v14, s[40:43], s30 offen offset:0 sc1
    s_add_u32 s76, s76, 3
    s_and_b32 s76, s76, 15
    s_lshl_b32 s6, s76, 13
    v_mfma_f32_32x32x16_bf16 v[32:47], v[116:119], v[132:135], v[32:47]
    ds_read_b64_tr_b16 v[108:109], v81 offset:6144
    ds_read_b64_tr_b16 v[110:111], v81 offset:7168
    buffer_load_dwordx4 v[164:167], v14, s[40:43], s30 offen offset:2048 sc1
    v_add_u32 v82, s5, v72
    v_add_u32_e64 v83, s5, v73
    s_waitcnt vmcnt(7) lgkmcnt(4)
    v_mfma_f32_32x32x16_bf16 v[16:31], v[120:123], v[136:139], v[16:31]
    ds_read_b64_tr_b16 v[112:113], v82 offset:0
    ds_read_b64_tr_b16 v[114:115], v82 offset:1024
    buffer_load_dwordx4 v[168:171], v78, s[40:43], s30 offen offset:0 sc1
    v_mfma_f32_32x32x16_bf16 v[32:47], v[124:127], v[136:139], v[32:47]
    ds_read_b64_tr_b16 v[116:117], v83 offset:0
    ds_read_b64_tr_b16 v[118:119], v83 offset:1024
    buffer_load_dwordx4 v[172:175], v78, s[40:43], s30 offen offset:2048 sc1
    v_readfirstlane_b32 s76, v79
    s_nop 0
    s_and_b32 s76, s76, s52
    s_cbranch_scc0 L_tr3
L_bk3:
    s_ff1_i32_b32 s76, s76
    s_bitset0_b32 s52, s76
    s_add_u32 s77, s76, s65
    s_and_b32 s77, s77, 15
    s_mul_i32 s77, s77, 32768
    s_add_u32 s31, s77, s80
    s_waitcnt vmcnt(8) lgkmcnt(4)
    v_mfma_f32_32x32x16_bf16 v[16:31], v[104:107], v[140:143], v[16:31]
    ds_read_b32 v79, v8 offset:25984
    ds_read_b64_tr_b16 v[120:121], v82 offset:2048
    ds_read_b64_tr_b16 v[122:123], v82 offset:3072
    buffer_load_dwordx4 v[176:179], v14, s[40:43], s31 offen offset:0 sc1
    s_add_u32 s76, s76, 3
    s_and_b32 s76, s76, 15
    s_lshl_b32 s7, s76, 13
    v_mfma_f32_32x32x16_bf16 v[32:47], v[108:111], v[140:143], v[32:47]
    ds_read_b64_tr_b16 v[124:125], v83 offset:2048
    ds_read_b64_tr_b16 v[126:127], v83 offset:3072
    buffer_load_dwordx4 v[180:183], v14, s[40:43], s31 offen offset:2048 sc1
    s_waitcnt vmcnt(9) lgkmcnt(4)
    v_mfma_f32_32x32x16_bf16 v[16:31], v[112:115], v[144:147], v[16:31]
    ds_read_b64_tr_b16 v[104:105], v82 offset:4096
    ds_read_b64_tr_b16 v[106:107], v82 offset:5120
    buffer_load_dwordx4 v[184:187], v78, s[40:43], s31 offen offset:0 sc1
    v_mfma_f32_32x32x16_bf16 v[32:47], v[116:119], v[144:147], v[32:47]
    ds_read_b64_tr_b16 v[108:109], v83 offset:4096
    ds_read_b64_tr_b16 v[110:111], v83 offset:5120
    buffer_load_dwordx4 v[188:191], v78, s[40:43], s31 offen offset:2048 sc1
    v_readfirstlane_b32 s76, v79
    s_nop 0
    s_and_b32 s76, s76, s52
    s_cbranch_scc0 L_tr4
L_bk4:
    s_ff1_i32_b32 s76, s76
    s_bitset0_b32 s52, s76
    s_add_u32 s77, s76, s65
    s_and_b32 s77, s77, 15
    s_mul_i32 s77, s77, 32768
    s_add_u32 s32, s77, s80
    s_waitcnt vmcnt(10) lgkmcnt(4)
    v_mfma_f32_32x32x16_bf16 v[16:31], v[120:123], v[148:151], v[16:31]
    ds_read_b64_tr_b16 v[112:113], v82 offset:6144
    ds_read_b64_tr_b16 v[114:115], v82 offset:7168
    buffer_load_dwordx4 v[128:131], v14, s[40:43], s32 offen offset:0 sc1
    s_add_u32 s76, s76, 3
    s_and_b32 s76, s76, 15
    s_lshl_b32 s8, s76, 13
    v_mfma_f32_32x32x16_bf16 v[32:47], v[124:127], v[148:151], v[32:47]
    ds_read_b64_tr_b16 v[116:117], v83 offset:6144
    ds_read_b64_tr_b16 v[118:119], v83 offset:7168
    buffer_load_dwordx4 v[132:135], v14, s[40:43], s32 offen offset:2048 sc1
    v_add_u32 v80, s6, v72
    v_add_u32 v81, s6, v73
    s_waitcnt vmcnt(11) lgkmcnt(4)
    v_mfma_f32_32x32x16_bf16 v[16:31], v[104:107], v[152:155], v[16:31]
    ds_read_b32 v79, v8 offset:25984
    ds_read_b64_tr_b16 v[120:121], v80 offset:0
    ds_read_b64_tr_b16 v[122:123], v80 offset:1024
    buffer_load_dwordx4 v[136:139], v78, s[40:43], s32 offen offset:0 sc1
    v_mfma_f32_32x32x16_bf16 v[32:47], v[108:111], v[152:155], v[32:47]
    ds_read_b64_tr_b16 v[124:125], v81 offset:0
    ds_read_b64_tr_b16 v[126:127], v81 offset:1024
    s_waitcnt vmcnt(11) lgkmcnt(4)
    v_mfma_f32_32x32x16_bf16 v[16:31], v[112:115], v[156:159], v[16:31]
    ds_read_b64_tr_b16 v[104:105], v80 offset:2048
    ds_read_b64_tr_b16 v[106:107], v80 offset:3072
    buffer_load_dwordx4 v[140:143], v78, s[40:43], s32 offen offset:2048 sc1
    v_mfma_f32_32x32x16_bf16 v[32:47], v[116:119], v[156:159], v[32:47]
    ds_read_b64_tr_b16 v[108:109], v81 offset:2048
    ds_read_b64_tr_b16 v[110:111], v81 offset:3072
    v_readfirstlane_b32 s76, v79
    s_nop 0
    s_and_b32 s76, s76, s52
    s_cbranch_scc0 L_tr5
L_bk5:
    s_ff1_i32_b32 s76, s76
    s_bitset0_b32 s52, s76
    s_add_u32 s77, s76, s65
    s_and_b32 s77, s77, 15
    s_mul_i32 s77, s77, 32768
    s_add_u32 s33, s77, s80
    s_waitcnt vmcnt(11) lgkmcnt(4)
    v_mfma_f32_32x32x16_bf16 v[16:31], v[120:123], v[160:163], v[16:31]
    ds_read_b64_tr_b16 v[112:113], v80 offset:4096
    ds_read_b64_tr_b16 v[114:115], v80 offset:5120
    buffer_load_dwordx4 v[144:147], v14, s[40:43], s33 offen offset:0 sc1
    s_add_u32 s76, s76, 3
    s_and_b32 s76, s76, 15
    s_lshl_b32 s9, s76, 13
    v_mfma_f32_32x32x16_bf16 v[32:47], v[124:127], v[160:163], v[32:47]
    ds_read_b64_tr_b16 v[116:117], v81 offset:4096
    ds_read_b64_tr_b16 v[118:119], v81 offset:5120
    s_waitcnt vmcnt(11) lgkmcnt(4)
    v_mfma_f32_32x32x16_bf16 v[16:31], v[104:107], v[164:167], v[16:31]
    ds_read_b64_tr_b16 v[120:121], v80 offset:6144
    ds_read_b64_tr_b16 v[122:123], v80 offset:7168
    buffer_load_dwordx4 v[148:151], v14, s[40:43], s33 offen offset:2048 sc1
    v_mfma_f32_32x32x16_bf16 v[32:47], v[108:111], v[164:167], v[32:47]
    ds_read_b64_tr_b16 v[124:125], v81 offset:6144
    ds_read_b64_tr_b16 v[126:127], v81 offset:7168
    v_add_u32 v82, s7, v72
    v_add_u32 v83, s7, v73
    s_waitcnt vmcnt(11) lgkmcnt(4)
    v_mfma_f32_32x32x16_bf16 v[16:31], v[112:115], v[168:171], v[16:31]
    ds_read_b32 v79, v8 offset:25984
    ds_read_b64_tr_b16 v[104:105], v82 offset:0
    ds_read_b64_tr_b16 v[106:107], v82 offset:1024
    buffer_load_dwordx4 v[152:155], v78, s[40:43], s33 offen offset:0 sc1
    v_mfma_f32_32x32x16_bf16 v[32:47], v[116:119], v[168:171], v[32:47]
    ds_read_b64_tr_b16 v[108:109], v83 offset:0
    ds_read_b64_tr_b16 v[110:111], v83 offset:1024
    s_waitcnt vmcnt(11) lgkmcnt(4)
    v_mfma_f32_32x32x16_bf16 v[16:31], v[120:123], v[172:175], v[16:31]
    ds_read_b64_tr_b16 v[112:113], v82 offset:2048
    ds_read_b64_tr_b16 v[114:115], v82 offset:3072
    buffer_load_dwordx4 v[156:159], v78, s[40:43], s33 offen offset:2048 sc1
    v_mfma_f32_32x32x16_bf16 v[32:47], v[124:127], v[172:175], v[32:47]
    ds_read_b64_tr_b16 v[116:117], v83 offset:2048
    ds_read_b64_tr_b16 v[118:119], v83 offset:3072
    v_readfirstlane_b32 s76, v79
    s_nop 0
    s_and_b32 s76, s76, s52
    s_cbranch_scc0 L_tr6
L_bk6:
    s_ff1_i32_b32 s76, s76
    s_bitset0_b32 s52, s76
    s_add_u32 s77, s76, s65
    s_and_b32 s77, s77, 15
    s_mul_i32 s77, s77, 32768
    s_add_u32 s34, s77, s80
    s_waitcnt vmcnt(11) lgkmcnt(4)
    v_mfma_f32_32x32x16_bf16 v[16:31], v[104:107], v[176:179], v[16:31]
    ds_read_b64_tr_b16 v[120:121], v82 offset:4096
    ds_read_b64_tr_b16 v[122:123], v82 offset:5120
    buffer_load_dwordx4 v[160:163], v14, s[40:43], s34 offen offset:0 sc1
    s_add_u32 s76, s76, 3
    s_and_b32 s76, s76, 15
    s_lshl_b32 s10, s76, 13
    v_mfma_f32_32x32x16_bf16 v[32:47], v[108:111], v[176:179], v[32:47]
    ds_read_b64_tr_b16 v[124:125], v83 offset:4096
    ds_read_b64_tr_b16 v[126:127], v83 offset:5120
    s_waitcnt vmcnt(11) lgkmcnt(4)
    v_mfma_f32_32x32x16_bf16 v[16:31], v[112:115], v[180:183], v[16:31]
    ds_read_b64_tr_b16 v[104:105], v82 offset:6144
    ds_read_b64_tr_b16 v[106:107], v82 offset:7168
    buffer_load_dwordx4 v[164:167], v14, s[40:43], s34 offen offset:2048 sc1
    v_mfma_f32_32x32x16_bf16 v[32:47], v[116:119], v[180:183], v[32:47]
    ds_read_b64_tr_b16 v[108:109], v83 offset:6144
    ds_read_b64_tr_b16 v[110:111], v83 offset:7168
    v_add_u32 v80, s8, v72
    v_add_u32 v81, s8, v73
    s_waitcnt vmcnt(11) lgkmcnt(4)
    v_mfma_f32_32x32x16_bf16 v[16:31], v[120:123], v[184:187], v[16:31]
    ds_read_b32 v79, v8 offset:25984
    ds_read_b64_tr_b16 v[112:113], v80 offset:0
    ds_read_b64_tr_b16 v[114:115], v80 offset:1024
    buffer_load_dwordx4 v[168:171], v78, s[40:43], s34 offen offset:0 sc1
    v_mfma_f32_32x32x16_bf16 v[32:47], v[124:127], v[184:187], v[32:47]
    ds_read_b64_tr_b16 v[116:117], v81 offset:0
    ds_read_b64_tr_b16 v[118:119], v81 offset:1024
    s_waitcnt vmcnt(11) lgkmcnt(4)
    v_mfma_f32_32x32x16_bf16 v[16:31], v[104:107], v[188:191], v[16:31]
    ds_read_b64_tr_b16 v[120:121], v80 offset:2048
    ds_read_b64_tr_b16 v[122:123], v80 offset:3072
    buffer_load_dwordx4 v[172:175], v78, s[40:43], s34 offen offset:2048 sc1
    v_mfma_f32_32x32x16_bf16 v[32:47], v[108:111], v[188:191], v[32:47]
    ds_read_b64_tr_b16 v[124:125], v81 offset:2048
    ds_read_b64_tr_b16 v[126:127], v81 offset:3072
    v_readfirstlane_b32 s76, v79
    s_nop 0
    s_and_b32 s76, s76, s52
    s_cbranch_scc0 L_tr7
L_bk7:
    s_ff1_i32_b32 s76, s76
    s_bitset0_b32 s52, s76
    s_add_u32 s77, s76, s65
    s_and_b32 s77, s77, 15
    s_mul_i32 s77, s77, 32768
    s_add_u32 s35, s77, s80
    s_waitcnt vmcnt(11) lgkmcnt(4)
    v_mfma_f32_32x32x16_bf16 v[16:31], v[112:115], v[128:131], v[16:31]
    ds_read_b64_tr_b16 v[104:105], v80 offset:4096
    ds_read_b64_tr_b16 v[106:107], v80 offset:5120
    buffer_load_dwordx4 v[176:179], v14, s[40:43], s35 offen offset:0 sc1
    s_add_u32 s76, s76, 3
    s_and_b32 s76, s76, 15
    s_lshl_b32 s11, s76, 13
    v_mfma_f32_32x32x16_bf16 v[32:47], v[116:119], v[128:131], v[32:47]
    ds_read_b64_tr_b16 v[108:109], v81 offset:4096
    ds_read_b64_tr_b16 v[110:111], v81 offset:5120
    s_waitcnt vmcnt(11) lgkmcnt(4)
    v_mfma_f32_32x32x16_bf16 v[16:31], v[120:123], v[132:135], v[16:31]
    ds_read_b64_tr_b16 v[112:113], v80 offset:6144
    ds_read_b64_tr_b16 v[114:115], v80 offset:7168
    buffer_load_dwordx4 v[180:183], v14, s[40:43], s35 offen offset:2048 sc1
    v_mfma_f32_32x32x16_bf16 v[32:47], v[124:127], v[132:135], v[32:47]
    ds_read_b64_tr_b16 v[116:117], v81 offset:6144
    ds_read_b64_tr_b16 v[118:119], v81 offset:7168
    v_add_u32 v82, s9, v72
    v_add_u32 v83, s9, v73
    s_waitcnt vmcnt(11) lgkmcnt(4)
    v_mfma_f32_32x32x16_bf16 v[16:31], v[104:107], v[136:139], v[16:31]
    ds_read_b32 v79, v8 offset:25984
    ds_read_b64_tr_b16 v[120:121], v82 offset:0
    ds_read_b64_tr_b16 v[122:123], v82 offset:1024
    buffer_load_dwordx4 v[184:187], v78, s[40:43], s35 offen offset:0 sc1
    v_mfma_f32_32x32x16_bf16 v[32:47], v[108:111], v[136:139], v[32:47]
    ds_read_b64_tr_b16 v[124:125], v83 offset:0
    ds_read_b64_tr_b16 v[126:127], v83 offset:1024
    s_waitcnt vmcnt(11) lgkmcnt(4)
    v_mfma_f32_32x32x16_bf16 v[16:31], v[112:115], v[140:143], v[16:31]
    ds_read_b64_tr_b16 v[104:105], v82 offset:2048
    ds_read_b64_tr_b16 v[106:107], v82 offset:3072
    buffer_load_dwordx4 v[188:191], v78, s[40:43], s35 offen offset:2048 sc1
    v_mfma_f32_32x32x16_bf16 v[32:47], v[116:119], v[140:143], v[32:47]
    ds_read_b64_tr_b16 v[108:109], v83 offset:2048
    ds_read_b64_tr_b16 v[110:111], v83 offset:3072
    v_readfirstlane_b32 s76, v79
    s_nop 0
    s_and_b32 s76, s76, s52
    s_cbranch_scc0 L_tr8
L_bk8:
    s_ff1_i32_b32 s76, s76
    s_bitset0_b32 s52, s76
    s_add_u32 s77, s76, s65
    s_and_b32 s77, s77, 15
    s_mul_i32 s77, s77, 32768
    s_add_u32 s36, s77, s80
    s_waitcnt vmcnt(11) lgkmcnt(4)
    v_mfma_f32_32x32x16_bf16 v[16:31], v[120:123], v[144:147], v[16:31]
    ds_read_b64_tr_b16 v[112:113], v82 offset:4096
    ds_read_b64_tr_b16 v[114:115], v82 offset:5120
    buffer_load_dwordx4 v[128:131], v14, s[40:43], s36 offen offset:0 sc1
    s_add_u32 s76, s76, 3
    s_and_b32 s76, s76, 15
    s_lshl_b32 s12, s76, 13
    v_mfma_f32_32x32x16_bf16 v[32:47], v[124:127], v[144:147], v[32:47]
    ds_read_b64_tr_b16 v[116:117], v83 offset:4096
    ds_read_b64_tr_b16 v[118:119], v83 offset:5120
    s_waitcnt vmcnt(11) lgkmcnt(4)
    v_mfma_f32_32x32x16_bf16 v[16:31], v[104:107], v[148:151], v[16:31]
    ds_read_b64_tr_b16 v[120:121], v82 offset:6144
    ds_read_b64_tr_b16 v[122:123], v82 offset:7168
    buffer_load_dwordx4 v[132:135], v14, s[40:43], s36 offen offset:2048 sc1
    v_mfma_f32_32x32x16_bf16 v[32:47], v[108:111], v[148:151], v[32:47]
    ds_read_b64_tr_b16 v[124:125], v83 offset:6144
    ds_read_b64_tr_b16 v[126:127], v83 offset:7168
    v_add_u32 v80, s10, v72
    v_add_u32 v81, s10, v73
    s_waitcnt vmcnt(11) lgkmcnt(4)
    v_mfma_f32_32x32x16_bf16 v[16:31], v[112:115], v[152:155], v[16:31]
    ds_read_b32 v79, v8 offset:25984
    ds_read_b64_tr_b16 v[104:105], v80 offset:0
    ds_read_b64_tr_b16 v[106:107], v80 offset:1024
    buffer_load_dwordx4 v[136:139], v78, s[40:43], s36 offen offset:0 sc1
    v_mfma_f32_32x32x16_bf16 v[32:47], v[116:119], v[152:155], v[32:47]
    ds_read_b64_tr_b16 v[108:109], v81 offset:0
    ds_read_b64_tr_b16 v[110:111], v81 offset:1024
    s_waitcnt vmcnt(11) lgkmcnt(4)
    v_mfma_f32_32x32x16_bf16 v[16:31], v[120:123], v[156:159], v[16:31]
    ds_read_b64_tr_b16 v[112:113], v80 offset:2048
    ds_read_b64_tr_b16 v[114:115], v80 offset:3072
    buffer_load_dwordx4 v[140:143], v78, s[40:43], s36 offen offset:2048 sc1
    v_mfma_f32_32x32x16_bf16 v[32:47], v[124:127], v[156:159], v[32:47]
    ds_read_b64_tr_b16 v[116:117], v81 offset:2048
    ds_read_b64_tr_b16 v[118:119], v81 offset:3072
    v_readfirstlane_b32 s76, v79
    s_nop 0
    s_and_b32 s76, s76, s52
    s_cbranch_scc0 L_tr9
L_bk9:
    s_ff1_i32_b32 s76, s76
    s_bitset0_b32 s52, s76
    s_add_u32 s77, s76, s65
    s_and_b32 s77, s77, 15
    s_mul_i32 s77, s77, 32768
    s_add_u32 s37, s77, s80
    s_waitcnt vmcnt(11) lgkmcnt(4)
    v_mfma_f32_32x32x16_bf16 v[16:31], v[104:107], v[160:163], v[16:31]
    ds_read_b64_tr_b16 v[120:121], v80 offset:4096
    ds_read_b64_tr_b16 v[122:123], v80 offset:5120
    buffer_load_dwordx4 v[144:147], v14, s[40:43], s37 offen offset:0 sc1
    s_add_u32 s76, s76, 3
    s_and_b32 s76, s76, 15
    s_lshl_b32 s13, s76, 13
    v_mfma_f32_32x32x16_bf16 v[32:47], v[108:111], v[160:163], v[32:47]
    ds_read_b64_tr_b16 v[124:125], v81 offset:4096
    ds_read_b64_tr_b16 v[126:127], v81 offset:5120
    s_waitcnt vmcnt(11) lgkmcnt(4)
    v_mfma_f32_32x32x16_bf16 v[16:31], v[112:115], v[164:167], v[16:31]
    ds_read_b64_tr_b16 v[104:105], v80 offset:6144
    ds_read_b64_tr_b16 v[106:107], v80 offset:7168
    buffer_load_dwordx4 v[148:151], v14, s[40:43], s37 offen offset:2048 sc1
    v_mfma_f32_32x32x16_bf16 v[32:47], v[116:119], v[164:167], v[32:47]
    ds_read_b64_tr_b16 v[108:109], v81 offset:6144
    ds_read_b64_tr_b16 v[110:111], v81 offset:7168
    v_add_u32 v82, s11, v72
    v_add_u32 v83, s11, v73
    s_waitcnt vmcnt(11) lgkmcnt(4)
    v_mfma_f32_32x32x16_bf16 v[16:31], v[120:123], v[168:171], v[16:31]
    ds_read_b32 v79, v8 offset:25984
    ds_read_b64_tr_b16 v[112:113], v82 offset:0
    ds_read_b64_tr_b16 v[114:115], v82 offset:1024
    buffer_load_dwordx4 v[152:155], v78, s[40:43], s37 offen offset:0 sc1
    v_mfma_f32_32x32x16_bf16 v[32:47], v[124:127], v[168:171], v[32:47]
    ds_read_b64_tr_b16 v[116:117], v83 offset:0
    ds_read_b64_tr_b16 v[118:119], v83 offset:1024
    s_waitcnt vmcnt(11) lgkmcnt(4)
    v_mfma_f32_32x32x16_bf16 v[16:31], v[104:107], v[172:175], v[16:31]
    ds_read_b64_tr_b16 v[120:121], v82 offset:2048
    ds_read_b64_tr_b16 v[122:123], v82 offset:3072
    buffer_load_dwordx4 v[156:159], v78, s[40:43], s37 offen offset:2048 sc1
    v_mfma_f32_32x32x16_bf16 v[32:47], v[108:111], v[172:175], v[32:47]
    ds_read_b64_tr_b16 v[124:125], v83 offset:2048
    ds_read_b64_tr_b16 v[126:127], v83 offset:3072
    v_readfirstlane_b32 s76, v79
    s_nop 0
    s_and_b32 s76, s76, s52
    s_cbranch_scc0 L_tr10
L_bk10:
    s_ff1_i32_b32 s76, s76
    s_bitset0_b32 s52, s76
    s_add_u32 s77, s76, s65
    s_and_b32 s77, s77, 15
    s_mul_i32 s77, s77, 32768
    s_add_u32 s38, s77, s80
    s_waitcnt vmcnt(11) lgkmcnt(4)
    v_mfma_f32_32x32x16_bf16 v[16:31], v[112:115], v[176:179], v[16:31]
    ds_read_b64_tr_b16 v[104:105], v82 offset:4096
    ds_read_b64_tr_b16 v[106:107], v82 offset:5120
    buffer_load_dwordx4 v[160:163], v14, s[40:43], s38 offen offset:0 sc1
    s_add_u32 s76, s76, 3
    s_and_b32 s76, s76, 15
    s_lshl_b32 s14, s76, 13
    v_mfma_f32_32x32x16_bf16 v[32:47], v[116:119], v[176:179], v[32:47]
    ds_read_b64_tr_b16 v[108:109], v83 offset:4096
    ds_read_b64_tr_b16 v[110:111], v83 offset:5120
    s_waitcnt vmcnt(11) lgkmcnt(4)
    v_mfma_f32_32x32x16_bf16 v[16:31], v[120:123], v[180:183], v[16:31]
    ds_read_b64_tr_b16 v[112:113], v82 offset:6144
    ds_read_b64_tr_b16 v[114:115], v82 offset:7168
    buffer_load_dwordx4 v[164:167], v14, s[40:43], s38 offen offset:2048 sc1
    v_mfma_f32_32x32x16_bf16 v[32:47], v[124:127], v[180:183], v[32:47]
    ds_read_b64_tr_b16 v[116:117], v83 offset:6144
    ds_read_b64_tr_b16 v[118:119], v83 offset:7168
    v_add_u32 v80, s12, v72
    v_add_u32 v81, s12, v73
    s_waitcnt vmcnt(11) lgkmcnt(4)
    v_mfma_f32_32x32x16_bf16 v[16:31], v[104:107], v[184:187], v[16:31]
    ds_read_b32 v79, v8 offset:25984
    ds_read_b64_tr_b16 v[120:121], v80 offset:0
    ds_read_b64_tr_b16 v[122:123], v80 offset:1024
    buffer_load_dwordx4 v[168:171], v78, s[40:43], s38 offen offset:0 sc1
    v_mfma_f32_32x32x16_bf16 v[32:47], v[108:111], v[184:187], v[32:47]
    ds_read_b64_tr_b16 v[124:125], v81 offset:0
    ds_read_b64_tr_b16 v[126:127], v81 offset:1024
    s_waitcnt vmcnt(11) lgkmcnt(4)
    v_mfma_f32_32x32x16_bf16 v[16:31], v[112:115], v[188:191], v[16:31]
    ds_read_b64_tr_b16 v[104:105], v80 offset:2048
    ds_read_b64_tr_b16 v[106:107], v80 offset:3072
    buffer_load_dwordx4 v[172:175], v78, s[40:43], s38 offen offset:2048 sc1
    v_mfma_f32_32x32x16_bf16 v[32:47], v[116:119], v[188:191], v[32:47]
    ds_read_b64_tr_b16 v[108:109], v81 offset:2048
    ds_read_b64_tr_b16 v[110:111], v81 offset:3072
    v_readfirstlane_b32 s76, v79
    s_nop 0
    s_and_b32 s76, s76, s52
    s_cbranch_scc0 L_tr11
L_bk11:
    s_ff1_i32_b32 s76, s76
    s_bitset0_b32 s52, s76
    s_add_u32 s77, s76, s65
    s_and_b32 s77, s77, 15
    s_mul_i32 s77, s77, 32768
    s_add_u32 s39, s77, s80
    s_waitcnt vmcnt(11) lgkmcnt(4)
    v_mfma_f32_32x32x16_bf16 v[16:31], v[120:123], v[128:131], v[16:31]
    ds_read_b64_tr_b16 v[112:113], v80 offset:4096
    ds_read_b64_tr_b16 v[114:115], v80 offset:5120
    buffer_load_dwordx4 v[176:179], v14, s[40:43], s39 offen offset:0 sc1
    s_add_u32 s76, s76, 3
    s_and_b32 s76, s76, 15
    s_lshl_b32 s15, s76, 13
    v_mfma_f32_32x32x16_bf16 v[32:47], v[124:127], v[128:131], v[32:47]
    ds_read_b64_tr_b16 v[116:117], v81 offset:4096
    ds_read_b64_tr_b16 v[118:119], v81 offset:5120
    s_waitcnt vmcnt(11) lgkmcnt(4)
    v_mfma_f32_32x32x16_bf16 v[16:31], v[104:107], v[132:135], v[16:31]
    ds_read_b64_tr_b16 v[120:121], v80 offset:6144
    ds_read_b64_tr_b16 v[122:123], v80 offset:7168
    buffer_load_dwordx4 v[180:183], v14, s[40:43], s39 offen offset:2048 sc1
    v_mfma_f32_32x32x16_bf16 v[32:47], v[108:111], v[132:135], v[32:47]
    ds_read_b64_tr_b16 v[124:125], v81 offset:6144
    ds_read_b64_tr_b16 v[126:127], v81 offset:7168
    v_add_u32 v82, s13, v72
    v_add_u32 v83, s13, v73
    s_waitcnt vmcnt(11) lgkmcnt(4)
    v_mfma_f32_32x32x16_bf16 v[16:31], v[112:115], v[136:139], v[16:31]
    ds_read_b32 v79, v8 offset:25984
    ds_read_b64_tr_b16 v[104:105], v82 offset:0
    ds_read_b64_tr_b16 v[106:107], v82 offset:1024
    buffer_load_dwordx4 v[184:187], v78, s[40:43], s39 offen offset:0 sc1
    v_mfma_f32_32x32x16_bf16 v[32:47], v[116:119], v[136:139], v[32:47]
    ds_read_b64_tr_b16 v[108:109], v83 offset:0
    ds_read_b64_tr_b16 v[110:111], v83 offset:1024
    s_waitcnt vmcnt(11) lgkmcnt(4)
    v_mfma_f32_32x32x16_bf16 v[16:31], v[120:123], v[140:143], v[16:31]
    ds_read_b64_tr_b16 v[112:113], v82 offset:2048
    ds_read_b64_tr_b16 v[114:115], v82 offset:3072
    buffer_load_dwordx4 v[188:191], v78, s[40:43], s39 offen offset:2048 sc1
    v_mfma_f32_32x32x16_bf16 v[32:47], v[124:127], v[140:143], v[32:47]
    ds_read_b64_tr_b16 v[116:117], v83 offset:2048
    ds_read_b64_tr_b16 v[118:119], v83 offset:3072
    v_readfirstlane_b32 s76, v79
    s_nop 0
    s_and_b32 s76, s76, s52
    s_cbranch_scc0 L_tr12
L_bk12:
    s_ff1_i32_b32 s76, s76
    s_bitset0_b32 s52, s76
    s_add_u32 s77, s76, s65
    s_and_b32 s77, s77, 15
    s_mul_i32 s77, s77, 32768
    s_add_u32 s48, s77, s80
    s_waitcnt vmcnt(11) lgkmcnt(4)
    v_mfma_f32_32x32x16_bf16 v[16:31], v[104:107], v[144:147], v[16:31]
    ds_read_b64_tr_b16 v[120:121], v82 offset:4096
    ds_read_b64_tr_b16 v[122:123], v82 offset:5120
    buffer_load_dwordx4 v[128:131], v14, s[40:43], s48 offen offset:0 sc1
    s_add_u32 s76, s76, 3
    s_and_b32 s76, s76, 15
    s_lshl_b32 s16, s76, 13
    v_mfma_f32_32x32x16_bf16 v[32:47], v[108:111], v[144:147], v[32:47]
    ds_read_b64_tr_b16 v[124:125], v83 offset:4096
    ds_read_b64_tr_b16 v[126:127], v83 offset:5120
    s_waitcnt vmcnt(11) lgkmcnt(4)
    v_mfma_f32_32x32x16_bf16 v[16:31], v[112:115], v[148:151], v[16:31]
    ds_read_b64_tr_b16 v[104:105], v82 offset:6144
    ds_read_b64_tr_b16 v[106:107], v82 offset:7168
    buffer_load_dwordx4 v[132:135], v14, s[40:43], s48 offen offset:2048 sc1
    v_mfma_f32_32x32x16_bf16 v[32:47], v[116:119], v[148:151], v[32:47]
    ds_read_b64_tr_b16 v[108:109], v83 offset:6144
    ds_read_b64_tr_b16 v[110:111], v83 offset:7168
    v_add_u32 v80, s14, v72
    v_add_u32 v81, s14, v73
    s_waitcnt vmcnt(11) lgkmcnt(4)
    v_mfma_f32_32x32x16_bf16 v[16:31], v[120:123], v[152:155], v[16:31]
    ds_read_b32 v79, v8 offset:25984
    ds_read_b64_tr_b16 v[112:113], v80 offset:0
    ds_read_b64_tr_b16 v[114:115], v80 offset:1024
    buffer_load_dwordx4 v[136:139], v78, s[40:43], s48 offen offset:0 sc1
    v_mfma_f32_32x32x16_bf16 v[32:47], v[124:127], v[152:155], v[32:47]
    ds_read_b64_tr_b16 v[116:117], v81 offset:0
    ds_read_b64_tr_b16 v[118:119], v81 offset:1024
    s_waitcnt vmcnt(11) lgkmcnt(4)
    v_mfma_f32_32x32x16_bf16 v[16:31], v[104:107], v[156:159], v[16:31]
    ds_read_b64_tr_b16 v[120:121], v80 offset:2048
    ds_read_b64_tr_b16 v[122:123], v80 offset:3072
    buffer_load_dwordx4 v[140:143], v78, s[40:43], s48 offen offset:2048 sc1
    v_mfma_f32_32x32x16_bf16 v[32:47], v[108:111], v[156:159], v[32:47]
    ds_read_b64_tr_b16 v[124:125], v81 offset:2048
    ds_read_b64_tr_b16 v[126:127], v81 offset:3072
    v_readfirstlane_b32 s76, v79
    s_nop 0
    s_and_b32 s76, s76, s52
    s_cbranch_scc0 L_tr13
L_bk13:
    s_ff1_i32_b32 s76, s76
    s_bitset0_b32 s52, s76
    s_add_u32 s77, s76, s65
    s_and_b32 s77, s77, 15
    s_mul_i32 s77, s77, 32768
    s_add_u32 s49, s77, s80
    s_waitcnt vmcnt(11) lgkmcnt(4)
    v_mfma_f32_32x32x16_bf16 v[16:31], v[112:115], v[160:163], v[16:31]
    ds_read_b64_tr_b16 v[104:105], v80 offset:4096
    ds_read_b64_tr_b16 v[106:107], v80 offset:5120
    buffer_load_dwordx4 v[144:147], v14, s[40:43], s49 offen offset:0 sc1
    s_add_u32 s76, s76, 3
    s_and_b32 s76, s76, 15
    s_lshl_b32 s17, s76, 13
    v_mfma_f32_32x32x16_bf16 v[32:47], v[116:119], v[160:163], v[32:47]
    ds_read_b64_tr_b16 v[108:109], v81 offset:4096
    ds_read_b64_tr_b16 v[110:111], v81 offset:5120
    s_waitcnt vmcnt(11) lgkmcnt(4)
    v_mfma_f32_32x32x16_bf16 v[16:31], v[120:123], v[164:167], v[16:31]
    ds_read_b64_tr_b16 v[112:113], v80 offset:6144
    ds_read_b64_tr_b16 v[114:115], v80 offset:7168
    buffer_load_dwordx4 v[148:151], v14, s[40:43], s49 offen offset:2048 sc1
    v_mfma_f32_32x32x16_bf16 v[32:47], v[124:127], v[164:167], v[32:47]
    ds_read_b64_tr_b16 v[116:117], v81 offset:6144
    ds_read_b64_tr_b16 v[118:119], v81 offset:7168
    v_add_u32 v82, s15, v72
    v_add_u32 v83, s15, v73
    s_waitcnt vmcnt(11) lgkmcnt(4)
    v_mfma_f32_32x32x16_bf16 v[16:31], v[104:107], v[168:171], v[16:31]
    ds_read_b32 v79, v8 offset:25984
    ds_read_b64_tr_b16 v[120:121], v82 offset:0
    ds_read_b64_tr_b16 v[122:123], v82 offset:1024
    buffer_load_dwordx4 v[152:155], v78, s[40:43], s49 offen offset:0 sc1
    v_mfma_f32_32x32x16_bf16 v[32:47], v[108:111], v[168:171], v[32:47]
    ds_read_b64_tr_b16 v[124:125], v83 offset:0
    ds_read_b64_tr_b16 v[126:127], v83 offset:1024
    s_waitcnt vmcnt(11) lgkmcnt(4)
    v_mfma_f32_32x32x16_bf16 v[16:31], v[112:115], v[172:175], v[16:31]
    ds_read_b64_tr_b16 v[104:105], v82 offset:2048
    ds_read_b64_tr_b16 v[106:107], v82 offset:3072
    buffer_load_dwordx4 v[156:159], v78, s[40:43], s49 offen offset:2048 sc1
    v_mfma_f32_32x32x16_bf16 v[32:47], v[116:119], v[172:175], v[32:47]
    ds_read_b64_tr_b16 v[108:109], v83 offset:2048
    ds_read_b64_tr_b16 v[110:111], v83 offset:3072
    v_readfirstlane_b32 s76, v79
    s_nop 0
    s_and_b32 s76, s76, s52
    s_cbranch_scc0 L_tr14
L_bk14:
    s_ff1_i32_b32 s76, s76
    s_bitset0_b32 s52, s76
    s_add_u32 s77, s76, s65
    s_and_b32 s77, s77, 15
    s_mul_i32 s77, s77, 32768
    s_add_u32 s50, s77, s80
    s_waitcnt vmcnt(11) lgkmcnt(4)
    v_mfma_f32_32x32x16_bf16 v[16:31], v[120:123], v[176:179], v[16:31]
    ds_read_b64_tr_b16 v[112:113], v82 offset:4096
    ds_read_b64_tr_b16 v[114:115], v82 offset:5120
    buffer_load_dwordx4 v[160:163], v14, s[40:43], s50 offen offset:0 sc1
    s_add_u32 s76, s76, 3
    s_and_b32 s76, s76, 15
    s_lshl_b32 s18, s76, 13
    v_mfma_f32_32x32x16_bf16 v[32:47], v[124:127], v[176:179], v[32:47]
    ds_read_b64_tr_b16 v[116:117], v83 offset:4096
    ds_read_b64_tr_b16 v[118:119], v83 offset:5120
    s_waitcnt vmcnt(11) lgkmcnt(4)
    v_mfma_f32_32x32x16_bf16 v[16:31], v[104:107], v[180:183], v[16:31]
    ds_read_b64_tr_b16 v[120:121], v82 offset:6144
    ds_read_b64_tr_b16 v[122:123], v82 offset:7168
    buffer_load_dwordx4 v[164:167], v14, s[40:43], s50 offen offset:2048 sc1
    v_mfma_f32_32x32x16_bf16 v[32:47], v[108:111], v[180:183], v[32:47]
    ds_read_b64_tr_b16 v[124:125], v83 offset:6144
    ds_read_b64_tr_b16 v[126:127], v83 offset:7168
    v_add_u32 v80, s16, v72
    v_add_u32 v81, s16, v73
    s_waitcnt vmcnt(11) lgkmcnt(4)
    v_mfma_f32_32x32x16_bf16 v[16:31], v[112:115], v[184:187], v[16:31]
    ds_read_b32 v79, v8 offset:25984
    ds_read_b64_tr_b16 v[104:105], v80 offset:0
    ds_read_b64_tr_b16 v[106:107], v80 offset:1024
    buffer_load_dwordx4 v[168:171], v78, s[40:43], s50 offen offset:0 sc1
    v_mfma_f32_32x32x16_bf16 v[32:47], v[116:119], v[184:187], v[32:47]
    ds_read_b64_tr_b16 v[108:109], v81 offset:0
    ds_read_b64_tr_b16 v[110:111], v81 offset:1024
    s_waitcnt vmcnt(11) lgkmcnt(4)
    v_mfma_f32_32x32x16_bf16 v[16:31], v[120:123], v[188:191], v[16:31]
    ds_read_b64_tr_b16 v[112:113], v80 offset:2048
    ds_read_b64_tr_b16 v[114:115], v80 offset:3072
    buffer_load_dwordx4 v[172:175], v78, s[40:43], s50 offen offset:2048 sc1
    v_mfma_f32_32x32x16_bf16 v[32:47], v[124:127], v[188:191], v[32:47]
    ds_read_b64_tr_b16 v[116:117], v81 offset:2048
    ds_read_b64_tr_b16 v[118:119], v81 offset:3072
    v_readfirstlane_b32 s76, v79
    s_nop 0
    s_and_b32 s76, s76, s52
    s_cbranch_scc0 L_tr15
L_bk15:
    s_ff1_i32_b32 s76, s76
    s_bitset0_b32 s52, s76
    s_add_u32 s77, s76, s65
    s_and_b32 s77, s77, 15
    s_mul_i32 s77, s77, 32768
    s_add_u32 s51, s77, s80
    s_waitcnt vmcnt(11) lgkmcnt(4)
    v_mfma_f32_32x32x16_bf16 v[16:31], v[104:107], v[128:131], v[16:31]
    ds_read_b64_tr_b16 v[120:121], v80 offset:4096
    ds_read_b64_tr_b16 v[122:123], v80 offset:5120
    buffer_load_dwordx4 v[176:179], v14, s[40:43], s51 offen offset:0 sc1
    s_add_u32 s76, s76, 3
    s_and_b32 s76, s76, 15
    s_lshl_b32 s19, s76, 13
    v_mfma_f32_32x32x16_bf16 v[32:47], v[108:111], v[128:131], v[32:47]
    ds_read_b64_tr_b16 v[124:125], v81 offset:4096
    ds_read_b64_tr_b16 v[126:127], v81 offset:5120
    s_waitcnt vmcnt(11) lgkmcnt(4)
    v_mfma_f32_32x32x16_bf16 v[16:31], v[112:115], v[132:135], v[16:31]
    ds_read_b64_tr_b16 v[104:105], v80 offset:6144
    ds_read_b64_tr_b16 v[106:107], v80 offset:7168
    buffer_load_dwordx4 v[180:183], v14, s[40:43], s51 offen offset:2048 sc1
    v_mfma_f32_32x32x16_bf16 v[32:47], v[116:119], v[132:135], v[32:47]
    ds_read_b64_tr_b16 v[108:109], v81 offset:6144
    ds_read_b64_tr_b16 v[110:111], v81 offset:7168
    v_add_u32 v82, s17, v72
    v_add_u32 v83, s17, v73
    s_waitcnt vmcnt(11) lgkmcnt(4)
    v_mfma_f32_32x32x16_bf16 v[16:31], v[120:123], v[136:139], v[16:31]
    ds_read_b64_tr_b16 v[112:113], v82 offset:0
    ds_read_b64_tr_b16 v[114:115], v82 offset:1024
    buffer_load_dwordx4 v[184:187], v78, s[40:43], s51 offen offset:0 sc1
    v_mfma_f32_32x32x16_bf16 v[32:47], v[124:127], v[136:139], v[32:47]
    ds_read_b64_tr_b16 v[116:117], v83 offset:0
    ds_read_b64_tr_b16 v[118:119], v83 offset:1024
    s_waitcnt vmcnt(11) lgkmcnt(4)
    v_mfma_f32_32x32x16_bf16 v[16:31], v[104:107], v[140:143], v[16:31]
    ds_read_b64_tr_b16 v[120:121], v82 offset:2048
    ds_read_b64_tr_b16 v[122:123], v82 offset:3072
    buffer_load_dwordx4 v[188:191], v78, s[40:43], s51 offen offset:2048 sc1
    s_barrier
    v_mfma_f32_32x32x16_bf16 v[32:47], v[108:111], v[140:143], v[32:47]
    ds_read_b64_tr_b16 v[124:125], v83 offset:2048
    ds_read_b64_tr_b16 v[126:127], v83 offset:3072
    s_waitcnt vmcnt(11) lgkmcnt(4)
    v_mfma_f32_32x32x16_bf16 v[16:31], v[112:115], v[144:147], v[16:31]
    ds_read_b64_tr_b16 v[104:105], v82 offset:4096
    ds_read_b64_tr_b16 v[106:107], v82 offset:5120
    v_mfma_f32_32x32x16_bf16 v[32:47], v[116:119], v[144:147], v[32:47]
    ds_read_b64_tr_b16 v[108:109], v83 offset:4096
    ds_read_b64_tr_b16 v[110:111], v83 offset:5120
    s_waitcnt vmcnt(10) lgkmcnt(4)
    v_mfma_f32_32x32x16_bf16 v[16:31], v[120:123], v[148:151], v[16:31]
    ds_read_b64_tr_b16 v[112:113], v82 offset:6144
    ds_read_b64_tr_b16 v[114:115], v82 offset:7168
    v_mfma_f32_32x32x16_bf16 v[32:47], v[124:127], v[148:151], v[32:47]
    ds_read_b64_tr_b16 v[116:117], v83 offset:6144
    ds_read_b64_tr_b16 v[118:119], v83 offset:7168
    v_add_u32 v80, s18, v72
    v_add_u32_e64 v81, s18, v73
    s_waitcnt vmcnt(9) lgkmcnt(4)
    v_mfma_f32_32x32x16_bf16 v[16:31], v[104:107], v[152:155], v[16:31]
    ds_read_b64_tr_b16 v[120:121], v80 offset:0
    ds_read_b64_tr_b16 v[122:123], v80 offset:1024
    v_mfma_f32_32x32x16_bf16 v[32:47], v[108:111], v[152:155], v[32:47]
    ds_read_b64_tr_b16 v[124:125], v81 offset:0
    ds_read_b64_tr_b16 v[126:127], v81 offset:1024
    s_waitcnt vmcnt(8) lgkmcnt(4)
    v_mfma_f32_32x32x16_bf16 v[16:31], v[112:115], v[156:159], v[16:31]
    ds_read_b64_tr_b16 v[104:105], v80 offset:2048
    ds_read_b64_tr_b16 v[106:107], v80 offset:3072
    v_mfma_f32_32x32x16_bf16 v[32:47], v[116:119], v[156:159], v[32:47]
    ds_read_b64_tr_b16 v[108:109], v81 offset:2048
    ds_read_b64_tr_b16 v[110:111], v81 offset:3072
    s_waitcnt vmcnt(7) lgkmcnt(4)
    v_mfma_f32_32x32x16_bf16 v[16:31], v[120:123], v[160:163], v[16:31]
    ds_read_b64_tr_b16 v[112:113], v80 offset:4096
    ds_read_b64_tr_b16 v[114:115], v80 offset:5120
    v_mfma_f32_32x32x16_bf16 v[32:47], v[124:127], v[160:163], v[32:47]
    ds_read_b64_tr_b16 v[116:117], v81 offset:4096
    ds_read_b64_tr_b16 v[118:119], v81 offset:5120
    s_waitcnt vmcnt(6) lgkmcnt(4)
    v_mfma_f32_32x32x16_bf16 v[16:31], v[104:107], v[164:167], v[16:31]
    ds_read_b64_tr_b16 v[120:121], v80 offset:6144
    ds_read_b64_tr_b16 v[122:123], v80 offset:7168
    v_mfma_f32_32x32x16_bf16 v[32:47], v[108:111], v[164:167], v[32:47]
    ds_read_b64_tr_b16 v[124:125], v81 offset:6144
    ds_read_b64_tr_b16 v[126:127], v81 offset:7168
    v_add_u32 v82, s19, v72
    v_add_u32 v83, s19, v73
    s_waitcnt vmcnt(5) lgkmcnt(4)
    v_mfma_f32_32x32x16_bf16 v[16:31], v[112:115], v[168:171], v[16:31]
    ds_read_b64_tr_b16 v[104:105], v82 offset:0
    ds_read_b64_tr_b16 v[106:107], v82 offset:1024
    v_mfma_f32_32x32x16_bf16 v[32:47], v[116:119], v[168:171], v[32:47]
    ds_read_b64_tr_b16 v[108:109], v83 offset:0
    ds_read_b64_tr_b16 v[110:111], v83 offset:1024
    s_waitcnt vmcnt(4) lgkmcnt(4)
    v_mfma_f32_32x32x16_bf16 v[16:31], v[120:123], v[172:175], v[16:31]
    ds_read_b64_tr_b16 v[112:113], v82 offset:2048
    ds_read_b64_tr_b16 v[114:115], v82 offset:3072
    v_mfma_f32_32x32x16_bf16 v[32:47], v[124:127], v[172:175], v[32:47]
    ds_read_b64_tr_b16 v[116:117], v83 offset:2048
    ds_read_b64_tr_b16 v[118:119], v83 offset:3072
    s_waitcnt vmcnt(3) lgkmcnt(4)
    v_mfma_f32_32x32x16_bf16 v[16:31], v[104:107], v[176:179], v[16:31]
    ds_read_b64_tr_b16 v[120:121], v82 offset:4096
    ds_read_b64_tr_b16 v[122:123], v82 offset:5120
    v_mfma_f32_32x32x16_bf16 v[32:47], v[108:111], v[176:179], v[32:47]
    ds_read_b64_tr_b16 v[124:125], v83 offset:4096
    ds_read_b64_tr_b16 v[126:127], v83 offset:5120
    s_waitcnt vmcnt(2) lgkmcnt(4)
    v_mfma_f32_32x32x16_bf16 v[16:31], v[112:115], v[180:183], v[16:31]
    ds_read_b64_tr_b16 v[104:105], v82 offset:6144
    ds_read_b64_tr_b16 v[106:107], v82 offset:7168
    v_mfma_f32_32x32x16_bf16 v[32:47], v[116:119], v[180:183], v[32:47]
    ds_read_b64_tr_b16 v[108:109], v83 offset:6144
    ds_read_b64_tr_b16 v[110:111], v83 offset:7168
    s_waitcnt vmcnt(1) lgkmcnt(4)
    v_mfma_f32_32x32x16_bf16 v[16:31], v[120:123], v[184:187], v[16:31]
    v_mfma_f32_32x32x16_bf16 v[32:47], v[124:127], v[184:187], v[32:47]
    s_waitcnt vmcnt(0) lgkmcnt(0)
    v_mfma_f32_32x32x16_bf16 v[16:31], v[104:107], v[188:191], v[16:31]
    v_mfma_f32_32x32x16_bf16 v[32:47], v[108:111], v[188:191], v[32:47]
    s_nop 10
    v_cvt_pk_bf16_f32 v88, v16, v17
    v_cvt_pk_bf16_f32 v89, v18, v19
    v_cvt_pk_bf16_f32 v90, v20, v21
    v_cvt_pk_bf16_f32 v91, v22, v23
    v_cvt_pk_bf16_f32 v92, v24, v25
    v_cvt_pk_bf16_f32 v93, v26, v27
    v_cvt_pk_bf16_f32 v94, v28, v29
    v_cvt_pk_bf16_f32 v95, v30, v31
    v_cvt_pk_bf16_f32 v96, v32, v33
    v_cvt_pk_bf16_f32 v97, v34, v35
    v_cvt_pk_bf16_f32 v98, v36, v37
    v_cvt_pk_bf16_f32 v99, v38, v39
    v_cvt_pk_bf16_f32 v100, v40, v41
    v_cvt_pk_bf16_f32 v101, v42, v43
    v_cvt_pk_bf16_f32 v102, v44, v45
    v_cvt_pk_bf16_f32 v103, v46, v47
    v_dot2_f32_bf16 v104, v88, s89, 0
    v_dot2_f32_bf16 v105, v88, v88, 0
    v_dot2_f32_bf16 v106, v88, v192, 0
    v_dot2_f32_bf16 v104, v89, s89, v104
    v_dot2_f32_bf16 v105, v89, v89, v105
    v_dot2_f32_bf16 v106, v89, v193, v106
    v_dot2_f32_bf16 v104, v90, s89, v104
    v_dot2_f32_bf16 v105, v90, v90, v105
    v_dot2_f32_bf16 v106, v90, v194, v106
    v_dot2_f32_bf16 v104, v91, s89, v104
    v_dot2_f32_bf16 v105, v91, v91, v105
    v_dot2_f32_bf16 v106, v91, v195, v106
    v_dot2_f32_bf16 v104, v92, s89, v104
    v_dot2_f32_bf16 v105, v92, v92, v105
    v_dot2_f32_bf16 v106, v92, v196, v106
    v_dot2_f32_bf16 v104, v93, s89, v104
    v_dot2_f32_bf16 v105, v93, v93, v105
    v_dot2_f32_bf16 v106, v93, v197, v106
    v_dot2_f32_bf16 v104, v94, s89, v104
    v_dot2_f32_bf16 v105, v94, v94, v105
    v_dot2_f32_bf16 v106, v94, v198, v106
    v_dot2_f32_bf16 v104, v95, s89, v104
    v_dot2_f32_bf16 v105, v95, v95, v105
    v_dot2_f32_bf16 v106, v95, v199, v106
    v_dot2_f32_bf16 v104, v96, s89, v104
    v_dot2_f32_bf16 v105, v96, v96, v105
    v_dot2_f32_bf16 v106, v96, v200, v106
    v_dot2_f32_bf16 v104, v97, s89, v104
    v_dot2_f32_bf16 v105, v97, v97, v105
    v_dot2_f32_bf16 v106, v97, v201, v106
    v_dot2_f32_bf16 v104, v98, s89, v104
    v_dot2_f32_bf16 v105, v98, v98, v105
    v_dot2_f32_bf16 v106, v98, v202, v106
    v_dot2_f32_bf16 v104, v99, s89, v104
    v_dot2_f32_bf16 v105, v99, v99, v105
    v_dot2_f32_bf16 v106, v99, v203, v106
    v_dot2_f32_bf16 v104, v100, s89, v104
    v_dot2_f32_bf16 v105, v100, v100, v105
    v_dot2_f32_bf16 v106, v100, v204, v106
    v_dot2_f32_bf16 v104, v101, s89, v104
    v_dot2_f32_bf16 v105, v101, v101, v105
    v_dot2_f32_bf16 v106, v101, v205, v106
    v_dot2_f32_bf16 v104, v102, s89, v104
    v_dot2_f32_bf16 v105, v102, v102, v105
    v_dot2_f32_bf16 v106, v102, v206, v106
    v_dot2_f32_bf16 v104, v103, s89, v104
    v_dot2_f32_bf16 v105, v103, v103, v105
    v_dot2_f32_bf16 v106, v103, v207, v106
    s_lshl_b32 s76, s62, 9
    s_add_u32 s77, s76, s99
    v_mov_b32 v107, 0
    v_mov_b32 v4, v104
    v_mov_b32 v5, v105
    v_mov_b32 v6, v106
    v_permlane32_swap_b32 v104, v4
    v_permlane32_swap_b32 v105, v5
    v_permlane32_swap_b32 v106, v6
    v_add_f32 v104, v104, v4
    v_add_f32 v105, v105, v5
    v_add_f32_e64 v106, v106, v6
    s_mov_b32 exec_hi, 0
    s_bitcmp1_b32 s100, 1
    s_cbranch_scc1 L_loc_57
    buffer_store_dwordx4 v[104:107], v12, s[40:43], s77 offen offset:1024 sc1
    s_branch L_pubd_58
L_loc_57:
    buffer_store_dwordx4 v[104:107], v12, s[40:43], s77 offen offset:1024
L_pubd_58:
    s_mov_b64 exec, -1
    ds_write_b64 v64, v[88:89]
    ds_write_b64 v65, v[90:91]
    ds_write_b64 v66, v[92:93]
    ds_write_b64 v67, v[94:95]
    ds_write_b64 v68, v[96:97]
    ds_write_b64 v69, v[98:99]
    ds_write_b64 v70, v[100:101]
    ds_write_b64 v71, v[102:103]
    v_bfe_u32 v4, v1, 1, 3
    v_bfe_u32 v5, v1, 4, 1
    v_lshlrev_b32_e64 v176, 4, v4
    v_lshl_add_u32 v176, v5, 3, v176
    v_and_b32_e64 v5, 1, v1
    v_lshl_add_u32 v176, v5, 2, v176
    v_lshlrev_b32_e64 v177, 2, v2
    v_lshl_add_u32 v177, v3, 8, v177
    v_and_b32 v4, 15, v1
    v_lshrrev_b32 v5, 4, v1
    v_mul_u32_u24 v179, 149504, v4
    v_lshl_add_u32 v180, v5, 4, v179
    s_lshl_b32 s82, s97, 7
    s_lshl_b32 s79, s62, 5
    s_add_u32 s82, s82, s79
    s_lshl_b32 s79, s62, 2
    v_mov_b32_e64 v7, s79
    v_mul_u32_u24 v6, 9344, v3
    v_lshl_add_u32 v6, v2, 4, v6
    s_mul_i32 s78, s97, 149504
    s_add_u32 s78, s78, s76
    s_add_u32 s78, s78, 8388608
    s_add_u32 s48, s78, 18688
    s_add_u32 s49, s48, 18688
    s_add_u32 s50, s49, 18688
    s_add_u32 s51, s50, 18688
    s_add_u32 s52, s51, 18688
    s_add_u32 s53, s52, 18688
    s_add_u32 s54, s53, 18688
    buffer_load_dwordx4 v[112:115], v6, s[40:43], s78 offen offset:1024 sc1
    buffer_load_dwordx4 v[116:119], v6, s[40:43], s48 offen offset:1024 sc1
    buffer_load_dwordx4 v[120:123], v6, s[40:43], s49 offen offset:1024 sc1
    buffer_load_dwordx4 v[124:127], v6, s[40:43], s50 offen offset:1024 sc1
    buffer_load_dwordx4 v[128:131], v6, s[40:43], s51 offen offset:1024 sc1
    buffer_load_dwordx4 v[132:135], v6, s[40:43], s52 offen offset:1024 sc1
    buffer_load_dwordx4 v[136:139], v6, s[40:43], s53 offen offset:1024 sc1
    buffer_load_dwordx4 v[140:143], v6, s[40:43], s54 offen offset:1024 sc1
    v_dot2_f32_bf16 v76, v208, s89, 0
    v_dot2_f32_bf16 v76, v209, s89, v76
    v_dot2_f32_bf16 v76, v210, s89, v76
    v_dot2_f32_bf16 v76, v211, s89, v76
    v_dot2_f32_bf16 v76, v212, s89, v76
    v_dot2_f32_bf16 v76, v213, s89, v76
    v_dot2_f32_bf16 v76, v214, s89, v76
    v_dot2_f32_bf16 v76, v215, s89, v76
    s_nop 2
    v_add_f32_dpp v76, v76, v76 row_ror:8 row_mask:0xf bank_mask:0xf
    s_nop 1
    v_add_f32_dpp v76, v76, v76 row_ror:4 row_mask:0xf bank_mask:0xf
    s_nop 1
    v_add_f32_dpp v76, v76, v76 row_ror:2 row_mask:0xf bank_mask:0xf
    s_nop 1
    v_add_f32_dpp v76, v76, v76 row_ror:1 row_mask:0xf bank_mask:0xf
    v_mov_b32 v4, v76
    s_nop 1
    v_permlane16_swap_b32 v76, v4
    v_add_f32 v76, v76, v4
    v_mov_b32 v4, v76
    s_nop 1
    v_permlane32_swap_b32 v76, v4
    v_add_f32 v76, v76, v4
    s_mov_b32 s88, 0
    s_branch L_s3first_59
L_s3_60:
    v_cmp_eq_u32 vcc, -1, v112
    s_nop 0
    s_cbranch_vccz L_s3skip_61
    buffer_load_dwordx4 v[112:115], v6, s[40:43], s78 offen offset:1024 sc1
L_s3skip_61:
    v_cmp_eq_u32_e64 vcc, -1, v116
    s_nop 0
    s_cbranch_vccz L_s3skip_62
    buffer_load_dwordx4 v[116:119], v6, s[40:43], s48 offen offset:1024 sc1
L_s3skip_62:
    v_cmp_eq_u32_e64 vcc, -1, v120
    s_nop 0
    s_cbranch_vccz L_s3skip_63
    buffer_load_dwordx4 v[120:123], v6, s[40:43], s49 offen offset:1024 sc1
L_s3skip_63:
    v_cmp_eq_u32_e64 vcc, -1, v124
    s_nop 0
    s_cbranch_vccz L_s3skip_64
    buffer_load_dwordx4 v[124:127], v6, s[40:43], s50 offen offset:1024 sc1
L_s3skip_64:
    v_cmp_eq_u32_e64 vcc, -1, v128
    s_nop 0
    s_cbranch_vccz L_s3skip_65
    buffer_load_dwordx4 v[128:131], v6, s[40:43], s51 offen offset:1024 sc1
L_s3skip_65:
    v_cmp_eq_u32_e64 vcc, -1, v132
    s_nop 0
    s_cbranch_vccz L_s3skip_66
    buffer_load_dwordx4 v[132:135], v6, s[40:43], s52 offen offset:1024 sc1
L_s3skip_66:
    v_cmp_eq_u32_e64 vcc, -1, v136
    s_nop 0
    s_cbranch_vccz L_s3skip_67
    buffer_load_dwordx4 v[136:139], v6, s[40:43], s53 offen offset:1024 sc1
L_s3skip_67:
    v_cmp_eq_u32_e64 vcc, -1, v140
    s_nop 0
    s_cbranch_vccz L_s3skip_68
    buffer_load_dwordx4 v[140:143], v6, s[40:43], s54 offen offset:1024 sc1
L_s3skip_68:
L_s3first_59:
    s_waitcnt vmcnt(0)
    v_max3_u32 v4, v112, v116, v120
    v_max3_u32 v4, v4, v124, v128
    v_max3_u32 v4, v4, v132, v136
    v_max_u32 v4, v4, v140
    v_cmp_eq_u32 vcc, -1, v4
    s_nop 0
    s_cbranch_vccz L_ok_69
    s_add_u32 s88, s88, 1
    s_cmp_lt_u32 s88, 65536
    s_cbranch_scc1 L_s3_60
L_ok_69:
    s_barrier
    v_pk_add_f32 v[112:113], v[112:113], v[128:129]
    v_pk_add_f32 v[114:115], v[114:115], v[130:131]
    v_pk_add_f32 v[116:117], v[116:117], v[132:133]
    v_pk_add_f32 v[118:119], v[118:119], v[134:135]
    v_pk_add_f32 v[120:121], v[120:121], v[136:137]
    v_pk_add_f32 v[122:123], v[122:123], v[138:139]
    v_pk_add_f32 v[124:125], v[124:125], v[140:141]
    v_pk_add_f32 v[126:127], v[126:127], v[142:143]
    v_pk_add_f32 v[112:113], v[112:113], v[120:121]
    v_pk_add_f32 v[114:115], v[114:115], v[122:123]
    v_pk_add_f32 v[116:117], v[116:117], v[124:125]
    v_pk_add_f32 v[118:119], v[118:119], v[126:127]
    v_pk_add_f32 v[112:113], v[112:113], v[116:117]
    v_pk_add_f32 v[114:115], v[114:115], v[118:119]
    v_mov_b32 v4, v112
    v_mov_b32 v5, v113
    v_mov_b32 v6, v114
    v_permlane32_swap_b32 v112, v4
    v_permlane32_swap_b32 v113, v5
    v_permlane32_swap_b32 v114, v6
    v_add_f32 v112, v112, v4
    v_add_f32 v113, v113, v5
    v_add_f32_e64 v114, v114, v6
    v_mul_f32 v112, 0x3a800000, v112
    v_mul_f32 v113, 0x3a800000, v113
    v_fma_f32 v4, -v112, v112, v113
    v_max_f32_e64 v4, 0, v4
    v_cvt_pk_bf16_f32 v116, v112, v112
    v_and_b32_e64 v116, s90, v116
    v_cvt_pk_bf16_f32 v4, v4, v4
    v_and_b32_e64 v4, s90, v4
    v_add_f32 v4, 0x3727c5ac, v4
    v_cvt_pk_bf16_f32 v4, v4, v4
    v_and_b32 v4, s90, v4
    v_sqrt_f32_e64 v4, v4
    s_nop 0
    v_cvt_pk_bf16_f32 v4, v4, v4
    v_and_b32 v4, s90, v4
    v_rcp_f32 v118, v4
    v_fma_f32 v120, -v116, v76, v114
    v_mul_f32 v119, v116, v118
    v_mul_f32 v120, v120, v118
    v_mov_b32 v6, 0
    s_lshl_b32 s83, s62, 12
    v_max_f32_dpp v4, v120, v120 row_ror:8 row_mask:0xf bank_mask:0xf
    s_nop 1
    v_max_f32_dpp v4, v4, v4 row_ror:4 row_mask:0xf bank_mask:0xf
    s_nop 1
    v_max_f32_dpp v4, v4, v4 row_ror:2 row_mask:0xf bank_mask:0xf
    s_nop 1
    v_max_f32_dpp v4, v4, v4 row_ror:1 row_mask:0xf bank_mask:0xf
    v_mov_b32 v5, v4
    s_nop 1
    v_permlane16_swap_b32 v4, v5
    v_max_f32_e64 v4, v4, v5
    ds_write_b32 v7, v4 offset:25600
    v_cmp_eq_f32 vcc, v4, v120
    s_nop 0
    s_ff1_i32_b32 s77, vcc_lo
    s_and_b32 s77, s77, 31
    s_bfe_u32 s79, s77, 0x30001
    s_lshl_b32 s79, s79, 4
    s_lshl_b32 s80, s77, 7
    s_add_u32 s80, s80, s83
    s_or_b32 s79, s79, s80
    v_xor_b32_e64 v176, s79, v176
    s_waitcnt lgkmcnt(0)
    s_barrier
    ds_read_b32 v182, v176 offset:0
    ds_read_b128 v[8:11], v6 offset:25600
    v_readlane_b32 s80, v118, s77
    v_readlane_b32 s81, v119, s77
    s_add_u32 s79, s82, s77
    v_writelane_b32 v4, s79, 33
    v_mov_b32 v5, s81
    v_cmp_gt_u32 s[84:85], 32, v1
    s_mov_b32 s83, 3
    s_waitcnt lgkmcnt(1)
    v_lshlrev_b32 v184, 16, v182
    v_and_b32 v185, s90, v182
    v_fma_f32 v184, v184, s80, -v5
    v_fma_f32 v185, v185, s80, -v5
    v_cvt_pk_bf16_f32 v184, v184, v185
    s_waitcnt lgkmcnt(0)
    v_max3_f32 v5, v8, v9, v10
    v_max_f32 v5, v5, v11
    v_cndmask_b32 v184, v4, v184, s[84:85]
    v_cmp_eq_f32 vcc, v5, v10
    s_nop 0
    s_cmp_lg_u32 vcc_lo, 0
    s_cselect_b32 s83, 2, s83
    v_cmp_eq_f32 vcc, v5, v9
    s_nop 0
    s_cmp_lg_u32 vcc_lo, 0
    s_cselect_b32 s83, 1, s83
    v_cmp_eq_f32_e64 vcc, v5, v8
    s_nop 0
    s_cmp_lg_u32 vcc_lo, 0
    s_cselect_b32 s83, 0, s83
    s_cmp_eq_u32 s83, s62
    s_cbranch_scc0 L_nopub_70
    s_mov_b32 exec_hi, -1
    buffer_store_dword v184, v177, s[40:43], s99 offen offset:0 sc1
    s_mov_b64 exec, -1
L_nopub_70:
    v_lshlrev_b32 v16, 16, v88
    v_and_b32_e64 v17, s90, v88
    v_pk_fma_f32 v[144:145], v[16:17], v[118:119], v[118:119] op_sel:[0,0,1] op_sel_hi:[1,0,1] neg_lo:[0,0,1] neg_hi:[0,0,1]
    v_cvt_pk_bf16_f32 v124, v144, v145
    v_lshlrev_b32 v144, 16, v124
    v_and_b32 v145, s90, v124
    v_pk_add_f32 v[144:145], v[144:145], v[16:17]
    v_cvt_pk_bf16_f32 v124, v144, v145
    v_lshlrev_b32 v18, 16, v89
    v_and_b32 v19, s90, v89
    v_pk_fma_f32 v[146:147], v[18:19], v[118:119], v[118:119] op_sel:[0,0,1] op_sel_hi:[1,0,1] neg_lo:[0,0,1] neg_hi:[0,0,1]
    v_cvt_pk_bf16_f32 v125, v146, v147
    v_lshlrev_b32 v146, 16, v125
    v_and_b32 v147, s90, v125
    v_pk_add_f32 v[146:147], v[146:147], v[18:19]
    v_cvt_pk_bf16_f32 v125, v146, v147
    ds_write_b64 v64, v[124:125]
    v_lshlrev_b32 v20, 16, v90
    v_and_b32 v21, s90, v90
    v_pk_fma_f32 v[148:149], v[20:21], v[118:119], v[118:119] op_sel:[0,0,1] op_sel_hi:[1,0,1] neg_lo:[0,0,1] neg_hi:[0,0,1]
    v_cvt_pk_bf16_f32 v126, v148, v149
    v_lshlrev_b32 v148, 16, v126
    v_and_b32 v149, s90, v126
    v_pk_add_f32 v[148:149], v[148:149], v[20:21]
    v_cvt_pk_bf16_f32 v126, v148, v149
    v_lshlrev_b32 v22, 16, v91
    v_and_b32 v23, s90, v91
    v_pk_fma_f32 v[150:151], v[22:23], v[118:119], v[118:119] op_sel:[0,0,1] op_sel_hi:[1,0,1] neg_lo:[0,0,1] neg_hi:[0,0,1]
    v_cvt_pk_bf16_f32 v127, v150, v151
    v_lshlrev_b32 v150, 16, v127
    v_and_b32 v151, s90, v127
    v_pk_add_f32 v[150:151], v[150:151], v[22:23]
    v_cvt_pk_bf16_f32 v127, v150, v151
    ds_write_b64 v65, v[126:127]
    v_lshlrev_b32 v24, 16, v92
    v_and_b32 v25, s90, v92
    v_pk_fma_f32 v[152:153], v[24:25], v[118:119], v[118:119] op_sel:[0,0,1] op_sel_hi:[1,0,1] neg_lo:[0,0,1] neg_hi:[0,0,1]
    v_cvt_pk_bf16_f32 v128, v152, v153
    v_lshlrev_b32 v152, 16, v128
    v_and_b32 v153, s90, v128
    v_pk_add_f32 v[152:153], v[152:153], v[24:25]
    v_cvt_pk_bf16_f32 v128, v152, v153
    v_lshlrev_b32 v26, 16, v93
    v_and_b32 v27, s90, v93
    v_pk_fma_f32 v[154:155], v[26:27], v[118:119], v[118:119] op_sel:[0,0,1] op_sel_hi:[1,0,1] neg_lo:[0,0,1] neg_hi:[0,0,1]
    v_cvt_pk_bf16_f32 v129, v154, v155
    v_lshlrev_b32 v154, 16, v129
    v_and_b32 v155, s90, v129
    v_pk_add_f32 v[154:155], v[154:155], v[26:27]
    v_cvt_pk_bf16_f32 v129, v154, v155
    ds_write_b64 v66, v[128:129]
    v_lshlrev_b32 v28, 16, v94
    v_and_b32 v29, s90, v94
    v_pk_fma_f32 v[156:157], v[28:29], v[118:119], v[118:119] op_sel:[0,0,1] op_sel_hi:[1,0,1] neg_lo:[0,0,1] neg_hi:[0,0,1]
    v_cvt_pk_bf16_f32 v130, v156, v157
    v_lshlrev_b32 v156, 16, v130
    v_and_b32 v157, s90, v130
    v_pk_add_f32 v[156:157], v[156:157], v[28:29]
    v_cvt_pk_bf16_f32 v130, v156, v157
    v_lshlrev_b32 v30, 16, v95
    v_and_b32 v31, s90, v95
    v_pk_fma_f32 v[158:159], v[30:31], v[118:119], v[118:119] op_sel:[0,0,1] op_sel_hi:[1,0,1] neg_lo:[0,0,1] neg_hi:[0,0,1]
    v_cvt_pk_bf16_f32 v131, v158, v159
    v_lshlrev_b32 v158, 16, v131
    v_and_b32 v159, s90, v131
    v_pk_add_f32 v[158:159], v[158:159], v[30:31]
    v_cvt_pk_bf16_f32 v131, v158, v159
    ds_write_b64 v67, v[130:131]
    v_and_b32 v7, 15, v1
    v_lshlrev_b32 v7, 3, v7
    s_cmp_eq_u32 s62, 0
    s_cbranch_scc0 L_nos4_71
    s_mul_i32 s76, s98, 9344
    s_add_u32 s76, s76, 8388608
    s_mov_b32 s88, 0
L_poll_72:
    buffer_load_dwordx2 v[196:197], v179, s[40:43], s76 offen offset:256 sc1
    buffer_load_dwordx4 v[188:191], v180, s[40:43], s76 offen offset:0 sc1
    buffer_load_dwordx4 v[192:195], v180, s[40:43], s76 offen offset:64 sc1
    s_waitcnt vmcnt(0)
    v_max3_u32 v4, v196, v197, v188
    v_max3_u32 v4, v4, v189, v190
    v_max3_u32 v4, v4, v191, v192
    v_max3_u32 v4, v4, v193, v194
    v_max_u32 v4, v4, v195
    v_cmp_eq_u32_e64 vcc, -1, v4
    s_nop 0
    s_cbranch_vccz L_ok_73
    s_add_u32 s88, s88, 1
    s_cmp_lt_u32 s88, 65536
    s_cbranch_scc1 L_poll_72
L_ok_73:
    ds_write_b128 v12, v[188:191] offset:28672
    ds_write_b128 v12, v[192:195] offset:29696
    ds_write_b64 v7, v[196:197] offset:25728
L_nos4_71:
    s_waitcnt lgkmcnt(0)
    s_barrier
    ds_read_b64 v[8:9], v7 offset:25728
    s_waitcnt lgkmcnt(0)
    v_max_f32_dpp v4, v8, v8 row_ror:8 row_mask:0xf bank_mask:0xf
    s_nop 1
    v_max_f32_dpp v4, v4, v4 row_ror:4 row_mask:0xf bank_mask:0xf
    s_nop 1
    v_max_f32_dpp v4, v4, v4 row_ror:2 row_mask:0xf bank_mask:0xf
    s_nop 1
    v_max_f32_dpp v4, v4, v4 row_ror:1 row_mask:0xf bank_mask:0xf
    v_cmp_eq_f32 vcc, v4, v8
    s_nop 0
    s_ff1_i32_b32 s92, vcc_lo
    s_and_b32 s92, s92, 15
    s_nop 3
    v_readlane_b32 s91, v9, s92
    s_nop 0
    s_cmp_eq_u32 s91, s79
    s_cbranch_scc0 L_noh_74
    s_mov_b32 exec_hi, 0
    buffer_store_dword v182, v177, s[40:43], s99 offen offset:128 sc1
    s_mov_b64 exec, -1
L_noh_74:
    s_sub_u32 s77, s91, s82
    v_lshrrev_b32 v7, 3, v1
    v_sub_u32 v5, s77, v7
    v_mov_b32 v6, 2146435072
    v_and_b32 v8, 7, v1
    v_lshrrev_b32 v9, 4, v1
    v_xor_b32 v8, v8, v9
    v_lshlrev_b32 v8, 4, v8
    v_lshl_add_u32 v7, v7, 11, v8
    v_xor_b32 v8, 64, v7
    s_lshl_b32 s76, s82, 11
    s_lshl_b32 s79, s98, 7
    s_add_u32 s76, s76, s79
    v_cmp_eq_u32 vcc, 0, v5
    s_nop 1
    v_cndmask_b32 v200, v7, v6, vcc
    v_cmp_eq_u32 vcc, 8, v5
    s_nop 1
    v_cndmask_b32 v201, v8, v6, vcc
    v_cmp_eq_u32 vcc, 16, v5
    s_nop 1
    v_cndmask_b32 v202, v7, v6, vcc
    v_cmp_eq_u32 vcc, 24, v5
    s_nop 1
    v_cndmask_b32 v203, v8, v6, vcc
    v_lshlrev_b32 v32, 16, v96
    v_and_b32 v33, s90, v96
    v_pk_fma_f32 v[160:161], v[32:33], v[118:119], v[118:119] op_sel:[0,0,1] op_sel_hi:[1,0,1] neg_lo:[0,0,1] neg_hi:[0,0,1]
    v_cvt_pk_bf16_f32 v132, v160, v161
    v_lshlrev_b32 v160, 16, v132
    v_and_b32 v161, s90, v132
    v_pk_add_f32 v[160:161], v[160:161], v[32:33]
    v_cvt_pk_bf16_f32 v132, v160, v161
    v_lshlrev_b32 v34, 16, v97
    v_and_b32 v35, s90, v97
    v_pk_fma_f32 v[162:163], v[34:35], v[118:119], v[118:119] op_sel:[0,0,1] op_sel_hi:[1,0,1] neg_lo:[0,0,1] neg_hi:[0,0,1]
    v_cvt_pk_bf16_f32 v133, v162, v163
    v_lshlrev_b32 v162, 16, v133
    v_and_b32 v163, s90, v133
    v_pk_add_f32 v[162:163], v[162:163], v[34:35]
    v_cvt_pk_bf16_f32 v133, v162, v163
    ds_write_b64 v68, v[132:133]
    v_lshlrev_b32 v36, 16, v98
    v_and_b32 v37, s90, v98
    v_pk_fma_f32 v[164:165], v[36:37], v[118:119], v[118:119] op_sel:[0,0,1] op_sel_hi:[1,0,1] neg_lo:[0,0,1] neg_hi:[0,0,1]
    v_cvt_pk_bf16_f32 v134, v164, v165
    v_lshlrev_b32 v164, 16, v134
    v_and_b32 v165, s90, v134
    v_pk_add_f32 v[164:165], v[164:165], v[36:37]
    v_cvt_pk_bf16_f32 v134, v164, v165
    v_lshlrev_b32 v38, 16, v99
    v_and_b32 v39, s90, v99
    v_pk_fma_f32 v[166:167], v[38:39], v[118:119], v[118:119] op_sel:[0,0,1] op_sel_hi:[1,0,1] neg_lo:[0,0,1] neg_hi:[0,0,1]
    v_cvt_pk_bf16_f32 v135, v166, v167
    v_lshlrev_b32 v166, 16, v135
    v_and_b32 v167, s90, v135
    v_pk_add_f32 v[166:167], v[166:167], v[38:39]
    v_cvt_pk_bf16_f32 v135, v166, v167
    ds_write_b64 v69, v[134:135]
    s_lshl_b32 s77, s62, 12
    s_add_u32 s77, s77, 0
    v_add_u32 v4, s77, v12
    s_barrier
    v_lshlrev_b32 v40, 16, v100
    v_and_b32 v41, s90, v100
    v_pk_fma_f32 v[168:169], v[40:41], v[118:119], v[118:119] op_sel:[0,0,1] op_sel_hi:[1,0,1] neg_lo:[0,0,1] neg_hi:[0,0,1]
    v_cvt_pk_bf16_f32 v136, v168, v169
    v_lshlrev_b32 v168, 16, v136
    v_and_b32 v169, s90, v136
    v_pk_add_f32 v[168:169], v[168:169], v[40:41]
    v_cvt_pk_bf16_f32 v136, v168, v169
    v_lshlrev_b32 v42, 16, v101
    v_and_b32 v43, s90, v101
    v_pk_fma_f32 v[170:171], v[42:43], v[118:119], v[118:119] op_sel:[0,0,1] op_sel_hi:[1,0,1] neg_lo:[0,0,1] neg_hi:[0,0,1]
    v_cvt_pk_bf16_f32 v137, v170, v171
    v_lshlrev_b32 v170, 16, v137
    v_and_b32 v171, s90, v137
    v_pk_add_f32 v[170:171], v[170:171], v[42:43]
    v_cvt_pk_bf16_f32 v137, v170, v171
    ds_write_b64 v70, v[136:137]
    v_lshlrev_b32 v44, 16, v102
    v_and_b32 v45, s90, v102
    v_pk_fma_f32 v[172:173], v[44:45], v[118:119], v[118:119] op_sel:[0,0,1] op_sel_hi:[1,0,1] neg_lo:[0,0,1] neg_hi:[0,0,1]
    v_cvt_pk_bf16_f32 v138, v172, v173
    v_lshlrev_b32 v172, 16, v138
    v_and_b32 v173, s90, v138
    v_pk_add_f32 v[172:173], v[172:173], v[44:45]
    v_cvt_pk_bf16_f32 v138, v172, v173
    v_lshlrev_b32 v46, 16, v103
    v_and_b32 v47, s90, v103
    v_pk_fma_f32 v[174:175], v[46:47], v[118:119], v[118:119] op_sel:[0,0,1] op_sel_hi:[1,0,1] neg_lo:[0,0,1] neg_hi:[0,0,1]
    v_cvt_pk_bf16_f32 v139, v174, v175
    v_lshlrev_b32 v174, 16, v139
    v_and_b32 v175, s90, v139
    v_pk_add_f32 v[174:175], v[174:175], v[46:47]
    v_cvt_pk_bf16_f32 v139, v174, v175
    ds_write_b64 v71, v[138:139]
    s_waitcnt lgkmcnt(0)
    ds_read_b128 v[48:51], v4 offset:0
    ds_read_b128 v[52:55], v4 offset:1024
    ds_read_b128 v[56:59], v4 offset:2048
    ds_read_b128 v[60:63], v4 offset:3072
    s_waitcnt lgkmcnt(3)
    buffer_store_dwordx4 v[48:51], v200, s[44:47], s76 offen sc1
    s_add_u32 s76, s76, 16384
    s_waitcnt lgkmcnt(2)
    buffer_store_dwordx4 v[52:55], v201, s[44:47], s76 offen sc1
    s_add_u32 s76, s76, 16384
    s_waitcnt lgkmcnt(1)
    buffer_store_dwordx4 v[56:59], v202, s[44:47], s76 offen sc1
    s_add_u32 s76, s76, 16384
    s_waitcnt lgkmcnt(0)
    buffer_store_dwordx4 v[60:63], v203, s[44:47], s76 offen sc1
L_cfin:
L_end:
    s_endpgm
L_tr0:
    s_call_b64 s[54:55], L_stall
    s_branch L_bk0
L_tr1:
    s_call_b64 s[54:55], L_stall
    s_branch L_bk1
L_tr2:
    s_call_b64 s[54:55], L_stall
    s_branch L_bk2
L_tr3:
    s_call_b64 s[54:55], L_stall
    s_branch L_bk3
L_tr4:
    s_call_b64 s[54:55], L_stall
    s_branch L_bk4
L_tr5:
    s_call_b64 s[54:55], L_stall
    s_branch L_bk5
L_tr6:
    s_call_b64 s[54:55], L_stall
    s_branch L_bk6
L_tr7:
    s_call_b64 s[54:55], L_stall
    s_branch L_bk7
L_tr8:
    s_call_b64 s[54:55], L_stall
    s_branch L_bk8
L_tr9:
    s_call_b64 s[54:55], L_stall
    s_branch L_bk9
L_tr10:
    s_call_b64 s[54:55], L_stall
    s_branch L_bk10
L_tr11:
    s_call_b64 s[54:55], L_stall
    s_branch L_bk11
L_tr12:
    s_call_b64 s[54:55], L_stall
    s_branch L_bk12
L_tr13:
    s_call_b64 s[54:55], L_stall
    s_branch L_bk13
L_tr14:
    s_call_b64 s[54:55], L_stall
    s_branch L_bk14
L_tr15:
    s_call_b64 s[54:55], L_stall
    s_branch L_bk15
L_stall:
    s_cmp_eq_u32 s53, 0
    s_cbranch_scc0 L_sent_56
    s_waitcnt vmcnt(0)
    s_mov_b64 exec, 1
    ds_add_u32 v8, v74 offset:25988
    s_mov_b64 exec, -1
    s_mov_b32 s53, 1
L_sent_56:
    s_mov_b32 s88, 0
L_stall1:
    ds_read_b32 v79, v8 offset:25984
    s_waitcnt lgkmcnt(0)
    v_readfirstlane_b32 s76, v79
    s_nop 0
    s_and_b32 s76, s76, s52
    s_cbranch_scc1 L_stall2
    s_add_u32 s88, s88, 1
    s_cmp_lt_u32 s88, 1048576
    s_cbranch_scc1 L_stall1
    s_mov_b32 s76, s52
L_stall2:
    s_setpc_b64 s[54:55]
L_code_end:
s_endpgm
.p2align 7
.type L_table,@object
L_table:
.long 0xf54b3721, 0xedca986, 0x40102, 0x3005
.long 0x65c03824, 0xfedba97, 0x400201, 0x3050
.long 0x6d419035, 0xfecba87, 0x4000120, 0x3500
.long 0x76543218, 0xfedcba9, 0x40000012, 0x5300
.long 0xf54b3721, 0xedca986, 0x14002, 0x3005
.long 0x65c03824, 0xfedba97, 0x400120, 0x3050
.long 0x6d419035, 0xfecba87, 0x4002001, 0x3500
.long 0x5e4a2160, 0xfdcb987, 0x41020000, 0x5300
.long 0xf54b3721, 0xedca986, 0x10040200, 0x3005
.long 0x65c03824, 0xfedba97, 0x400012, 0x3050
.long 0x6d419035, 0xfecba87, 0x1402000, 0x3500
.long 0x76543218, 0xfedcba9, 0x41000200, 0x5300
.long 0xf54b3721, 0xedca986, 0x41200, 0x3005
.long 0x65c03824, 0xfedba97, 0x140002, 0x3050
.long 0x6d419035, 0xfecba87, 0x4001020, 0x3500
.long 0x5e4a2160, 0xfdcb987, 0x42010000, 0x5300
.long 0x65c03824, 0xfedba97, 0x400021, 0x3050
.long 0x6d419035, 0xfecba87, 0x2400010, 0x3500
.long 0x5e4a2160, 0xfdcb987, 0x42000010, 0x5300
.long 0x76543209, 0xfedcba8, 0x10040002, 0x3005
.long 0x65c03824, 0xfedba97, 0x400102, 0x3050
.long 0x6d419035, 0xfecba87, 0x4010020, 0x3500
.long 0x5e4a2160, 0xfdcb987, 0x40000021, 0x5300
.long 0xf54b3721, 0xedca986, 0x20014000, 0x3005
.long 0x65c03824, 0xfedba97, 0x140002, 0x3050
.long 0x6d419035, 0xfecba87, 0x2400001, 0x3500
.long 0x5e4a2160, 0xfdcb987, 0x40010020, 0x5300
.long 0x76543209, 0xfedcba8, 0x24001, 0x3005
.long 0x65c03824, 0xfedba97, 0x400012, 0x3050
.long 0x6d419035, 0xfecba87, 0x1400002, 0x3500
.long 0x5e4a2160, 0xfdcb987, 0x41020000, 0x5300
.long 0xf54b3721, 0xedca986, 0x10024000, 0x3005
.long 0x6d419035, 0xfecba87, 0x1400002, 0x3500
.long 0x5e4a2160, 0xfdcb987, 0x40020010, 0x5300
.long 0xf54b3721, 0xedca986, 0x14002, 0x3005
.long 0x765431a0, 0xfedcb98, 0x400021, 0x3050
.long 0x6d419035, 0xfecba87, 0x4001020, 0x3500
.long 0x5e4a2160, 0xfdcb987, 0x41000002, 0x5300
.long 0xf54b3721, 0xedca986, 0x20040001, 0x3005
.long 0x65c03824, 0xfedba97, 0x240100, 0x3050
.long 0x6d419035, 0xfecba87, 0x4002001, 0x3500
.long 0x5e4a2160, 0xfdcb987, 0x42001000, 0x5300
.long 0xf54b3721, 0xedca986, 0x20040100, 0x3005
.long 0x765431a0, 0xfedcb98, 0x410020, 0x3050
.long 0x6d419035, 0xfecba87, 0x2400010, 0x3500
.long 0x5e4a2160, 0xfdcb987, 0x42010000, 0x5300
.long 0xf54b3721, 0xedca986, 0x10024000, 0x3005
.long 0x65c03824, 0xfedba97, 0x140002, 0x3050
.long 0x5e4a2160, 0xfdcb987, 0x42000010, 0x5300
.long 0xf54b3721, 0xedca986, 0x10024000, 0x3005
.long 0x65c03824, 0xfedba97, 0x140200, 0x3050
.long 0x765421b0, 0xfedca98, 0x4200010, 0x3500
.long 0x5e4a2160, 0xfdcb987, 0x40000120, 0x5300
.long 0xf54b3721, 0xedca986, 0x20040010, 0x3005
.long 0x65c03824, 0xfedba97, 0x1400020, 0x3050
.long 0x6d419035, 0xfecba87, 0x1400020, 0x3500
.long 0x5e4a2160, 0xfdcb987, 0x40010020, 0x5300
.long 0xf54b3721, 0xedca986, 0x20040100, 0x3005
.long 0x65c03824, 0xfedba97, 0x400102, 0x3050
.long 0x765421b0, 0xfedca98, 0x4000021, 0x3500
.long 0x5e4a2160, 0xfdcb987, 0x41020000, 0x5300
.long 0xf54b3721, 0xedca986, 0x124000, 0x3005
.long 0x65c03824, 0xfedba97, 0x401002, 0x3050
.long 0x6d419035, 0xfecba87, 0x4001020, 0x3500
.long 0xf54b3721, 0xedca986, 0x10040200, 0x3005
.long 0x65c03824, 0xfedba97, 0x240001, 0x3050
.long 0x6d419035, 0xfecba87, 0x1402000, 0x3500
.long 0x76532c10, 0xfedba98, 0x40000201, 0x5300
.long 0xf54b3721, 0xedca986, 0x41200, 0x3005
.long 0x65c03824, 0xfedba97, 0x400102, 0x3050
.long 0x6d419035, 0xfecba87, 0x14000020, 0x3500
.long 0x5e4a2160, 0xfdcb987, 0x41000002, 0x5300
.long 0xf54b3721, 0xedca986, 0x24001, 0x3005
.long 0x65c03824, 0xfedba97, 0x140200, 0x3050
.long 0x6d419035, 0xfecba87, 0x4001002, 0x3500
.long 0x76532c10, 0xfedba98, 0x14000200, 0x5300
.long 0xf54b3721, 0xedca986, 0x20014000, 0x3005
.long 0x65c03824, 0xfedba97, 0x240010, 0x3050
.long 0x6d419035, 0xfecba87, 0x4002001, 0x3500
.long 0x5e4a2160, 0xfdcb987, 0x40010020, 0x5300
.long 0x65c03824, 0xfedba97, 0x140200, 0x3050
.long 0x6d419035, 0xfecba87, 0x4001020, 0x3500
.long 0x5e4a2160, 0xfdcb987, 0x40010002, 0x5300
.long 0x76432d10, 0xfecba98, 0x40201, 0x3005
.long 0x65c03824, 0xfedba97, 0x400201, 0x3050
.long 0x6d419035, 0xfecba87, 0x1400002, 0x3500
.long 0x5e4a2160, 0xfdcb987, 0x41020000, 0x5300
.long 0xf54b3721, 0xedca986, 0x10040002, 0x3005
.long 0x65c03824, 0xfedba97, 0x400120, 0x3050
.long 0x6d419035, 0xfecba87, 0x4000012, 0x3500
.long 0x5e4a2160, 0xfdcb987, 0x40000012, 0x5300
.long 0x76432d10, 0xfecba98, 0x10040200, 0x3005
.long 0x65c03824, 0xfedba97, 0x400210, 0x3050
.long 0x6d419035, 0xfecba87, 0x2400001, 0x3500
.long 0x5e4a2160, 0xfdcb987, 0x40000102, 0x5300
.long 0xf54b3721, 0xedca986, 0x14002, 0x3005
.long 0x6d419035, 0xfecba87, 0x2401000, 0x3500
.long 0x5e4a2160, 0xfdcb987, 0x42100000, 0x5300
.long 0xf54b3721, 0xedca986, 0x20014000, 0x3005
.long 0x7543e210, 0xfdcba98, 0x20401000, 0x3050
.long 0x6d419035, 0xfecba87, 0x2400010, 0x3500
.long 0x5e4a2160, 0xfdcb987, 0x42000010, 0x5300
.long 0xf54b3721, 0xedca986, 0x24001, 0x3005
.long 0x65c03824, 0xfedba97, 0x400102, 0x3050
.long 0x6d419035, 0xfecba87, 0x4000021, 0x3500
.long 0x5e4a2160, 0xfdcb987, 0x40000021, 0x5300
.long 0xf54b3721, 0xedca986, 0x40102, 0x3005
.long 0x7543e210, 0xfdcba98, 0x402100, 0x3050
.long 0x6d419035, 0xfecba87, 0x1400020, 0x3500
.long 0x5e4a2160, 0xfdcb987, 0x40010002, 0x5300
.long 0xf54b3721, 0xedca986, 0x10040002, 0x3005
.long 0x65c03824, 0xfedba97, 0x140200, 0x3050
.long 0x5e4a2160, 0xfdcb987, 0x40001002, 0x5300
.long 0xf54b3721, 0xedca986, 0x41002, 0x3005
.long 0x65c03824, 0xfedba97, 0x240001, 0x3050
.long 0x6543f210, 0xedcba98, 0x4002001, 0x3500
.long 0x5e4a2160, 0xfdcb987, 0x40000012, 0x5300
.long 0xf54b3721, 0xedca986, 0x40201, 0x3005
.long 0x65c03824, 0xfedba97, 0x1400200, 0x3050
.long 0x6d419035, 0xfecba87, 0x1402000, 0x3500
.long 0x5e4a2160, 0xfdcb987, 0x41000002, 0x5300
.long 0xf54b3721, 0xedca986, 0x14200, 0x3005
.long 0x65c03824, 0xfedba97, 0x240100, 0x3050
.long 0x6543f210, 0xedcba98, 0x2401000, 0x3500
.long 0x5e4a2160, 0xfdcb987, 0x40010020, 0x5300
.long 0xf54b3721, 0xedca986, 0x20040100, 0x3005
.long 0x65c03824, 0xfedba97, 0x140200, 0x3050
.long 0x6d419035, 0xfecba87, 0x2401000, 0x3500
.long 0xf54b3721, 0xedca986, 0x20040100, 0x3005
.long 0x65c03824, 0xfedba97, 0x140002, 0x3050
.long 0x6d419035, 0xfecba87, 0x1400002, 0x3500
.long 0x76543218, 0xfedcba9, 0x42001000, 0x5300
.long 0xf54b3721, 0xedca986, 0x10024000, 0x3005
.long 0x65c03824, 0xfedba97, 0x240001, 0x3050
.long 0x6d419035, 0xfecba87, 0x4001002, 0x3500
.long 0x5e4a2160, 0xfdcb987, 0x40010020, 0x5300
.long 0xf54b3721, 0xedca986, 0x20014000, 0x3005
.long 0x65c03824, 0xfedba97, 0x400120, 0x3050
.long 0x6d419035, 0xfecba87, 0x2400100, 0x3500
.long 0x76543218, 0xfedcba9, 0x40000102, 0x5300
.long 0xf54b3721, 0xedca986, 0x24001, 0x3005
.long 0x65c03824, 0xfedba97, 0x10400200, 0x3050
.long 0x6d419035, 0xfecba87, 0x2400001, 0x3500
.long 0x5e4a2160, 0xfdcb987, 0x41020000, 0x5300
.long 0x65c03824, 0xfedba97, 0x140002, 0x3050
.long 0x6d419035, 0xfecba87, 0x4002001, 0x3500
.long 0x5e4a2160, 0xfdcb987, 0x40000021, 0x5300
.long 0x76543209, 0xfedcba8, 0x10040020, 0x3005
.long 0x65c03824, 0xfedba97, 0x240001, 0x3050
.long 0x6d419035, 0xfecba87, 0x2410000, 0x3500
.long 0x5e4a2160, 0xfdcb987, 0x40010002, 0x5300
.long 0xf54b3721, 0xedca986, 0x10024000, 0x3005
.long 0x65c03824, 0xfedba97, 0x241000, 0x3050
.long 0x6d419035, 0xfecba87, 0x4001020, 0x3500
.long 0x5e4a2160, 0xfdcb987, 0x41020000, 0x5300
.long 0x76543209, 0xfedcba8, 0x40102, 0x3005
.long 0x65c03824, 0xfedba97, 0x240100, 0x3050
.long 0x6d419035, 0xfecba87, 0x1400020, 0x3500
.long 0x5e4a2160, 0xfdcb987, 0x42000010, 0x5300
.long 0xf54b3721, 0xedca986, 0x14200, 0x3005
.long 0x6d419035, 0xfecba87, 0x4000120, 0x3500
.long 0x5e4a2160, 0xfdcb987, 0x40000120, 0x5300
.long 0xf54b3721, 0xedca986, 0x24010, 0x3005
.long 0x765431a0, 0xfedcb98, 0x10400200, 0x3050
.long 0x6d419035, 0xfecba87, 0x1400002, 0x3500
.long 0x5e4a2160, 0xfdcb987, 0x40120000, 0x5300
.long 0xf54b3721, 0xedca986, 0x14002, 0x3005
.long 0x65c03824, 0xfedba97, 0x140020, 0x3050
.long 0x6d419035, 0xfecba87, 0x4001002, 0x3500
.long 0x5e4a2160, 0xfdcb987, 0x41020000, 0x5300
.long 0xf54b3721, 0xedca986, 0x10024000, 0x3005
.long 0x765431a0, 0xfedcb98, 0x400012, 0x3050
.long 0x6d419035, 0xfecba87, 0x4002001, 0x3500
.long 0x5e4a2160, 0xfdcb987, 0x40020010, 0x5300
.long 0xf54b3721, 0xedca986, 0x41200, 0x3005
.long 0x65c03824, 0xfedba97, 0x400120, 0x3050
.long 0x5e4a2160, 0xfdcb987, 0x41020000, 0x5300
.long 0xf54b3721, 0xedca986, 0x20040100, 0x3005
.long 0x65c03824, 0xfedba97, 0x140020, 0x3050
.long 0x765421b0, 0xfedca98, 0x4000021, 0x3500
.long 0x5e4a2160, 0xfdcb987, 0x42010000, 0x5300
.long 0xf54b3721, 0xedca986, 0x24010, 0x3005
.long 0x65c03824, 0xfedba97, 0x400102, 0x3050
.long 0x6d419035, 0xfecba87, 0x1400002, 0x3500
.long 0x5e4a2160, 0xfdcb987, 0x42000010, 0x5300
.long 0xf54b3721, 0xedca986, 0x24001, 0x3005
.long 0x65c03824, 0xfedba97, 0x401020, 0x3050
.long 0x765421b0, 0xfedca98, 0x24000010, 0x3500
.long 0x5e4a2160, 0xfdcb987, 0x12000000, 0x5304
.long 0xf54b3721, 0xedca986, 0x10040002, 0x3005
.long 0x65c03824, 0xfedba97, 0x400021, 0x3050
.long 0x6d419035, 0xfecba87, 0x4001002, 0x3500
.long 0xf54b3721, 0xedca986, 0x10024000, 0x3005
.long 0x65c03824, 0xfedba97, 0x400120, 0x3050
.long 0x6d419035, 0xfecba87, 0x2401000, 0x3500
.long 0x76532c10, 0xfedba98, 0x40002001, 0x5300
.long 0xf54b3721, 0xedca986, 0x20040001, 0x3005
.long 0x65c03824, 0xfedba97, 0x400201, 0x3050
.long 0x6d419035, 0xfecba87, 0x2400001, 0x3500
.long 0x5e4a2160, 0xfdcb987, 0x42010000, 0x5300
.long 0xf54b3721, 0xedca986, 0x40102, 0x3005
.long 0x65c03824, 0xfedba97, 0x240010, 0x3050
.long 0x6d419035, 0xfecba87, 0x1400020, 0x3500
.long 0x76532c10, 0xfedba98, 0x40020100, 0x5300
.long 0xf54b3721, 0xedca986, 0x14002, 0x3005
.long 0x65c03824, 0xfedba97, 0x401020, 0x3050
.long 0x6d419035, 0xfecba87, 0x14000002, 0x3500
.long 0x5e4a2160, 0xfdcb987, 0x41000002, 0x5300
.long 0x65c03824, 0xfedba97, 0x240001, 0x3050
.long 0x6d419035, 0xfecba87, 0x4001002, 0x3500
.long 0x5e4a2160, 0xfdcb987, 0x40020001, 0x5300
.long 0x76432d10, 0xfecba98, 0x10240000, 0x3005
.long 0x65c03824, 0xfedba97, 0x400120, 0x3050
.long 0x6d419035, 0xfecba87, 0x4002010, 0x3500
.long 0x5e4a2160, 0xfdcb987, 0x42010000, 0x5300
.long 0xf54b3721, 0xedca986, 0x10040200, 0x3005
.long 0x65c03824, 0xfedba97, 0x400210, 0x3050
.long 0x6d419035, 0xfecba87, 0x4002001, 0x3500
.long 0x5e4a2160, 0xfdcb987, 0x42000010, 0x5300
.long 0x76432d10, 0xfecba98, 0x2040100, 0x3005
.long 0x65c03824, 0xfedba97, 0x140020, 0x3050
.long 0x6d419035, 0xfecba87, 0x4012000, 0x3500
.long 0x5e4a2160, 0xfdcb987, 0x41000020, 0x5300
.long 0xf54b3721, 0xedca986, 0x20014000, 0x3005
.long 0x6d419035, 0xfecba87, 0x1402000, 0x3500
.long 0x5e4a2160, 0xfdcb987, 0x40010002, 0x5300
.long 0xf54b3721, 0xedca986, 0x14200, 0x3005
.long 0x7543e210, 0xfdcba98, 0x402001, 0x3050
.long 0x6d419035, 0xfecba87, 0x4002010, 0x3500
.long 0x5e4a2160, 0xfdcb987, 0x41000020, 0x5300
.long 0xf54b3721, 0xedca986, 0x10040200, 0x3005
.long 0x65c03824, 0xfedba97, 0x140200, 0x3050
.long 0x6d419035, 0xfecba87, 0x2400001, 0x3500
.long 0x5e4a2160, 0xfdcb987, 0x40000012, 0x5300
.long 0xf54b3721, 0xedca986, 0x40201, 0x3005
.long 0x7543e210, 0xfdcba98, 0x400120, 0x3050
.long 0x6d419035, 0xfecba87, 0x4001002, 0x3500
.long 0x5e4a2160, 0xfdcb987, 0x40100020, 0x5300
.long 0xf54b3721, 0xedca986, 0x20040100, 0x3005
.long 0x65c03824, 0xfedba97, 0x240100, 0x3050
.long 0x5e4a2160, 0xfdcb987, 0x40010020, 0x5300
.long 0xf54b3721, 0xedca986, 0x14200, 0x3005
.long 0x65c03824, 0xfedba97, 0x400102, 0x3050
.long 0x6543f210, 0xedcba98, 0x4021000, 0x3500
.long 0x5e4a2160, 0xfdcb987, 0x40020001, 0x5300
.long 0xf54b3721, 0xedca986, 0x1040002, 0x3005
.long 0x65c03824, 0xfedba97, 0x240001, 0x3050
.long 0x6d419035, 0xfecba87, 0x2401000, 0x3500
.long 0x5e4a2160, 0xfdcb987, 0x41020000, 0x5300
.long 0xf54b3721, 0xedca986, 0x40102, 0x3005
.long 0x65c03824, 0xfedba97, 0x140200, 0x3050
.long 0x6543f210, 0xedcba98, 0x4002010, 0x3500
.long 0x5e4a2160, 0xfdcb987, 0x40000012, 0x5300
.long 0xf54b3721, 0xedca986, 0x41200, 0x3005
.long 0x65c03824, 0xfedba97, 0x240010, 0x3050
.long 0x6d419035, 0xfecba87, 0x1402000, 0x3500
.fill 1, 4, 0
.size L_table, .-L_table
.section .rodata,"a"
.p2align 6
.amdhsa_kernel sequential_preLN__linear_kernel_hedgehog__moe_arch_mod__prompt_kernel
  .amdhsa_next_free_vgpr 256
  .amdhsa_next_free_sgpr 102
  .amdhsa_accum_offset 256
  .amdhsa_group_segment_fixed_size 0
  .amdhsa_kernarg_size 96
  .amdhsa_user_sgpr_count 2
  .amdhsa_user_sgpr_kernarg_segment_ptr 1
  .amdhsa_system_sgpr_workgroup_id_x 1
  .amdhsa_float_denorm_mode_32 3
.end_amdhsa_kernel
```

```asm
; @launch grid=(256,1,1) block=(512,1,1) lds=163840
.amdgcn_target "amdgcn-amd-amdhsa--gfx950"
.text
.globl sequential_preLN__linear_kernel_hedgehog__moe_arch_mod__prompt_kernel
.p2align 8
.type sequential_preLN__linear_kernel_hedgehog__moe_arch_mod__prompt_kernel,@function
sequential_preLN__linear_kernel_hedgehog__moe_arch_mod__prompt_kernel:
    s_cmp_ge_u32 s2, 256
    s_cbranch_scc1 L_end
    s_load_dwordx2 s[28:29], s[0:1], 0
    s_load_dwordx2 s[32:33], s[0:1], 8
    s_load_dwordx4 s[8:11], s[0:1], 16
    s_load_dwordx16 s[12:27], s[0:1], 32
    v_lshrrev_b32 v4, 6, v0
    v_and_b32 v1, 63, v0
    v_readfirstlane_b32 s79, v4
    s_and_b32 s76, s2, 7
    s_lshr_b32 s77, s2, 3
    s_and_b32 s60, s77, 15
    s_lshl_b32 s76, s76, 3
    s_bfe_u32 s77, s2, 0x10007
    s_lshl2_add_u32 s76, s77, s76
    s_mov_b32 s80, 0x654210b3
    s_mov_b32 s81, 0xfedca987
    s_lshr_b64 s[80:81], s[80:81], s76
    s_and_b32 s61, s80, 15
    s_and_b32 s62, s79, 3
    s_cmp_ge_u32 s79, 4
    s_cbranch_scc1 L_compute
    s_setprio 3
    s_getpc_b64 s[66:67]
L_pc:
    s_lshr_b32 s76, s2, 3
    s_lshl2_add_u32 s76, s76, s62
    s_mul_i32 s76, s76, 256
    v_lshl_add_u32 v91, v1, 7, s76
    s_mov_b64 exec, 3
    global_load_dword v27, v91, s[66:67]
    s_mov_b64 exec, -1
    s_add_u32 s84, s60, s2
    s_and_b32 s84, s84, 3
    s_and_b32 s76, s60, 7
    s_and_b32 s77, s61, 7
    s_cmp_eq_u32 s77, 3
    s_cselect_b32 s84, s76, s84
    v_lshrrev_b32 v4, 3, v1
    v_and_b32 v5, 7, v1
    v_lshrrev_b32_e64 v6, 4, v1
    s_lshl2_add_u32 s76, s60, s62
    s_lshl_b32 s76, s76, 16
    s_mul_i32 s70, s62, 10240
    v_xor_b32 v7, v5, v6
    v_lshlrev_b32 v7, 4, v7
    v_lshl_add_u32 v78, v4, 11, v7
    v_add_u32 v16, s76, v78
    v_xor_b32 v7, 64, v16
    v_add_u32 v17, 15360, v7
    v_add_u32 v18, 30720, v16
    v_add_u32 v19, 46080, v7
    s_mov_b32 s30, 4194304
    s_mov_b32 s31, 0x20000
    s_and_b32 s72, s84, 15
    s_mov_b32 m0, s70
    s_lshl_b32 s71, s72, 7
    s_waitcnt lgkmcnt(0)
    buffer_load_dwordx4 v16, s[28:31], s71 offen offset:0 lds
    s_mul_i32 s72, s72, 393216
    s_lshr_b64 s[84:85], s[84:85], 4
    buffer_load_dwordx4 v17, s[28:31], s71 offen offset:1024 lds
    buffer_load_dwordx4 v18, s[28:31], s71 offen offset:2048 lds
    buffer_load_dwordx4 v19, s[28:31], s71 offen offset:3072 lds
    v_and_b32 v6, 1, v6
    v_lshlrev_b32 v6, 2, v6
    v_xor_b32 v8, v5, v6
    v_lshlrev_b32 v8, 4, v8
    s_lshl_b32 s76, s61, 7
    s_mul_i32 s77, s62, 98304
    s_add_u32 s76, s76, s77
    v_mul_u32_u24 v7, 6144, v4
    v_add3_u32 v20, v7, v8, s76
    v_xor_b32 v7, 32, v20
    s_mov_b32 s34, 6291456
    s_mov_b32 s35, 0x20000
    s_add_u32 m0, s70, 4096
    s_nop 0
    buffer_load_dwordx4 v20, s[32:35], s72 offen offset:0 lds
    v_add_u32 v21, 48128, v7
    buffer_load_dwordx4 v21, s[32:35], s72 offen offset:1024 lds
    v_add_u32 v22, 0, v20
    buffer_load_dwordx4 v22, s[32:35], s72 offen offset:2048 lds
    v_add_u32 v23, 48128, v7
    buffer_load_dwordx4 v23, s[32:35], s72 offen offset:3072 lds
    v_add_u32 v24, 4096, v20
    s_add_u32 m0, s70, 8192
    s_nop 0
    buffer_load_dwordx4 v24, s[32:35], s72 offen offset:0 lds
    v_add_u32 v25, 52224, v7
    buffer_load_dwordx4 v25, s[32:35], s72 offen offset:1024 lds
    s_add_u32 s70, s70, 40960
    s_cmp_ge_u32 s70, 122880
    s_cselect_b32 s76, 122880, 0
    s_sub_u32 s70, s70, s76
    s_lshl_b32 s76, s60, 8
    s_lshl_b32 s77, s61, 4
    s_add_u32 s76, s76, s77
    s_add_u32 s76, s76, 29056
    s_load_dwordx4 s[84:87], s[66:67], s76
    v_lshl_add_u32 v26, v4, 11, v8
    v_xor_b32 v79, 64, v78
    s_and_b32 s63, s62, 1
    s_lshr_b32 s64, s62, 1
    s_lshl_b32 s73, s60, 4
    s_add_u32 s73, s73, s61
    s_mul_i32 s73, s73, 28800
    s_add_u32 s76, s2, 7
    s_and_b32 s76, s76, 7
    s_bfe_u32 s77, s2, 0x10003
    s_lshl1_add_u32 s97, s76, s77
    s_lshr_b32 s98, s2, 4
    s_lshl_b32 s99, s97, 4
    s_add_u32 s99, s99, s98
    s_mul_i32 s99, s99, 9344
    s_add_u32 s99, s99, 8388608
    s_lshr_b32 s65, s97, 1
    s_lshl_b32 s76, s97, 3
    s_add_u32 s65, s65, s76
    s_mul_i32 s76, s98, 4
    s_add_u32 s65, s65, s76
    s_and_b32 s65, s65, 15
    s_mov_b32 s89, 0x3f803f80
    s_mov_b32 s90, 0xffff0000
    v_and_b32 v2, 31, v1
    v_lshrrev_b32 v3, 5, v1
    v_lshlrev_b32 v12, 4, v1
    v_lshrrev_b32 v4, 3, v1
    v_mul_u32_u24 v13, 460800, v4
    v_and_b32_e64 v4, 7, v1
    v_lshl_add_u32 v13, v4, 4, v13
    s_lshl_b32 s76, s98, 7
    s_lshl_b32 s77, s62, 15
    s_add_u32 s76, s76, s77
    v_add_u32_e64 v26, s76, v26
    s_mov_b32 s40, s26
    s_and_b32 s41, s27, 0xffff
    s_mov_b32 s42, 33554432
    s_mov_b32 s43, 0x20000
    s_mov_b32 s56, s8
    s_and_b32 s57, s9, 0xffff
    s_mov_b32 s58, 65536
    s_mov_b32 s59, 0x20000
    v_mov_b32 v28, -1
    v_mov_b32 v29, -1
    v_mov_b32 v30, -1
    v_mov_b32_e64 v31, -1
    s_waitcnt lgkmcnt(0)
    s_and_b32 s72, s84, 15
    s_mov_b32 m0, s70
    s_lshl_b32 s71, s72, 7
    buffer_load_dwordx4 v16, s[28:31], s71 offen offset:0 lds
    s_mul_i32 s72, s72, 393216
    s_lshr_b64 s[84:85], s[84:85], 4
    buffer_load_dwordx4 v17, s[28:31], s71 offen offset:1024 lds
    buffer_load_dwordx4 v18, s[28:31], s71 offen offset:2048 lds
    buffer_load_dwordx4 v19, s[28:31], s71 offen offset:3072 lds
    s_add_u32 m0, s70, 4096
    s_nop 0
    buffer_load_dwordx4 v20, s[32:35], s72 offen offset:0 lds
    buffer_load_dwordx4 v21, s[32:35], s72 offen offset:1024 lds
    buffer_load_dwordx4 v22, s[32:35], s72 offen offset:2048 lds
    buffer_load_dwordx4 v23, s[32:35], s72 offen offset:3072 lds
    s_add_u32 m0, s70, 8192
    s_nop 0
    buffer_load_dwordx4 v24, s[32:35], s72 offen offset:0 lds
    buffer_load_dwordx4 v25, s[32:35], s72 offen offset:1024 lds
    s_add_u32 s70, s70, 40960
    s_cmp_ge_u32 s70, 122880
    s_cselect_b32 s76, 122880, 0
    s_sub_u32 s70, s70, s76
    s_lshl_b32 s77, s62, 10
    s_add_u32 s76, s77, s73
    buffer_store_dwordx4 v[28:31], v12, s[40:43], s76 offen sc1
    s_lshl_b32 s76, s61, 12
    s_add_u32 s76, s76, s77
    s_add_u32 m0, s77, 122880
    s_nop 0
    buffer_load_dwordx4 v12, s[56:59], s76 offen lds
    v_mov_b32 v4, 13631488
    buffer_load_dwordx2 v[88:89], v4, s[40:43], 0 offen
    s_setprio 0
    s_waitcnt vmcnt(13)
    s_barrier
    s_and_b32 s72, s84, 15
    s_mov_b32 m0, s70
    s_lshl_b32 s71, s72, 7
    buffer_load_dwordx4 v16, s[28:31], s71 offen offset:0 lds
    s_mul_i32 s72, s72, 393216
    s_lshr_b64 s[84:85], s[84:85], 4
    buffer_load_dwordx4 v17, s[28:31], s71 offen offset:1024 lds
    buffer_load_dwordx4 v18, s[28:31], s71 offen offset:2048 lds
    buffer_load_dwordx4 v19, s[28:31], s71 offen offset:3072 lds
    s_add_u32 m0, s70, 4096
    s_nop 0
    buffer_load_dwordx4 v20, s[32:35], s72 offen offset:0 lds
    buffer_load_dwordx4 v21, s[32:35], s72 offen offset:1024 lds
    buffer_load_dwordx4 v22, s[32:35], s72 offen offset:2048 lds
    buffer_load_dwordx4 v23, s[32:35], s72 offen offset:3072 lds
    s_add_u32 m0, s70, 8192
    s_nop 0
    buffer_load_dwordx4 v24, s[32:35], s72 offen offset:0 lds
    buffer_load_dwordx4 v25, s[32:35], s72 offen offset:1024 lds
    s_add_u32 s70, s70, 40960
    s_cmp_ge_u32 s70, 122880
    s_cselect_b32 s76, 122880, 0
    s_sub_u32 s70, s70, s76
    s_mov_b32 s36, s10
    s_and_b32 s37, s11, 0xffff
    s_mov_b32 s38, 2097152
    s_mov_b32 s39, 0x20000
    s_mov_b32 s44, s22
    s_and_b32 s45, s23, 0xffff
    s_mov_b32 s46, 4194304
    s_mov_b32 s47, 0x20000
    s_mov_b32 s52, s20
    s_and_b32 s53, s21, 0xffff
    s_mov_b32 s54, 7340032
    s_mov_b32 s55, 0x20000
    s_cmp_eq_u32 s64, 0
    s_cselect_b32 s48, s16, s18
    s_cselect_b32 s49, s17, s19
    s_and_b32 s49, s49, 0xffff
    s_mov_b32 s51, 0x20000
    s_cmp_lt_u32 s97, 14
    s_cselect_b32 s50, 7340032, 0
    s_cselect_b32 s54, 7340032, 0
    v_bfe_u32 v4, v2, 1, 3
    v_xor_b32 v4, v4, v3
    v_lshlrev_b32 v4, 4, v4
    v_lshl_add_u32 v72, v2, 7, v4
    v_bfe_u32 v4, v1, 2, 2
    v_lshl_add_u32 v5, v3, 3, v4
    v_lshlrev_b32 v5, 7, v5
    v_lshrrev_b32 v4, 1, v4
    v_xor_b32_e64 v4, s64, v4
    v_lshl_add_u32 v5, v4, 6, v5
    v_bfe_u32 v4, v1, 4, 1
    v_xor_b32_e64 v4, v4, v3
    v_lshl_add_u32 v5, v4, 5, v5
    v_and_b32_e64 v4, 3, v1
    v_lshl_add_u32 v5, v4, 3, v5
    s_mul_i32 s76, s62, 10240
    s_sub_u32 s76, 4096, s76
    v_add_u32_e64 v73, s76, v5
    v_mul_u32_u24 v74, 28800, v3
    v_lshl_add_u32 v74, v2, 3, v74
    v_lshrrev_b32 v4, 4, v1
    v_and_b32 v5, 15, v1
    v_mul_u32_u24 v75, 460800, v4
    v_lshl_add_u32 v75, v5, 4, v75
    v_lshrrev_b32 v4, 4, v1
    v_and_b32 v5, 15, v1
    v_mul_u32_u24 v76, 114688, v4
    v_lshl_add_u32 v76, v5, 4, v76
    v_lshlrev_b32_e64 v77, 4, v2
    v_lshl_add_u32 v77, v3, 11, v77
    s_mul_i32 s75, s98, 458752
    s_lshl_b32 s77, s97, 9
    s_add_u32 s75, s75, s77
    s_lshl_b32 s77, s63, 8
    s_add_u32 s75, s75, s77
    s_lshl_b32 s96, s97, 19
    s_lshl_b32 s77, s98, 15
    s_add_u32 s96, s96, s77
    s_lshl_b32 s77, s62, 9
    s_add_u32 s96, s96, s77
    s_mov_b32 s68, 1
    s_getreg_b32 s101, hwreg(HW_REG_XCC_ID, 0, 4)
    s_lshl_b32 s76, s61, 8
    s_add_u32 s76, s76, 12582912
    s_lshl_b32 s77, s60, 8
    s_add_u32 s77, s77, 12586752
    s_lshr_b32 s78, s97, 1
    s_lshl_b32 s78, s78, 9
    s_add_u32 s78, s78, 12590592
    v_mov_b32 v4, s76
    v_mov_b32 v5, s77
    v_mov_b32 v6, s78
    v_cmp_gt_u32 vcc, 16, v1
    s_nop 1
    v_cndmask_b32 v4, v5, v4, vcc
    v_cmp_gt_u32 vcc, 32, v1
    s_nop 1
    v_cndmask_b32 v4, v6, v4, vcc
    v_add_u32 v90, v4, v12
    s_waitcnt vmcnt(10)
    s_barrier
L_hloop:
    s_and_b32 s77, s86, 15
    s_cbranch_scc1 L_event
L_evret:
    s_and_b32 s72, s84, 15
    s_mov_b32 m0, s70
    s_lshl_b32 s71, s72, 7
    buffer_load_dwordx4 v16, s[28:31], s71 offen offset:0 lds
    s_mul_i32 s72, s72, 393216
    s_lshr_b64 s[84:85], s[84:85], 4
    buffer_load_dwordx4 v17, s[28:31], s71 offen offset:1024 lds
    buffer_load_dwordx4 v18, s[28:31], s71 offen offset:2048 lds
    buffer_load_dwordx4 v19, s[28:31], s71 offen offset:3072 lds
    s_add_u32 m0, s70, 4096
    s_nop 0
    buffer_load_dwordx4 v20, s[32:35], s72 offen offset:0 lds
    buffer_load_dwordx4 v21, s[32:35], s72 offen offset:1024 lds
    buffer_load_dwordx4 v22, s[32:35], s72 offen offset:2048 lds
    buffer_load_dwordx4 v23, s[32:35], s72 offen offset:3072 lds
    s_add_u32 m0, s70, 8192
    s_nop 0
    buffer_load_dwordx4 v24, s[32:35], s72 offen offset:0 lds
    buffer_load_dwordx4 v25, s[32:35], s72 offen offset:1024 lds
    s_add_u32 s70, s70, 40960
    s_cmp_ge_u32 s70, 122880
    s_cselect_b32 s76, 122880, 0
    s_sub_u32 s70, s70, s76
    s_waitcnt vmcnt(10)
L_hbar:
    s_lshr_b64 s[86:87], s[86:87], 4
    s_add_u32 s68, s68, 1
    s_cmp_lt_u32 s68, 14
    s_barrier
    s_cbranch_scc1 L_hloop
    v_add_co_u32 v88, vcc, 1, v88
    s_nop 1
    v_addc_co_u32 v89, vcc, 0, v89, vcc
    v_cmp_ne_u64 vcc, v[92:93], v[88:89]
    s_nop 0
    s_cbranch_vccz L_hello_ok_1
    s_mov_b32 s88, 0
L_spin_2:
    buffer_load_dwordx4 v[92:95], v90, s[40:43], 0 offen sc1
    s_waitcnt vmcnt(0)
    v_cmp_ne_u64 vcc, v[92:93], v[88:89]
    s_nop 0
    s_cbranch_vccz L_hello_ok_1
    s_add_u32 s88, s88, 1
    s_cmp_lt_u32 s88, 65536
    s_cbranch_scc1 L_spin_2
L_hello_ok_1:
    v_cmp_ne_u32_e64 vcc, s101, v94
    s_nop 0
    s_and_b32 s76, vcc_lo, 0xffff
    s_cselect_b32 s100, 0, 1
    s_cmp_eq_u32 vcc_hi, 0
    s_cselect_b32 s76, 2, 0
    s_or_b32 s100, s100, s76
    v_mov_b32 v4, s100
    v_mov_b32 v5, 0
    ds_write_b32 v5, v4 offset:53248
    s_mul_i32 s80, s60, 460800
    s_lshl_b32 s81, s62, 8
    s_add_u32 s80, s80, s81
    buffer_load_dwordx2 v[32:33], v74, s[40:43], s80 offen offset:0 sc1
    s_add_u32 s80, s80, 57600
    buffer_load_dwordx2 v[34:35], v74, s[40:43], s80 offen offset:0 sc1
    s_add_u32 s80, s80, 57600
    buffer_load_dwordx2 v[36:37], v74, s[40:43], s80 offen offset:0 sc1
    s_add_u32 s80, s80, 57600
    buffer_load_dwordx2 v[38:39], v74, s[40:43], s80 offen offset:0 sc1
    s_add_u32 s80, s80, 57600
    buffer_load_dwordx2 v[40:41], v74, s[40:43], s80 offen offset:0 sc1
    s_add_u32 s80, s80, 57600
    buffer_load_dwordx2 v[42:43], v74, s[40:43], s80 offen offset:0 sc1
    s_add_u32 s80, s80, 57600
    buffer_load_dwordx2 v[44:45], v74, s[40:43], s80 offen offset:0 sc1
    s_add_u32 s80, s80, 57600
    buffer_load_dwordx2 v[46:47], v74, s[40:43], s80 offen offset:0 sc1
    s_mul_i32 s80, s61, 28800
    s_add_u32 s80, s80, s81
    buffer_load_dwordx4 v[48:51], v75, s[40:43], s80 offen offset:1024 sc1
    s_add_u32 s80, s80, 1843200
    buffer_load_dwordx4 v[52:55], v75, s[40:43], s80 offen offset:1024 sc1
    s_add_u32 s80, s80, 1843200
    buffer_load_dwordx4 v[56:59], v75, s[40:43], s80 offen offset:1024 sc1
    s_add_u32 s80, s80, 1843200
    buffer_load_dwordx4 v[60:63], v75, s[40:43], s80 offen offset:1024 sc1
    s_waitcnt vmcnt(12)
    s_barrier
    s_mul_i32 s78, s62, 2048
    s_add_u32 s78, s78, s73
    s_add_u32 s78, s78, 4096
    v_lshlrev_b32_e64 v11, 7, v1
    s_mov_b64 exec, 65535
    buffer_load_dword v27, v11, s[40:43], s78 offen sc1
    s_mov_b64 exec, -1
    buffer_load_dwordx4 v[152:155], v76, s[48:51], s75 offen nt
    s_add_u32 s75, s75, 7168
    buffer_load_dwordx4 v[156:159], v76, s[48:51], s75 offen nt
    s_add_u32 s75, s75, 7168
    s_add_u32 s78, s65, 0
    s_and_b32 s78, s78, 15
    s_lshl_b32 s78, s78, 17
    s_lshl_b32 s79, s62, 11
    s_add_u32 m0, s79, 57344
    s_add_u32 s79, s78, 15360
    buffer_load_dwordx4 v26, s[36:39], s78 offen lds
    buffer_load_dwordx4 v26, s[36:39], s79 offen offset:1024 lds
    s_add_u32 s78, s65, 1
    s_and_b32 s78, s78, 15
    s_lshl_b32 s78, s78, 17
    s_lshl_b32 s79, s62, 11
    s_add_u32 m0, s79, 65536
    s_add_u32 s79, s78, 15360
    buffer_load_dwordx4 v26, s[36:39], s78 offen lds
    buffer_load_dwordx4 v26, s[36:39], s79 offen offset:1024 lds
    s_waitcnt vmcnt(7)
    s_mov_b32 s88, 0
    s_branch L_g1first_3
L_g1_4:
    s_mul_i32 s80, s60, 460800
    s_lshl_b32 s81, s62, 8
    s_add_u32 s80, s80, s81
    buffer_load_dwordx2 v[32:33], v74, s[40:43], s80 offen offset:0 sc1
    s_add_u32 s80, s80, 57600
    buffer_load_dwordx2 v[34:35], v74, s[40:43], s80 offen offset:0 sc1
    s_add_u32 s80, s80, 57600
    buffer_load_dwordx2 v[36:37], v74, s[40:43], s80 offen offset:0 sc1
    s_add_u32 s80, s80, 57600
    buffer_load_dwordx2 v[38:39], v74, s[40:43], s80 offen offset:0 sc1
    s_add_u32 s80, s80, 57600
    buffer_load_dwordx2 v[40:41], v74, s[40:43], s80 offen offset:0 sc1
    s_add_u32 s80, s80, 57600
    buffer_load_dwordx2 v[42:43], v74, s[40:43], s80 offen offset:0 sc1
    s_add_u32 s80, s80, 57600
    buffer_load_dwordx2 v[44:45], v74, s[40:43], s80 offen offset:0 sc1
    s_add_u32 s80, s80, 57600
    buffer_load_dwordx2 v[46:47], v74, s[40:43], s80 offen offset:0 sc1
    s_mul_i32 s80, s61, 28800
    s_add_u32 s80, s80, s81
    buffer_load_dwordx4 v[48:51], v75, s[40:43], s80 offen offset:1024 sc1
    s_add_u32 s80, s80, 1843200
    buffer_load_dwordx4 v[52:55], v75, s[40:43], s80 offen offset:1024 sc1
    s_add_u32 s80, s80, 1843200
    buffer_load_dwordx4 v[56:59], v75, s[40:43], s80 offen offset:1024 sc1
    s_add_u32 s80, s80, 1843200
    buffer_load_dwordx4 v[60:63], v75, s[40:43], s80 offen offset:1024 sc1
    s_waitcnt vmcnt(0)
L_g1first_3:
    v_max3_u32 v4, v32, v34, v36
    v_max3_u32 v4, v4, v38, v40
    v_max3_u32 v4, v4, v42, v44
    v_max3_u32 v4, v4, v46, v48
    v_max3_u32 v4, v4, v50, v52
    v_max3_u32 v4, v4, v54, v56
    v_max3_u32 v4, v4, v58, v60
    v_max_u32 v4, v4, v62
    v_cmp_eq_u32_e64 vcc, -1, v4
    s_nop 0
    s_cbranch_vccz L_ok_5
    s_add_u32 s88, s88, 1
    s_cmp_lt_u32 s88, 65536
    s_cbranch_scc1 L_g1_4
L_ok_5:
    s_setprio 3
    v_add_f32 v32, v32, v40
    v_add_f32 v33, v33, v41
    v_add_f32 v34, v34, v42
    v_add_f32 v35, v35, v43
    v_add_f32 v36, v36, v44
    v_add_f32 v37, v37, v45
    v_add_f32 v38, v38, v46
    v_add_f32 v39, v39, v47
    v_add_f32 v32, v32, v36
    v_add_f32 v33, v33, v37
    v_add_f32 v34, v34, v38
    v_add_f32 v35, v35, v39
    v_add_f32 v32, v32, v34
    v_add_f32 v33, v33, v35
    v_add_f32 v48, v48, v56
    v_add_f32 v49, v49, v57
    v_add_f32 v50, v50, v58
    v_add_f32 v51, v51, v59
    v_add_f32 v52, v52, v60
    v_add_f32 v53, v53, v61
    v_add_f32 v54, v54, v62
    v_add_f32 v55, v55, v63
    v_add_f32 v48, v48, v52
    v_add_f32 v49, v49, v53
    v_add_f32 v50, v50, v54
    v_add_f32 v51, v51, v55
    v_add_f32 v49, v49, v51
    v_mov_b32 v5, v32
    v_mov_b32 v6, v33
    v_mov_b32 v51, v49
    v_permlane32_swap_b32 v48, v50
    v_permlane32_swap_b32 v32, v5
    v_permlane32_swap_b32 v33, v6
    v_permlane32_swap_b32 v49, v51
    v_add_f32 v48, v48, v50
    v_add_f32 v49, v49, v51
    v_add_f32 v32, v32, v5
    v_add_f32 v33, v33, v6
    v_permlane16_swap_b32 v48, v49
    v_add_f32 v48, v48, v49
    v_cvt_pk_bf16_f32 v49, v48, v48
    v_and_b32 v49, s90, v49
    v_sub_f32 v49, v48, v49
    v_cvt_pk_bf16_f32 v50, v48, v49
    v_and_b32 v51, s90, v50
    v_sub_f32 v49, v49, v51
    v_cvt_pk_bf16_f32 v51, v49, 0
    v_bfe_u32 v4, v1, 4, 1
    v_lshl_add_u32 v4, v4, 1, v3
    v_min_u32 v4, 2, v4
    v_and_b32 v7, 15, v1
    v_lshlrev_b32 v7, 3, v7
    s_lshl_b32 s76, s62, 7
    v_lshl_add_u32 v4, v4, 9, v7
    v_add_u32_e64 v4, s76, v4
    ds_write_b64 v4, v[50:51] offset:50176
    v_mul_f32 v32, 0x3a800000, v32
    v_mul_f32 v33, 0x3a800000, v33
    v_fma_f32 v7, -v32, v32, v33
    v_max_f32_e64 v7, 0, v7
    v_cvt_pk_bf16_f32 v5, v32, v32
    v_and_b32_e64 v5, s90, v5
    v_cvt_pk_bf16_f32 v7, v7, v7
    v_and_b32_e64 v7, s90, v7
    v_add_f32 v7, 0x3727c5ac, v7
    v_cvt_pk_bf16_f32 v7, v7, v7
    v_and_b32 v7, s90, v7
    v_sqrt_f32_e64 v7, v7
    s_nop 0
    v_cvt_pk_bf16_f32 v7, v7, v7
    v_and_b32 v7, s90, v7
    v_rcp_f32 v9, v7
    v_xor_b32 v5, 0x80000000, v5
    v_cvt_pk_bf16_f32 v8, v5, v5
    s_lshl_b32 s76, s62, 8
    v_lshl_add_u32 v6, v2, 3, s76
    ds_write_b64 v6, v[8:9] offset:49152
    s_setprio 0
    s_waitcnt lgkmcnt(0)
    s_barrier
    s_lshl_b32 s78, s62, 11
    s_add_u32 s79, s78, s73
    s_add_u32 s79, s79, 4096
    s_bitcmp1_b32 s100, 0
    s_cbranch_scc1 L_loc_6
    buffer_store_dwordx4 v[28:31], v12, s[40:43], s79 offen offset:0 sc1
    buffer_store_dwordx4 v[28:31], v12, s[40:43], s79 offen offset:1024 sc1
    s_branch L_pubd_7
L_loc_6:
    buffer_store_dwordx4 v[28:31], v12, s[40:43], s79 offen offset:0
    buffer_store_dwordx4 v[28:31], v12, s[40:43], s79 offen offset:1024
L_pubd_7:
    s_add_u32 s79, s78, s99
    s_bitcmp1_b32 s100, 1
    s_cbranch_scc1 L_loc_8
    buffer_store_dwordx4 v[28:31], v12, s[40:43], s79 offen offset:1024 sc1
    buffer_store_dwordx4 v[28:31], v12, s[40:43], s79 offen offset:2048 sc1
    s_branch L_pubd_9
L_loc_8:
    buffer_store_dwordx4 v[28:31], v12, s[40:43], s79 offen offset:1024
    buffer_store_dwordx4 v[28:31], v12, s[40:43], s79 offen offset:2048
L_pubd_9:
    s_lshl_b32 s79, s62, 8
    s_add_u32 s79, s79, s99
    s_mov_b64 exec, 0xffff
    buffer_store_dwordx4 v[28:31], v12, s[40:43], s79 offen sc1
    s_mov_b64 exec, -1
    s_add_u32 s78, s65, 2
    s_and_b32 s78, s78, 15
    s_lshl_b32 s78, s78, 17
    s_lshl_b32 s79, s62, 11
    s_add_u32 m0, s79, 73728
    s_add_u32 s79, s78, 15360
    buffer_load_dwordx4 v26, s[36:39], s78 offen lds
    buffer_load_dwordx4 v26, s[36:39], s79 offen offset:1024 lds
    s_add_u32 s78, s65, 3
    s_and_b32 s78, s78, 15
    s_lshl_b32 s78, s78, 17
    s_lshl_b32 s79, s62, 11
    s_add_u32 m0, s79, 81920
    s_add_u32 s79, s78, 15360
    buffer_load_dwordx4 v26, s[36:39], s78 offen lds
    buffer_load_dwordx4 v26, s[36:39], s79 offen offset:1024 lds
    s_add_u32 s78, s65, 4
    s_and_b32 s78, s78, 15
    s_lshl_b32 s78, s78, 17
    s_lshl_b32 s79, s62, 11
    s_add_u32 m0, s79, 90112
    s_add_u32 s79, s78, 15360
    buffer_load_dwordx4 v26, s[36:39], s78 offen lds
    buffer_load_dwordx4 v26, s[36:39], s79 offen offset:1024 lds
    s_add_u32 s78, s65, 5
    s_and_b32 s78, s78, 15
    s_lshl_b32 s78, s78, 17
    s_lshl_b32 s79, s62, 11
    s_add_u32 m0, s79, 98304
    s_add_u32 s79, s78, 15360
    buffer_load_dwordx4 v26, s[36:39], s78 offen lds
    buffer_load_dwordx4 v26, s[36:39], s79 offen offset:1024 lds
    s_mul_i32 s78, s62, 384
    s_add_u32 s78, s78, s73
    s_add_u32 s78, s78, 2048
    v_lshlrev_b32_e64 v11, 7, v1
    s_mov_b64 exec, 7
    buffer_load_dword v27, v11, s[40:43], s78 offen sc1
    s_mov_b64 exec, -1
    s_waitcnt vmcnt(9)
    s_lshl_b32 s76, s62, 2
    s_add_u32 s76, s76, s73
    v_mov_b32 v4, 0
    s_mov_b64 exec, 1
    s_bitcmp1_b32 s100, 0
    s_cbranch_scc1 L_loc_10
    buffer_store_dword v4, v4, s[40:43], s76 offen offset:2560 sc1
    s_branch L_pubd_11
L_loc_10:
    buffer_store_dword v4, v4, s[40:43], s76 offen offset:2560
L_pubd_11:
    s_mov_b64 exec, -1
    s_add_u32 s78, s65, 6
    s_and_b32 s78, s78, 15
    s_lshl_b32 s78, s78, 17
    s_lshl_b32 s79, s62, 11
    s_add_u32 m0, s79, 106496
    s_add_u32 s79, s78, 15360
    buffer_load_dwordx4 v26, s[36:39], s78 offen lds
    buffer_load_dwordx4 v26, s[36:39], s79 offen offset:1024 lds
    s_add_u32 s78, s65, 7
    s_and_b32 s78, s78, 15
    s_lshl_b32 s78, s78, 17
    s_lshl_b32 s79, s62, 11
    s_add_u32 m0, s79, 114688
    s_add_u32 s79, s78, 15360
    buffer_load_dwordx4 v26, s[36:39], s78 offen lds
    buffer_load_dwordx4 v26, s[36:39], s79 offen offset:1024 lds
    s_add_u32 s78, s65, 8
    s_and_b32 s78, s78, 15
    s_lshl_b32 s78, s78, 17
    s_lshl_b32 s79, s62, 11
    s_add_u32 m0, s79, 122880
    s_add_u32 s79, s78, 15360
    buffer_load_dwordx4 v26, s[36:39], s78 offen lds
    buffer_load_dwordx4 v26, s[36:39], s79 offen offset:1024 lds
    s_add_u32 s78, s65, 9
    s_and_b32 s78, s78, 15
    s_lshl_b32 s78, s78, 17
    s_lshl_b32 s79, s62, 11
    s_add_u32 m0, s79, 131072
    s_add_u32 s79, s78, 15360
    buffer_load_dwordx4 v26, s[36:39], s78 offen lds
    buffer_load_dwordx4 v26, s[36:39], s79 offen offset:1024 lds
    v_and_b32_e64 v65, 15, v1
    v_mul_u32_u24 v65, 460800, v65
    s_mul_i32 s80, s61, 28800
    s_lshl_b32 s82, s62, 2
    s_add_u32 s82, s82, s80
    v_bfe_u32 v4, v1, 4, 1
    v_lshl_add_u32 v4, v4, 1, v3
    s_lshl_b32 s77, s62, 6
    v_lshl_add_u32 v66, v4, 1, s77
    v_bfe_u32 v4, v1, 2, 1
    v_lshl_add_u32 v66, v4, 5, v66
    v_bfe_u32 v4, v1, 0, 1
    v_lshl_add_u32 v66, v4, 4, v66
    v_bfe_u32 v4, v1, 1, 1
    v_lshl_add_u32 v66, v4, 3, v66
    s_lshl_b32 s83, s62, 7
    s_add_u32 s81, s83, s80
    s_add_u32 s68, s81, 3686400
    s_add_u32 s83, s83, s73
    v_and_b32 v4, 7, v1
    v_lshrrev_b32 v5, 4, v1
    v_lshlrev_b32_e64 v5, 2, v5
    v_lshl_add_u32 v67, v4, 4, v5
    s_barrier
    s_add_u32 s78, s65, 10
    s_and_b32 s78, s78, 15
    s_lshl_b32 s78, s78, 17
    s_lshl_b32 s79, s62, 11
    s_add_u32 m0, s79, 139264
    s_add_u32 s79, s78, 15360
    buffer_load_dwordx4 v26, s[36:39], s78 offen lds
    buffer_load_dwordx4 v26, s[36:39], s79 offen offset:1024 lds
    s_add_u32 s78, s65, 11
    s_and_b32 s78, s78, 15
    s_lshl_b32 s78, s78, 17
    s_lshl_b32 s79, s62, 11
    s_add_u32 m0, s79, 147456
    s_add_u32 s79, s78, 15360
    buffer_load_dwordx4 v26, s[36:39], s78 offen lds
    buffer_load_dwordx4 v26, s[36:39], s79 offen offset:1024 lds
    s_add_u32 s78, s65, 12
    s_and_b32 s78, s78, 15
    s_lshl_b32 s78, s78, 17
    s_lshl_b32 s79, s62, 11
    s_add_u32 m0, s79, 155648
    s_add_u32 s79, s78, 15360
    buffer_load_dwordx4 v26, s[36:39], s78 offen lds
    buffer_load_dwordx4 v26, s[36:39], s79 offen offset:1024 lds
    buffer_load_dword v64, v65, s[40:43], s82 offen offset:2560 sc1
    s_barrier
    s_setprio 3
    v_mov_b32 v4, s89
    v_lshlrev_b32_e64 v5, 2, v1
    ds_write_b32 v5, v4 offset:24832
    v_mov_b32 v70, 0
    v_mov_b32 v71, 0
    ds_write_b64 v70, v[70:71] offset:25984
    s_mov_b32 s88, 0
    s_branch L_p2first_12
L_p2_13:
    buffer_load_dword v64, v65, s[40:43], s82 offen offset:2560 sc1
L_p2first_12:
    s_waitcnt vmcnt(0)
    v_cmp_eq_u32_e64 vcc, -1, v64
    s_nop 0
    s_cbranch_vccz L_ok_14
    s_add_u32 s88, s88, 1
    s_cmp_lt_u32 s88, 65536
    s_cbranch_scc1 L_p2_13
L_ok_14:
    s_add_u32 s78, s65, 13
    s_and_b32 s78, s78, 15
    s_lshl_b32 s78, s78, 17
    s_lshl_b32 s79, s62, 11
    s_add_u32 m0, s79, 32768
    s_add_u32 s79, s78, 15360
    buffer_load_dwordx4 v26, s[36:39], s78 offen lds
    buffer_load_dwordx4 v26, s[36:39], s79 offen offset:1024 lds
    s_add_u32 s78, s65, 14
    s_and_b32 s78, s78, 15
    s_lshl_b32 s78, s78, 17
    s_lshl_b32 s79, s62, 11
    s_add_u32 m0, s79, 40960
    s_add_u32 s79, s78, 15360
    buffer_load_dwordx4 v26, s[36:39], s78 offen lds
    buffer_load_dwordx4 v26, s[36:39], s79 offen offset:1024 lds
    s_add_u32 s78, s65, 15
    s_and_b32 s78, s78, 15
    s_lshl_b32 s78, s78, 17
    s_lshl_b32 s79, s62, 11
    s_add_u32 m0, s79, 49152
    s_add_u32 s79, s78, 15360
    buffer_load_dwordx4 v26, s[36:39], s78 offen lds
    buffer_load_dwordx4 v26, s[36:39], s79 offen offset:1024 lds
    s_lshl_b32 s76, s62, 11
    s_lshl_b32 s77, s60, 7
    s_add_u32 s76, s76, s77
    s_add_u32 s76, s76, s80
    s_add_u32 s76, s76, 4096
    s_add_u32 s77, s76, 3686400
    s_mov_b32 s78, 0x00003f80
    s_mov_b32 s79, 0x3f800000
    s_mov_b32 s88, 0
L_poll_15:
    buffer_load_dwordx4 v[32:35], v13, s[40:43], s76 offen sc1
    buffer_load_dwordx4 v[36:39], v13, s[40:43], s77 offen sc1
    s_waitcnt vmcnt(0)
    v_max_u32 v4, v32, v36
    v_cmp_eq_u32_e64 vcc, -1, v4
    s_nop 0
    s_cbranch_vccz L_ok_16
    s_add_u32 s88, s88, 1
    s_cmp_lt_u32 s88, 65536
    s_cbranch_scc1 L_poll_15
L_ok_16:
    v_dot2_f32_bf16 v48, v32, s78, 0
    v_dot2_f32_bf16 v49, v32, s79, 0
    v_dot2_f32_bf16 v50, v33, s78, 0
    v_dot2_f32_bf16 v51, v33, s79, 0
    v_dot2_f32_bf16 v52, v34, s78, 0
    v_dot2_f32_bf16 v53, v34, s79, 0
    v_dot2_f32_bf16 v54, v35, s78, 0
    v_dot2_f32_bf16 v55, v35, s79, 0
    v_dot2_f32_bf16 v48, v36, s78, v48
    v_dot2_f32_bf16 v49, v36, s79, v49
    v_dot2_f32_bf16 v50, v37, s78, v50
    v_dot2_f32_bf16 v51, v37, s79, v51
    v_dot2_f32_bf16 v52, v38, s78, v52
    v_dot2_f32_bf16 v53, v38, s79, v53
    v_dot2_f32_bf16 v54, v39, s78, v54
    v_dot2_f32_bf16 v55, v39, s79, v55
    buffer_load_dwordx4 v[40:43], v13, s[40:43], s81 offen offset:2048 sc1
    buffer_load_dwordx4 v[44:47], v13, s[40:43], s68 offen offset:2048 sc1
    v_permlane32_swap_b32 v48, v52
    v_permlane32_swap_b32 v49, v53
    v_permlane32_swap_b32 v50, v54
    v_permlane32_swap_b32 v51, v55
    v_add_f32 v48, v48, v52
    v_add_f32 v49, v49, v53
    v_add_f32 v50, v50, v54
    v_add_f32 v51, v51, v55
    s_nop 0
    v_permlane16_swap_b32 v48, v50
    v_permlane16_swap_b32 v49, v51
    v_add_f32 v48, v48, v50
    v_add_f32_e64 v49, v49, v51
    s_nop 0
    v_add_f32_dpp v48, v48, v48 row_ror:8 row_mask:0xf bank_mask:0xf
    v_add_f32_dpp v49, v49, v49 row_ror:8 row_mask:0xf bank_mask:0xf
    v_cvt_pk_bf16_f32 v48, v48, v49
    s_bitcmp1_b32 s100, 0
    s_cbranch_scc1 L_loc_17
    buffer_store_dword v48, v67, s[40:43], s83 offen offset:3072 sc1
    s_branch L_pubd_18
L_loc_17:
    buffer_store_dword v48, v67, s[40:43], s83 offen offset:3072
L_pubd_18:
    s_mov_b32 s88, 0
    s_waitcnt vmcnt(1)
    s_branch L_zfirst_19
L_z_20:
    buffer_load_dwordx4 v[40:43], v13, s[40:43], s81 offen offset:2048 sc1
    buffer_load_dwordx4 v[44:47], v13, s[40:43], s68 offen offset:2048 sc1
    s_waitcnt vmcnt(0)
L_zfirst_19:
    v_max3_u32 v4, v40, v41, v42
    v_max3_u32 v4, v4, v43, v44
    v_max3_u32 v4, v4, v45, v46
    v_max_u32 v4, v4, v47
    v_cmp_eq_u32 vcc, -1, v4
    s_nop 0
    s_cbranch_vccz L_ok_21
    s_add_u32 s88, s88, 1
    s_cmp_lt_u32 s88, 65536
    s_cbranch_scc1 L_z_20
L_ok_21:
    v_add_f32 v40, v40, v44
    v_add_f32 v41, v41, v45
    v_add_f32 v42, v42, v46
    v_add_f32 v43, v43, v47
    v_permlane32_swap_b32 v40, v41
    s_nop 0
    v_permlane32_swap_b32 v42, v43
    v_add_f32 v40, v40, v41
    v_add_f32 v42, v42, v43
    s_nop 1
    v_permlane16_swap_b32 v40, v42
    v_add_f32 v40, v40, v42
    s_nop 1
    v_add_f32_dpp v40, v40, v40 row_ror:8 row_mask:0xf bank_mask:0xf
    v_cvt_pk_bf16_f32 v40, v40, v40
    ds_write_b16 v66, v40 offset:24576
    s_waitcnt lgkmcnt(0)
    s_barrier
    s_setprio 0
    s_mov_b64 exec, 3
    global_load_dword v27, v91, s[66:67]
    s_mov_b64 exec, -1
    s_lshl_b32 s78, s97, 18
    s_lshl_b32 s79, s62, 16
    s_add_u32 s78, s78, s79
    s_lshl_b32 s79, s98, 7
    s_add_u32 s78, s78, s79
    s_lshl_b32 s79, s62, 12
    s_add_u32 m0, s79, 0
    s_nop 0
    buffer_load_dwordx4 v78, s[28:31], s78 offen offset:0 lds
    s_add_u32 s78, s78, 15360
    buffer_load_dwordx4 v79, s[28:31], s78 offen offset:1024 lds
    s_add_u32 s78, s78, 15360
    buffer_load_dwordx4 v78, s[28:31], s78 offen offset:2048 lds
    s_add_u32 s78, s78, 15360
    buffer_load_dwordx4 v79, s[28:31], s78 offen offset:3072 lds
    s_barrier
    s_lshl4_add_u32 s76, s97, s98
    s_mul_i32 s76, s76, 28800
    s_add_u32 s20, s26, s76
    s_addc_u32 s21, s27, 0
    s_cmp_eq_u32 s62, 0
    s_cbranch_scc0 L_now0_24
    s_sleep 4
    s_load_dwordx16 s[4:19], s[20:21], 3584 glc
    s_waitcnt lgkmcnt(0)
    s_and_b64 s[4:5], s[4:5], s[6:7]
    s_and_b64 s[4:5], s[4:5], s[8:9]
    s_and_b64 s[4:5], s[4:5], s[10:11]
    s_and_b64 s[4:5], s[4:5], s[12:13]
    s_and_b64 s[4:5], s[4:5], s[14:15]
    s_and_b64 s[4:5], s[4:5], s[16:17]
    s_and_b64 s[4:5], s[4:5], s[18:19]
    s_nand_b32 s4, s4, s5
    s_and_b32 s4, s4, 0xffff
    s_mul_i32 s4, s4, 0x10001
    s_lshr_b32 s4, s4, s65
    s_and_b32 s77, s4, 0xffff
    v_mov_b32_e64 v69, s77
    ds_write_b32 v70, v69 offset:25984
L_now0_24:
    s_waitcnt vmcnt(0) lgkmcnt(0)
    s_barrier
    s_cmp_eq_u32 s62, 0
    s_cbranch_scc0 L_now1_22
    s_mov_b32 s88, 0
L_spin_25:
    s_load_dwordx16 s[4:19], s[20:21], 3584 glc
    s_waitcnt lgkmcnt(0)
    s_and_b64 s[4:5], s[4:5], s[6:7]
    s_and_b64 s[4:5], s[4:5], s[8:9]
    s_and_b64 s[4:5], s[4:5], s[10:11]
    s_and_b64 s[4:5], s[4:5], s[12:13]
    s_and_b64 s[4:5], s[4:5], s[14:15]
    s_and_b64 s[4:5], s[4:5], s[16:17]
    s_and_b64 s[4:5], s[4:5], s[18:19]
    s_nand_b32 s4, s4, s5
    s_and_b32 s4, s4, 0xffff
    s_mul_i32 s4, s4, 0x10001
    s_lshr_b32 s4, s4, s65
    s_and_b32 s77, s4, 0xffff
    v_mov_b32 v69, s77
    ds_write_b32 v70, v69 offset:25984
    s_cmp_eq_u32 s77, 0xffff
    s_cbranch_scc1 L_s2done_23
    s_add_u32 s88, s88, 1
    s_cmp_lt_u32 s88, 65536
    s_cbranch_scc1 L_spin_25
    s_branch L_s2done_23
L_now1_22:
    s_cmp_eq_u32 s62, 1
    s_cbranch_scc0 L_s2done_23
    s_lshl_b32 s77, 1, s61
    s_not_b32 s77, s77
    v_mov_b32_e64 v4, s77
    v_mul_u32_u24 v5, 28800, v1
    s_mul_i32 s76, s60, 460800
    s_lshl2_add_u32 s76, s61, s76
    s_mov_b32 s88, 0
L_spin_26:
    ds_read_b32 v69, v70 offset:25988
    s_waitcnt lgkmcnt(0)
    v_cmp_eq_u32_e64 vcc, 4, v69
    s_nop 0
    s_cbranch_vccnz L_drained_27
    s_add_u32 s88, s88, 1
    s_cmp_lt_u32 s88, 1048576
    s_cbranch_scc1 L_spin_26
L_drained_27:
    s_mov_b64 exec, 0xffff
    buffer_store_dword v4, v5, s[40:43], s76 offen offset:3584 sc1
    s_mov_b64 exec, -1
L_s2done_23:
    s_waitcnt vmcnt(0)
    s_mov_b32 s78, 0x05040100
    s_mov_b32 s79, 0x07060302
    v_perm_b32 v160, v100, v96, s78
    v_perm_b32 v164, v100, v96, s79
    v_perm_b32 v168, v101, v97, s78
    v_perm_b32 v172, v101, v97, s79
    v_perm_b32 v176, v102, v98, s78
    v_perm_b32 v180, v102, v98, s79
    v_perm_b32 v184, v103, v99, s78
    v_perm_b32 v188, v103, v99, s79
    v_perm_b32 v161, v108, v104, s78
    v_perm_b32 v165, v108, v104, s79
    v_perm_b32 v169, v109, v105, s78
    v_perm_b32 v173, v109, v105, s79
    v_perm_b32 v177, v110, v106, s78
    v_perm_b32 v181, v110, v106, s79
    v_perm_b32 v185, v111, v107, s78
    v_perm_b32 v189, v111, v107, s79
    v_perm_b32 v162, v116, v112, s78
    v_perm_b32 v166, v116, v112, s79
    v_perm_b32 v170, v117, v113, s78
    v_perm_b32 v174, v117, v113, s79
    v_perm_b32 v178, v118, v114, s78
    v_perm_b32 v182, v118, v114, s79
    v_perm_b32 v186, v119, v115, s78
    v_perm_b32 v190, v119, v115, s79
    v_perm_b32 v163, v124, v120, s78
    v_perm_b32 v167, v124, v120, s79
    v_perm_b32 v171, v125, v121, s78
    v_perm_b32 v175, v125, v121, s79
    v_perm_b32 v179, v126, v122, s78
    v_perm_b32 v183, v126, v122, s79
    v_perm_b32 v187, v127, v123, s78
    v_perm_b32 v191, v127, v123, s79
    v_perm_b32 v192, v132, v128, s78
    v_perm_b32 v196, v132, v128, s79
    v_perm_b32 v200, v133, v129, s78
    v_perm_b32 v204, v133, v129, s79
    v_perm_b32 v208, v134, v130, s78
    v_perm_b32 v212, v134, v130, s79
    v_perm_b32 v216, v135, v131, s78
    v_perm_b32 v220, v135, v131, s79
    v_perm_b32 v193, v140, v136, s78
    v_perm_b32 v197, v140, v136, s79
    v_perm_b32 v201, v141, v137, s78
    v_perm_b32 v205, v141, v137, s79
    v_perm_b32 v209, v142, v138, s78
    v_perm_b32 v213, v142, v138, s79
    v_perm_b32 v217, v143, v139, s78
    v_perm_b32 v221, v143, v139, s79
    v_perm_b32 v194, v148, v144, s78
    v_perm_b32 v198, v148, v144, s79
    v_perm_b32 v202, v149, v145, s78
    v_perm_b32 v206, v149, v145, s79
    v_perm_b32 v210, v150, v146, s78
    v_perm_b32 v214, v150, v146, s79
    v_perm_b32 v218, v151, v147, s78
    v_perm_b32 v222, v151, v147, s79
    v_perm_b32 v195, v156, v152, s78
    v_perm_b32 v199, v156, v152, s79
    v_perm_b32 v203, v157, v153, s78
    v_perm_b32 v207, v157, v153, s79
    v_perm_b32 v211, v158, v154, s78
    v_perm_b32 v215, v158, v154, s79
    v_perm_b32 v219, v159, v155, s78
    v_perm_b32 v223, v159, v155, s79
    v_lshlrev_b32 v17, 5, v2
    v_lshl_add_u32 v17, v3, 4, v17
    v_and_b32 v4, 15, v1
    v_lshrrev_b32 v5, 1, v4
    v_and_b32 v4, 1, v4
    v_lshlrev_b32 v4, 5, v4
    v_lshl_add_u32 v16, v5, 7, v4
    v_lshrrev_b32 v4, 3, v1
    v_and_b32 v5, 7, v1
    v_lshlrev_b32_e64 v5, 4, v5
    v_mul_u32_u24 v18, 9344, v4
    v_add_u32_e64 v18, v18, v5
    v_bfe_u32 v6, v1, 4, 1
    v_lshl_add_u32 v6, v6, 1, v3
    v_lshl_add_u32 v19, v6, 2, v5
    s_mul_i32 s84, s97, 149504
    s_lshl_b32 s77, s98, 7
    s_add_u32 s84, s84, s77
    s_add_u32 s84, s84, 8388608
    s_lshl_b32 s85, s62, 10
    s_add_u32 s85, s85, s99
    s_add_u32 s85, s85, 5120
    s_and_b32 s87, s97, 1
    s_lshl_b32 s87, s87, 4
    s_add_u32 s87, s87, s98
    s_lshr_b32 s86, s97, 1
    s_mul_i32 s86, s86, 299008
    s_lshl_b32 s77, s87, 7
    s_add_u32 s86, s86, s77
    s_add_u32 s86, s86, 8393728
    s_barrier
    s_mul_i32 s78, s62, 2048
    s_add_u32 s78, s78, s99
    s_add_u32 s78, s78, 1024
    v_lshlrev_b32_e64 v11, 7, v1
    s_mov_b64 exec, 65535
    buffer_load_dword v27, v11, s[40:43], s78 offen sc1
    s_mov_b64 exec, -1
    buffer_load_dwordx4 v[32:35], v77, s[52:55], s96 offen nt
    s_add_u32 s96, s96, 4096
    buffer_load_dwordx4 v[36:39], v77, s[52:55], s96 offen nt
    s_add_u32 s96, s96, 4096
    buffer_load_dwordx4 v[40:43], v77, s[52:55], s96 offen nt
    s_add_u32 s96, s96, 4096
    buffer_load_dwordx4 v[44:47], v77, s[52:55], s96 offen nt
    s_add_u32 s96, s96, 4096
    s_barrier
    buffer_load_dwordx4 v[48:51], v77, s[52:55], s96 offen nt
    s_add_u32 s96, s96, 4096
    buffer_load_dwordx4 v[52:55], v77, s[52:55], s96 offen nt
    s_add_u32 s96, s96, 4096
    buffer_load_dwordx4 v[56:59], v77, s[52:55], s96 offen nt
    s_add_u32 s96, s96, 4096
    buffer_load_dwordx4 v[60:63], v77, s[52:55], s96 offen nt
    s_add_u32 s96, s96, 4096
    s_barrier
    s_waitcnt vmcnt(0)
    s_mov_b32 s78, 0x05040100
    s_mov_b32 s79, 0x07060302
    v_permlane32_swap_b32 v32, v34
    v_permlane32_swap_b32 v33, v35
    v_permlane32_swap_b32 v36, v38
    v_permlane32_swap_b32 v37, v39
    v_permlane32_swap_b32 v40, v42
    v_permlane32_swap_b32 v41, v43
    v_permlane32_swap_b32 v44, v46
    v_permlane32_swap_b32 v45, v47
    v_permlane32_swap_b32 v48, v50
    v_permlane32_swap_b32 v49, v51
    v_permlane32_swap_b32 v52, v54
    v_permlane32_swap_b32 v53, v55
    v_permlane32_swap_b32 v56, v58
    v_permlane32_swap_b32 v57, v59
    v_permlane32_swap_b32 v60, v62
    v_permlane32_swap_b32 v61, v63
    v_perm_b32 v224, v34, v32, s78
    v_perm_b32 v225, v34, v32, s79
    v_perm_b32 v226, v35, v33, s78
    v_perm_b32 v227, v35, v33, s79
    v_perm_b32 v228, v38, v36, s78
    v_perm_b32 v229, v38, v36, s79
    v_perm_b32 v230, v39, v37, s78
    v_perm_b32 v231, v39, v37, s79
    v_perm_b32 v232, v42, v40, s78
    v_perm_b32 v233, v42, v40, s79
    v_perm_b32 v234, v43, v41, s78
    v_perm_b32 v235, v43, v41, s79
    v_perm_b32 v236, v46, v44, s78
    v_perm_b32 v237, v46, v44, s79
    v_perm_b32 v238, v47, v45, s78
    v_perm_b32 v239, v47, v45, s79
    v_perm_b32 v240, v50, v48, s78
    v_perm_b32 v241, v50, v48, s79
    v_perm_b32 v242, v51, v49, s78
    v_perm_b32 v243, v51, v49, s79
    v_perm_b32 v244, v54, v52, s78
    v_perm_b32 v245, v54, v52, s79
    v_perm_b32 v246, v55, v53, s78
    v_perm_b32 v247, v55, v53, s79
    v_perm_b32 v248, v58, v56, s78
    v_perm_b32 v249, v58, v56, s79
    v_perm_b32 v250, v59, v57, s78
    v_perm_b32 v251, v59, v57, s79
    v_perm_b32 v252, v62, v60, s78
    v_perm_b32 v253, v62, v60, s79
    v_perm_b32 v254, v63, v61, s78
    v_perm_b32 v255, v63, v61, s79
    v_and_b32 v5, 15, v1
    v_lshlrev_b32 v5, 3, v5
    s_lshl_b32 s76, s63, 10
    s_lshl_b32 s77, s64, 6
    s_add_u32 s76, s76, s77
    s_add_u32 s76, s76, s99
    s_mov_b64 s[80:81], 0xffff
    s_add_u32 s68, s84, 74752
    s_add_u32 s69, s86, 74752
    s_add_u32 s70, s86, 149504
    s_add_u32 s71, s86, 224256
    s_setprio 3
    s_barrier
    ds_read_b128 v[64:67], v12 offset:28672
    ds_read_b128 v[68:71], v12 offset:29696
    ds_read_b64 v[8:9], v5 offset:25728
    s_waitcnt lgkmcnt(2)
    v_mfma_f32_16x16x32_bf16 v[96:99], v[64:67], v[160:163], 0
    v_mfma_f32_16x16x32_bf16 v[100:103], v[64:67], v[164:167], 0
    s_waitcnt lgkmcnt(0)
    v_max_f32_dpp v4, v8, v8 row_ror:8 row_mask:0xf bank_mask:0xf
    v_mfma_f32_16x16x32_bf16 v[104:107], v[64:67], v[168:171], 0
    v_mfma_f32_16x16x32_bf16 v[108:111], v[64:67], v[172:175], 0
    v_max_f32_dpp v4, v4, v4 row_ror:4 row_mask:0xf bank_mask:0xf
    v_mfma_f32_16x16x32_bf16 v[112:115], v[64:67], v[176:179], 0
    v_mfma_f32_16x16x32_bf16 v[116:119], v[64:67], v[180:183], 0
    v_max_f32_dpp v4, v4, v4 row_ror:2 row_mask:0xf bank_mask:0xf
    v_mfma_f32_16x16x32_bf16 v[120:123], v[64:67], v[184:187], 0
    v_mfma_f32_16x16x32_bf16 v[124:127], v[64:67], v[188:191], 0
    v_max_f32_dpp v4, v4, v4 row_ror:1 row_mask:0xf bank_mask:0xf
    v_mfma_f32_16x16x32_bf16 v[96:99], v[68:71], v[192:195], v[96:99]
    v_cmp_eq_f32_e64 vcc, v4, v8
    v_mfma_f32_16x16x32_bf16 v[100:103], v[68:71], v[196:199], v[100:103]
    s_ff1_i32_b32 s92, vcc_lo
    s_and_b32 s92, s92, 15
    v_mfma_f32_16x16x32_bf16 v[104:107], v[68:71], v[200:203], v[104:107]
    s_lshr_b32 s78, s92, 2
    s_lshl_b32 s78, s78, 4
    v_mfma_f32_16x16x32_bf16 v[108:111], v[68:71], v[204:207], v[108:111]
    s_and_b32 s77, s92, 3
    v_mfma_f32_16x16x32_bf16 v[112:115], v[68:71], v[208:211], v[112:115]
    v_readlane_b32 s91, v9, s92
    v_readlane_b32 s93, v8, s92
    v_mfma_f32_16x16x32_bf16 v[116:119], v[68:71], v[212:215], v[116:119]
    v_mfma_f32_16x16x32_bf16 v[120:123], v[68:71], v[216:219], v[120:123]
    v_mfma_f32_16x16x32_bf16 v[124:127], v[68:71], v[220:223], v[124:127]
    s_cmp_ge_u32 s97, 14
    s_cbranch_scc1 L_final
    s_cmp_eq_u32 s77, 0
    s_cbranch_scc0 L_sel_29
    v_mov_b32 v64, v96
    v_mov_b32 v65, v100
    v_mov_b32 v66, v104
    v_mov_b32 v67, v108
    v_mov_b32 v68, v112
    v_mov_b32 v69, v116
    v_mov_b32 v70, v120
    v_mov_b32 v71, v124
    s_branch L_seldone_28
L_sel_29:
    s_cmp_eq_u32 s77, 1
    s_cbranch_scc0 L_sel_30
    v_mov_b32 v64, v97
    v_mov_b32 v65, v101
    v_mov_b32 v66, v105
    v_mov_b32 v67, v109
    v_mov_b32 v68, v113
    v_mov_b32 v69, v117
    v_mov_b32 v70, v121
    v_mov_b32 v71, v125
    s_branch L_seldone_28
L_sel_30:
    s_cmp_eq_u32 s77, 2
    s_cbranch_scc0 L_sel_31
    v_mov_b32 v64, v98
    v_mov_b32 v65, v102
    v_mov_b32 v66, v106
    v_mov_b32 v67, v110
    v_mov_b32 v68, v114
    v_mov_b32 v69, v118
    v_mov_b32 v70, v122
    v_mov_b32 v71, v126
    s_branch L_seldone_28
L_sel_31:
    v_mov_b32 v64, v99
    v_mov_b32 v65, v103
    v_mov_b32 v66, v107
    v_mov_b32 v67, v111
    v_mov_b32 v68, v115
    v_mov_b32 v69, v119
    v_mov_b32 v70, v123
    v_mov_b32_e64 v71, v127
L_seldone_28:
    s_lshl_b64 exec, s[80:81], s78
    s_bitcmp1_b32 s100, 1
    s_cbranch_scc1 L_loc_33
    buffer_store_dwordx4 v[64:67], v16, s[40:43], s76 offen offset:3072 sc1
    buffer_store_dwordx4 v[68:71], v16, s[40:43], s76 offen offset:3088 sc1
    s_branch L_pubd_34
L_loc_33:
    buffer_store_dwordx4 v[64:67], v16, s[40:43], s76 offen offset:3072
    buffer_store_dwordx4 v[68:71], v16, s[40:43], s76 offen offset:3088
L_pubd_34:
    s_mov_b64 exec, -1
    s_mov_b32 s88, 0
L_poll_35:
    buffer_load_dwordx4 v[128:131], v18, s[40:43], s84 offen offset:3072 sc1
    buffer_load_dwordx4 v[132:135], v18, s[40:43], s68 offen offset:3072 sc1
    s_waitcnt vmcnt(0)
    v_max_u32 v4, v128, v132
    v_cmp_eq_u32_e64 vcc, -1, v4
    s_nop 0
    s_cbranch_vccz L_ok_36
    s_add_u32 s88, s88, 1
    s_cmp_lt_u32 s88, 65536
    s_cbranch_scc1 L_poll_35
L_ok_36:
    v_pk_add_f32 v[48:49], v[128:129], v[132:133]
    v_pk_add_f32 v[50:51], v[130:131], v[134:135]
    s_nop 0
    v_permlane32_swap_b32 v48, v49
    v_permlane32_swap_b32 v50, v51
    v_add_f32 v48, v48, v49
    v_add_f32 v50, v50, v51
    s_nop 1
    v_permlane16_swap_b32 v48, v50
    v_add_f32 v48, v48, v50
    s_nop 1
    v_add_f32_dpp v48, v48, v48 row_ror:8 row_mask:0xf bank_mask:0xf
    v_cvt_pk_bf16_f32 v48, v48, v48
    v_and_b32_e64 v48, s90, v48
    v_mul_f32 v4, 0xbfb8aa3b, v48
    v_exp_f32_e64 v4, v4
    v_mov_b32_dpp v49, v48 row_ror:12 row_mask:0xf bank_mask:0xf
    v_add_f32 v4, 1.0, v4
    v_rcp_f32 v4, v4
    s_nop 0
    v_mul_f32 v4, v4, v48
    v_cvt_pk_bf16_f32 v4, v4, v4
    v_and_b32 v4, s90, v4
    v_mul_f32 v4, v4, v49
    v_mov_b32 v5, v4
    s_nop 1
    v_permlane32_swap_b32_e64 v4, v5
    v_cvt_pk_bf16_f32 v4, v4, v5
    s_nop 0
    v_readlane_b32 s76, v4, 0
    v_readlane_b32 s77, v4, 16
    v_readlane_b32 s78, v4, 1
    v_readlane_b32 s79, v4, 17
    v_readlane_b32 s80, v4, 2
    v_readlane_b32 s81, v4, 18
    v_readlane_b32 s82, v4, 3
    v_readlane_b32 s83, v4, 19
    v_dot2_f32_bf16 v40, v224, s76, 0
    v_dot2_f32_bf16 v41, v225, s76, 0
    v_dot2_f32_bf16 v42, v226, s76, 0
    v_dot2_f32_bf16 v43, v227, s76, 0
    v_dot2_f32_bf16 v40, v228, s77, v40
    v_dot2_f32_bf16 v41, v229, s77, v41
    v_dot2_f32_bf16 v42, v230, s77, v42
    v_dot2_f32_bf16 v43, v231, s77, v43
    v_dot2_f32_bf16 v40, v232, s78, v40
    v_dot2_f32_bf16 v41, v233, s78, v41
    v_dot2_f32_bf16 v42, v234, s78, v42
    v_dot2_f32_bf16 v43, v235, s78, v43
    v_dot2_f32_bf16 v40, v236, s79, v40
    v_dot2_f32_bf16 v41, v237, s79, v41
    v_dot2_f32_bf16 v42, v238, s79, v42
    v_dot2_f32_bf16 v43, v239, s79, v43
    v_dot2_f32_bf16 v40, v240, s80, v40
    v_dot2_f32_bf16 v41, v241, s80, v41
    v_dot2_f32_bf16 v42, v242, s80, v42
    v_dot2_f32_bf16 v43, v243, s80, v43
    v_dot2_f32_bf16 v40, v244, s81, v40
    v_dot2_f32_bf16 v41, v245, s81, v41
    v_dot2_f32_bf16 v42, v246, s81, v42
    v_dot2_f32_bf16 v43, v247, s81, v43
    v_dot2_f32_bf16 v40, v248, s82, v40
    v_dot2_f32_bf16 v41, v249, s82, v41
    v_dot2_f32_bf16 v42, v250, s82, v42
    v_dot2_f32_bf16 v43, v251, s82, v43
    v_dot2_f32_bf16 v40, v252, s83, v40
    v_dot2_f32_bf16 v41, v253, s83, v41
    v_dot2_f32_bf16 v42, v254, s83, v42
    v_dot2_f32_bf16 v43, v255, s83, v43
    s_bitcmp1_b32 s100, 1
    s_cbranch_scc1 L_loc_37
    s_nop 0
    buffer_store_dwordx4 v[40:43], v17, s[40:43], s85 offen sc1
    s_branch L_pubd_38
L_loc_37:
    s_nop 0
    buffer_store_dwordx4 v[40:43], v17, s[40:43], s85 offen
L_pubd_38:
    s_cmp_eq_u32 s62, 0
    s_cbranch_scc0 L_hby
    s_mov_b32 s88, 0
L_poll_39:
    buffer_load_dwordx4 v[136:139], v18, s[40:43], s86 offen sc1
    buffer_load_dwordx4 v[140:143], v18, s[40:43], s69 offen sc1
    buffer_load_dwordx4 v[144:147], v18, s[40:43], s70 offen sc1
    buffer_load_dwordx4 v[148:151], v18, s[40:43], s71 offen sc1
    s_waitcnt vmcnt(0)
    v_max3_u32 v4, v136, v140, v144
    v_max_u32 v4, v4, v148
    v_cmp_eq_u32_e64 vcc, -1, v4
    s_nop 0
    s_cbranch_vccz L_ok_40
    s_add_u32 s88, s88, 1
    s_cmp_lt_u32 s88, 65536
    s_cbranch_scc1 L_poll_39
L_ok_40:
    v_pk_add_f32 v[48:49], v[136:137], v[144:145]
    v_pk_add_f32 v[50:51], v[138:139], v[146:147]
    v_pk_add_f32 v[52:53], v[140:141], v[148:149]
    v_pk_add_f32 v[54:55], v[142:143], v[150:151]
    v_pk_add_f32 v[48:49], v[48:49], v[52:53]
    v_pk_add_f32 v[50:51], v[50:51], v[54:55]
    s_nop 0
    v_permlane32_swap_b32 v48, v49
    v_permlane32_swap_b32 v50, v51
    v_add_f32 v48, v48, v49
    v_add_f32 v50, v50, v51
    s_nop 1
    v_permlane16_swap_b32 v48, v50
    v_add_f32 v48, v48, v50
    s_nop 1
    v_add_f32_dpp v48, v48, v48 row_ror:8 row_mask:0xf bank_mask:0xf
    buffer_store_dword v48, v19, s[40:43], s99 offen offset:512 sc1
L_hby:
    s_barrier
    s_branch L_hfin
L_final:
    s_barrier
    s_cmp_eq_u32 s62, 1
    s_cbranch_scc0 L_noep_41
    s_cmp_eq_u32 s87, 0
    s_cbranch_scc0 L_noep_41
    v_mov_b32 v4, 13631488
    s_mov_b64 exec, 1
    buffer_store_dwordx2 v[88:89], v4, s[40:43], 0 offen sc1
    s_mov_b64 exec, -1
L_noep_41:
    s_cmp_eq_u32 s62, 0
    s_cbranch_scc0 L_hfin
    v_mov_b32 v8, s93
    v_cvt_pk_bf16_f32 v8, v8, v8
    v_and_b32_e64 v8, s90, v8
    v_mul_f32 v8, 0xbfb8aa3b, v8
    v_exp_f32 v8, v8
    s_nop 0
    v_add_f32 v8, 1.0, v8
    v_rcp_f32_e64 v8, v8
    s_nop 0
    v_cvt_pk_bf16_f32 v8, v8, v8
    v_and_b32 v8, s90, v8
    s_lshl_b32 s76, s92, 4
    s_lshr_b32 s77, s87, 1
    s_add_u32 s76, s76, s77
    s_mul_i32 s76, s76, 9344
    s_add_u32 s76, s76, 8388608
    s_and_b32 s77, s87, 1
    s_lshl_b32 s77, s77, 5
    s_add_u32 s76, s76, s77
    v_and_b32 v10, 1, v1
    v_lshlrev_b32_e64 v10, 6, v10
    v_bfe_u32 v4, v1, 1, 2
    v_lshl_add_u32 v10, v4, 3, v10
    v_bfe_u32 v4, v1, 4, 1
    v_lshl_add_u32 v10, v4, 2, v10
    v_lshrrev_b32_e64 v4, 3, v1
    v_mul_u32_u24 v6, 299008, v4
    v_and_b32_e64 v5, 7, v1
    v_lshl_add_u32 v6, v5, 4, v6
    v_mov_b32 v7, 2146435072
    v_cmp_gt_u32 vcc, 56, v1
    s_nop 1
    v_cndmask_b32_e64 v6, v7, v6, vcc
    s_mul_i32 s79, s87, 9344
    s_add_u32 s79, s79, 8388608
    s_lshl_b32 s80, s91, 11
    s_lshl_b32 s77, s87, 6
    s_add_u32 s80, s80, s77
    s_sleep 16
    s_mov_b32 s88, 0
L_spin_42:
    buffer_load_dword v64, v10, s[40:43], s76 offen offset:0 sc1
    buffer_load_dword v65, v10, s[40:43], s76 offen offset:128 sc1
    s_waitcnt vmcnt(0)
    v_max_u32 v4, v64, v65
    v_cmp_eq_u32_e64 vcc, -1, v4
    s_nop 0
    s_cbranch_vccz L_ok_43
    s_add_u32 s88, s88, 1
    s_cmp_lt_u32 s88, 65536
    s_cbranch_scc1 L_spin_42
L_ok_43:
    v_lshlrev_b32 v4, 4, v3
    v_lshrrev_b32 v64, v4, v64
    v_lshrrev_b32 v65, v4, v65
    v_lshlrev_b32 v64, 16, v64
    v_lshlrev_b32 v65, 16, v65
    v_lshrrev_b32 v9, 1, v19
    s_mov_b32 s88, 0
    buffer_load_dwordx4 v[128:131], v6, s[40:43], s79 offen offset:512 sc1
    s_sleep 3
    buffer_load_dwordx4 v[128:131], v6, s[40:43], s79 offen offset:512 sc1
    s_sleep 3
L_poll_44:
    buffer_load_dwordx4 v[128:131], v6, s[40:43], s79 offen offset:512 sc1
    s_waitcnt vmcnt(2)
    v_max3_u32 v4, v128, v129, v130
    v_max_u32 v4, v4, v131
    v_cmp_eq_u32 vcc, -1, v4
    s_nop 0
    s_cbranch_vccz L_ok_45
    s_add_u32 s88, s88, 1
    s_cmp_lt_u32 s88, 65536
    s_cbranch_scc1 L_poll_44
L_ok_45:
    v_mov_b32 v48, v128
    v_mov_b32 v49, v129
    v_mov_b32 v50, v130
    v_mov_b32 v51, v131
    v_permlane32_swap_b32 v48, v49
    s_nop 0
    v_permlane32_swap_b32 v50, v51
    v_add_f32 v48, v48, v49
    v_add_f32 v50, v50, v51
    s_nop 1
    v_permlane16_swap_b32 v48, v50
    v_add_f32 v48, v48, v50
    s_nop 1
    v_add_f32_dpp v48, v48, v48 row_ror:8 row_mask:0xf bank_mask:0xf
    v_cvt_pk_bf16_f32 v48, v48, v48
    v_and_b32 v48, s90, v48
    v_mul_f32 v48, v48, v8
    v_cvt_pk_bf16_f32 v48, v48, v48
    v_and_b32 v48, s90, v48
    v_add_f32 v48, v48, v64
    v_cvt_pk_bf16_f32 v48, v48, v48
    v_and_b32 v48, s90, v48
    v_add_f32 v48, v48, v65
    v_cvt_pk_bf16_f32 v48, v48, v48
    s_mov_b32 exec_lo, 0x00ff00ff
    s_mov_b32 exec_hi, 0x00ff00ff
    buffer_store_short v48, v9, s[44:47], s80 offen sc1
    s_mov_b64 exec, -1
L_hfin:
    s_endpgm
L_event:
    s_cmp_eq_u32 s77, 3
    s_cbranch_scc0 L_ev1
    buffer_load_dwordx4 v[92:95], v90, s[40:43], 0 offen sc1
    s_mov_b64 exec, 3
    global_load_dword v27, v91, s[66:67]
    s_mov_b64 exec, -1
    s_branch L_evret
L_ev1:
    s_cmp_eq_u32 s77, 5
    s_cbranch_scc0 L_ev_46
    s_and_b32 s72, s84, 15
    s_mov_b32 m0, s70
    s_lshl_b32 s71, s72, 7
    buffer_load_dwordx4 v16, s[28:31], s71 offen offset:0 lds
    s_mul_i32 s72, s72, 393216
    s_lshr_b64 s[84:85], s[84:85], 4
    buffer_load_dwordx4 v17, s[28:31], s71 offen offset:1024 lds
    buffer_load_dwordx4 v18, s[28:31], s71 offen offset:2048 lds
    buffer_load_dwordx4 v19, s[28:31], s71 offen offset:3072 lds
    s_add_u32 m0, s70, 4096
    s_nop 0
    buffer_load_dwordx4 v20, s[32:35], s72 offen offset:0 lds
    buffer_load_dwordx4 v21, s[32:35], s72 offen offset:1024 lds
    buffer_load_dwordx4 v22, s[32:35], s72 offen offset:2048 lds
    buffer_load_dwordx4 v23, s[32:35], s72 offen offset:3072 lds
    s_add_u32 m0, s70, 8192
    s_nop 0
    buffer_load_dwordx4 v24, s[32:35], s72 offen offset:0 lds
    buffer_load_dwordx4 v25, s[32:35], s72 offen offset:1024 lds
    s_add_u32 s70, s70, 40960
    s_cmp_ge_u32 s70, 122880
    s_cselect_b32 s76, 122880, 0
    s_sub_u32 s70, s70, s76
    buffer_load_dwordx4 v[96:99], v76, s[48:51], s75 offen nt
    s_add_u32 s75, s75, 7168
    buffer_load_dwordx4 v[100:103], v76, s[48:51], s75 offen nt
    s_add_u32 s75, s75, 7168
    buffer_load_dwordx4 v[104:107], v76, s[48:51], s75 offen nt
    s_add_u32 s75, s75, 7168
    buffer_load_dwordx4 v[108:111], v76, s[48:51], s75 offen nt
    s_add_u32 s75, s75, 7168
    buffer_load_dwordx4 v[128:131], v76, s[48:51], s75 offen nt
    s_add_u32 s75, s75, 7168
    buffer_load_dwordx4 v[132:135], v76, s[48:51], s75 offen nt
    s_add_u32 s75, s75, 7168
    buffer_load_dwordx4 v[136:139], v76, s[48:51], s75 offen nt
    s_add_u32 s75, s75, 7168
    buffer_load_dwordx4 v[140:143], v76, s[48:51], s75 offen nt
    s_add_u32 s75, s75, 7168
    s_waitcnt vmcnt(18)
    s_branch L_hbar
L_ev_46:
    s_cmp_eq_u32 s77, 6
    s_cbranch_scc0 L_ev_47
    s_and_b32 s72, s84, 15
    s_mov_b32 m0, s70
    s_lshl_b32 s71, s72, 7
    buffer_load_dwordx4 v16, s[28:31], s71 offen offset:0 lds
    s_mul_i32 s72, s72, 393216
    s_lshr_b64 s[84:85], s[84:85], 4
    buffer_load_dwordx4 v17, s[28:31], s71 offen offset:1024 lds
    buffer_load_dwordx4 v18, s[28:31], s71 offen offset:2048 lds
    buffer_load_dwordx4 v19, s[28:31], s71 offen offset:3072 lds
    s_add_u32 m0, s70, 4096
    s_nop 0
    buffer_load_dwordx4 v20, s[32:35], s72 offen offset:0 lds
    buffer_load_dwordx4 v21, s[32:35], s72 offen offset:1024 lds
    buffer_load_dwordx4 v22, s[32:35], s72 offen offset:2048 lds
    buffer_load_dwordx4 v23, s[32:35], s72 offen offset:3072 lds
    s_add_u32 m0, s70, 8192
    s_nop 0
    buffer_load_dwordx4 v24, s[32:35], s72 offen offset:0 lds
    buffer_load_dwordx4 v25, s[32:35], s72 offen offset:1024 lds
    s_add_u32 s70, s70, 40960
    s_cmp_ge_u32 s70, 122880
    s_cselect_b32 s76, 122880, 0
    s_sub_u32 s70, s70, s76
    s_lshr_b32 s78, s2, 3
    s_lshl2_add_u32 s78, s78, s62
    s_lshl_b32 s78, s78, 14
    v_lshlrev_b32_e64 v11, 10, v1
    s_mov_b64 exec, 65535
    buffer_load_dword v27, v11, s[36:39], s78 offen offset:384
    s_mov_b64 exec, -1
    s_lshl_b32 s78, s62, 9
    v_lshl_add_u32 v11, v1, 7, s78
    s_mov_b64 exec, 15
    global_load_dword v27, v11, s[14:15]
    s_mov_b64 exec, -1
    buffer_load_dwordx4 v[112:115], v76, s[48:51], s75 offen nt
    s_add_u32 s75, s75, 7168
    buffer_load_dwordx4 v[116:119], v76, s[48:51], s75 offen nt
    s_add_u32 s75, s75, 7168
    buffer_load_dwordx4 v[120:123], v76, s[48:51], s75 offen nt
    s_add_u32 s75, s75, 7168
    buffer_load_dwordx4 v[124:127], v76, s[48:51], s75 offen nt
    s_add_u32 s75, s75, 7168
    buffer_load_dwordx4 v[144:147], v76, s[48:51], s75 offen nt
    s_add_u32 s75, s75, 7168
    buffer_load_dwordx4 v[148:151], v76, s[48:51], s75 offen nt
    s_add_u32 s75, s75, 7168
    s_waitcnt vmcnt(18)
    s_branch L_hbar
L_ev_47:
    s_add_u32 s78, s70, 40960
    s_cmp_ge_u32 s78, 122880
    s_cselect_b32 s76, 122880, 0
    s_sub_u32 s78, s78, s76
    s_cmp_eq_u32 s77, 2
    s_cbranch_scc1 L_evw
    v_add_u32 v4, s78, v72
    v_xor_b32 v5, 32, v4
    v_xor_b32 v6, 64, v4
    v_xor_b32 v7, 96, v4
    s_and_b32 s72, s84, 15
    s_mov_b32 m0, s70
    s_lshl_b32 s71, s72, 7
    buffer_load_dwordx4 v16, s[28:31], s71 offen offset:0 lds
    s_mul_i32 s72, s72, 393216
    s_lshr_b64 s[84:85], s[84:85], 4
    ds_read_b128 v[32:35], v4
    ds_read_b128 v[36:39], v5
    ds_read_b128 v[40:43], v6
    ds_read_b128 v[44:47], v7
    buffer_load_dwordx4 v17, s[28:31], s71 offen offset:1024 lds
    s_lshl_b32 s79, s62, 8
    s_add_u32 s79, s79, s73
    s_waitcnt lgkmcnt(0)
    v_lshlrev_b32 v80, 16, v32
    v_and_b32 v82, s90, v32
    v_mul_f32 v81, v80, v80
    v_mul_f32 v83, v82, v82
    v_lshlrev_b32 v10, 16, v33
    v_and_b32 v11, s90, v33
    v_add_f32 v80, v80, v10
    v_add_f32 v82, v82, v11
    v_fmac_f32 v81, v10, v10
    v_fmac_f32 v83, v11, v11
    v_lshlrev_b32 v8, 16, v34
    v_and_b32_e64 v9, s90, v34
    buffer_load_dwordx4 v18, s[28:31], s71 offen offset:2048 lds
    v_add_f32 v80, v80, v8
    v_add_f32 v82, v82, v9
    v_fmac_f32 v81, v8, v8
    v_fmac_f32 v83, v9, v9
    v_lshlrev_b32 v10, 16, v35
    v_and_b32 v11, s90, v35
    v_add_f32 v80, v80, v10
    v_add_f32 v82, v82, v11
    v_fmac_f32 v81, v10, v10
    v_fmac_f32 v83, v11, v11
    v_lshlrev_b32 v8, 16, v36
    v_and_b32 v9, s90, v36
    buffer_load_dwordx4 v19, s[28:31], s71 offen offset:3072 lds
    v_add_f32 v80, v80, v8
    v_add_f32 v82, v82, v9
    v_fmac_f32 v81, v8, v8
    v_fmac_f32 v83, v9, v9
    v_lshlrev_b32 v10, 16, v37
    v_and_b32 v11, s90, v37
    v_add_f32 v80, v80, v10
    v_add_f32 v82, v82, v11
    v_fmac_f32 v81, v10, v10
    v_fmac_f32 v83, v11, v11
    v_lshlrev_b32 v8, 16, v38
    v_and_b32 v9, s90, v38
    s_add_u32 m0, s70, 4096
    s_nop 0
    buffer_load_dwordx4 v20, s[32:35], s72 offen offset:0 lds
    v_add_f32 v80, v80, v8
    v_add_f32 v82, v82, v9
    v_fmac_f32 v81, v8, v8
    v_fmac_f32 v83, v9, v9
    v_lshlrev_b32 v10, 16, v39
    v_and_b32 v11, s90, v39
    v_add_f32 v80, v80, v10
    v_add_f32 v82, v82, v11
    v_fmac_f32 v81, v10, v10
    v_fmac_f32 v83, v11, v11
    v_lshlrev_b32 v8, 16, v40
    v_and_b32_e64 v9, s90, v40
    buffer_load_dwordx4 v21, s[32:35], s72 offen offset:1024 lds
    v_add_f32 v80, v80, v8
    v_add_f32 v82, v82, v9
    v_fmac_f32 v81, v8, v8
    v_fmac_f32 v83, v9, v9
    v_lshlrev_b32 v10, 16, v41
    v_and_b32 v11, s90, v41
    v_add_f32 v80, v80, v10
    v_add_f32 v82, v82, v11
    v_fmac_f32 v81, v10, v10
    v_fmac_f32 v83, v11, v11
    v_lshlrev_b32 v8, 16, v42
    v_and_b32 v9, s90, v42
    buffer_load_dwordx4 v22, s[32:35], s72 offen offset:2048 lds
    v_add_f32 v80, v80, v8
    v_add_f32 v82, v82, v9
    v_fmac_f32 v81, v8, v8
    v_fmac_f32 v83, v9, v9
    v_lshlrev_b32 v10, 16, v43
    v_and_b32 v11, s90, v43
    v_add_f32 v80, v80, v10
    v_add_f32 v82, v82, v11
    v_fmac_f32 v81, v10, v10
    v_fmac_f32 v83, v11, v11
    v_lshlrev_b32 v8, 16, v44
    v_and_b32 v9, s90, v44
    buffer_load_dwordx4 v23, s[32:35], s72 offen offset:3072 lds
    v_add_f32 v80, v80, v8
    v_add_f32 v82, v82, v9
    v_fmac_f32 v81, v8, v8
    v_fmac_f32 v83, v9, v9
    v_lshlrev_b32 v10, 16, v45
    v_and_b32 v11, s90, v45
    v_add_f32 v80, v80, v10
    v_add_f32 v82, v82, v11
    v_fmac_f32 v81, v10, v10
    v_fmac_f32 v83, v11, v11
    v_lshlrev_b32 v8, 16, v46
    v_and_b32 v9, s90, v46
    s_add_u32 m0, s70, 8192
    s_nop 0
    buffer_load_dwordx4 v24, s[32:35], s72 offen offset:0 lds
    v_add_f32 v80, v80, v8
    v_add_f32 v82, v82, v9
    v_fmac_f32 v81, v8, v8
    v_fmac_f32 v83, v9, v9
    v_lshlrev_b32 v10, 16, v47
    v_and_b32 v11, s90, v47
    v_add_f32 v80, v80, v10
    v_add_f32 v82, v82, v11
    v_fmac_f32 v81, v10, v10
    v_fmac_f32_e64 v83, v11, v11
    buffer_load_dwordx4 v25, s[32:35], s72 offen offset:1024 lds
    s_add_u32 s70, s70, 40960
    s_cmp_ge_u32 s70, 122880
    s_cselect_b32 s76, 122880, 0
    s_sub_u32 s70, s70, s76
    v_add_f32 v80, v80, v82
    v_add_f32 v81, v81, v83
    v_mov_b32 v82, v80
    v_mov_b32 v83, v81
    s_nop 0
    v_permlane32_swap_b32 v80, v82
    v_permlane32_swap_b32 v81, v83
    v_add_f32 v80, v80, v82
    v_add_f32_e64 v81, v81, v83
    s_mov_b32 exec_hi, 0
    buffer_store_dwordx2 v[80:81], v74, s[40:43], s79 offen offset:0 sc1
    s_mov_b64 exec, -1
    s_waitcnt vmcnt(11)
    s_branch L_hbar
L_evw:
    s_mul_i32 s79, s63, 2048
    s_add_u32 s79, s79, s78
    v_add_u32_e64 v4, s79, v73
    s_mul_i32 s79, s63, 20480
    s_add_u32 s79, s79, s78
    v_add_u32_e64 v5, s79, v73
    s_and_b32 s72, s84, 15
    s_mov_b32 m0, s70
    s_lshl_b32 s71, s72, 7
    buffer_load_dwordx4 v16, s[28:31], s71 offen offset:0 lds
    s_mul_i32 s72, s72, 393216
    s_lshr_b64 s[84:85], s[84:85], 4
    ds_read_b64_tr_b16 v[32:33], v4 offset:0
    ds_read_b64_tr_b16 v[34:35], v4 offset:512
    ds_read_b64_tr_b16 v[36:37], v4 offset:10240
    ds_read_b64_tr_b16 v[38:39], v4 offset:10752
    ds_read_b64_tr_b16 v[40:41], v4 offset:20480
    ds_read_b64_tr_b16 v[42:43], v4 offset:20992
    ds_read_b64_tr_b16 v[44:45], v4 offset:30720
    ds_read_b64_tr_b16 v[46:47], v4 offset:31232
    ds_read_b64_tr_b16 v[48:49], v5 offset:4096
    ds_read_b64_tr_b16 v[50:51], v5 offset:4608
    ds_read_b64_tr_b16 v[52:53], v5 offset:14336
    ds_read_b64_tr_b16 v[54:55], v5 offset:14848
    buffer_load_dwordx4 v17, s[28:31], s71 offen offset:1024 lds
    s_lshl_b32 s79, s64, 9
    s_lshl_b32 s80, s63, 3
    s_add_u32 s79, s79, s80
    s_add_u32 s79, s79, s73
    s_waitcnt lgkmcnt(0)
    v_lshlrev_b32 v80, 16, v32
    v_and_b32 v82, s90, v32
    v_lshlrev_b32 v10, 16, v33
    v_and_b32 v11, s90, v33
    v_add_f32 v80, v80, v10
    v_add_f32 v82, v82, v11
    v_lshlrev_b32 v8, 16, v34
    v_and_b32 v9, s90, v34
    v_add_f32 v80, v80, v8
    v_add_f32 v82, v82, v9
    v_lshlrev_b32 v10, 16, v35
    v_and_b32 v11, s90, v35
    buffer_load_dwordx4 v18, s[28:31], s71 offen offset:2048 lds
    v_add_f32 v80, v80, v10
    v_add_f32 v82, v82, v11
    v_lshlrev_b32 v8, 16, v36
    v_and_b32 v9, s90, v36
    v_add_f32 v80, v80, v8
    v_add_f32 v82, v82, v9
    v_lshlrev_b32 v10, 16, v37
    v_and_b32 v11, s90, v37
    v_add_f32 v80, v80, v10
    v_add_f32 v82, v82, v11
    v_lshlrev_b32 v8, 16, v38
    v_and_b32 v9, s90, v38
    buffer_load_dwordx4 v19, s[28:31], s71 offen offset:3072 lds
    v_add_f32 v80, v80, v8
    v_add_f32 v82, v82, v9
    v_lshlrev_b32 v10, 16, v39
    v_and_b32 v11, s90, v39
    v_add_f32 v80, v80, v10
    v_add_f32 v82, v82, v11
    v_lshlrev_b32 v8, 16, v40
    v_and_b32 v9, s90, v40
    v_add_f32 v80, v80, v8
    v_add_f32 v82, v82, v9
    v_lshlrev_b32 v10, 16, v41
    v_and_b32 v11, s90, v41
    s_add_u32 m0, s70, 4096
    s_nop 0
    buffer_load_dwordx4 v20, s[32:35], s72 offen offset:0 lds
    v_add_f32 v80, v80, v10
    v_add_f32 v82, v82, v11
    v_lshlrev_b32 v8, 16, v42
    v_and_b32 v9, s90, v42
    v_add_f32 v80, v80, v8
    v_add_f32 v82, v82, v9
    v_lshlrev_b32 v10, 16, v43
    v_and_b32 v11, s90, v43
    v_add_f32 v80, v80, v10
    v_add_f32 v82, v82, v11
    v_lshlrev_b32 v8, 16, v44
    v_and_b32_e64 v9, s90, v44
    buffer_load_dwordx4 v21, s[32:35], s72 offen offset:1024 lds
    v_add_f32 v80, v80, v8
    v_add_f32 v82, v82, v9
    v_lshlrev_b32 v10, 16, v45
    v_and_b32 v11, s90, v45
    v_add_f32 v80, v80, v10
    v_add_f32 v82, v82, v11
    v_lshlrev_b32 v8, 16, v46
    v_and_b32 v9, s90, v46
    v_add_f32 v80, v80, v8
    v_add_f32 v82, v82, v9
    v_lshlrev_b32 v10, 16, v47
    v_and_b32 v11, s90, v47
    buffer_load_dwordx4 v22, s[32:35], s72 offen offset:2048 lds
    v_add_f32 v80, v80, v10
    v_add_f32 v82, v82, v11
    v_lshlrev_b32 v81, 16, v48
    v_and_b32 v83, s90, v48
    v_lshlrev_b32 v10, 16, v49
    v_and_b32 v11, s90, v49
    v_add_f32 v81, v81, v10
    v_add_f32 v83, v83, v11
    v_lshlrev_b32 v8, 16, v50
    v_and_b32 v9, s90, v50
    v_add_f32 v81, v81, v8
    v_add_f32 v83, v83, v9
    buffer_load_dwordx4 v23, s[32:35], s72 offen offset:3072 lds
    v_lshlrev_b32 v10, 16, v51
    v_and_b32 v11, s90, v51
    v_add_f32 v81, v81, v10
    v_add_f32 v83, v83, v11
    v_lshlrev_b32 v8, 16, v52
    v_and_b32 v9, s90, v52
    v_add_f32 v81, v81, v8
    v_add_f32 v83, v83, v9
    v_lshlrev_b32 v10, 16, v53
    v_and_b32 v11, s90, v53
    v_add_f32 v81, v81, v10
    v_add_f32 v83, v83, v11
    s_add_u32 m0, s70, 8192
    s_nop 0
    buffer_load_dwordx4 v24, s[32:35], s72 offen offset:0 lds
    v_lshlrev_b32 v8, 16, v54
    v_and_b32 v9, s90, v54
    v_add_f32 v81, v81, v8
    v_add_f32 v83, v83, v9
    v_lshlrev_b32 v10, 16, v55
    v_and_b32 v11, s90, v55
    v_add_f32 v81, v81, v10
    v_add_f32_e64 v83, v83, v11
    buffer_load_dwordx4 v25, s[32:35], s72 offen offset:1024 lds
    s_add_u32 s70, s70, 40960
    s_cmp_ge_u32 s70, 122880
    s_cselect_b32 s76, 122880, 0
    s_sub_u32 s70, s70, s76
    v_add_f32 v80, v80, v82
    v_add_f32 v81, v81, v83
    v_mov_b32 v82, v80
    v_mov_b32 v83, v81
    s_nop 0
    v_permlane32_swap_b32 v80, v82
    v_permlane32_swap_b32 v81, v83
    v_add_f32 v80, v80, v82
    v_add_f32_e64 v81, v81, v83
    s_mov_b32 exec_hi, 0
    buffer_store_dwordx2 v[80:81], v12, s[40:43], s79 offen offset:1024 sc1
    s_mov_b64 exec, -1
    s_waitcnt vmcnt(11)
    s_branch L_hbar
L_compute:
    s_setprio 2
    s_and_b32 s63, s62, 1
    s_lshr_b32 s64, s62, 1
    s_lshl_b32 s73, s60, 4
    s_add_u32 s73, s73, s61
    s_mul_i32 s73, s73, 28800
    s_add_u32 s76, s2, 7
    s_and_b32 s76, s76, 7
    s_bfe_u32 s77, s2, 0x10003
    s_lshl1_add_u32 s97, s76, s77
    s_lshr_b32 s98, s2, 4
    s_lshl_b32 s99, s97, 4
    s_add_u32 s99, s99, s98
    s_mul_i32 s99, s99, 9344
    s_add_u32 s99, s99, 8388608
    s_lshr_b32 s65, s97, 1
    s_lshl_b32 s76, s97, 3
    s_add_u32 s65, s65, s76
    s_mul_i32 s76, s98, 4
    s_add_u32 s65, s65, s76
    s_and_b32 s65, s65, 15
    s_mov_b32 s89, 0x3f803f80
    s_mov_b32 s90, 0xffff0000
    v_and_b32 v2, 31, v1
    v_lshrrev_b32 v3, 5, v1
    v_lshlrev_b32 v12, 4, v1
    v_lshrrev_b32 v4, 3, v1
    v_mul_u32_u24 v13, 460800, v4
    v_and_b32_e64 v4, 7, v1
    v_lshl_add_u32 v13, v4, 4, v13
    v_and_b32 v10, 15, v1
    v_lshrrev_b32 v11, 4, v1
    s_mul_i32 s76, s63, 20480
    v_lshrrev_b32 v4, 1, v10
    v_xor_b32 v4, v4, v11
    v_lshlrev_b32_e64 v4, 4, v4
    v_lshl_add_u32 v4, v10, 7, v4
    v_add_u32 v192, s76, v4
    v_xor_b32 v193, 64, v192
    v_bfe_u32 v4, v1, 2, 2
    v_and_b32_e64 v6, 1, v11
    v_lshl_add_u32 v5, v6, 3, v4
    v_lshlrev_b32 v5, 7, v5
    v_lshrrev_b32 v4, 1, v4
    v_xor_b32_e64 v4, s64, v4
    v_lshl_add_u32 v5, v4, 6, v5
    v_lshl_add_u32 v5, v6, 5, v5
    v_and_b32_e64 v4, 3, v1
    v_lshl_add_u32 v5, v4, 3, v5
    v_mul_u32_u24 v4, 10240, v3
    v_add_u32_e64 v5, v5, v4
    v_add_u32 v194, 4096, v5
    v_xor_b32_e64 v195, 32, v194
    v_add_u32 v196, 40960, v192
    v_add_u32 v197, 40960, v193
    v_add_u32 v198, 40960, v194
    v_add_u32 v199, 40960, v195
    v_add_u32 v200, 81920, v192
    v_add_u32 v201, 81920, v193
    v_add_u32 v202, 81920, v194
    v_add_u32 v203, 81920, v195
    v_bfe_u32 v4, v1, 2, 2
    v_lshl_add_u32 v4, v3, 3, v4
    v_lshlrev_b32 v4, 6, v4
    v_and_b32 v5, 1, v11
    v_lshl_add_u32 v4, v5, 5, v4
    v_and_b32_e64 v5, 3, v1
    v_lshl_add_u32 v4, v5, 3, v4
    s_lshl_b32 s76, s64, 11
    s_add_u32 s76, s76, 122880
    v_add_u32_e64 v212, s76, v4
    s_lshl_b32 s76, s63, 9
    v_lshl_add_u32 v213, v10, 3, s76
    v_lshl_add_u32 v214, v2, 3, s76
    s_lshl_b32 s76, s64, 8
    v_lshl_add_u32 v215, v10, 3, s76
    v_bfe_u32 v4, v10, 1, 1
    v_xor_b32 v4, s64, v4
    v_lshrrev_b32 v5, 2, v10
    v_xor_b32 v5, v5, v3
    v_xor_b32 v6, v10, v11
    v_and_b32 v6, 1, v6
    v_lshlrev_b32_e64 v4, 6, v4
    v_lshl_add_u32 v4, v5, 4, v4
    v_lshl_add_u32 v4, v6, 3, v4
    v_lshl_add_u32 v4, v10, 7, v4
    s_lshl_b32 s76, s63, 13
    v_add_u32 v216, s76, v4
    v_bfe_u32 v4, v2, 1, 1
    v_bfe_u32 v5, v2, 2, 2
    v_and_b32 v6, 1, v2
    v_xor_b32 v6, v6, v3
    v_lshlrev_b32_e64 v4, 6, v4
    v_lshl_add_u32 v4, v5, 4, v4
    v_lshl_add_u32 v4, v6, 3, v4
    v_lshl_add_u32 v4, v2, 7, v4
    s_lshl_b32 s77, s64, 14
    s_add_u32 s76, s76, s77
    v_add_u32_e64 v217, s76, v4
    v_bfe_u32 v4, v1, 2, 2
    v_lshl_add_u32 v5, v3, 3, v4
    v_lshlrev_b32 v5, 7, v5
    v_lshrrev_b32 v6, 1, v4
    v_lshl_add_u32 v5, v6, 6, v5
    v_bfe_u32 v6, v1, 4, 1
    v_xor_b32_e64 v6, v6, v3
    v_lshl_add_u32 v5, v6, 5, v5
    v_bfe_u32 v6, v1, 1, 1
    v_lshl_add_u32 v5, v6, 4, v5
    v_xor_b32 v6, v1, v4
    v_and_b32 v6, 1, v6
    v_lshl_add_u32 v5, v6, 3, v5
    s_lshl_b32 s76, s63, 6
    s_or_b32 s76, s76, s77
    v_xor_b32 v218, s76, v5
    s_lshl_b32 s76, s64, 6
    v_xor_b32_e64 v220, s76, v5
    v_xor_b32 v219, 528, v218
    v_xor_b32 v221, 528, v220
    v_cmp_gt_u32 s[86:87], 16, v1
    s_waitcnt lgkmcnt(0)
    s_mov_b32 s40, s26
    s_and_b32 s41, s27, 0xffff
    s_mov_b32 s42, 33554432
    s_mov_b32 s43, 0x20000
    s_mov_b32 s44, s22
    s_and_b32 s45, s23, 0xffff
    s_mov_b32 s46, 4194304
    s_mov_b32 s47, 0x20000
    s_mov_b32 s68, 0
    s_getreg_b32 s101, hwreg(HW_REG_XCC_ID, 0, 4)
    v_mov_b32 v9, 13631488
    s_lshl_b32 s76, s61, 8
    s_lshl4_add_u32 s76, s60, s76
    s_add_u32 s76, s76, 12582912
    v_mov_b32 v8, s76
    s_lshl_b32 s76, s60, 8
    s_lshl4_add_u32 s76, s61, s76
    s_add_u32 s76, s76, 12587008
    v_writelane_b32 v8, s76, 1
    s_lshl_b32 s76, s97, 8
    s_lshl4_add_u32 s76, s98, s76
    s_add_u32 s76, s76, 12591104
    v_writelane_b32 v8, s76, 2
    v_mov_b32 v6, s101
    v_mov_b32 v7, 0
    v_mov_b32_e64 v10, 0
    s_cmp_eq_u32 s62, 0
    s_cbranch_scc0 L_noep
    buffer_load_dwordx2 v[4:5], v9, s[40:43], 0 offen
L_noep:
    s_barrier
    ds_read_b128 v[112:115], v192 offset:0
    ds_read_b64_tr_b16 v[128:129], v194 offset:0
    ds_read_b64_tr_b16 v[130:131], v194 offset:512
    ds_read_b128 v[116:119], v192 offset:2048
    ds_read_b128 v[120:123], v192 offset:10240
    ds_read_b128 v[124:127], v192 offset:12288
    ds_read_b64_tr_b16 v[132:133], v195 offset:0
    ds_read_b64_tr_b16 v[134:135], v195 offset:512
    ds_read_b64_tr_b16 v[136:137], v194 offset:2048
    ds_read_b64_tr_b16 v[138:139], v194 offset:2560
    ds_read_b64_tr_b16 v[140:141], v195 offset:2048
    ds_read_b64_tr_b16 v[142:143], v195 offset:2560
    ds_read_b64_tr_b16 v[144:145], v194 offset:4096
    ds_read_b64_tr_b16 v[146:147], v194 offset:4608
    s_waitcnt lgkmcnt(8)
    ds_read_b64_tr_b16 v[148:149], v195 offset:4096
    ds_read_b64_tr_b16 v[150:151], v195 offset:4608
    v_mfma_f32_16x16x32_bf16 v[16:19], v[128:131], v[112:115], 0
    ds_read_b128 v[152:155], v193 offset:0
    v_mfma_f32_16x16x32_bf16 v[20:23], v[128:131], v[116:119], 0
    ds_read_b64_tr_b16 v[168:169], v194 offset:20480
    v_mfma_f32_16x16x32_bf16 v[24:27], v[128:131], v[120:123], 0
    ds_read_b64_tr_b16 v[170:171], v194 offset:20992
    v_mfma_f32_16x16x32_bf16 v[28:31], v[128:131], v[124:127], 0
    ds_read_b128 v[156:159], v193 offset:2048
    s_waitcnt lgkmcnt(4)
    v_mfma_f32_16x16x32_bf16 v[32:35], v[132:135], v[112:115], 0
    ds_read_b128 v[160:163], v193 offset:10240
    v_mfma_f32_16x16x32_bf16 v[36:39], v[132:135], v[116:119], 0
    ds_read_b128 v[164:167], v193 offset:12288
    v_mfma_f32_16x16x32_bf16 v[40:43], v[132:135], v[120:123], 0
    ds_read_b64_tr_b16 v[172:173], v195 offset:20480
    v_mfma_f32_16x16x32_bf16 v[44:47], v[132:135], v[124:127], 0
    ds_read_b64_tr_b16 v[174:175], v195 offset:20992
    v_mfma_f32_16x16x32_bf16 v[48:51], v[136:139], v[112:115], 0
    ds_read_b64_tr_b16 v[176:177], v194 offset:22528
    v_mfma_f32_16x16x32_bf16 v[52:55], v[136:139], v[116:119], 0
    ds_read_b64_tr_b16 v[178:179], v194 offset:23040
    v_mfma_f32_16x16x32_bf16 v[56:59], v[136:139], v[120:123], 0
    ds_read_b64_tr_b16 v[180:181], v195 offset:22528
    v_mfma_f32_16x16x32_bf16 v[60:63], v[136:139], v[124:127], 0
    ds_read_b64_tr_b16 v[182:183], v195 offset:23040
    v_mfma_f32_16x16x32_bf16 v[64:67], v[140:143], v[112:115], 0
    ds_read_b64_tr_b16 v[184:185], v194 offset:24576
    v_mfma_f32_16x16x32_bf16 v[68:71], v[140:143], v[116:119], 0
    ds_read_b64_tr_b16 v[186:187], v194 offset:25088
    v_mfma_f32_16x16x32_bf16 v[72:75], v[140:143], v[120:123], 0
    ds_read_b64_tr_b16 v[188:189], v195 offset:24576
    v_mfma_f32_16x16x32_bf16 v[76:79], v[140:143], v[124:127], 0
    ds_read_b64_tr_b16 v[190:191], v195 offset:25088
    v_mfma_f32_16x16x32_bf16 v[80:83], v[144:147], v[112:115], 0
    v_mfma_f32_16x16x32_bf16 v[84:87], v[144:147], v[116:119], 0
    v_mfma_f32_16x16x32_bf16 v[88:91], v[144:147], v[120:123], 0
    v_mfma_f32_16x16x32_bf16 v[92:95], v[144:147], v[124:127], 0
    v_mfma_f32_16x16x32_bf16 v[96:99], v[148:151], v[112:115], 0
    v_mfma_f32_16x16x32_bf16 v[100:103], v[148:151], v[116:119], 0
    v_mfma_f32_16x16x32_bf16 v[104:107], v[148:151], v[120:123], 0
    v_mfma_f32_16x16x32_bf16 v[108:111], v[148:151], v[124:127], 0
    s_waitcnt lgkmcnt(0)
    v_mfma_f32_16x16x32_bf16 v[16:19], v[168:171], v[152:155], v[16:19]
    s_barrier
    v_mfma_f32_16x16x32_bf16 v[20:23], v[168:171], v[156:159], v[20:23]
    ds_read_b128 v[112:115], v196 offset:0
    ds_read_b64_tr_b16 v[204:205], v212 offset:0
    ds_read_b64_tr_b16 v[206:207], v212 offset:256
    ds_read_b64_tr_b16 v[208:209], v212 offset:1024
    ds_read_b64_tr_b16 v[210:211], v212 offset:1280
    v_mfma_f32_16x16x32_bf16 v[24:27], v[168:171], v[160:163], v[24:27]
    ds_read_b64_tr_b16 v[128:129], v198 offset:0
    s_cmp_eq_u32 s62, 0
    s_cbranch_scc0 L_cloop
    s_waitcnt vmcnt(0)
    v_add_co_u32 v4, vcc, 1, v4
    s_nop 1
    v_addc_co_u32 v5, vcc, 0, v5, vcc
    s_mov_b64 exec, 7
    buffer_store_dwordx4 v[4:7], v8, s[40:43], 0 offen sc1
    s_mov_b64 exec, -1
.p2align 3
L_cloop:
    v_mfma_f32_16x16x32_bf16 v[28:31], v[168:171], v[164:167], v[28:31]
    ds_read_b64_tr_b16 v[130:131], v198 offset:512
    v_mfma_f32_16x16x32_bf16 v[32:35], v[172:175], v[152:155], v[32:35]
    ds_read_b128 v[116:119], v196 offset:2048
    v_mfma_f32_16x16x32_bf16 v[36:39], v[172:175], v[156:159], v[36:39]
    ds_read_b128 v[120:123], v196 offset:10240
    v_mfma_f32_16x16x32_bf16 v[40:43], v[172:175], v[160:163], v[40:43]
    ds_read_b128 v[124:127], v196 offset:12288
    v_mfma_f32_16x16x32_bf16 v[44:47], v[172:175], v[164:167], v[44:47]
    ds_read_b64_tr_b16 v[132:133], v199 offset:0
    v_mfma_f32_16x16x32_bf16 v[48:51], v[176:179], v[152:155], v[48:51]
    ds_read_b64_tr_b16 v[134:135], v199 offset:512
    v_mfma_f32_16x16x32_bf16 v[52:55], v[176:179], v[156:159], v[52:55]
    ds_read_b64_tr_b16 v[136:137], v198 offset:2048
    v_mfma_f32_16x16x32_bf16 v[56:59], v[176:179], v[160:163], v[56:59]
    ds_read_b64_tr_b16 v[138:139], v198 offset:2560
    v_mfma_f32_16x16x32_bf16 v[60:63], v[176:179], v[164:167], v[60:63]
    ds_read_b64_tr_b16 v[140:141], v199 offset:2048
    v_mfma_f32_16x16x32_bf16 v[64:67], v[180:183], v[152:155], v[64:67]
    ds_read_b64_tr_b16 v[142:143], v199 offset:2560
    v_mfma_f32_16x16x32_bf16 v[68:71], v[180:183], v[156:159], v[68:71]
    ds_read_b64_tr_b16 v[144:145], v198 offset:4096
    v_mfma_f32_16x16x32_bf16 v[72:75], v[180:183], v[160:163], v[72:75]
    ds_read_b64_tr_b16 v[146:147], v198 offset:4608
    v_mfma_f32_16x16x32_bf16 v[76:79], v[180:183], v[164:167], v[76:79]
    ds_read_b64_tr_b16 v[148:149], v199 offset:4096
    v_mfma_f32_16x16x32_bf16 v[80:83], v[184:187], v[152:155], v[80:83]
    ds_read_b64_tr_b16 v[150:151], v199 offset:4608
    v_mfma_f32_16x16x32_bf16 v[84:87], v[184:187], v[156:159], v[84:87]
    v_mfma_f32_16x16x32_bf16 v[88:91], v[184:187], v[160:163], v[88:91]
    v_mfma_f32_16x16x32_bf16 v[92:95], v[184:187], v[164:167], v[92:95]
    v_mfma_f32_16x16x32_bf16 v[96:99], v[188:191], v[152:155], v[96:99]
    v_mfma_f32_16x16x32_bf16 v[100:103], v[188:191], v[156:159], v[100:103]
    v_mfma_f32_16x16x32_bf16 v[104:107], v[188:191], v[160:163], v[104:107]
    v_mfma_f32_16x16x32_bf16 v[108:111], v[188:191], v[164:167], v[108:111]
    s_waitcnt lgkmcnt(0)
    v_mfma_f32_16x16x32_bf16 v[16:19], v[128:131], v[112:115], v[16:19]
    ds_read_b128 v[152:155], v197 offset:0
    v_mfma_f32_16x16x32_bf16 v[20:23], v[128:131], v[116:119], v[20:23]
    ds_read_b64_tr_b16 v[168:169], v198 offset:20480
    v_mfma_f32_16x16x32_bf16 v[24:27], v[128:131], v[120:123], v[24:27]
    ds_read_b64_tr_b16 v[170:171], v198 offset:20992
    v_mfma_f32_16x16x32_bf16 v[28:31], v[128:131], v[124:127], v[28:31]
    ds_read_b128 v[156:159], v197 offset:2048
    v_mfma_f32_16x16x32_bf16 v[32:35], v[132:135], v[112:115], v[32:35]
    ds_read_b128 v[160:163], v197 offset:10240
    v_mfma_f32_16x16x32_bf16 v[36:39], v[132:135], v[116:119], v[36:39]
    ds_read_b128 v[164:167], v197 offset:12288
    v_mfma_f32_16x16x32_bf16 v[40:43], v[132:135], v[120:123], v[40:43]
    ds_read_b64_tr_b16 v[172:173], v199 offset:20480
    v_mfma_f32_16x16x32_bf16 v[44:47], v[132:135], v[124:127], v[44:47]
    ds_read_b64_tr_b16 v[174:175], v199 offset:20992
    v_mfma_f32_16x16x32_bf16 v[48:51], v[136:139], v[112:115], v[48:51]
    ds_read_b64_tr_b16 v[176:177], v198 offset:22528
    v_mfma_f32_16x16x32_bf16 v[52:55], v[136:139], v[116:119], v[52:55]
    ds_read_b64_tr_b16 v[178:179], v198 offset:23040
    v_mfma_f32_16x16x32_bf16 v[56:59], v[136:139], v[120:123], v[56:59]
    ds_read_b64_tr_b16 v[180:181], v199 offset:22528
    v_mfma_f32_16x16x32_bf16 v[60:63], v[136:139], v[124:127], v[60:63]
    ds_read_b64_tr_b16 v[182:183], v199 offset:23040
    v_mfma_f32_16x16x32_bf16 v[64:67], v[140:143], v[112:115], v[64:67]
    ds_read_b64_tr_b16 v[184:185], v198 offset:24576
    v_mfma_f32_16x16x32_bf16 v[68:71], v[140:143], v[116:119], v[68:71]
    ds_read_b64_tr_b16 v[186:187], v198 offset:25088
    v_mfma_f32_16x16x32_bf16 v[72:75], v[140:143], v[120:123], v[72:75]
    ds_read_b64_tr_b16 v[188:189], v199 offset:24576
    v_mfma_f32_16x16x32_bf16 v[76:79], v[140:143], v[124:127], v[76:79]
    ds_read_b64_tr_b16 v[190:191], v199 offset:25088
    v_mfma_f32_16x16x32_bf16 v[80:83], v[144:147], v[112:115], v[80:83]
    v_mfma_f32_16x16x32_bf16 v[84:87], v[144:147], v[116:119], v[84:87]
    v_mfma_f32_16x16x32_bf16 v[88:91], v[144:147], v[120:123], v[88:91]
    v_mfma_f32_16x16x32_bf16 v[92:95], v[144:147], v[124:127], v[92:95]
    v_mfma_f32_16x16x32_bf16 v[96:99], v[148:151], v[112:115], v[96:99]
    v_mfma_f32_16x16x32_bf16 v[100:103], v[148:151], v[116:119], v[100:103]
    v_mfma_f32_16x16x32_bf16 v[104:107], v[148:151], v[120:123], v[104:107]
    v_mfma_f32_16x16x32_bf16 v[108:111], v[148:151], v[124:127], v[108:111]
    s_waitcnt lgkmcnt(0)
    v_mfma_f32_16x16x32_bf16 v[16:19], v[168:171], v[152:155], v[16:19]
    s_barrier
    v_mfma_f32_16x16x32_bf16 v[20:23], v[168:171], v[156:159], v[20:23]
    ds_read_b128 v[112:115], v200 offset:0
    v_mfma_f32_16x16x32_bf16 v[24:27], v[168:171], v[160:163], v[24:27]
    ds_read_b64_tr_b16 v[128:129], v202 offset:0
    v_mfma_f32_16x16x32_bf16 v[28:31], v[168:171], v[164:167], v[28:31]
    ds_read_b64_tr_b16 v[130:131], v202 offset:512
    v_mfma_f32_16x16x32_bf16 v[32:35], v[172:175], v[152:155], v[32:35]
    ds_read_b128 v[116:119], v200 offset:2048
    v_mfma_f32_16x16x32_bf16 v[36:39], v[172:175], v[156:159], v[36:39]
    ds_read_b128 v[120:123], v200 offset:10240
    v_mfma_f32_16x16x32_bf16 v[40:43], v[172:175], v[160:163], v[40:43]
    ds_read_b128 v[124:127], v200 offset:12288
    v_mfma_f32_16x16x32_bf16 v[44:47], v[172:175], v[164:167], v[44:47]
    ds_read_b64_tr_b16 v[132:133], v203 offset:0
    v_mfma_f32_16x16x32_bf16 v[48:51], v[176:179], v[152:155], v[48:51]
    ds_read_b64_tr_b16 v[134:135], v203 offset:512
    v_mfma_f32_16x16x32_bf16 v[52:55], v[176:179], v[156:159], v[52:55]
    ds_read_b64_tr_b16 v[136:137], v202 offset:2048
    v_mfma_f32_16x16x32_bf16 v[56:59], v[176:179], v[160:163], v[56:59]
    ds_read_b64_tr_b16 v[138:139], v202 offset:2560
    v_mfma_f32_16x16x32_bf16 v[60:63], v[176:179], v[164:167], v[60:63]
    ds_read_b64_tr_b16 v[140:141], v203 offset:2048
    v_mfma_f32_16x16x32_bf16 v[64:67], v[180:183], v[152:155], v[64:67]
    ds_read_b64_tr_b16 v[142:143], v203 offset:2560
    v_mfma_f32_16x16x32_bf16 v[68:71], v[180:183], v[156:159], v[68:71]
    ds_read_b64_tr_b16 v[144:145], v202 offset:4096
    v_mfma_f32_16x16x32_bf16 v[72:75], v[180:183], v[160:163], v[72:75]
    ds_read_b64_tr_b16 v[146:147], v202 offset:4608
    v_mfma_f32_16x16x32_bf16 v[76:79], v[180:183], v[164:167], v[76:79]
    ds_read_b64_tr_b16 v[148:149], v203 offset:4096
    v_mfma_f32_16x16x32_bf16 v[80:83], v[184:187], v[152:155], v[80:83]
    ds_read_b64_tr_b16 v[150:151], v203 offset:4608
    v_mfma_f32_16x16x32_bf16 v[84:87], v[184:187], v[156:159], v[84:87]
    v_mfma_f32_16x16x32_bf16 v[88:91], v[184:187], v[160:163], v[88:91]
    v_mfma_f32_16x16x32_bf16 v[92:95], v[184:187], v[164:167], v[92:95]
    v_mfma_f32_16x16x32_bf16 v[96:99], v[188:191], v[152:155], v[96:99]
    v_mfma_f32_16x16x32_bf16 v[100:103], v[188:191], v[156:159], v[100:103]
    v_mfma_f32_16x16x32_bf16 v[104:107], v[188:191], v[160:163], v[104:107]
    v_mfma_f32_16x16x32_bf16 v[108:111], v[188:191], v[164:167], v[108:111]
    s_waitcnt lgkmcnt(0)
    v_mfma_f32_16x16x32_bf16 v[16:19], v[128:131], v[112:115], v[16:19]
    ds_read_b128 v[152:155], v201 offset:0
    v_mfma_f32_16x16x32_bf16 v[20:23], v[128:131], v[116:119], v[20:23]
    ds_read_b64_tr_b16 v[168:169], v202 offset:20480
    v_mfma_f32_16x16x32_bf16 v[24:27], v[128:131], v[120:123], v[24:27]
    ds_read_b64_tr_b16 v[170:171], v202 offset:20992
    v_mfma_f32_16x16x32_bf16 v[28:31], v[128:131], v[124:127], v[28:31]
    ds_read_b128 v[156:159], v201 offset:2048
    v_mfma_f32_16x16x32_bf16 v[32:35], v[132:135], v[112:115], v[32:35]
    ds_read_b128 v[160:163], v201 offset:10240
    v_mfma_f32_16x16x32_bf16 v[36:39], v[132:135], v[116:119], v[36:39]
    ds_read_b128 v[164:167], v201 offset:12288
    v_mfma_f32_16x16x32_bf16 v[40:43], v[132:135], v[120:123], v[40:43]
    ds_read_b64_tr_b16 v[172:173], v203 offset:20480
    v_mfma_f32_16x16x32_bf16 v[44:47], v[132:135], v[124:127], v[44:47]
    ds_read_b64_tr_b16 v[174:175], v203 offset:20992
    v_mfma_f32_16x16x32_bf16 v[48:51], v[136:139], v[112:115], v[48:51]
    ds_read_b64_tr_b16 v[176:177], v202 offset:22528
    v_mfma_f32_16x16x32_bf16 v[52:55], v[136:139], v[116:119], v[52:55]
    ds_read_b64_tr_b16 v[178:179], v202 offset:23040
    v_mfma_f32_16x16x32_bf16 v[56:59], v[136:139], v[120:123], v[56:59]
    ds_read_b64_tr_b16 v[180:181], v203 offset:22528
    v_mfma_f32_16x16x32_bf16 v[60:63], v[136:139], v[124:127], v[60:63]
    ds_read_b64_tr_b16 v[182:183], v203 offset:23040
    v_mfma_f32_16x16x32_bf16 v[64:67], v[140:143], v[112:115], v[64:67]
    ds_read_b64_tr_b16 v[184:185], v202 offset:24576
    v_mfma_f32_16x16x32_bf16 v[68:71], v[140:143], v[116:119], v[68:71]
    ds_read_b64_tr_b16 v[186:187], v202 offset:25088
    v_mfma_f32_16x16x32_bf16 v[72:75], v[140:143], v[120:123], v[72:75]
    ds_read_b64_tr_b16 v[188:189], v203 offset:24576
    v_mfma_f32_16x16x32_bf16 v[76:79], v[140:143], v[124:127], v[76:79]
    ds_read_b64_tr_b16 v[190:191], v203 offset:25088
    v_mfma_f32_16x16x32_bf16 v[80:83], v[144:147], v[112:115], v[80:83]
    v_mfma_f32_16x16x32_bf16 v[84:87], v[144:147], v[116:119], v[84:87]
    v_mfma_f32_16x16x32_bf16 v[88:91], v[144:147], v[120:123], v[88:91]
    v_mfma_f32_16x16x32_bf16 v[92:95], v[144:147], v[124:127], v[92:95]
    v_mfma_f32_16x16x32_bf16 v[96:99], v[148:151], v[112:115], v[96:99]
    v_mfma_f32_16x16x32_bf16 v[100:103], v[148:151], v[116:119], v[100:103]
    v_mfma_f32_16x16x32_bf16 v[104:107], v[148:151], v[120:123], v[104:107]
    v_mfma_f32_16x16x32_bf16 v[108:111], v[148:151], v[124:127], v[108:111]
    s_waitcnt lgkmcnt(0)
    v_mfma_f32_16x16x32_bf16 v[16:19], v[168:171], v[152:155], v[16:19]
    s_barrier
    v_mfma_f32_16x16x32_bf16 v[20:23], v[168:171], v[156:159], v[20:23]
    ds_read_b128 v[112:115], v192 offset:0
    v_mfma_f32_16x16x32_bf16 v[24:27], v[168:171], v[160:163], v[24:27]
    ds_read_b64_tr_b16 v[128:129], v194 offset:0
    v_mfma_f32_16x16x32_bf16 v[28:31], v[168:171], v[164:167], v[28:31]
    ds_read_b64_tr_b16 v[130:131], v194 offset:512
    v_mfma_f32_16x16x32_bf16 v[32:35], v[172:175], v[152:155], v[32:35]
    ds_read_b128 v[116:119], v192 offset:2048
    v_mfma_f32_16x16x32_bf16 v[36:39], v[172:175], v[156:159], v[36:39]
    ds_read_b128 v[120:123], v192 offset:10240
    v_mfma_f32_16x16x32_bf16 v[40:43], v[172:175], v[160:163], v[40:43]
    ds_read_b128 v[124:127], v192 offset:12288
    v_mfma_f32_16x16x32_bf16 v[44:47], v[172:175], v[164:167], v[44:47]
    ds_read_b64_tr_b16 v[132:133], v195 offset:0
    v_mfma_f32_16x16x32_bf16 v[48:51], v[176:179], v[152:155], v[48:51]
    ds_read_b64_tr_b16 v[134:135], v195 offset:512
    v_mfma_f32_16x16x32_bf16 v[52:55], v[176:179], v[156:159], v[52:55]
    ds_read_b64_tr_b16 v[136:137], v194 offset:2048
    v_mfma_f32_16x16x32_bf16 v[56:59], v[176:179], v[160:163], v[56:59]
    ds_read_b64_tr_b16 v[138:139], v194 offset:2560
    v_mfma_f32_16x16x32_bf16 v[60:63], v[176:179], v[164:167], v[60:63]
    ds_read_b64_tr_b16 v[140:141], v195 offset:2048
    v_mfma_f32_16x16x32_bf16 v[64:67], v[180:183], v[152:155], v[64:67]
    ds_read_b64_tr_b16 v[142:143], v195 offset:2560
    v_mfma_f32_16x16x32_bf16 v[68:71], v[180:183], v[156:159], v[68:71]
    ds_read_b64_tr_b16 v[144:145], v194 offset:4096
    v_mfma_f32_16x16x32_bf16 v[72:75], v[180:183], v[160:163], v[72:75]
    ds_read_b64_tr_b16 v[146:147], v194 offset:4608
    v_mfma_f32_16x16x32_bf16 v[76:79], v[180:183], v[164:167], v[76:79]
    ds_read_b64_tr_b16 v[148:149], v195 offset:4096
    v_mfma_f32_16x16x32_bf16 v[80:83], v[184:187], v[152:155], v[80:83]
    ds_read_b64_tr_b16 v[150:151], v195 offset:4608
    v_mfma_f32_16x16x32_bf16 v[84:87], v[184:187], v[156:159], v[84:87]
    v_mfma_f32_16x16x32_bf16 v[88:91], v[184:187], v[160:163], v[88:91]
    v_mfma_f32_16x16x32_bf16 v[92:95], v[184:187], v[164:167], v[92:95]
    v_mfma_f32_16x16x32_bf16 v[96:99], v[188:191], v[152:155], v[96:99]
    v_mfma_f32_16x16x32_bf16 v[100:103], v[188:191], v[156:159], v[100:103]
    v_mfma_f32_16x16x32_bf16 v[104:107], v[188:191], v[160:163], v[104:107]
    v_mfma_f32_16x16x32_bf16 v[108:111], v[188:191], v[164:167], v[108:111]
    s_waitcnt lgkmcnt(0)
    v_mfma_f32_16x16x32_bf16 v[16:19], v[128:131], v[112:115], v[16:19]
    ds_read_b128 v[152:155], v193 offset:0
    v_mfma_f32_16x16x32_bf16 v[20:23], v[128:131], v[116:119], v[20:23]
    ds_read_b64_tr_b16 v[168:169], v194 offset:20480
    v_mfma_f32_16x16x32_bf16 v[24:27], v[128:131], v[120:123], v[24:27]
    ds_read_b64_tr_b16 v[170:171], v194 offset:20992
    v_mfma_f32_16x16x32_bf16 v[28:31], v[128:131], v[124:127], v[28:31]
    ds_read_b128 v[156:159], v193 offset:2048
    v_mfma_f32_16x16x32_bf16 v[32:35], v[132:135], v[112:115], v[32:35]
    ds_read_b128 v[160:163], v193 offset:10240
    v_mfma_f32_16x16x32_bf16 v[36:39], v[132:135], v[116:119], v[36:39]
    ds_read_b128 v[164:167], v193 offset:12288
    v_mfma_f32_16x16x32_bf16 v[40:43], v[132:135], v[120:123], v[40:43]
    ds_read_b64_tr_b16 v[172:173], v195 offset:20480
    v_mfma_f32_16x16x32_bf16 v[44:47], v[132:135], v[124:127], v[44:47]
    ds_read_b64_tr_b16 v[174:175], v195 offset:20992
    v_mfma_f32_16x16x32_bf16 v[48:51], v[136:139], v[112:115], v[48:51]
    ds_read_b64_tr_b16 v[176:177], v194 offset:22528
    v_mfma_f32_16x16x32_bf16 v[52:55], v[136:139], v[116:119], v[52:55]
    ds_read_b64_tr_b16 v[178:179], v194 offset:23040
    v_mfma_f32_16x16x32_bf16 v[56:59], v[136:139], v[120:123], v[56:59]
    ds_read_b64_tr_b16 v[180:181], v195 offset:22528
    v_mfma_f32_16x16x32_bf16 v[60:63], v[136:139], v[124:127], v[60:63]
    ds_read_b64_tr_b16 v[182:183], v195 offset:23040
    v_mfma_f32_16x16x32_bf16 v[64:67], v[140:143], v[112:115], v[64:67]
    ds_read_b64_tr_b16 v[184:185], v194 offset:24576
    v_mfma_f32_16x16x32_bf16 v[68:71], v[140:143], v[116:119], v[68:71]
    ds_read_b64_tr_b16 v[186:187], v194 offset:25088
    v_mfma_f32_16x16x32_bf16 v[72:75], v[140:143], v[120:123], v[72:75]
    ds_read_b64_tr_b16 v[188:189], v195 offset:24576
    v_mfma_f32_16x16x32_bf16 v[76:79], v[140:143], v[124:127], v[76:79]
    ds_read_b64_tr_b16 v[190:191], v195 offset:25088
    v_mfma_f32_16x16x32_bf16 v[80:83], v[144:147], v[112:115], v[80:83]
    v_mfma_f32_16x16x32_bf16 v[84:87], v[144:147], v[116:119], v[84:87]
    v_mfma_f32_16x16x32_bf16 v[88:91], v[144:147], v[120:123], v[88:91]
    v_mfma_f32_16x16x32_bf16 v[92:95], v[144:147], v[124:127], v[92:95]
    v_mfma_f32_16x16x32_bf16 v[96:99], v[148:151], v[112:115], v[96:99]
    s_add_u32 s68, s68, 1
    s_cmp_lt_u32 s68, 5
    v_mfma_f32_16x16x32_bf16 v[100:103], v[148:151], v[116:119], v[100:103]
    v_mfma_f32_16x16x32_bf16 v[104:107], v[148:151], v[120:123], v[104:107]
    v_mfma_f32_16x16x32_bf16 v[108:111], v[148:151], v[124:127], v[108:111]
    s_waitcnt lgkmcnt(0)
    v_mfma_f32_16x16x32_bf16 v[16:19], v[168:171], v[152:155], v[16:19]
    s_cbranch_scc0 L_cexit
    s_barrier
    v_mfma_f32_16x16x32_bf16 v[20:23], v[168:171], v[156:159], v[20:23]
    ds_read_b128 v[112:115], v196 offset:0
    v_mfma_f32_16x16x32_bf16 v[24:27], v[168:171], v[160:163], v[24:27]
    ds_read_b64_tr_b16 v[128:129], v198 offset:0
    s_branch L_cloop
L_cexit:
    v_mfma_f32_16x16x32_bf16 v[20:23], v[168:171], v[156:159], v[20:23]
    v_mfma_f32_16x16x32_bf16 v[24:27], v[168:171], v[160:163], v[24:27]
    v_mfma_f32_16x16x32_bf16 v[28:31], v[168:171], v[164:167], v[28:31]
    v_mfma_f32_16x16x32_bf16 v[32:35], v[172:175], v[152:155], v[32:35]
    v_mfma_f32_16x16x32_bf16 v[36:39], v[172:175], v[156:159], v[36:39]
    v_mfma_f32_16x16x32_bf16 v[40:43], v[172:175], v[160:163], v[40:43]
    v_mfma_f32_16x16x32_bf16 v[44:47], v[172:175], v[164:167], v[44:47]
    v_mfma_f32_16x16x32_bf16 v[48:51], v[176:179], v[152:155], v[48:51]
    v_mfma_f32_16x16x32_bf16 v[52:55], v[176:179], v[156:159], v[52:55]
    v_mfma_f32_16x16x32_bf16 v[56:59], v[176:179], v[160:163], v[56:59]
    v_mfma_f32_16x16x32_bf16 v[60:63], v[176:179], v[164:167], v[60:63]
    v_mfma_f32_16x16x32_bf16 v[64:67], v[180:183], v[152:155], v[64:67]
    v_mfma_f32_16x16x32_bf16 v[68:71], v[180:183], v[156:159], v[68:71]
    v_mfma_f32_16x16x32_bf16 v[72:75], v[180:183], v[160:163], v[72:75]
    s_barrier
    ds_read_b32 v11, v10 offset:53248
    ds_read_b64 v[222:223], v213 offset:49152
    ds_read_b64 v[224:225], v213 offset:49280
    ds_read_b64 v[226:227], v213 offset:49408
    v_mfma_f32_16x16x32_bf16 v[76:79], v[180:183], v[164:167], v[76:79]
    ds_read_b64 v[228:229], v213 offset:49536
    ds_read_b64 v[238:239], v215 offset:50176
    ds_read_b64 v[240:241], v215 offset:50304
    v_mfma_f32_16x16x32_bf16 v[80:83], v[184:187], v[152:155], v[80:83]
    ds_read_b64 v[242:243], v215 offset:50688
    ds_read_b64 v[244:245], v215 offset:50816
    ds_read_b64 v[246:247], v215 offset:51200
    v_mfma_f32_16x16x32_bf16 v[84:87], v[184:187], v[156:159], v[84:87]
    ds_read_b64 v[248:249], v215 offset:51328
    ds_read_b32 v250, v214 offset:49156
    ds_read_b32 v252, v214 offset:49412
    v_mfma_f32_16x16x32_bf16 v[88:91], v[184:187], v[160:163], v[88:91]
    s_waitcnt lgkmcnt(8)
    v_readfirstlane_b32 s100, v11
    v_mov_b32_e64 v230, v223
    v_cndmask_b32 v222, 0, v222, s[86:87]
    v_mov_b32_e64 v232, v225
    v_cndmask_b32 v224, 0, v224, s[86:87]
    v_mfma_f32_16x16x32_bf16 v[92:95], v[184:187], v[164:167], v[92:95]
    v_mov_b32_e64 v234, v227
    v_cndmask_b32 v226, 0, v226, s[86:87]
    v_mov_b32_e64 v236, v229
    v_cndmask_b32 v228, 0, v228, s[86:87]
    v_mov_b32 v223, v222
    v_mov_b32 v225, v224
    v_mfma_f32_16x16x32_bf16 v[96:99], v[188:191], v[152:155], v[96:99]
    v_mov_b32 v227, v226
    v_mov_b32_e64 v229, v228
    s_waitcnt lgkmcnt(0)
    v_mul_f32 v251, 0x3fb8aa3b, v250
    v_mul_f32 v253, 0x3fb8aa3b, v252
    v_mfma_f32_16x16x32_bf16 v[100:103], v[188:191], v[156:159], v[100:103]
    v_mfma_f32_16x16x32_bf16 v[104:107], v[188:191], v[160:163], v[104:107]
    v_mfma_f32_16x16x32_bf16 v[108:111], v[188:191], v[164:167], v[108:111]
    v_mfma_f32_16x16x16_bf16 v[48:51], v[242:243], v[222:223], v[48:51]
    v_mfma_f32_16x16x16_bf16 v[52:55], v[242:243], v[224:225], v[52:55]
    v_mfma_f32_16x16x16_bf16 v[56:59], v[242:243], v[226:227], v[56:59]
    v_mfma_f32_16x16x16_bf16 v[60:63], v[242:243], v[228:229], v[60:63]
    v_mfma_f32_16x16x16_bf16 v[64:67], v[244:245], v[222:223], v[64:67]
    v_mfma_f32_16x16x16_bf16 v[68:71], v[244:245], v[224:225], v[68:71]
    v_mfma_f32_16x16x16_bf16 v[72:75], v[244:245], v[226:227], v[72:75]
    v_mfma_f32_16x16x16_bf16 v[76:79], v[244:245], v[228:229], v[76:79]
    v_mfma_f32_16x16x16_bf16 v[80:83], v[246:247], v[222:223], v[80:83]
    v_mfma_f32_16x16x16_bf16 v[84:87], v[246:247], v[224:225], v[84:87]
    v_mfma_f32_16x16x16_bf16 v[88:91], v[246:247], v[226:227], v[88:91]
    v_mfma_f32_16x16x16_bf16 v[92:95], v[246:247], v[228:229], v[92:95]
    v_mfma_f32_16x16x16_bf16 v[96:99], v[248:249], v[222:223], v[96:99]
    v_cvt_pk_bf16_f32 v112, v48, v49
    v_cvt_pk_bf16_f32 v113, v50, v51
    v_mfma_f32_16x16x16_bf16 v[100:103], v[248:249], v[224:225], v[100:103]
    v_cvt_pk_bf16_f32 v114, v52, v53
    v_cvt_pk_bf16_f32 v115, v54, v55
    v_mfma_f32_16x16x16_bf16 v[104:107], v[248:249], v[226:227], v[104:107]
    v_cvt_pk_bf16_f32 v116, v64, v65
    v_cvt_pk_bf16_f32 v117, v66, v67
    v_mfma_f32_16x16x16_bf16 v[108:111], v[248:249], v[228:229], v[108:111]
    v_cvt_pk_bf16_f32 v118, v68, v69
    v_cvt_pk_bf16_f32 v119, v70, v71
    v_mfma_f32_16x16x16_bf16 v[16:19], v[238:239], v[222:223], v[16:19]
    v_cvt_pk_bf16_f32 v120, v56, v57
    v_cvt_pk_bf16_f32 v121, v58, v59
    v_mfma_f32_16x16x16_bf16 v[20:23], v[238:239], v[224:225], v[20:23]
    v_cvt_pk_bf16_f32 v122, v60, v61
    v_cvt_pk_bf16_f32 v123, v62, v63
    v_mfma_f32_16x16x16_bf16 v[24:27], v[238:239], v[226:227], v[24:27]
    v_cvt_pk_bf16_f32 v124, v72, v73
    v_cvt_pk_bf16_f32 v125, v74, v75
    v_mfma_f32_16x16x16_bf16 v[28:31], v[238:239], v[228:229], v[28:31]
    v_cvt_pk_bf16_f32 v126, v76, v77
    v_cvt_pk_bf16_f32 v127, v78, v79
    v_mfma_f32_16x16x16_bf16 v[32:35], v[240:241], v[222:223], v[32:35]
    v_mfma_f32_16x16x16_bf16 v[36:39], v[240:241], v[224:225], v[36:39]
    v_mfma_f32_16x16x16_bf16 v[40:43], v[240:241], v[226:227], v[40:43]
    v_mfma_f32_16x16x16_bf16 v[44:47], v[240:241], v[228:229], v[44:47]
    v_permlane16_swap_b32 v112, v114
    v_permlane16_swap_b32 v113, v115
    v_permlane16_swap_b32 v116, v118
    v_permlane16_swap_b32 v117, v119
    v_permlane16_swap_b32 v120, v122
    v_permlane16_swap_b32 v121, v123
    v_permlane16_swap_b32 v124, v126
    v_permlane16_swap_b32 v125, v127
    v_xor_b32 v168, 0, v217
    v_xor_b32 v169, 16, v217
    v_xor_b32 v170, 32, v217
    v_xor_b32 v171, 48, v217
    v_xor_b32_e64 v172, 64, v217
    v_xor_b32 v173, 80, v217
    v_xor_b32 v174, 96, v217
    v_xor_b32 v175, 112, v217
    v_xor_b32_e64 v4, 32, v216
    v_mfma_f32_32x32x16_bf16 v[48:63], v[204:207], v[112:115], 0
    v_mul_f32 v80, v80, v230
    v_mul_f32 v81, v81, v230
    v_mul_f32 v82, v82, v230
    v_mul_f32 v83, v83, v230
    v_cvt_pk_bf16_f32 v80, v80, v81
    v_cvt_pk_bf16_f32 v81, v82, v83
    ds_write_b64 v216, v[80:81] offset:32768
    v_mfma_f32_32x32x16_bf16 v[64:79], v[204:207], v[120:123], 0
    v_mul_f32 v96, v96, v230
    v_mul_f32 v97, v97, v230
    v_mul_f32 v98, v98, v230
    v_mul_f32 v99, v99, v230
    v_cvt_pk_bf16_f32 v96, v96, v97
    v_cvt_pk_bf16_f32 v97, v98, v99
    ds_write_b64 v4, v[96:97] offset:32768
    v_mfma_f32_32x32x16_bf16 v[48:63], v[208:211], v[116:119], v[48:63]
    v_mul_f32 v84, v84, v232
    v_mul_f32 v85, v85, v232
    v_mul_f32 v86, v86, v232
    v_mul_f32 v87, v87, v232
    v_cvt_pk_bf16_f32 v84, v84, v85
    v_cvt_pk_bf16_f32 v85, v86, v87
    ds_write_b64 v216, v[84:85] offset:34816
    v_mfma_f32_32x32x16_bf16 v[64:79], v[208:211], v[124:127], v[64:79]
    v_mul_f32 v100, v100, v232
    v_mul_f32 v101, v101, v232
    v_mul_f32 v102, v102, v232
    v_mul_f32 v103, v103, v232
    v_cvt_pk_bf16_f32 v100, v100, v101
    v_cvt_pk_bf16_f32 v101, v102, v103
    ds_write_b64 v4, v[100:101] offset:34816
    v_mul_f32 v88, v88, v234
    v_mul_f32 v89, v89, v234
    v_mul_f32 v90, v90, v234
    v_mul_f32 v91, v91, v234
    v_cvt_pk_bf16_f32 v88, v88, v89
    v_cvt_pk_bf16_f32 v89, v90, v91
    ds_write_b64 v216, v[88:89] offset:36864
    v_mul_f32 v104, v104, v234
    v_mul_f32 v105, v105, v234
    v_mul_f32 v106, v106, v234
    v_mul_f32 v107, v107, v234
    v_cvt_pk_bf16_f32 v104, v104, v105
    v_cvt_pk_bf16_f32 v105, v106, v107
    ds_write_b64 v4, v[104:105] offset:36864
    v_mul_f32 v92, v92, v236
    v_mul_f32 v93, v93, v236
    v_mul_f32 v94, v94, v236
    v_mul_f32 v95, v95, v236
    v_cvt_pk_bf16_f32 v92, v92, v93
    v_cvt_pk_bf16_f32 v93, v94, v95
    ds_write_b64 v216, v[92:93] offset:38912
    v_mul_f32 v108, v108, v236
    v_mul_f32 v109, v109, v236
    v_mul_f32 v110, v110, v236
    v_mul_f32 v111, v111, v236
    v_cvt_pk_bf16_f32 v108, v108, v109
    v_cvt_pk_bf16_f32 v109, v110, v111
    ds_write_b64 v4, v[108:109] offset:38912
    v_max3_f32 v160, v48, v49, v50
    v_min3_f32 v162, v48, v49, v50
    v_max3_f32 v160, v160, v51, v52
    v_min3_f32 v162, v162, v51, v52
    v_max3_f32 v160, v160, v53, v54
    v_min3_f32 v162, v162, v53, v54
    v_max3_f32 v160, v160, v55, v56
    v_min3_f32 v162, v162, v55, v56
    v_max3_f32 v160, v160, v57, v58
    v_min3_f32 v162, v162, v57, v58
    v_max3_f32 v160, v160, v59, v60
    v_min3_f32 v162, v162, v59, v60
    v_max3_f32 v160, v160, v61, v62
    v_min3_f32 v162, v162, v61, v62
    v_max_f32 v160, v160, v63
    v_min_f32 v162, v162, v63
    v_max3_f32 v164, v64, v65, v66
    v_min3_f32 v166, v64, v65, v66
    v_max3_f32 v164, v164, v67, v68
    v_min3_f32 v166, v166, v67, v68
    v_max3_f32 v164, v164, v69, v70
    v_min3_f32 v166, v166, v69, v70
    v_max3_f32 v164, v164, v71, v72
    v_min3_f32 v166, v166, v71, v72
    v_max3_f32 v164, v164, v73, v74
    v_min3_f32 v166, v166, v73, v74
    v_max3_f32 v164, v164, v75, v76
    v_min3_f32 v166, v166, v75, v76
    v_max3_f32 v164, v164, v77, v78
    v_min3_f32 v166, v166, v77, v78
    v_max_f32 v164, v164, v79
    v_min_f32 v166, v166, v79
    v_mov_b32 v161, v160
    v_mov_b32 v163, v162
    v_mov_b32 v165, v164
    v_mov_b32 v167, v166
    v_permlane32_swap_b32 v160, v161
    v_permlane32_swap_b32 v162, v163
    v_permlane32_swap_b32 v164, v165
    v_permlane32_swap_b32 v166, v167
    v_max_f32 v160, v160, v161
    v_min_f32 v162, v162, v163
    v_max_f32 v164, v164, v165
    v_min_f32 v166, v166, v167
    v_mul_f32 v160, v160, v251
    v_mul_f32 v162, v162, v251
    v_mul_f32 v164, v164, v253
    v_mul_f32 v166, v166, v253
    v_pk_fma_f32 v[128:129], v[48:49], v[250:251], v[160:161] op_sel:[0,1,0] op_sel_hi:[1,1,0] neg_lo:[0,0,1] neg_hi:[0,0,1]
    v_pk_fma_f32 v[48:49], v[48:49], v[250:251], v[162:163] op_sel:[0,1,0] op_sel_hi:[1,1,0] neg_lo:[0,1,0] neg_hi:[0,1,0]
    v_pk_fma_f32 v[130:131], v[50:51], v[250:251], v[160:161] op_sel:[0,1,0] op_sel_hi:[1,1,0] neg_lo:[0,0,1] neg_hi:[0,0,1]
    v_pk_fma_f32 v[50:51], v[50:51], v[250:251], v[162:163] op_sel:[0,1,0] op_sel_hi:[1,1,0] neg_lo:[0,1,0] neg_hi:[0,1,0]
    v_pk_fma_f32 v[132:133], v[52:53], v[250:251], v[160:161] op_sel:[0,1,0] op_sel_hi:[1,1,0] neg_lo:[0,0,1] neg_hi:[0,0,1]
    v_pk_fma_f32 v[52:53], v[52:53], v[250:251], v[162:163] op_sel:[0,1,0] op_sel_hi:[1,1,0] neg_lo:[0,1,0] neg_hi:[0,1,0]
    v_pk_fma_f32 v[134:135], v[54:55], v[250:251], v[160:161] op_sel:[0,1,0] op_sel_hi:[1,1,0] neg_lo:[0,0,1] neg_hi:[0,0,1]
    v_pk_fma_f32 v[54:55], v[54:55], v[250:251], v[162:163] op_sel:[0,1,0] op_sel_hi:[1,1,0] neg_lo:[0,1,0] neg_hi:[0,1,0]
    v_pk_fma_f32 v[136:137], v[56:57], v[250:251], v[160:161] op_sel:[0,1,0] op_sel_hi:[1,1,0] neg_lo:[0,0,1] neg_hi:[0,0,1]
    v_pk_fma_f32 v[56:57], v[56:57], v[250:251], v[162:163] op_sel:[0,1,0] op_sel_hi:[1,1,0] neg_lo:[0,1,0] neg_hi:[0,1,0]
    v_pk_fma_f32 v[138:139], v[58:59], v[250:251], v[160:161] op_sel:[0,1,0] op_sel_hi:[1,1,0] neg_lo:[0,0,1] neg_hi:[0,0,1]
    v_pk_fma_f32 v[58:59], v[58:59], v[250:251], v[162:163] op_sel:[0,1,0] op_sel_hi:[1,1,0] neg_lo:[0,1,0] neg_hi:[0,1,0]
    v_pk_fma_f32 v[140:141], v[60:61], v[250:251], v[160:161] op_sel:[0,1,0] op_sel_hi:[1,1,0] neg_lo:[0,0,1] neg_hi:[0,0,1]
    v_pk_fma_f32 v[60:61], v[60:61], v[250:251], v[162:163] op_sel:[0,1,0] op_sel_hi:[1,1,0] neg_lo:[0,1,0] neg_hi:[0,1,0]
    v_pk_fma_f32 v[142:143], v[62:63], v[250:251], v[160:161] op_sel:[0,1,0] op_sel_hi:[1,1,0] neg_lo:[0,0,1] neg_hi:[0,0,1]
    v_pk_fma_f32 v[62:63], v[62:63], v[250:251], v[162:163] op_sel:[0,1,0] op_sel_hi:[1,1,0] neg_lo:[0,1,0] neg_hi:[0,1,0]
    v_exp_f32 v128, v128
    v_exp_f32 v48, v48
    v_exp_f32 v129, v129
    v_exp_f32 v49, v49
    v_exp_f32 v130, v130
    v_exp_f32 v50, v50
    v_exp_f32 v131, v131
    v_exp_f32 v51, v51
    v_exp_f32 v132, v132
    v_exp_f32 v52, v52
    v_exp_f32 v133, v133
    v_exp_f32 v53, v53
    v_exp_f32 v134, v134
    v_exp_f32 v54, v54
    v_exp_f32 v135, v135
    v_exp_f32 v55, v55
    v_exp_f32 v136, v136
    v_exp_f32 v56, v56
    v_exp_f32 v137, v137
    v_exp_f32 v57, v57
    v_exp_f32 v138, v138
    v_exp_f32 v58, v58
    v_exp_f32 v139, v139
    v_exp_f32 v59, v59
    v_exp_f32 v140, v140
    v_exp_f32 v60, v60
    v_exp_f32 v141, v141
    v_exp_f32 v61, v61
    v_exp_f32 v142, v142
    v_exp_f32 v62, v62
    v_exp_f32 v143, v143
    v_exp_f32 v63, v63
    v_pk_fma_f32 v[144:145], v[64:65], v[252:253], v[164:165] op_sel:[0,1,0] op_sel_hi:[1,1,0] neg_lo:[0,0,1] neg_hi:[0,0,1]
    v_pk_fma_f32 v[64:65], v[64:65], v[252:253], v[166:167] op_sel:[0,1,0] op_sel_hi:[1,1,0] neg_lo:[0,1,0] neg_hi:[0,1,0]
    v_pk_fma_f32 v[146:147], v[66:67], v[252:253], v[164:165] op_sel:[0,1,0] op_sel_hi:[1,1,0] neg_lo:[0,0,1] neg_hi:[0,0,1]
    v_pk_fma_f32 v[66:67], v[66:67], v[252:253], v[166:167] op_sel:[0,1,0] op_sel_hi:[1,1,0] neg_lo:[0,1,0] neg_hi:[0,1,0]
    v_pk_fma_f32 v[148:149], v[68:69], v[252:253], v[164:165] op_sel:[0,1,0] op_sel_hi:[1,1,0] neg_lo:[0,0,1] neg_hi:[0,0,1]
    v_pk_fma_f32 v[68:69], v[68:69], v[252:253], v[166:167] op_sel:[0,1,0] op_sel_hi:[1,1,0] neg_lo:[0,1,0] neg_hi:[0,1,0]
    v_pk_fma_f32 v[150:151], v[70:71], v[252:253], v[164:165] op_sel:[0,1,0] op_sel_hi:[1,1,0] neg_lo:[0,0,1] neg_hi:[0,0,1]
    v_pk_fma_f32 v[70:71], v[70:71], v[252:253], v[166:167] op_sel:[0,1,0] op_sel_hi:[1,1,0] neg_lo:[0,1,0] neg_hi:[0,1,0]
    v_pk_fma_f32 v[152:153], v[72:73], v[252:253], v[164:165] op_sel:[0,1,0] op_sel_hi:[1,1,0] neg_lo:[0,0,1] neg_hi:[0,0,1]
    v_pk_fma_f32 v[72:73], v[72:73], v[252:253], v[166:167] op_sel:[0,1,0] op_sel_hi:[1,1,0] neg_lo:[0,1,0] neg_hi:[0,1,0]
    v_pk_fma_f32 v[154:155], v[74:75], v[252:253], v[164:165] op_sel:[0,1,0] op_sel_hi:[1,1,0] neg_lo:[0,0,1] neg_hi:[0,0,1]
    v_pk_fma_f32 v[74:75], v[74:75], v[252:253], v[166:167] op_sel:[0,1,0] op_sel_hi:[1,1,0] neg_lo:[0,1,0] neg_hi:[0,1,0]
    v_pk_fma_f32 v[156:157], v[76:77], v[252:253], v[164:165] op_sel:[0,1,0] op_sel_hi:[1,1,0] neg_lo:[0,0,1] neg_hi:[0,0,1]
    v_pk_fma_f32 v[76:77], v[76:77], v[252:253], v[166:167] op_sel:[0,1,0] op_sel_hi:[1,1,0] neg_lo:[0,1,0] neg_hi:[0,1,0]
    v_pk_fma_f32 v[158:159], v[78:79], v[252:253], v[164:165] op_sel:[0,1,0] op_sel_hi:[1,1,0] neg_lo:[0,0,1] neg_hi:[0,0,1]
    v_pk_fma_f32 v[78:79], v[78:79], v[252:253], v[166:167] op_sel:[0,1,0] op_sel_hi:[1,1,0] neg_lo:[0,1,0] neg_hi:[0,1,0]
    v_exp_f32 v144, v144
    v_exp_f32 v64, v64
    v_exp_f32 v145, v145
    v_exp_f32 v65, v65
    v_exp_f32 v146, v146
    v_exp_f32 v66, v66
    v_exp_f32 v147, v147
    v_exp_f32 v67, v67
    v_exp_f32 v148, v148
    v_exp_f32 v68, v68
    v_exp_f32 v149, v149
    v_exp_f32 v69, v69
    v_exp_f32 v150, v150
    v_exp_f32 v70, v70
    v_exp_f32 v151, v151
    v_exp_f32 v71, v71
    v_exp_f32 v152, v152
    v_exp_f32 v72, v72
    v_exp_f32 v153, v153
    v_exp_f32 v73, v73
    v_exp_f32 v154, v154
    v_exp_f32 v74, v74
    v_exp_f32 v155, v155
    v_exp_f32 v75, v75
    v_exp_f32 v156, v156
    v_exp_f32 v76, v76
    v_exp_f32 v157, v157
    v_exp_f32 v77, v77
    v_exp_f32 v158, v158
    v_exp_f32 v78, v78
    v_exp_f32 v159, v159
    v_exp_f32 v79, v79
    v_pk_add_f32 v[176:177], v[128:129], v[130:131]
    v_pk_add_f32 v[176:177], v[176:177], v[132:133]
    v_pk_add_f32 v[176:177], v[176:177], v[134:135]
    v_pk_add_f32 v[176:177], v[176:177], v[136:137]
    v_pk_add_f32 v[176:177], v[176:177], v[138:139]
    v_pk_add_f32 v[176:177], v[176:177], v[140:141]
    v_pk_add_f32 v[176:177], v[176:177], v[142:143]
    v_pk_add_f32 v[178:179], v[48:49], v[50:51]
    v_pk_add_f32 v[178:179], v[178:179], v[52:53]
    v_pk_add_f32 v[178:179], v[178:179], v[54:55]
    v_pk_add_f32 v[178:179], v[178:179], v[56:57]
    v_pk_add_f32 v[178:179], v[178:179], v[58:59]
    v_pk_add_f32 v[178:179], v[178:179], v[60:61]
    v_pk_add_f32 v[178:179], v[178:179], v[62:63]
    v_pk_add_f32 v[180:181], v[144:145], v[146:147]
    v_pk_add_f32 v[180:181], v[180:181], v[148:149]
    v_pk_add_f32 v[180:181], v[180:181], v[150:151]
    v_pk_add_f32 v[180:181], v[180:181], v[152:153]
    v_pk_add_f32 v[180:181], v[180:181], v[154:155]
    v_pk_add_f32 v[180:181], v[180:181], v[156:157]
    v_pk_add_f32 v[180:181], v[180:181], v[158:159]
    v_pk_add_f32 v[182:183], v[64:65], v[66:67]
    v_pk_add_f32 v[182:183], v[182:183], v[68:69]
    v_pk_add_f32 v[182:183], v[182:183], v[70:71]
    v_pk_add_f32 v[182:183], v[182:183], v[72:73]
    v_pk_add_f32 v[182:183], v[182:183], v[74:75]
    v_pk_add_f32 v[182:183], v[182:183], v[76:77]
    v_pk_add_f32 v[182:183], v[182:183], v[78:79]
    v_add_f32 v176, v176, v177
    v_add_f32 v178, v178, v179
    v_add_f32 v180, v180, v181
    v_add_f32 v182, v182, v183
    v_mov_b32 v177, v176
    v_mov_b32 v179, v178
    v_mov_b32 v181, v180
    v_mov_b32 v183, v182
    v_permlane32_swap_b32 v176, v177
    v_permlane32_swap_b32 v178, v179
    v_permlane32_swap_b32 v180, v181
    v_permlane32_swap_b32 v182, v183
    v_add_f32 v176, v176, v177
    v_add_f32 v178, v178, v179
    v_add_f32 v180, v180, v181
    v_add_f32 v182, v182, v183
    v_rcp_f32 v176, v176
    v_rcp_f32 v178, v178
    v_rcp_f32 v180, v180
    v_rcp_f32 v182, v182
    v_pk_mul_f32 v[128:129], v[128:129], v[176:177] op_sel_hi:[1,0]
    v_pk_mul_f32 v[130:131], v[130:131], v[176:177] op_sel_hi:[1,0]
    v_pk_mul_f32 v[132:133], v[132:133], v[176:177] op_sel_hi:[1,0]
    v_pk_mul_f32 v[134:135], v[134:135], v[176:177] op_sel_hi:[1,0]
    v_pk_mul_f32 v[136:137], v[136:137], v[176:177] op_sel_hi:[1,0]
    v_pk_mul_f32 v[138:139], v[138:139], v[176:177] op_sel_hi:[1,0]
    v_pk_mul_f32 v[140:141], v[140:141], v[176:177] op_sel_hi:[1,0]
    v_pk_mul_f32 v[142:143], v[142:143], v[176:177] op_sel_hi:[1,0]
    v_cvt_pk_bf16_f32 v128, v128, v129
    v_cvt_pk_bf16_f32 v129, v130, v131
    ds_write_b64 v168, v[128:129] offset:0
    v_cvt_pk_bf16_f32 v130, v132, v133
    v_cvt_pk_bf16_f32 v131, v134, v135
    ds_write_b64 v169, v[130:131] offset:0
    v_cvt_pk_bf16_f32 v132, v136, v137
    v_cvt_pk_bf16_f32 v133, v138, v139
    ds_write_b64 v170, v[132:133] offset:0
    v_cvt_pk_bf16_f32 v134, v140, v141
    v_cvt_pk_bf16_f32 v135, v142, v143
    ds_write_b64 v171, v[134:135] offset:0
    v_pk_mul_f32 v[48:49], v[48:49], v[178:179] op_sel_hi:[1,0]
    v_pk_mul_f32 v[50:51], v[50:51], v[178:179] op_sel_hi:[1,0]
    v_pk_mul_f32 v[52:53], v[52:53], v[178:179] op_sel_hi:[1,0]
    v_pk_mul_f32 v[54:55], v[54:55], v[178:179] op_sel_hi:[1,0]
    v_pk_mul_f32 v[56:57], v[56:57], v[178:179] op_sel_hi:[1,0]
    v_pk_mul_f32 v[58:59], v[58:59], v[178:179] op_sel_hi:[1,0]
    v_pk_mul_f32 v[60:61], v[60:61], v[178:179] op_sel_hi:[1,0]
    v_pk_mul_f32 v[62:63], v[62:63], v[178:179] op_sel_hi:[1,0]
    v_cvt_pk_bf16_f32 v48, v48, v49
    v_cvt_pk_bf16_f32 v49, v50, v51
    ds_write_b64 v172, v[48:49] offset:0
    v_cvt_pk_bf16_f32 v50, v52, v53
    v_cvt_pk_bf16_f32 v51, v54, v55
    ds_write_b64 v173, v[50:51] offset:0
    v_cvt_pk_bf16_f32 v52, v56, v57
    v_cvt_pk_bf16_f32 v53, v58, v59
    ds_write_b64 v174, v[52:53] offset:0
    v_cvt_pk_bf16_f32 v54, v60, v61
    v_cvt_pk_bf16_f32 v55, v62, v63
    ds_write_b64 v175, v[54:55] offset:0
    v_pk_mul_f32 v[144:145], v[144:145], v[180:181] op_sel_hi:[1,0]
    v_pk_mul_f32 v[146:147], v[146:147], v[180:181] op_sel_hi:[1,0]
    v_pk_mul_f32 v[148:149], v[148:149], v[180:181] op_sel_hi:[1,0]
    v_pk_mul_f32 v[150:151], v[150:151], v[180:181] op_sel_hi:[1,0]
    v_pk_mul_f32 v[152:153], v[152:153], v[180:181] op_sel_hi:[1,0]
    v_pk_mul_f32 v[154:155], v[154:155], v[180:181] op_sel_hi:[1,0]
    v_pk_mul_f32 v[156:157], v[156:157], v[180:181] op_sel_hi:[1,0]
    v_pk_mul_f32 v[158:159], v[158:159], v[180:181] op_sel_hi:[1,0]
    v_cvt_pk_bf16_f32 v144, v144, v145
    v_cvt_pk_bf16_f32 v145, v146, v147
    ds_write_b64 v168, v[144:145] offset:4096
    v_cvt_pk_bf16_f32 v146, v148, v149
    v_cvt_pk_bf16_f32 v147, v150, v151
    ds_write_b64 v169, v[146:147] offset:4096
    v_cvt_pk_bf16_f32 v148, v152, v153
    v_cvt_pk_bf16_f32 v149, v154, v155
    ds_write_b64 v170, v[148:149] offset:4096
    v_cvt_pk_bf16_f32 v150, v156, v157
    v_cvt_pk_bf16_f32 v151, v158, v159
    ds_write_b64 v171, v[150:151] offset:4096
    v_pk_mul_f32 v[64:65], v[64:65], v[182:183] op_sel_hi:[1,0]
    v_pk_mul_f32 v[66:67], v[66:67], v[182:183] op_sel_hi:[1,0]
    v_pk_mul_f32 v[68:69], v[68:69], v[182:183] op_sel_hi:[1,0]
    v_pk_mul_f32 v[70:71], v[70:71], v[182:183] op_sel_hi:[1,0]
    v_pk_mul_f32 v[72:73], v[72:73], v[182:183] op_sel_hi:[1,0]
    v_pk_mul_f32 v[74:75], v[74:75], v[182:183] op_sel_hi:[1,0]
    v_pk_mul_f32 v[76:77], v[76:77], v[182:183] op_sel_hi:[1,0]
    v_pk_mul_f32 v[78:79], v[78:79], v[182:183] op_sel_hi:[1,0]
    v_cvt_pk_bf16_f32 v64, v64, v65
    v_cvt_pk_bf16_f32 v65, v66, v67
    ds_write_b64 v172, v[64:65] offset:4096
    v_cvt_pk_bf16_f32 v66, v68, v69
    v_cvt_pk_bf16_f32 v67, v70, v71
    ds_write_b64 v173, v[66:67] offset:4096
    v_cvt_pk_bf16_f32 v68, v72, v73
    v_cvt_pk_bf16_f32 v69, v74, v75
    ds_write_b64 v174, v[68:69] offset:4096
    v_cvt_pk_bf16_f32 v70, v76, v77
    v_cvt_pk_bf16_f32 v71, v78, v79
    ds_write_b64 v175, v[70:71] offset:4096
    s_waitcnt lgkmcnt(0)
    s_barrier
    ds_read_b64_tr_b16 v[112:113], v218 offset:0
    ds_read_b64_tr_b16 v[114:115], v219 offset:0
    ds_read_b64_tr_b16 v[144:145], v220 offset:32768
    ds_read_b64_tr_b16 v[146:147], v221 offset:32768
    ds_read_b64_tr_b16 v[116:117], v218 offset:2048
    ds_read_b64_tr_b16 v[118:119], v219 offset:2048
    ds_read_b64_tr_b16 v[148:149], v220 offset:34816
    ds_read_b64_tr_b16 v[150:151], v221 offset:34816
    ds_read_b64_tr_b16 v[120:121], v218 offset:4096
    ds_read_b64_tr_b16 v[122:123], v219 offset:4096
    ds_read_b64_tr_b16 v[152:153], v220 offset:36864
    ds_read_b64_tr_b16 v[154:155], v221 offset:36864
    v_cvt_pk_bf16_f32 v176, v16, v17
    v_cvt_pk_bf16_f32 v177, v18, v19
    v_cvt_pk_bf16_f32 v178, v20, v21
    v_cvt_pk_bf16_f32 v179, v22, v23
    v_cvt_pk_bf16_f32 v180, v32, v33
    v_cvt_pk_bf16_f32 v181, v34, v35
    v_cvt_pk_bf16_f32 v182, v36, v37
    v_cvt_pk_bf16_f32 v183, v38, v39
    v_cvt_pk_bf16_f32 v184, v24, v25
    v_cvt_pk_bf16_f32 v185, v26, v27
    v_cvt_pk_bf16_f32 v186, v28, v29
    v_cvt_pk_bf16_f32 v187, v30, v31
    v_cvt_pk_bf16_f32 v188, v40, v41
    v_cvt_pk_bf16_f32 v189, v42, v43
    v_cvt_pk_bf16_f32 v190, v44, v45
    v_cvt_pk_bf16_f32 v191, v46, v47
    s_waitcnt lgkmcnt(8)
    v_mfma_f32_32x32x16_bf16 v[48:63], v[112:115], v[144:147], 0
    ds_read_b64_tr_b16 v[124:125], v218 offset:6144
    ds_read_b64_tr_b16 v[126:127], v219 offset:6144
    ds_read_b64_tr_b16 v[156:157], v220 offset:38912
    ds_read_b64_tr_b16 v[158:159], v221 offset:38912
    s_waitcnt lgkmcnt(8)
    v_mfma_f32_32x32x16_bf16 v[48:63], v[116:119], v[148:151], v[48:63]
    ds_read_b64_tr_b16 v[128:129], v218 offset:8192
    ds_read_b64_tr_b16 v[130:131], v219 offset:8192
    ds_read_b64_tr_b16 v[160:161], v220 offset:40960
    ds_read_b64_tr_b16 v[162:163], v221 offset:40960
    s_waitcnt lgkmcnt(8)
    v_mfma_f32_32x32x16_bf16 v[48:63], v[120:123], v[152:155], v[48:63]
    ds_read_b64_tr_b16 v[132:133], v218 offset:10240
    ds_read_b64_tr_b16 v[134:135], v219 offset:10240
    ds_read_b64_tr_b16 v[164:165], v220 offset:43008
    ds_read_b64_tr_b16 v[166:167], v221 offset:43008
    s_waitcnt lgkmcnt(8)
    v_mfma_f32_32x32x16_bf16 v[48:63], v[124:127], v[156:159], v[48:63]
    ds_read_b64_tr_b16 v[136:137], v218 offset:12288
    ds_read_b64_tr_b16 v[138:139], v219 offset:12288
    ds_read_b64_tr_b16 v[168:169], v220 offset:45056
    ds_read_b64_tr_b16 v[170:171], v221 offset:45056
    s_waitcnt lgkmcnt(8)
    v_mfma_f32_32x32x16_bf16 v[48:63], v[128:131], v[160:163], v[48:63]
    ds_read_b64_tr_b16 v[140:141], v218 offset:14336
    ds_read_b64_tr_b16 v[142:143], v219 offset:14336
    ds_read_b64_tr_b16 v[172:173], v220 offset:47104
    ds_read_b64_tr_b16 v[174:175], v221 offset:47104
    s_waitcnt lgkmcnt(8)
    v_mfma_f32_32x32x16_bf16 v[48:63], v[132:135], v[164:167], v[48:63]
    v_permlane16_swap_b32 v176, v178
    v_permlane16_swap_b32_e64 v177, v179
    s_waitcnt lgkmcnt(4)
    v_mfma_f32_32x32x16_bf16 v[48:63], v[136:139], v[168:171], v[48:63]
    v_permlane16_swap_b32 v180, v182
    v_permlane16_swap_b32 v181, v183
    v_permlane16_swap_b32 v184, v186
    s_waitcnt lgkmcnt(0)
    v_mfma_f32_32x32x16_bf16 v[48:63], v[140:143], v[172:175], v[48:63]
    s_barrier
    v_permlane16_swap_b32 v185, v187
    v_permlane16_swap_b32 v188, v190
    v_permlane16_swap_b32 v189, v191
    s_lshl_b32 s76, s62, 11
    s_add_u32 s76, s76, s73
    v_mfma_f32_32x32x16_bf16 v[16:31], v[204:207], v[176:179], 0
    s_add_u32 s76, s76, 4096
    s_lshl_b32 s77, s62, 7
    s_add_u32 s77, s77, s73
    v_lshlrev_b32_e64 v4, 2, v2
    v_mfma_f32_32x32x16_bf16 v[32:47], v[204:207], v[184:187], 0
    v_cvt_pk_bf16_f32 v64, v48, v49
    v_cvt_pk_bf16_f32 v65, v50, v51
    v_cvt_pk_bf16_f32 v66, v52, v53
    v_cvt_pk_bf16_f32 v67, v54, v55
    v_cvt_pk_bf16_f32 v68, v56, v57
    v_mfma_f32_32x32x16_bf16 v[16:31], v[208:211], v[180:183], v[16:31]
    v_cvt_pk_bf16_f32 v69, v58, v59
    v_cvt_pk_bf16_f32 v70, v60, v61
    v_cvt_pk_bf16_f32 v71, v62, v63
    s_bitcmp1_b32 s100, 0
    s_cbranch_scc1 L_loc_48
    buffer_store_dwordx4 v[64:67], v12, s[40:43], s76 offen offset:0 sc1
    buffer_store_dwordx4 v[68:71], v12, s[40:43], s76 offen offset:1024 sc1
    s_branch L_pubd_49
L_loc_48:
    buffer_store_dwordx4 v[64:67], v12, s[40:43], s76 offen offset:0
    buffer_store_dwordx4 v[68:71], v12, s[40:43], s76 offen offset:1024
L_pubd_49:
    v_mfma_f32_32x32x16_bf16 v[32:47], v[208:211], v[188:191], v[32:47]
    v_and_b32 v216, 1, v1
    v_lshlrev_b32_e64 v216, 8, v216
    v_lshl_add_u32 v216, v3, 4, v216
    s_lshl_b32 s76, s64, 7
    v_add_u32 v216, s76, v216
    s_mul_i32 s78, s61, 28800
    s_lshl_b32 s79, s64, 8
    s_add_u32 s78, s78, s79
    s_add_u32 s79, s78, 3686400
    v_dot2_f32_bf16 v72, v112, s89, 0
    v_dot2_f32_bf16 v73, v113, s89, 0
    v_dot2_f32_bf16 v72, v114, s89, v72
    v_dot2_f32_bf16 v73, v115, s89, v73
    v_dot2_f32_bf16 v72, v116, s89, v72
    v_dot2_f32_bf16 v73, v117, s89, v73
    v_dot2_f32_bf16 v72, v118, s89, v72
    v_dot2_f32_bf16 v73, v119, s89, v73
    v_dot2_f32_bf16 v72, v120, s89, v72
    v_dot2_f32_bf16 v73, v121, s89, v73
    v_dot2_f32_bf16 v72, v122, s89, v72
    v_dot2_f32_bf16 v73, v123, s89, v73
    v_dot2_f32_bf16 v72, v124, s89, v72
    v_dot2_f32_bf16 v73, v125, s89, v73
    v_dot2_f32_bf16 v72, v126, s89, v72
    v_dot2_f32_bf16 v73, v127, s89, v73
    v_dot2_f32_bf16 v72, v128, s89, v72
    v_dot2_f32_bf16 v73, v129, s89, v73
    v_dot2_f32_bf16 v72, v130, s89, v72
    v_dot2_f32_bf16 v73, v131, s89, v73
    v_dot2_f32_bf16 v72, v132, s89, v72
    v_dot2_f32_bf16 v73, v133, s89, v73
    v_dot2_f32_bf16 v72, v134, s89, v72
    v_dot2_f32_bf16 v73, v135, s89, v73
    v_dot2_f32_bf16 v72, v136, s89, v72
    v_dot2_f32_bf16 v73, v137, s89, v73
    v_dot2_f32_bf16 v72, v138, s89, v72
    v_dot2_f32_bf16 v73, v139, s89, v73
    v_dot2_f32_bf16 v72, v140, s89, v72
    v_dot2_f32_bf16 v73, v141, s89, v73
    v_dot2_f32_bf16 v72, v142, s89, v72
    v_dot2_f32_bf16 v73, v143, s89, v73
    s_lshl_b32 s76, s98, 7
    v_lshl_add_u32 v10, v3, 3, s76
    v_lshlrev_b32 v11, 5, v1
    v_add_f32 v72, v72, v73
    v_mov_b32 v73, v72
    s_nop 1
    v_permlane32_swap_b32 v72, v73
    v_add_f32 v72, v72, v73
    s_mov_b32 exec_hi, 0
    s_bitcmp1_b32 s100, 0
    s_cbranch_scc1 L_loc_50
    buffer_store_dword v72, v4, s[40:43], s77 offen offset:2048 sc1
    s_branch L_pubd_51
L_loc_50:
    buffer_store_dword v72, v4, s[40:43], s77 offen offset:2048
L_pubd_51:
    s_mov_b64 exec, -1
    v_max3_f32 v160, v16, v17, v18
    v_min3_f32 v162, v16, v17, v18
    v_max3_f32 v160, v160, v19, v20
    v_min3_f32 v162, v162, v19, v20
    v_max3_f32 v160, v160, v21, v22
    v_min3_f32 v162, v162, v21, v22
    v_max3_f32 v160, v160, v23, v24
    v_min3_f32 v162, v162, v23, v24
    v_max3_f32 v160, v160, v25, v26
    v_min3_f32 v162, v162, v25, v26
    v_max3_f32 v160, v160, v27, v28
    v_min3_f32 v162, v162, v27, v28
    v_max3_f32 v160, v160, v29, v30
    v_min3_f32 v162, v162, v29, v30
    v_max_f32 v160, v160, v31
    v_min_f32 v162, v162, v31
    v_max3_f32 v164, v32, v33, v34
    v_min3_f32 v166, v32, v33, v34
    v_max3_f32 v164, v164, v35, v36
    v_min3_f32 v166, v166, v35, v36
    v_max3_f32 v164, v164, v37, v38
    v_min3_f32 v166, v166, v37, v38
    v_max3_f32 v164, v164, v39, v40
    v_min3_f32 v166, v166, v39, v40
    v_max3_f32 v164, v164, v41, v42
    v_min3_f32 v166, v166, v41, v42
    v_max3_f32 v164, v164, v43, v44
    v_min3_f32 v166, v166, v43, v44
    v_max3_f32 v164, v164, v45, v46
    v_min3_f32 v166, v166, v45, v46
    v_max_f32 v164, v164, v47
    v_min_f32 v166, v166, v47
    v_mov_b32 v161, v160
    v_mov_b32 v163, v162
    v_mov_b32 v165, v164
    v_mov_b32 v167, v166
    v_permlane32_swap_b32 v160, v161
    v_permlane32_swap_b32 v162, v163
    v_permlane32_swap_b32 v164, v165
    v_permlane32_swap_b32 v166, v167
    v_max_f32 v160, v160, v161
    v_min_f32 v162, v162, v163
    v_max_f32 v164, v164, v165
    v_min_f32 v166, v166, v167
    v_mul_f32 v160, v160, v251
    v_mul_f32 v162, v162, v251
    v_mul_f32 v164, v164, v253
    v_mul_f32 v166, v166, v253
    v_pk_fma_f32 v[128:129], v[16:17], v[250:251], v[160:161] op_sel:[0,1,0] op_sel_hi:[1,1,0] neg_lo:[0,0,1] neg_hi:[0,0,1]
    v_pk_fma_f32 v[16:17], v[16:17], v[250:251], v[162:163] op_sel:[0,1,0] op_sel_hi:[1,1,0] neg_lo:[0,1,0] neg_hi:[0,1,0]
    v_pk_fma_f32 v[130:131], v[18:19], v[250:251], v[160:161] op_sel:[0,1,0] op_sel_hi:[1,1,0] neg_lo:[0,0,1] neg_hi:[0,0,1]
    v_pk_fma_f32 v[18:19], v[18:19], v[250:251], v[162:163] op_sel:[0,1,0] op_sel_hi:[1,1,0] neg_lo:[0,1,0] neg_hi:[0,1,0]
    v_pk_fma_f32 v[132:133], v[20:21], v[250:251], v[160:161] op_sel:[0,1,0] op_sel_hi:[1,1,0] neg_lo:[0,0,1] neg_hi:[0,0,1]
    v_pk_fma_f32 v[20:21], v[20:21], v[250:251], v[162:163] op_sel:[0,1,0] op_sel_hi:[1,1,0] neg_lo:[0,1,0] neg_hi:[0,1,0]
    v_pk_fma_f32 v[134:135], v[22:23], v[250:251], v[160:161] op_sel:[0,1,0] op_sel_hi:[1,1,0] neg_lo:[0,0,1] neg_hi:[0,0,1]
    v_pk_fma_f32 v[22:23], v[22:23], v[250:251], v[162:163] op_sel:[0,1,0] op_sel_hi:[1,1,0] neg_lo:[0,1,0] neg_hi:[0,1,0]
    v_pk_fma_f32 v[136:137], v[24:25], v[250:251], v[160:161] op_sel:[0,1,0] op_sel_hi:[1,1,0] neg_lo:[0,0,1] neg_hi:[0,0,1]
    v_pk_fma_f32 v[24:25], v[24:25], v[250:251], v[162:163] op_sel:[0,1,0] op_sel_hi:[1,1,0] neg_lo:[0,1,0] neg_hi:[0,1,0]
    v_pk_fma_f32 v[138:139], v[26:27], v[250:251], v[160:161] op_sel:[0,1,0] op_sel_hi:[1,1,0] neg_lo:[0,0,1] neg_hi:[0,0,1]
    v_pk_fma_f32 v[26:27], v[26:27], v[250:251], v[162:163] op_sel:[0,1,0] op_sel_hi:[1,1,0] neg_lo:[0,1,0] neg_hi:[0,1,0]
    v_pk_fma_f32 v[140:141], v[28:29], v[250:251], v[160:161] op_sel:[0,1,0] op_sel_hi:[1,1,0] neg_lo:[0,0,1] neg_hi:[0,0,1]
    v_pk_fma_f32 v[28:29], v[28:29], v[250:251], v[162:163] op_sel:[0,1,0] op_sel_hi:[1,1,0] neg_lo:[0,1,0] neg_hi:[0,1,0]
    v_pk_fma_f32 v[142:143], v[30:31], v[250:251], v[160:161] op_sel:[0,1,0] op_sel_hi:[1,1,0] neg_lo:[0,0,1] neg_hi:[0,0,1]
    v_pk_fma_f32 v[30:31], v[30:31], v[250:251], v[162:163] op_sel:[0,1,0] op_sel_hi:[1,1,0] neg_lo:[0,1,0] neg_hi:[0,1,0]
    v_pk_fma_f32 v[144:145], v[32:33], v[252:253], v[164:165] op_sel:[0,1,0] op_sel_hi:[1,1,0] neg_lo:[0,0,1] neg_hi:[0,0,1]
    v_pk_fma_f32 v[32:33], v[32:33], v[252:253], v[166:167] op_sel:[0,1,0] op_sel_hi:[1,1,0] neg_lo:[0,1,0] neg_hi:[0,1,0]
    v_pk_fma_f32 v[146:147], v[34:35], v[252:253], v[164:165] op_sel:[0,1,0] op_sel_hi:[1,1,0] neg_lo:[0,0,1] neg_hi:[0,0,1]
    v_pk_fma_f32 v[34:35], v[34:35], v[252:253], v[166:167] op_sel:[0,1,0] op_sel_hi:[1,1,0] neg_lo:[0,1,0] neg_hi:[0,1,0]
    v_pk_fma_f32 v[148:149], v[36:37], v[252:253], v[164:165] op_sel:[0,1,0] op_sel_hi:[1,1,0] neg_lo:[0,0,1] neg_hi:[0,0,1]
    v_pk_fma_f32 v[36:37], v[36:37], v[252:253], v[166:167] op_sel:[0,1,0] op_sel_hi:[1,1,0] neg_lo:[0,1,0] neg_hi:[0,1,0]
    v_pk_fma_f32 v[150:151], v[38:39], v[252:253], v[164:165] op_sel:[0,1,0] op_sel_hi:[1,1,0] neg_lo:[0,0,1] neg_hi:[0,0,1]
    v_pk_fma_f32 v[38:39], v[38:39], v[252:253], v[166:167] op_sel:[0,1,0] op_sel_hi:[1,1,0] neg_lo:[0,1,0] neg_hi:[0,1,0]
    v_pk_fma_f32 v[152:153], v[40:41], v[252:253], v[164:165] op_sel:[0,1,0] op_sel_hi:[1,1,0] neg_lo:[0,0,1] neg_hi:[0,0,1]
    v_pk_fma_f32 v[40:41], v[40:41], v[252:253], v[166:167] op_sel:[0,1,0] op_sel_hi:[1,1,0] neg_lo:[0,1,0] neg_hi:[0,1,0]
    v_pk_fma_f32 v[154:155], v[42:43], v[252:253], v[164:165] op_sel:[0,1,0] op_sel_hi:[1,1,0] neg_lo:[0,0,1] neg_hi:[0,0,1]
    v_pk_fma_f32 v[42:43], v[42:43], v[252:253], v[166:167] op_sel:[0,1,0] op_sel_hi:[1,1,0] neg_lo:[0,1,0] neg_hi:[0,1,0]
    v_pk_fma_f32 v[156:157], v[44:45], v[252:253], v[164:165] op_sel:[0,1,0] op_sel_hi:[1,1,0] neg_lo:[0,0,1] neg_hi:[0,0,1]
    v_pk_fma_f32 v[44:45], v[44:45], v[252:253], v[166:167] op_sel:[0,1,0] op_sel_hi:[1,1,0] neg_lo:[0,1,0] neg_hi:[0,1,0]
    v_pk_fma_f32 v[158:159], v[46:47], v[252:253], v[164:165] op_sel:[0,1,0] op_sel_hi:[1,1,0] neg_lo:[0,0,1] neg_hi:[0,0,1]
    v_pk_fma_f32 v[46:47], v[46:47], v[252:253], v[166:167] op_sel:[0,1,0] op_sel_hi:[1,1,0] neg_lo:[0,1,0] neg_hi:[0,1,0]
    v_exp_f32 v128, v128
    v_exp_f32 v16, v16
    v_exp_f32 v129, v129
    v_exp_f32 v17, v17
    v_exp_f32 v130, v130
    v_exp_f32 v18, v18
    v_exp_f32 v131, v131
    v_exp_f32 v19, v19
    v_exp_f32 v132, v132
    v_exp_f32 v20, v20
    v_exp_f32 v133, v133
    v_exp_f32 v21, v21
    v_exp_f32 v134, v134
    v_exp_f32 v22, v22
    v_exp_f32 v135, v135
    v_exp_f32 v23, v23
    v_exp_f32 v136, v136
    v_exp_f32 v24, v24
    v_exp_f32 v137, v137
    v_exp_f32 v25, v25
    v_exp_f32 v138, v138
    v_exp_f32 v26, v26
    v_exp_f32 v139, v139
    v_exp_f32 v27, v27
    v_exp_f32 v140, v140
    v_exp_f32 v28, v28
    v_exp_f32 v141, v141
    v_exp_f32 v29, v29
    v_exp_f32 v142, v142
    v_exp_f32 v30, v30
    v_exp_f32 v143, v143
    v_exp_f32 v31, v31
    v_cvt_pk_bf16_f32 v218, v128, v129
    v_cvt_pk_bf16_f32 v219, v130, v131
    v_cvt_pk_bf16_f32 v220, v132, v133
    v_cvt_pk_bf16_f32 v221, v134, v135
    v_cvt_pk_bf16_f32 v222, v136, v137
    v_cvt_pk_bf16_f32 v223, v138, v139
    v_cvt_pk_bf16_f32 v224, v140, v141
    v_cvt_pk_bf16_f32 v225, v142, v143
    v_cvt_pk_bf16_f32 v226, v16, v17
    v_cvt_pk_bf16_f32 v227, v18, v19
    v_cvt_pk_bf16_f32 v228, v20, v21
    v_cvt_pk_bf16_f32 v229, v22, v23
    v_cvt_pk_bf16_f32 v230, v24, v25
    v_cvt_pk_bf16_f32 v231, v26, v27
    v_cvt_pk_bf16_f32 v232, v28, v29
    v_cvt_pk_bf16_f32 v233, v30, v31
    v_exp_f32 v144, v144
    v_exp_f32 v32, v32
    v_exp_f32 v145, v145
    v_exp_f32 v33, v33
    v_exp_f32 v146, v146
    v_exp_f32 v34, v34
    v_exp_f32 v147, v147
    v_exp_f32_e64 v35, v35
    s_barrier
    buffer_load_dwordx4 v[48:51], v13, s[40:43], s78 offen offset:3072 sc1
    buffer_load_dwordx4 v[52:55], v13, s[40:43], s79 offen offset:3072 sc1
    buffer_load_dwordx4 v[56:59], v13, s[40:43], s78 offen offset:3200 sc1
    buffer_load_dwordx4 v[60:63], v13, s[40:43], s79 offen offset:3200 sc1
    ds_read_b128 v[168:171], v216 offset:24576
    ds_read_b128 v[172:175], v216 offset:24608
    ds_read_b128 v[176:179], v216 offset:24640
    ds_read_b128 v[180:183], v216 offset:24672
    v_exp_f32 v148, v148
    v_exp_f32 v36, v36
    v_exp_f32 v149, v149
    v_exp_f32 v37, v37
    v_exp_f32 v150, v150
    v_exp_f32 v38, v38
    v_exp_f32 v151, v151
    v_exp_f32 v39, v39
    v_exp_f32 v152, v152
    v_exp_f32_e64 v40, v40
    s_waitcnt lgkmcnt(0)
    v_mfma_f32_32x32x16_bf16 v[64:79], v[168:171], v[218:221], 0
    v_exp_f32 v153, v153
    v_exp_f32 v41, v41
    v_exp_f32_e64 v154, v154
    v_mfma_f32_32x32x16_bf16 v[80:95], v[176:179], v[226:229], 0
    v_exp_f32 v42, v42
    v_exp_f32 v155, v155
    v_exp_f32_e64 v43, v43
    v_mfma_f32_32x32x16_bf16 v[64:79], v[172:175], v[222:225], v[64:79]
    v_exp_f32 v156, v156
    v_exp_f32 v44, v44
    v_exp_f32_e64 v157, v157
    v_mfma_f32_32x32x16_bf16 v[80:95], v[180:183], v[230:233], v[80:95]
    v_exp_f32 v45, v45
    v_exp_f32 v158, v158
    v_exp_f32 v46, v46
    v_exp_f32 v159, v159
    v_exp_f32_e64 v47, v47
    v_cvt_pk_bf16_f32 v234, v144, v145
    v_cvt_pk_bf16_f32 v235, v146, v147
    v_cvt_pk_bf16_f32 v236, v148, v149
    v_cvt_pk_bf16_f32 v237, v150, v151
    v_cvt_pk_bf16_f32 v238, v152, v153
    v_cvt_pk_bf16_f32 v239, v154, v155
    v_cvt_pk_bf16_f32 v240, v156, v157
    v_cvt_pk_bf16_f32 v241, v158, v159
    v_cvt_pk_bf16_f32 v242, v32, v33
    v_cvt_pk_bf16_f32 v243, v34, v35
    v_cvt_pk_bf16_f32 v244, v36, v37
    v_cvt_pk_bf16_f32 v245, v38, v39
    v_cvt_pk_bf16_f32 v246, v40, v41
    v_cvt_pk_bf16_f32 v247, v42, v43
    v_cvt_pk_bf16_f32 v248, v44, v45
    v_cvt_pk_bf16_f32 v249, v46, v47
    v_mfma_f32_32x32x16_bf16 v[96:111], v[168:171], v[234:237], 0
    v_rcp_f32 v184, v65
    v_rcp_f32 v185, v81
    v_mul_f32 v6, v64, v184
    v_fmac_f32 v6, v80, v185
    v_add_f32 v6, 0x358637bd, v6
    v_mfma_f32_32x32x16_bf16 v[112:127], v[176:179], v[242:245], 0
    v_rcp_f32 v6, v6
    v_mov_b32 v8, 0
    v_mul_f32 v184, v184, v6
    v_mul_f32_e64 v185, v185, v6
    s_lshl4_add_u32 s76, s60, s61
    v_mfma_f32_32x32x16_bf16 v[96:111], v[172:175], v[238:241], v[96:111]
    s_mul_i32 s76, s76, 32768
    s_lshl2_add_u32 s77, s63, s64
    s_lshl_b32 s77, s77, 12
    s_add_u32 s76, s76, s77
    s_add_u32 s76, s76, 16777216
    v_mfma_f32_32x32x16_bf16 v[112:127], v[180:183], v[246:249], v[112:127]
    s_add_u32 s77, s76, 8192
    v_add_u32 v14, 128, v12
    v_cmp_gt_u32 vcc, 24, v1
    s_nop 0
    s_nop 0
    v_cndmask_b32_e64 v14, v14, v12, vcc
    s_mov_b32 s88, 0
    s_branch L_pfirst_53
L_poll_52:
    buffer_load_dwordx4 v[48:51], v13, s[40:43], s78 offen offset:3072 sc1
    buffer_load_dwordx4 v[52:55], v13, s[40:43], s79 offen offset:3072 sc1
    buffer_load_dwordx4 v[56:59], v13, s[40:43], s78 offen offset:3200 sc1
    buffer_load_dwordx4 v[60:63], v13, s[40:43], s79 offen offset:3200 sc1
L_pfirst_53:
    s_waitcnt vmcnt(0)
    v_max3_u32 v9, v48, v49, v50
    v_max3_u32 v9, v9, v51, v52
    v_max3_u32 v9, v9, v53, v54
    v_max3_u32 v9, v9, v55, v56
    v_max3_u32 v9, v9, v57, v58
    v_max3_u32 v9, v9, v59, v60
    v_max3_u32 v9, v9, v61, v62
    v_max_u32 v9, v9, v63
    v_cmp_eq_u32 vcc, -1, v9
    s_nop 0
    s_cbranch_vccz L_ok_54
    s_add_u32 s88, s88, 1
    s_cmp_lt_u32 s88, 65536
    s_cbranch_scc1 L_poll_52
L_ok_54:
    v_mfma_f32_32x32x16_bf16 v[16:31], v[48:51], v[218:221], 0
    s_barrier
    v_rcp_f32 v186, v97
    v_rcp_f32 v187, v113
    v_mul_f32 v7, v96, v186
    v_fmac_f32 v7, v112, v187
    v_mfma_f32_32x32x16_bf16 v[128:143], v[56:59], v[226:229], 0
    v_add_f32 v7, 0x358637bd, v7
    v_rcp_f32 v7, v7
    v_mov_b32 v8, 0
    v_mul_f32_e64 v186, v186, v7
    v_mfma_f32_32x32x16_bf16 v[16:31], v[52:55], v[222:225], v[16:31]
    v_mul_f32_e64 v187, v187, v7
    global_load_dwordx2 v[192:193], v10, s[14:15] offset:0
    global_load_dwordx2 v[194:195], v10, s[14:15] offset:16
    global_load_dwordx2 v[196:197], v10, s[14:15] offset:32
    v_mfma_f32_32x32x16_bf16 v[128:143], v[60:63], v[230:233], v[128:143]
    global_load_dwordx2 v[198:199], v10, s[14:15] offset:48
    global_load_dwordx2 v[200:201], v10, s[14:15] offset:64
    global_load_dwordx2 v[202:203], v10, s[14:15] offset:80
    global_load_dwordx2 v[204:205], v10, s[14:15] offset:96
    v_mfma_f32_32x32x16_bf16 v[32:47], v[48:51], v[234:237], 0
    global_load_dwordx2 v[206:207], v10, s[14:15] offset:112
    global_load_dwordx4 v[208:211], v11, s[14:15] offset:0
    global_load_dwordx4 v[212:215], v11, s[14:15] offset:16
    v_mfma_f32_32x32x16_bf16 v[144:159], v[56:59], v[242:245], 0
    v_mul_f32 v16, v16, v184
    v_mul_f32 v17, v17, v184
    v_mul_f32 v18, v18, v184
    v_mul_f32 v19, v19, v184
    v_mul_f32 v20, v20, v184
    v_mul_f32 v21, v21, v184
    v_mfma_f32_32x32x16_bf16 v[32:47], v[52:55], v[238:241], v[32:47]
    v_mul_f32 v22, v22, v184
    v_mul_f32 v23, v23, v184
    v_mul_f32 v24, v24, v184
    v_mul_f32 v25, v25, v184
    v_mul_f32 v26, v26, v184
    v_mul_f32 v27, v27, v184
    v_mfma_f32_32x32x16_bf16 v[144:159], v[60:63], v[246:249], v[144:159]
    v_mul_f32 v28, v28, v184
    v_mul_f32 v29, v29, v184
    v_mul_f32 v30, v30, v184
    v_mul_f32 v31, v31, v184
    v_fmac_f32 v16, v128, v185
    v_fmac_f32 v17, v129, v185
    v_cvt_pk_bf16_f32 v64, v16, v17
    v_fmac_f32 v18, v130, v185
    v_fmac_f32 v19, v131, v185
    v_cvt_pk_bf16_f32 v65, v18, v19
    v_fmac_f32 v20, v132, v185
    v_fmac_f32 v21, v133, v185
    v_cvt_pk_bf16_f32 v66, v20, v21
    v_fmac_f32 v22, v134, v185
    v_fmac_f32 v23, v135, v185
    v_cvt_pk_bf16_f32 v67, v22, v23
    buffer_store_dwordx4 v[64:67], v14, s[40:43], s76 offen offset:0 sc1
    v_fmac_f32 v24, v136, v185
    v_fmac_f32 v25, v137, v185
    v_cvt_pk_bf16_f32 v68, v24, v25
    v_fmac_f32 v26, v138, v185
    v_fmac_f32 v27, v139, v185
    v_cvt_pk_bf16_f32 v69, v26, v27
    v_fmac_f32 v28, v140, v185
    v_fmac_f32 v29, v141, v185
    v_cvt_pk_bf16_f32 v70, v28, v29
    v_fmac_f32 v30, v142, v185
    v_fmac_f32 v31, v143, v185
    v_cvt_pk_bf16_f32 v71, v30, v31
    buffer_store_dwordx4 v[68:71], v14, s[40:43], s76 offen offset:2048 sc1
    v_pk_mul_f32 v[32:33], v[32:33], v[186:187] op_sel_hi:[1,0]
    v_pk_fma_f32 v[32:33], v[144:145], v[186:187], v[32:33] op_sel:[0,1,0] op_sel_hi:[1,1,1]
    v_cvt_pk_bf16_f32 v72, v32, v33
    v_pk_mul_f32 v[34:35], v[34:35], v[186:187] op_sel_hi:[1,0]
    v_pk_fma_f32 v[34:35], v[146:147], v[186:187], v[34:35] op_sel:[0,1,0] op_sel_hi:[1,1,1]
    v_cvt_pk_bf16_f32 v73, v34, v35
    v_pk_mul_f32 v[36:37], v[36:37], v[186:187] op_sel_hi:[1,0]
    v_pk_fma_f32 v[36:37], v[148:149], v[186:187], v[36:37] op_sel:[0,1,0] op_sel_hi:[1,1,1]
    v_cvt_pk_bf16_f32 v74, v36, v37
    v_pk_mul_f32 v[38:39], v[38:39], v[186:187] op_sel_hi:[1,0]
    v_pk_fma_f32 v[38:39], v[150:151], v[186:187], v[38:39] op_sel:[0,1,0] op_sel_hi:[1,1,1]
    v_cvt_pk_bf16_f32 v75, v38, v39
    buffer_store_dwordx4 v[72:75], v14, s[40:43], s77 offen offset:0 sc1
    v_pk_mul_f32 v[40:41], v[40:41], v[186:187] op_sel_hi:[1,0]
    v_pk_fma_f32 v[40:41], v[152:153], v[186:187], v[40:41] op_sel:[0,1,0] op_sel_hi:[1,1,1]
    v_cvt_pk_bf16_f32 v76, v40, v41
    v_pk_mul_f32 v[42:43], v[42:43], v[186:187] op_sel_hi:[1,0]
    v_pk_fma_f32 v[42:43], v[154:155], v[186:187], v[42:43] op_sel:[0,1,0] op_sel_hi:[1,1,1]
    v_cvt_pk_bf16_f32 v77, v42, v43
    v_pk_mul_f32 v[44:45], v[44:45], v[186:187] op_sel_hi:[1,0]
    v_pk_fma_f32 v[44:45], v[156:157], v[186:187], v[44:45] op_sel:[0,1,0] op_sel_hi:[1,1,1]
    v_cvt_pk_bf16_f32 v78, v44, v45
    v_pk_mul_f32 v[46:47], v[46:47], v[186:187] op_sel_hi:[1,0]
    v_pk_fma_f32 v[46:47], v[158:159], v[186:187], v[46:47] op_sel:[0,1,0] op_sel_hi:[1,1,1]
    v_cvt_pk_bf16_f32 v79, v46, v47
    buffer_store_dwordx4 v[76:79], v14, s[40:43], s77 offen offset:2048 sc1
    v_bfe_u32 v4, v2, 1, 3
    v_lshlrev_b32_e64 v4, 4, v4
    v_lshl_add_u32 v4, v3, 3, v4
    v_lshl_add_u32 v4, v2, 7, v4
    s_lshl_b32 s76, s62, 12
    s_add_u32 s77, s76, 0
    v_add_u32 v64, s77, v4
    v_xor_b32 v65, 16, v64
    v_xor_b32 v66, 32, v64
    v_xor_b32 v67, 48, v64
    v_xor_b32_e64 v68, 64, v64
    v_xor_b32 v69, 80, v64
    v_xor_b32 v70, 96, v64
    v_xor_b32 v71, 112, v64
    v_bfe_u32 v4, v1, 2, 2
    v_lshl_add_u32 v5, v3, 2, v4
    v_lshlrev_b32 v5, 7, v5
    v_lshrrev_b32 v4, 1, v4
    v_lshl_add_u32 v5, v4, 6, v5
    v_bfe_u32 v4, v1, 4, 1
    v_lshl_add_u32 v5, v4, 5, v5
    v_and_b32_e64 v4, 3, v1
    v_lshl_add_u32 v5, v4, 3, v5
    v_add_u32 v72, 32768, v5
    v_xor_b32_e64 v73, 64, v72
    s_mul_i32 s80, s97, 524288
    s_mul_i32 s76, s62, 8192
    s_add_u32 s80, s80, s76
    s_add_u32 s80, s80, 16777216
    v_add_u32 v78, 4096, v14
    v_mov_b32 v74, 1
    s_mov_b32 s52, 0xffff
    s_mov_b32 s53, 0
    s_barrier
    ds_read_b32 v79, v8 offset:25984
    ds_read_b64 v[88:89], v64
    ds_read_b64 v[90:91], v65
    ds_read_b64 v[92:93], v66
    ds_read_b64 v[94:95], v67
    ds_read_b64 v[96:97], v68
    ds_read_b64 v[98:99], v69
    ds_read_b64 v[100:101], v70
    ds_read_b64 v[102:103], v71
    s_waitcnt lgkmcnt(8)
    v_readfirstlane_b32 s76, v79
    s_nop 0
    s_and_b32 s76, s76, s52
    s_cbranch_scc0 L_tr0
L_bk0:
    s_ff1_i32_b32 s76, s76
    s_bitset0_b32 s52, s76
    s_add_u32 s77, s76, s65
    s_and_b32 s77, s77, 15
    s_mul_i32 s77, s77, 32768
    s_add_u32 s28, s77, s80
    s_add_u32 s76, s76, 3
    s_and_b32 s76, s76, 15
    s_lshl_b32 s4, s76, 13
    buffer_load_dwordx4 v[128:131], v14, s[40:43], s28 offen offset:0 sc1
    buffer_load_dwordx4 v[132:135], v14, s[40:43], s28 offen offset:2048 sc1
    buffer_load_dwordx4 v[136:139], v78, s[40:43], s28 offen offset:0 sc1
    buffer_load_dwordx4 v[140:143], v78, s[40:43], s28 offen offset:2048 sc1
    v_readfirstlane_b32 s76, v79
    s_nop 0
    s_and_b32 s76, s76, s52
    s_cbranch_scc0 L_tr1
L_bk1:
    s_ff1_i32_b32 s76, s76
    s_bitset0_b32 s52, s76
    s_add_u32 s77, s76, s65
    s_and_b32 s77, s77, 15
    s_mul_i32 s77, s77, 32768
    s_add_u32 s29, s77, s80
    s_add_u32 s76, s76, 3
    s_and_b32 s76, s76, 15
    s_lshl_b32 s5, s76, 13
    buffer_load_dwordx4 v[144:147], v14, s[40:43], s29 offen offset:0 sc1
    buffer_load_dwordx4 v[148:151], v14, s[40:43], s29 offen offset:2048 sc1
    v_add_u32 v80, s4, v72
    v_add_u32 v81, s4, v73
    s_waitcnt lgkmcnt(0)
    v_lshlrev_b32 v16, 16, v88
    v_and_b32 v17, s90, v88
    v_lshlrev_b32 v18, 16, v89
    v_and_b32 v19, s90, v89
    v_lshlrev_b32 v20, 16, v90
    v_and_b32 v21, s90, v90
    v_lshlrev_b32 v22, 16, v91
    v_and_b32 v23, s90, v91
    v_lshlrev_b32 v24, 16, v92
    v_and_b32 v25, s90, v92
    v_lshlrev_b32 v26, 16, v93
    v_and_b32 v27, s90, v93
    v_lshlrev_b32 v28, 16, v94
    v_and_b32 v29, s90, v94
    v_lshlrev_b32 v30, 16, v95
    v_and_b32 v31, s90, v95
    v_lshlrev_b32 v32, 16, v96
    v_and_b32 v33, s90, v96
    v_lshlrev_b32 v34, 16, v97
    v_and_b32 v35, s90, v97
    v_lshlrev_b32 v36, 16, v98
    v_and_b32 v37, s90, v98
    v_lshlrev_b32 v38, 16, v99
    v_and_b32 v39, s90, v99
    v_lshlrev_b32 v40, 16, v100
    v_and_b32 v41, s90, v100
    v_lshlrev_b32 v42, 16, v101
    v_and_b32 v43, s90, v101
    v_lshlrev_b32 v44, 16, v102
    v_and_b32 v45, s90, v102
    v_lshlrev_b32 v46, 16, v103
    v_and_b32 v47, s90, v103
    s_cmp_eq_u32 s53, 0
    s_cbranch_scc0 L_sent_55
    s_waitcnt vmcnt(6)
    s_mov_b64 exec, 1
    ds_add_u32 v8, v74 offset:25988
    s_mov_b64 exec, -1
    s_mov_b32 s53, 1
L_sent_55:
    ds_read_b32 v79, v8 offset:25984
    ds_read_b64_tr_b16 v[104:105], v80 offset:0
    ds_read_b64_tr_b16 v[106:107], v80 offset:1024
    ds_read_b64_tr_b16 v[108:109], v81 offset:0
    ds_read_b64_tr_b16 v[110:111], v81 offset:1024
    ds_read_b64_tr_b16 v[112:113], v80 offset:2048
    ds_read_b64_tr_b16 v[114:115], v80 offset:3072
    ds_read_b64_tr_b16 v[116:117], v81 offset:2048
    ds_read_b64_tr_b16 v[118:119], v81 offset:3072
    s_waitcnt vmcnt(5) lgkmcnt(4)
    v_mfma_f32_32x32x16_bf16 v[16:31], v[104:107], v[128:131], v[16:31]
    ds_read_b64_tr_b16 v[120:121], v80 offset:4096
    ds_read_b64_tr_b16 v[122:123], v80 offset:5120
    buffer_load_dwordx4 v[152:155], v78, s[40:43], s29 offen offset:0 sc1
    v_mfma_f32_32x32x16_bf16 v[32:47], v[108:111], v[128:131], v[32:47]
    ds_read_b64_tr_b16 v[124:125], v81 offset:4096
    ds_read_b64_tr_b16 v[126:127], v81 offset:5120
    buffer_load_dwordx4 v[156:159], v78, s[40:43], s29 offen offset:2048 sc1
    v_readfirstlane_b32 s76, v79
    s_nop 0
    s_and_b32 s76, s76, s52
    s_cbranch_scc0 L_tr2
L_bk2:
    s_ff1_i32_b32 s76, s76
    s_bitset0_b32 s52, s76
    s_add_u32 s77, s76, s65
    s_and_b32 s77, s77, 15
    s_mul_i32 s77, s77, 32768
    s_add_u32 s30, s77, s80
    s_waitcnt vmcnt(6) lgkmcnt(4)
    v_mfma_f32_32x32x16_bf16 v[16:31], v[112:115], v[132:135], v[16:31]
    ds_read_b32 v79, v8 offset:25984
    ds_read_b64_tr_b16 v[104:105], v80 offset:6144
    ds_read_b64_tr_b16 v[106:107], v80 offset:7168
    buffer_load_dwordx4 v[160:163], v14, s[40:43], s30 offen offset:0 sc1
    s_add_u32 s76, s76, 3
    s_and_b32 s76, s76, 15
    s_lshl_b32 s6, s76, 13
    v_mfma_f32_32x32x16_bf16 v[32:47], v[116:119], v[132:135], v[32:47]
    ds_read_b64_tr_b16 v[108:109], v81 offset:6144
    ds_read_b64_tr_b16 v[110:111], v81 offset:7168
    buffer_load_dwordx4 v[164:167], v14, s[40:43], s30 offen offset:2048 sc1
    v_add_u32 v82, s5, v72
    v_add_u32_e64 v83, s5, v73
    s_waitcnt vmcnt(7) lgkmcnt(4)
    v_mfma_f32_32x32x16_bf16 v[16:31], v[120:123], v[136:139], v[16:31]
    ds_read_b64_tr_b16 v[112:113], v82 offset:0
    ds_read_b64_tr_b16 v[114:115], v82 offset:1024
    buffer_load_dwordx4 v[168:171], v78, s[40:43], s30 offen offset:0 sc1
    v_mfma_f32_32x32x16_bf16 v[32:47], v[124:127], v[136:139], v[32:47]
    ds_read_b64_tr_b16 v[116:117], v83 offset:0
    ds_read_b64_tr_b16 v[118:119], v83 offset:1024
    buffer_load_dwordx4 v[172:175], v78, s[40:43], s30 offen offset:2048 sc1
    v_readfirstlane_b32 s76, v79
    s_nop 0
    s_and_b32 s76, s76, s52
    s_cbranch_scc0 L_tr3
L_bk3:
    s_ff1_i32_b32 s76, s76
    s_bitset0_b32 s52, s76
    s_add_u32 s77, s76, s65
    s_and_b32 s77, s77, 15
    s_mul_i32 s77, s77, 32768
    s_add_u32 s31, s77, s80
    s_waitcnt vmcnt(8) lgkmcnt(4)
    v_mfma_f32_32x32x16_bf16 v[16:31], v[104:107], v[140:143], v[16:31]
    ds_read_b32 v79, v8 offset:25984
    ds_read_b64_tr_b16 v[120:121], v82 offset:2048
    ds_read_b64_tr_b16 v[122:123], v82 offset:3072
    buffer_load_dwordx4 v[176:179], v14, s[40:43], s31 offen offset:0 sc1
    s_add_u32 s76, s76, 3
    s_and_b32 s76, s76, 15
    s_lshl_b32 s7, s76, 13
    v_mfma_f32_32x32x16_bf16 v[32:47], v[108:111], v[140:143], v[32:47]
    ds_read_b64_tr_b16 v[124:125], v83 offset:2048
    ds_read_b64_tr_b16 v[126:127], v83 offset:3072
    buffer_load_dwordx4 v[180:183], v14, s[40:43], s31 offen offset:2048 sc1
    s_waitcnt vmcnt(9) lgkmcnt(4)
    v_mfma_f32_32x32x16_bf16 v[16:31], v[112:115], v[144:147], v[16:31]
    ds_read_b64_tr_b16 v[104:105], v82 offset:4096
    ds_read_b64_tr_b16 v[106:107], v82 offset:5120
    buffer_load_dwordx4 v[184:187], v78, s[40:43], s31 offen offset:0 sc1
    v_mfma_f32_32x32x16_bf16 v[32:47], v[116:119], v[144:147], v[32:47]
    ds_read_b64_tr_b16 v[108:109], v83 offset:4096
    ds_read_b64_tr_b16 v[110:111], v83 offset:5120
    buffer_load_dwordx4 v[188:191], v78, s[40:43], s31 offen offset:2048 sc1
    v_readfirstlane_b32 s76, v79
    s_nop 0
    s_and_b32 s76, s76, s52
    s_cbranch_scc0 L_tr4
L_bk4:
    s_ff1_i32_b32 s76, s76
    s_bitset0_b32 s52, s76
    s_add_u32 s77, s76, s65
    s_and_b32 s77, s77, 15
    s_mul_i32 s77, s77, 32768
    s_add_u32 s32, s77, s80
    s_waitcnt vmcnt(10) lgkmcnt(4)
    v_mfma_f32_32x32x16_bf16 v[16:31], v[120:123], v[148:151], v[16:31]
    ds_read_b64_tr_b16 v[112:113], v82 offset:6144
    ds_read_b64_tr_b16 v[114:115], v82 offset:7168
    buffer_load_dwordx4 v[128:131], v14, s[40:43], s32 offen offset:0 sc1
    s_add_u32 s76, s76, 3
    s_and_b32 s76, s76, 15
    s_lshl_b32 s8, s76, 13
    v_mfma_f32_32x32x16_bf16 v[32:47], v[124:127], v[148:151], v[32:47]
    ds_read_b64_tr_b16 v[116:117], v83 offset:6144
    ds_read_b64_tr_b16 v[118:119], v83 offset:7168
    buffer_load_dwordx4 v[132:135], v14, s[40:43], s32 offen offset:2048 sc1
    v_add_u32 v80, s6, v72
    v_add_u32 v81, s6, v73
    s_waitcnt vmcnt(11) lgkmcnt(4)
    v_mfma_f32_32x32x16_bf16 v[16:31], v[104:107], v[152:155], v[16:31]
    ds_read_b32 v79, v8 offset:25984
    ds_read_b64_tr_b16 v[120:121], v80 offset:0
    ds_read_b64_tr_b16 v[122:123], v80 offset:1024
    buffer_load_dwordx4 v[136:139], v78, s[40:43], s32 offen offset:0 sc1
    v_mfma_f32_32x32x16_bf16 v[32:47], v[108:111], v[152:155], v[32:47]
    ds_read_b64_tr_b16 v[124:125], v81 offset:0
    ds_read_b64_tr_b16 v[126:127], v81 offset:1024
    s_waitcnt vmcnt(11) lgkmcnt(4)
    v_mfma_f32_32x32x16_bf16 v[16:31], v[112:115], v[156:159], v[16:31]
    ds_read_b64_tr_b16 v[104:105], v80 offset:2048
    ds_read_b64_tr_b16 v[106:107], v80 offset:3072
    buffer_load_dwordx4 v[140:143], v78, s[40:43], s32 offen offset:2048 sc1
    v_mfma_f32_32x32x16_bf16 v[32:47], v[116:119], v[156:159], v[32:47]
    ds_read_b64_tr_b16 v[108:109], v81 offset:2048
    ds_read_b64_tr_b16 v[110:111], v81 offset:3072
    v_readfirstlane_b32 s76, v79
    s_nop 0
    s_and_b32 s76, s76, s52
    s_cbranch_scc0 L_tr5
L_bk5:
    s_ff1_i32_b32 s76, s76
    s_bitset0_b32 s52, s76
    s_add_u32 s77, s76, s65
    s_and_b32 s77, s77, 15
    s_mul_i32 s77, s77, 32768
    s_add_u32 s33, s77, s80
    s_waitcnt vmcnt(11) lgkmcnt(4)
    v_mfma_f32_32x32x16_bf16 v[16:31], v[120:123], v[160:163], v[16:31]
    ds_read_b64_tr_b16 v[112:113], v80 offset:4096
    ds_read_b64_tr_b16 v[114:115], v80 offset:5120
    buffer_load_dwordx4 v[144:147], v14, s[40:43], s33 offen offset:0 sc1
    s_add_u32 s76, s76, 3
    s_and_b32 s76, s76, 15
    s_lshl_b32 s9, s76, 13
    v_mfma_f32_32x32x16_bf16 v[32:47], v[124:127], v[160:163], v[32:47]
    ds_read_b64_tr_b16 v[116:117], v81 offset:4096
    ds_read_b64_tr_b16 v[118:119], v81 offset:5120
    s_waitcnt vmcnt(11) lgkmcnt(4)
    v_mfma_f32_32x32x16_bf16 v[16:31], v[104:107], v[164:167], v[16:31]
    ds_read_b64_tr_b16 v[120:121], v80 offset:6144
    ds_read_b64_tr_b16 v[122:123], v80 offset:7168
    buffer_load_dwordx4 v[148:151], v14, s[40:43], s33 offen offset:2048 sc1
    v_mfma_f32_32x32x16_bf16 v[32:47], v[108:111], v[164:167], v[32:47]
    ds_read_b64_tr_b16 v[124:125], v81 offset:6144
    ds_read_b64_tr_b16 v[126:127], v81 offset:7168
    v_add_u32 v82, s7, v72
    v_add_u32 v83, s7, v73
    s_waitcnt vmcnt(11) lgkmcnt(4)
    v_mfma_f32_32x32x16_bf16 v[16:31], v[112:115], v[168:171], v[16:31]
    ds_read_b32 v79, v8 offset:25984
    ds_read_b64_tr_b16 v[104:105], v82 offset:0
    ds_read_b64_tr_b16 v[106:107], v82 offset:1024
    buffer_load_dwordx4 v[152:155], v78, s[40:43], s33 offen offset:0 sc1
    v_mfma_f32_32x32x16_bf16 v[32:47], v[116:119], v[168:171], v[32:47]
    ds_read_b64_tr_b16 v[108:109], v83 offset:0
    ds_read_b64_tr_b16 v[110:111], v83 offset:1024
    s_waitcnt vmcnt(11) lgkmcnt(4)
    v_mfma_f32_32x32x16_bf16 v[16:31], v[120:123], v[172:175], v[16:31]
    ds_read_b64_tr_b16 v[112:113], v82 offset:2048
    ds_read_b64_tr_b16 v[114:115], v82 offset:3072
    buffer_load_dwordx4 v[156:159], v78, s[40:43], s33 offen offset:2048 sc1
    v_mfma_f32_32x32x16_bf16 v[32:47], v[124:127], v[172:175], v[32:47]
    ds_read_b64_tr_b16 v[116:117], v83 offset:2048
    ds_read_b64_tr_b16 v[118:119], v83 offset:3072
    v_readfirstlane_b32 s76, v79
    s_nop 0
    s_and_b32 s76, s76, s52
    s_cbranch_scc0 L_tr6
L_bk6:
    s_ff1_i32_b32 s76, s76
    s_bitset0_b32 s52, s76
    s_add_u32 s77, s76, s65
    s_and_b32 s77, s77, 15
    s_mul_i32 s77, s77, 32768
    s_add_u32 s34, s77, s80
    s_waitcnt vmcnt(11) lgkmcnt(4)
    v_mfma_f32_32x32x16_bf16 v[16:31], v[104:107], v[176:179], v[16:31]
    ds_read_b64_tr_b16 v[120:121], v82 offset:4096
    ds_read_b64_tr_b16 v[122:123], v82 offset:5120
    buffer_load_dwordx4 v[160:163], v14, s[40:43], s34 offen offset:0 sc1
    s_add_u32 s76, s76, 3
    s_and_b32 s76, s76, 15
    s_lshl_b32 s10, s76, 13
    v_mfma_f32_32x32x16_bf16 v[32:47], v[108:111], v[176:179], v[32:47]
    ds_read_b64_tr_b16 v[124:125], v83 offset:4096
    ds_read_b64_tr_b16 v[126:127], v83 offset:5120
    s_waitcnt vmcnt(11) lgkmcnt(4)
    v_mfma_f32_32x32x16_bf16 v[16:31], v[112:115], v[180:183], v[16:31]
    ds_read_b64_tr_b16 v[104:105], v82 offset:6144
    ds_read_b64_tr_b16 v[106:107], v82 offset:7168
    buffer_load_dwordx4 v[164:167], v14, s[40:43], s34 offen offset:2048 sc1
    v_mfma_f32_32x32x16_bf16 v[32:47], v[116:119], v[180:183], v[32:47]
    ds_read_b64_tr_b16 v[108:109], v83 offset:6144
    ds_read_b64_tr_b16 v[110:111], v83 offset:7168
    v_add_u32 v80, s8, v72
    v_add_u32 v81, s8, v73
    s_waitcnt vmcnt(11) lgkmcnt(4)
    v_mfma_f32_32x32x16_bf16 v[16:31], v[120:123], v[184:187], v[16:31]
    ds_read_b32 v79, v8 offset:25984
    ds_read_b64_tr_b16 v[112:113], v80 offset:0
    ds_read_b64_tr_b16 v[114:115], v80 offset:1024
    buffer_load_dwordx4 v[168:171], v78, s[40:43], s34 offen offset:0 sc1
    v_mfma_f32_32x32x16_bf16 v[32:47], v[124:127], v[184:187], v[32:47]
    ds_read_b64_tr_b16 v[116:117], v81 offset:0
    ds_read_b64_tr_b16 v[118:119], v81 offset:1024
    s_waitcnt vmcnt(11) lgkmcnt(4)
    v_mfma_f32_32x32x16_bf16 v[16:31], v[104:107], v[188:191], v[16:31]
    ds_read_b64_tr_b16 v[120:121], v80 offset:2048
    ds_read_b64_tr_b16 v[122:123], v80 offset:3072
    buffer_load_dwordx4 v[172:175], v78, s[40:43], s34 offen offset:2048 sc1
    v_mfma_f32_32x32x16_bf16 v[32:47], v[108:111], v[188:191], v[32:47]
    ds_read_b64_tr_b16 v[124:125], v81 offset:2048
    ds_read_b64_tr_b16 v[126:127], v81 offset:3072
    v_readfirstlane_b32 s76, v79
    s_nop 0
    s_and_b32 s76, s76, s52
    s_cbranch_scc0 L_tr7
L_bk7:
    s_ff1_i32_b32 s76, s76
    s_bitset0_b32 s52, s76
    s_add_u32 s77, s76, s65
    s_and_b32 s77, s77, 15
    s_mul_i32 s77, s77, 32768
    s_add_u32 s35, s77, s80
    s_waitcnt vmcnt(11) lgkmcnt(4)
    v_mfma_f32_32x32x16_bf16 v[16:31], v[112:115], v[128:131], v[16:31]
    ds_read_b64_tr_b16 v[104:105], v80 offset:4096
    ds_read_b64_tr_b16 v[106:107], v80 offset:5120
    buffer_load_dwordx4 v[176:179], v14, s[40:43], s35 offen offset:0 sc1
    s_add_u32 s76, s76, 3
    s_and_b32 s76, s76, 15
    s_lshl_b32 s11, s76, 13
    v_mfma_f32_32x32x16_bf16 v[32:47], v[116:119], v[128:131], v[32:47]
    ds_read_b64_tr_b16 v[108:109], v81 offset:4096
    ds_read_b64_tr_b16 v[110:111], v81 offset:5120
    s_waitcnt vmcnt(11) lgkmcnt(4)
    v_mfma_f32_32x32x16_bf16 v[16:31], v[120:123], v[132:135], v[16:31]
    ds_read_b64_tr_b16 v[112:113], v80 offset:6144
    ds_read_b64_tr_b16 v[114:115], v80 offset:7168
    buffer_load_dwordx4 v[180:183], v14, s[40:43], s35 offen offset:2048 sc1
    v_mfma_f32_32x32x16_bf16 v[32:47], v[124:127], v[132:135], v[32:47]
    ds_read_b64_tr_b16 v[116:117], v81 offset:6144
    ds_read_b64_tr_b16 v[118:119], v81 offset:7168
    v_add_u32 v82, s9, v72
    v_add_u32 v83, s9, v73
    s_waitcnt vmcnt(11) lgkmcnt(4)
    v_mfma_f32_32x32x16_bf16 v[16:31], v[104:107], v[136:139], v[16:31]
    ds_read_b32 v79, v8 offset:25984
    ds_read_b64_tr_b16 v[120:121], v82 offset:0
    ds_read_b64_tr_b16 v[122:123], v82 offset:1024
    buffer_load_dwordx4 v[184:187], v78, s[40:43], s35 offen offset:0 sc1
    v_mfma_f32_32x32x16_bf16 v[32:47], v[108:111], v[136:139], v[32:47]
    ds_read_b64_tr_b16 v[124:125], v83 offset:0
    ds_read_b64_tr_b16 v[126:127], v83 offset:1024
    s_waitcnt vmcnt(11) lgkmcnt(4)
    v_mfma_f32_32x32x16_bf16 v[16:31], v[112:115], v[140:143], v[16:31]
    ds_read_b64_tr_b16 v[104:105], v82 offset:2048
    ds_read_b64_tr_b16 v[106:107], v82 offset:3072
    buffer_load_dwordx4 v[188:191], v78, s[40:43], s35 offen offset:2048 sc1
    v_mfma_f32_32x32x16_bf16 v[32:47], v[116:119], v[140:143], v[32:47]
    ds_read_b64_tr_b16 v[108:109], v83 offset:2048
    ds_read_b64_tr_b16 v[110:111], v83 offset:3072
    v_readfirstlane_b32 s76, v79
    s_nop 0
    s_and_b32 s76, s76, s52
    s_cbranch_scc0 L_tr8
L_bk8:
    s_ff1_i32_b32 s76, s76
    s_bitset0_b32 s52, s76
    s_add_u32 s77, s76, s65
    s_and_b32 s77, s77, 15
    s_mul_i32 s77, s77, 32768
    s_add_u32 s36, s77, s80
    s_waitcnt vmcnt(11) lgkmcnt(4)
    v_mfma_f32_32x32x16_bf16 v[16:31], v[120:123], v[144:147], v[16:31]
    ds_read_b64_tr_b16 v[112:113], v82 offset:4096
    ds_read_b64_tr_b16 v[114:115], v82 offset:5120
    buffer_load_dwordx4 v[128:131], v14, s[40:43], s36 offen offset:0 sc1
    s_add_u32 s76, s76, 3
    s_and_b32 s76, s76, 15
    s_lshl_b32 s12, s76, 13
    v_mfma_f32_32x32x16_bf16 v[32:47], v[124:127], v[144:147], v[32:47]
    ds_read_b64_tr_b16 v[116:117], v83 offset:4096
    ds_read_b64_tr_b16 v[118:119], v83 offset:5120
    s_waitcnt vmcnt(11) lgkmcnt(4)
    v_mfma_f32_32x32x16_bf16 v[16:31], v[104:107], v[148:151], v[16:31]
    ds_read_b64_tr_b16 v[120:121], v82 offset:6144
    ds_read_b64_tr_b16 v[122:123], v82 offset:7168
    buffer_load_dwordx4 v[132:135], v14, s[40:43], s36 offen offset:2048 sc1
    v_mfma_f32_32x32x16_bf16 v[32:47], v[108:111], v[148:151], v[32:47]
    ds_read_b64_tr_b16 v[124:125], v83 offset:6144
    ds_read_b64_tr_b16 v[126:127], v83 offset:7168
    v_add_u32 v80, s10, v72
    v_add_u32 v81, s10, v73
    s_waitcnt vmcnt(11) lgkmcnt(4)
    v_mfma_f32_32x32x16_bf16 v[16:31], v[112:115], v[152:155], v[16:31]
    ds_read_b32 v79, v8 offset:25984
    ds_read_b64_tr_b16 v[104:105], v80 offset:0
    ds_read_b64_tr_b16 v[106:107], v80 offset:1024
    buffer_load_dwordx4 v[136:139], v78, s[40:43], s36 offen offset:0 sc1
    v_mfma_f32_32x32x16_bf16 v[32:47], v[116:119], v[152:155], v[32:47]
    ds_read_b64_tr_b16 v[108:109], v81 offset:0
    ds_read_b64_tr_b16 v[110:111], v81 offset:1024
    s_waitcnt vmcnt(11) lgkmcnt(4)
    v_mfma_f32_32x32x16_bf16 v[16:31], v[120:123], v[156:159], v[16:31]
    ds_read_b64_tr_b16 v[112:113], v80 offset:2048
    ds_read_b64_tr_b16 v[114:115], v80 offset:3072
    buffer_load_dwordx4 v[140:143], v78, s[40:43], s36 offen offset:2048 sc1
    v_mfma_f32_32x32x16_bf16 v[32:47], v[124:127], v[156:159], v[32:47]
    ds_read_b64_tr_b16 v[116:117], v81 offset:2048
    ds_read_b64_tr_b16 v[118:119], v81 offset:3072
    v_readfirstlane_b32 s76, v79
    s_nop 0
    s_and_b32 s76, s76, s52
    s_cbranch_scc0 L_tr9
L_bk9:
    s_ff1_i32_b32 s76, s76
    s_bitset0_b32 s52, s76
    s_add_u32 s77, s76, s65
    s_and_b32 s77, s77, 15
    s_mul_i32 s77, s77, 32768
    s_add_u32 s37, s77, s80
    s_waitcnt vmcnt(11) lgkmcnt(4)
    v_mfma_f32_32x32x16_bf16 v[16:31], v[104:107], v[160:163], v[16:31]
    ds_read_b64_tr_b16 v[120:121], v80 offset:4096
    ds_read_b64_tr_b16 v[122:123], v80 offset:5120
    buffer_load_dwordx4 v[144:147], v14, s[40:43], s37 offen offset:0 sc1
    s_add_u32 s76, s76, 3
    s_and_b32 s76, s76, 15
    s_lshl_b32 s13, s76, 13
    v_mfma_f32_32x32x16_bf16 v[32:47], v[108:111], v[160:163], v[32:47]
    ds_read_b64_tr_b16 v[124:125], v81 offset:4096
    ds_read_b64_tr_b16 v[126:127], v81 offset:5120
    s_waitcnt vmcnt(11) lgkmcnt(4)
    v_mfma_f32_32x32x16_bf16 v[16:31], v[112:115], v[164:167], v[16:31]
    ds_read_b64_tr_b16 v[104:105], v80 offset:6144
    ds_read_b64_tr_b16 v[106:107], v80 offset:7168
    buffer_load_dwordx4 v[148:151], v14, s[40:43], s37 offen offset:2048 sc1
    v_mfma_f32_32x32x16_bf16 v[32:47], v[116:119], v[164:167], v[32:47]
    ds_read_b64_tr_b16 v[108:109], v81 offset:6144
    ds_read_b64_tr_b16 v[110:111], v81 offset:7168
    v_add_u32 v82, s11, v72
    v_add_u32 v83, s11, v73
    s_waitcnt vmcnt(11) lgkmcnt(4)
    v_mfma_f32_32x32x16_bf16 v[16:31], v[120:123], v[168:171], v[16:31]
    ds_read_b32 v79, v8 offset:25984
    ds_read_b64_tr_b16 v[112:113], v82 offset:0
    ds_read_b64_tr_b16 v[114:115], v82 offset:1024
    buffer_load_dwordx4 v[152:155], v78, s[40:43], s37 offen offset:0 sc1
    v_mfma_f32_32x32x16_bf16 v[32:47], v[124:127], v[168:171], v[32:47]
    ds_read_b64_tr_b16 v[116:117], v83 offset:0
    ds_read_b64_tr_b16 v[118:119], v83 offset:1024
    s_waitcnt vmcnt(11) lgkmcnt(4)
    v_mfma_f32_32x32x16_bf16 v[16:31], v[104:107], v[172:175], v[16:31]
    ds_read_b64_tr_b16 v[120:121], v82 offset:2048
    ds_read_b64_tr_b16 v[122:123], v82 offset:3072
    buffer_load_dwordx4 v[156:159], v78, s[40:43], s37 offen offset:2048 sc1
    v_mfma_f32_32x32x16_bf16 v[32:47], v[108:111], v[172:175], v[32:47]
    ds_read_b64_tr_b16 v[124:125], v83 offset:2048
    ds_read_b64_tr_b16 v[126:127], v83 offset:3072
    v_readfirstlane_b32 s76, v79
    s_nop 0
    s_and_b32 s76, s76, s52
    s_cbranch_scc0 L_tr10
L_bk10:
    s_ff1_i32_b32 s76, s76
    s_bitset0_b32 s52, s76
    s_add_u32 s77, s76, s65
    s_and_b32 s77, s77, 15
    s_mul_i32 s77, s77, 32768
    s_add_u32 s38, s77, s80
    s_waitcnt vmcnt(11) lgkmcnt(4)
    v_mfma_f32_32x32x16_bf16 v[16:31], v[112:115], v[176:179], v[16:31]
    ds_read_b64_tr_b16 v[104:105], v82 offset:4096
    ds_read_b64_tr_b16 v[106:107], v82 offset:5120
    buffer_load_dwordx4 v[160:163], v14, s[40:43], s38 offen offset:0 sc1
    s_add_u32 s76, s76, 3
    s_and_b32 s76, s76, 15
    s_lshl_b32 s14, s76, 13
    v_mfma_f32_32x32x16_bf16 v[32:47], v[116:119], v[176:179], v[32:47]
    ds_read_b64_tr_b16 v[108:109], v83 offset:4096
    ds_read_b64_tr_b16 v[110:111], v83 offset:5120
    s_waitcnt vmcnt(11) lgkmcnt(4)
    v_mfma_f32_32x32x16_bf16 v[16:31], v[120:123], v[180:183], v[16:31]
    ds_read_b64_tr_b16 v[112:113], v82 offset:6144
    ds_read_b64_tr_b16 v[114:115], v82 offset:7168
    buffer_load_dwordx4 v[164:167], v14, s[40:43], s38 offen offset:2048 sc1
    v_mfma_f32_32x32x16_bf16 v[32:47], v[124:127], v[180:183], v[32:47]
    ds_read_b64_tr_b16 v[116:117], v83 offset:6144
    ds_read_b64_tr_b16 v[118:119], v83 offset:7168
    v_add_u32 v80, s12, v72
    v_add_u32 v81, s12, v73
    s_waitcnt vmcnt(11) lgkmcnt(4)
    v_mfma_f32_32x32x16_bf16 v[16:31], v[104:107], v[184:187], v[16:31]
    ds_read_b32 v79, v8 offset:25984
    ds_read_b64_tr_b16 v[120:121], v80 offset:0
    ds_read_b64_tr_b16 v[122:123], v80 offset:1024
    buffer_load_dwordx4 v[168:171], v78, s[40:43], s38 offen offset:0 sc1
    v_mfma_f32_32x32x16_bf16 v[32:47], v[108:111], v[184:187], v[32:47]
    ds_read_b64_tr_b16 v[124:125], v81 offset:0
    ds_read_b64_tr_b16 v[126:127], v81 offset:1024
    s_waitcnt vmcnt(11) lgkmcnt(4)
    v_mfma_f32_32x32x16_bf16 v[16:31], v[112:115], v[188:191], v[16:31]
    ds_read_b64_tr_b16 v[104:105], v80 offset:2048
    ds_read_b64_tr_b16 v[106:107], v80 offset:3072
    buffer_load_dwordx4 v[172:175], v78, s[40:43], s38 offen offset:2048 sc1
    v_mfma_f32_32x32x16_bf16 v[32:47], v[116:119], v[188:191], v[32:47]
    ds_read_b64_tr_b16 v[108:109], v81 offset:2048
    ds_read_b64_tr_b16 v[110:111], v81 offset:3072
    v_readfirstlane_b32 s76, v79
    s_nop 0
    s_and_b32 s76, s76, s52
    s_cbranch_scc0 L_tr11
L_bk11:
    s_ff1_i32_b32 s76, s76
    s_bitset0_b32 s52, s76
    s_add_u32 s77, s76, s65
    s_and_b32 s77, s77, 15
    s_mul_i32 s77, s77, 32768
    s_add_u32 s39, s77, s80
    s_waitcnt vmcnt(11) lgkmcnt(4)
    v_mfma_f32_32x32x16_bf16 v[16:31], v[120:123], v[128:131], v[16:31]
    ds_read_b64_tr_b16 v[112:113], v80 offset:4096
    ds_read_b64_tr_b16 v[114:115], v80 offset:5120
    buffer_load_dwordx4 v[176:179], v14, s[40:43], s39 offen offset:0 sc1
    s_add_u32 s76, s76, 3
    s_and_b32 s76, s76, 15
    s_lshl_b32 s15, s76, 13
    v_mfma_f32_32x32x16_bf16 v[32:47], v[124:127], v[128:131], v[32:47]
    ds_read_b64_tr_b16 v[116:117], v81 offset:4096
    ds_read_b64_tr_b16 v[118:119], v81 offset:5120
    s_waitcnt vmcnt(11) lgkmcnt(4)
    v_mfma_f32_32x32x16_bf16 v[16:31], v[104:107], v[132:135], v[16:31]
    ds_read_b64_tr_b16 v[120:121], v80 offset:6144
    ds_read_b64_tr_b16 v[122:123], v80 offset:7168
    buffer_load_dwordx4 v[180:183], v14, s[40:43], s39 offen offset:2048 sc1
    v_mfma_f32_32x32x16_bf16 v[32:47], v[108:111], v[132:135], v[32:47]
    ds_read_b64_tr_b16 v[124:125], v81 offset:6144
    ds_read_b64_tr_b16 v[126:127], v81 offset:7168
    v_add_u32 v82, s13, v72
    v_add_u32 v83, s13, v73
    s_waitcnt vmcnt(11) lgkmcnt(4)
    v_mfma_f32_32x32x16_bf16 v[16:31], v[112:115], v[136:139], v[16:31]
    ds_read_b32 v79, v8 offset:25984
    ds_read_b64_tr_b16 v[104:105], v82 offset:0
    ds_read_b64_tr_b16 v[106:107], v82 offset:1024
    buffer_load_dwordx4 v[184:187], v78, s[40:43], s39 offen offset:0 sc1
    v_mfma_f32_32x32x16_bf16 v[32:47], v[116:119], v[136:139], v[32:47]
    ds_read_b64_tr_b16 v[108:109], v83 offset:0
    ds_read_b64_tr_b16 v[110:111], v83 offset:1024
    s_waitcnt vmcnt(11) lgkmcnt(4)
    v_mfma_f32_32x32x16_bf16 v[16:31], v[120:123], v[140:143], v[16:31]
    ds_read_b64_tr_b16 v[112:113], v82 offset:2048
    ds_read_b64_tr_b16 v[114:115], v82 offset:3072
    buffer_load_dwordx4 v[188:191], v78, s[40:43], s39 offen offset:2048 sc1
    v_mfma_f32_32x32x16_bf16 v[32:47], v[124:127], v[140:143], v[32:47]
    ds_read_b64_tr_b16 v[116:117], v83 offset:2048
    ds_read_b64_tr_b16 v[118:119], v83 offset:3072
    v_readfirstlane_b32 s76, v79
    s_nop 0
    s_and_b32 s76, s76, s52
    s_cbranch_scc0 L_tr12
L_bk12:
    s_ff1_i32_b32 s76, s76
    s_bitset0_b32 s52, s76
    s_add_u32 s77, s76, s65
    s_and_b32 s77, s77, 15
    s_mul_i32 s77, s77, 32768
    s_add_u32 s48, s77, s80
    s_waitcnt vmcnt(11) lgkmcnt(4)
    v_mfma_f32_32x32x16_bf16 v[16:31], v[104:107], v[144:147], v[16:31]
    ds_read_b64_tr_b16 v[120:121], v82 offset:4096
    ds_read_b64_tr_b16 v[122:123], v82 offset:5120
    buffer_load_dwordx4 v[128:131], v14, s[40:43], s48 offen offset:0 sc1
    s_add_u32 s76, s76, 3
    s_and_b32 s76, s76, 15
    s_lshl_b32 s16, s76, 13
    v_mfma_f32_32x32x16_bf16 v[32:47], v[108:111], v[144:147], v[32:47]
    ds_read_b64_tr_b16 v[124:125], v83 offset:4096
    ds_read_b64_tr_b16 v[126:127], v83 offset:5120
    s_waitcnt vmcnt(11) lgkmcnt(4)
    v_mfma_f32_32x32x16_bf16 v[16:31], v[112:115], v[148:151], v[16:31]
    ds_read_b64_tr_b16 v[104:105], v82 offset:6144
    ds_read_b64_tr_b16 v[106:107], v82 offset:7168
    buffer_load_dwordx4 v[132:135], v14, s[40:43], s48 offen offset:2048 sc1
    v_mfma_f32_32x32x16_bf16 v[32:47], v[116:119], v[148:151], v[32:47]
    ds_read_b64_tr_b16 v[108:109], v83 offset:6144
    ds_read_b64_tr_b16 v[110:111], v83 offset:7168
    v_add_u32 v80, s14, v72
    v_add_u32 v81, s14, v73
    s_waitcnt vmcnt(11) lgkmcnt(4)
    v_mfma_f32_32x32x16_bf16 v[16:31], v[120:123], v[152:155], v[16:31]
    ds_read_b32 v79, v8 offset:25984
    ds_read_b64_tr_b16 v[112:113], v80 offset:0
    ds_read_b64_tr_b16 v[114:115], v80 offset:1024
    buffer_load_dwordx4 v[136:139], v78, s[40:43], s48 offen offset:0 sc1
    v_mfma_f32_32x32x16_bf16 v[32:47], v[124:127], v[152:155], v[32:47]
    ds_read_b64_tr_b16 v[116:117], v81 offset:0
    ds_read_b64_tr_b16 v[118:119], v81 offset:1024
    s_waitcnt vmcnt(11) lgkmcnt(4)
    v_mfma_f32_32x32x16_bf16 v[16:31], v[104:107], v[156:159], v[16:31]
    ds_read_b64_tr_b16 v[120:121], v80 offset:2048
    ds_read_b64_tr_b16 v[122:123], v80 offset:3072
    buffer_load_dwordx4 v[140:143], v78, s[40:43], s48 offen offset:2048 sc1
    v_mfma_f32_32x32x16_bf16 v[32:47], v[108:111], v[156:159], v[32:47]
    ds_read_b64_tr_b16 v[124:125], v81 offset:2048
    ds_read_b64_tr_b16 v[126:127], v81 offset:3072
    v_readfirstlane_b32 s76, v79
    s_nop 0
    s_and_b32 s76, s76, s52
    s_cbranch_scc0 L_tr13
L_bk13:
    s_ff1_i32_b32 s76, s76
    s_bitset0_b32 s52, s76
    s_add_u32 s77, s76, s65
    s_and_b32 s77, s77, 15
    s_mul_i32 s77, s77, 32768
    s_add_u32 s49, s77, s80
    s_waitcnt vmcnt(11) lgkmcnt(4)
    v_mfma_f32_32x32x16_bf16 v[16:31], v[112:115], v[160:163], v[16:31]
    ds_read_b64_tr_b16 v[104:105], v80 offset:4096
    ds_read_b64_tr_b16 v[106:107], v80 offset:5120
    buffer_load_dwordx4 v[144:147], v14, s[40:43], s49 offen offset:0 sc1
    s_add_u32 s76, s76, 3
    s_and_b32 s76, s76, 15
    s_lshl_b32 s17, s76, 13
    v_mfma_f32_32x32x16_bf16 v[32:47], v[116:119], v[160:163], v[32:47]
    ds_read_b64_tr_b16 v[108:109], v81 offset:4096
    ds_read_b64_tr_b16 v[110:111], v81 offset:5120
    s_waitcnt vmcnt(11) lgkmcnt(4)
    v_mfma_f32_32x32x16_bf16 v[16:31], v[120:123], v[164:167], v[16:31]
    ds_read_b64_tr_b16 v[112:113], v80 offset:6144
    ds_read_b64_tr_b16 v[114:115], v80 offset:7168
    buffer_load_dwordx4 v[148:151], v14, s[40:43], s49 offen offset:2048 sc1
    v_mfma_f32_32x32x16_bf16 v[32:47], v[124:127], v[164:167], v[32:47]
    ds_read_b64_tr_b16 v[116:117], v81 offset:6144
    ds_read_b64_tr_b16 v[118:119], v81 offset:7168
    v_add_u32 v82, s15, v72
    v_add_u32 v83, s15, v73
    s_waitcnt vmcnt(11) lgkmcnt(4)
    v_mfma_f32_32x32x16_bf16 v[16:31], v[104:107], v[168:171], v[16:31]
    ds_read_b32 v79, v8 offset:25984
    ds_read_b64_tr_b16 v[120:121], v82 offset:0
    ds_read_b64_tr_b16 v[122:123], v82 offset:1024
    buffer_load_dwordx4 v[152:155], v78, s[40:43], s49 offen offset:0 sc1
    v_mfma_f32_32x32x16_bf16 v[32:47], v[108:111], v[168:171], v[32:47]
    ds_read_b64_tr_b16 v[124:125], v83 offset:0
    ds_read_b64_tr_b16 v[126:127], v83 offset:1024
    s_waitcnt vmcnt(11) lgkmcnt(4)
    v_mfma_f32_32x32x16_bf16 v[16:31], v[112:115], v[172:175], v[16:31]
    ds_read_b64_tr_b16 v[104:105], v82 offset:2048
    ds_read_b64_tr_b16 v[106:107], v82 offset:3072
    buffer_load_dwordx4 v[156:159], v78, s[40:43], s49 offen offset:2048 sc1
    v_mfma_f32_32x32x16_bf16 v[32:47], v[116:119], v[172:175], v[32:47]
    ds_read_b64_tr_b16 v[108:109], v83 offset:2048
    ds_read_b64_tr_b16 v[110:111], v83 offset:3072
    v_readfirstlane_b32 s76, v79
    s_nop 0
    s_and_b32 s76, s76, s52
    s_cbranch_scc0 L_tr14
L_bk14:
    s_ff1_i32_b32 s76, s76
    s_bitset0_b32 s52, s76
    s_add_u32 s77, s76, s65
    s_and_b32 s77, s77, 15
    s_mul_i32 s77, s77, 32768
    s_add_u32 s50, s77, s80
    s_waitcnt vmcnt(11) lgkmcnt(4)
    v_mfma_f32_32x32x16_bf16 v[16:31], v[120:123], v[176:179], v[16:31]
    ds_read_b64_tr_b16 v[112:113], v82 offset:4096
    ds_read_b64_tr_b16 v[114:115], v82 offset:5120
    buffer_load_dwordx4 v[160:163], v14, s[40:43], s50 offen offset:0 sc1
    s_add_u32 s76, s76, 3
    s_and_b32 s76, s76, 15
    s_lshl_b32 s18, s76, 13
    v_mfma_f32_32x32x16_bf16 v[32:47], v[124:127], v[176:179], v[32:47]
    ds_read_b64_tr_b16 v[116:117], v83 offset:4096
    ds_read_b64_tr_b16 v[118:119], v83 offset:5120
    s_waitcnt vmcnt(11) lgkmcnt(4)
    v_mfma_f32_32x32x16_bf16 v[16:31], v[104:107], v[180:183], v[16:31]
    ds_read_b64_tr_b16 v[120:121], v82 offset:6144
    ds_read_b64_tr_b16 v[122:123], v82 offset:7168
    buffer_load_dwordx4 v[164:167], v14, s[40:43], s50 offen offset:2048 sc1
    v_mfma_f32_32x32x16_bf16 v[32:47], v[108:111], v[180:183], v[32:47]
    ds_read_b64_tr_b16 v[124:125], v83 offset:6144
    ds_read_b64_tr_b16 v[126:127], v83 offset:7168
    v_add_u32 v80, s16, v72
    v_add_u32 v81, s16, v73
    s_waitcnt vmcnt(11) lgkmcnt(4)
    v_mfma_f32_32x32x16_bf16 v[16:31], v[112:115], v[184:187], v[16:31]
    ds_read_b32 v79, v8 offset:25984
    ds_read_b64_tr_b16 v[104:105], v80 offset:0
    ds_read_b64_tr_b16 v[106:107], v80 offset:1024
    buffer_load_dwordx4 v[168:171], v78, s[40:43], s50 offen offset:0 sc1
    v_mfma_f32_32x32x16_bf16 v[32:47], v[116:119], v[184:187], v[32:47]
    ds_read_b64_tr_b16 v[108:109], v81 offset:0
    ds_read_b64_tr_b16 v[110:111], v81 offset:1024
    s_waitcnt vmcnt(11) lgkmcnt(4)
    v_mfma_f32_32x32x16_bf16 v[16:31], v[120:123], v[188:191], v[16:31]
    ds_read_b64_tr_b16 v[112:113], v80 offset:2048
    ds_read_b64_tr_b16 v[114:115], v80 offset:3072
    buffer_load_dwordx4 v[172:175], v78, s[40:43], s50 offen offset:2048 sc1
    v_mfma_f32_32x32x16_bf16 v[32:47], v[124:127], v[188:191], v[32:47]
    ds_read_b64_tr_b16 v[116:117], v81 offset:2048
    ds_read_b64_tr_b16 v[118:119], v81 offset:3072
    v_readfirstlane_b32 s76, v79
    s_nop 0
    s_and_b32 s76, s76, s52
    s_cbranch_scc0 L_tr15
L_bk15:
    s_ff1_i32_b32 s76, s76
    s_bitset0_b32 s52, s76
    s_add_u32 s77, s76, s65
    s_and_b32 s77, s77, 15
    s_mul_i32 s77, s77, 32768
    s_add_u32 s51, s77, s80
    s_waitcnt vmcnt(11) lgkmcnt(4)
    v_mfma_f32_32x32x16_bf16 v[16:31], v[104:107], v[128:131], v[16:31]
    ds_read_b64_tr_b16 v[120:121], v80 offset:4096
    ds_read_b64_tr_b16 v[122:123], v80 offset:5120
    buffer_load_dwordx4 v[176:179], v14, s[40:43], s51 offen offset:0 sc1
    s_add_u32 s76, s76, 3
    s_and_b32 s76, s76, 15
    s_lshl_b32 s19, s76, 13
    v_mfma_f32_32x32x16_bf16 v[32:47], v[108:111], v[128:131], v[32:47]
    ds_read_b64_tr_b16 v[124:125], v81 offset:4096
    ds_read_b64_tr_b16 v[126:127], v81 offset:5120
    s_waitcnt vmcnt(11) lgkmcnt(4)
    v_mfma_f32_32x32x16_bf16 v[16:31], v[112:115], v[132:135], v[16:31]
    ds_read_b64_tr_b16 v[104:105], v80 offset:6144
    ds_read_b64_tr_b16 v[106:107], v80 offset:7168
    buffer_load_dwordx4 v[180:183], v14, s[40:43], s51 offen offset:2048 sc1
    v_mfma_f32_32x32x16_bf16 v[32:47], v[116:119], v[132:135], v[32:47]
    ds_read_b64_tr_b16 v[108:109], v81 offset:6144
    ds_read_b64_tr_b16 v[110:111], v81 offset:7168
    v_add_u32 v82, s17, v72
    v_add_u32 v83, s17, v73
    s_waitcnt vmcnt(11) lgkmcnt(4)
    v_mfma_f32_32x32x16_bf16 v[16:31], v[120:123], v[136:139], v[16:31]
    ds_read_b64_tr_b16 v[112:113], v82 offset:0
    ds_read_b64_tr_b16 v[114:115], v82 offset:1024
    buffer_load_dwordx4 v[184:187], v78, s[40:43], s51 offen offset:0 sc1
    v_mfma_f32_32x32x16_bf16 v[32:47], v[124:127], v[136:139], v[32:47]
    ds_read_b64_tr_b16 v[116:117], v83 offset:0
    ds_read_b64_tr_b16 v[118:119], v83 offset:1024
    s_waitcnt vmcnt(11) lgkmcnt(4)
    v_mfma_f32_32x32x16_bf16 v[16:31], v[104:107], v[140:143], v[16:31]
    ds_read_b64_tr_b16 v[120:121], v82 offset:2048
    ds_read_b64_tr_b16 v[122:123], v82 offset:3072
    buffer_load_dwordx4 v[188:191], v78, s[40:43], s51 offen offset:2048 sc1
    s_barrier
    v_mfma_f32_32x32x16_bf16 v[32:47], v[108:111], v[140:143], v[32:47]
    ds_read_b64_tr_b16 v[124:125], v83 offset:2048
    ds_read_b64_tr_b16 v[126:127], v83 offset:3072
    s_waitcnt vmcnt(11) lgkmcnt(4)
    v_mfma_f32_32x32x16_bf16 v[16:31], v[112:115], v[144:147], v[16:31]
    ds_read_b64_tr_b16 v[104:105], v82 offset:4096
    ds_read_b64_tr_b16 v[106:107], v82 offset:5120
    v_mfma_f32_32x32x16_bf16 v[32:47], v[116:119], v[144:147], v[32:47]
    ds_read_b64_tr_b16 v[108:109], v83 offset:4096
    ds_read_b64_tr_b16 v[110:111], v83 offset:5120
    s_waitcnt vmcnt(10) lgkmcnt(4)
    v_mfma_f32_32x32x16_bf16 v[16:31], v[120:123], v[148:151], v[16:31]
    ds_read_b64_tr_b16 v[112:113], v82 offset:6144
    ds_read_b64_tr_b16 v[114:115], v82 offset:7168
    v_mfma_f32_32x32x16_bf16 v[32:47], v[124:127], v[148:151], v[32:47]
    ds_read_b64_tr_b16 v[116:117], v83 offset:6144
    ds_read_b64_tr_b16 v[118:119], v83 offset:7168
    v_add_u32 v80, s18, v72
    v_add_u32_e64 v81, s18, v73
    s_waitcnt vmcnt(9) lgkmcnt(4)
    v_mfma_f32_32x32x16_bf16 v[16:31], v[104:107], v[152:155], v[16:31]
    ds_read_b64_tr_b16 v[120:121], v80 offset:0
    ds_read_b64_tr_b16 v[122:123], v80 offset:1024
    v_mfma_f32_32x32x16_bf16 v[32:47], v[108:111], v[152:155], v[32:47]
    ds_read_b64_tr_b16 v[124:125], v81 offset:0
    ds_read_b64_tr_b16 v[126:127], v81 offset:1024
    s_waitcnt vmcnt(8) lgkmcnt(4)
    v_mfma_f32_32x32x16_bf16 v[16:31], v[112:115], v[156:159], v[16:31]
    ds_read_b64_tr_b16 v[104:105], v80 offset:2048
    ds_read_b64_tr_b16 v[106:107], v80 offset:3072
    v_mfma_f32_32x32x16_bf16 v[32:47], v[116:119], v[156:159], v[32:47]
    ds_read_b64_tr_b16 v[108:109], v81 offset:2048
    ds_read_b64_tr_b16 v[110:111], v81 offset:3072
    s_waitcnt vmcnt(7) lgkmcnt(4)
    v_mfma_f32_32x32x16_bf16 v[16:31], v[120:123], v[160:163], v[16:31]
    ds_read_b64_tr_b16 v[112:113], v80 offset:4096
    ds_read_b64_tr_b16 v[114:115], v80 offset:5120
    v_mfma_f32_32x32x16_bf16 v[32:47], v[124:127], v[160:163], v[32:47]
    ds_read_b64_tr_b16 v[116:117], v81 offset:4096
    ds_read_b64_tr_b16 v[118:119], v81 offset:5120
    s_waitcnt vmcnt(6) lgkmcnt(4)
    v_mfma_f32_32x32x16_bf16 v[16:31], v[104:107], v[164:167], v[16:31]
    ds_read_b64_tr_b16 v[120:121], v80 offset:6144
    ds_read_b64_tr_b16 v[122:123], v80 offset:7168
    v_mfma_f32_32x32x16_bf16 v[32:47], v[108:111], v[164:167], v[32:47]
    ds_read_b64_tr_b16 v[124:125], v81 offset:6144
    ds_read_b64_tr_b16 v[126:127], v81 offset:7168
    v_add_u32 v82, s19, v72
    v_add_u32 v83, s19, v73
    s_waitcnt vmcnt(5) lgkmcnt(4)
    v_mfma_f32_32x32x16_bf16 v[16:31], v[112:115], v[168:171], v[16:31]
    ds_read_b64_tr_b16 v[104:105], v82 offset:0
    ds_read_b64_tr_b16 v[106:107], v82 offset:1024
    v_mfma_f32_32x32x16_bf16 v[32:47], v[116:119], v[168:171], v[32:47]
    ds_read_b64_tr_b16 v[108:109], v83 offset:0
    ds_read_b64_tr_b16 v[110:111], v83 offset:1024
    s_waitcnt vmcnt(4) lgkmcnt(4)
    v_mfma_f32_32x32x16_bf16 v[16:31], v[120:123], v[172:175], v[16:31]
    ds_read_b64_tr_b16 v[112:113], v82 offset:2048
    ds_read_b64_tr_b16 v[114:115], v82 offset:3072
    v_mfma_f32_32x32x16_bf16 v[32:47], v[124:127], v[172:175], v[32:47]
    ds_read_b64_tr_b16 v[116:117], v83 offset:2048
    ds_read_b64_tr_b16 v[118:119], v83 offset:3072
    s_waitcnt vmcnt(3) lgkmcnt(4)
    v_mfma_f32_32x32x16_bf16 v[16:31], v[104:107], v[176:179], v[16:31]
    ds_read_b64_tr_b16 v[120:121], v82 offset:4096
    ds_read_b64_tr_b16 v[122:123], v82 offset:5120
    v_mfma_f32_32x32x16_bf16 v[32:47], v[108:111], v[176:179], v[32:47]
    ds_read_b64_tr_b16 v[124:125], v83 offset:4096
    ds_read_b64_tr_b16 v[126:127], v83 offset:5120
    s_waitcnt vmcnt(2) lgkmcnt(4)
    v_mfma_f32_32x32x16_bf16 v[16:31], v[112:115], v[180:183], v[16:31]
    ds_read_b64_tr_b16 v[104:105], v82 offset:6144
    ds_read_b64_tr_b16 v[106:107], v82 offset:7168
    v_mfma_f32_32x32x16_bf16 v[32:47], v[116:119], v[180:183], v[32:47]
    ds_read_b64_tr_b16 v[108:109], v83 offset:6144
    ds_read_b64_tr_b16 v[110:111], v83 offset:7168
    s_waitcnt vmcnt(1) lgkmcnt(4)
    v_mfma_f32_32x32x16_bf16 v[16:31], v[120:123], v[184:187], v[16:31]
    v_mfma_f32_32x32x16_bf16 v[32:47], v[124:127], v[184:187], v[32:47]
    s_waitcnt vmcnt(0) lgkmcnt(0)
    v_mfma_f32_32x32x16_bf16 v[16:31], v[104:107], v[188:191], v[16:31]
    v_mfma_f32_32x32x16_bf16 v[32:47], v[108:111], v[188:191], v[32:47]
    s_nop 10
    v_cvt_pk_bf16_f32 v88, v16, v17
    v_cvt_pk_bf16_f32 v89, v18, v19
    v_cvt_pk_bf16_f32 v90, v20, v21
    v_cvt_pk_bf16_f32 v91, v22, v23
    v_cvt_pk_bf16_f32 v92, v24, v25
    v_cvt_pk_bf16_f32 v93, v26, v27
    v_cvt_pk_bf16_f32 v94, v28, v29
    v_cvt_pk_bf16_f32 v95, v30, v31
    v_cvt_pk_bf16_f32 v96, v32, v33
    v_cvt_pk_bf16_f32 v97, v34, v35
    v_cvt_pk_bf16_f32 v98, v36, v37
    v_cvt_pk_bf16_f32 v99, v38, v39
    v_cvt_pk_bf16_f32 v100, v40, v41
    v_cvt_pk_bf16_f32 v101, v42, v43
    v_cvt_pk_bf16_f32 v102, v44, v45
    v_cvt_pk_bf16_f32 v103, v46, v47
    v_dot2_f32_bf16 v104, v88, s89, 0
    v_dot2_f32_bf16 v105, v88, v88, 0
    v_dot2_f32_bf16 v106, v88, v192, 0
    v_dot2_f32_bf16 v104, v89, s89, v104
    v_dot2_f32_bf16 v105, v89, v89, v105
    v_dot2_f32_bf16 v106, v89, v193, v106
    v_dot2_f32_bf16 v104, v90, s89, v104
    v_dot2_f32_bf16 v105, v90, v90, v105
    v_dot2_f32_bf16 v106, v90, v194, v106
    v_dot2_f32_bf16 v104, v91, s89, v104
    v_dot2_f32_bf16 v105, v91, v91, v105
    v_dot2_f32_bf16 v106, v91, v195, v106
    v_dot2_f32_bf16 v104, v92, s89, v104
    v_dot2_f32_bf16 v105, v92, v92, v105
    v_dot2_f32_bf16 v106, v92, v196, v106
    v_dot2_f32_bf16 v104, v93, s89, v104
    v_dot2_f32_bf16 v105, v93, v93, v105
    v_dot2_f32_bf16 v106, v93, v197, v106
    v_dot2_f32_bf16 v104, v94, s89, v104
    v_dot2_f32_bf16 v105, v94, v94, v105
    v_dot2_f32_bf16 v106, v94, v198, v106
    v_dot2_f32_bf16 v104, v95, s89, v104
    v_dot2_f32_bf16 v105, v95, v95, v105
    v_dot2_f32_bf16 v106, v95, v199, v106
    v_dot2_f32_bf16 v104, v96, s89, v104
    v_dot2_f32_bf16 v105, v96, v96, v105
    v_dot2_f32_bf16 v106, v96, v200, v106
    v_dot2_f32_bf16 v104, v97, s89, v104
    v_dot2_f32_bf16 v105, v97, v97, v105
    v_dot2_f32_bf16 v106, v97, v201, v106
    v_dot2_f32_bf16 v104, v98, s89, v104
    v_dot2_f32_bf16 v105, v98, v98, v105
    v_dot2_f32_bf16 v106, v98, v202, v106
    v_dot2_f32_bf16 v104, v99, s89, v104
    v_dot2_f32_bf16 v105, v99, v99, v105
    v_dot2_f32_bf16 v106, v99, v203, v106
    v_dot2_f32_bf16 v104, v100, s89, v104
    v_dot2_f32_bf16 v105, v100, v100, v105
    v_dot2_f32_bf16 v106, v100, v204, v106
    v_dot2_f32_bf16 v104, v101, s89, v104
    v_dot2_f32_bf16 v105, v101, v101, v105
    v_dot2_f32_bf16 v106, v101, v205, v106
    v_dot2_f32_bf16 v104, v102, s89, v104
    v_dot2_f32_bf16 v105, v102, v102, v105
    v_dot2_f32_bf16 v106, v102, v206, v106
    v_dot2_f32_bf16 v104, v103, s89, v104
    v_dot2_f32_bf16 v105, v103, v103, v105
    v_dot2_f32_bf16 v106, v103, v207, v106
    s_lshl_b32 s76, s62, 9
    s_add_u32 s77, s76, s99
    v_mov_b32 v107, 0
    v_mov_b32 v4, v104
    v_mov_b32 v5, v105
    v_mov_b32 v6, v106
    v_permlane32_swap_b32 v104, v4
    v_permlane32_swap_b32 v105, v5
    v_permlane32_swap_b32 v106, v6
    v_add_f32 v104, v104, v4
    v_add_f32 v105, v105, v5
    v_add_f32_e64 v106, v106, v6
    s_mov_b32 exec_hi, 0
    s_bitcmp1_b32 s100, 1
    s_cbranch_scc1 L_loc_57
    buffer_store_dwordx4 v[104:107], v12, s[40:43], s77 offen offset:1024 sc1
    s_branch L_pubd_58
L_loc_57:
    buffer_store_dwordx4 v[104:107], v12, s[40:43], s77 offen offset:1024
L_pubd_58:
    s_mov_b64 exec, -1
    ds_write_b64 v64, v[88:89]
    ds_write_b64 v65, v[90:91]
    ds_write_b64 v66, v[92:93]
    ds_write_b64 v67, v[94:95]
    ds_write_b64 v68, v[96:97]
    ds_write_b64 v69, v[98:99]
    ds_write_b64 v70, v[100:101]
    ds_write_b64 v71, v[102:103]
    v_bfe_u32 v4, v1, 1, 3
    v_bfe_u32 v5, v1, 4, 1
    v_lshlrev_b32_e64 v176, 4, v4
    v_lshl_add_u32 v176, v5, 3, v176
    v_and_b32_e64 v5, 1, v1
    v_lshl_add_u32 v176, v5, 2, v176
    v_lshlrev_b32_e64 v177, 2, v2
    v_lshl_add_u32 v177, v3, 8, v177
    v_and_b32 v4, 15, v1
    v_lshrrev_b32 v5, 4, v1
    v_mul_u32_u24 v179, 149504, v4
    v_lshl_add_u32 v180, v5, 4, v179
    s_lshl_b32 s82, s97, 7
    s_lshl_b32 s79, s62, 5
    s_add_u32 s82, s82, s79
    s_lshl_b32 s79, s62, 2
    v_mov_b32_e64 v7, s79
    v_mul_u32_u24 v6, 9344, v3
    v_lshl_add_u32 v6, v2, 4, v6
    s_mul_i32 s78, s97, 149504
    s_add_u32 s78, s78, s76
    s_add_u32 s78, s78, 8388608
    s_add_u32 s48, s78, 18688
    s_add_u32 s49, s48, 18688
    s_add_u32 s50, s49, 18688
    s_add_u32 s51, s50, 18688
    s_add_u32 s52, s51, 18688
    s_add_u32 s53, s52, 18688
    s_add_u32 s54, s53, 18688
    buffer_load_dwordx4 v[112:115], v6, s[40:43], s78 offen offset:1024 sc1
    buffer_load_dwordx4 v[116:119], v6, s[40:43], s48 offen offset:1024 sc1
    buffer_load_dwordx4 v[120:123], v6, s[40:43], s49 offen offset:1024 sc1
    buffer_load_dwordx4 v[124:127], v6, s[40:43], s50 offen offset:1024 sc1
    buffer_load_dwordx4 v[128:131], v6, s[40:43], s51 offen offset:1024 sc1
    buffer_load_dwordx4 v[132:135], v6, s[40:43], s52 offen offset:1024 sc1
    buffer_load_dwordx4 v[136:139], v6, s[40:43], s53 offen offset:1024 sc1
    buffer_load_dwordx4 v[140:143], v6, s[40:43], s54 offen offset:1024 sc1
    v_dot2_f32_bf16 v76, v208, s89, 0
    v_dot2_f32_bf16 v76, v209, s89, v76
    v_dot2_f32_bf16 v76, v210, s89, v76
    v_dot2_f32_bf16 v76, v211, s89, v76
    v_dot2_f32_bf16 v76, v212, s89, v76
    v_dot2_f32_bf16 v76, v213, s89, v76
    v_dot2_f32_bf16 v76, v214, s89, v76
    v_dot2_f32_bf16 v76, v215, s89, v76
    s_nop 2
    v_add_f32_dpp v76, v76, v76 row_ror:8 row_mask:0xf bank_mask:0xf
    s_nop 1
    v_add_f32_dpp v76, v76, v76 row_ror:4 row_mask:0xf bank_mask:0xf
    s_nop 1
    v_add_f32_dpp v76, v76, v76 row_ror:2 row_mask:0xf bank_mask:0xf
    s_nop 1
    v_add_f32_dpp v76, v76, v76 row_ror:1 row_mask:0xf bank_mask:0xf
    v_mov_b32 v4, v76
    s_nop 1
    v_permlane16_swap_b32 v76, v4
    v_add_f32 v76, v76, v4
    v_mov_b32 v4, v76
    s_nop 1
    v_permlane32_swap_b32 v76, v4
    v_add_f32 v76, v76, v4
    s_mov_b32 s88, 0
    s_branch L_s3first_59
L_s3_60:
    v_cmp_eq_u32 vcc, -1, v112
    s_nop 0
    s_cbranch_vccz L_s3skip_61
    buffer_load_dwordx4 v[112:115], v6, s[40:43], s78 offen offset:1024 sc1
L_s3skip_61:
    v_cmp_eq_u32_e64 vcc, -1, v116
    s_nop 0
    s_cbranch_vccz L_s3skip_62
    buffer_load_dwordx4 v[116:119], v6, s[40:43], s48 offen offset:1024 sc1
L_s3skip_62:
    v_cmp_eq_u32_e64 vcc, -1, v120
    s_nop 0
    s_cbranch_vccz L_s3skip_63
    buffer_load_dwordx4 v[120:123], v6, s[40:43], s49 offen offset:1024 sc1
L_s3skip_63:
    v_cmp_eq_u32_e64 vcc, -1, v124
    s_nop 0
    s_cbranch_vccz L_s3skip_64
    buffer_load_dwordx4 v[124:127], v6, s[40:43], s50 offen offset:1024 sc1
L_s3skip_64:
    v_cmp_eq_u32_e64 vcc, -1, v128
    s_nop 0
    s_cbranch_vccz L_s3skip_65
    buffer_load_dwordx4 v[128:131], v6, s[40:43], s51 offen offset:1024 sc1
L_s3skip_65:
    v_cmp_eq_u32_e64 vcc, -1, v132
    s_nop 0
    s_cbranch_vccz L_s3skip_66
    buffer_load_dwordx4 v[132:135], v6, s[40:43], s52 offen offset:1024 sc1
L_s3skip_66:
    v_cmp_eq_u32_e64 vcc, -1, v136
    s_nop 0
    s_cbranch_vccz L_s3skip_67
    buffer_load_dwordx4 v[136:139], v6, s[40:43], s53 offen offset:1024 sc1
L_s3skip_67:
    v_cmp_eq_u32_e64 vcc, -1, v140
    s_nop 0
    s_cbranch_vccz L_s3skip_68
    buffer_load_dwordx4 v[140:143], v6, s[40:43], s54 offen offset:1024 sc1
L_s3skip_68:
L_s3first_59:
    s_waitcnt vmcnt(0)
    v_max3_u32 v4, v112, v116, v120
    v_max3_u32 v4, v4, v124, v128
    v_max3_u32 v4, v4, v132, v136
    v_max_u32 v4, v4, v140
    v_cmp_eq_u32 vcc, -1, v4
    s_nop 0
    s_cbranch_vccz L_ok_69
    s_add_u32 s88, s88, 1
    s_cmp_lt_u32 s88, 65536
    s_cbranch_scc1 L_s3_60
L_ok_69:
    s_barrier
    v_pk_add_f32 v[112:113], v[112:113], v[128:129]
    v_pk_add_f32 v[114:115], v[114:115], v[130:131]
    v_pk_add_f32 v[116:117], v[116:117], v[132:133]
    v_pk_add_f32 v[118:119], v[118:119], v[134:135]
    v_pk_add_f32 v[120:121], v[120:121], v[136:137]
    v_pk_add_f32 v[122:123], v[122:123], v[138:139]
    v_pk_add_f32 v[124:125], v[124:125], v[140:141]
    v_pk_add_f32 v[126:127], v[126:127], v[142:143]
    v_pk_add_f32 v[112:113], v[112:113], v[120:121]
    v_pk_add_f32 v[114:115], v[114:115], v[122:123]
    v_pk_add_f32 v[116:117], v[116:117], v[124:125]
    v_pk_add_f32 v[118:119], v[118:119], v[126:127]
    v_pk_add_f32 v[112:113], v[112:113], v[116:117]
    v_pk_add_f32 v[114:115], v[114:115], v[118:119]
    v_mov_b32 v4, v112
    v_mov_b32 v5, v113
    v_mov_b32 v6, v114
    v_permlane32_swap_b32 v112, v4
    v_permlane32_swap_b32 v113, v5
    v_permlane32_swap_b32 v114, v6
    v_add_f32 v112, v112, v4
    v_add_f32 v113, v113, v5
    v_add_f32_e64 v114, v114, v6
    v_mul_f32 v112, 0x3a800000, v112
    v_mul_f32 v113, 0x3a800000, v113
    v_fma_f32 v4, -v112, v112, v113
    v_max_f32_e64 v4, 0, v4
    v_cvt_pk_bf16_f32 v116, v112, v112
    v_and_b32_e64 v116, s90, v116
    v_cvt_pk_bf16_f32 v4, v4, v4
    v_and_b32_e64 v4, s90, v4
    v_add_f32 v4, 0x3727c5ac, v4
    v_cvt_pk_bf16_f32 v4, v4, v4
    v_and_b32 v4, s90, v4
    v_sqrt_f32_e64 v4, v4
    s_nop 0
    v_cvt_pk_bf16_f32 v4, v4, v4
    v_and_b32 v4, s90, v4
    v_rcp_f32 v118, v4
    v_fma_f32 v120, -v116, v76, v114
    v_mul_f32 v119, v116, v118
    v_mul_f32 v120, v120, v118
    v_mov_b32 v6, 0
    s_lshl_b32 s83, s62, 12
    v_max_f32_dpp v4, v120, v120 row_ror:8 row_mask:0xf bank_mask:0xf
    s_nop 1
    v_max_f32_dpp v4, v4, v4 row_ror:4 row_mask:0xf bank_mask:0xf
    s_nop 1
    v_max_f32_dpp v4, v4, v4 row_ror:2 row_mask:0xf bank_mask:0xf
    s_nop 1
    v_max_f32_dpp v4, v4, v4 row_ror:1 row_mask:0xf bank_mask:0xf
    v_mov_b32 v5, v4
    s_nop 1
    v_permlane16_swap_b32 v4, v5
    v_max_f32_e64 v4, v4, v5
    ds_write_b32 v7, v4 offset:25600
    v_cmp_eq_f32 vcc, v4, v120
    s_nop 0
    s_ff1_i32_b32 s77, vcc_lo
    s_and_b32 s77, s77, 31
    s_bfe_u32 s79, s77, 0x30001
    s_lshl_b32 s79, s79, 4
    s_lshl_b32 s80, s77, 7
    s_add_u32 s80, s80, s83
    s_or_b32 s79, s79, s80
    v_xor_b32_e64 v176, s79, v176
    s_waitcnt lgkmcnt(0)
    s_barrier
    ds_read_b32 v182, v176 offset:0
    ds_read_b128 v[8:11], v6 offset:25600
    v_readlane_b32 s80, v118, s77
    v_readlane_b32 s81, v119, s77
    s_add_u32 s79, s82, s77
    v_writelane_b32 v4, s79, 33
    v_mov_b32 v5, s81
    v_cmp_gt_u32 s[84:85], 32, v1
    s_mov_b32 s83, 3
    s_waitcnt lgkmcnt(1)
    v_lshlrev_b32 v184, 16, v182
    v_and_b32 v185, s90, v182
    v_fma_f32 v184, v184, s80, -v5
    v_fma_f32 v185, v185, s80, -v5
    v_cvt_pk_bf16_f32 v184, v184, v185
    s_waitcnt lgkmcnt(0)
    v_max3_f32 v5, v8, v9, v10
    v_max_f32 v5, v5, v11
    v_cndmask_b32 v184, v4, v184, s[84:85]
    v_cmp_eq_f32 vcc, v5, v10
    s_nop 0
    s_cmp_lg_u32 vcc_lo, 0
    s_cselect_b32 s83, 2, s83
    v_cmp_eq_f32 vcc, v5, v9
    s_nop 0
    s_cmp_lg_u32 vcc_lo, 0
    s_cselect_b32 s83, 1, s83
    v_cmp_eq_f32_e64 vcc, v5, v8
    s_nop 0
    s_cmp_lg_u32 vcc_lo, 0
    s_cselect_b32 s83, 0, s83
    s_cmp_eq_u32 s83, s62
    s_cbranch_scc0 L_nopub_70
    s_mov_b32 exec_hi, -1
    buffer_store_dword v184, v177, s[40:43], s99 offen offset:0 sc1
    s_mov_b64 exec, -1
L_nopub_70:
    v_lshlrev_b32 v16, 16, v88
    v_and_b32_e64 v17, s90, v88
    v_pk_fma_f32 v[144:145], v[16:17], v[118:119], v[118:119] op_sel:[0,0,1] op_sel_hi:[1,0,1] neg_lo:[0,0,1] neg_hi:[0,0,1]
    v_cvt_pk_bf16_f32 v124, v144, v145
    v_lshlrev_b32 v144, 16, v124
    v_and_b32 v145, s90, v124
    v_pk_add_f32 v[144:145], v[144:145], v[16:17]
    v_cvt_pk_bf16_f32 v124, v144, v145
    v_lshlrev_b32 v18, 16, v89
    v_and_b32 v19, s90, v89
    v_pk_fma_f32 v[146:147], v[18:19], v[118:119], v[118:119] op_sel:[0,0,1] op_sel_hi:[1,0,1] neg_lo:[0,0,1] neg_hi:[0,0,1]
    v_cvt_pk_bf16_f32 v125, v146, v147
    v_lshlrev_b32 v146, 16, v125
    v_and_b32 v147, s90, v125
    v_pk_add_f32 v[146:147], v[146:147], v[18:19]
    v_cvt_pk_bf16_f32 v125, v146, v147
    ds_write_b64 v64, v[124:125]
    v_lshlrev_b32 v20, 16, v90
    v_and_b32 v21, s90, v90
    v_pk_fma_f32 v[148:149], v[20:21], v[118:119], v[118:119] op_sel:[0,0,1] op_sel_hi:[1,0,1] neg_lo:[0,0,1] neg_hi:[0,0,1]
    v_cvt_pk_bf16_f32 v126, v148, v149
    v_lshlrev_b32 v148, 16, v126
    v_and_b32 v149, s90, v126
    v_pk_add_f32 v[148:149], v[148:149], v[20:21]
    v_cvt_pk_bf16_f32 v126, v148, v149
    v_lshlrev_b32 v22, 16, v91
    v_and_b32 v23, s90, v91
    v_pk_fma_f32 v[150:151], v[22:23], v[118:119], v[118:119] op_sel:[0,0,1] op_sel_hi:[1,0,1] neg_lo:[0,0,1] neg_hi:[0,0,1]
    v_cvt_pk_bf16_f32 v127, v150, v151
    v_lshlrev_b32 v150, 16, v127
    v_and_b32 v151, s90, v127
    v_pk_add_f32 v[150:151], v[150:151], v[22:23]
    v_cvt_pk_bf16_f32 v127, v150, v151
    ds_write_b64 v65, v[126:127]
    v_lshlrev_b32 v24, 16, v92
    v_and_b32 v25, s90, v92
    v_pk_fma_f32 v[152:153], v[24:25], v[118:119], v[118:119] op_sel:[0,0,1] op_sel_hi:[1,0,1] neg_lo:[0,0,1] neg_hi:[0,0,1]
    v_cvt_pk_bf16_f32 v128, v152, v153
    v_lshlrev_b32 v152, 16, v128
    v_and_b32 v153, s90, v128
    v_pk_add_f32 v[152:153], v[152:153], v[24:25]
    v_cvt_pk_bf16_f32 v128, v152, v153
    v_lshlrev_b32 v26, 16, v93
    v_and_b32 v27, s90, v93
    v_pk_fma_f32 v[154:155], v[26:27], v[118:119], v[118:119] op_sel:[0,0,1] op_sel_hi:[1,0,1] neg_lo:[0,0,1] neg_hi:[0,0,1]
    v_cvt_pk_bf16_f32 v129, v154, v155
    v_lshlrev_b32 v154, 16, v129
    v_and_b32 v155, s90, v129
    v_pk_add_f32 v[154:155], v[154:155], v[26:27]
    v_cvt_pk_bf16_f32 v129, v154, v155
    ds_write_b64 v66, v[128:129]
    v_lshlrev_b32 v28, 16, v94
    v_and_b32 v29, s90, v94
    v_pk_fma_f32 v[156:157], v[28:29], v[118:119], v[118:119] op_sel:[0,0,1] op_sel_hi:[1,0,1] neg_lo:[0,0,1] neg_hi:[0,0,1]
    v_cvt_pk_bf16_f32 v130, v156, v157
    v_lshlrev_b32 v156, 16, v130
    v_and_b32 v157, s90, v130
    v_pk_add_f32 v[156:157], v[156:157], v[28:29]
    v_cvt_pk_bf16_f32 v130, v156, v157
    v_lshlrev_b32 v30, 16, v95
    v_and_b32 v31, s90, v95
    v_pk_fma_f32 v[158:159], v[30:31], v[118:119], v[118:119] op_sel:[0,0,1] op_sel_hi:[1,0,1] neg_lo:[0,0,1] neg_hi:[0,0,1]
    v_cvt_pk_bf16_f32 v131, v158, v159
    v_lshlrev_b32 v158, 16, v131
    v_and_b32 v159, s90, v131
    v_pk_add_f32 v[158:159], v[158:159], v[30:31]
    v_cvt_pk_bf16_f32 v131, v158, v159
    ds_write_b64 v67, v[130:131]
    v_and_b32 v7, 15, v1
    v_lshlrev_b32 v7, 3, v7
    s_cmp_eq_u32 s62, 0
    s_cbranch_scc0 L_nos4_71
    s_mul_i32 s76, s98, 9344
    s_add_u32 s76, s76, 8388608
    s_mov_b32 s88, 0
L_poll_72:
    buffer_load_dwordx2 v[196:197], v179, s[40:43], s76 offen offset:256 sc1
    buffer_load_dwordx4 v[188:191], v180, s[40:43], s76 offen offset:0 sc1
    buffer_load_dwordx4 v[192:195], v180, s[40:43], s76 offen offset:64 sc1
    s_waitcnt vmcnt(0)
    v_max3_u32 v4, v196, v197, v188
    v_max3_u32 v4, v4, v189, v190
    v_max3_u32 v4, v4, v191, v192
    v_max3_u32 v4, v4, v193, v194
    v_max_u32 v4, v4, v195
    v_cmp_eq_u32_e64 vcc, -1, v4
    s_nop 0
    s_cbranch_vccz L_ok_73
    s_add_u32 s88, s88, 1
    s_cmp_lt_u32 s88, 65536
    s_cbranch_scc1 L_poll_72
L_ok_73:
    ds_write_b128 v12, v[188:191] offset:28672
    ds_write_b128 v12, v[192:195] offset:29696
    ds_write_b64 v7, v[196:197] offset:25728
L_nos4_71:
    s_waitcnt lgkmcnt(0)
    s_barrier
    ds_read_b64 v[8:9], v7 offset:25728
    s_waitcnt lgkmcnt(0)
    v_max_f32_dpp v4, v8, v8 row_ror:8 row_mask:0xf bank_mask:0xf
    s_nop 1
    v_max_f32_dpp v4, v4, v4 row_ror:4 row_mask:0xf bank_mask:0xf
    s_nop 1
    v_max_f32_dpp v4, v4, v4 row_ror:2 row_mask:0xf bank_mask:0xf
    s_nop 1
    v_max_f32_dpp v4, v4, v4 row_ror:1 row_mask:0xf bank_mask:0xf
    v_cmp_eq_f32 vcc, v4, v8
    s_nop 0
    s_ff1_i32_b32 s92, vcc_lo
    s_and_b32 s92, s92, 15
    s_nop 3
    v_readlane_b32 s91, v9, s92
    s_nop 0
    s_cmp_eq_u32 s91, s79
    s_cbranch_scc0 L_noh_74
    s_mov_b32 exec_hi, 0
    buffer_store_dword v182, v177, s[40:43], s99 offen offset:128 sc1
    s_mov_b64 exec, -1
L_noh_74:
    s_sub_u32 s77, s91, s82
    v_lshrrev_b32 v7, 3, v1
    v_sub_u32 v5, s77, v7
    v_mov_b32 v6, 2146435072
    v_and_b32 v8, 7, v1
    v_lshrrev_b32 v9, 4, v1
    v_xor_b32 v8, v8, v9
    v_lshlrev_b32 v8, 4, v8
    v_lshl_add_u32 v7, v7, 11, v8
    v_xor_b32 v8, 64, v7
    s_lshl_b32 s76, s82, 11
    s_lshl_b32 s79, s98, 7
    s_add_u32 s76, s76, s79
    v_cmp_eq_u32 vcc, 0, v5
    s_nop 1
    v_cndmask_b32 v200, v7, v6, vcc
    v_cmp_eq_u32 vcc, 8, v5
    s_nop 1
    v_cndmask_b32 v201, v8, v6, vcc
    v_cmp_eq_u32 vcc, 16, v5
    s_nop 1
    v_cndmask_b32 v202, v7, v6, vcc
    v_cmp_eq_u32 vcc, 24, v5
    s_nop 1
    v_cndmask_b32 v203, v8, v6, vcc
    v_lshlrev_b32 v32, 16, v96
    v_and_b32 v33, s90, v96
    v_pk_fma_f32 v[160:161], v[32:33], v[118:119], v[118:119] op_sel:[0,0,1] op_sel_hi:[1,0,1] neg_lo:[0,0,1] neg_hi:[0,0,1]
    v_cvt_pk_bf16_f32 v132, v160, v161
    v_lshlrev_b32 v160, 16, v132
    v_and_b32 v161, s90, v132
    v_pk_add_f32 v[160:161], v[160:161], v[32:33]
    v_cvt_pk_bf16_f32 v132, v160, v161
    v_lshlrev_b32 v34, 16, v97
    v_and_b32 v35, s90, v97
    v_pk_fma_f32 v[162:163], v[34:35], v[118:119], v[118:119] op_sel:[0,0,1] op_sel_hi:[1,0,1] neg_lo:[0,0,1] neg_hi:[0,0,1]
    v_cvt_pk_bf16_f32 v133, v162, v163
    v_lshlrev_b32 v162, 16, v133
    v_and_b32 v163, s90, v133
    v_pk_add_f32 v[162:163], v[162:163], v[34:35]
    v_cvt_pk_bf16_f32 v133, v162, v163
    ds_write_b64 v68, v[132:133]
    v_lshlrev_b32 v36, 16, v98
    v_and_b32 v37, s90, v98
    v_pk_fma_f32 v[164:165], v[36:37], v[118:119], v[118:119] op_sel:[0,0,1] op_sel_hi:[1,0,1] neg_lo:[0,0,1] neg_hi:[0,0,1]
    v_cvt_pk_bf16_f32 v134, v164, v165
    v_lshlrev_b32 v164, 16, v134
    v_and_b32 v165, s90, v134
    v_pk_add_f32 v[164:165], v[164:165], v[36:37]
    v_cvt_pk_bf16_f32 v134, v164, v165
    v_lshlrev_b32 v38, 16, v99
    v_and_b32 v39, s90, v99
    v_pk_fma_f32 v[166:167], v[38:39], v[118:119], v[118:119] op_sel:[0,0,1] op_sel_hi:[1,0,1] neg_lo:[0,0,1] neg_hi:[0,0,1]
    v_cvt_pk_bf16_f32 v135, v166, v167
    v_lshlrev_b32 v166, 16, v135
    v_and_b32 v167, s90, v135
    v_pk_add_f32 v[166:167], v[166:167], v[38:39]
    v_cvt_pk_bf16_f32 v135, v166, v167
    ds_write_b64 v69, v[134:135]
    s_lshl_b32 s77, s62, 12
    s_add_u32 s77, s77, 0
    v_add_u32 v4, s77, v12
    s_barrier
    v_lshlrev_b32 v40, 16, v100
    v_and_b32 v41, s90, v100
    v_pk_fma_f32 v[168:169], v[40:41], v[118:119], v[118:119] op_sel:[0,0,1] op_sel_hi:[1,0,1] neg_lo:[0,0,1] neg_hi:[0,0,1]
    v_cvt_pk_bf16_f32 v136, v168, v169
    v_lshlrev_b32 v168, 16, v136
    v_and_b32 v169, s90, v136
    v_pk_add_f32 v[168:169], v[168:169], v[40:41]
    v_cvt_pk_bf16_f32 v136, v168, v169
    v_lshlrev_b32 v42, 16, v101
    v_and_b32 v43, s90, v101
    v_pk_fma_f32 v[170:171], v[42:43], v[118:119], v[118:119] op_sel:[0,0,1] op_sel_hi:[1,0,1] neg_lo:[0,0,1] neg_hi:[0,0,1]
    v_cvt_pk_bf16_f32 v137, v170, v171
    v_lshlrev_b32 v170, 16, v137
    v_and_b32 v171, s90, v137
    v_pk_add_f32 v[170:171], v[170:171], v[42:43]
    v_cvt_pk_bf16_f32 v137, v170, v171
    ds_write_b64 v70, v[136:137]
    v_lshlrev_b32 v44, 16, v102
    v_and_b32 v45, s90, v102
    v_pk_fma_f32 v[172:173], v[44:45], v[118:119], v[118:119] op_sel:[0,0,1] op_sel_hi:[1,0,1] neg_lo:[0,0,1] neg_hi:[0,0,1]
    v_cvt_pk_bf16_f32 v138, v172, v173
    v_lshlrev_b32 v172, 16, v138
    v_and_b32 v173, s90, v138
    v_pk_add_f32 v[172:173], v[172:173], v[44:45]
    v_cvt_pk_bf16_f32 v138, v172, v173
    v_lshlrev_b32 v46, 16, v103
    v_and_b32 v47, s90, v103
    v_pk_fma_f32 v[174:175], v[46:47], v[118:119], v[118:119] op_sel:[0,0,1] op_sel_hi:[1,0,1] neg_lo:[0,0,1] neg_hi:[0,0,1]
    v_cvt_pk_bf16_f32 v139, v174, v175
    v_lshlrev_b32 v174, 16, v139
    v_and_b32 v175, s90, v139
    v_pk_add_f32 v[174:175], v[174:175], v[46:47]
    v_cvt_pk_bf16_f32 v139, v174, v175
    ds_write_b64 v71, v[138:139]
    s_waitcnt lgkmcnt(0)
    ds_read_b128 v[48:51], v4 offset:0
    ds_read_b128 v[52:55], v4 offset:1024
    ds_read_b128 v[56:59], v4 offset:2048
    ds_read_b128 v[60:63], v4 offset:3072
    s_waitcnt lgkmcnt(3)
    buffer_store_dwordx4 v[48:51], v200, s[44:47], s76 offen sc1
    s_add_u32 s76, s76, 16384
    s_waitcnt lgkmcnt(2)
    buffer_store_dwordx4 v[52:55], v201, s[44:47], s76 offen sc1
    s_add_u32 s76, s76, 16384
    s_waitcnt lgkmcnt(1)
    buffer_store_dwordx4 v[56:59], v202, s[44:47], s76 offen sc1
    s_add_u32 s76, s76, 16384
    s_waitcnt lgkmcnt(0)
    buffer_store_dwordx4 v[60:63], v203, s[44:47], s76 offen sc1
L_cfin:
L_end:
    s_endpgm
L_tr0:
    s_call_b64 s[54:55], L_stall
    s_branch L_bk0
L_tr1:
    s_call_b64 s[54:55], L_stall
    s_branch L_bk1
L_tr2:
    s_call_b64 s[54:55], L_stall
    s_branch L_bk2
L_tr3:
    s_call_b64 s[54:55], L_stall
    s_branch L_bk3
L_tr4:
    s_call_b64 s[54:55], L_stall
    s_branch L_bk4
L_tr5:
    s_call_b64 s[54:55], L_stall
    s_branch L_bk5
L_tr6:
    s_call_b64 s[54:55], L_stall
    s_branch L_bk6
L_tr7:
    s_call_b64 s[54:55], L_stall
    s_branch L_bk7
L_tr8:
    s_call_b64 s[54:55], L_stall
    s_branch L_bk8
L_tr9:
    s_call_b64 s[54:55], L_stall
    s_branch L_bk9
L_tr10:
    s_call_b64 s[54:55], L_stall
    s_branch L_bk10
L_tr11:
    s_call_b64 s[54:55], L_stall
    s_branch L_bk11
L_tr12:
    s_call_b64 s[54:55], L_stall
    s_branch L_bk12
L_tr13:
    s_call_b64 s[54:55], L_stall
    s_branch L_bk13
L_tr14:
    s_call_b64 s[54:55], L_stall
    s_branch L_bk14
L_tr15:
    s_call_b64 s[54:55], L_stall
    s_branch L_bk15
L_stall:
    s_cmp_eq_u32 s53, 0
    s_cbranch_scc0 L_sent_56
    s_waitcnt vmcnt(0)
    s_mov_b64 exec, 1
    ds_add_u32 v8, v74 offset:25988
    s_mov_b64 exec, -1
    s_mov_b32 s53, 1
L_sent_56:
    s_mov_b32 s88, 0
L_stall1:
    ds_read_b32 v79, v8 offset:25984
    s_waitcnt lgkmcnt(0)
    v_readfirstlane_b32 s76, v79
    s_nop 0
    s_and_b32 s76, s76, s52
    s_cbranch_scc1 L_stall2
    s_add_u32 s88, s88, 1
    s_cmp_lt_u32 s88, 1048576
    s_cbranch_scc1 L_stall1
    s_mov_b32 s76, s52
L_stall2:
    s_setpc_b64 s[54:55]
L_code_end:
s_endpgm
.p2align 7
.type L_table,@object
L_table:
.long 0x650c3824, 0xfedba97, 0x50102, 0x3006
.long 0x650c3824, 0xfedba97, 0x510200, 0x3060
.long 0x641d0935, 0xfecba87, 0x5020001, 0x3600
.long 0x76543218, 0xfedcba9, 0x15000002, 0x6300
.long 0x641d0935, 0xfecba87, 0x25100, 0x3006
.long 0x54e2a160, 0xfdcb987, 0x502001, 0x3060
.long 0x54e2a160, 0xfdcb987, 0x5002010, 0x3600
.long 0x54f3b271, 0xedca986, 0x50201000, 0x6300
.long 0x54f3b271, 0xedca986, 0x152000, 0x3006
.long 0x650c3824, 0xfedba97, 0x520010, 0x3060
.long 0x650c3824, 0xfedba97, 0x5020001, 0x3600
.long 0x76543218, 0xfedcba9, 0x50000012, 0x6300
.long 0x641d0935, 0xfecba87, 0x25010, 0x3006
.long 0x641d0935, 0xfecba87, 0x510020, 0x3060
.long 0x54e2a160, 0xfdcb987, 0x5100002, 0x3600
.long 0x54e2a160, 0xfdcb987, 0x50001002, 0x6300
.long 0x641d0935, 0xfecba87, 0x500210, 0x3060
.long 0x641d0935, 0xfecba87, 0x5010200, 0x3600
.long 0x54e2a160, 0xfdcb987, 0x50100002, 0x6300
.long 0x76543209, 0xfedcba8, 0x15002, 0x3006
.long 0x54e2a160, 0xfdcb987, 0x501002, 0x3060
.long 0x54f3b271, 0xedca986, 0x5000120, 0x3600
.long 0x54f3b271, 0xedca986, 0x50000012, 0x6300
.long 0x650c3824, 0xfedba97, 0x15200, 0x3006
.long 0x650c3824, 0xfedba97, 0x520100, 0x3060
.long 0x641d0935, 0xfecba87, 0x5001200, 0x3600
.long 0x641d0935, 0xfecba87, 0x50020001, 0x6300
.long 0x76543209, 0xfedcba8, 0x25001, 0x3006
.long 0x54e2a160, 0xfdcb987, 0x502100, 0x3060
.long 0x54e2a160, 0xfdcb987, 0x5002010, 0x3600
.long 0x54f3b271, 0xedca986, 0x50001002, 0x6300
.long 0x54f3b271, 0xedca986, 0x152000, 0x3006
.long 0x54e2a160, 0xfdcb987, 0x5001002, 0x3600
.long 0x54e2a160, 0xfdcb987, 0x50000012, 0x6300
.long 0x54f3b271, 0xedca986, 0x51020, 0x3006
.long 0x765431a0, 0xfedcb98, 0x150200, 0x3060
.long 0x54f3b271, 0xedca986, 0x5102000, 0x3600
.long 0x650c3824, 0xfedba97, 0x50000102, 0x6300
.long 0x650c3824, 0xfedba97, 0x15020, 0x3006
.long 0x641d0935, 0xfecba87, 0x510200, 0x3060
.long 0x641d0935, 0xfecba87, 0x5020100, 0x3600
.long 0x54e2a160, 0xfdcb987, 0x50100002, 0x6300
.long 0x54e2a160, 0xfdcb987, 0x250001, 0x3006
.long 0x765431a0, 0xfedcb98, 0x251000, 0x3060
.long 0x54f3b271, 0xedca986, 0x5200010, 0x3600
.long 0x54f3b271, 0xedca986, 0x50200001, 0x6300
.long 0x650c3824, 0xfedba97, 0x50021, 0x3006
.long 0x650c3824, 0xfedba97, 0x520010, 0x3060
.long 0x54f3b271, 0xedca986, 0x50200010, 0x6300
.long 0x54f3b271, 0xedca986, 0x152000, 0x3006
.long 0x650c3824, 0xfedba97, 0x500102, 0x3060
.long 0x765421b0, 0xfedca98, 0x2500010, 0x3600
.long 0x650c3824, 0xfedba97, 0x50010200, 0x6300
.long 0x641d0935, 0xfecba87, 0x15200, 0x3006
.long 0x641d0935, 0xfecba87, 0x520001, 0x3060
.long 0x54e2a160, 0xfdcb987, 0x5100020, 0x3600
.long 0x54e2a160, 0xfdcb987, 0x50001020, 0x6300
.long 0x54f3b271, 0xedca986, 0x52001, 0x3006
.long 0x54f3b271, 0xedca986, 0x500102, 0x3060
.long 0x765421b0, 0xfedca98, 0x1500020, 0x3600
.long 0x650c3824, 0xfedba97, 0x50000021, 0x6300
.long 0x650c3824, 0xfedba97, 0x521000, 0x3006
.long 0x641d0935, 0xfecba87, 0x520100, 0x3060
.long 0x641d0935, 0xfecba87, 0x5001002, 0x3600
.long 0x650c3824, 0xfedba97, 0x50021, 0x3006
.long 0x650c3824, 0xfedba97, 0x520010, 0x3060
.long 0x641d0935, 0xfecba87, 0x5010002, 0x3600
.long 0x76532c10, 0xfedba98, 0x15002000, 0x6300
.long 0x641d0935, 0xfecba87, 0x50021, 0x3006
.long 0x54e2a160, 0xfdcb987, 0x251000, 0x3060
.long 0x54e2a160, 0xfdcb987, 0x5000012, 0x3600
.long 0x54f3b271, 0xedca986, 0x50100002, 0x6300
.long 0x54f3b271, 0xedca986, 0x51020, 0x3006
.long 0x650c3824, 0xfedba97, 0x510200, 0x3060
.long 0x650c3824, 0xfedba97, 0x5000102, 0x3600
.long 0x76532c10, 0xfedba98, 0x50000210, 0x6300
.long 0x641d0935, 0xfecba87, 0x50210, 0x3006
.long 0x641d0935, 0xfecba87, 0x520100, 0x3060
.long 0x54e2a160, 0xfdcb987, 0x5100020, 0x3600
.long 0x54e2a160, 0xfdcb987, 0x50000021, 0x6300
.long 0x641d0935, 0xfecba87, 0x500120, 0x3060
.long 0x641d0935, 0xfecba87, 0x5000012, 0x3600
.long 0x54e2a160, 0xfdcb987, 0x50002010, 0x6300
.long 0x76432d10, 0xfecba98, 0x150002, 0x3006
.long 0x54e2a160, 0xfdcb987, 0x510020, 0x3060
.long 0x54f3b271, 0xedca986, 0x5201000, 0x3600
.long 0x54f3b271, 0xedca986, 0x50100020, 0x6300
.long 0x650c3824, 0xfedba97, 0x50102, 0x3006
.long 0x650c3824, 0xfedba97, 0x510200, 0x3060
.long 0x641d0935, 0xfecba87, 0x5000021, 0x3600
.long 0x641d0935, 0xfecba87, 0x50010020, 0x6300
.long 0x76432d10, 0xfecba98, 0x50201, 0x3006
.long 0x54e2a160, 0xfdcb987, 0x251000, 0x3060
.long 0x54e2a160, 0xfdcb987, 0x5100002, 0x3600
.long 0x54f3b271, 0xedca986, 0x50200010, 0x6300
.long 0x54f3b271, 0xedca986, 0x250001, 0x3006
.long 0x54e2a160, 0xfdcb987, 0x5001020, 0x3600
.long 0x54e2a160, 0xfdcb987, 0x50002100, 0x6300
.long 0x54f3b271, 0xedca986, 0x250100, 0x3006
.long 0x7543e210, 0xfdcba98, 0x1502000, 0x3060
.long 0x54f3b271, 0xedca986, 0x5200010, 0x3600
.long 0x650c3824, 0xfedba97, 0x50000201, 0x6300
.long 0x650c3824, 0xfedba97, 0x15200, 0x3006
.long 0x641d0935, 0xfecba87, 0x500120, 0x3060
.long 0x641d0935, 0xfecba87, 0x5010200, 0x3600
.long 0x54e2a160, 0xfdcb987, 0x50100020, 0x6300
.long 0x54e2a160, 0xfdcb987, 0x52010, 0x3006
.long 0x7543e210, 0xfdcba98, 0x500021, 0x3060
.long 0x54f3b271, 0xedca986, 0x5100020, 0x3600
.long 0x54f3b271, 0xedca986, 0x50001020, 0x6300
.long 0x650c3824, 0xfedba97, 0x51200, 0x3006
.long 0x650c3824, 0xfedba97, 0x500120, 0x3060
.long 0x54f3b271, 0xedca986, 0x50000102, 0x6300
.long 0x54f3b271, 0xedca986, 0x50012, 0x3006
.long 0x650c3824, 0xfedba97, 0x500120, 0x3060
.long 0x6543f210, 0xedcba98, 0x15200000, 0x3600
.long 0x650c3824, 0xfedba97, 0x50001020, 0x6300
.long 0x641d0935, 0xfecba87, 0x15002, 0x3006
.long 0x641d0935, 0xfecba87, 0x500102, 0x3060
.long 0x54e2a160, 0xfdcb987, 0x5102000, 0x3600
.long 0x54e2a160, 0xfdcb987, 0x50201000, 0x6300
.long 0x54f3b271, 0xedca986, 0x150020, 0x3006
.long 0x54f3b271, 0xedca986, 0x501020, 0x3060
.long 0x6543f210, 0xedcba98, 0x25000010, 0x3600
.long 0x650c3824, 0xfedba97, 0x50000201, 0x6300
.long 0x650c3824, 0xfedba97, 0x15200, 0x3006
.long 0x641d0935, 0xfecba87, 0x501200, 0x3060
.long 0x641d0935, 0xfecba87, 0x5000201, 0x3600
.long 0x650c3824, 0xfedba97, 0x50210, 0x3006
.long 0x650c3824, 0xfedba97, 0x510002, 0x3060
.long 0x641d0935, 0xfecba87, 0x5000120, 0x3600
.long 0x76543218, 0xfedcba9, 0x25000010, 0x6300
.long 0x641d0935, 0xfecba87, 0x50210, 0x3006
.long 0x54e2a160, 0xfdcb987, 0x150002, 0x3060
.long 0x54e2a160, 0xfdcb987, 0x5200010, 0x3600
.long 0x54f3b271, 0xedca986, 0x50102000, 0x6300
.long 0x54f3b271, 0xedca986, 0x251000, 0x3006
.long 0x650c3824, 0xfedba97, 0x500120, 0x3060
.long 0x650c3824, 0xfedba97, 0x5000021, 0x3600
.long 0x76543218, 0xfedcba9, 0x15002000, 0x6300
.long 0x641d0935, 0xfecba87, 0x50021, 0x3006
.long 0x641d0935, 0xfecba87, 0x510200, 0x3060
.long 0x54e2a160, 0xfdcb987, 0x5201000, 0x3600
.long 0x54e2a160, 0xfdcb987, 0x50200001, 0x6300
.long 0x641d0935, 0xfecba87, 0x500102, 0x3060
.long 0x641d0935, 0xfecba87, 0x5020010, 0x3600
.long 0x54e2a160, 0xfdcb987, 0x50201000, 0x6300
.long 0x76543209, 0xfedcba8, 0x215000, 0x3006
.long 0x54e2a160, 0xfdcb987, 0x502010, 0x3060
.long 0x54f3b271, 0xedca986, 0x5001002, 0x3600
.long 0x54f3b271, 0xedca986, 0x50200001, 0x6300
.long 0x650c3824, 0xfedba97, 0x50120, 0x3006
.long 0x650c3824, 0xfedba97, 0x510002, 0x3060
.long 0x641d0935, 0xfecba87, 0x5020001, 0x3600
.long 0x641d0935, 0xfecba87, 0x50010200, 0x6300
.long 0x76543209, 0xfedcba8, 0x50102, 0x3006
.long 0x54e2a160, 0xfdcb987, 0x150020, 0x3060
.long 0x54e2a160, 0xfdcb987, 0x5000021, 0x3600
.long 0x54f3b271, 0xedca986, 0x50102000, 0x6300
.long 0x54f3b271, 0xedca986, 0x50012, 0x3006
.long 0x54e2a160, 0xfdcb987, 0x5002010, 0x3600
.long 0x54e2a160, 0xfdcb987, 0x50001020, 0x6300
.long 0x54f3b271, 0xedca986, 0x150002, 0x3006
.long 0x765431a0, 0xfedcb98, 0x500021, 0x3060
.long 0x54f3b271, 0xedca986, 0x5001020, 0x3600
.long 0x650c3824, 0xfedba97, 0x50020001, 0x6300
.long 0x650c3824, 0xfedba97, 0x15002, 0x3006
.long 0x641d0935, 0xfecba87, 0x520100, 0x3060
.long 0x641d0935, 0xfecba87, 0x5010020, 0x3600
.long 0x54e2a160, 0xfdcb987, 0x50002100, 0x6300
.long 0x54e2a160, 0xfdcb987, 0x150002, 0x3006
.long 0x765431a0, 0xfedcb98, 0x150020, 0x3060
.long 0x54f3b271, 0xedca986, 0x5000102, 0x3600
.long 0x54f3b271, 0xedca986, 0x50002010, 0x6300
.long 0x650c3824, 0xfedba97, 0x50102, 0x3006
.long 0x650c3824, 0xfedba97, 0x501002, 0x3060
.long 0x54f3b271, 0xedca986, 0x50102000, 0x6300
.long 0x54f3b271, 0xedca986, 0x250001, 0x3006
.long 0x650c3824, 0xfedba97, 0x520001, 0x3060
.long 0x765421b0, 0xfedca98, 0x1500020, 0x3600
.long 0x650c3824, 0xfedba97, 0x50000102, 0x6300
.long 0x641d0935, 0xfecba87, 0x51020, 0x3006
.long 0x641d0935, 0xfecba87, 0x510020, 0x3060
.long 0x54e2a160, 0xfdcb987, 0x5001002, 0x3600
.long 0x54e2a160, 0xfdcb987, 0x50102000, 0x6300
.long 0x54f3b271, 0xedca986, 0x51002, 0x3006
.long 0x54f3b271, 0xedca986, 0x502010, 0x3060
.long 0x765421b0, 0xfedca98, 0x5100002, 0x3600
.long 0x650c3824, 0xfedba97, 0x50020010, 0x6300
.long 0x650c3824, 0xfedba97, 0x15002, 0x3006
.long 0x641d0935, 0xfecba87, 0x500102, 0x3060
.long 0x641d0935, 0xfecba87, 0x5020010, 0x3600
.long 0x650c3824, 0xfedba97, 0x521000, 0x3006
.long 0x650c3824, 0xfedba97, 0x500021, 0x3060
.long 0x641d0935, 0xfecba87, 0x5000201, 0x3600
.long 0x76532c10, 0xfedba98, 0x15000200, 0x6300
.long 0x641d0935, 0xfecba87, 0x15002, 0x3006
.long 0x54e2a160, 0xfdcb987, 0x501020, 0x3060
.long 0x54e2a160, 0xfdcb987, 0x5000120, 0x3600
.long 0x54f3b271, 0xedca986, 0x50100020, 0x6300
.long 0x54f3b271, 0xedca986, 0x51002, 0x3006
.long 0x650c3824, 0xfedba97, 0x500102, 0x3060
.long 0x650c3824, 0xfedba97, 0x5000210, 0x3600
.long 0x76532c10, 0xfedba98, 0x25000100, 0x6300
.long 0x641d0935, 0xfecba87, 0x50102, 0x3006
.long 0x641d0935, 0xfecba87, 0x501002, 0x3060
.long 0x54e2a160, 0xfdcb987, 0x5002010, 0x3600
.long 0x54e2a160, 0xfdcb987, 0x50102000, 0x6300
.long 0x641d0935, 0xfecba87, 0x520001, 0x3060
.long 0x641d0935, 0xfecba87, 0x5010020, 0x3600
.long 0x54e2a160, 0xfdcb987, 0x50100020, 0x6300
.long 0x76432d10, 0xfecba98, 0x50201, 0x3006
.long 0x54e2a160, 0xfdcb987, 0x251000, 0x3060
.long 0x54f3b271, 0xedca986, 0x5002001, 0x3600
.long 0x54f3b271, 0xedca986, 0x50002010, 0x6300
.long 0x650c3824, 0xfedba97, 0x25100, 0x3006
.long 0x650c3824, 0xfedba97, 0x510020, 0x3060
.long 0x641d0935, 0xfecba87, 0x5000102, 0x3600
.long 0x641d0935, 0xfecba87, 0x50000012, 0x6300
.long 0x76432d10, 0xfecba98, 0x152000, 0x3006
.long 0x54e2a160, 0xfdcb987, 0x500012, 0x3060
.long 0x54e2a160, 0xfdcb987, 0x5210000, 0x3600
.long 0x54f3b271, 0xedca986, 0x50001020, 0x6300
.long 0x54f3b271, 0xedca986, 0x150020, 0x3006
.long 0x54e2a160, 0xfdcb987, 0x5200010, 0x3600
.long 0x54e2a160, 0xfdcb987, 0x50201000, 0x6300
.long 0x54f3b271, 0xedca986, 0x52100, 0x3006
.long 0x7543e210, 0xfdcba98, 0x520001, 0x3060
.long 0x54f3b271, 0xedca986, 0x5100002, 0x3600
.long 0x650c3824, 0xfedba97, 0x50000120, 0x6300
.long 0x650c3824, 0xfedba97, 0x521000, 0x3006
.long 0x641d0935, 0xfecba87, 0x500102, 0x3060
.long 0x641d0935, 0xfecba87, 0x5010002, 0x3600
.long 0x54e2a160, 0xfdcb987, 0x51200000, 0x6300
.long 0x54e2a160, 0xfdcb987, 0x150020, 0x3006
.long 0x7543e210, 0xfdcba98, 0x502010, 0x3060
.long 0x54f3b271, 0xedca986, 0x5002010, 0x3600
.long 0x54f3b271, 0xedca986, 0x50001002, 0x6300
.long 0x650c3824, 0xfedba97, 0x1025000, 0x3006
.long 0x650c3824, 0xfedba97, 0x510200, 0x3060
.long 0x54f3b271, 0xedca986, 0x50100020, 0x6300
.long 0x54f3b271, 0xedca986, 0x51020, 0x3006
.long 0x650c3824, 0xfedba97, 0x510200, 0x3060
.long 0x6543f210, 0xedcba98, 0x5102000, 0x3600
.long 0x650c3824, 0xfedba97, 0x15020000, 0x6300
.long 0x641d0935, 0xfecba87, 0x25100, 0x3006
.long 0x641d0935, 0xfecba87, 0x500210, 0x3060
.long 0x54e2a160, 0xfdcb987, 0x5201000, 0x3600
.long 0x54e2a160, 0xfdcb987, 0x50100002, 0x6300
.long 0x54f3b271, 0xedca986, 0x250001, 0x3006
.long 0x54f3b271, 0xedca986, 0x250010, 0x3060
.long 0x6543f210, 0xedcba98, 0x5002001, 0x3600
.long 0x650c3824, 0xfedba97, 0x50000012, 0x6300
.long 0x650c3824, 0xfedba97, 0x50120, 0x3006
.long 0x641d0935, 0xfecba87, 0x510020, 0x3060
.long 0x641d0935, 0xfecba87, 0x5000021, 0x3600
.fill 1, 4, 0
.size L_table, .-L_table
.section .rodata,"a"
.p2align 6
.amdhsa_kernel sequential_preLN__linear_kernel_hedgehog__moe_arch_mod__prompt_kernel
  .amdhsa_next_free_vgpr 256
  .amdhsa_next_free_sgpr 102
  .amdhsa_accum_offset 256
  .amdhsa_group_segment_fixed_size 0
  .amdhsa_kernarg_size 96
  .amdhsa_user_sgpr_count 2
  .amdhsa_user_sgpr_kernarg_segment_ptr 1
  .amdhsa_system_sgpr_workgroup_id_x 1
  .amdhsa_float_denorm_mode_32 3
.end_amdhsa_kernel
```

```asm
; @launch grid=(256,1,1) block=(512,1,1) lds=163840
.amdgcn_target "amdgcn-amd-amdhsa--gfx950"
.text
.globl sequential_preLN__linear_kernel_hedgehog__moe_arch_mod__prompt_kernel
.p2align 8
.type sequential_preLN__linear_kernel_hedgehog__moe_arch_mod__prompt_kernel,@function
sequential_preLN__linear_kernel_hedgehog__moe_arch_mod__prompt_kernel:
    s_cmp_ge_u32 s2, 256
    s_cbranch_scc1 L_end
    s_load_dwordx2 s[28:29], s[0:1], 0
    s_load_dwordx2 s[32:33], s[0:1], 8
    s_load_dwordx4 s[8:11], s[0:1], 16
    s_load_dwordx16 s[12:27], s[0:1], 32
    v_lshrrev_b32 v4, 6, v0
    v_and_b32 v1, 63, v0
    v_readfirstlane_b32 s79, v4
    s_and_b32 s76, s2, 7
    s_lshr_b32 s77, s2, 3
    s_and_b32 s60, s77, 15
    s_lshl_b32 s76, s76, 3
    s_bfe_u32 s77, s2, 0x10007
    s_lshl2_add_u32 s76, s77, s76
    s_mov_b32 s80, 0x654210b3
    s_mov_b32 s81, 0xfedca987
    s_lshr_b64 s[80:81], s[80:81], s76
    s_and_b32 s61, s80, 15
    s_and_b32 s62, s79, 3
    s_cmp_ge_u32 s79, 4
    s_cbranch_scc1 L_compute
    s_setprio 3
    s_getpc_b64 s[66:67]
L_pc:
    s_lshr_b32 s76, s2, 3
    s_lshl2_add_u32 s76, s76, s62
    s_mul_i32 s76, s76, 256
    v_lshl_add_u32 v91, v1, 7, s76
    s_mov_b64 exec, 3
    global_load_dword v27, v91, s[66:67]
    s_mov_b64 exec, -1
    s_add_u32 s84, s60, s2
    s_and_b32 s84, s84, 3
    s_and_b32 s76, s60, 7
    s_and_b32 s77, s61, 7
    s_cmp_eq_u32 s77, 3
    s_cselect_b32 s84, s76, s84
    v_lshrrev_b32 v4, 3, v1
    v_and_b32 v5, 7, v1
    v_lshrrev_b32_e64 v6, 4, v1
    s_lshl2_add_u32 s76, s60, s62
    s_lshl_b32 s76, s76, 16
    s_mul_i32 s70, s62, 10240
    v_xor_b32 v7, v5, v6
    v_lshlrev_b32 v7, 4, v7
    v_lshl_add_u32 v78, v4, 11, v7
    v_add_u32 v16, s76, v78
    v_xor_b32 v7, 64, v16
    v_add_u32 v17, 15360, v7
    v_add_u32 v18, 30720, v16
    v_add_u32 v19, 46080, v7
    s_mov_b32 s30, 4194304
    s_mov_b32 s31, 0x20000
    s_and_b32 s72, s84, 15
    s_mov_b32 m0, s70
    s_lshl_b32 s71, s72, 7
    s_waitcnt lgkmcnt(0)
    buffer_load_dwordx4 v16, s[28:31], s71 offen offset:0 lds
    s_mul_i32 s72, s72, 393216
    s_lshr_b64 s[84:85], s[84:85], 4
    buffer_load_dwordx4 v17, s[28:31], s71 offen offset:1024 lds
    buffer_load_dwordx4 v18, s[28:31], s71 offen offset:2048 lds
    buffer_load_dwordx4 v19, s[28:31], s71 offen offset:3072 lds
    v_and_b32 v6, 1, v6
    v_lshlrev_b32 v6, 2, v6
    v_xor_b32 v8, v5, v6
    v_lshlrev_b32 v8, 4, v8
    s_lshl_b32 s76, s61, 7
    s_mul_i32 s77, s62, 98304
    s_add_u32 s76, s76, s77
    v_mul_u32_u24 v7, 6144, v4
    v_add3_u32 v20, v7, v8, s76
    v_xor_b32 v7, 32, v20
    s_mov_b32 s34, 6291456
    s_mov_b32 s35, 0x20000
    s_add_u32 m0, s70, 4096
    s_nop 0
    buffer_load_dwordx4 v20, s[32:35], s72 offen offset:0 lds
    v_add_u32 v21, 48128, v7
    buffer_load_dwordx4 v21, s[32:35], s72 offen offset:1024 lds
    v_add_u32 v22, 0, v20
    buffer_load_dwordx4 v22, s[32:35], s72 offen offset:2048 lds
    v_add_u32 v23, 48128, v7
    buffer_load_dwordx4 v23, s[32:35], s72 offen offset:3072 lds
    v_add_u32 v24, 4096, v20
    s_add_u32 m0, s70, 8192
    s_nop 0
    buffer_load_dwordx4 v24, s[32:35], s72 offen offset:0 lds
    v_add_u32 v25, 52224, v7
    buffer_load_dwordx4 v25, s[32:35], s72 offen offset:1024 lds
    s_add_u32 s70, s70, 40960
    s_cmp_ge_u32 s70, 122880
    s_cselect_b32 s76, 122880, 0
    s_sub_u32 s70, s70, s76
    s_lshl_b32 s76, s60, 8
    s_lshl_b32 s77, s61, 4
    s_add_u32 s76, s76, s77
    s_add_u32 s76, s76, 29056
    s_load_dwordx4 s[84:87], s[66:67], s76
    v_lshl_add_u32 v26, v4, 11, v8
    v_xor_b32 v79, 64, v78
    s_and_b32 s63, s62, 1
    s_lshr_b32 s64, s62, 1
    s_lshl_b32 s73, s60, 4
    s_add_u32 s73, s73, s61
    s_mul_i32 s73, s73, 28800
    s_add_u32 s76, s2, 7
    s_and_b32 s76, s76, 7
    s_bfe_u32 s77, s2, 0x10003
    s_lshl1_add_u32 s97, s76, s77
    s_lshr_b32 s98, s2, 4
    s_lshl_b32 s99, s97, 4
    s_add_u32 s99, s99, s98
    s_mul_i32 s99, s99, 9344
    s_add_u32 s99, s99, 8388608
    s_lshr_b32 s65, s97, 1
    s_lshl_b32 s76, s97, 3
    s_add_u32 s65, s65, s76
    s_mul_i32 s76, s98, 4
    s_add_u32 s65, s65, s76
    s_and_b32 s65, s65, 15
    s_mov_b32 s89, 0x3f803f80
    s_mov_b32 s90, 0xffff0000
    v_and_b32 v2, 31, v1
    v_lshrrev_b32 v3, 5, v1
    v_lshlrev_b32 v12, 4, v1
    v_lshrrev_b32 v4, 3, v1
    v_mul_u32_u24 v13, 460800, v4
    v_and_b32_e64 v4, 7, v1
    v_lshl_add_u32 v13, v4, 4, v13
    s_lshl_b32 s76, s98, 7
    s_lshl_b32 s77, s62, 15
    s_add_u32 s76, s76, s77
    v_add_u32_e64 v26, s76, v26
    s_mov_b32 s40, s26
    s_and_b32 s41, s27, 0xffff
    s_mov_b32 s42, 33554432
    s_mov_b32 s43, 0x20000
    s_mov_b32 s56, s8
    s_and_b32 s57, s9, 0xffff
    s_mov_b32 s58, 65536
    s_mov_b32 s59, 0x20000
    v_mov_b32 v28, -1
    v_mov_b32 v29, -1
    v_mov_b32 v30, -1
    v_mov_b32_e64 v31, -1
    s_waitcnt lgkmcnt(0)
    s_and_b32 s72, s84, 15
    s_mov_b32 m0, s70
    s_lshl_b32 s71, s72, 7
    buffer_load_dwordx4 v16, s[28:31], s71 offen offset:0 lds
    s_mul_i32 s72, s72, 393216
    s_lshr_b64 s[84:85], s[84:85], 4
    buffer_load_dwordx4 v17, s[28:31], s71 offen offset:1024 lds
    buffer_load_dwordx4 v18, s[28:31], s71 offen offset:2048 lds
    buffer_load_dwordx4 v19, s[28:31], s71 offen offset:3072 lds
    s_add_u32 m0, s70, 4096
    s_nop 0
    buffer_load_dwordx4 v20, s[32:35], s72 offen offset:0 lds
    buffer_load_dwordx4 v21, s[32:35], s72 offen offset:1024 lds
    buffer_load_dwordx4 v22, s[32:35], s72 offen offset:2048 lds
    buffer_load_dwordx4 v23, s[32:35], s72 offen offset:3072 lds
    s_add_u32 m0, s70, 8192
    s_nop 0
    buffer_load_dwordx4 v24, s[32:35], s72 offen offset:0 lds
    buffer_load_dwordx4 v25, s[32:35], s72 offen offset:1024 lds
    s_add_u32 s70, s70, 40960
    s_cmp_ge_u32 s70, 122880
    s_cselect_b32 s76, 122880, 0
    s_sub_u32 s70, s70, s76
    s_lshl_b32 s77, s62, 10
    s_add_u32 s76, s77, s73
    buffer_store_dwordx4 v[28:31], v12, s[40:43], s76 offen sc1
    s_lshl_b32 s76, s61, 12
    s_add_u32 s76, s76, s77
    s_add_u32 m0, s77, 122880
    s_nop 0
    buffer_load_dwordx4 v12, s[56:59], s76 offen lds
    v_mov_b32 v4, 13631488
    buffer_load_dwordx2 v[88:89], v4, s[40:43], 0 offen
    s_setprio 0
    s_waitcnt vmcnt(13)
    s_barrier
    s_and_b32 s72, s84, 15
    s_mov_b32 m0, s70
    s_lshl_b32 s71, s72, 7
    buffer_load_dwordx4 v16, s[28:31], s71 offen offset:0 lds
    s_mul_i32 s72, s72, 393216
    s_lshr_b64 s[84:85], s[84:85], 4
    buffer_load_dwordx4 v17, s[28:31], s71 offen offset:1024 lds
    buffer_load_dwordx4 v18, s[28:31], s71 offen offset:2048 lds
    buffer_load_dwordx4 v19, s[28:31], s71 offen offset:3072 lds
    s_add_u32 m0, s70, 4096
    s_nop 0
    buffer_load_dwordx4 v20, s[32:35], s72 offen offset:0 lds
    buffer_load_dwordx4 v21, s[32:35], s72 offen offset:1024 lds
    buffer_load_dwordx4 v22, s[32:35], s72 offen offset:2048 lds
    buffer_load_dwordx4 v23, s[32:35], s72 offen offset:3072 lds
    s_add_u32 m0, s70, 8192
    s_nop 0
    buffer_load_dwordx4 v24, s[32:35], s72 offen offset:0 lds
    buffer_load_dwordx4 v25, s[32:35], s72 offen offset:1024 lds
    s_add_u32 s70, s70, 40960
    s_cmp_ge_u32 s70, 122880
    s_cselect_b32 s76, 122880, 0
    s_sub_u32 s70, s70, s76
    s_mov_b32 s36, s10
    s_and_b32 s37, s11, 0xffff
    s_mov_b32 s38, 2097152
    s_mov_b32 s39, 0x20000
    s_mov_b32 s44, s22
    s_and_b32 s45, s23, 0xffff
    s_mov_b32 s46, 4194304
    s_mov_b32 s47, 0x20000
    s_mov_b32 s52, s20
    s_and_b32 s53, s21, 0xffff
    s_mov_b32 s54, 7340032
    s_mov_b32 s55, 0x20000
    s_cmp_eq_u32 s64, 0
    s_cselect_b32 s48, s16, s18
    s_cselect_b32 s49, s17, s19
    s_and_b32 s49, s49, 0xffff
    s_mov_b32 s51, 0x20000
    s_cmp_lt_u32 s97, 14
    s_cselect_b32 s50, 7340032, 0
    s_cselect_b32 s54, 7340032, 0
    v_bfe_u32 v4, v2, 1, 3
    v_xor_b32 v4, v4, v3
    v_lshlrev_b32 v4, 4, v4
    v_lshl_add_u32 v72, v2, 7, v4
    v_bfe_u32 v4, v1, 2, 2
    v_lshl_add_u32 v5, v3, 3, v4
    v_lshlrev_b32 v5, 7, v5
    v_lshrrev_b32 v4, 1, v4
    v_xor_b32_e64 v4, s64, v4
    v_lshl_add_u32 v5, v4, 6, v5
    v_bfe_u32 v4, v1, 4, 1
    v_xor_b32_e64 v4, v4, v3
    v_lshl_add_u32 v5, v4, 5, v5
    v_and_b32_e64 v4, 3, v1
    v_lshl_add_u32 v5, v4, 3, v5
    s_mul_i32 s76, s62, 10240
    s_sub_u32 s76, 4096, s76
    v_add_u32_e64 v73, s76, v5
    v_mul_u32_u24 v74, 28800, v3
    v_lshl_add_u32 v74, v2, 3, v74
    v_lshrrev_b32 v4, 4, v1
    v_and_b32 v5, 15, v1
    v_mul_u32_u24 v75, 460800, v4
    v_lshl_add_u32 v75, v5, 4, v75
    v_lshrrev_b32 v4, 4, v1
    v_and_b32 v5, 15, v1
    v_mul_u32_u24 v76, 114688, v4
    v_lshl_add_u32 v76, v5, 4, v76
    v_lshlrev_b32_e64 v77, 4, v2
    v_lshl_add_u32 v77, v3, 11, v77
    s_mul_i32 s75, s98, 458752
    s_lshl_b32 s77, s97, 9
    s_add_u32 s75, s75, s77
    s_lshl_b32 s77, s63, 8
    s_add_u32 s75, s75, s77
    s_lshl_b32 s96, s97, 19
    s_lshl_b32 s77, s98, 15
    s_add_u32 s96, s96, s77
    s_lshl_b32 s77, s62, 9
    s_add_u32 s96, s96, s77
    s_mov_b32 s68, 1
    s_getreg_b32 s101, hwreg(HW_REG_XCC_ID, 0, 4)
    s_lshl_b32 s76, s61, 8
    s_add_u32 s76, s76, 12582912
    s_lshl_b32 s77, s60, 8
    s_add_u32 s77, s77, 12586752
    s_lshr_b32 s78, s97, 1
    s_lshl_b32 s78, s78, 9
    s_add_u32 s78, s78, 12590592
    v_mov_b32 v4, s76
    v_mov_b32 v5, s77
    v_mov_b32 v6, s78
    v_cmp_gt_u32 vcc, 16, v1
    s_nop 1
    v_cndmask_b32 v4, v5, v4, vcc
    v_cmp_gt_u32 vcc, 32, v1
    s_nop 1
    v_cndmask_b32 v4, v6, v4, vcc
    v_add_u32 v90, v4, v12
    s_waitcnt vmcnt(10)
    s_barrier
L_hloop:
    s_and_b32 s77, s86, 15
    s_cbranch_scc1 L_event
L_evret:
    s_and_b32 s72, s84, 15
    s_mov_b32 m0, s70
    s_lshl_b32 s71, s72, 7
    buffer_load_dwordx4 v16, s[28:31], s71 offen offset:0 lds
    s_mul_i32 s72, s72, 393216
    s_lshr_b64 s[84:85], s[84:85], 4
    buffer_load_dwordx4 v17, s[28:31], s71 offen offset:1024 lds
    buffer_load_dwordx4 v18, s[28:31], s71 offen offset:2048 lds
    buffer_load_dwordx4 v19, s[28:31], s71 offen offset:3072 lds
    s_add_u32 m0, s70, 4096
    s_nop 0
    buffer_load_dwordx4 v20, s[32:35], s72 offen offset:0 lds
    buffer_load_dwordx4 v21, s[32:35], s72 offen offset:1024 lds
    buffer_load_dwordx4 v22, s[32:35], s72 offen offset:2048 lds
    buffer_load_dwordx4 v23, s[32:35], s72 offen offset:3072 lds
    s_add_u32 m0, s70, 8192
    s_nop 0
    buffer_load_dwordx4 v24, s[32:35], s72 offen offset:0 lds
    buffer_load_dwordx4 v25, s[32:35], s72 offen offset:1024 lds
    s_add_u32 s70, s70, 40960
    s_cmp_ge_u32 s70, 122880
    s_cselect_b32 s76, 122880, 0
    s_sub_u32 s70, s70, s76
    s_waitcnt vmcnt(10)
L_hbar:
    s_lshr_b64 s[86:87], s[86:87], 4
    s_add_u32 s68, s68, 1
    s_cmp_lt_u32 s68, 14
    s_barrier
    s_cbranch_scc1 L_hloop
    v_add_co_u32 v88, vcc, 1, v88
    s_nop 1
    v_addc_co_u32 v89, vcc, 0, v89, vcc
    v_cmp_ne_u64 vcc, v[92:93], v[88:89]
    s_nop 0
    s_cbranch_vccz L_hello_ok_1
    s_mov_b32 s88, 0
L_spin_2:
    buffer_load_dwordx4 v[92:95], v90, s[40:43], 0 offen sc1
    s_waitcnt vmcnt(0)
    v_cmp_ne_u64 vcc, v[92:93], v[88:89]
    s_nop 0
    s_cbranch_vccz L_hello_ok_1
    s_add_u32 s88, s88, 1
    s_cmp_lt_u32 s88, 65536
    s_cbranch_scc1 L_spin_2
L_hello_ok_1:
    v_cmp_ne_u32_e64 vcc, s101, v94
    s_nop 0
    s_and_b32 s76, vcc_lo, 0xffff
    s_cselect_b32 s100, 0, 1
    s_cmp_eq_u32 vcc_hi, 0
    s_cselect_b32 s76, 2, 0
    s_or_b32 s100, s100, s76
    v_mov_b32 v4, s100
    v_mov_b32 v5, 0
    ds_write_b32 v5, v4 offset:53248
    s_lshl_b32 s81, s62, 8
    s_mul_i32 s80, s60, 460800
    s_add_u32 s80, s80, s81
    buffer_load_dwordx2 v[32:33], v74, s[40:43], s80 offen offset:0 sc1
    s_add_u32 s80, s80, 57600
    buffer_load_dwordx2 v[34:35], v74, s[40:43], s80 offen offset:0 sc1
    s_add_u32 s80, s80, 57600
    buffer_load_dwordx2 v[36:37], v74, s[40:43], s80 offen offset:0 sc1
    s_add_u32 s80, s80, 57600
    buffer_load_dwordx2 v[38:39], v74, s[40:43], s80 offen offset:0 sc1
    s_add_u32 s80, s80, 57600
    buffer_load_dwordx2 v[40:41], v74, s[40:43], s80 offen offset:0 sc1
    s_add_u32 s80, s80, 57600
    buffer_load_dwordx2 v[42:43], v74, s[40:43], s80 offen offset:0 sc1
    s_add_u32 s80, s80, 57600
    buffer_load_dwordx2 v[44:45], v74, s[40:43], s80 offen offset:0 sc1
    s_add_u32 s80, s80, 57600
    buffer_load_dwordx2 v[46:47], v74, s[40:43], s80 offen offset:0 sc1
    s_mul_i32 s80, s61, 28800
    s_add_u32 s80, s80, s81
    buffer_load_dwordx4 v[48:51], v75, s[40:43], s80 offen offset:1024 sc1
    s_add_u32 s80, s80, 1843200
    buffer_load_dwordx4 v[52:55], v75, s[40:43], s80 offen offset:1024 sc1
    s_add_u32 s80, s80, 1843200
    buffer_load_dwordx4 v[56:59], v75, s[40:43], s80 offen offset:1024 sc1
    s_add_u32 s80, s80, 1843200
    buffer_load_dwordx4 v[60:63], v75, s[40:43], s80 offen offset:1024 sc1
    v_bfe_u32 v10, v1, 4, 1
    v_lshl_add_u32 v10, v10, 1, v3
    v_min_u32 v10, 2, v10
    v_and_b32 v7, 15, v1
    v_lshlrev_b32_e64 v7, 3, v7
    s_lshl_b32 s76, s62, 7
    v_lshl_add_u32 v10, v10, 9, v7
    v_add_u32_e64 v64, s76, v10
    v_lshl_add_u32 v65, v2, 3, s81
    s_waitcnt vmcnt(12)
    s_barrier
    s_mul_i32 s78, s62, 2048
    s_add_u32 s78, s78, s73
    s_add_u32 s78, s78, 4096
    v_lshlrev_b32 v11, 7, v1
    s_mov_b64 exec, 65535
    buffer_load_dword v27, v11, s[40:43], s78 offen sc1
    s_mov_b64 exec, -1
    buffer_load_dwordx4 v[152:155], v76, s[48:51], s75 offen nt
    s_add_u32 s75, s75, 7168
    buffer_load_dwordx4 v[156:159], v76, s[48:51], s75 offen nt
    s_add_u32 s75, s75, 7168
    s_add_u32 s78, s65, 0
    s_and_b32 s78, s78, 15
    s_lshl_b32 s78, s78, 17
    s_lshl_b32 s79, s62, 11
    s_add_u32 m0, s79, 57344
    s_add_u32 s79, s78, 15360
    buffer_load_dwordx4 v26, s[36:39], s78 offen lds
    buffer_load_dwordx4 v26, s[36:39], s79 offen offset:1024 lds
    s_add_u32 s78, s65, 1
    s_and_b32 s78, s78, 15
    s_lshl_b32 s78, s78, 17
    s_lshl_b32 s79, s62, 11
    s_add_u32 m0, s79, 65536
    s_add_u32 s79, s78, 15360
    buffer_load_dwordx4 v26, s[36:39], s78 offen lds
    buffer_load_dwordx4 v26, s[36:39], s79 offen offset:1024 lds
    s_setprio 3
    s_mov_b32 s88, 0
    s_waitcnt vmcnt(11)
    s_branch L_g1first_3
L_g1_4:
    s_mul_i32 s80, s60, 460800
    s_add_u32 s80, s80, s81
    buffer_load_dwordx2 v[32:33], v74, s[40:43], s80 offen offset:0 sc1
    s_add_u32 s80, s80, 57600
    buffer_load_dwordx2 v[34:35], v74, s[40:43], s80 offen offset:0 sc1
    s_add_u32 s80, s80, 57600
    buffer_load_dwordx2 v[36:37], v74, s[40:43], s80 offen offset:0 sc1
    s_add_u32 s80, s80, 57600
    buffer_load_dwordx2 v[38:39], v74, s[40:43], s80 offen offset:0 sc1
    s_add_u32 s80, s80, 57600
    buffer_load_dwordx2 v[40:41], v74, s[40:43], s80 offen offset:0 sc1
    s_add_u32 s80, s80, 57600
    buffer_load_dwordx2 v[42:43], v74, s[40:43], s80 offen offset:0 sc1
    s_add_u32 s80, s80, 57600
    buffer_load_dwordx2 v[44:45], v74, s[40:43], s80 offen offset:0 sc1
    s_add_u32 s80, s80, 57600
    buffer_load_dwordx2 v[46:47], v74, s[40:43], s80 offen offset:0 sc1
    s_waitcnt vmcnt(0)
L_g1first_3:
    v_max3_u32 v4, v32, v34, v36
    v_max3_u32 v4, v4, v38, v40
    v_max3_u32 v4, v4, v42, v44
    v_max_u32 v4, v4, v46
    v_cmp_eq_u32 vcc, -1, v4
    s_nop 0
    s_cbranch_vccz L_ok_5
    s_add_u32 s88, s88, 1
    s_cmp_lt_u32 s88, 65536
    s_cbranch_scc1 L_g1_4
L_ok_5:
    v_add_f32 v32, v32, v40
    v_add_f32 v33, v33, v41
    v_add_f32 v34, v34, v42
    v_add_f32 v35, v35, v43
    v_add_f32 v36, v36, v44
    v_add_f32 v37, v37, v45
    v_add_f32 v38, v38, v46
    v_add_f32 v39, v39, v47
    v_add_f32 v32, v32, v36
    v_add_f32 v33, v33, v37
    v_add_f32 v34, v34, v38
    v_add_f32 v35, v35, v39
    v_add_f32 v32, v32, v34
    v_add_f32 v33, v33, v35
    v_mov_b32 v5, v32
    v_mov_b32_e64 v6, v33
    s_add_u32 s78, s65, 2
    s_and_b32 s78, s78, 15
    s_lshl_b32 s78, s78, 17
    s_lshl_b32 s79, s62, 11
    s_add_u32 m0, s79, 73728
    s_add_u32 s79, s78, 15360
    buffer_load_dwordx4 v26, s[36:39], s78 offen lds
    buffer_load_dwordx4 v26, s[36:39], s79 offen offset:1024 lds
    v_permlane32_swap_b32 v32, v5
    v_permlane32_swap_b32 v33, v6
    v_add_f32 v32, v32, v5
    v_add_f32 v33, v33, v6
    v_mul_f32 v32, 0x3a800000, v32
    v_mul_f32 v33, 0x3a800000, v33
    v_fma_f32 v7, -v32, v32, v33
    v_max_f32_e64 v7, 0, v7
    v_cvt_pk_bf16_f32 v5, v32, v32
    v_and_b32_e64 v5, s90, v5
    v_cvt_pk_bf16_f32 v7, v7, v7
    v_and_b32_e64 v7, s90, v7
    v_add_f32 v7, 0x3727c5ac, v7
    v_cvt_pk_bf16_f32 v7, v7, v7
    v_and_b32 v7, s90, v7
    v_sqrt_f32_e64 v7, v7
    s_nop 0
    v_cvt_pk_bf16_f32 v7, v7, v7
    v_and_b32 v7, s90, v7
    v_rcp_f32 v9, v7
    v_xor_b32 v5, 0x80000000, v5
    v_cvt_pk_bf16_f32 v8, v5, v5
    ds_write_b64 v65, v[8:9] offset:49152
    s_mov_b32 s88, 0
    s_waitcnt vmcnt(9)
    s_branch L_g1first_6
L_g1_7:
    s_mul_i32 s80, s61, 28800
    s_add_u32 s80, s80, s81
    buffer_load_dwordx4 v[48:51], v75, s[40:43], s80 offen offset:1024 sc1
    s_add_u32 s80, s80, 1843200
    buffer_load_dwordx4 v[52:55], v75, s[40:43], s80 offen offset:1024 sc1
    s_add_u32 s80, s80, 1843200
    buffer_load_dwordx4 v[56:59], v75, s[40:43], s80 offen offset:1024 sc1
    s_add_u32 s80, s80, 1843200
    buffer_load_dwordx4 v[60:63], v75, s[40:43], s80 offen offset:1024 sc1
    s_waitcnt vmcnt(0)
L_g1first_6:
    v_max3_u32 v4, v48, v50, v52
    v_max3_u32 v4, v4, v54, v56
    v_max3_u32 v4, v4, v58, v60
    v_max_u32 v4, v4, v62
    v_cmp_eq_u32 vcc, -1, v4
    s_nop 0
    s_cbranch_vccz L_ok_8
    s_add_u32 s88, s88, 1
    s_cmp_lt_u32 s88, 65536
    s_cbranch_scc1 L_g1_7
L_ok_8:
    v_add_f32 v48, v48, v56
    v_add_f32 v49, v49, v57
    v_add_f32 v50, v50, v58
    v_add_f32 v51, v51, v59
    v_add_f32 v52, v52, v60
    v_add_f32 v53, v53, v61
    v_add_f32 v54, v54, v62
    v_add_f32 v55, v55, v63
    v_add_f32 v48, v48, v52
    v_add_f32 v49, v49, v53
    v_add_f32 v50, v50, v54
    v_add_f32 v51, v51, v55
    v_add_f32 v49, v49, v51
    v_mov_b32 v51, v49
    v_permlane32_swap_b32 v48, v50
    s_nop 0
    v_permlane32_swap_b32 v49, v51
    v_add_f32 v48, v48, v50
    v_add_f32 v49, v49, v51
    s_nop 1
    v_permlane16_swap_b32 v48, v49
    v_add_f32_e64 v48, v48, v49
    v_cvt_pk_bf16_f32 v49, v48, v48
    v_and_b32 v49, s90, v49
    v_sub_f32 v49, v48, v49
    v_cvt_pk_bf16_f32 v50, v48, v49
    v_and_b32 v51, s90, v50
    v_sub_f32 v49, v49, v51
    v_cvt_pk_bf16_f32 v51, v49, 0
    ds_write_b64 v64, v[50:51] offset:50176
    s_setprio 0
    s_waitcnt lgkmcnt(0)
    s_barrier
    s_add_u32 s78, s65, 3
    s_and_b32 s78, s78, 15
    s_lshl_b32 s78, s78, 17
    s_lshl_b32 s79, s62, 11
    s_add_u32 m0, s79, 81920
    s_add_u32 s79, s78, 15360
    buffer_load_dwordx4 v26, s[36:39], s78 offen lds
    buffer_load_dwordx4 v26, s[36:39], s79 offen offset:1024 lds
    s_add_u32 s78, s65, 4
    s_and_b32 s78, s78, 15
    s_lshl_b32 s78, s78, 17
    s_lshl_b32 s79, s62, 11
    s_add_u32 m0, s79, 90112
    s_add_u32 s79, s78, 15360
    buffer_load_dwordx4 v26, s[36:39], s78 offen lds
    buffer_load_dwordx4 v26, s[36:39], s79 offen offset:1024 lds
    s_lshl_b32 s78, s62, 11
    s_add_u32 s79, s78, s73
    s_add_u32 s79, s79, 4096
    s_bitcmp1_b32 s100, 0
    s_cbranch_scc1 L_loc_9
    buffer_store_dwordx4 v[28:31], v12, s[40:43], s79 offen offset:0 sc1
    buffer_store_dwordx4 v[28:31], v12, s[40:43], s79 offen offset:1024 sc1
    s_branch L_pubd_10
L_loc_9:
    buffer_store_dwordx4 v[28:31], v12, s[40:43], s79 offen offset:0
    buffer_store_dwordx4 v[28:31], v12, s[40:43], s79 offen offset:1024
L_pubd_10:
    s_add_u32 s79, s78, s99
    s_bitcmp1_b32 s100, 1
    s_cbranch_scc1 L_loc_11
    buffer_store_dwordx4 v[28:31], v12, s[40:43], s79 offen offset:1024 sc1
    buffer_store_dwordx4 v[28:31], v12, s[40:43], s79 offen offset:2048 sc1
    s_branch L_pubd_12
L_loc_11:
    buffer_store_dwordx4 v[28:31], v12, s[40:43], s79 offen offset:1024
    buffer_store_dwordx4 v[28:31], v12, s[40:43], s79 offen offset:2048
L_pubd_12:
    s_lshl_b32 s79, s62, 8
    s_add_u32 s79, s79, s99
    s_mov_b64 exec, 0xffff
    buffer_store_dwordx4 v[28:31], v12, s[40:43], s79 offen sc1
    s_mov_b64 exec, -1
    s_add_u32 s78, s65, 5
    s_and_b32 s78, s78, 15
    s_lshl_b32 s78, s78, 17
    s_lshl_b32 s79, s62, 11
    s_add_u32 m0, s79, 98304
    s_add_u32 s79, s78, 15360
    buffer_load_dwordx4 v26, s[36:39], s78 offen lds
    buffer_load_dwordx4 v26, s[36:39], s79 offen offset:1024 lds
    s_add_u32 s78, s65, 6
    s_and_b32 s78, s78, 15
    s_lshl_b32 s78, s78, 17
    s_lshl_b32 s79, s62, 11
    s_add_u32 m0, s79, 106496
    s_add_u32 s79, s78, 15360
    buffer_load_dwordx4 v26, s[36:39], s78 offen lds
    buffer_load_dwordx4 v26, s[36:39], s79 offen offset:1024 lds
    s_add_u32 s78, s65, 7
    s_and_b32 s78, s78, 15
    s_lshl_b32 s78, s78, 17
    s_lshl_b32 s79, s62, 11
    s_add_u32 m0, s79, 114688
    s_add_u32 s79, s78, 15360
    buffer_load_dwordx4 v26, s[36:39], s78 offen lds
    buffer_load_dwordx4 v26, s[36:39], s79 offen offset:1024 lds
    s_mul_i32 s78, s62, 384
    s_add_u32 s78, s78, s73
    s_add_u32 s78, s78, 2048
    v_lshlrev_b32 v11, 7, v1
    s_mov_b64 exec, 7
    buffer_load_dword v27, v11, s[40:43], s78 offen sc1
    s_mov_b64 exec, -1
    s_waitcnt vmcnt(7)
    s_lshl_b32 s76, s62, 2
    s_add_u32 s76, s76, s73
    v_mov_b32 v4, 0
    s_mov_b64 exec, 1
    s_bitcmp1_b32 s100, 0
    s_cbranch_scc1 L_loc_13
    buffer_store_dword v4, v4, s[40:43], s76 offen offset:2560 sc1
    s_branch L_pubd_14
L_loc_13:
    buffer_store_dword v4, v4, s[40:43], s76 offen offset:2560
L_pubd_14:
    s_mov_b64 exec, -1
    s_add_u32 s78, s65, 8
    s_and_b32 s78, s78, 15
    s_lshl_b32 s78, s78, 17
    s_lshl_b32 s79, s62, 11
    s_add_u32 m0, s79, 122880
    s_add_u32 s79, s78, 15360
    buffer_load_dwordx4 v26, s[36:39], s78 offen lds
    buffer_load_dwordx4 v26, s[36:39], s79 offen offset:1024 lds
    s_add_u32 s78, s65, 9
    s_and_b32 s78, s78, 15
    s_lshl_b32 s78, s78, 17
    s_lshl_b32 s79, s62, 11
    s_add_u32 m0, s79, 131072
    s_add_u32 s79, s78, 15360
    buffer_load_dwordx4 v26, s[36:39], s78 offen lds
    buffer_load_dwordx4 v26, s[36:39], s79 offen offset:1024 lds
    s_add_u32 s78, s65, 10
    s_and_b32 s78, s78, 15
    s_lshl_b32 s78, s78, 17
    s_lshl_b32 s79, s62, 11
    s_add_u32 m0, s79, 139264
    s_add_u32 s79, s78, 15360
    buffer_load_dwordx4 v26, s[36:39], s78 offen lds
    buffer_load_dwordx4 v26, s[36:39], s79 offen offset:1024 lds
    v_and_b32_e64 v65, 15, v1
    v_mul_u32_u24 v65, 460800, v65
    s_mul_i32 s80, s61, 28800
    s_lshl_b32 s82, s62, 2
    s_add_u32 s82, s82, s80
    v_bfe_u32 v4, v1, 4, 1
    v_lshl_add_u32 v4, v4, 1, v3
    s_lshl_b32 s77, s62, 6
    v_lshl_add_u32 v66, v4, 1, s77
    v_bfe_u32 v4, v1, 2, 1
    v_lshl_add_u32 v66, v4, 5, v66
    v_bfe_u32 v4, v1, 0, 1
    v_lshl_add_u32 v66, v4, 4, v66
    v_bfe_u32 v4, v1, 1, 1
    v_lshl_add_u32 v66, v4, 3, v66
    s_lshl_b32 s83, s62, 7
    s_add_u32 s81, s83, s80
    s_add_u32 s68, s81, 3686400
    s_add_u32 s83, s83, s73
    v_and_b32 v4, 7, v1
    v_lshrrev_b32 v5, 4, v1
    v_lshlrev_b32_e64 v5, 2, v5
    v_lshl_add_u32 v67, v4, 4, v5
    s_barrier
    s_add_u32 s78, s65, 11
    s_and_b32 s78, s78, 15
    s_lshl_b32 s78, s78, 17
    s_lshl_b32 s79, s62, 11
    s_add_u32 m0, s79, 147456
    s_add_u32 s79, s78, 15360
    buffer_load_dwordx4 v26, s[36:39], s78 offen lds
    buffer_load_dwordx4 v26, s[36:39], s79 offen offset:1024 lds
    s_add_u32 s78, s65, 12
    s_and_b32 s78, s78, 15
    s_lshl_b32 s78, s78, 17
    s_lshl_b32 s79, s62, 11
    s_add_u32 m0, s79, 155648
    s_add_u32 s79, s78, 15360
    buffer_load_dwordx4 v26, s[36:39], s78 offen lds
    buffer_load_dwordx4 v26, s[36:39], s79 offen offset:1024 lds
    buffer_load_dword v64, v65, s[40:43], s82 offen offset:2560 sc1
    s_barrier
    s_setprio 3
    v_mov_b32 v4, s89
    v_lshlrev_b32_e64 v5, 2, v1
    ds_write_b32 v5, v4 offset:24832
    v_mov_b32 v70, 0
    v_mov_b32 v71, 0
    ds_write_b64 v70, v[70:71] offset:25984
    s_mov_b32 s88, 0
    s_branch L_p2first_15
L_p2_16:
    buffer_load_dword v64, v65, s[40:43], s82 offen offset:2560 sc1
L_p2first_15:
    s_waitcnt vmcnt(0)
    v_cmp_eq_u32_e64 vcc, -1, v64
    s_nop 0
    s_cbranch_vccz L_ok_17
    s_add_u32 s88, s88, 1
    s_cmp_lt_u32 s88, 65536
    s_cbranch_scc1 L_p2_16
L_ok_17:
    s_add_u32 s78, s65, 13
    s_and_b32 s78, s78, 15
    s_lshl_b32 s78, s78, 17
    s_lshl_b32 s79, s62, 11
    s_add_u32 m0, s79, 32768
    s_add_u32 s79, s78, 15360
    buffer_load_dwordx4 v26, s[36:39], s78 offen lds
    buffer_load_dwordx4 v26, s[36:39], s79 offen offset:1024 lds
    s_add_u32 s78, s65, 14
    s_and_b32 s78, s78, 15
    s_lshl_b32 s78, s78, 17
    s_lshl_b32 s79, s62, 11
    s_add_u32 m0, s79, 40960
    s_add_u32 s79, s78, 15360
    buffer_load_dwordx4 v26, s[36:39], s78 offen lds
    buffer_load_dwordx4 v26, s[36:39], s79 offen offset:1024 lds
    s_add_u32 s78, s65, 15
    s_and_b32 s78, s78, 15
    s_lshl_b32 s78, s78, 17
    s_lshl_b32 s79, s62, 11
    s_add_u32 m0, s79, 49152
    s_add_u32 s79, s78, 15360
    buffer_load_dwordx4 v26, s[36:39], s78 offen lds
    buffer_load_dwordx4 v26, s[36:39], s79 offen offset:1024 lds
    s_lshl_b32 s76, s62, 11
    s_lshl_b32 s77, s60, 7
    s_add_u32 s76, s76, s77
    s_add_u32 s76, s76, s80
    s_add_u32 s76, s76, 4096
    s_add_u32 s77, s76, 3686400
    s_mov_b32 s78, 0x00003f80
    s_mov_b32 s79, 0x3f800000
    s_mov_b32 s88, 0
L_poll_18:
    buffer_load_dwordx4 v[32:35], v13, s[40:43], s76 offen sc1
    buffer_load_dwordx4 v[36:39], v13, s[40:43], s77 offen sc1
    s_waitcnt vmcnt(0)
    v_max_u32 v4, v32, v36
    v_cmp_eq_u32_e64 vcc, -1, v4
    s_nop 0
    s_cbranch_vccz L_ok_19
    s_add_u32 s88, s88, 1
    s_cmp_lt_u32 s88, 65536
    s_cbranch_scc1 L_poll_18
L_ok_19:
    v_dot2_f32_bf16 v48, v32, s78, 0
    v_dot2_f32_bf16 v49, v32, s79, 0
    v_dot2_f32_bf16 v50, v33, s78, 0
    v_dot2_f32_bf16 v51, v33, s79, 0
    v_dot2_f32_bf16 v52, v34, s78, 0
    v_dot2_f32_bf16 v53, v34, s79, 0
    v_dot2_f32_bf16 v54, v35, s78, 0
    v_dot2_f32_bf16 v55, v35, s79, 0
    v_dot2_f32_bf16 v48, v36, s78, v48
    v_dot2_f32_bf16 v49, v36, s79, v49
    v_dot2_f32_bf16 v50, v37, s78, v50
    v_dot2_f32_bf16 v51, v37, s79, v51
    v_dot2_f32_bf16 v52, v38, s78, v52
    v_dot2_f32_bf16 v53, v38, s79, v53
    v_dot2_f32_bf16 v54, v39, s78, v54
    v_dot2_f32_bf16 v55, v39, s79, v55
    buffer_load_dwordx4 v[40:43], v13, s[40:43], s81 offen offset:2048 sc1
    buffer_load_dwordx4 v[44:47], v13, s[40:43], s68 offen offset:2048 sc1
    v_permlane32_swap_b32 v48, v52
    v_permlane32_swap_b32 v49, v53
    v_permlane32_swap_b32 v50, v54
    v_permlane32_swap_b32 v51, v55
    v_add_f32 v48, v48, v52
    v_add_f32 v49, v49, v53
    v_add_f32 v50, v50, v54
    v_add_f32 v51, v51, v55
    s_nop 0
    v_permlane16_swap_b32 v48, v50
    v_permlane16_swap_b32 v49, v51
    v_add_f32 v48, v48, v50
    v_add_f32_e64 v49, v49, v51
    s_nop 0
    v_add_f32_dpp v48, v48, v48 row_ror:8 row_mask:0xf bank_mask:0xf
    v_add_f32_dpp v49, v49, v49 row_ror:8 row_mask:0xf bank_mask:0xf
    v_cvt_pk_bf16_f32 v48, v48, v49
    s_bitcmp1_b32 s100, 0
    s_cbranch_scc1 L_loc_20
    buffer_store_dword v48, v67, s[40:43], s83 offen offset:3072 sc1
    s_branch L_pubd_21
L_loc_20:
    buffer_store_dword v48, v67, s[40:43], s83 offen offset:3072
L_pubd_21:
    s_mov_b32 s88, 0
    s_waitcnt vmcnt(1)
    s_branch L_zfirst_22
L_z_23:
    buffer_load_dwordx4 v[40:43], v13, s[40:43], s81 offen offset:2048 sc1
    buffer_load_dwordx4 v[44:47], v13, s[40:43], s68 offen offset:2048 sc1
    s_waitcnt vmcnt(0)
L_zfirst_22:
    v_max3_u32 v4, v40, v41, v42
    v_max3_u32 v4, v4, v43, v44
    v_max3_u32 v4, v4, v45, v46
    v_max_u32 v4, v4, v47
    v_cmp_eq_u32 vcc, -1, v4
    s_nop 0
    s_cbranch_vccz L_ok_24
    s_add_u32 s88, s88, 1
    s_cmp_lt_u32 s88, 65536
    s_cbranch_scc1 L_z_23
L_ok_24:
    v_add_f32 v40, v40, v44
    v_add_f32 v41, v41, v45
    v_add_f32 v42, v42, v46
    v_add_f32 v43, v43, v47
    v_permlane32_swap_b32 v40, v41
    s_nop 0
    v_permlane32_swap_b32 v42, v43
    v_add_f32 v40, v40, v41
    v_add_f32 v42, v42, v43
    s_nop 1
    v_permlane16_swap_b32 v40, v42
    v_add_f32 v40, v40, v42
    s_nop 1
    v_add_f32_dpp v40, v40, v40 row_ror:8 row_mask:0xf bank_mask:0xf
    v_cvt_pk_bf16_f32 v40, v40, v40
    ds_write_b16 v66, v40 offset:24576
    s_waitcnt lgkmcnt(0)
    s_barrier
    s_setprio 0
    s_mov_b64 exec, 3
    global_load_dword v27, v91, s[66:67]
    s_mov_b64 exec, -1
    s_lshl_b32 s78, s97, 18
    s_lshl_b32 s79, s62, 16
    s_add_u32 s78, s78, s79
    s_lshl_b32 s79, s98, 7
    s_add_u32 s78, s78, s79
    s_lshl_b32 s79, s62, 12
    s_add_u32 m0, s79, 0
    s_nop 0
    buffer_load_dwordx4 v78, s[28:31], s78 offen offset:0 lds
    s_add_u32 s78, s78, 15360
    buffer_load_dwordx4 v79, s[28:31], s78 offen offset:1024 lds
    s_add_u32 s78, s78, 15360
    buffer_load_dwordx4 v78, s[28:31], s78 offen offset:2048 lds
    s_add_u32 s78, s78, 15360
    buffer_load_dwordx4 v79, s[28:31], s78 offen offset:3072 lds
    s_barrier
    s_lshl4_add_u32 s76, s97, s98
    s_mul_i32 s76, s76, 28800
    s_add_u32 s20, s26, s76
    s_addc_u32 s21, s27, 0
    s_cmp_eq_u32 s62, 0
    s_cbranch_scc0 L_now0_27
    s_sleep 4
    s_load_dwordx16 s[4:19], s[20:21], 3584 glc
    s_waitcnt lgkmcnt(0)
    s_and_b64 s[4:5], s[4:5], s[6:7]
    s_and_b64 s[4:5], s[4:5], s[8:9]
    s_and_b64 s[4:5], s[4:5], s[10:11]
    s_and_b64 s[4:5], s[4:5], s[12:13]
    s_and_b64 s[4:5], s[4:5], s[14:15]
    s_and_b64 s[4:5], s[4:5], s[16:17]
    s_and_b64 s[4:5], s[4:5], s[18:19]
    s_nand_b32 s4, s4, s5
    s_and_b32 s4, s4, 0xffff
    s_mul_i32 s4, s4, 0x10001
    s_lshr_b32 s4, s4, s65
    s_and_b32 s77, s4, 0xffff
    v_mov_b32_e64 v69, s77
    ds_write_b32 v70, v69 offset:25984
L_now0_27:
    s_waitcnt vmcnt(0) lgkmcnt(0)
    s_barrier
    s_cmp_eq_u32 s62, 0
    s_cbranch_scc0 L_now1_25
    s_mov_b32 s88, 0
L_spin_28:
    s_load_dwordx16 s[4:19], s[20:21], 3584 glc
    s_waitcnt lgkmcnt(0)
    s_and_b64 s[4:5], s[4:5], s[6:7]
    s_and_b64 s[4:5], s[4:5], s[8:9]
    s_and_b64 s[4:5], s[4:5], s[10:11]
    s_and_b64 s[4:5], s[4:5], s[12:13]
    s_and_b64 s[4:5], s[4:5], s[14:15]
    s_and_b64 s[4:5], s[4:5], s[16:17]
    s_and_b64 s[4:5], s[4:5], s[18:19]
    s_nand_b32 s4, s4, s5
    s_and_b32 s4, s4, 0xffff
    s_mul_i32 s4, s4, 0x10001
    s_lshr_b32 s4, s4, s65
    s_and_b32 s77, s4, 0xffff
    v_mov_b32 v69, s77
    ds_write_b32 v70, v69 offset:25984
    s_cmp_eq_u32 s77, 0xffff
    s_cbranch_scc1 L_s2done_26
    s_add_u32 s88, s88, 1
    s_cmp_lt_u32 s88, 65536
    s_cbranch_scc1 L_spin_28
    s_branch L_s2done_26
L_now1_25:
    s_cmp_eq_u32 s62, 1
    s_cbranch_scc0 L_s2done_26
    s_lshl_b32 s77, 1, s61
    s_not_b32 s77, s77
    v_mov_b32_e64 v4, s77
    v_mul_u32_u24 v5, 28800, v1
    s_mul_i32 s76, s60, 460800
    s_lshl2_add_u32 s76, s61, s76
    s_mov_b32 s88, 0
L_spin_29:
    ds_read_b32 v69, v70 offset:25988
    s_waitcnt lgkmcnt(0)
    v_cmp_eq_u32_e64 vcc, 4, v69
    s_nop 0
    s_cbranch_vccnz L_drained_30
    s_add_u32 s88, s88, 1
    s_cmp_lt_u32 s88, 1048576
    s_cbranch_scc1 L_spin_29
L_drained_30:
    s_mov_b64 exec, 0xffff
    buffer_store_dword v4, v5, s[40:43], s76 offen offset:3584 sc1
    s_mov_b64 exec, -1
L_s2done_26:
    s_waitcnt vmcnt(0)
    s_mov_b32 s78, 0x05040100
    s_mov_b32 s79, 0x07060302
    v_perm_b32 v160, v100, v96, s78
    v_perm_b32 v164, v100, v96, s79
    v_perm_b32 v168, v101, v97, s78
    v_perm_b32 v172, v101, v97, s79
    v_perm_b32 v176, v102, v98, s78
    v_perm_b32 v180, v102, v98, s79
    v_perm_b32 v184, v103, v99, s78
    v_perm_b32 v188, v103, v99, s79
    v_perm_b32 v161, v108, v104, s78
    v_perm_b32 v165, v108, v104, s79
    v_perm_b32 v169, v109, v105, s78
    v_perm_b32 v173, v109, v105, s79
    v_perm_b32 v177, v110, v106, s78
    v_perm_b32 v181, v110, v106, s79
    v_perm_b32 v185, v111, v107, s78
    v_perm_b32 v189, v111, v107, s79
    v_perm_b32 v162, v116, v112, s78
    v_perm_b32 v166, v116, v112, s79
    v_perm_b32 v170, v117, v113, s78
    v_perm_b32 v174, v117, v113, s79
    v_perm_b32 v178, v118, v114, s78
    v_perm_b32 v182, v118, v114, s79
    v_perm_b32 v186, v119, v115, s78
    v_perm_b32 v190, v119, v115, s79
    v_perm_b32 v163, v124, v120, s78
    v_perm_b32 v167, v124, v120, s79
    v_perm_b32 v171, v125, v121, s78
    v_perm_b32 v175, v125, v121, s79
    v_perm_b32 v179, v126, v122, s78
    v_perm_b32 v183, v126, v122, s79
    v_perm_b32 v187, v127, v123, s78
    v_perm_b32 v191, v127, v123, s79
    v_perm_b32 v192, v132, v128, s78
    v_perm_b32 v196, v132, v128, s79
    v_perm_b32 v200, v133, v129, s78
    v_perm_b32 v204, v133, v129, s79
    v_perm_b32 v208, v134, v130, s78
    v_perm_b32 v212, v134, v130, s79
    v_perm_b32 v216, v135, v131, s78
    v_perm_b32 v220, v135, v131, s79
    v_perm_b32 v193, v140, v136, s78
    v_perm_b32 v197, v140, v136, s79
    v_perm_b32 v201, v141, v137, s78
    v_perm_b32 v205, v141, v137, s79
    v_perm_b32 v209, v142, v138, s78
    v_perm_b32 v213, v142, v138, s79
    v_perm_b32 v217, v143, v139, s78
    v_perm_b32 v221, v143, v139, s79
    v_perm_b32 v194, v148, v144, s78
    v_perm_b32 v198, v148, v144, s79
    v_perm_b32 v202, v149, v145, s78
    v_perm_b32 v206, v149, v145, s79
    v_perm_b32 v210, v150, v146, s78
    v_perm_b32 v214, v150, v146, s79
    v_perm_b32 v218, v151, v147, s78
    v_perm_b32 v222, v151, v147, s79
    v_perm_b32 v195, v156, v152, s78
    v_perm_b32 v199, v156, v152, s79
    v_perm_b32 v203, v157, v153, s78
    v_perm_b32 v207, v157, v153, s79
    v_perm_b32 v211, v158, v154, s78
    v_perm_b32 v215, v158, v154, s79
    v_perm_b32 v219, v159, v155, s78
    v_perm_b32 v223, v159, v155, s79
    v_lshlrev_b32 v17, 5, v2
    v_lshl_add_u32 v17, v3, 4, v17
    v_and_b32 v4, 15, v1
    v_lshrrev_b32 v5, 1, v4
    v_and_b32 v4, 1, v4
    v_lshlrev_b32 v4, 5, v4
    v_lshl_add_u32 v16, v5, 7, v4
    v_lshrrev_b32 v4, 3, v1
    v_and_b32 v5, 7, v1
    v_lshlrev_b32_e64 v5, 4, v5
    v_mul_u32_u24 v18, 9344, v4
    v_add_u32_e64 v18, v18, v5
    v_bfe_u32 v6, v1, 4, 1
    v_lshl_add_u32 v6, v6, 1, v3
    v_lshl_add_u32 v19, v6, 2, v5
    s_mul_i32 s84, s97, 149504
    s_lshl_b32 s77, s98, 7
    s_add_u32 s84, s84, s77
    s_add_u32 s84, s84, 8388608
    s_lshl_b32 s85, s62, 10
    s_add_u32 s85, s85, s99
    s_add_u32 s85, s85, 5120
    s_and_b32 s87, s97, 1
    s_lshl_b32 s87, s87, 4
    s_add_u32 s87, s87, s98
    s_lshr_b32 s86, s97, 1
    s_mul_i32 s86, s86, 299008
    s_lshl_b32 s77, s87, 7
    s_add_u32 s86, s86, s77
    s_add_u32 s86, s86, 8393728
    s_barrier
    s_mul_i32 s78, s62, 2048
    s_add_u32 s78, s78, s99
    s_add_u32 s78, s78, 1024
    v_lshlrev_b32_e64 v11, 7, v1
    s_mov_b64 exec, 65535
    buffer_load_dword v27, v11, s[40:43], s78 offen sc1
    s_mov_b64 exec, -1
    buffer_load_dwordx4 v[32:35], v77, s[52:55], s96 offen nt
    s_add_u32 s96, s96, 4096
    buffer_load_dwordx4 v[36:39], v77, s[52:55], s96 offen nt
    s_add_u32 s96, s96, 4096
    buffer_load_dwordx4 v[40:43], v77, s[52:55], s96 offen nt
    s_add_u32 s96, s96, 4096
    buffer_load_dwordx4 v[44:47], v77, s[52:55], s96 offen nt
    s_add_u32 s96, s96, 4096
    s_barrier
    buffer_load_dwordx4 v[48:51], v77, s[52:55], s96 offen nt
    s_add_u32 s96, s96, 4096
    buffer_load_dwordx4 v[52:55], v77, s[52:55], s96 offen nt
    s_add_u32 s96, s96, 4096
    buffer_load_dwordx4 v[56:59], v77, s[52:55], s96 offen nt
    s_add_u32 s96, s96, 4096
    buffer_load_dwordx4 v[60:63], v77, s[52:55], s96 offen nt
    s_add_u32 s96, s96, 4096
    s_barrier
    s_waitcnt vmcnt(0)
    s_mov_b32 s78, 0x05040100
    s_mov_b32 s79, 0x07060302
    v_permlane32_swap_b32 v32, v34
    v_permlane32_swap_b32 v33, v35
    v_permlane32_swap_b32 v36, v38
    v_permlane32_swap_b32 v37, v39
    v_permlane32_swap_b32 v40, v42
    v_permlane32_swap_b32 v41, v43
    v_permlane32_swap_b32 v44, v46
    v_permlane32_swap_b32 v45, v47
    v_permlane32_swap_b32 v48, v50
    v_permlane32_swap_b32 v49, v51
    v_permlane32_swap_b32 v52, v54
    v_permlane32_swap_b32 v53, v55
    v_permlane32_swap_b32 v56, v58
    v_permlane32_swap_b32 v57, v59
    v_permlane32_swap_b32 v60, v62
    v_permlane32_swap_b32 v61, v63
    v_perm_b32 v224, v34, v32, s78
    v_perm_b32 v225, v34, v32, s79
    v_perm_b32 v226, v35, v33, s78
    v_perm_b32 v227, v35, v33, s79
    v_perm_b32 v228, v38, v36, s78
    v_perm_b32 v229, v38, v36, s79
    v_perm_b32 v230, v39, v37, s78
    v_perm_b32 v231, v39, v37, s79
    v_perm_b32 v232, v42, v40, s78
    v_perm_b32 v233, v42, v40, s79
    v_perm_b32 v234, v43, v41, s78
    v_perm_b32 v235, v43, v41, s79
    v_perm_b32 v236, v46, v44, s78
    v_perm_b32 v237, v46, v44, s79
    v_perm_b32 v238, v47, v45, s78
    v_perm_b32 v239, v47, v45, s79
    v_perm_b32 v240, v50, v48, s78
    v_perm_b32 v241, v50, v48, s79
    v_perm_b32 v242, v51, v49, s78
    v_perm_b32 v243, v51, v49, s79
    v_perm_b32 v244, v54, v52, s78
    v_perm_b32 v245, v54, v52, s79
    v_perm_b32 v246, v55, v53, s78
    v_perm_b32 v247, v55, v53, s79
    v_perm_b32 v248, v58, v56, s78
    v_perm_b32 v249, v58, v56, s79
    v_perm_b32 v250, v59, v57, s78
    v_perm_b32 v251, v59, v57, s79
    v_perm_b32 v252, v62, v60, s78
    v_perm_b32 v253, v62, v60, s79
    v_perm_b32 v254, v63, v61, s78
    v_perm_b32 v255, v63, v61, s79
    v_and_b32 v5, 15, v1
    v_lshlrev_b32 v5, 3, v5
    s_lshl_b32 s76, s63, 10
    s_lshl_b32 s77, s64, 6
    s_add_u32 s76, s76, s77
    s_add_u32 s76, s76, s99
    s_mov_b64 s[80:81], 0xffff
    s_add_u32 s68, s84, 74752
    s_add_u32 s69, s86, 74752
    s_add_u32 s70, s86, 149504
    s_add_u32 s71, s86, 224256
    s_setprio 3
    s_barrier
    ds_read_b128 v[64:67], v12 offset:28672
    ds_read_b128 v[68:71], v12 offset:29696
    ds_read_b64 v[8:9], v5 offset:25728
    s_waitcnt lgkmcnt(2)
    v_mfma_f32_16x16x32_bf16 v[96:99], v[64:67], v[160:163], 0
    v_mfma_f32_16x16x32_bf16 v[100:103], v[64:67], v[164:167], 0
    s_waitcnt lgkmcnt(0)
    v_max_f32_dpp v4, v8, v8 row_ror:8 row_mask:0xf bank_mask:0xf
    v_mfma_f32_16x16x32_bf16 v[104:107], v[64:67], v[168:171], 0
    v_mfma_f32_16x16x32_bf16 v[108:111], v[64:67], v[172:175], 0
    v_max_f32_dpp v4, v4, v4 row_ror:4 row_mask:0xf bank_mask:0xf
    v_mfma_f32_16x16x32_bf16 v[112:115], v[64:67], v[176:179], 0
    v_mfma_f32_16x16x32_bf16 v[116:119], v[64:67], v[180:183], 0
    v_max_f32_dpp v4, v4, v4 row_ror:2 row_mask:0xf bank_mask:0xf
    v_mfma_f32_16x16x32_bf16 v[120:123], v[64:67], v[184:187], 0
    v_mfma_f32_16x16x32_bf16 v[124:127], v[64:67], v[188:191], 0
    v_max_f32_dpp v4, v4, v4 row_ror:1 row_mask:0xf bank_mask:0xf
    v_mfma_f32_16x16x32_bf16 v[96:99], v[68:71], v[192:195], v[96:99]
    v_cmp_eq_f32_e64 vcc, v4, v8
    v_mfma_f32_16x16x32_bf16 v[100:103], v[68:71], v[196:199], v[100:103]
    s_ff1_i32_b32 s92, vcc_lo
    s_and_b32 s92, s92, 15
    v_mfma_f32_16x16x32_bf16 v[104:107], v[68:71], v[200:203], v[104:107]
    s_lshr_b32 s78, s92, 2
    s_lshl_b32 s78, s78, 4
    v_mfma_f32_16x16x32_bf16 v[108:111], v[68:71], v[204:207], v[108:111]
    s_and_b32 s77, s92, 3
    v_mfma_f32_16x16x32_bf16 v[112:115], v[68:71], v[208:211], v[112:115]
    v_readlane_b32 s91, v9, s92
    v_readlane_b32 s93, v8, s92
    v_mfma_f32_16x16x32_bf16 v[116:119], v[68:71], v[212:215], v[116:119]
    v_mfma_f32_16x16x32_bf16 v[120:123], v[68:71], v[216:219], v[120:123]
    v_mfma_f32_16x16x32_bf16 v[124:127], v[68:71], v[220:223], v[124:127]
    s_cmp_ge_u32 s97, 14
    s_cbranch_scc1 L_final
    s_cmp_eq_u32 s77, 0
    s_cbranch_scc0 L_sel_32
    v_mov_b32 v64, v96
    v_mov_b32 v65, v100
    v_mov_b32 v66, v104
    v_mov_b32 v67, v108
    v_mov_b32 v68, v112
    v_mov_b32 v69, v116
    v_mov_b32 v70, v120
    v_mov_b32 v71, v124
    s_branch L_seldone_31
L_sel_32:
    s_cmp_eq_u32 s77, 1
    s_cbranch_scc0 L_sel_33
    v_mov_b32 v64, v97
    v_mov_b32 v65, v101
    v_mov_b32 v66, v105
    v_mov_b32 v67, v109
    v_mov_b32 v68, v113
    v_mov_b32 v69, v117
    v_mov_b32 v70, v121
    v_mov_b32 v71, v125
    s_branch L_seldone_31
L_sel_33:
    s_cmp_eq_u32 s77, 2
    s_cbranch_scc0 L_sel_34
    v_mov_b32 v64, v98
    v_mov_b32 v65, v102
    v_mov_b32 v66, v106
    v_mov_b32 v67, v110
    v_mov_b32 v68, v114
    v_mov_b32 v69, v118
    v_mov_b32 v70, v122
    v_mov_b32 v71, v126
    s_branch L_seldone_31
L_sel_34:
    v_mov_b32 v64, v99
    v_mov_b32 v65, v103
    v_mov_b32 v66, v107
    v_mov_b32 v67, v111
    v_mov_b32 v68, v115
    v_mov_b32 v69, v119
    v_mov_b32 v70, v123
    v_mov_b32_e64 v71, v127
L_seldone_31:
    s_lshl_b64 exec, s[80:81], s78
    s_bitcmp1_b32 s100, 1
    s_cbranch_scc1 L_loc_36
    buffer_store_dwordx4 v[64:67], v16, s[40:43], s76 offen offset:3072 sc1
    buffer_store_dwordx4 v[68:71], v16, s[40:43], s76 offen offset:3088 sc1
    s_branch L_pubd_37
L_loc_36:
    buffer_store_dwordx4 v[64:67], v16, s[40:43], s76 offen offset:3072
    buffer_store_dwordx4 v[68:71], v16, s[40:43], s76 offen offset:3088
L_pubd_37:
    s_mov_b64 exec, -1
    s_mov_b32 s88, 0
L_poll_38:
    buffer_load_dwordx4 v[128:131], v18, s[40:43], s84 offen offset:3072 sc1
    buffer_load_dwordx4 v[132:135], v18, s[40:43], s68 offen offset:3072 sc1
    s_waitcnt vmcnt(0)
    v_max_u32 v4, v128, v132
    v_cmp_eq_u32_e64 vcc, -1, v4
    s_nop 0
    s_cbranch_vccz L_ok_39
    s_add_u32 s88, s88, 1
    s_cmp_lt_u32 s88, 65536
    s_cbranch_scc1 L_poll_38
L_ok_39:
    v_pk_add_f32 v[48:49], v[128:129], v[132:133]
    v_pk_add_f32 v[50:51], v[130:131], v[134:135]
    s_nop 0
    v_permlane32_swap_b32 v48, v49
    v_permlane32_swap_b32 v50, v51
    v_add_f32 v48, v48, v49
    v_add_f32 v50, v50, v51
    s_nop 1
    v_permlane16_swap_b32 v48, v50
    v_add_f32 v48, v48, v50
    s_nop 1
    v_add_f32_dpp v48, v48, v48 row_ror:8 row_mask:0xf bank_mask:0xf
    v_cvt_pk_bf16_f32 v48, v48, v48
    v_and_b32_e64 v48, s90, v48
    v_mul_f32 v4, 0xbfb8aa3b, v48
    v_exp_f32_e64 v4, v4
    v_mov_b32_dpp v49, v48 row_ror:12 row_mask:0xf bank_mask:0xf
    v_add_f32 v4, 1.0, v4
    v_rcp_f32 v4, v4
    s_nop 0
    v_mul_f32 v4, v4, v48
    v_cvt_pk_bf16_f32 v4, v4, v4
    v_and_b32 v4, s90, v4
    v_mul_f32 v4, v4, v49
    v_mov_b32 v5, v4
    s_nop 1
    v_permlane32_swap_b32_e64 v4, v5
    v_cvt_pk_bf16_f32 v4, v4, v5
    s_nop 0
    v_readlane_b32 s76, v4, 0
    v_readlane_b32 s77, v4, 16
    v_readlane_b32 s78, v4, 1
    v_readlane_b32 s79, v4, 17
    v_readlane_b32 s80, v4, 2
    v_readlane_b32 s81, v4, 18
    v_readlane_b32 s82, v4, 3
    v_readlane_b32 s83, v4, 19
    v_dot2_f32_bf16 v40, v224, s76, 0
    v_dot2_f32_bf16 v41, v225, s76, 0
    v_dot2_f32_bf16 v42, v226, s76, 0
    v_dot2_f32_bf16 v43, v227, s76, 0
    v_dot2_f32_bf16 v40, v228, s77, v40
    v_dot2_f32_bf16 v41, v229, s77, v41
    v_dot2_f32_bf16 v42, v230, s77, v42
    v_dot2_f32_bf16 v43, v231, s77, v43
    v_dot2_f32_bf16 v40, v232, s78, v40
    v_dot2_f32_bf16 v41, v233, s78, v41
    v_dot2_f32_bf16 v42, v234, s78, v42
    v_dot2_f32_bf16 v43, v235, s78, v43
    v_dot2_f32_bf16 v40, v236, s79, v40
    v_dot2_f32_bf16 v41, v237, s79, v41
    v_dot2_f32_bf16 v42, v238, s79, v42
    v_dot2_f32_bf16 v43, v239, s79, v43
    v_dot2_f32_bf16 v40, v240, s80, v40
    v_dot2_f32_bf16 v41, v241, s80, v41
    v_dot2_f32_bf16 v42, v242, s80, v42
    v_dot2_f32_bf16 v43, v243, s80, v43
    v_dot2_f32_bf16 v40, v244, s81, v40
    v_dot2_f32_bf16 v41, v245, s81, v41
    v_dot2_f32_bf16 v42, v246, s81, v42
    v_dot2_f32_bf16 v43, v247, s81, v43
    v_dot2_f32_bf16 v40, v248, s82, v40
    v_dot2_f32_bf16 v41, v249, s82, v41
    v_dot2_f32_bf16 v42, v250, s82, v42
    v_dot2_f32_bf16 v43, v251, s82, v43
    v_dot2_f32_bf16 v40, v252, s83, v40
    v_dot2_f32_bf16 v41, v253, s83, v41
    v_dot2_f32_bf16 v42, v254, s83, v42
    v_dot2_f32_bf16 v43, v255, s83, v43
    s_bitcmp1_b32 s100, 1
    s_cbranch_scc1 L_loc_40
    s_nop 0
    buffer_store_dwordx4 v[40:43], v17, s[40:43], s85 offen sc1
    s_branch L_pubd_41
L_loc_40:
    s_nop 0
    buffer_store_dwordx4 v[40:43], v17, s[40:43], s85 offen
L_pubd_41:
    s_cmp_eq_u32 s62, 0
    s_cbranch_scc0 L_hby
    s_mov_b32 s88, 0
L_poll_42:
    buffer_load_dwordx4 v[136:139], v18, s[40:43], s86 offen sc1
    buffer_load_dwordx4 v[140:143], v18, s[40:43], s69 offen sc1
    buffer_load_dwordx4 v[144:147], v18, s[40:43], s70 offen sc1
    buffer_load_dwordx4 v[148:151], v18, s[40:43], s71 offen sc1
    s_waitcnt vmcnt(0)
    v_max3_u32 v4, v136, v140, v144
    v_max_u32 v4, v4, v148
    v_cmp_eq_u32_e64 vcc, -1, v4
    s_nop 0
    s_cbranch_vccz L_ok_43
    s_add_u32 s88, s88, 1
    s_cmp_lt_u32 s88, 65536
    s_cbranch_scc1 L_poll_42
L_ok_43:
    v_pk_add_f32 v[48:49], v[136:137], v[144:145]
    v_pk_add_f32 v[50:51], v[138:139], v[146:147]
    v_pk_add_f32 v[52:53], v[140:141], v[148:149]
    v_pk_add_f32 v[54:55], v[142:143], v[150:151]
    v_pk_add_f32 v[48:49], v[48:49], v[52:53]
    v_pk_add_f32 v[50:51], v[50:51], v[54:55]
    s_nop 0
    v_permlane32_swap_b32 v48, v49
    v_permlane32_swap_b32 v50, v51
    v_add_f32 v48, v48, v49
    v_add_f32 v50, v50, v51
    s_nop 1
    v_permlane16_swap_b32 v48, v50
    v_add_f32 v48, v48, v50
    s_nop 1
    v_add_f32_dpp v48, v48, v48 row_ror:8 row_mask:0xf bank_mask:0xf
    buffer_store_dword v48, v19, s[40:43], s99 offen offset:512 sc1
L_hby:
    s_barrier
    s_branch L_hfin
L_final:
    s_barrier
    s_cmp_eq_u32 s62, 1
    s_cbranch_scc0 L_noep_44
    s_cmp_eq_u32 s87, 0
    s_cbranch_scc0 L_noep_44
    v_mov_b32 v4, 13631488
    s_mov_b64 exec, 1
    buffer_store_dwordx2 v[88:89], v4, s[40:43], 0 offen sc1
    s_mov_b64 exec, -1
L_noep_44:
    s_cmp_eq_u32 s62, 0
    s_cbranch_scc0 L_hfin
    v_mov_b32 v8, s93
    v_cvt_pk_bf16_f32 v8, v8, v8
    v_and_b32_e64 v8, s90, v8
    v_mul_f32 v8, 0xbfb8aa3b, v8
    v_exp_f32 v8, v8
    s_nop 0
    v_add_f32 v8, 1.0, v8
    v_rcp_f32_e64 v8, v8
    s_nop 0
    v_cvt_pk_bf16_f32 v8, v8, v8
    v_and_b32 v8, s90, v8
    s_lshl_b32 s76, s92, 4
    s_lshr_b32 s77, s87, 1
    s_add_u32 s76, s76, s77
    s_mul_i32 s76, s76, 9344
    s_add_u32 s76, s76, 8388608
    s_and_b32 s77, s87, 1
    s_lshl_b32 s77, s77, 5
    s_add_u32 s76, s76, s77
    v_and_b32 v10, 1, v1
    v_lshlrev_b32_e64 v10, 6, v10
    v_bfe_u32 v4, v1, 1, 2
    v_lshl_add_u32 v10, v4, 3, v10
    v_bfe_u32 v4, v1, 4, 1
    v_lshl_add_u32 v10, v4, 2, v10
    v_lshrrev_b32_e64 v4, 3, v1
    v_mul_u32_u24 v6, 299008, v4
    v_and_b32_e64 v5, 7, v1
    v_lshl_add_u32 v6, v5, 4, v6
    v_mov_b32 v7, 2146435072
    v_cmp_gt_u32 vcc, 56, v1
    s_nop 1
    v_cndmask_b32_e64 v6, v7, v6, vcc
    s_mul_i32 s79, s87, 9344
    s_add_u32 s79, s79, 8388608
    s_lshl_b32 s80, s91, 11
    s_lshl_b32 s77, s87, 6
    s_add_u32 s80, s80, s77
    s_sleep 16
    s_mov_b32 s88, 0
L_spin_45:
    buffer_load_dword v64, v10, s[40:43], s76 offen offset:0 sc1
    buffer_load_dword v65, v10, s[40:43], s76 offen offset:128 sc1
    s_waitcnt vmcnt(0)
    v_max_u32 v4, v64, v65
    v_cmp_eq_u32_e64 vcc, -1, v4
    s_nop 0
    s_cbranch_vccz L_ok_46
    s_add_u32 s88, s88, 1
    s_cmp_lt_u32 s88, 65536
    s_cbranch_scc1 L_spin_45
L_ok_46:
    v_lshlrev_b32 v4, 4, v3
    v_lshrrev_b32 v64, v4, v64
    v_lshrrev_b32 v65, v4, v65
    v_lshlrev_b32 v64, 16, v64
    v_lshlrev_b32 v65, 16, v65
    v_lshrrev_b32 v9, 1, v19
    s_mov_b32 s88, 0
    buffer_load_dwordx4 v[128:131], v6, s[40:43], s79 offen offset:512 sc1
    s_sleep 3
    buffer_load_dwordx4 v[128:131], v6, s[40:43], s79 offen offset:512 sc1
    s_sleep 3
L_poll_47:
    buffer_load_dwordx4 v[128:131], v6, s[40:43], s79 offen offset:512 sc1
    s_waitcnt vmcnt(2)
    v_max3_u32 v4, v128, v129, v130
    v_max_u32 v4, v4, v131
    v_cmp_eq_u32 vcc, -1, v4
    s_nop 0
    s_cbranch_vccz L_ok_48
    s_add_u32 s88, s88, 1
    s_cmp_lt_u32 s88, 65536
    s_cbranch_scc1 L_poll_47
L_ok_48:
    v_mov_b32 v48, v128
    v_mov_b32 v49, v129
    v_mov_b32 v50, v130
    v_mov_b32 v51, v131
    v_permlane32_swap_b32 v48, v49
    s_nop 0
    v_permlane32_swap_b32 v50, v51
    v_add_f32 v48, v48, v49
    v_add_f32 v50, v50, v51
    s_nop 1
    v_permlane16_swap_b32 v48, v50
    v_add_f32 v48, v48, v50
    s_nop 1
    v_add_f32_dpp v48, v48, v48 row_ror:8 row_mask:0xf bank_mask:0xf
    v_cvt_pk_bf16_f32 v48, v48, v48
    v_and_b32 v48, s90, v48
    v_mul_f32 v48, v48, v8
    v_cvt_pk_bf16_f32 v48, v48, v48
    v_and_b32 v48, s90, v48
    v_add_f32 v48, v48, v64
    v_cvt_pk_bf16_f32 v48, v48, v48
    v_and_b32 v48, s90, v48
    v_add_f32 v48, v48, v65
    v_cvt_pk_bf16_f32 v48, v48, v48
    s_mov_b32 exec_lo, 0x00ff00ff
    s_mov_b32 exec_hi, 0x00ff00ff
    buffer_store_short v48, v9, s[44:47], s80 offen sc1
    s_mov_b64 exec, -1
L_hfin:
    s_endpgm
L_event:
    s_cmp_eq_u32 s77, 3
    s_cbranch_scc0 L_ev1
    buffer_load_dwordx4 v[92:95], v90, s[40:43], 0 offen sc1
    s_mov_b64 exec, 3
    global_load_dword v27, v91, s[66:67]
    s_mov_b64 exec, -1
    s_branch L_evret
L_ev1:
    s_cmp_eq_u32 s77, 5
    s_cbranch_scc0 L_ev_49
    s_and_b32 s72, s84, 15
    s_mov_b32 m0, s70
    s_lshl_b32 s71, s72, 7
    buffer_load_dwordx4 v16, s[28:31], s71 offen offset:0 lds
    s_mul_i32 s72, s72, 393216
    s_lshr_b64 s[84:85], s[84:85], 4
    buffer_load_dwordx4 v17, s[28:31], s71 offen offset:1024 lds
    buffer_load_dwordx4 v18, s[28:31], s71 offen offset:2048 lds
    buffer_load_dwordx4 v19, s[28:31], s71 offen offset:3072 lds
    s_add_u32 m0, s70, 4096
    s_nop 0
    buffer_load_dwordx4 v20, s[32:35], s72 offen offset:0 lds
    buffer_load_dwordx4 v21, s[32:35], s72 offen offset:1024 lds
    buffer_load_dwordx4 v22, s[32:35], s72 offen offset:2048 lds
    buffer_load_dwordx4 v23, s[32:35], s72 offen offset:3072 lds
    s_add_u32 m0, s70, 8192
    s_nop 0
    buffer_load_dwordx4 v24, s[32:35], s72 offen offset:0 lds
    buffer_load_dwordx4 v25, s[32:35], s72 offen offset:1024 lds
    s_add_u32 s70, s70, 40960
    s_cmp_ge_u32 s70, 122880
    s_cselect_b32 s76, 122880, 0
    s_sub_u32 s70, s70, s76
    buffer_load_dwordx4 v[96:99], v76, s[48:51], s75 offen nt
    s_add_u32 s75, s75, 7168
    buffer_load_dwordx4 v[100:103], v76, s[48:51], s75 offen nt
    s_add_u32 s75, s75, 7168
    buffer_load_dwordx4 v[104:107], v76, s[48:51], s75 offen nt
    s_add_u32 s75, s75, 7168
    buffer_load_dwordx4 v[108:111], v76, s[48:51], s75 offen nt
    s_add_u32 s75, s75, 7168
    buffer_load_dwordx4 v[128:131], v76, s[48:51], s75 offen nt
    s_add_u32 s75, s75, 7168
    buffer_load_dwordx4 v[132:135], v76, s[48:51], s75 offen nt
    s_add_u32 s75, s75, 7168
    buffer_load_dwordx4 v[136:139], v76, s[48:51], s75 offen nt
    s_add_u32 s75, s75, 7168
    buffer_load_dwordx4 v[140:143], v76, s[48:51], s75 offen nt
    s_add_u32 s75, s75, 7168
    s_waitcnt vmcnt(18)
    s_branch L_hbar
L_ev_49:
    s_cmp_eq_u32 s77, 6
    s_cbranch_scc0 L_ev_50
    s_and_b32 s72, s84, 15
    s_mov_b32 m0, s70
    s_lshl_b32 s71, s72, 7
    buffer_load_dwordx4 v16, s[28:31], s71 offen offset:0 lds
    s_mul_i32 s72, s72, 393216
    s_lshr_b64 s[84:85], s[84:85], 4
    buffer_load_dwordx4 v17, s[28:31], s71 offen offset:1024 lds
    buffer_load_dwordx4 v18, s[28:31], s71 offen offset:2048 lds
    buffer_load_dwordx4 v19, s[28:31], s71 offen offset:3072 lds
    s_add_u32 m0, s70, 4096
    s_nop 0
    buffer_load_dwordx4 v20, s[32:35], s72 offen offset:0 lds
    buffer_load_dwordx4 v21, s[32:35], s72 offen offset:1024 lds
    buffer_load_dwordx4 v22, s[32:35], s72 offen offset:2048 lds
    buffer_load_dwordx4 v23, s[32:35], s72 offen offset:3072 lds
    s_add_u32 m0, s70, 8192
    s_nop 0
    buffer_load_dwordx4 v24, s[32:35], s72 offen offset:0 lds
    buffer_load_dwordx4 v25, s[32:35], s72 offen offset:1024 lds
    s_add_u32 s70, s70, 40960
    s_cmp_ge_u32 s70, 122880
    s_cselect_b32 s76, 122880, 0
    s_sub_u32 s70, s70, s76
    s_lshr_b32 s78, s2, 3
    s_lshl2_add_u32 s78, s78, s62
    s_lshl_b32 s78, s78, 14
    v_lshlrev_b32_e64 v11, 10, v1
    s_mov_b64 exec, 65535
    buffer_load_dword v27, v11, s[36:39], s78 offen offset:384
    s_mov_b64 exec, -1
    s_lshl_b32 s78, s62, 9
    v_lshl_add_u32 v11, v1, 7, s78
    s_mov_b64 exec, 15
    global_load_dword v27, v11, s[14:15]
    s_mov_b64 exec, -1
    buffer_load_dwordx4 v[112:115], v76, s[48:51], s75 offen nt
    s_add_u32 s75, s75, 7168
    buffer_load_dwordx4 v[116:119], v76, s[48:51], s75 offen nt
    s_add_u32 s75, s75, 7168
    buffer_load_dwordx4 v[120:123], v76, s[48:51], s75 offen nt
    s_add_u32 s75, s75, 7168
    buffer_load_dwordx4 v[124:127], v76, s[48:51], s75 offen nt
    s_add_u32 s75, s75, 7168
    buffer_load_dwordx4 v[144:147], v76, s[48:51], s75 offen nt
    s_add_u32 s75, s75, 7168
    buffer_load_dwordx4 v[148:151], v76, s[48:51], s75 offen nt
    s_add_u32 s75, s75, 7168
    s_waitcnt vmcnt(18)
    s_branch L_hbar
L_ev_50:
    s_add_u32 s78, s70, 40960
    s_cmp_ge_u32 s78, 122880
    s_cselect_b32 s76, 122880, 0
    s_sub_u32 s78, s78, s76
    s_cmp_eq_u32 s77, 2
    s_cbranch_scc1 L_evw
    v_add_u32 v4, s78, v72
    v_xor_b32 v5, 32, v4
    v_xor_b32 v6, 64, v4
    v_xor_b32 v7, 96, v4
    s_and_b32 s72, s84, 15
    s_mov_b32 m0, s70
    s_lshl_b32 s71, s72, 7
    buffer_load_dwordx4 v16, s[28:31], s71 offen offset:0 lds
    s_mul_i32 s72, s72, 393216
    s_lshr_b64 s[84:85], s[84:85], 4
    ds_read_b128 v[32:35], v4
    ds_read_b128 v[36:39], v5
    ds_read_b128 v[40:43], v6
    ds_read_b128 v[44:47], v7
    buffer_load_dwordx4 v17, s[28:31], s71 offen offset:1024 lds
    s_lshl_b32 s79, s62, 8
    s_add_u32 s79, s79, s73
    s_waitcnt lgkmcnt(0)
    v_lshlrev_b32 v80, 16, v32
    v_and_b32 v82, s90, v32
    v_mul_f32 v81, v80, v80
    v_mul_f32 v83, v82, v82
    v_lshlrev_b32 v10, 16, v33
    v_and_b32 v11, s90, v33
    v_add_f32 v80, v80, v10
    v_add_f32 v82, v82, v11
    v_fmac_f32 v81, v10, v10
    v_fmac_f32 v83, v11, v11
    v_lshlrev_b32 v8, 16, v34
    v_and_b32_e64 v9, s90, v34
    buffer_load_dwordx4 v18, s[28:31], s71 offen offset:2048 lds
    v_add_f32 v80, v80, v8
    v_add_f32 v82, v82, v9
    v_fmac_f32 v81, v8, v8
    v_fmac_f32 v83, v9, v9
    v_lshlrev_b32 v10, 16, v35
    v_and_b32 v11, s90, v35
    v_add_f32 v80, v80, v10
    v_add_f32 v82, v82, v11
    v_fmac_f32 v81, v10, v10
    v_fmac_f32 v83, v11, v11
    v_lshlrev_b32 v8, 16, v36
    v_and_b32 v9, s90, v36
    buffer_load_dwordx4 v19, s[28:31], s71 offen offset:3072 lds
    v_add_f32 v80, v80, v8
    v_add_f32 v82, v82, v9
    v_fmac_f32 v81, v8, v8
    v_fmac_f32 v83, v9, v9
    v_lshlrev_b32 v10, 16, v37
    v_and_b32 v11, s90, v37
    v_add_f32 v80, v80, v10
    v_add_f32 v82, v82, v11
    v_fmac_f32 v81, v10, v10
    v_fmac_f32 v83, v11, v11
    v_lshlrev_b32 v8, 16, v38
    v_and_b32 v9, s90, v38
    s_add_u32 m0, s70, 4096
    s_nop 0
    buffer_load_dwordx4 v20, s[32:35], s72 offen offset:0 lds
    v_add_f32 v80, v80, v8
    v_add_f32 v82, v82, v9
    v_fmac_f32 v81, v8, v8
    v_fmac_f32 v83, v9, v9
    v_lshlrev_b32 v10, 16, v39
    v_and_b32 v11, s90, v39
    v_add_f32 v80, v80, v10
    v_add_f32 v82, v82, v11
    v_fmac_f32 v81, v10, v10
    v_fmac_f32 v83, v11, v11
    v_lshlrev_b32 v8, 16, v40
    v_and_b32_e64 v9, s90, v40
    buffer_load_dwordx4 v21, s[32:35], s72 offen offset:1024 lds
    v_add_f32 v80, v80, v8
    v_add_f32 v82, v82, v9
    v_fmac_f32 v81, v8, v8
    v_fmac_f32 v83, v9, v9
    v_lshlrev_b32 v10, 16, v41
    v_and_b32 v11, s90, v41
    v_add_f32 v80, v80, v10
    v_add_f32 v82, v82, v11
    v_fmac_f32 v81, v10, v10
    v_fmac_f32 v83, v11, v11
    v_lshlrev_b32 v8, 16, v42
    v_and_b32 v9, s90, v42
    buffer_load_dwordx4 v22, s[32:35], s72 offen offset:2048 lds
    v_add_f32 v80, v80, v8
    v_add_f32 v82, v82, v9
    v_fmac_f32 v81, v8, v8
    v_fmac_f32 v83, v9, v9
    v_lshlrev_b32 v10, 16, v43
    v_and_b32 v11, s90, v43
    v_add_f32 v80, v80, v10
    v_add_f32 v82, v82, v11
    v_fmac_f32 v81, v10, v10
    v_fmac_f32 v83, v11, v11
    v_lshlrev_b32 v8, 16, v44
    v_and_b32 v9, s90, v44
    buffer_load_dwordx4 v23, s[32:35], s72 offen offset:3072 lds
    v_add_f32 v80, v80, v8
    v_add_f32 v82, v82, v9
    v_fmac_f32 v81, v8, v8
    v_fmac_f32 v83, v9, v9
    v_lshlrev_b32 v10, 16, v45
    v_and_b32 v11, s90, v45
    v_add_f32 v80, v80, v10
    v_add_f32 v82, v82, v11
    v_fmac_f32 v81, v10, v10
    v_fmac_f32 v83, v11, v11
    v_lshlrev_b32 v8, 16, v46
    v_and_b32 v9, s90, v46
    s_add_u32 m0, s70, 8192
    s_nop 0
    buffer_load_dwordx4 v24, s[32:35], s72 offen offset:0 lds
    v_add_f32 v80, v80, v8
    v_add_f32 v82, v82, v9
    v_fmac_f32 v81, v8, v8
    v_fmac_f32 v83, v9, v9
    v_lshlrev_b32 v10, 16, v47
    v_and_b32 v11, s90, v47
    v_add_f32 v80, v80, v10
    v_add_f32 v82, v82, v11
    v_fmac_f32 v81, v10, v10
    v_fmac_f32_e64 v83, v11, v11
    buffer_load_dwordx4 v25, s[32:35], s72 offen offset:1024 lds
    s_add_u32 s70, s70, 40960
    s_cmp_ge_u32 s70, 122880
    s_cselect_b32 s76, 122880, 0
    s_sub_u32 s70, s70, s76
    v_add_f32 v80, v80, v82
    v_add_f32 v81, v81, v83
    v_mov_b32 v82, v80
    v_mov_b32 v83, v81
    s_nop 0
    v_permlane32_swap_b32 v80, v82
    v_permlane32_swap_b32 v81, v83
    v_add_f32 v80, v80, v82
    v_add_f32_e64 v81, v81, v83
    s_mov_b32 exec_hi, 0
    buffer_store_dwordx2 v[80:81], v74, s[40:43], s79 offen offset:0 sc1
    s_mov_b64 exec, -1
    s_waitcnt vmcnt(11)
    s_branch L_hbar
L_evw:
    s_mul_i32 s79, s63, 2048
    s_add_u32 s79, s79, s78
    v_add_u32_e64 v4, s79, v73
    s_mul_i32 s79, s63, 20480
    s_add_u32 s79, s79, s78
    v_add_u32_e64 v5, s79, v73
    s_and_b32 s72, s84, 15
    s_mov_b32 m0, s70
    s_lshl_b32 s71, s72, 7
    buffer_load_dwordx4 v16, s[28:31], s71 offen offset:0 lds
    s_mul_i32 s72, s72, 393216
    s_lshr_b64 s[84:85], s[84:85], 4
    ds_read_b64_tr_b16 v[32:33], v4 offset:0
    ds_read_b64_tr_b16 v[34:35], v4 offset:512
    ds_read_b64_tr_b16 v[36:37], v4 offset:10240
    ds_read_b64_tr_b16 v[38:39], v4 offset:10752
    ds_read_b64_tr_b16 v[40:41], v4 offset:20480
    ds_read_b64_tr_b16 v[42:43], v4 offset:20992
    ds_read_b64_tr_b16 v[44:45], v4 offset:30720
    ds_read_b64_tr_b16 v[46:47], v4 offset:31232
    ds_read_b64_tr_b16 v[48:49], v5 offset:4096
    ds_read_b64_tr_b16 v[50:51], v5 offset:4608
    ds_read_b64_tr_b16 v[52:53], v5 offset:14336
    ds_read_b64_tr_b16 v[54:55], v5 offset:14848
    buffer_load_dwordx4 v17, s[28:31], s71 offen offset:1024 lds
    s_lshl_b32 s79, s64, 9
    s_lshl_b32 s80, s63, 3
    s_add_u32 s79, s79, s80
    s_add_u32 s79, s79, s73
    s_waitcnt lgkmcnt(0)
    v_lshlrev_b32 v80, 16, v32
    v_and_b32 v82, s90, v32
    v_lshlrev_b32 v10, 16, v33
    v_and_b32 v11, s90, v33
    v_add_f32 v80, v80, v10
    v_add_f32 v82, v82, v11
    v_lshlrev_b32 v8, 16, v34
    v_and_b32 v9, s90, v34
    v_add_f32 v80, v80, v8
    v_add_f32 v82, v82, v9
    v_lshlrev_b32 v10, 16, v35
    v_and_b32 v11, s90, v35
    buffer_load_dwordx4 v18, s[28:31], s71 offen offset:2048 lds
    v_add_f32 v80, v80, v10
    v_add_f32 v82, v82, v11
    v_lshlrev_b32 v8, 16, v36
    v_and_b32 v9, s90, v36
    v_add_f32 v80, v80, v8
    v_add_f32 v82, v82, v9
    v_lshlrev_b32 v10, 16, v37
    v_and_b32 v11, s90, v37
    v_add_f32 v80, v80, v10
    v_add_f32 v82, v82, v11
    v_lshlrev_b32 v8, 16, v38
    v_and_b32 v9, s90, v38
    buffer_load_dwordx4 v19, s[28:31], s71 offen offset:3072 lds
    v_add_f32 v80, v80, v8
    v_add_f32 v82, v82, v9
    v_lshlrev_b32 v10, 16, v39
    v_and_b32 v11, s90, v39
    v_add_f32 v80, v80, v10
    v_add_f32 v82, v82, v11
    v_lshlrev_b32 v8, 16, v40
    v_and_b32 v9, s90, v40
    v_add_f32 v80, v80, v8
    v_add_f32 v82, v82, v9
    v_lshlrev_b32 v10, 16, v41
    v_and_b32 v11, s90, v41
    s_add_u32 m0, s70, 4096
    s_nop 0
    buffer_load_dwordx4 v20, s[32:35], s72 offen offset:0 lds
    v_add_f32 v80, v80, v10
    v_add_f32 v82, v82, v11
    v_lshlrev_b32 v8, 16, v42
    v_and_b32 v9, s90, v42
    v_add_f32 v80, v80, v8
    v_add_f32 v82, v82, v9
    v_lshlrev_b32 v10, 16, v43
    v_and_b32 v11, s90, v43
    v_add_f32 v80, v80, v10
    v_add_f32 v82, v82, v11
    v_lshlrev_b32 v8, 16, v44
    v_and_b32_e64 v9, s90, v44
    buffer_load_dwordx4 v21, s[32:35], s72 offen offset:1024 lds
    v_add_f32 v80, v80, v8
    v_add_f32 v82, v82, v9
    v_lshlrev_b32 v10, 16, v45
    v_and_b32 v11, s90, v45
    v_add_f32 v80, v80, v10
    v_add_f32 v82, v82, v11
    v_lshlrev_b32 v8, 16, v46
    v_and_b32 v9, s90, v46
    v_add_f32 v80, v80, v8
    v_add_f32 v82, v82, v9
    v_lshlrev_b32 v10, 16, v47
    v_and_b32 v11, s90, v47
    buffer_load_dwordx4 v22, s[32:35], s72 offen offset:2048 lds
    v_add_f32 v80, v80, v10
    v_add_f32 v82, v82, v11
    v_lshlrev_b32 v81, 16, v48
    v_and_b32 v83, s90, v48
    v_lshlrev_b32 v10, 16, v49
    v_and_b32 v11, s90, v49
    v_add_f32 v81, v81, v10
    v_add_f32 v83, v83, v11
    v_lshlrev_b32 v8, 16, v50
    v_and_b32 v9, s90, v50
    v_add_f32 v81, v81, v8
    v_add_f32 v83, v83, v9
    buffer_load_dwordx4 v23, s[32:35], s72 offen offset:3072 lds
    v_lshlrev_b32 v10, 16, v51
    v_and_b32 v11, s90, v51
    v_add_f32 v81, v81, v10
    v_add_f32 v83, v83, v11
    v_lshlrev_b32 v8, 16, v52
    v_and_b32 v9, s90, v52
    v_add_f32 v81, v81, v8
    v_add_f32 v83, v83, v9
    v_lshlrev_b32 v10, 16, v53
    v_and_b32 v11, s90, v53
    v_add_f32 v81, v81, v10
    v_add_f32 v83, v83, v11
    s_add_u32 m0, s70, 8192
    s_nop 0
    buffer_load_dwordx4 v24, s[32:35], s72 offen offset:0 lds
    v_lshlrev_b32 v8, 16, v54
    v_and_b32 v9, s90, v54
    v_add_f32 v81, v81, v8
    v_add_f32 v83, v83, v9
    v_lshlrev_b32 v10, 16, v55
    v_and_b32 v11, s90, v55
    v_add_f32 v81, v81, v10
    v_add_f32_e64 v83, v83, v11
    buffer_load_dwordx4 v25, s[32:35], s72 offen offset:1024 lds
    s_add_u32 s70, s70, 40960
    s_cmp_ge_u32 s70, 122880
    s_cselect_b32 s76, 122880, 0
    s_sub_u32 s70, s70, s76
    v_add_f32 v80, v80, v82
    v_add_f32 v81, v81, v83
    v_mov_b32 v82, v80
    v_mov_b32 v83, v81
    s_nop 0
    v_permlane32_swap_b32 v80, v82
    v_permlane32_swap_b32 v81, v83
    v_add_f32 v80, v80, v82
    v_add_f32_e64 v81, v81, v83
    s_mov_b32 exec_hi, 0
    buffer_store_dwordx2 v[80:81], v12, s[40:43], s79 offen offset:1024 sc1
    s_mov_b64 exec, -1
    s_waitcnt vmcnt(11)
    s_branch L_hbar
L_compute:
    s_setprio 2
    s_and_b32 s63, s62, 1
    s_lshr_b32 s64, s62, 1
    s_lshl_b32 s73, s60, 4
    s_add_u32 s73, s73, s61
    s_mul_i32 s73, s73, 28800
    s_add_u32 s76, s2, 7
    s_and_b32 s76, s76, 7
    s_bfe_u32 s77, s2, 0x10003
    s_lshl1_add_u32 s97, s76, s77
    s_lshr_b32 s98, s2, 4
    s_lshl_b32 s99, s97, 4
    s_add_u32 s99, s99, s98
    s_mul_i32 s99, s99, 9344
    s_add_u32 s99, s99, 8388608
    s_lshr_b32 s65, s97, 1
    s_lshl_b32 s76, s97, 3
    s_add_u32 s65, s65, s76
    s_mul_i32 s76, s98, 4
    s_add_u32 s65, s65, s76
    s_and_b32 s65, s65, 15
    s_mov_b32 s89, 0x3f803f80
    s_mov_b32 s90, 0xffff0000
    v_and_b32 v2, 31, v1
    v_lshrrev_b32 v3, 5, v1
    v_lshlrev_b32 v12, 4, v1
    v_lshrrev_b32 v4, 3, v1
    v_mul_u32_u24 v13, 460800, v4
    v_and_b32_e64 v4, 7, v1
    v_lshl_add_u32 v13, v4, 4, v13
    v_and_b32 v10, 15, v1
    v_lshrrev_b32 v11, 4, v1
    s_mul_i32 s76, s63, 20480
    v_lshrrev_b32 v4, 1, v10
    v_xor_b32 v4, v4, v11
    v_lshlrev_b32_e64 v4, 4, v4
    v_lshl_add_u32 v4, v10, 7, v4
    v_add_u32 v192, s76, v4
    v_xor_b32 v193, 64, v192
    v_bfe_u32 v4, v1, 2, 2
    v_and_b32_e64 v6, 1, v11
    v_lshl_add_u32 v5, v6, 3, v4
    v_lshlrev_b32 v5, 7, v5
    v_lshrrev_b32 v4, 1, v4
    v_xor_b32_e64 v4, s64, v4
    v_lshl_add_u32 v5, v4, 6, v5
    v_lshl_add_u32 v5, v6, 5, v5
    v_and_b32_e64 v4, 3, v1
    v_lshl_add_u32 v5, v4, 3, v5
    v_mul_u32_u24 v4, 10240, v3
    v_add_u32_e64 v5, v5, v4
    v_add_u32 v194, 4096, v5
    v_xor_b32_e64 v195, 32, v194
    v_add_u32 v196, 40960, v192
    v_add_u32 v197, 40960, v193
    v_add_u32 v198, 40960, v194
    v_add_u32 v199, 40960, v195
    v_add_u32 v200, 81920, v192
    v_add_u32 v201, 81920, v193
    v_add_u32 v202, 81920, v194
    v_add_u32 v203, 81920, v195
    v_bfe_u32 v4, v1, 2, 2
    v_lshl_add_u32 v4, v3, 3, v4
    v_lshlrev_b32 v4, 6, v4
    v_and_b32 v5, 1, v11
    v_lshl_add_u32 v4, v5, 5, v4
    v_and_b32_e64 v5, 3, v1
    v_lshl_add_u32 v4, v5, 3, v4
    s_lshl_b32 s76, s64, 11
    s_add_u32 s76, s76, 122880
    v_add_u32_e64 v212, s76, v4
    s_lshl_b32 s76, s63, 9
    v_lshl_add_u32 v213, v10, 3, s76
    v_lshl_add_u32 v214, v2, 3, s76
    s_lshl_b32 s76, s64, 8
    v_lshl_add_u32 v215, v10, 3, s76
    v_bfe_u32 v4, v10, 1, 1
    v_xor_b32 v4, s64, v4
    v_lshrrev_b32 v5, 2, v10
    v_xor_b32 v5, v5, v3
    v_xor_b32 v6, v10, v11
    v_and_b32 v6, 1, v6
    v_lshlrev_b32_e64 v4, 6, v4
    v_lshl_add_u32 v4, v5, 4, v4
    v_lshl_add_u32 v4, v6, 3, v4
    v_lshl_add_u32 v4, v10, 7, v4
    s_lshl_b32 s76, s63, 13
    v_add_u32 v216, s76, v4
    v_bfe_u32 v4, v2, 1, 1
    v_bfe_u32 v5, v2, 2, 2
    v_and_b32 v6, 1, v2
    v_xor_b32 v6, v6, v3
    v_lshlrev_b32_e64 v4, 6, v4
    v_lshl_add_u32 v4, v5, 4, v4
    v_lshl_add_u32 v4, v6, 3, v4
    v_lshl_add_u32 v4, v2, 7, v4
    s_lshl_b32 s77, s64, 14
    s_add_u32 s76, s76, s77
    v_add_u32_e64 v217, s76, v4
    v_bfe_u32 v4, v1, 2, 2
    v_lshl_add_u32 v5, v3, 3, v4
    v_lshlrev_b32 v5, 7, v5
    v_lshrrev_b32 v6, 1, v4
    v_lshl_add_u32 v5, v6, 6, v5
    v_bfe_u32 v6, v1, 4, 1
    v_xor_b32_e64 v6, v6, v3
    v_lshl_add_u32 v5, v6, 5, v5
    v_bfe_u32 v6, v1, 1, 1
    v_lshl_add_u32 v5, v6, 4, v5
    v_xor_b32 v6, v1, v4
    v_and_b32 v6, 1, v6
    v_lshl_add_u32 v5, v6, 3, v5
    s_lshl_b32 s76, s63, 6
    s_or_b32 s76, s76, s77
    v_xor_b32 v218, s76, v5
    s_lshl_b32 s76, s64, 6
    v_xor_b32_e64 v220, s76, v5
    v_xor_b32 v219, 528, v218
    v_xor_b32 v221, 528, v220
    v_cmp_gt_u32 s[86:87], 16, v1
    s_waitcnt lgkmcnt(0)
    s_mov_b32 s40, s26
    s_and_b32 s41, s27, 0xffff
    s_mov_b32 s42, 33554432
    s_mov_b32 s43, 0x20000
    s_mov_b32 s44, s22
    s_and_b32 s45, s23, 0xffff
    s_mov_b32 s46, 4194304
    s_mov_b32 s47, 0x20000
    s_mov_b32 s68, 0
    s_getreg_b32 s101, hwreg(HW_REG_XCC_ID, 0, 4)
    v_mov_b32 v9, 13631488
    s_lshl_b32 s76, s61, 8
    s_lshl4_add_u32 s76, s60, s76
    s_add_u32 s76, s76, 12582912
    v_mov_b32 v8, s76
    s_lshl_b32 s76, s60, 8
    s_lshl4_add_u32 s76, s61, s76
    s_add_u32 s76, s76, 12587008
    v_writelane_b32 v8, s76, 1
    s_lshl_b32 s76, s97, 8
    s_lshl4_add_u32 s76, s98, s76
    s_add_u32 s76, s76, 12591104
    v_writelane_b32 v8, s76, 2
    v_mov_b32 v6, s101
    v_mov_b32 v7, 0
    v_mov_b32_e64 v10, 0
    s_cmp_eq_u32 s62, 0
    s_cbranch_scc0 L_noep
    buffer_load_dwordx2 v[4:5], v9, s[40:43], 0 offen
L_noep:
    s_barrier
    ds_read_b128 v[112:115], v192 offset:0
    ds_read_b64_tr_b16 v[128:129], v194 offset:0
    ds_read_b64_tr_b16 v[130:131], v194 offset:512
    ds_read_b128 v[116:119], v192 offset:2048
    ds_read_b128 v[120:123], v192 offset:10240
    ds_read_b128 v[124:127], v192 offset:12288
    ds_read_b64_tr_b16 v[132:133], v195 offset:0
    ds_read_b64_tr_b16 v[134:135], v195 offset:512
    ds_read_b64_tr_b16 v[136:137], v194 offset:2048
    ds_read_b64_tr_b16 v[138:139], v194 offset:2560
    ds_read_b64_tr_b16 v[140:141], v195 offset:2048
    ds_read_b64_tr_b16 v[142:143], v195 offset:2560
    ds_read_b64_tr_b16 v[144:145], v194 offset:4096
    ds_read_b64_tr_b16 v[146:147], v194 offset:4608
    s_waitcnt lgkmcnt(8)
    ds_read_b64_tr_b16 v[148:149], v195 offset:4096
    ds_read_b64_tr_b16 v[150:151], v195 offset:4608
    v_mfma_f32_16x16x32_bf16 v[16:19], v[128:131], v[112:115], 0
    ds_read_b128 v[152:155], v193 offset:0
    v_mfma_f32_16x16x32_bf16 v[20:23], v[128:131], v[116:119], 0
    ds_read_b64_tr_b16 v[168:169], v194 offset:20480
    v_mfma_f32_16x16x32_bf16 v[24:27], v[128:131], v[120:123], 0
    ds_read_b64_tr_b16 v[170:171], v194 offset:20992
    v_mfma_f32_16x16x32_bf16 v[28:31], v[128:131], v[124:127], 0
    ds_read_b128 v[156:159], v193 offset:2048
    s_waitcnt lgkmcnt(4)
    v_mfma_f32_16x16x32_bf16 v[32:35], v[132:135], v[112:115], 0
    ds_read_b128 v[160:163], v193 offset:10240
    v_mfma_f32_16x16x32_bf16 v[36:39], v[132:135], v[116:119], 0
    ds_read_b128 v[164:167], v193 offset:12288
    v_mfma_f32_16x16x32_bf16 v[40:43], v[132:135], v[120:123], 0
    ds_read_b64_tr_b16 v[172:173], v195 offset:20480
    v_mfma_f32_16x16x32_bf16 v[44:47], v[132:135], v[124:127], 0
    ds_read_b64_tr_b16 v[174:175], v195 offset:20992
    v_mfma_f32_16x16x32_bf16 v[48:51], v[136:139], v[112:115], 0
    ds_read_b64_tr_b16 v[176:177], v194 offset:22528
    v_mfma_f32_16x16x32_bf16 v[52:55], v[136:139], v[116:119], 0
    ds_read_b64_tr_b16 v[178:179], v194 offset:23040
    v_mfma_f32_16x16x32_bf16 v[56:59], v[136:139], v[120:123], 0
    ds_read_b64_tr_b16 v[180:181], v195 offset:22528
    v_mfma_f32_16x16x32_bf16 v[60:63], v[136:139], v[124:127], 0
    ds_read_b64_tr_b16 v[182:183], v195 offset:23040
    v_mfma_f32_16x16x32_bf16 v[64:67], v[140:143], v[112:115], 0
    ds_read_b64_tr_b16 v[184:185], v194 offset:24576
    v_mfma_f32_16x16x32_bf16 v[68:71], v[140:143], v[116:119], 0
    ds_read_b64_tr_b16 v[186:187], v194 offset:25088
    v_mfma_f32_16x16x32_bf16 v[72:75], v[140:143], v[120:123], 0
    ds_read_b64_tr_b16 v[188:189], v195 offset:24576
    v_mfma_f32_16x16x32_bf16 v[76:79], v[140:143], v[124:127], 0
    ds_read_b64_tr_b16 v[190:191], v195 offset:25088
    v_mfma_f32_16x16x32_bf16 v[80:83], v[144:147], v[112:115], 0
    v_mfma_f32_16x16x32_bf16 v[84:87], v[144:147], v[116:119], 0
    v_mfma_f32_16x16x32_bf16 v[88:91], v[144:147], v[120:123], 0
    v_mfma_f32_16x16x32_bf16 v[92:95], v[144:147], v[124:127], 0
    v_mfma_f32_16x16x32_bf16 v[96:99], v[148:151], v[112:115], 0
    v_mfma_f32_16x16x32_bf16 v[100:103], v[148:151], v[116:119], 0
    v_mfma_f32_16x16x32_bf16 v[104:107], v[148:151], v[120:123], 0
    v_mfma_f32_16x16x32_bf16 v[108:111], v[148:151], v[124:127], 0
    s_waitcnt lgkmcnt(0)
    v_mfma_f32_16x16x32_bf16 v[16:19], v[168:171], v[152:155], v[16:19]
    s_barrier
    v_mfma_f32_16x16x32_bf16 v[20:23], v[168:171], v[156:159], v[20:23]
    ds_read_b128 v[112:115], v196 offset:0
    ds_read_b64_tr_b16 v[204:205], v212 offset:0
    ds_read_b64_tr_b16 v[206:207], v212 offset:256
    ds_read_b64_tr_b16 v[208:209], v212 offset:1024
    ds_read_b64_tr_b16 v[210:211], v212 offset:1280
    v_mfma_f32_16x16x32_bf16 v[24:27], v[168:171], v[160:163], v[24:27]
    ds_read_b64_tr_b16 v[128:129], v198 offset:0
    s_cmp_eq_u32 s62, 0
    s_cbranch_scc0 L_cloop
    s_waitcnt vmcnt(0)
    v_add_co_u32 v4, vcc, 1, v4
    s_nop 1
    v_addc_co_u32 v5, vcc, 0, v5, vcc
    s_mov_b64 exec, 7
    buffer_store_dwordx4 v[4:7], v8, s[40:43], 0 offen sc1
    s_mov_b64 exec, -1
.p2align 3
L_cloop:
    v_mfma_f32_16x16x32_bf16 v[28:31], v[168:171], v[164:167], v[28:31]
    ds_read_b64_tr_b16 v[130:131], v198 offset:512
    v_mfma_f32_16x16x32_bf16 v[32:35], v[172:175], v[152:155], v[32:35]
    ds_read_b128 v[116:119], v196 offset:2048
    v_mfma_f32_16x16x32_bf16 v[36:39], v[172:175], v[156:159], v[36:39]
    ds_read_b128 v[120:123], v196 offset:10240
    v_mfma_f32_16x16x32_bf16 v[40:43], v[172:175], v[160:163], v[40:43]
    ds_read_b128 v[124:127], v196 offset:12288
    v_mfma_f32_16x16x32_bf16 v[44:47], v[172:175], v[164:167], v[44:47]
    ds_read_b64_tr_b16 v[132:133], v199 offset:0
    v_mfma_f32_16x16x32_bf16 v[48:51], v[176:179], v[152:155], v[48:51]
    ds_read_b64_tr_b16 v[134:135], v199 offset:512
    v_mfma_f32_16x16x32_bf16 v[52:55], v[176:179], v[156:159], v[52:55]
    ds_read_b64_tr_b16 v[136:137], v198 offset:2048
    v_mfma_f32_16x16x32_bf16 v[56:59], v[176:179], v[160:163], v[56:59]
    ds_read_b64_tr_b16 v[138:139], v198 offset:2560
    v_mfma_f32_16x16x32_bf16 v[60:63], v[176:179], v[164:167], v[60:63]
    ds_read_b64_tr_b16 v[140:141], v199 offset:2048
    v_mfma_f32_16x16x32_bf16 v[64:67], v[180:183], v[152:155], v[64:67]
    ds_read_b64_tr_b16 v[142:143], v199 offset:2560
    v_mfma_f32_16x16x32_bf16 v[68:71], v[180:183], v[156:159], v[68:71]
    ds_read_b64_tr_b16 v[144:145], v198 offset:4096
    v_mfma_f32_16x16x32_bf16 v[72:75], v[180:183], v[160:163], v[72:75]
    ds_read_b64_tr_b16 v[146:147], v198 offset:4608
    v_mfma_f32_16x16x32_bf16 v[76:79], v[180:183], v[164:167], v[76:79]
    ds_read_b64_tr_b16 v[148:149], v199 offset:4096
    v_mfma_f32_16x16x32_bf16 v[80:83], v[184:187], v[152:155], v[80:83]
    ds_read_b64_tr_b16 v[150:151], v199 offset:4608
    v_mfma_f32_16x16x32_bf16 v[84:87], v[184:187], v[156:159], v[84:87]
    v_mfma_f32_16x16x32_bf16 v[88:91], v[184:187], v[160:163], v[88:91]
    v_mfma_f32_16x16x32_bf16 v[92:95], v[184:187], v[164:167], v[92:95]
    v_mfma_f32_16x16x32_bf16 v[96:99], v[188:191], v[152:155], v[96:99]
    v_mfma_f32_16x16x32_bf16 v[100:103], v[188:191], v[156:159], v[100:103]
    v_mfma_f32_16x16x32_bf16 v[104:107], v[188:191], v[160:163], v[104:107]
    v_mfma_f32_16x16x32_bf16 v[108:111], v[188:191], v[164:167], v[108:111]
    s_waitcnt lgkmcnt(0)
    v_mfma_f32_16x16x32_bf16 v[16:19], v[128:131], v[112:115], v[16:19]
    ds_read_b128 v[152:155], v197 offset:0
    v_mfma_f32_16x16x32_bf16 v[20:23], v[128:131], v[116:119], v[20:23]
    ds_read_b64_tr_b16 v[168:169], v198 offset:20480
    v_mfma_f32_16x16x32_bf16 v[24:27], v[128:131], v[120:123], v[24:27]
    ds_read_b64_tr_b16 v[170:171], v198 offset:20992
    v_mfma_f32_16x16x32_bf16 v[28:31], v[128:131], v[124:127], v[28:31]
    ds_read_b128 v[156:159], v197 offset:2048
    v_mfma_f32_16x16x32_bf16 v[32:35], v[132:135], v[112:115], v[32:35]
    ds_read_b128 v[160:163], v197 offset:10240
    v_mfma_f32_16x16x32_bf16 v[36:39], v[132:135], v[116:119], v[36:39]
    ds_read_b128 v[164:167], v197 offset:12288
    v_mfma_f32_16x16x32_bf16 v[40:43], v[132:135], v[120:123], v[40:43]
    ds_read_b64_tr_b16 v[172:173], v199 offset:20480
    v_mfma_f32_16x16x32_bf16 v[44:47], v[132:135], v[124:127], v[44:47]
    ds_read_b64_tr_b16 v[174:175], v199 offset:20992
    v_mfma_f32_16x16x32_bf16 v[48:51], v[136:139], v[112:115], v[48:51]
    ds_read_b64_tr_b16 v[176:177], v198 offset:22528
    v_mfma_f32_16x16x32_bf16 v[52:55], v[136:139], v[116:119], v[52:55]
    ds_read_b64_tr_b16 v[178:179], v198 offset:23040
    v_mfma_f32_16x16x32_bf16 v[56:59], v[136:139], v[120:123], v[56:59]
    ds_read_b64_tr_b16 v[180:181], v199 offset:22528
    v_mfma_f32_16x16x32_bf16 v[60:63], v[136:139], v[124:127], v[60:63]
    ds_read_b64_tr_b16 v[182:183], v199 offset:23040
    v_mfma_f32_16x16x32_bf16 v[64:67], v[140:143], v[112:115], v[64:67]
    ds_read_b64_tr_b16 v[184:185], v198 offset:24576
    v_mfma_f32_16x16x32_bf16 v[68:71], v[140:143], v[116:119], v[68:71]
    ds_read_b64_tr_b16 v[186:187], v198 offset:25088
    v_mfma_f32_16x16x32_bf16 v[72:75], v[140:143], v[120:123], v[72:75]
    ds_read_b64_tr_b16 v[188:189], v199 offset:24576
    v_mfma_f32_16x16x32_bf16 v[76:79], v[140:143], v[124:127], v[76:79]
    ds_read_b64_tr_b16 v[190:191], v199 offset:25088
    v_mfma_f32_16x16x32_bf16 v[80:83], v[144:147], v[112:115], v[80:83]
    v_mfma_f32_16x16x32_bf16 v[84:87], v[144:147], v[116:119], v[84:87]
    v_mfma_f32_16x16x32_bf16 v[88:91], v[144:147], v[120:123], v[88:91]
    v_mfma_f32_16x16x32_bf16 v[92:95], v[144:147], v[124:127], v[92:95]
    v_mfma_f32_16x16x32_bf16 v[96:99], v[148:151], v[112:115], v[96:99]
    v_mfma_f32_16x16x32_bf16 v[100:103], v[148:151], v[116:119], v[100:103]
    v_mfma_f32_16x16x32_bf16 v[104:107], v[148:151], v[120:123], v[104:107]
    v_mfma_f32_16x16x32_bf16 v[108:111], v[148:151], v[124:127], v[108:111]
    s_waitcnt lgkmcnt(0)
    v_mfma_f32_16x16x32_bf16 v[16:19], v[168:171], v[152:155], v[16:19]
    s_barrier
    v_mfma_f32_16x16x32_bf16 v[20:23], v[168:171], v[156:159], v[20:23]
    ds_read_b128 v[112:115], v200 offset:0
    v_mfma_f32_16x16x32_bf16 v[24:27], v[168:171], v[160:163], v[24:27]
    ds_read_b64_tr_b16 v[128:129], v202 offset:0
    v_mfma_f32_16x16x32_bf16 v[28:31], v[168:171], v[164:167], v[28:31]
    ds_read_b64_tr_b16 v[130:131], v202 offset:512
    v_mfma_f32_16x16x32_bf16 v[32:35], v[172:175], v[152:155], v[32:35]
    ds_read_b128 v[116:119], v200 offset:2048
    v_mfma_f32_16x16x32_bf16 v[36:39], v[172:175], v[156:159], v[36:39]
    ds_read_b128 v[120:123], v200 offset:10240
    v_mfma_f32_16x16x32_bf16 v[40:43], v[172:175], v[160:163], v[40:43]
    ds_read_b128 v[124:127], v200 offset:12288
    v_mfma_f32_16x16x32_bf16 v[44:47], v[172:175], v[164:167], v[44:47]
    ds_read_b64_tr_b16 v[132:133], v203 offset:0
    v_mfma_f32_16x16x32_bf16 v[48:51], v[176:179], v[152:155], v[48:51]
    ds_read_b64_tr_b16 v[134:135], v203 offset:512
    v_mfma_f32_16x16x32_bf16 v[52:55], v[176:179], v[156:159], v[52:55]
    ds_read_b64_tr_b16 v[136:137], v202 offset:2048
    v_mfma_f32_16x16x32_bf16 v[56:59], v[176:179], v[160:163], v[56:59]
    ds_read_b64_tr_b16 v[138:139], v202 offset:2560
    v_mfma_f32_16x16x32_bf16 v[60:63], v[176:179], v[164:167], v[60:63]
    ds_read_b64_tr_b16 v[140:141], v203 offset:2048
    v_mfma_f32_16x16x32_bf16 v[64:67], v[180:183], v[152:155], v[64:67]
    ds_read_b64_tr_b16 v[142:143], v203 offset:2560
    v_mfma_f32_16x16x32_bf16 v[68:71], v[180:183], v[156:159], v[68:71]
    ds_read_b64_tr_b16 v[144:145], v202 offset:4096
    v_mfma_f32_16x16x32_bf16 v[72:75], v[180:183], v[160:163], v[72:75]
    ds_read_b64_tr_b16 v[146:147], v202 offset:4608
    v_mfma_f32_16x16x32_bf16 v[76:79], v[180:183], v[164:167], v[76:79]
    ds_read_b64_tr_b16 v[148:149], v203 offset:4096
    v_mfma_f32_16x16x32_bf16 v[80:83], v[184:187], v[152:155], v[80:83]
    ds_read_b64_tr_b16 v[150:151], v203 offset:4608
    v_mfma_f32_16x16x32_bf16 v[84:87], v[184:187], v[156:159], v[84:87]
    v_mfma_f32_16x16x32_bf16 v[88:91], v[184:187], v[160:163], v[88:91]
    v_mfma_f32_16x16x32_bf16 v[92:95], v[184:187], v[164:167], v[92:95]
    v_mfma_f32_16x16x32_bf16 v[96:99], v[188:191], v[152:155], v[96:99]
    v_mfma_f32_16x16x32_bf16 v[100:103], v[188:191], v[156:159], v[100:103]
    v_mfma_f32_16x16x32_bf16 v[104:107], v[188:191], v[160:163], v[104:107]
    v_mfma_f32_16x16x32_bf16 v[108:111], v[188:191], v[164:167], v[108:111]
    s_waitcnt lgkmcnt(0)
    v_mfma_f32_16x16x32_bf16 v[16:19], v[128:131], v[112:115], v[16:19]
    ds_read_b128 v[152:155], v201 offset:0
    v_mfma_f32_16x16x32_bf16 v[20:23], v[128:131], v[116:119], v[20:23]
    ds_read_b64_tr_b16 v[168:169], v202 offset:20480
    v_mfma_f32_16x16x32_bf16 v[24:27], v[128:131], v[120:123], v[24:27]
    ds_read_b64_tr_b16 v[170:171], v202 offset:20992
    v_mfma_f32_16x16x32_bf16 v[28:31], v[128:131], v[124:127], v[28:31]
    ds_read_b128 v[156:159], v201 offset:2048
    v_mfma_f32_16x16x32_bf16 v[32:35], v[132:135], v[112:115], v[32:35]
    ds_read_b128 v[160:163], v201 offset:10240
    v_mfma_f32_16x16x32_bf16 v[36:39], v[132:135], v[116:119], v[36:39]
    ds_read_b128 v[164:167], v201 offset:12288
    v_mfma_f32_16x16x32_bf16 v[40:43], v[132:135], v[120:123], v[40:43]
    ds_read_b64_tr_b16 v[172:173], v203 offset:20480
    v_mfma_f32_16x16x32_bf16 v[44:47], v[132:135], v[124:127], v[44:47]
    ds_read_b64_tr_b16 v[174:175], v203 offset:20992
    v_mfma_f32_16x16x32_bf16 v[48:51], v[136:139], v[112:115], v[48:51]
    ds_read_b64_tr_b16 v[176:177], v202 offset:22528
    v_mfma_f32_16x16x32_bf16 v[52:55], v[136:139], v[116:119], v[52:55]
    ds_read_b64_tr_b16 v[178:179], v202 offset:23040
    v_mfma_f32_16x16x32_bf16 v[56:59], v[136:139], v[120:123], v[56:59]
    ds_read_b64_tr_b16 v[180:181], v203 offset:22528
    v_mfma_f32_16x16x32_bf16 v[60:63], v[136:139], v[124:127], v[60:63]
    ds_read_b64_tr_b16 v[182:183], v203 offset:23040
    v_mfma_f32_16x16x32_bf16 v[64:67], v[140:143], v[112:115], v[64:67]
    ds_read_b64_tr_b16 v[184:185], v202 offset:24576
    v_mfma_f32_16x16x32_bf16 v[68:71], v[140:143], v[116:119], v[68:71]
    ds_read_b64_tr_b16 v[186:187], v202 offset:25088
    v_mfma_f32_16x16x32_bf16 v[72:75], v[140:143], v[120:123], v[72:75]
    ds_read_b64_tr_b16 v[188:189], v203 offset:24576
    v_mfma_f32_16x16x32_bf16 v[76:79], v[140:143], v[124:127], v[76:79]
    ds_read_b64_tr_b16 v[190:191], v203 offset:25088
    v_mfma_f32_16x16x32_bf16 v[80:83], v[144:147], v[112:115], v[80:83]
    v_mfma_f32_16x16x32_bf16 v[84:87], v[144:147], v[116:119], v[84:87]
    v_mfma_f32_16x16x32_bf16 v[88:91], v[144:147], v[120:123], v[88:91]
    v_mfma_f32_16x16x32_bf16 v[92:95], v[144:147], v[124:127], v[92:95]
    v_mfma_f32_16x16x32_bf16 v[96:99], v[148:151], v[112:115], v[96:99]
    v_mfma_f32_16x16x32_bf16 v[100:103], v[148:151], v[116:119], v[100:103]
    v_mfma_f32_16x16x32_bf16 v[104:107], v[148:151], v[120:123], v[104:107]
    v_mfma_f32_16x16x32_bf16 v[108:111], v[148:151], v[124:127], v[108:111]
    s_waitcnt lgkmcnt(0)
    v_mfma_f32_16x16x32_bf16 v[16:19], v[168:171], v[152:155], v[16:19]
    s_barrier
    v_mfma_f32_16x16x32_bf16 v[20:23], v[168:171], v[156:159], v[20:23]
    ds_read_b128 v[112:115], v192 offset:0
    v_mfma_f32_16x16x32_bf16 v[24:27], v[168:171], v[160:163], v[24:27]
    ds_read_b64_tr_b16 v[128:129], v194 offset:0
    v_mfma_f32_16x16x32_bf16 v[28:31], v[168:171], v[164:167], v[28:31]
    ds_read_b64_tr_b16 v[130:131], v194 offset:512
    v_mfma_f32_16x16x32_bf16 v[32:35], v[172:175], v[152:155], v[32:35]
    ds_read_b128 v[116:119], v192 offset:2048
    v_mfma_f32_16x16x32_bf16 v[36:39], v[172:175], v[156:159], v[36:39]
    ds_read_b128 v[120:123], v192 offset:10240
    v_mfma_f32_16x16x32_bf16 v[40:43], v[172:175], v[160:163], v[40:43]
    ds_read_b128 v[124:127], v192 offset:12288
    v_mfma_f32_16x16x32_bf16 v[44:47], v[172:175], v[164:167], v[44:47]
    ds_read_b64_tr_b16 v[132:133], v195 offset:0
    v_mfma_f32_16x16x32_bf16 v[48:51], v[176:179], v[152:155], v[48:51]
    ds_read_b64_tr_b16 v[134:135], v195 offset:512
    v_mfma_f32_16x16x32_bf16 v[52:55], v[176:179], v[156:159], v[52:55]
    ds_read_b64_tr_b16 v[136:137], v194 offset:2048
    v_mfma_f32_16x16x32_bf16 v[56:59], v[176:179], v[160:163], v[56:59]
    ds_read_b64_tr_b16 v[138:139], v194 offset:2560
    v_mfma_f32_16x16x32_bf16 v[60:63], v[176:179], v[164:167], v[60:63]
    ds_read_b64_tr_b16 v[140:141], v195 offset:2048
    v_mfma_f32_16x16x32_bf16 v[64:67], v[180:183], v[152:155], v[64:67]
    ds_read_b64_tr_b16 v[142:143], v195 offset:2560
    v_mfma_f32_16x16x32_bf16 v[68:71], v[180:183], v[156:159], v[68:71]
    ds_read_b64_tr_b16 v[144:145], v194 offset:4096
    v_mfma_f32_16x16x32_bf16 v[72:75], v[180:183], v[160:163], v[72:75]
    ds_read_b64_tr_b16 v[146:147], v194 offset:4608
    v_mfma_f32_16x16x32_bf16 v[76:79], v[180:183], v[164:167], v[76:79]
    ds_read_b64_tr_b16 v[148:149], v195 offset:4096
    v_mfma_f32_16x16x32_bf16 v[80:83], v[184:187], v[152:155], v[80:83]
    ds_read_b64_tr_b16 v[150:151], v195 offset:4608
    v_mfma_f32_16x16x32_bf16 v[84:87], v[184:187], v[156:159], v[84:87]
    v_mfma_f32_16x16x32_bf16 v[88:91], v[184:187], v[160:163], v[88:91]
    v_mfma_f32_16x16x32_bf16 v[92:95], v[184:187], v[164:167], v[92:95]
    v_mfma_f32_16x16x32_bf16 v[96:99], v[188:191], v[152:155], v[96:99]
    v_mfma_f32_16x16x32_bf16 v[100:103], v[188:191], v[156:159], v[100:103]
    v_mfma_f32_16x16x32_bf16 v[104:107], v[188:191], v[160:163], v[104:107]
    v_mfma_f32_16x16x32_bf16 v[108:111], v[188:191], v[164:167], v[108:111]
    s_waitcnt lgkmcnt(0)
    v_mfma_f32_16x16x32_bf16 v[16:19], v[128:131], v[112:115], v[16:19]
    ds_read_b128 v[152:155], v193 offset:0
    v_mfma_f32_16x16x32_bf16 v[20:23], v[128:131], v[116:119], v[20:23]
    ds_read_b64_tr_b16 v[168:169], v194 offset:20480
    v_mfma_f32_16x16x32_bf16 v[24:27], v[128:131], v[120:123], v[24:27]
    ds_read_b64_tr_b16 v[170:171], v194 offset:20992
    v_mfma_f32_16x16x32_bf16 v[28:31], v[128:131], v[124:127], v[28:31]
    ds_read_b128 v[156:159], v193 offset:2048
    v_mfma_f32_16x16x32_bf16 v[32:35], v[132:135], v[112:115], v[32:35]
    ds_read_b128 v[160:163], v193 offset:10240
    v_mfma_f32_16x16x32_bf16 v[36:39], v[132:135], v[116:119], v[36:39]
    ds_read_b128 v[164:167], v193 offset:12288
    v_mfma_f32_16x16x32_bf16 v[40:43], v[132:135], v[120:123], v[40:43]
    ds_read_b64_tr_b16 v[172:173], v195 offset:20480
    v_mfma_f32_16x16x32_bf16 v[44:47], v[132:135], v[124:127], v[44:47]
    ds_read_b64_tr_b16 v[174:175], v195 offset:20992
    v_mfma_f32_16x16x32_bf16 v[48:51], v[136:139], v[112:115], v[48:51]
    ds_read_b64_tr_b16 v[176:177], v194 offset:22528
    v_mfma_f32_16x16x32_bf16 v[52:55], v[136:139], v[116:119], v[52:55]
    ds_read_b64_tr_b16 v[178:179], v194 offset:23040
    v_mfma_f32_16x16x32_bf16 v[56:59], v[136:139], v[120:123], v[56:59]
    ds_read_b64_tr_b16 v[180:181], v195 offset:22528
    v_mfma_f32_16x16x32_bf16 v[60:63], v[136:139], v[124:127], v[60:63]
    ds_read_b64_tr_b16 v[182:183], v195 offset:23040
    v_mfma_f32_16x16x32_bf16 v[64:67], v[140:143], v[112:115], v[64:67]
    ds_read_b64_tr_b16 v[184:185], v194 offset:24576
    v_mfma_f32_16x16x32_bf16 v[68:71], v[140:143], v[116:119], v[68:71]
    ds_read_b64_tr_b16 v[186:187], v194 offset:25088
    v_mfma_f32_16x16x32_bf16 v[72:75], v[140:143], v[120:123], v[72:75]
    ds_read_b64_tr_b16 v[188:189], v195 offset:24576
    v_mfma_f32_16x16x32_bf16 v[76:79], v[140:143], v[124:127], v[76:79]
    ds_read_b64_tr_b16 v[190:191], v195 offset:25088
    v_mfma_f32_16x16x32_bf16 v[80:83], v[144:147], v[112:115], v[80:83]
    v_mfma_f32_16x16x32_bf16 v[84:87], v[144:147], v[116:119], v[84:87]
    v_mfma_f32_16x16x32_bf16 v[88:91], v[144:147], v[120:123], v[88:91]
    v_mfma_f32_16x16x32_bf16 v[92:95], v[144:147], v[124:127], v[92:95]
    v_mfma_f32_16x16x32_bf16 v[96:99], v[148:151], v[112:115], v[96:99]
    s_add_u32 s68, s68, 1
    s_cmp_lt_u32 s68, 5
    v_mfma_f32_16x16x32_bf16 v[100:103], v[148:151], v[116:119], v[100:103]
    v_mfma_f32_16x16x32_bf16 v[104:107], v[148:151], v[120:123], v[104:107]
    v_mfma_f32_16x16x32_bf16 v[108:111], v[148:151], v[124:127], v[108:111]
    s_waitcnt lgkmcnt(0)
    v_mfma_f32_16x16x32_bf16 v[16:19], v[168:171], v[152:155], v[16:19]
    s_cbranch_scc0 L_cexit
    s_barrier
    v_mfma_f32_16x16x32_bf16 v[20:23], v[168:171], v[156:159], v[20:23]
    ds_read_b128 v[112:115], v196 offset:0
    v_mfma_f32_16x16x32_bf16 v[24:27], v[168:171], v[160:163], v[24:27]
    ds_read_b64_tr_b16 v[128:129], v198 offset:0
    s_branch L_cloop
L_cexit:
    v_mfma_f32_16x16x32_bf16 v[20:23], v[168:171], v[156:159], v[20:23]
    v_mfma_f32_16x16x32_bf16 v[24:27], v[168:171], v[160:163], v[24:27]
    v_mfma_f32_16x16x32_bf16 v[28:31], v[168:171], v[164:167], v[28:31]
    v_mfma_f32_16x16x32_bf16 v[32:35], v[172:175], v[152:155], v[32:35]
    v_mfma_f32_16x16x32_bf16 v[36:39], v[172:175], v[156:159], v[36:39]
    v_mfma_f32_16x16x32_bf16 v[40:43], v[172:175], v[160:163], v[40:43]
    v_mfma_f32_16x16x32_bf16 v[44:47], v[172:175], v[164:167], v[44:47]
    v_mfma_f32_16x16x32_bf16 v[48:51], v[176:179], v[152:155], v[48:51]
    v_mfma_f32_16x16x32_bf16 v[52:55], v[176:179], v[156:159], v[52:55]
    v_mfma_f32_16x16x32_bf16 v[56:59], v[176:179], v[160:163], v[56:59]
    s_barrier
    ds_read_b32 v11, v10 offset:53248
    ds_read_b64 v[222:223], v213 offset:49152
    ds_read_b64 v[224:225], v213 offset:49280
    v_mfma_f32_16x16x32_bf16 v[60:63], v[176:179], v[164:167], v[60:63]
    ds_read_b64 v[226:227], v213 offset:49408
    ds_read_b64 v[228:229], v213 offset:49536
    v_mfma_f32_16x16x32_bf16 v[64:67], v[180:183], v[152:155], v[64:67]
    ds_read_b64 v[238:239], v215 offset:50176
    ds_read_b64 v[240:241], v215 offset:50304
    v_mfma_f32_16x16x32_bf16 v[68:71], v[180:183], v[156:159], v[68:71]
    ds_read_b64 v[242:243], v215 offset:50688
    ds_read_b64 v[244:245], v215 offset:50816
    v_mfma_f32_16x16x32_bf16 v[72:75], v[180:183], v[160:163], v[72:75]
    ds_read_b64 v[246:247], v215 offset:51200
    ds_read_b64 v[248:249], v215 offset:51328
    v_mfma_f32_16x16x32_bf16 v[76:79], v[180:183], v[164:167], v[76:79]
    ds_read_b32 v250, v214 offset:49156
    ds_read_b32 v252, v214 offset:49412
    v_mfma_f32_16x16x32_bf16 v[80:83], v[184:187], v[152:155], v[80:83]
    s_waitcnt lgkmcnt(8)
    v_readfirstlane_b32 s100, v11
    v_mov_b32_e64 v230, v223
    v_cndmask_b32 v222, 0, v222, s[86:87]
    v_mfma_f32_16x16x32_bf16 v[84:87], v[184:187], v[156:159], v[84:87]
    v_mov_b32_e64 v232, v225
    v_cndmask_b32 v224, 0, v224, s[86:87]
    v_mov_b32_e64 v234, v227
    v_cndmask_b32 v226, 0, v226, s[86:87]
    v_mfma_f32_16x16x32_bf16 v[88:91], v[184:187], v[160:163], v[88:91]
    v_mov_b32_e64 v236, v229
    v_cndmask_b32 v228, 0, v228, s[86:87]
    v_mov_b32 v223, v222
    v_mov_b32 v225, v224
    v_mfma_f32_16x16x32_bf16 v[92:95], v[184:187], v[164:167], v[92:95]
    v_mov_b32 v227, v226
    v_mov_b32_e64 v229, v228
    s_waitcnt lgkmcnt(0)
    v_mul_f32 v251, 0x3fb8aa3b, v250
    v_mfma_f32_16x16x32_bf16 v[96:99], v[188:191], v[152:155], v[96:99]
    v_mul_f32 v253, 0x3fb8aa3b, v252
    v_mfma_f32_16x16x32_bf16 v[100:103], v[188:191], v[156:159], v[100:103]
    v_mfma_f32_16x16x32_bf16 v[104:107], v[188:191], v[160:163], v[104:107]
    v_mfma_f32_16x16x32_bf16 v[108:111], v[188:191], v[164:167], v[108:111]
    v_mfma_f32_16x16x16_bf16 v[48:51], v[242:243], v[222:223], v[48:51]
    v_xor_b32 v168, 0, v217
    v_xor_b32 v169, 16, v217
    v_mfma_f32_16x16x16_bf16 v[52:55], v[242:243], v[224:225], v[52:55]
    v_xor_b32 v170, 32, v217
    v_xor_b32 v171, 48, v217
    v_mfma_f32_16x16x16_bf16 v[64:67], v[244:245], v[222:223], v[64:67]
    v_xor_b32_e64 v172, 64, v217
    v_xor_b32 v173, 80, v217
    v_mfma_f32_16x16x16_bf16 v[68:71], v[244:245], v[224:225], v[68:71]
    v_xor_b32 v174, 96, v217
    v_xor_b32 v175, 112, v217
    v_mfma_f32_16x16x16_bf16 v[56:59], v[242:243], v[226:227], v[56:59]
    v_xor_b32_e64 v4, 32, v216
    v_mfma_f32_16x16x16_bf16 v[60:63], v[242:243], v[228:229], v[60:63]
    v_mfma_f32_16x16x16_bf16 v[72:75], v[244:245], v[226:227], v[72:75]
    v_mfma_f32_16x16x16_bf16 v[76:79], v[244:245], v[228:229], v[76:79]
    v_mfma_f32_16x16x16_bf16 v[80:83], v[246:247], v[222:223], v[80:83]
    v_cvt_pk_bf16_f32 v112, v48, v49
    v_cvt_pk_bf16_f32 v113, v50, v51
    v_mfma_f32_16x16x16_bf16 v[84:87], v[246:247], v[224:225], v[84:87]
    v_cvt_pk_bf16_f32 v114, v52, v53
    v_cvt_pk_bf16_f32 v115, v54, v55
    v_mfma_f32_16x16x16_bf16 v[88:91], v[246:247], v[226:227], v[88:91]
    v_cvt_pk_bf16_f32 v116, v64, v65
    v_cvt_pk_bf16_f32 v117, v66, v67
    v_mfma_f32_16x16x16_bf16 v[92:95], v[246:247], v[228:229], v[92:95]
    v_cvt_pk_bf16_f32 v118, v68, v69
    v_cvt_pk_bf16_f32 v119, v70, v71
    v_mfma_f32_16x16x16_bf16 v[96:99], v[248:249], v[222:223], v[96:99]
    v_cvt_pk_bf16_f32 v120, v56, v57
    v_cvt_pk_bf16_f32 v121, v58, v59
    v_mfma_f32_16x16x16_bf16 v[100:103], v[248:249], v[224:225], v[100:103]
    v_cvt_pk_bf16_f32 v122, v60, v61
    v_cvt_pk_bf16_f32 v123, v62, v63
    v_mfma_f32_16x16x16_bf16 v[104:107], v[248:249], v[226:227], v[104:107]
    v_permlane16_swap_b32 v112, v114
    v_permlane16_swap_b32 v113, v115
    v_mfma_f32_16x16x16_bf16 v[108:111], v[248:249], v[228:229], v[108:111]
    v_permlane16_swap_b32 v116, v118
    v_permlane16_swap_b32 v117, v119
    v_cvt_pk_bf16_f32 v124, v72, v73
    v_cvt_pk_bf16_f32 v125, v74, v75
    v_cvt_pk_bf16_f32 v126, v76, v77
    v_cvt_pk_bf16_f32 v127, v78, v79
    v_permlane16_swap_b32 v120, v122
    v_permlane16_swap_b32 v121, v123
    v_permlane16_swap_b32 v124, v126
    v_permlane16_swap_b32 v125, v127
    v_mfma_f32_32x32x16_bf16 v[48:63], v[204:207], v[112:115], 0
    v_mul_f32 v80, v80, v230
    v_mul_f32 v81, v81, v230
    v_mul_f32 v82, v82, v230
    v_mul_f32 v83, v83, v230
    v_cvt_pk_bf16_f32 v80, v80, v81
    v_cvt_pk_bf16_f32 v81, v82, v83
    v_mfma_f32_32x32x16_bf16 v[64:79], v[204:207], v[120:123], 0
    v_mul_f32 v96, v96, v230
    v_mul_f32 v97, v97, v230
    v_mul_f32 v98, v98, v230
    v_mul_f32 v99, v99, v230
    v_cvt_pk_bf16_f32 v96, v96, v97
    v_cvt_pk_bf16_f32 v97, v98, v99
    v_mfma_f32_32x32x16_bf16 v[48:63], v[208:211], v[116:119], v[48:63]
    v_mul_f32 v84, v84, v232
    v_mul_f32 v85, v85, v232
    v_mul_f32 v86, v86, v232
    v_mul_f32 v87, v87, v232
    v_cvt_pk_bf16_f32 v84, v84, v85
    v_cvt_pk_bf16_f32 v85, v86, v87
    v_mfma_f32_32x32x16_bf16 v[64:79], v[208:211], v[124:127], v[64:79]
    v_mul_f32 v100, v100, v232
    v_mul_f32 v101, v101, v232
    v_mul_f32 v102, v102, v232
    v_mul_f32 v103, v103, v232
    v_cvt_pk_bf16_f32 v100, v100, v101
    v_cvt_pk_bf16_f32 v101, v102, v103
    v_mul_f32 v88, v88, v234
    v_mul_f32 v89, v89, v234
    v_mul_f32 v90, v90, v234
    v_mul_f32 v91, v91, v234
    v_cvt_pk_bf16_f32 v88, v88, v89
    v_cvt_pk_bf16_f32 v89, v90, v91
    v_mul_f32 v104, v104, v234
    v_mul_f32 v105, v105, v234
    v_mul_f32 v106, v106, v234
    v_mul_f32 v107, v107, v234
    v_cvt_pk_bf16_f32 v104, v104, v105
    v_cvt_pk_bf16_f32 v105, v106, v107
    v_mul_f32 v92, v92, v236
    v_mul_f32 v93, v93, v236
    v_mul_f32 v94, v94, v236
    v_mul_f32 v95, v95, v236
    v_cvt_pk_bf16_f32 v92, v92, v93
    v_cvt_pk_bf16_f32 v93, v94, v95
    v_mul_f32 v108, v108, v236
    v_mul_f32 v109, v109, v236
    v_mul_f32 v110, v110, v236
    v_mul_f32 v111, v111, v236
    v_cvt_pk_bf16_f32 v108, v108, v109
    v_cvt_pk_bf16_f32 v109, v110, v111
    v_max3_f32 v160, v48, v49, v50
    v_min3_f32 v162, v48, v49, v50
    v_max3_f32 v160, v160, v51, v52
    v_min3_f32 v162, v162, v51, v52
    v_max3_f32 v160, v160, v53, v54
    v_min3_f32 v162, v162, v53, v54
    v_max3_f32 v160, v160, v55, v56
    v_min3_f32 v162, v162, v55, v56
    v_max3_f32 v160, v160, v57, v58
    v_min3_f32 v162, v162, v57, v58
    v_max3_f32 v160, v160, v59, v60
    v_min3_f32 v162, v162, v59, v60
    v_max3_f32 v160, v160, v61, v62
    v_min3_f32 v162, v162, v61, v62
    v_max_f32 v160, v160, v63
    v_min_f32 v162, v162, v63
    v_max3_f32 v164, v64, v65, v66
    v_min3_f32 v166, v64, v65, v66
    v_max3_f32 v164, v164, v67, v68
    v_min3_f32 v166, v166, v67, v68
    v_max3_f32 v164, v164, v69, v70
    v_min3_f32 v166, v166, v69, v70
    v_max3_f32 v164, v164, v71, v72
    v_min3_f32 v166, v166, v71, v72
    v_max3_f32 v164, v164, v73, v74
    v_min3_f32 v166, v166, v73, v74
    v_max3_f32 v164, v164, v75, v76
    v_min3_f32 v166, v166, v75, v76
    v_max3_f32 v164, v164, v77, v78
    v_min3_f32 v166, v166, v77, v78
    v_max_f32 v164, v164, v79
    v_min_f32 v166, v166, v79
    v_mov_b32 v161, v160
    v_mov_b32 v163, v162
    v_mov_b32 v165, v164
    v_mov_b32 v167, v166
    v_permlane32_swap_b32 v160, v161
    v_permlane32_swap_b32 v162, v163
    v_permlane32_swap_b32 v164, v165
    v_permlane32_swap_b32 v166, v167
    v_max_f32 v160, v160, v161
    v_min_f32 v162, v162, v163
    v_max_f32 v164, v164, v165
    v_min_f32 v166, v166, v167
    v_mul_f32 v160, v160, v251
    v_mul_f32 v162, v162, v251
    v_mul_f32 v164, v164, v253
    v_mul_f32 v166, v166, v253
    v_pk_fma_f32 v[128:129], v[48:49], v[250:251], v[160:161] op_sel:[0,1,0] op_sel_hi:[1,1,0] neg_lo:[0,0,1] neg_hi:[0,0,1]
    v_pk_fma_f32 v[48:49], v[48:49], v[250:251], v[162:163] op_sel:[0,1,0] op_sel_hi:[1,1,0] neg_lo:[0,1,0] neg_hi:[0,1,0]
    v_pk_fma_f32 v[130:131], v[50:51], v[250:251], v[160:161] op_sel:[0,1,0] op_sel_hi:[1,1,0] neg_lo:[0,0,1] neg_hi:[0,0,1]
    v_pk_fma_f32 v[50:51], v[50:51], v[250:251], v[162:163] op_sel:[0,1,0] op_sel_hi:[1,1,0] neg_lo:[0,1,0] neg_hi:[0,1,0]
    v_pk_fma_f32 v[132:133], v[52:53], v[250:251], v[160:161] op_sel:[0,1,0] op_sel_hi:[1,1,0] neg_lo:[0,0,1] neg_hi:[0,0,1]
    v_pk_fma_f32 v[52:53], v[52:53], v[250:251], v[162:163] op_sel:[0,1,0] op_sel_hi:[1,1,0] neg_lo:[0,1,0] neg_hi:[0,1,0]
    v_pk_fma_f32 v[134:135], v[54:55], v[250:251], v[160:161] op_sel:[0,1,0] op_sel_hi:[1,1,0] neg_lo:[0,0,1] neg_hi:[0,0,1]
    v_pk_fma_f32 v[54:55], v[54:55], v[250:251], v[162:163] op_sel:[0,1,0] op_sel_hi:[1,1,0] neg_lo:[0,1,0] neg_hi:[0,1,0]
    v_pk_fma_f32 v[136:137], v[56:57], v[250:251], v[160:161] op_sel:[0,1,0] op_sel_hi:[1,1,0] neg_lo:[0,0,1] neg_hi:[0,0,1]
    v_pk_fma_f32 v[56:57], v[56:57], v[250:251], v[162:163] op_sel:[0,1,0] op_sel_hi:[1,1,0] neg_lo:[0,1,0] neg_hi:[0,1,0]
    v_pk_fma_f32 v[138:139], v[58:59], v[250:251], v[160:161] op_sel:[0,1,0] op_sel_hi:[1,1,0] neg_lo:[0,0,1] neg_hi:[0,0,1]
    v_pk_fma_f32 v[58:59], v[58:59], v[250:251], v[162:163] op_sel:[0,1,0] op_sel_hi:[1,1,0] neg_lo:[0,1,0] neg_hi:[0,1,0]
    v_pk_fma_f32 v[140:141], v[60:61], v[250:251], v[160:161] op_sel:[0,1,0] op_sel_hi:[1,1,0] neg_lo:[0,0,1] neg_hi:[0,0,1]
    v_pk_fma_f32 v[60:61], v[60:61], v[250:251], v[162:163] op_sel:[0,1,0] op_sel_hi:[1,1,0] neg_lo:[0,1,0] neg_hi:[0,1,0]
    v_pk_fma_f32 v[142:143], v[62:63], v[250:251], v[160:161] op_sel:[0,1,0] op_sel_hi:[1,1,0] neg_lo:[0,0,1] neg_hi:[0,0,1]
    v_pk_fma_f32 v[62:63], v[62:63], v[250:251], v[162:163] op_sel:[0,1,0] op_sel_hi:[1,1,0] neg_lo:[0,1,0] neg_hi:[0,1,0]
    v_pk_fma_f32 v[144:145], v[64:65], v[252:253], v[164:165] op_sel:[0,1,0] op_sel_hi:[1,1,0] neg_lo:[0,0,1] neg_hi:[0,0,1]
    v_pk_fma_f32 v[64:65], v[64:65], v[252:253], v[166:167] op_sel:[0,1,0] op_sel_hi:[1,1,0] neg_lo:[0,1,0] neg_hi:[0,1,0]
    v_pk_fma_f32 v[146:147], v[66:67], v[252:253], v[164:165] op_sel:[0,1,0] op_sel_hi:[1,1,0] neg_lo:[0,0,1] neg_hi:[0,0,1]
    v_pk_fma_f32 v[66:67], v[66:67], v[252:253], v[166:167] op_sel:[0,1,0] op_sel_hi:[1,1,0] neg_lo:[0,1,0] neg_hi:[0,1,0]
    v_pk_fma_f32 v[148:149], v[68:69], v[252:253], v[164:165] op_sel:[0,1,0] op_sel_hi:[1,1,0] neg_lo:[0,0,1] neg_hi:[0,0,1]
    v_pk_fma_f32 v[68:69], v[68:69], v[252:253], v[166:167] op_sel:[0,1,0] op_sel_hi:[1,1,0] neg_lo:[0,1,0] neg_hi:[0,1,0]
    v_pk_fma_f32 v[150:151], v[70:71], v[252:253], v[164:165] op_sel:[0,1,0] op_sel_hi:[1,1,0] neg_lo:[0,0,1] neg_hi:[0,0,1]
    v_pk_fma_f32 v[70:71], v[70:71], v[252:253], v[166:167] op_sel:[0,1,0] op_sel_hi:[1,1,0] neg_lo:[0,1,0] neg_hi:[0,1,0]
    v_pk_fma_f32 v[152:153], v[72:73], v[252:253], v[164:165] op_sel:[0,1,0] op_sel_hi:[1,1,0] neg_lo:[0,0,1] neg_hi:[0,0,1]
    v_pk_fma_f32 v[72:73], v[72:73], v[252:253], v[166:167] op_sel:[0,1,0] op_sel_hi:[1,1,0] neg_lo:[0,1,0] neg_hi:[0,1,0]
    v_pk_fma_f32 v[154:155], v[74:75], v[252:253], v[164:165] op_sel:[0,1,0] op_sel_hi:[1,1,0] neg_lo:[0,0,1] neg_hi:[0,0,1]
    v_pk_fma_f32 v[74:75], v[74:75], v[252:253], v[166:167] op_sel:[0,1,0] op_sel_hi:[1,1,0] neg_lo:[0,1,0] neg_hi:[0,1,0]
    v_pk_fma_f32 v[156:157], v[76:77], v[252:253], v[164:165] op_sel:[0,1,0] op_sel_hi:[1,1,0] neg_lo:[0,0,1] neg_hi:[0,0,1]
    v_pk_fma_f32 v[76:77], v[76:77], v[252:253], v[166:167] op_sel:[0,1,0] op_sel_hi:[1,1,0] neg_lo:[0,1,0] neg_hi:[0,1,0]
    v_pk_fma_f32 v[158:159], v[78:79], v[252:253], v[164:165] op_sel:[0,1,0] op_sel_hi:[1,1,0] neg_lo:[0,0,1] neg_hi:[0,0,1]
    v_pk_fma_f32 v[78:79], v[78:79], v[252:253], v[166:167] op_sel:[0,1,0] op_sel_hi:[1,1,0] neg_lo:[0,1,0] neg_hi:[0,1,0]
    v_exp_f32_e64 v128, v128
    v_mfma_f32_16x16x16_bf16 v[16:19], v[238:239], v[222:223], v[16:19]
    v_exp_f32 v144, v144
    v_exp_f32 v129, v129
    v_exp_f32_e64 v145, v145
    v_mfma_f32_16x16x16_bf16 v[20:23], v[238:239], v[224:225], v[20:23]
    ds_write2st64_b64 v216, v[80:81], v[84:85] offset0:64 offset1:68
    v_exp_f32 v130, v130
    v_exp_f32 v146, v146
    v_exp_f32_e64 v131, v131
    v_mfma_f32_16x16x16_bf16 v[24:27], v[238:239], v[226:227], v[24:27]
    v_exp_f32 v147, v147
    v_exp_f32 v132, v132
    v_exp_f32_e64 v148, v148
    v_mfma_f32_16x16x16_bf16 v[28:31], v[238:239], v[228:229], v[28:31]
    ds_write2st64_b64 v4, v[96:97], v[100:101] offset0:64 offset1:68
    v_exp_f32 v133, v133
    v_exp_f32 v149, v149
    v_exp_f32_e64 v134, v134
    v_mfma_f32_16x16x16_bf16 v[32:35], v[240:241], v[222:223], v[32:35]
    v_exp_f32 v150, v150
    v_exp_f32 v135, v135
    v_exp_f32_e64 v151, v151
    v_mfma_f32_16x16x16_bf16 v[36:39], v[240:241], v[224:225], v[36:39]
    ds_write2st64_b64 v216, v[88:89], v[92:93] offset0:72 offset1:76
    v_exp_f32 v136, v136
    v_exp_f32 v152, v152
    v_exp_f32_e64 v137, v137
    v_mfma_f32_16x16x16_bf16 v[40:43], v[240:241], v[226:227], v[40:43]
    v_exp_f32 v153, v153
    v_exp_f32 v138, v138
    v_exp_f32_e64 v154, v154
    v_mfma_f32_16x16x16_bf16 v[44:47], v[240:241], v[228:229], v[44:47]
    ds_write2st64_b64 v4, v[104:105], v[108:109] offset0:72 offset1:76
    v_exp_f32 v139, v139
    v_exp_f32 v155, v155
    v_exp_f32 v140, v140
    v_exp_f32 v156, v156
    v_exp_f32 v141, v141
    v_exp_f32 v157, v157
    v_exp_f32 v142, v142
    v_exp_f32 v158, v158
    v_exp_f32 v143, v143
    v_exp_f32 v159, v159
    v_pk_add_f32 v[176:177], v[128:129], v[130:131]
    v_pk_add_f32 v[178:179], v[144:145], v[146:147]
    v_pk_add_f32 v[176:177], v[176:177], v[132:133]
    v_pk_add_f32 v[178:179], v[178:179], v[148:149]
    v_pk_add_f32 v[176:177], v[176:177], v[134:135]
    v_pk_add_f32 v[178:179], v[178:179], v[150:151]
    v_pk_add_f32 v[176:177], v[176:177], v[136:137]
    v_pk_add_f32 v[178:179], v[178:179], v[152:153]
    v_pk_add_f32 v[176:177], v[176:177], v[138:139]
    v_pk_add_f32 v[178:179], v[178:179], v[154:155]
    v_pk_add_f32 v[176:177], v[176:177], v[140:141]
    v_pk_add_f32 v[178:179], v[178:179], v[156:157]
    v_pk_add_f32 v[176:177], v[176:177], v[142:143]
    v_pk_add_f32 v[178:179], v[178:179], v[158:159]
    v_exp_f32 v48, v48
    v_add_f32 v176, v176, v177
    v_add_f32 v178, v178, v179
    v_exp_f32 v64, v64
    v_mov_b32 v177, v176
    v_mov_b32 v179, v178
    v_exp_f32 v49, v49
    v_permlane32_swap_b32 v176, v177
    v_permlane32_swap_b32 v178, v179
    v_exp_f32 v65, v65
    v_add_f32 v176, v176, v177
    v_add_f32 v178, v178, v179
    v_exp_f32 v50, v50
    v_rcp_f32 v176, v176
    v_rcp_f32 v178, v178
    v_exp_f32 v66, v66
    v_exp_f32 v51, v51
    v_exp_f32 v67, v67
    v_exp_f32 v52, v52
    v_exp_f32 v68, v68
    v_exp_f32 v53, v53
    v_exp_f32 v69, v69
    v_exp_f32 v54, v54
    v_exp_f32 v70, v70
    v_exp_f32 v55, v55
    v_exp_f32 v71, v71
    v_exp_f32 v56, v56
    v_exp_f32 v72, v72
    v_exp_f32 v57, v57
    v_exp_f32 v73, v73
    v_exp_f32 v58, v58
    v_exp_f32 v74, v74
    v_exp_f32 v59, v59
    v_exp_f32 v75, v75
    v_exp_f32 v60, v60
    v_exp_f32 v76, v76
    v_exp_f32 v61, v61
    v_exp_f32 v77, v77
    v_exp_f32 v62, v62
    v_exp_f32 v78, v78
    v_exp_f32 v63, v63
    v_exp_f32 v79, v79
    v_pk_add_f32 v[180:181], v[48:49], v[50:51]
    v_pk_add_f32 v[182:183], v[64:65], v[66:67]
    v_pk_add_f32 v[180:181], v[180:181], v[52:53]
    v_pk_add_f32 v[182:183], v[182:183], v[68:69]
    v_pk_add_f32 v[180:181], v[180:181], v[54:55]
    v_pk_add_f32 v[182:183], v[182:183], v[70:71]
    v_pk_add_f32 v[180:181], v[180:181], v[56:57]
    v_pk_add_f32 v[182:183], v[182:183], v[72:73]
    v_pk_add_f32 v[180:181], v[180:181], v[58:59]
    v_pk_add_f32 v[182:183], v[182:183], v[74:75]
    v_pk_add_f32 v[180:181], v[180:181], v[60:61]
    v_pk_add_f32 v[182:183], v[182:183], v[76:77]
    v_pk_add_f32 v[180:181], v[180:181], v[62:63]
    v_pk_add_f32 v[182:183], v[182:183], v[78:79]
    v_add_f32 v180, v180, v181
    v_add_f32 v182, v182, v183
    v_mov_b32 v181, v180
    v_mov_b32 v183, v182
    v_pk_mul_f32 v[128:129], v[128:129], v[176:177] op_sel_hi:[1,0]
    v_pk_mul_f32 v[130:131], v[130:131], v[176:177] op_sel_hi:[1,0]
    v_cvt_pk_bf16_f32 v128, v128, v129
    v_permlane32_swap_b32 v180, v181
    v_permlane32_swap_b32 v182, v183
    v_cvt_pk_bf16_f32 v129, v130, v131
    v_pk_mul_f32 v[144:145], v[144:145], v[178:179] op_sel_hi:[1,0]
    v_pk_mul_f32 v[146:147], v[146:147], v[178:179] op_sel_hi:[1,0]
    v_cvt_pk_bf16_f32 v144, v144, v145
    v_cvt_pk_bf16_f32 v145, v146, v147
    v_add_f32 v180, v180, v181
    v_add_f32 v182, v182, v183
    ds_write2st64_b64 v168, v[128:129], v[144:145] offset0:0 offset1:8
    v_pk_mul_f32 v[132:133], v[132:133], v[176:177] op_sel_hi:[1,0]
    v_pk_mul_f32 v[134:135], v[134:135], v[176:177] op_sel_hi:[1,0]
    v_cvt_pk_bf16_f32 v132, v132, v133
    v_cvt_pk_bf16_f32 v133, v134, v135
    v_pk_mul_f32 v[148:149], v[148:149], v[178:179] op_sel_hi:[1,0]
    v_rcp_f32 v180, v180
    v_rcp_f32 v182, v182
    v_pk_mul_f32 v[150:151], v[150:151], v[178:179] op_sel_hi:[1,0]
    v_cvt_pk_bf16_f32 v148, v148, v149
    v_cvt_pk_bf16_f32 v149, v150, v151
    ds_write2st64_b64 v169, v[132:133], v[148:149] offset0:0 offset1:8
    v_pk_mul_f32 v[136:137], v[136:137], v[176:177] op_sel_hi:[1,0]
    v_pk_mul_f32 v[138:139], v[138:139], v[176:177] op_sel_hi:[1,0]
    v_cvt_pk_bf16_f32 v136, v136, v137
    v_cvt_pk_bf16_f32 v137, v138, v139
    v_pk_mul_f32 v[152:153], v[152:153], v[178:179] op_sel_hi:[1,0]
    v_pk_mul_f32 v[154:155], v[154:155], v[178:179] op_sel_hi:[1,0]
    v_cvt_pk_bf16_f32 v152, v152, v153
    v_cvt_pk_bf16_f32 v153, v154, v155
    ds_write2st64_b64 v170, v[136:137], v[152:153] offset0:0 offset1:8
    v_pk_mul_f32 v[140:141], v[140:141], v[176:177] op_sel_hi:[1,0]
    v_pk_mul_f32 v[142:143], v[142:143], v[176:177] op_sel_hi:[1,0]
    v_cvt_pk_bf16_f32 v140, v140, v141
    v_cvt_pk_bf16_f32 v141, v142, v143
    v_pk_mul_f32 v[156:157], v[156:157], v[178:179] op_sel_hi:[1,0]
    v_pk_mul_f32 v[158:159], v[158:159], v[178:179] op_sel_hi:[1,0]
    v_cvt_pk_bf16_f32 v156, v156, v157
    v_cvt_pk_bf16_f32 v157, v158, v159
    ds_write2st64_b64 v171, v[140:141], v[156:157] offset0:0 offset1:8
    v_pk_mul_f32 v[48:49], v[48:49], v[180:181] op_sel_hi:[1,0]
    v_pk_mul_f32 v[50:51], v[50:51], v[180:181] op_sel_hi:[1,0]
    v_cvt_pk_bf16_f32 v48, v48, v49
    v_cvt_pk_bf16_f32 v49, v50, v51
    v_pk_mul_f32 v[64:65], v[64:65], v[182:183] op_sel_hi:[1,0]
    v_pk_mul_f32 v[66:67], v[66:67], v[182:183] op_sel_hi:[1,0]
    v_cvt_pk_bf16_f32 v64, v64, v65
    v_cvt_pk_bf16_f32 v65, v66, v67
    ds_write2st64_b64 v172, v[48:49], v[64:65] offset0:0 offset1:8
    v_pk_mul_f32 v[52:53], v[52:53], v[180:181] op_sel_hi:[1,0]
    v_pk_mul_f32 v[54:55], v[54:55], v[180:181] op_sel_hi:[1,0]
    v_cvt_pk_bf16_f32 v52, v52, v53
    v_cvt_pk_bf16_f32 v53, v54, v55
    v_pk_mul_f32 v[68:69], v[68:69], v[182:183] op_sel_hi:[1,0]
    v_pk_mul_f32 v[70:71], v[70:71], v[182:183] op_sel_hi:[1,0]
    v_cvt_pk_bf16_f32 v68, v68, v69
    v_cvt_pk_bf16_f32 v69, v70, v71
    ds_write2st64_b64 v173, v[52:53], v[68:69] offset0:0 offset1:8
    v_pk_mul_f32 v[56:57], v[56:57], v[180:181] op_sel_hi:[1,0]
    v_pk_mul_f32 v[58:59], v[58:59], v[180:181] op_sel_hi:[1,0]
    v_cvt_pk_bf16_f32 v56, v56, v57
    v_cvt_pk_bf16_f32 v57, v58, v59
    v_pk_mul_f32 v[72:73], v[72:73], v[182:183] op_sel_hi:[1,0]
    v_pk_mul_f32 v[74:75], v[74:75], v[182:183] op_sel_hi:[1,0]
    v_cvt_pk_bf16_f32 v72, v72, v73
    v_cvt_pk_bf16_f32 v73, v74, v75
    ds_write2st64_b64 v174, v[56:57], v[72:73] offset0:0 offset1:8
    v_pk_mul_f32 v[60:61], v[60:61], v[180:181] op_sel_hi:[1,0]
    v_pk_mul_f32 v[62:63], v[62:63], v[180:181] op_sel_hi:[1,0]
    v_cvt_pk_bf16_f32 v60, v60, v61
    v_cvt_pk_bf16_f32 v61, v62, v63
    v_pk_mul_f32 v[76:77], v[76:77], v[182:183] op_sel_hi:[1,0]
    v_pk_mul_f32 v[78:79], v[78:79], v[182:183] op_sel_hi:[1,0]
    v_cvt_pk_bf16_f32 v76, v76, v77
    v_cvt_pk_bf16_f32 v77, v78, v79
    ds_write2st64_b64 v175, v[60:61], v[76:77] offset0:0 offset1:8
    s_waitcnt lgkmcnt(0)
    s_barrier
    ds_read_b64_tr_b16 v[112:113], v218 offset:0
    ds_read_b64_tr_b16 v[114:115], v219 offset:0
    ds_read_b64_tr_b16 v[144:145], v220 offset:32768
    ds_read_b64_tr_b16 v[146:147], v221 offset:32768
    ds_read_b64_tr_b16 v[116:117], v218 offset:2048
    ds_read_b64_tr_b16 v[118:119], v219 offset:2048
    ds_read_b64_tr_b16 v[148:149], v220 offset:34816
    ds_read_b64_tr_b16 v[150:151], v221 offset:34816
    ds_read_b64_tr_b16 v[120:121], v218 offset:4096
    ds_read_b64_tr_b16 v[122:123], v219 offset:4096
    ds_read_b64_tr_b16 v[152:153], v220 offset:36864
    ds_read_b64_tr_b16 v[154:155], v221 offset:36864
    v_cvt_pk_bf16_f32 v176, v16, v17
    v_cvt_pk_bf16_f32 v177, v18, v19
    v_cvt_pk_bf16_f32 v178, v20, v21
    v_cvt_pk_bf16_f32 v179, v22, v23
    v_cvt_pk_bf16_f32 v180, v32, v33
    v_cvt_pk_bf16_f32 v181, v34, v35
    v_cvt_pk_bf16_f32 v182, v36, v37
    v_cvt_pk_bf16_f32 v183, v38, v39
    v_cvt_pk_bf16_f32 v184, v24, v25
    v_cvt_pk_bf16_f32 v185, v26, v27
    v_cvt_pk_bf16_f32 v186, v28, v29
    v_cvt_pk_bf16_f32 v187, v30, v31
    v_cvt_pk_bf16_f32 v188, v40, v41
    v_cvt_pk_bf16_f32 v189, v42, v43
    v_cvt_pk_bf16_f32 v190, v44, v45
    v_cvt_pk_bf16_f32 v191, v46, v47
    s_waitcnt lgkmcnt(8)
    v_mfma_f32_32x32x16_bf16 v[48:63], v[112:115], v[144:147], 0
    ds_read_b64_tr_b16 v[124:125], v218 offset:6144
    ds_read_b64_tr_b16 v[126:127], v219 offset:6144
    ds_read_b64_tr_b16 v[156:157], v220 offset:38912
    ds_read_b64_tr_b16 v[158:159], v221 offset:38912
    s_waitcnt lgkmcnt(8)
    v_mfma_f32_32x32x16_bf16 v[48:63], v[116:119], v[148:151], v[48:63]
    ds_read_b64_tr_b16 v[128:129], v218 offset:8192
    ds_read_b64_tr_b16 v[130:131], v219 offset:8192
    ds_read_b64_tr_b16 v[160:161], v220 offset:40960
    ds_read_b64_tr_b16 v[162:163], v221 offset:40960
    s_waitcnt lgkmcnt(8)
    v_mfma_f32_32x32x16_bf16 v[48:63], v[120:123], v[152:155], v[48:63]
    ds_read_b64_tr_b16 v[132:133], v218 offset:10240
    ds_read_b64_tr_b16 v[134:135], v219 offset:10240
    ds_read_b64_tr_b16 v[164:165], v220 offset:43008
    ds_read_b64_tr_b16 v[166:167], v221 offset:43008
    s_waitcnt lgkmcnt(8)
    v_mfma_f32_32x32x16_bf16 v[48:63], v[124:127], v[156:159], v[48:63]
    ds_read_b64_tr_b16 v[136:137], v218 offset:12288
    ds_read_b64_tr_b16 v[138:139], v219 offset:12288
    ds_read_b64_tr_b16 v[168:169], v220 offset:45056
    ds_read_b64_tr_b16 v[170:171], v221 offset:45056
    s_waitcnt lgkmcnt(8)
    v_mfma_f32_32x32x16_bf16 v[48:63], v[128:131], v[160:163], v[48:63]
    ds_read_b64_tr_b16 v[140:141], v218 offset:14336
    ds_read_b64_tr_b16 v[142:143], v219 offset:14336
    ds_read_b64_tr_b16 v[172:173], v220 offset:47104
    ds_read_b64_tr_b16 v[174:175], v221 offset:47104
    s_waitcnt lgkmcnt(8)
    v_mfma_f32_32x32x16_bf16 v[48:63], v[132:135], v[164:167], v[48:63]
    v_permlane16_swap_b32 v176, v178
    v_permlane16_swap_b32_e64 v177, v179
    s_waitcnt lgkmcnt(4)
    v_mfma_f32_32x32x16_bf16 v[48:63], v[136:139], v[168:171], v[48:63]
    v_permlane16_swap_b32 v180, v182
    v_permlane16_swap_b32 v181, v183
    v_permlane16_swap_b32 v184, v186
    s_waitcnt lgkmcnt(0)
    v_mfma_f32_32x32x16_bf16 v[48:63], v[140:143], v[172:175], v[48:63]
    s_barrier
    v_permlane16_swap_b32 v185, v187
    v_permlane16_swap_b32 v188, v190
    v_permlane16_swap_b32 v189, v191
    s_lshl_b32 s76, s62, 11
    s_add_u32 s76, s76, s73
    v_mfma_f32_32x32x16_bf16 v[16:31], v[204:207], v[176:179], 0
    s_add_u32 s76, s76, 4096
    s_lshl_b32 s77, s62, 7
    s_add_u32 s77, s77, s73
    v_lshlrev_b32_e64 v4, 2, v2
    v_mfma_f32_32x32x16_bf16 v[32:47], v[204:207], v[184:187], 0
    v_cvt_pk_bf16_f32 v64, v48, v49
    v_cvt_pk_bf16_f32 v65, v50, v51
    v_cvt_pk_bf16_f32 v66, v52, v53
    v_cvt_pk_bf16_f32 v67, v54, v55
    v_cvt_pk_bf16_f32 v68, v56, v57
    v_mfma_f32_32x32x16_bf16 v[16:31], v[208:211], v[180:183], v[16:31]
    v_cvt_pk_bf16_f32 v69, v58, v59
    v_cvt_pk_bf16_f32 v70, v60, v61
    v_cvt_pk_bf16_f32 v71, v62, v63
    s_bitcmp1_b32 s100, 0
    s_cbranch_scc1 L_loc_51
    buffer_store_dwordx4 v[64:67], v12, s[40:43], s76 offen offset:0 sc1
    buffer_store_dwordx4 v[68:71], v12, s[40:43], s76 offen offset:1024 sc1
    s_branch L_pubd_52
L_loc_51:
    buffer_store_dwordx4 v[64:67], v12, s[40:43], s76 offen offset:0
    buffer_store_dwordx4 v[68:71], v12, s[40:43], s76 offen offset:1024
L_pubd_52:
    v_mfma_f32_32x32x16_bf16 v[32:47], v[208:211], v[188:191], v[32:47]
    v_and_b32 v216, 1, v1
    v_lshlrev_b32_e64 v216, 8, v216
    v_lshl_add_u32 v216, v3, 4, v216
    s_lshl_b32 s76, s64, 7
    v_add_u32 v216, s76, v216
    s_mul_i32 s78, s61, 28800
    s_lshl_b32 s79, s64, 8
    s_add_u32 s78, s78, s79
    s_add_u32 s79, s78, 3686400
    v_dot2_f32_bf16 v72, v112, s89, 0
    v_dot2_f32_bf16 v73, v113, s89, 0
    v_dot2_f32_bf16 v72, v114, s89, v72
    v_dot2_f32_bf16 v73, v115, s89, v73
    v_dot2_f32_bf16 v72, v116, s89, v72
    v_dot2_f32_bf16 v73, v117, s89, v73
    v_dot2_f32_bf16 v72, v118, s89, v72
    v_dot2_f32_bf16 v73, v119, s89, v73
    v_dot2_f32_bf16 v72, v120, s89, v72
    v_dot2_f32_bf16 v73, v121, s89, v73
    v_dot2_f32_bf16 v72, v122, s89, v72
    v_dot2_f32_bf16 v73, v123, s89, v73
    v_dot2_f32_bf16 v72, v124, s89, v72
    v_dot2_f32_bf16 v73, v125, s89, v73
    v_dot2_f32_bf16 v72, v126, s89, v72
    v_dot2_f32_bf16 v73, v127, s89, v73
    v_dot2_f32_bf16 v72, v128, s89, v72
    v_dot2_f32_bf16 v73, v129, s89, v73
    v_dot2_f32_bf16 v72, v130, s89, v72
    v_dot2_f32_bf16 v73, v131, s89, v73
    v_dot2_f32_bf16 v72, v132, s89, v72
    v_dot2_f32_bf16 v73, v133, s89, v73
    v_dot2_f32_bf16 v72, v134, s89, v72
    v_dot2_f32_bf16 v73, v135, s89, v73
    v_dot2_f32_bf16 v72, v136, s89, v72
    v_dot2_f32_bf16 v73, v137, s89, v73
    v_dot2_f32_bf16 v72, v138, s89, v72
    v_dot2_f32_bf16 v73, v139, s89, v73
    v_dot2_f32_bf16 v72, v140, s89, v72
    v_dot2_f32_bf16 v73, v141, s89, v73
    v_dot2_f32_bf16 v72, v142, s89, v72
    v_dot2_f32_bf16 v73, v143, s89, v73
    s_lshl_b32 s76, s98, 7
    v_lshl_add_u32 v10, v3, 3, s76
    v_lshlrev_b32 v11, 5, v1
    v_add_f32 v72, v72, v73
    v_mov_b32 v73, v72
    s_nop 1
    v_permlane32_swap_b32 v72, v73
    v_add_f32 v72, v72, v73
    s_mov_b32 exec_hi, 0
    s_bitcmp1_b32 s100, 0
    s_cbranch_scc1 L_loc_53
    buffer_store_dword v72, v4, s[40:43], s77 offen offset:2048 sc1
    s_branch L_pubd_54
L_loc_53:
    buffer_store_dword v72, v4, s[40:43], s77 offen offset:2048
L_pubd_54:
    s_mov_b64 exec, -1
    v_max3_f32 v160, v16, v17, v18
    v_min3_f32 v162, v16, v17, v18
    v_max3_f32 v160, v160, v19, v20
    v_min3_f32 v162, v162, v19, v20
    v_max3_f32 v160, v160, v21, v22
    v_min3_f32 v162, v162, v21, v22
    v_max3_f32 v160, v160, v23, v24
    v_min3_f32 v162, v162, v23, v24
    v_max3_f32 v160, v160, v25, v26
    v_min3_f32 v162, v162, v25, v26
    v_max3_f32 v160, v160, v27, v28
    v_min3_f32 v162, v162, v27, v28
    v_max3_f32 v160, v160, v29, v30
    v_min3_f32 v162, v162, v29, v30
    v_max_f32 v160, v160, v31
    v_min_f32 v162, v162, v31
    v_max3_f32 v164, v32, v33, v34
    v_min3_f32 v166, v32, v33, v34
    v_max3_f32 v164, v164, v35, v36
    v_min3_f32 v166, v166, v35, v36
    v_max3_f32 v164, v164, v37, v38
    v_min3_f32 v166, v166, v37, v38
    v_max3_f32 v164, v164, v39, v40
    v_min3_f32 v166, v166, v39, v40
    v_max3_f32 v164, v164, v41, v42
    v_min3_f32 v166, v166, v41, v42
    v_max3_f32 v164, v164, v43, v44
    v_min3_f32 v166, v166, v43, v44
    v_max3_f32 v164, v164, v45, v46
    v_min3_f32 v166, v166, v45, v46
    v_max_f32 v164, v164, v47
    v_min_f32 v166, v166, v47
    v_mov_b32 v161, v160
    v_mov_b32 v163, v162
    v_mov_b32 v165, v164
    v_mov_b32 v167, v166
    v_permlane32_swap_b32 v160, v161
    v_permlane32_swap_b32 v162, v163
    v_permlane32_swap_b32 v164, v165
    v_permlane32_swap_b32 v166, v167
    v_max_f32 v160, v160, v161
    v_min_f32 v162, v162, v163
    v_max_f32 v164, v164, v165
    v_min_f32 v166, v166, v167
    v_mul_f32 v160, v160, v251
    v_mul_f32 v162, v162, v251
    v_mul_f32 v164, v164, v253
    v_mul_f32 v166, v166, v253
    v_pk_fma_f32 v[128:129], v[16:17], v[250:251], v[160:161] op_sel:[0,1,0] op_sel_hi:[1,1,0] neg_lo:[0,0,1] neg_hi:[0,0,1]
    v_pk_fma_f32 v[16:17], v[16:17], v[250:251], v[162:163] op_sel:[0,1,0] op_sel_hi:[1,1,0] neg_lo:[0,1,0] neg_hi:[0,1,0]
    v_pk_fma_f32 v[130:131], v[18:19], v[250:251], v[160:161] op_sel:[0,1,0] op_sel_hi:[1,1,0] neg_lo:[0,0,1] neg_hi:[0,0,1]
    v_pk_fma_f32 v[18:19], v[18:19], v[250:251], v[162:163] op_sel:[0,1,0] op_sel_hi:[1,1,0] neg_lo:[0,1,0] neg_hi:[0,1,0]
    v_pk_fma_f32 v[132:133], v[20:21], v[250:251], v[160:161] op_sel:[0,1,0] op_sel_hi:[1,1,0] neg_lo:[0,0,1] neg_hi:[0,0,1]
    v_pk_fma_f32 v[20:21], v[20:21], v[250:251], v[162:163] op_sel:[0,1,0] op_sel_hi:[1,1,0] neg_lo:[0,1,0] neg_hi:[0,1,0]
    v_pk_fma_f32 v[134:135], v[22:23], v[250:251], v[160:161] op_sel:[0,1,0] op_sel_hi:[1,1,0] neg_lo:[0,0,1] neg_hi:[0,0,1]
    v_pk_fma_f32 v[22:23], v[22:23], v[250:251], v[162:163] op_sel:[0,1,0] op_sel_hi:[1,1,0] neg_lo:[0,1,0] neg_hi:[0,1,0]
    v_pk_fma_f32 v[136:137], v[24:25], v[250:251], v[160:161] op_sel:[0,1,0] op_sel_hi:[1,1,0] neg_lo:[0,0,1] neg_hi:[0,0,1]
    v_pk_fma_f32 v[24:25], v[24:25], v[250:251], v[162:163] op_sel:[0,1,0] op_sel_hi:[1,1,0] neg_lo:[0,1,0] neg_hi:[0,1,0]
    v_pk_fma_f32 v[138:139], v[26:27], v[250:251], v[160:161] op_sel:[0,1,0] op_sel_hi:[1,1,0] neg_lo:[0,0,1] neg_hi:[0,0,1]
    v_pk_fma_f32 v[26:27], v[26:27], v[250:251], v[162:163] op_sel:[0,1,0] op_sel_hi:[1,1,0] neg_lo:[0,1,0] neg_hi:[0,1,0]
    v_pk_fma_f32 v[140:141], v[28:29], v[250:251], v[160:161] op_sel:[0,1,0] op_sel_hi:[1,1,0] neg_lo:[0,0,1] neg_hi:[0,0,1]
    v_pk_fma_f32 v[28:29], v[28:29], v[250:251], v[162:163] op_sel:[0,1,0] op_sel_hi:[1,1,0] neg_lo:[0,1,0] neg_hi:[0,1,0]
    v_pk_fma_f32 v[142:143], v[30:31], v[250:251], v[160:161] op_sel:[0,1,0] op_sel_hi:[1,1,0] neg_lo:[0,0,1] neg_hi:[0,0,1]
    v_pk_fma_f32 v[30:31], v[30:31], v[250:251], v[162:163] op_sel:[0,1,0] op_sel_hi:[1,1,0] neg_lo:[0,1,0] neg_hi:[0,1,0]
    v_pk_fma_f32 v[144:145], v[32:33], v[252:253], v[164:165] op_sel:[0,1,0] op_sel_hi:[1,1,0] neg_lo:[0,0,1] neg_hi:[0,0,1]
    v_pk_fma_f32 v[32:33], v[32:33], v[252:253], v[166:167] op_sel:[0,1,0] op_sel_hi:[1,1,0] neg_lo:[0,1,0] neg_hi:[0,1,0]
    v_pk_fma_f32 v[146:147], v[34:35], v[252:253], v[164:165] op_sel:[0,1,0] op_sel_hi:[1,1,0] neg_lo:[0,0,1] neg_hi:[0,0,1]
    v_pk_fma_f32 v[34:35], v[34:35], v[252:253], v[166:167] op_sel:[0,1,0] op_sel_hi:[1,1,0] neg_lo:[0,1,0] neg_hi:[0,1,0]
    v_pk_fma_f32 v[148:149], v[36:37], v[252:253], v[164:165] op_sel:[0,1,0] op_sel_hi:[1,1,0] neg_lo:[0,0,1] neg_hi:[0,0,1]
    v_pk_fma_f32 v[36:37], v[36:37], v[252:253], v[166:167] op_sel:[0,1,0] op_sel_hi:[1,1,0] neg_lo:[0,1,0] neg_hi:[0,1,0]
    v_pk_fma_f32 v[150:151], v[38:39], v[252:253], v[164:165] op_sel:[0,1,0] op_sel_hi:[1,1,0] neg_lo:[0,0,1] neg_hi:[0,0,1]
    v_pk_fma_f32 v[38:39], v[38:39], v[252:253], v[166:167] op_sel:[0,1,0] op_sel_hi:[1,1,0] neg_lo:[0,1,0] neg_hi:[0,1,0]
    v_pk_fma_f32 v[152:153], v[40:41], v[252:253], v[164:165] op_sel:[0,1,0] op_sel_hi:[1,1,0] neg_lo:[0,0,1] neg_hi:[0,0,1]
    v_pk_fma_f32 v[40:41], v[40:41], v[252:253], v[166:167] op_sel:[0,1,0] op_sel_hi:[1,1,0] neg_lo:[0,1,0] neg_hi:[0,1,0]
    v_pk_fma_f32 v[154:155], v[42:43], v[252:253], v[164:165] op_sel:[0,1,0] op_sel_hi:[1,1,0] neg_lo:[0,0,1] neg_hi:[0,0,1]
    v_pk_fma_f32 v[42:43], v[42:43], v[252:253], v[166:167] op_sel:[0,1,0] op_sel_hi:[1,1,0] neg_lo:[0,1,0] neg_hi:[0,1,0]
    v_pk_fma_f32 v[156:157], v[44:45], v[252:253], v[164:165] op_sel:[0,1,0] op_sel_hi:[1,1,0] neg_lo:[0,0,1] neg_hi:[0,0,1]
    v_pk_fma_f32 v[44:45], v[44:45], v[252:253], v[166:167] op_sel:[0,1,0] op_sel_hi:[1,1,0] neg_lo:[0,1,0] neg_hi:[0,1,0]
    v_pk_fma_f32 v[158:159], v[46:47], v[252:253], v[164:165] op_sel:[0,1,0] op_sel_hi:[1,1,0] neg_lo:[0,0,1] neg_hi:[0,0,1]
    v_pk_fma_f32 v[46:47], v[46:47], v[252:253], v[166:167] op_sel:[0,1,0] op_sel_hi:[1,1,0] neg_lo:[0,1,0] neg_hi:[0,1,0]
    v_exp_f32 v128, v128
    v_exp_f32 v16, v16
    v_exp_f32 v129, v129
    v_exp_f32 v17, v17
    v_exp_f32 v130, v130
    v_exp_f32 v18, v18
    v_exp_f32 v131, v131
    v_exp_f32 v19, v19
    v_exp_f32 v132, v132
    v_exp_f32 v20, v20
    v_exp_f32 v133, v133
    v_exp_f32 v21, v21
    v_exp_f32 v134, v134
    v_exp_f32 v22, v22
    v_exp_f32 v135, v135
    v_exp_f32 v23, v23
    v_exp_f32 v136, v136
    v_exp_f32 v24, v24
    v_exp_f32 v137, v137
    v_exp_f32 v25, v25
    v_exp_f32 v138, v138
    v_exp_f32 v26, v26
    v_exp_f32 v139, v139
    v_exp_f32 v27, v27
    v_exp_f32 v140, v140
    v_exp_f32 v28, v28
    v_exp_f32 v141, v141
    v_exp_f32 v29, v29
    v_exp_f32 v142, v142
    v_exp_f32 v30, v30
    v_exp_f32 v143, v143
    v_exp_f32 v31, v31
    v_cvt_pk_bf16_f32 v218, v128, v129
    v_cvt_pk_bf16_f32 v219, v130, v131
    v_cvt_pk_bf16_f32 v220, v132, v133
    v_cvt_pk_bf16_f32 v221, v134, v135
    v_cvt_pk_bf16_f32 v222, v136, v137
    v_cvt_pk_bf16_f32 v223, v138, v139
    v_cvt_pk_bf16_f32 v224, v140, v141
    v_cvt_pk_bf16_f32 v225, v142, v143
    v_cvt_pk_bf16_f32 v226, v16, v17
    v_cvt_pk_bf16_f32 v227, v18, v19
    v_cvt_pk_bf16_f32 v228, v20, v21
    v_cvt_pk_bf16_f32 v229, v22, v23
    v_cvt_pk_bf16_f32 v230, v24, v25
    v_cvt_pk_bf16_f32 v231, v26, v27
    v_cvt_pk_bf16_f32 v232, v28, v29
    v_cvt_pk_bf16_f32 v233, v30, v31
    v_exp_f32 v144, v144
    v_exp_f32 v32, v32
    v_exp_f32 v145, v145
    v_exp_f32 v33, v33
    v_exp_f32 v146, v146
    v_exp_f32 v34, v34
    v_exp_f32 v147, v147
    v_exp_f32_e64 v35, v35
    s_barrier
    buffer_load_dwordx4 v[48:51], v13, s[40:43], s78 offen offset:3072 sc1
    buffer_load_dwordx4 v[52:55], v13, s[40:43], s79 offen offset:3072 sc1
    buffer_load_dwordx4 v[56:59], v13, s[40:43], s78 offen offset:3200 sc1
    buffer_load_dwordx4 v[60:63], v13, s[40:43], s79 offen offset:3200 sc1
    ds_read_b128 v[168:171], v216 offset:24576
    ds_read_b128 v[172:175], v216 offset:24608
    ds_read_b128 v[176:179], v216 offset:24640
    ds_read_b128 v[180:183], v216 offset:24672
    v_exp_f32 v148, v148
    v_exp_f32 v36, v36
    v_exp_f32 v149, v149
    v_exp_f32 v37, v37
    v_exp_f32 v150, v150
    v_exp_f32 v38, v38
    v_exp_f32 v151, v151
    v_exp_f32 v39, v39
    v_exp_f32 v152, v152
    v_exp_f32_e64 v40, v40
    s_waitcnt lgkmcnt(0)
    v_mfma_f32_32x32x16_bf16 v[64:79], v[168:171], v[218:221], 0
    v_exp_f32 v153, v153
    v_exp_f32 v41, v41
    v_exp_f32_e64 v154, v154
    v_mfma_f32_32x32x16_bf16 v[80:95], v[176:179], v[226:229], 0
    v_exp_f32 v42, v42
    v_exp_f32 v155, v155
    v_exp_f32_e64 v43, v43
    v_mfma_f32_32x32x16_bf16 v[64:79], v[172:175], v[222:225], v[64:79]
    v_exp_f32 v156, v156
    v_exp_f32 v44, v44
    v_exp_f32_e64 v157, v157
    v_mfma_f32_32x32x16_bf16 v[80:95], v[180:183], v[230:233], v[80:95]
    v_exp_f32 v45, v45
    v_exp_f32 v158, v158
    v_exp_f32 v46, v46
    v_exp_f32 v159, v159
    v_exp_f32_e64 v47, v47
    v_cvt_pk_bf16_f32 v234, v144, v145
    v_cvt_pk_bf16_f32 v235, v146, v147
    v_cvt_pk_bf16_f32 v236, v148, v149
    v_cvt_pk_bf16_f32 v237, v150, v151
    v_cvt_pk_bf16_f32 v238, v152, v153
    v_cvt_pk_bf16_f32 v239, v154, v155
    v_cvt_pk_bf16_f32 v240, v156, v157
    v_cvt_pk_bf16_f32 v241, v158, v159
    v_cvt_pk_bf16_f32 v242, v32, v33
    v_cvt_pk_bf16_f32 v243, v34, v35
    v_cvt_pk_bf16_f32 v244, v36, v37
    v_cvt_pk_bf16_f32 v245, v38, v39
    v_cvt_pk_bf16_f32 v246, v40, v41
    v_cvt_pk_bf16_f32 v247, v42, v43
    v_cvt_pk_bf16_f32 v248, v44, v45
    v_cvt_pk_bf16_f32 v249, v46, v47
    v_mfma_f32_32x32x16_bf16 v[96:111], v[168:171], v[234:237], 0
    v_rcp_f32 v184, v65
    v_rcp_f32 v185, v81
    v_mul_f32 v6, v64, v184
    v_fmac_f32 v6, v80, v185
    v_add_f32 v6, 0x358637bd, v6
    v_mfma_f32_32x32x16_bf16 v[112:127], v[176:179], v[242:245], 0
    v_rcp_f32 v6, v6
    v_mov_b32 v8, 0
    v_mul_f32 v184, v184, v6
    v_mul_f32_e64 v185, v185, v6
    s_lshl4_add_u32 s76, s60, s61
    v_mfma_f32_32x32x16_bf16 v[96:111], v[172:175], v[238:241], v[96:111]
    s_mul_i32 s76, s76, 32768
    s_lshl2_add_u32 s77, s63, s64
    s_lshl_b32 s77, s77, 12
    s_add_u32 s76, s76, s77
    s_add_u32 s76, s76, 16777216
    v_mfma_f32_32x32x16_bf16 v[112:127], v[180:183], v[246:249], v[112:127]
    s_add_u32 s77, s76, 8192
    v_add_u32 v14, 128, v12
    v_cmp_gt_u32 vcc, 24, v1
    s_nop 0
    s_nop 0
    v_cndmask_b32_e64 v14, v14, v12, vcc
    s_mov_b32 s88, 0
    s_branch L_pfirst_56
L_poll_55:
    buffer_load_dwordx4 v[48:51], v13, s[40:43], s78 offen offset:3072 sc1
    buffer_load_dwordx4 v[52:55], v13, s[40:43], s79 offen offset:3072 sc1
    buffer_load_dwordx4 v[56:59], v13, s[40:43], s78 offen offset:3200 sc1
    buffer_load_dwordx4 v[60:63], v13, s[40:43], s79 offen offset:3200 sc1
L_pfirst_56:
    s_waitcnt vmcnt(0)
    v_max3_u32 v9, v48, v49, v50
    v_max3_u32 v9, v9, v51, v52
    v_max3_u32 v9, v9, v53, v54
    v_max3_u32 v9, v9, v55, v56
    v_max3_u32 v9, v9, v57, v58
    v_max3_u32 v9, v9, v59, v60
    v_max3_u32 v9, v9, v61, v62
    v_max_u32 v9, v9, v63
    v_cmp_eq_u32 vcc, -1, v9
    s_nop 0
    s_cbranch_vccz L_ok_57
    s_add_u32 s88, s88, 1
    s_cmp_lt_u32 s88, 65536
    s_cbranch_scc1 L_poll_55
L_ok_57:
    v_mfma_f32_32x32x16_bf16 v[16:31], v[48:51], v[218:221], 0
    s_barrier
    v_rcp_f32 v186, v97
    v_rcp_f32 v187, v113
    v_mul_f32 v7, v96, v186
    v_fmac_f32 v7, v112, v187
    v_mfma_f32_32x32x16_bf16 v[128:143], v[56:59], v[226:229], 0
    v_add_f32 v7, 0x358637bd, v7
    v_rcp_f32 v7, v7
    v_mov_b32 v8, 0
    v_mul_f32_e64 v186, v186, v7
    v_mfma_f32_32x32x16_bf16 v[16:31], v[52:55], v[222:225], v[16:31]
    v_mul_f32_e64 v187, v187, v7
    global_load_dwordx2 v[192:193], v10, s[14:15] offset:0
    global_load_dwordx2 v[194:195], v10, s[14:15] offset:16
    global_load_dwordx2 v[196:197], v10, s[14:15] offset:32
    v_mfma_f32_32x32x16_bf16 v[128:143], v[60:63], v[230:233], v[128:143]
    global_load_dwordx2 v[198:199], v10, s[14:15] offset:48
    global_load_dwordx2 v[200:201], v10, s[14:15] offset:64
    global_load_dwordx2 v[202:203], v10, s[14:15] offset:80
    global_load_dwordx2 v[204:205], v10, s[14:15] offset:96
    v_mfma_f32_32x32x16_bf16 v[32:47], v[48:51], v[234:237], 0
    global_load_dwordx2 v[206:207], v10, s[14:15] offset:112
    global_load_dwordx4 v[208:211], v11, s[14:15] offset:0
    global_load_dwordx4 v[212:215], v11, s[14:15] offset:16
    v_mfma_f32_32x32x16_bf16 v[144:159], v[56:59], v[242:245], 0
    v_mul_f32 v16, v16, v184
    v_mul_f32 v17, v17, v184
    v_mul_f32 v18, v18, v184
    v_mul_f32 v19, v19, v184
    v_mul_f32 v20, v20, v184
    v_mul_f32 v21, v21, v184
    v_mfma_f32_32x32x16_bf16 v[32:47], v[52:55], v[238:241], v[32:47]
    v_mul_f32 v22, v22, v184
    v_mul_f32 v23, v23, v184
    v_mul_f32 v24, v24, v184
    v_mul_f32 v25, v25, v184
    v_mul_f32 v26, v26, v184
    v_mul_f32 v27, v27, v184
    v_mfma_f32_32x32x16_bf16 v[144:159], v[60:63], v[246:249], v[144:159]
    v_mul_f32 v28, v28, v184
    v_mul_f32 v29, v29, v184
    v_mul_f32 v30, v30, v184
    v_mul_f32 v31, v31, v184
    v_fmac_f32 v16, v128, v185
    v_fmac_f32 v17, v129, v185
    v_cvt_pk_bf16_f32 v64, v16, v17
    v_fmac_f32 v18, v130, v185
    v_fmac_f32 v19, v131, v185
    v_cvt_pk_bf16_f32 v65, v18, v19
    v_fmac_f32 v20, v132, v185
    v_fmac_f32 v21, v133, v185
    v_cvt_pk_bf16_f32 v66, v20, v21
    v_fmac_f32 v22, v134, v185
    v_fmac_f32 v23, v135, v185
    v_cvt_pk_bf16_f32 v67, v22, v23
    buffer_store_dwordx4 v[64:67], v14, s[40:43], s76 offen offset:0 sc1
    v_fmac_f32 v24, v136, v185
    v_fmac_f32 v25, v137, v185
    v_cvt_pk_bf16_f32 v68, v24, v25
    v_fmac_f32 v26, v138, v185
    v_fmac_f32 v27, v139, v185
    v_cvt_pk_bf16_f32 v69, v26, v27
    v_fmac_f32 v28, v140, v185
    v_fmac_f32 v29, v141, v185
    v_cvt_pk_bf16_f32 v70, v28, v29
    v_fmac_f32 v30, v142, v185
    v_fmac_f32 v31, v143, v185
    v_cvt_pk_bf16_f32 v71, v30, v31
    buffer_store_dwordx4 v[68:71], v14, s[40:43], s76 offen offset:2048 sc1
    v_pk_mul_f32 v[32:33], v[32:33], v[186:187] op_sel_hi:[1,0]
    v_pk_fma_f32 v[32:33], v[144:145], v[186:187], v[32:33] op_sel:[0,1,0] op_sel_hi:[1,1,1]
    v_cvt_pk_bf16_f32 v72, v32, v33
    v_pk_mul_f32 v[34:35], v[34:35], v[186:187] op_sel_hi:[1,0]
    v_pk_fma_f32 v[34:35], v[146:147], v[186:187], v[34:35] op_sel:[0,1,0] op_sel_hi:[1,1,1]
    v_cvt_pk_bf16_f32 v73, v34, v35
    v_pk_mul_f32 v[36:37], v[36:37], v[186:187] op_sel_hi:[1,0]
    v_pk_fma_f32 v[36:37], v[148:149], v[186:187], v[36:37] op_sel:[0,1,0] op_sel_hi:[1,1,1]
    v_cvt_pk_bf16_f32 v74, v36, v37
    v_pk_mul_f32 v[38:39], v[38:39], v[186:187] op_sel_hi:[1,0]
    v_pk_fma_f32 v[38:39], v[150:151], v[186:187], v[38:39] op_sel:[0,1,0] op_sel_hi:[1,1,1]
    v_cvt_pk_bf16_f32 v75, v38, v39
    buffer_store_dwordx4 v[72:75], v14, s[40:43], s77 offen offset:0 sc1
    v_pk_mul_f32 v[40:41], v[40:41], v[186:187] op_sel_hi:[1,0]
    v_pk_fma_f32 v[40:41], v[152:153], v[186:187], v[40:41] op_sel:[0,1,0] op_sel_hi:[1,1,1]
    v_cvt_pk_bf16_f32 v76, v40, v41
    v_pk_mul_f32 v[42:43], v[42:43], v[186:187] op_sel_hi:[1,0]
    v_pk_fma_f32 v[42:43], v[154:155], v[186:187], v[42:43] op_sel:[0,1,0] op_sel_hi:[1,1,1]
    v_cvt_pk_bf16_f32 v77, v42, v43
    v_pk_mul_f32 v[44:45], v[44:45], v[186:187] op_sel_hi:[1,0]
    v_pk_fma_f32 v[44:45], v[156:157], v[186:187], v[44:45] op_sel:[0,1,0] op_sel_hi:[1,1,1]
    v_cvt_pk_bf16_f32 v78, v44, v45
    v_pk_mul_f32 v[46:47], v[46:47], v[186:187] op_sel_hi:[1,0]
    v_pk_fma_f32 v[46:47], v[158:159], v[186:187], v[46:47] op_sel:[0,1,0] op_sel_hi:[1,1,1]
    v_cvt_pk_bf16_f32 v79, v46, v47
    buffer_store_dwordx4 v[76:79], v14, s[40:43], s77 offen offset:2048 sc1
    v_bfe_u32 v4, v2, 1, 3
    v_lshlrev_b32_e64 v4, 4, v4
    v_lshl_add_u32 v4, v3, 3, v4
    v_lshl_add_u32 v4, v2, 7, v4
    s_lshl_b32 s76, s62, 12
    s_add_u32 s77, s76, 0
    v_add_u32 v64, s77, v4
    v_xor_b32 v65, 16, v64
    v_xor_b32 v66, 32, v64
    v_xor_b32 v67, 48, v64
    v_xor_b32_e64 v68, 64, v64
    v_xor_b32 v69, 80, v64
    v_xor_b32 v70, 96, v64
    v_xor_b32 v71, 112, v64
    v_bfe_u32 v4, v1, 2, 2
    v_lshl_add_u32 v5, v3, 2, v4
    v_lshlrev_b32 v5, 7, v5
    v_lshrrev_b32 v4, 1, v4
    v_lshl_add_u32 v5, v4, 6, v5
    v_bfe_u32 v4, v1, 4, 1
    v_lshl_add_u32 v5, v4, 5, v5
    v_and_b32_e64 v4, 3, v1
    v_lshl_add_u32 v5, v4, 3, v5
    v_add_u32 v72, 32768, v5
    v_xor_b32_e64 v73, 64, v72
    s_mul_i32 s80, s97, 524288
    s_mul_i32 s76, s62, 8192
    s_add_u32 s80, s80, s76
    s_add_u32 s80, s80, 16777216
    v_add_u32 v78, 4096, v14
    v_mov_b32 v74, 1
    s_mov_b32 s52, 0xffff
    s_mov_b32 s53, 0
    s_barrier
    ds_read_b32 v79, v8 offset:25984
    ds_read_b64 v[88:89], v64
    ds_read_b64 v[90:91], v65
    ds_read_b64 v[92:93], v66
    ds_read_b64 v[94:95], v67
    ds_read_b64 v[96:97], v68
    ds_read_b64 v[98:99], v69
    ds_read_b64 v[100:101], v70
    ds_read_b64 v[102:103], v71
    s_waitcnt lgkmcnt(8)
    v_readfirstlane_b32 s76, v79
    s_nop 0
    s_and_b32 s76, s76, s52
    s_cbranch_scc0 L_tr0
L_bk0:
    s_ff1_i32_b32 s76, s76
    s_bitset0_b32 s52, s76
    s_add_u32 s77, s76, s65
    s_and_b32 s77, s77, 15
    s_mul_i32 s77, s77, 32768
    s_add_u32 s28, s77, s80
    s_add_u32 s76, s76, 3
    s_and_b32 s76, s76, 15
    s_lshl_b32 s4, s76, 13
    buffer_load_dwordx4 v[128:131], v14, s[40:43], s28 offen offset:0 sc1
    buffer_load_dwordx4 v[132:135], v14, s[40:43], s28 offen offset:2048 sc1
    buffer_load_dwordx4 v[136:139], v78, s[40:43], s28 offen offset:0 sc1
    buffer_load_dwordx4 v[140:143], v78, s[40:43], s28 offen offset:2048 sc1
    v_readfirstlane_b32 s76, v79
    s_nop 0
    s_and_b32 s76, s76, s52
    s_cbranch_scc0 L_tr1
L_bk1:
    s_ff1_i32_b32 s76, s76
    s_bitset0_b32 s52, s76
    s_add_u32 s77, s76, s65
    s_and_b32 s77, s77, 15
    s_mul_i32 s77, s77, 32768
    s_add_u32 s29, s77, s80
    s_add_u32 s76, s76, 3
    s_and_b32 s76, s76, 15
    s_lshl_b32 s5, s76, 13
    buffer_load_dwordx4 v[144:147], v14, s[40:43], s29 offen offset:0 sc1
    buffer_load_dwordx4 v[148:151], v14, s[40:43], s29 offen offset:2048 sc1
    v_add_u32 v80, s4, v72
    v_add_u32 v81, s4, v73
    s_waitcnt lgkmcnt(0)
    v_lshlrev_b32 v16, 16, v88
    v_and_b32 v17, s90, v88
    v_lshlrev_b32 v18, 16, v89
    v_and_b32 v19, s90, v89
    v_lshlrev_b32 v20, 16, v90
    v_and_b32 v21, s90, v90
    v_lshlrev_b32 v22, 16, v91
    v_and_b32 v23, s90, v91
    v_lshlrev_b32 v24, 16, v92
    v_and_b32 v25, s90, v92
    v_lshlrev_b32 v26, 16, v93
    v_and_b32 v27, s90, v93
    v_lshlrev_b32 v28, 16, v94
    v_and_b32 v29, s90, v94
    v_lshlrev_b32 v30, 16, v95
    v_and_b32 v31, s90, v95
    v_lshlrev_b32 v32, 16, v96
    v_and_b32 v33, s90, v96
    v_lshlrev_b32 v34, 16, v97
    v_and_b32 v35, s90, v97
    v_lshlrev_b32 v36, 16, v98
    v_and_b32 v37, s90, v98
    v_lshlrev_b32 v38, 16, v99
    v_and_b32 v39, s90, v99
    v_lshlrev_b32 v40, 16, v100
    v_and_b32 v41, s90, v100
    v_lshlrev_b32 v42, 16, v101
    v_and_b32 v43, s90, v101
    v_lshlrev_b32 v44, 16, v102
    v_and_b32 v45, s90, v102
    v_lshlrev_b32 v46, 16, v103
    v_and_b32 v47, s90, v103
    s_cmp_eq_u32 s53, 0
    s_cbranch_scc0 L_sent_58
    s_waitcnt vmcnt(6)
    s_mov_b64 exec, 1
    ds_add_u32 v8, v74 offset:25988
    s_mov_b64 exec, -1
    s_mov_b32 s53, 1
L_sent_58:
    ds_read_b32 v79, v8 offset:25984
    ds_read_b64_tr_b16 v[104:105], v80 offset:0
    ds_read_b64_tr_b16 v[106:107], v80 offset:1024
    ds_read_b64_tr_b16 v[108:109], v81 offset:0
    ds_read_b64_tr_b16 v[110:111], v81 offset:1024
    ds_read_b64_tr_b16 v[112:113], v80 offset:2048
    ds_read_b64_tr_b16 v[114:115], v80 offset:3072
    ds_read_b64_tr_b16 v[116:117], v81 offset:2048
    ds_read_b64_tr_b16 v[118:119], v81 offset:3072
    s_waitcnt vmcnt(5) lgkmcnt(4)
    v_mfma_f32_32x32x16_bf16 v[16:31], v[104:107], v[128:131], v[16:31]
    ds_read_b64_tr_b16 v[120:121], v80 offset:4096
    ds_read_b64_tr_b16 v[122:123], v80 offset:5120
    buffer_load_dwordx4 v[152:155], v78, s[40:43], s29 offen offset:0 sc1
    v_mfma_f32_32x32x16_bf16 v[32:47], v[108:111], v[128:131], v[32:47]
    ds_read_b64_tr_b16 v[124:125], v81 offset:4096
    ds_read_b64_tr_b16 v[126:127], v81 offset:5120
    buffer_load_dwordx4 v[156:159], v78, s[40:43], s29 offen offset:2048 sc1
    v_readfirstlane_b32 s76, v79
    s_nop 0
    s_and_b32 s76, s76, s52
    s_cbranch_scc0 L_tr2
L_bk2:
    s_ff1_i32_b32 s76, s76
    s_bitset0_b32 s52, s76
    s_add_u32 s77, s76, s65
    s_and_b32 s77, s77, 15
    s_mul_i32 s77, s77, 32768
    s_add_u32 s30, s77, s80
    s_waitcnt vmcnt(6) lgkmcnt(4)
    v_mfma_f32_32x32x16_bf16 v[16:31], v[112:115], v[132:135], v[16:31]
    ds_read_b32 v79, v8 offset:25984
    ds_read_b64_tr_b16 v[104:105], v80 offset:6144
    ds_read_b64_tr_b16 v[106:107], v80 offset:7168
    buffer_load_dwordx4 v[160:163], v14, s[40:43], s30 offen offset:0 sc1
    s_add_u32 s76, s76, 3
    s_and_b32 s76, s76, 15
    s_lshl_b32 s6, s76, 13
    v_mfma_f32_32x32x16_bf16 v[32:47], v[116:119], v[132:135], v[32:47]
    ds_read_b64_tr_b16 v[108:109], v81 offset:6144
    ds_read_b64_tr_b16 v[110:111], v81 offset:7168
    buffer_load_dwordx4 v[164:167], v14, s[40:43], s30 offen offset:2048 sc1
    v_add_u32 v82, s5, v72
    v_add_u32_e64 v83, s5, v73
    s_waitcnt vmcnt(7) lgkmcnt(4)
    v_mfma_f32_32x32x16_bf16 v[16:31], v[120:123], v[136:139], v[16:31]
    ds_read_b64_tr_b16 v[112:113], v82 offset:0
    ds_read_b64_tr_b16 v[114:115], v82 offset:1024
    buffer_load_dwordx4 v[168:171], v78, s[40:43], s30 offen offset:0 sc1
    v_mfma_f32_32x32x16_bf16 v[32:47], v[124:127], v[136:139], v[32:47]
    ds_read_b64_tr_b16 v[116:117], v83 offset:0
    ds_read_b64_tr_b16 v[118:119], v83 offset:1024
    buffer_load_dwordx4 v[172:175], v78, s[40:43], s30 offen offset:2048 sc1
    v_readfirstlane_b32 s76, v79
    s_nop 0
    s_and_b32 s76, s76, s52
    s_cbranch_scc0 L_tr3
L_bk3:
    s_ff1_i32_b32 s76, s76
    s_bitset0_b32 s52, s76
    s_add_u32 s77, s76, s65
    s_and_b32 s77, s77, 15
    s_mul_i32 s77, s77, 32768
    s_add_u32 s31, s77, s80
    s_waitcnt vmcnt(8) lgkmcnt(4)
    v_mfma_f32_32x32x16_bf16 v[16:31], v[104:107], v[140:143], v[16:31]
    ds_read_b32 v79, v8 offset:25984
    ds_read_b64_tr_b16 v[120:121], v82 offset:2048
    ds_read_b64_tr_b16 v[122:123], v82 offset:3072
    buffer_load_dwordx4 v[176:179], v14, s[40:43], s31 offen offset:0 sc1
    s_add_u32 s76, s76, 3
    s_and_b32 s76, s76, 15
    s_lshl_b32 s7, s76, 13
    v_mfma_f32_32x32x16_bf16 v[32:47], v[108:111], v[140:143], v[32:47]
    ds_read_b64_tr_b16 v[124:125], v83 offset:2048
    ds_read_b64_tr_b16 v[126:127], v83 offset:3072
    buffer_load_dwordx4 v[180:183], v14, s[40:43], s31 offen offset:2048 sc1
    s_waitcnt vmcnt(9) lgkmcnt(4)
    v_mfma_f32_32x32x16_bf16 v[16:31], v[112:115], v[144:147], v[16:31]
    ds_read_b64_tr_b16 v[104:105], v82 offset:4096
    ds_read_b64_tr_b16 v[106:107], v82 offset:5120
    buffer_load_dwordx4 v[184:187], v78, s[40:43], s31 offen offset:0 sc1
    v_mfma_f32_32x32x16_bf16 v[32:47], v[116:119], v[144:147], v[32:47]
    ds_read_b64_tr_b16 v[108:109], v83 offset:4096
    ds_read_b64_tr_b16 v[110:111], v83 offset:5120
    buffer_load_dwordx4 v[188:191], v78, s[40:43], s31 offen offset:2048 sc1
    v_readfirstlane_b32 s76, v79
    s_nop 0
    s_and_b32 s76, s76, s52
    s_cbranch_scc0 L_tr4
L_bk4:
    s_ff1_i32_b32 s76, s76
    s_bitset0_b32 s52, s76
    s_add_u32 s77, s76, s65
    s_and_b32 s77, s77, 15
    s_mul_i32 s77, s77, 32768
    s_add_u32 s32, s77, s80
    s_waitcnt vmcnt(10) lgkmcnt(4)
    v_mfma_f32_32x32x16_bf16 v[16:31], v[120:123], v[148:151], v[16:31]
    ds_read_b64_tr_b16 v[112:113], v82 offset:6144
    ds_read_b64_tr_b16 v[114:115], v82 offset:7168
    buffer_load_dwordx4 v[128:131], v14, s[40:43], s32 offen offset:0 sc1
    s_add_u32 s76, s76, 3
    s_and_b32 s76, s76, 15
    s_lshl_b32 s8, s76, 13
    v_mfma_f32_32x32x16_bf16 v[32:47], v[124:127], v[148:151], v[32:47]
    ds_read_b64_tr_b16 v[116:117], v83 offset:6144
    ds_read_b64_tr_b16 v[118:119], v83 offset:7168
    buffer_load_dwordx4 v[132:135], v14, s[40:43], s32 offen offset:2048 sc1
    v_add_u32 v80, s6, v72
    v_add_u32 v81, s6, v73
    s_waitcnt vmcnt(11) lgkmcnt(4)
    v_mfma_f32_32x32x16_bf16 v[16:31], v[104:107], v[152:155], v[16:31]
    ds_read_b32 v79, v8 offset:25984
    ds_read_b64_tr_b16 v[120:121], v80 offset:0
    ds_read_b64_tr_b16 v[122:123], v80 offset:1024
    buffer_load_dwordx4 v[136:139], v78, s[40:43], s32 offen offset:0 sc1
    v_mfma_f32_32x32x16_bf16 v[32:47], v[108:111], v[152:155], v[32:47]
    ds_read_b64_tr_b16 v[124:125], v81 offset:0
    ds_read_b64_tr_b16 v[126:127], v81 offset:1024
    s_waitcnt vmcnt(11) lgkmcnt(4)
    v_mfma_f32_32x32x16_bf16 v[16:31], v[112:115], v[156:159], v[16:31]
    ds_read_b64_tr_b16 v[104:105], v80 offset:2048
    ds_read_b64_tr_b16 v[106:107], v80 offset:3072
    buffer_load_dwordx4 v[140:143], v78, s[40:43], s32 offen offset:2048 sc1
    v_mfma_f32_32x32x16_bf16 v[32:47], v[116:119], v[156:159], v[32:47]
    ds_read_b64_tr_b16 v[108:109], v81 offset:2048
    ds_read_b64_tr_b16 v[110:111], v81 offset:3072
    v_readfirstlane_b32 s76, v79
    s_nop 0
    s_and_b32 s76, s76, s52
    s_cbranch_scc0 L_tr5
L_bk5:
    s_ff1_i32_b32 s76, s76
    s_bitset0_b32 s52, s76
    s_add_u32 s77, s76, s65
    s_and_b32 s77, s77, 15
    s_mul_i32 s77, s77, 32768
    s_add_u32 s33, s77, s80
    s_waitcnt vmcnt(11) lgkmcnt(4)
    v_mfma_f32_32x32x16_bf16 v[16:31], v[120:123], v[160:163], v[16:31]
    ds_read_b64_tr_b16 v[112:113], v80 offset:4096
    ds_read_b64_tr_b16 v[114:115], v80 offset:5120
    buffer_load_dwordx4 v[144:147], v14, s[40:43], s33 offen offset:0 sc1
    s_add_u32 s76, s76, 3
    s_and_b32 s76, s76, 15
    s_lshl_b32 s9, s76, 13
    v_mfma_f32_32x32x16_bf16 v[32:47], v[124:127], v[160:163], v[32:47]
    ds_read_b64_tr_b16 v[116:117], v81 offset:4096
    ds_read_b64_tr_b16 v[118:119], v81 offset:5120
    s_waitcnt vmcnt(11) lgkmcnt(4)
    v_mfma_f32_32x32x16_bf16 v[16:31], v[104:107], v[164:167], v[16:31]
    ds_read_b64_tr_b16 v[120:121], v80 offset:6144
    ds_read_b64_tr_b16 v[122:123], v80 offset:7168
    buffer_load_dwordx4 v[148:151], v14, s[40:43], s33 offen offset:2048 sc1
    v_mfma_f32_32x32x16_bf16 v[32:47], v[108:111], v[164:167], v[32:47]
    ds_read_b64_tr_b16 v[124:125], v81 offset:6144
    ds_read_b64_tr_b16 v[126:127], v81 offset:7168
    v_add_u32 v82, s7, v72
    v_add_u32 v83, s7, v73
    s_waitcnt vmcnt(11) lgkmcnt(4)
    v_mfma_f32_32x32x16_bf16 v[16:31], v[112:115], v[168:171], v[16:31]
    ds_read_b32 v79, v8 offset:25984
    ds_read_b64_tr_b16 v[104:105], v82 offset:0
    ds_read_b64_tr_b16 v[106:107], v82 offset:1024
    buffer_load_dwordx4 v[152:155], v78, s[40:43], s33 offen offset:0 sc1
    v_mfma_f32_32x32x16_bf16 v[32:47], v[116:119], v[168:171], v[32:47]
    ds_read_b64_tr_b16 v[108:109], v83 offset:0
    ds_read_b64_tr_b16 v[110:111], v83 offset:1024
    s_waitcnt vmcnt(11) lgkmcnt(4)
    v_mfma_f32_32x32x16_bf16 v[16:31], v[120:123], v[172:175], v[16:31]
    ds_read_b64_tr_b16 v[112:113], v82 offset:2048
    ds_read_b64_tr_b16 v[114:115], v82 offset:3072
    buffer_load_dwordx4 v[156:159], v78, s[40:43], s33 offen offset:2048 sc1
    v_mfma_f32_32x32x16_bf16 v[32:47], v[124:127], v[172:175], v[32:47]
    ds_read_b64_tr_b16 v[116:117], v83 offset:2048
    ds_read_b64_tr_b16 v[118:119], v83 offset:3072
    v_readfirstlane_b32 s76, v79
    s_nop 0
    s_and_b32 s76, s76, s52
    s_cbranch_scc0 L_tr6
L_bk6:
    s_ff1_i32_b32 s76, s76
    s_bitset0_b32 s52, s76
    s_add_u32 s77, s76, s65
    s_and_b32 s77, s77, 15
    s_mul_i32 s77, s77, 32768
    s_add_u32 s34, s77, s80
    s_waitcnt vmcnt(11) lgkmcnt(4)
    v_mfma_f32_32x32x16_bf16 v[16:31], v[104:107], v[176:179], v[16:31]
    ds_read_b64_tr_b16 v[120:121], v82 offset:4096
    ds_read_b64_tr_b16 v[122:123], v82 offset:5120
    buffer_load_dwordx4 v[160:163], v14, s[40:43], s34 offen offset:0 sc1
    s_add_u32 s76, s76, 3
    s_and_b32 s76, s76, 15
    s_lshl_b32 s10, s76, 13
    v_mfma_f32_32x32x16_bf16 v[32:47], v[108:111], v[176:179], v[32:47]
    ds_read_b64_tr_b16 v[124:125], v83 offset:4096
    ds_read_b64_tr_b16 v[126:127], v83 offset:5120
    s_waitcnt vmcnt(11) lgkmcnt(4)
    v_mfma_f32_32x32x16_bf16 v[16:31], v[112:115], v[180:183], v[16:31]
    ds_read_b64_tr_b16 v[104:105], v82 offset:6144
    ds_read_b64_tr_b16 v[106:107], v82 offset:7168
    buffer_load_dwordx4 v[164:167], v14, s[40:43], s34 offen offset:2048 sc1
    v_mfma_f32_32x32x16_bf16 v[32:47], v[116:119], v[180:183], v[32:47]
    ds_read_b64_tr_b16 v[108:109], v83 offset:6144
    ds_read_b64_tr_b16 v[110:111], v83 offset:7168
    v_add_u32 v80, s8, v72
    v_add_u32 v81, s8, v73
    s_waitcnt vmcnt(11) lgkmcnt(4)
    v_mfma_f32_32x32x16_bf16 v[16:31], v[120:123], v[184:187], v[16:31]
    ds_read_b32 v79, v8 offset:25984
    ds_read_b64_tr_b16 v[112:113], v80 offset:0
    ds_read_b64_tr_b16 v[114:115], v80 offset:1024
    buffer_load_dwordx4 v[168:171], v78, s[40:43], s34 offen offset:0 sc1
    v_mfma_f32_32x32x16_bf16 v[32:47], v[124:127], v[184:187], v[32:47]
    ds_read_b64_tr_b16 v[116:117], v81 offset:0
    ds_read_b64_tr_b16 v[118:119], v81 offset:1024
    s_waitcnt vmcnt(11) lgkmcnt(4)
    v_mfma_f32_32x32x16_bf16 v[16:31], v[104:107], v[188:191], v[16:31]
    ds_read_b64_tr_b16 v[120:121], v80 offset:2048
    ds_read_b64_tr_b16 v[122:123], v80 offset:3072
    buffer_load_dwordx4 v[172:175], v78, s[40:43], s34 offen offset:2048 sc1
    v_mfma_f32_32x32x16_bf16 v[32:47], v[108:111], v[188:191], v[32:47]
    ds_read_b64_tr_b16 v[124:125], v81 offset:2048
    ds_read_b64_tr_b16 v[126:127], v81 offset:3072
    v_readfirstlane_b32 s76, v79
    s_nop 0
    s_and_b32 s76, s76, s52
    s_cbranch_scc0 L_tr7
L_bk7:
    s_ff1_i32_b32 s76, s76
    s_bitset0_b32 s52, s76
    s_add_u32 s77, s76, s65
    s_and_b32 s77, s77, 15
    s_mul_i32 s77, s77, 32768
    s_add_u32 s35, s77, s80
    s_waitcnt vmcnt(11) lgkmcnt(4)
    v_mfma_f32_32x32x16_bf16 v[16:31], v[112:115], v[128:131], v[16:31]
    ds_read_b64_tr_b16 v[104:105], v80 offset:4096
    ds_read_b64_tr_b16 v[106:107], v80 offset:5120
    buffer_load_dwordx4 v[176:179], v14, s[40:43], s35 offen offset:0 sc1
    s_add_u32 s76, s76, 3
    s_and_b32 s76, s76, 15
    s_lshl_b32 s11, s76, 13
    v_mfma_f32_32x32x16_bf16 v[32:47], v[116:119], v[128:131], v[32:47]
    ds_read_b64_tr_b16 v[108:109], v81 offset:4096
    ds_read_b64_tr_b16 v[110:111], v81 offset:5120
    s_waitcnt vmcnt(11) lgkmcnt(4)
    v_mfma_f32_32x32x16_bf16 v[16:31], v[120:123], v[132:135], v[16:31]
    ds_read_b64_tr_b16 v[112:113], v80 offset:6144
    ds_read_b64_tr_b16 v[114:115], v80 offset:7168
    buffer_load_dwordx4 v[180:183], v14, s[40:43], s35 offen offset:2048 sc1
    v_mfma_f32_32x32x16_bf16 v[32:47], v[124:127], v[132:135], v[32:47]
    ds_read_b64_tr_b16 v[116:117], v81 offset:6144
    ds_read_b64_tr_b16 v[118:119], v81 offset:7168
    v_add_u32 v82, s9, v72
    v_add_u32 v83, s9, v73
    s_waitcnt vmcnt(11) lgkmcnt(4)
    v_mfma_f32_32x32x16_bf16 v[16:31], v[104:107], v[136:139], v[16:31]
    ds_read_b32 v79, v8 offset:25984
    ds_read_b64_tr_b16 v[120:121], v82 offset:0
    ds_read_b64_tr_b16 v[122:123], v82 offset:1024
    buffer_load_dwordx4 v[184:187], v78, s[40:43], s35 offen offset:0 sc1
    v_mfma_f32_32x32x16_bf16 v[32:47], v[108:111], v[136:139], v[32:47]
    ds_read_b64_tr_b16 v[124:125], v83 offset:0
    ds_read_b64_tr_b16 v[126:127], v83 offset:1024
    s_waitcnt vmcnt(11) lgkmcnt(4)
    v_mfma_f32_32x32x16_bf16 v[16:31], v[112:115], v[140:143], v[16:31]
    ds_read_b64_tr_b16 v[104:105], v82 offset:2048
    ds_read_b64_tr_b16 v[106:107], v82 offset:3072
    buffer_load_dwordx4 v[188:191], v78, s[40:43], s35 offen offset:2048 sc1
    v_mfma_f32_32x32x16_bf16 v[32:47], v[116:119], v[140:143], v[32:47]
    ds_read_b64_tr_b16 v[108:109], v83 offset:2048
    ds_read_b64_tr_b16 v[110:111], v83 offset:3072
    v_readfirstlane_b32 s76, v79
    s_nop 0
    s_and_b32 s76, s76, s52
    s_cbranch_scc0 L_tr8
L_bk8:
    s_ff1_i32_b32 s76, s76
    s_bitset0_b32 s52, s76
    s_add_u32 s77, s76, s65
    s_and_b32 s77, s77, 15
    s_mul_i32 s77, s77, 32768
    s_add_u32 s36, s77, s80
    s_waitcnt vmcnt(11) lgkmcnt(4)
    v_mfma_f32_32x32x16_bf16 v[16:31], v[120:123], v[144:147], v[16:31]
    ds_read_b64_tr_b16 v[112:113], v82 offset:4096
    ds_read_b64_tr_b16 v[114:115], v82 offset:5120
    buffer_load_dwordx4 v[128:131], v14, s[40:43], s36 offen offset:0 sc1
    s_add_u32 s76, s76, 3
    s_and_b32 s76, s76, 15
    s_lshl_b32 s12, s76, 13
    v_mfma_f32_32x32x16_bf16 v[32:47], v[124:127], v[144:147], v[32:47]
    ds_read_b64_tr_b16 v[116:117], v83 offset:4096
    ds_read_b64_tr_b16 v[118:119], v83 offset:5120
    s_waitcnt vmcnt(11) lgkmcnt(4)
    v_mfma_f32_32x32x16_bf16 v[16:31], v[104:107], v[148:151], v[16:31]
    ds_read_b64_tr_b16 v[120:121], v82 offset:6144
    ds_read_b64_tr_b16 v[122:123], v82 offset:7168
    buffer_load_dwordx4 v[132:135], v14, s[40:43], s36 offen offset:2048 sc1
    v_mfma_f32_32x32x16_bf16 v[32:47], v[108:111], v[148:151], v[32:47]
    ds_read_b64_tr_b16 v[124:125], v83 offset:6144
    ds_read_b64_tr_b16 v[126:127], v83 offset:7168
    v_add_u32 v80, s10, v72
    v_add_u32 v81, s10, v73
    s_waitcnt vmcnt(11) lgkmcnt(4)
    v_mfma_f32_32x32x16_bf16 v[16:31], v[112:115], v[152:155], v[16:31]
    ds_read_b32 v79, v8 offset:25984
    ds_read_b64_tr_b16 v[104:105], v80 offset:0
    ds_read_b64_tr_b16 v[106:107], v80 offset:1024
    buffer_load_dwordx4 v[136:139], v78, s[40:43], s36 offen offset:0 sc1
    v_mfma_f32_32x32x16_bf16 v[32:47], v[116:119], v[152:155], v[32:47]
    ds_read_b64_tr_b16 v[108:109], v81 offset:0
    ds_read_b64_tr_b16 v[110:111], v81 offset:1024
    s_waitcnt vmcnt(11) lgkmcnt(4)
    v_mfma_f32_32x32x16_bf16 v[16:31], v[120:123], v[156:159], v[16:31]
    ds_read_b64_tr_b16 v[112:113], v80 offset:2048
    ds_read_b64_tr_b16 v[114:115], v80 offset:3072
    buffer_load_dwordx4 v[140:143], v78, s[40:43], s36 offen offset:2048 sc1
    v_mfma_f32_32x32x16_bf16 v[32:47], v[124:127], v[156:159], v[32:47]
    ds_read_b64_tr_b16 v[116:117], v81 offset:2048
    ds_read_b64_tr_b16 v[118:119], v81 offset:3072
    v_readfirstlane_b32 s76, v79
    s_nop 0
    s_and_b32 s76, s76, s52
    s_cbranch_scc0 L_tr9
L_bk9:
    s_ff1_i32_b32 s76, s76
    s_bitset0_b32 s52, s76
    s_add_u32 s77, s76, s65
    s_and_b32 s77, s77, 15
    s_mul_i32 s77, s77, 32768
    s_add_u32 s37, s77, s80
    s_waitcnt vmcnt(11) lgkmcnt(4)
    v_mfma_f32_32x32x16_bf16 v[16:31], v[104:107], v[160:163], v[16:31]
    ds_read_b64_tr_b16 v[120:121], v80 offset:4096
    ds_read_b64_tr_b16 v[122:123], v80 offset:5120
    buffer_load_dwordx4 v[144:147], v14, s[40:43], s37 offen offset:0 sc1
    s_add_u32 s76, s76, 3
    s_and_b32 s76, s76, 15
    s_lshl_b32 s13, s76, 13
    v_mfma_f32_32x32x16_bf16 v[32:47], v[108:111], v[160:163], v[32:47]
    ds_read_b64_tr_b16 v[124:125], v81 offset:4096
    ds_read_b64_tr_b16 v[126:127], v81 offset:5120
    s_waitcnt vmcnt(11) lgkmcnt(4)
    v_mfma_f32_32x32x16_bf16 v[16:31], v[112:115], v[164:167], v[16:31]
    ds_read_b64_tr_b16 v[104:105], v80 offset:6144
    ds_read_b64_tr_b16 v[106:107], v80 offset:7168
    buffer_load_dwordx4 v[148:151], v14, s[40:43], s37 offen offset:2048 sc1
    v_mfma_f32_32x32x16_bf16 v[32:47], v[116:119], v[164:167], v[32:47]
    ds_read_b64_tr_b16 v[108:109], v81 offset:6144
    ds_read_b64_tr_b16 v[110:111], v81 offset:7168
    v_add_u32 v82, s11, v72
    v_add_u32 v83, s11, v73
    s_waitcnt vmcnt(11) lgkmcnt(4)
    v_mfma_f32_32x32x16_bf16 v[16:31], v[120:123], v[168:171], v[16:31]
    ds_read_b32 v79, v8 offset:25984
    ds_read_b64_tr_b16 v[112:113], v82 offset:0
    ds_read_b64_tr_b16 v[114:115], v82 offset:1024
    buffer_load_dwordx4 v[152:155], v78, s[40:43], s37 offen offset:0 sc1
    v_mfma_f32_32x32x16_bf16 v[32:47], v[124:127], v[168:171], v[32:47]
    ds_read_b64_tr_b16 v[116:117], v83 offset:0
    ds_read_b64_tr_b16 v[118:119], v83 offset:1024
    s_waitcnt vmcnt(11) lgkmcnt(4)
    v_mfma_f32_32x32x16_bf16 v[16:31], v[104:107], v[172:175], v[16:31]
    ds_read_b64_tr_b16 v[120:121], v82 offset:2048
    ds_read_b64_tr_b16 v[122:123], v82 offset:3072
    buffer_load_dwordx4 v[156:159], v78, s[40:43], s37 offen offset:2048 sc1
    v_mfma_f32_32x32x16_bf16 v[32:47], v[108:111], v[172:175], v[32:47]
    ds_read_b64_tr_b16 v[124:125], v83 offset:2048
    ds_read_b64_tr_b16 v[126:127], v83 offset:3072
    v_readfirstlane_b32 s76, v79
    s_nop 0
    s_and_b32 s76, s76, s52
    s_cbranch_scc0 L_tr10
L_bk10:
    s_ff1_i32_b32 s76, s76
    s_bitset0_b32 s52, s76
    s_add_u32 s77, s76, s65
    s_and_b32 s77, s77, 15
    s_mul_i32 s77, s77, 32768
    s_add_u32 s38, s77, s80
    s_waitcnt vmcnt(11) lgkmcnt(4)
    v_mfma_f32_32x32x16_bf16 v[16:31], v[112:115], v[176:179], v[16:31]
    ds_read_b64_tr_b16 v[104:105], v82 offset:4096
    ds_read_b64_tr_b16 v[106:107], v82 offset:5120
    buffer_load_dwordx4 v[160:163], v14, s[40:43], s38 offen offset:0 sc1
    s_add_u32 s76, s76, 3
    s_and_b32 s76, s76, 15
    s_lshl_b32 s14, s76, 13
    v_mfma_f32_32x32x16_bf16 v[32:47], v[116:119], v[176:179], v[32:47]
    ds_read_b64_tr_b16 v[108:109], v83 offset:4096
    ds_read_b64_tr_b16 v[110:111], v83 offset:5120
    s_waitcnt vmcnt(11) lgkmcnt(4)
    v_mfma_f32_32x32x16_bf16 v[16:31], v[120:123], v[180:183], v[16:31]
    ds_read_b64_tr_b16 v[112:113], v82 offset:6144
    ds_read_b64_tr_b16 v[114:115], v82 offset:7168
    buffer_load_dwordx4 v[164:167], v14, s[40:43], s38 offen offset:2048 sc1
    v_mfma_f32_32x32x16_bf16 v[32:47], v[124:127], v[180:183], v[32:47]
    ds_read_b64_tr_b16 v[116:117], v83 offset:6144
    ds_read_b64_tr_b16 v[118:119], v83 offset:7168
    v_add_u32 v80, s12, v72
    v_add_u32 v81, s12, v73
    s_waitcnt vmcnt(11) lgkmcnt(4)
    v_mfma_f32_32x32x16_bf16 v[16:31], v[104:107], v[184:187], v[16:31]
    ds_read_b32 v79, v8 offset:25984
    ds_read_b64_tr_b16 v[120:121], v80 offset:0
    ds_read_b64_tr_b16 v[122:123], v80 offset:1024
    buffer_load_dwordx4 v[168:171], v78, s[40:43], s38 offen offset:0 sc1
    v_mfma_f32_32x32x16_bf16 v[32:47], v[108:111], v[184:187], v[32:47]
    ds_read_b64_tr_b16 v[124:125], v81 offset:0
    ds_read_b64_tr_b16 v[126:127], v81 offset:1024
    s_waitcnt vmcnt(11) lgkmcnt(4)
    v_mfma_f32_32x32x16_bf16 v[16:31], v[112:115], v[188:191], v[16:31]
    ds_read_b64_tr_b16 v[104:105], v80 offset:2048
    ds_read_b64_tr_b16 v[106:107], v80 offset:3072
    buffer_load_dwordx4 v[172:175], v78, s[40:43], s38 offen offset:2048 sc1
    v_mfma_f32_32x32x16_bf16 v[32:47], v[116:119], v[188:191], v[32:47]
    ds_read_b64_tr_b16 v[108:109], v81 offset:2048
    ds_read_b64_tr_b16 v[110:111], v81 offset:3072
    v_readfirstlane_b32 s76, v79
    s_nop 0
    s_and_b32 s76, s76, s52
    s_cbranch_scc0 L_tr11
L_bk11:
    s_ff1_i32_b32 s76, s76
    s_bitset0_b32 s52, s76
    s_add_u32 s77, s76, s65
    s_and_b32 s77, s77, 15
    s_mul_i32 s77, s77, 32768
    s_add_u32 s39, s77, s80
    s_waitcnt vmcnt(11) lgkmcnt(4)
    v_mfma_f32_32x32x16_bf16 v[16:31], v[120:123], v[128:131], v[16:31]
    ds_read_b64_tr_b16 v[112:113], v80 offset:4096
    ds_read_b64_tr_b16 v[114:115], v80 offset:5120
    buffer_load_dwordx4 v[176:179], v14, s[40:43], s39 offen offset:0 sc1
    s_add_u32 s76, s76, 3
    s_and_b32 s76, s76, 15
    s_lshl_b32 s15, s76, 13
    v_mfma_f32_32x32x16_bf16 v[32:47], v[124:127], v[128:131], v[32:47]
    ds_read_b64_tr_b16 v[116:117], v81 offset:4096
    ds_read_b64_tr_b16 v[118:119], v81 offset:5120
    s_waitcnt vmcnt(11) lgkmcnt(4)
    v_mfma_f32_32x32x16_bf16 v[16:31], v[104:107], v[132:135], v[16:31]
    ds_read_b64_tr_b16 v[120:121], v80 offset:6144
    ds_read_b64_tr_b16 v[122:123], v80 offset:7168
    buffer_load_dwordx4 v[180:183], v14, s[40:43], s39 offen offset:2048 sc1
    v_mfma_f32_32x32x16_bf16 v[32:47], v[108:111], v[132:135], v[32:47]
    ds_read_b64_tr_b16 v[124:125], v81 offset:6144
    ds_read_b64_tr_b16 v[126:127], v81 offset:7168
    v_add_u32 v82, s13, v72
    v_add_u32 v83, s13, v73
    s_waitcnt vmcnt(11) lgkmcnt(4)
    v_mfma_f32_32x32x16_bf16 v[16:31], v[112:115], v[136:139], v[16:31]
    ds_read_b32 v79, v8 offset:25984
    ds_read_b64_tr_b16 v[104:105], v82 offset:0
    ds_read_b64_tr_b16 v[106:107], v82 offset:1024
    buffer_load_dwordx4 v[184:187], v78, s[40:43], s39 offen offset:0 sc1
    v_mfma_f32_32x32x16_bf16 v[32:47], v[116:119], v[136:139], v[32:47]
    ds_read_b64_tr_b16 v[108:109], v83 offset:0
    ds_read_b64_tr_b16 v[110:111], v83 offset:1024
    s_waitcnt vmcnt(11) lgkmcnt(4)
    v_mfma_f32_32x32x16_bf16 v[16:31], v[120:123], v[140:143], v[16:31]
    ds_read_b64_tr_b16 v[112:113], v82 offset:2048
    ds_read_b64_tr_b16 v[114:115], v82 offset:3072
    buffer_load_dwordx4 v[188:191], v78, s[40:43], s39 offen offset:2048 sc1
    v_mfma_f32_32x32x16_bf16 v[32:47], v[124:127], v[140:143], v[32:47]
    ds_read_b64_tr_b16 v[116:117], v83 offset:2048
    ds_read_b64_tr_b16 v[118:119], v83 offset:3072
    v_readfirstlane_b32 s76, v79
    s_nop 0
    s_and_b32 s76, s76, s52
    s_cbranch_scc0 L_tr12
L_bk12:
    s_ff1_i32_b32 s76, s76
    s_bitset0_b32 s52, s76
    s_add_u32 s77, s76, s65
    s_and_b32 s77, s77, 15
    s_mul_i32 s77, s77, 32768
    s_add_u32 s48, s77, s80
    s_waitcnt vmcnt(11) lgkmcnt(4)
    v_mfma_f32_32x32x16_bf16 v[16:31], v[104:107], v[144:147], v[16:31]
    ds_read_b64_tr_b16 v[120:121], v82 offset:4096
    ds_read_b64_tr_b16 v[122:123], v82 offset:5120
    buffer_load_dwordx4 v[128:131], v14, s[40:43], s48 offen offset:0 sc1
    s_add_u32 s76, s76, 3
    s_and_b32 s76, s76, 15
    s_lshl_b32 s16, s76, 13
    v_mfma_f32_32x32x16_bf16 v[32:47], v[108:111], v[144:147], v[32:47]
    ds_read_b64_tr_b16 v[124:125], v83 offset:4096
    ds_read_b64_tr_b16 v[126:127], v83 offset:5120
    s_waitcnt vmcnt(11) lgkmcnt(4)
    v_mfma_f32_32x32x16_bf16 v[16:31], v[112:115], v[148:151], v[16:31]
    ds_read_b64_tr_b16 v[104:105], v82 offset:6144
    ds_read_b64_tr_b16 v[106:107], v82 offset:7168
    buffer_load_dwordx4 v[132:135], v14, s[40:43], s48 offen offset:2048 sc1
    v_mfma_f32_32x32x16_bf16 v[32:47], v[116:119], v[148:151], v[32:47]
    ds_read_b64_tr_b16 v[108:109], v83 offset:6144
    ds_read_b64_tr_b16 v[110:111], v83 offset:7168
    v_add_u32 v80, s14, v72
    v_add_u32 v81, s14, v73
    s_waitcnt vmcnt(11) lgkmcnt(4)
    v_mfma_f32_32x32x16_bf16 v[16:31], v[120:123], v[152:155], v[16:31]
    ds_read_b32 v79, v8 offset:25984
    ds_read_b64_tr_b16 v[112:113], v80 offset:0
    ds_read_b64_tr_b16 v[114:115], v80 offset:1024
    buffer_load_dwordx4 v[136:139], v78, s[40:43], s48 offen offset:0 sc1
    v_mfma_f32_32x32x16_bf16 v[32:47], v[124:127], v[152:155], v[32:47]
    ds_read_b64_tr_b16 v[116:117], v81 offset:0
    ds_read_b64_tr_b16 v[118:119], v81 offset:1024
    s_waitcnt vmcnt(11) lgkmcnt(4)
    v_mfma_f32_32x32x16_bf16 v[16:31], v[104:107], v[156:159], v[16:31]
    ds_read_b64_tr_b16 v[120:121], v80 offset:2048
    ds_read_b64_tr_b16 v[122:123], v80 offset:3072
    buffer_load_dwordx4 v[140:143], v78, s[40:43], s48 offen offset:2048 sc1
    v_mfma_f32_32x32x16_bf16 v[32:47], v[108:111], v[156:159], v[32:47]
    ds_read_b64_tr_b16 v[124:125], v81 offset:2048
    ds_read_b64_tr_b16 v[126:127], v81 offset:3072
    v_readfirstlane_b32 s76, v79
    s_nop 0
    s_and_b32 s76, s76, s52
    s_cbranch_scc0 L_tr13
L_bk13:
    s_ff1_i32_b32 s76, s76
    s_bitset0_b32 s52, s76
    s_add_u32 s77, s76, s65
    s_and_b32 s77, s77, 15
    s_mul_i32 s77, s77, 32768
    s_add_u32 s49, s77, s80
    s_waitcnt vmcnt(11) lgkmcnt(4)
    v_mfma_f32_32x32x16_bf16 v[16:31], v[112:115], v[160:163], v[16:31]
    ds_read_b64_tr_b16 v[104:105], v80 offset:4096
    ds_read_b64_tr_b16 v[106:107], v80 offset:5120
    buffer_load_dwordx4 v[144:147], v14, s[40:43], s49 offen offset:0 sc1
    s_add_u32 s76, s76, 3
    s_and_b32 s76, s76, 15
    s_lshl_b32 s17, s76, 13
    v_mfma_f32_32x32x16_bf16 v[32:47], v[116:119], v[160:163], v[32:47]
    ds_read_b64_tr_b16 v[108:109], v81 offset:4096
    ds_read_b64_tr_b16 v[110:111], v81 offset:5120
    s_waitcnt vmcnt(11) lgkmcnt(4)
    v_mfma_f32_32x32x16_bf16 v[16:31], v[120:123], v[164:167], v[16:31]
    ds_read_b64_tr_b16 v[112:113], v80 offset:6144
    ds_read_b64_tr_b16 v[114:115], v80 offset:7168
    buffer_load_dwordx4 v[148:151], v14, s[40:43], s49 offen offset:2048 sc1
    v_mfma_f32_32x32x16_bf16 v[32:47], v[124:127], v[164:167], v[32:47]
    ds_read_b64_tr_b16 v[116:117], v81 offset:6144
    ds_read_b64_tr_b16 v[118:119], v81 offset:7168
    v_add_u32 v82, s15, v72
    v_add_u32 v83, s15, v73
    s_waitcnt vmcnt(11) lgkmcnt(4)
    v_mfma_f32_32x32x16_bf16 v[16:31], v[104:107], v[168:171], v[16:31]
    ds_read_b32 v79, v8 offset:25984
    ds_read_b64_tr_b16 v[120:121], v82 offset:0
    ds_read_b64_tr_b16 v[122:123], v82 offset:1024
    buffer_load_dwordx4 v[152:155], v78, s[40:43], s49 offen offset:0 sc1
    v_mfma_f32_32x32x16_bf16 v[32:47], v[108:111], v[168:171], v[32:47]
    ds_read_b64_tr_b16 v[124:125], v83 offset:0
    ds_read_b64_tr_b16 v[126:127], v83 offset:1024
    s_waitcnt vmcnt(11) lgkmcnt(4)
    v_mfma_f32_32x32x16_bf16 v[16:31], v[112:115], v[172:175], v[16:31]
    ds_read_b64_tr_b16 v[104:105], v82 offset:2048
    ds_read_b64_tr_b16 v[106:107], v82 offset:3072
    buffer_load_dwordx4 v[156:159], v78, s[40:43], s49 offen offset:2048 sc1
    v_mfma_f32_32x32x16_bf16 v[32:47], v[116:119], v[172:175], v[32:47]
    ds_read_b64_tr_b16 v[108:109], v83 offset:2048
    ds_read_b64_tr_b16 v[110:111], v83 offset:3072
    v_readfirstlane_b32 s76, v79
    s_nop 0
    s_and_b32 s76, s76, s52
    s_cbranch_scc0 L_tr14
L_bk14:
    s_ff1_i32_b32 s76, s76
    s_bitset0_b32 s52, s76
    s_add_u32 s77, s76, s65
    s_and_b32 s77, s77, 15
    s_mul_i32 s77, s77, 32768
    s_add_u32 s50, s77, s80
    s_waitcnt vmcnt(11) lgkmcnt(4)
    v_mfma_f32_32x32x16_bf16 v[16:31], v[120:123], v[176:179], v[16:31]
    ds_read_b64_tr_b16 v[112:113], v82 offset:4096
    ds_read_b64_tr_b16 v[114:115], v82 offset:5120
    buffer_load_dwordx4 v[160:163], v14, s[40:43], s50 offen offset:0 sc1
    s_add_u32 s76, s76, 3
    s_and_b32 s76, s76, 15
    s_lshl_b32 s18, s76, 13
    v_mfma_f32_32x32x16_bf16 v[32:47], v[124:127], v[176:179], v[32:47]
    ds_read_b64_tr_b16 v[116:117], v83 offset:4096
    ds_read_b64_tr_b16 v[118:119], v83 offset:5120
    s_waitcnt vmcnt(11) lgkmcnt(4)
    v_mfma_f32_32x32x16_bf16 v[16:31], v[104:107], v[180:183], v[16:31]
    ds_read_b64_tr_b16 v[120:121], v82 offset:6144
    ds_read_b64_tr_b16 v[122:123], v82 offset:7168
    buffer_load_dwordx4 v[164:167], v14, s[40:43], s50 offen offset:2048 sc1
    v_mfma_f32_32x32x16_bf16 v[32:47], v[108:111], v[180:183], v[32:47]
    ds_read_b64_tr_b16 v[124:125], v83 offset:6144
    ds_read_b64_tr_b16 v[126:127], v83 offset:7168
    v_add_u32 v80, s16, v72
    v_add_u32 v81, s16, v73
    s_waitcnt vmcnt(11) lgkmcnt(4)
    v_mfma_f32_32x32x16_bf16 v[16:31], v[112:115], v[184:187], v[16:31]
    ds_read_b32 v79, v8 offset:25984
    ds_read_b64_tr_b16 v[104:105], v80 offset:0
    ds_read_b64_tr_b16 v[106:107], v80 offset:1024
    buffer_load_dwordx4 v[168:171], v78, s[40:43], s50 offen offset:0 sc1
    v_mfma_f32_32x32x16_bf16 v[32:47], v[116:119], v[184:187], v[32:47]
    ds_read_b64_tr_b16 v[108:109], v81 offset:0
    ds_read_b64_tr_b16 v[110:111], v81 offset:1024
    s_waitcnt vmcnt(11) lgkmcnt(4)
    v_mfma_f32_32x32x16_bf16 v[16:31], v[120:123], v[188:191], v[16:31]
    ds_read_b64_tr_b16 v[112:113], v80 offset:2048
    ds_read_b64_tr_b16 v[114:115], v80 offset:3072
    buffer_load_dwordx4 v[172:175], v78, s[40:43], s50 offen offset:2048 sc1
    v_mfma_f32_32x32x16_bf16 v[32:47], v[124:127], v[188:191], v[32:47]
    ds_read_b64_tr_b16 v[116:117], v81 offset:2048
    ds_read_b64_tr_b16 v[118:119], v81 offset:3072
    v_readfirstlane_b32 s76, v79
    s_nop 0
    s_and_b32 s76, s76, s52
    s_cbranch_scc0 L_tr15
L_bk15:
    s_ff1_i32_b32 s76, s76
    s_bitset0_b32 s52, s76
    s_add_u32 s77, s76, s65
    s_and_b32 s77, s77, 15
    s_mul_i32 s77, s77, 32768
    s_add_u32 s51, s77, s80
    s_waitcnt vmcnt(11) lgkmcnt(4)
    v_mfma_f32_32x32x16_bf16 v[16:31], v[104:107], v[128:131], v[16:31]
    ds_read_b64_tr_b16 v[120:121], v80 offset:4096
    ds_read_b64_tr_b16 v[122:123], v80 offset:5120
    buffer_load_dwordx4 v[176:179], v14, s[40:43], s51 offen offset:0 sc1
    s_add_u32 s76, s76, 3
    s_and_b32 s76, s76, 15
    s_lshl_b32 s19, s76, 13
    v_mfma_f32_32x32x16_bf16 v[32:47], v[108:111], v[128:131], v[32:47]
    ds_read_b64_tr_b16 v[124:125], v81 offset:4096
    ds_read_b64_tr_b16 v[126:127], v81 offset:5120
    s_waitcnt vmcnt(11) lgkmcnt(4)
    v_mfma_f32_32x32x16_bf16 v[16:31], v[112:115], v[132:135], v[16:31]
    ds_read_b64_tr_b16 v[104:105], v80 offset:6144
    ds_read_b64_tr_b16 v[106:107], v80 offset:7168
    buffer_load_dwordx4 v[180:183], v14, s[40:43], s51 offen offset:2048 sc1
    v_mfma_f32_32x32x16_bf16 v[32:47], v[116:119], v[132:135], v[32:47]
    ds_read_b64_tr_b16 v[108:109], v81 offset:6144
    ds_read_b64_tr_b16 v[110:111], v81 offset:7168
    v_add_u32 v82, s17, v72
    v_add_u32 v83, s17, v73
    s_waitcnt vmcnt(11) lgkmcnt(4)
    v_mfma_f32_32x32x16_bf16 v[16:31], v[120:123], v[136:139], v[16:31]
    ds_read_b64_tr_b16 v[112:113], v82 offset:0
    ds_read_b64_tr_b16 v[114:115], v82 offset:1024
    buffer_load_dwordx4 v[184:187], v78, s[40:43], s51 offen offset:0 sc1
    v_mfma_f32_32x32x16_bf16 v[32:47], v[124:127], v[136:139], v[32:47]
    ds_read_b64_tr_b16 v[116:117], v83 offset:0
    ds_read_b64_tr_b16 v[118:119], v83 offset:1024
    s_waitcnt vmcnt(11) lgkmcnt(4)
    v_mfma_f32_32x32x16_bf16 v[16:31], v[104:107], v[140:143], v[16:31]
    ds_read_b64_tr_b16 v[120:121], v82 offset:2048
    ds_read_b64_tr_b16 v[122:123], v82 offset:3072
    buffer_load_dwordx4 v[188:191], v78, s[40:43], s51 offen offset:2048 sc1
    s_barrier
    v_mfma_f32_32x32x16_bf16 v[32:47], v[108:111], v[140:143], v[32:47]
    ds_read_b64_tr_b16 v[124:125], v83 offset:2048
    ds_read_b64_tr_b16 v[126:127], v83 offset:3072
    s_waitcnt vmcnt(11) lgkmcnt(4)
    v_mfma_f32_32x32x16_bf16 v[16:31], v[112:115], v[144:147], v[16:31]
    ds_read_b64_tr_b16 v[104:105], v82 offset:4096
    ds_read_b64_tr_b16 v[106:107], v82 offset:5120
    v_mfma_f32_32x32x16_bf16 v[32:47], v[116:119], v[144:147], v[32:47]
    ds_read_b64_tr_b16 v[108:109], v83 offset:4096
    ds_read_b64_tr_b16 v[110:111], v83 offset:5120
    s_waitcnt vmcnt(10) lgkmcnt(4)
    v_mfma_f32_32x32x16_bf16 v[16:31], v[120:123], v[148:151], v[16:31]
    ds_read_b64_tr_b16 v[112:113], v82 offset:6144
    ds_read_b64_tr_b16 v[114:115], v82 offset:7168
    v_mfma_f32_32x32x16_bf16 v[32:47], v[124:127], v[148:151], v[32:47]
    ds_read_b64_tr_b16 v[116:117], v83 offset:6144
    ds_read_b64_tr_b16 v[118:119], v83 offset:7168
    v_add_u32 v80, s18, v72
    v_add_u32_e64 v81, s18, v73
    s_waitcnt vmcnt(9) lgkmcnt(4)
    v_mfma_f32_32x32x16_bf16 v[16:31], v[104:107], v[152:155], v[16:31]
    ds_read_b64_tr_b16 v[120:121], v80 offset:0
    ds_read_b64_tr_b16 v[122:123], v80 offset:1024
    v_mfma_f32_32x32x16_bf16 v[32:47], v[108:111], v[152:155], v[32:47]
    ds_read_b64_tr_b16 v[124:125], v81 offset:0
    ds_read_b64_tr_b16 v[126:127], v81 offset:1024
    s_waitcnt vmcnt(8) lgkmcnt(4)
    v_mfma_f32_32x32x16_bf16 v[16:31], v[112:115], v[156:159], v[16:31]
    ds_read_b64_tr_b16 v[104:105], v80 offset:2048
    ds_read_b64_tr_b16 v[106:107], v80 offset:3072
    v_mfma_f32_32x32x16_bf16 v[32:47], v[116:119], v[156:159], v[32:47]
    ds_read_b64_tr_b16 v[108:109], v81 offset:2048
    ds_read_b64_tr_b16 v[110:111], v81 offset:3072
    s_waitcnt vmcnt(7) lgkmcnt(4)
    v_mfma_f32_32x32x16_bf16 v[16:31], v[120:123], v[160:163], v[16:31]
    ds_read_b64_tr_b16 v[112:113], v80 offset:4096
    ds_read_b64_tr_b16 v[114:115], v80 offset:5120
    v_mfma_f32_32x32x16_bf16 v[32:47], v[124:127], v[160:163], v[32:47]
    ds_read_b64_tr_b16 v[116:117], v81 offset:4096
    ds_read_b64_tr_b16 v[118:119], v81 offset:5120
    s_waitcnt vmcnt(6) lgkmcnt(4)
    v_mfma_f32_32x32x16_bf16 v[16:31], v[104:107], v[164:167], v[16:31]
    ds_read_b64_tr_b16 v[120:121], v80 offset:6144
    ds_read_b64_tr_b16 v[122:123], v80 offset:7168
    v_mfma_f32_32x32x16_bf16 v[32:47], v[108:111], v[164:167], v[32:47]
    ds_read_b64_tr_b16 v[124:125], v81 offset:6144
    ds_read_b64_tr_b16 v[126:127], v81 offset:7168
    v_add_u32 v82, s19, v72
    v_add_u32 v83, s19, v73
    s_waitcnt vmcnt(5) lgkmcnt(4)
    v_mfma_f32_32x32x16_bf16 v[16:31], v[112:115], v[168:171], v[16:31]
    ds_read_b64_tr_b16 v[104:105], v82 offset:0
    ds_read_b64_tr_b16 v[106:107], v82 offset:1024
    v_mfma_f32_32x32x16_bf16 v[32:47], v[116:119], v[168:171], v[32:47]
    ds_read_b64_tr_b16 v[108:109], v83 offset:0
    ds_read_b64_tr_b16 v[110:111], v83 offset:1024
    s_waitcnt vmcnt(4) lgkmcnt(4)
    v_mfma_f32_32x32x16_bf16 v[16:31], v[120:123], v[172:175], v[16:31]
    ds_read_b64_tr_b16 v[112:113], v82 offset:2048
    ds_read_b64_tr_b16 v[114:115], v82 offset:3072
    v_mfma_f32_32x32x16_bf16 v[32:47], v[124:127], v[172:175], v[32:47]
    ds_read_b64_tr_b16 v[116:117], v83 offset:2048
    ds_read_b64_tr_b16 v[118:119], v83 offset:3072
    s_waitcnt vmcnt(3) lgkmcnt(4)
    v_mfma_f32_32x32x16_bf16 v[16:31], v[104:107], v[176:179], v[16:31]
    ds_read_b64_tr_b16 v[120:121], v82 offset:4096
    ds_read_b64_tr_b16 v[122:123], v82 offset:5120
    v_mfma_f32_32x32x16_bf16 v[32:47], v[108:111], v[176:179], v[32:47]
    ds_read_b64_tr_b16 v[124:125], v83 offset:4096
    ds_read_b64_tr_b16 v[126:127], v83 offset:5120
    s_waitcnt vmcnt(2) lgkmcnt(4)
    v_mfma_f32_32x32x16_bf16 v[16:31], v[112:115], v[180:183], v[16:31]
    ds_read_b64_tr_b16 v[104:105], v82 offset:6144
    ds_read_b64_tr_b16 v[106:107], v82 offset:7168
    v_mfma_f32_32x32x16_bf16 v[32:47], v[116:119], v[180:183], v[32:47]
    ds_read_b64_tr_b16 v[108:109], v83 offset:6144
    ds_read_b64_tr_b16 v[110:111], v83 offset:7168
    s_waitcnt vmcnt(1) lgkmcnt(4)
    v_mfma_f32_32x32x16_bf16 v[16:31], v[120:123], v[184:187], v[16:31]
    v_mfma_f32_32x32x16_bf16 v[32:47], v[124:127], v[184:187], v[32:47]
    s_waitcnt vmcnt(0) lgkmcnt(0)
    v_mfma_f32_32x32x16_bf16 v[16:31], v[104:107], v[188:191], v[16:31]
    v_mfma_f32_32x32x16_bf16 v[32:47], v[108:111], v[188:191], v[32:47]
    s_nop 10
    v_cvt_pk_bf16_f32 v88, v16, v17
    v_cvt_pk_bf16_f32 v89, v18, v19
    v_cvt_pk_bf16_f32 v90, v20, v21
    v_cvt_pk_bf16_f32 v91, v22, v23
    v_cvt_pk_bf16_f32 v92, v24, v25
    v_cvt_pk_bf16_f32 v93, v26, v27
    v_cvt_pk_bf16_f32 v94, v28, v29
    v_cvt_pk_bf16_f32 v95, v30, v31
    v_cvt_pk_bf16_f32 v96, v32, v33
    v_cvt_pk_bf16_f32 v97, v34, v35
    v_cvt_pk_bf16_f32 v98, v36, v37
    v_cvt_pk_bf16_f32 v99, v38, v39
    v_cvt_pk_bf16_f32 v100, v40, v41
    v_cvt_pk_bf16_f32 v101, v42, v43
    v_cvt_pk_bf16_f32 v102, v44, v45
    v_cvt_pk_bf16_f32 v103, v46, v47
    v_dot2_f32_bf16 v104, v88, s89, 0
    v_dot2_f32_bf16 v105, v88, v88, 0
    v_dot2_f32_bf16 v106, v88, v192, 0
    v_dot2_f32_bf16 v104, v89, s89, v104
    v_dot2_f32_bf16 v105, v89, v89, v105
    v_dot2_f32_bf16 v106, v89, v193, v106
    v_dot2_f32_bf16 v104, v90, s89, v104
    v_dot2_f32_bf16 v105, v90, v90, v105
    v_dot2_f32_bf16 v106, v90, v194, v106
    v_dot2_f32_bf16 v104, v91, s89, v104
    v_dot2_f32_bf16 v105, v91, v91, v105
    v_dot2_f32_bf16 v106, v91, v195, v106
    v_dot2_f32_bf16 v104, v92, s89, v104
    v_dot2_f32_bf16 v105, v92, v92, v105
    v_dot2_f32_bf16 v106, v92, v196, v106
    v_dot2_f32_bf16 v104, v93, s89, v104
    v_dot2_f32_bf16 v105, v93, v93, v105
    v_dot2_f32_bf16 v106, v93, v197, v106
    v_dot2_f32_bf16 v104, v94, s89, v104
    v_dot2_f32_bf16 v105, v94, v94, v105
    v_dot2_f32_bf16 v106, v94, v198, v106
    v_dot2_f32_bf16 v104, v95, s89, v104
    v_dot2_f32_bf16 v105, v95, v95, v105
    v_dot2_f32_bf16 v106, v95, v199, v106
    v_dot2_f32_bf16 v104, v96, s89, v104
    v_dot2_f32_bf16 v105, v96, v96, v105
    v_dot2_f32_bf16 v106, v96, v200, v106
    v_dot2_f32_bf16 v104, v97, s89, v104
    v_dot2_f32_bf16 v105, v97, v97, v105
    v_dot2_f32_bf16 v106, v97, v201, v106
    v_dot2_f32_bf16 v104, v98, s89, v104
    v_dot2_f32_bf16 v105, v98, v98, v105
    v_dot2_f32_bf16 v106, v98, v202, v106
    v_dot2_f32_bf16 v104, v99, s89, v104
    v_dot2_f32_bf16 v105, v99, v99, v105
    v_dot2_f32_bf16 v106, v99, v203, v106
    v_dot2_f32_bf16 v104, v100, s89, v104
    v_dot2_f32_bf16 v105, v100, v100, v105
    v_dot2_f32_bf16 v106, v100, v204, v106
    v_dot2_f32_bf16 v104, v101, s89, v104
    v_dot2_f32_bf16 v105, v101, v101, v105
    v_dot2_f32_bf16 v106, v101, v205, v106
    v_dot2_f32_bf16 v104, v102, s89, v104
    v_dot2_f32_bf16 v105, v102, v102, v105
    v_dot2_f32_bf16 v106, v102, v206, v106
    v_dot2_f32_bf16 v104, v103, s89, v104
    v_dot2_f32_bf16 v105, v103, v103, v105
    v_dot2_f32_bf16 v106, v103, v207, v106
    s_lshl_b32 s76, s62, 9
    s_add_u32 s77, s76, s99
    v_mov_b32 v107, 0
    v_mov_b32 v4, v104
    v_mov_b32 v5, v105
    v_mov_b32 v6, v106
    v_permlane32_swap_b32 v104, v4
    v_permlane32_swap_b32 v105, v5
    v_permlane32_swap_b32 v106, v6
    v_add_f32 v104, v104, v4
    v_add_f32 v105, v105, v5
    v_add_f32_e64 v106, v106, v6
    s_mov_b32 exec_hi, 0
    s_bitcmp1_b32 s100, 1
    s_cbranch_scc1 L_loc_60
    buffer_store_dwordx4 v[104:107], v12, s[40:43], s77 offen offset:1024 sc1
    s_branch L_pubd_61
L_loc_60:
    buffer_store_dwordx4 v[104:107], v12, s[40:43], s77 offen offset:1024
L_pubd_61:
    s_mov_b64 exec, -1
    ds_write_b64 v64, v[88:89]
    ds_write_b64 v65, v[90:91]
    ds_write_b64 v66, v[92:93]
    ds_write_b64 v67, v[94:95]
    ds_write_b64 v68, v[96:97]
    ds_write_b64 v69, v[98:99]
    ds_write_b64 v70, v[100:101]
    ds_write_b64 v71, v[102:103]
    v_bfe_u32 v4, v1, 1, 3
    v_bfe_u32 v5, v1, 4, 1
    v_lshlrev_b32_e64 v176, 4, v4
    v_lshl_add_u32 v176, v5, 3, v176
    v_and_b32_e64 v5, 1, v1
    v_lshl_add_u32 v176, v5, 2, v176
    v_lshlrev_b32_e64 v177, 2, v2
    v_lshl_add_u32 v177, v3, 8, v177
    v_and_b32 v4, 15, v1
    v_lshrrev_b32 v5, 4, v1
    v_mul_u32_u24 v179, 149504, v4
    v_lshl_add_u32 v180, v5, 4, v179
    s_lshl_b32 s82, s97, 7
    s_lshl_b32 s79, s62, 5
    s_add_u32 s82, s82, s79
    s_lshl_b32 s79, s62, 2
    v_mov_b32_e64 v7, s79
    v_mul_u32_u24 v178, 9344, v3
    v_lshl_add_u32 v178, v2, 4, v178
    s_mul_i32 s78, s97, 149504
    s_add_u32 s78, s78, s76
    s_add_u32 s78, s78, 8388608
    s_add_u32 s48, s78, 18688
    s_add_u32 s49, s48, 18688
    s_add_u32 s50, s49, 18688
    s_add_u32 s51, s50, 18688
    s_add_u32 s52, s51, 18688
    s_add_u32 s53, s52, 18688
    s_add_u32 s54, s53, 18688
    buffer_load_dwordx4 v[112:115], v178, s[40:43], s78 offen offset:1024 sc1
    buffer_load_dwordx4 v[116:119], v178, s[40:43], s48 offen offset:1024 sc1
    buffer_load_dwordx4 v[120:123], v178, s[40:43], s49 offen offset:1024 sc1
    buffer_load_dwordx4 v[124:127], v178, s[40:43], s50 offen offset:1024 sc1
    buffer_load_dwordx4 v[128:131], v178, s[40:43], s51 offen offset:1024 sc1
    buffer_load_dwordx4 v[132:135], v178, s[40:43], s52 offen offset:1024 sc1
    buffer_load_dwordx4 v[136:139], v178, s[40:43], s53 offen offset:1024 sc1
    buffer_load_dwordx4 v[140:143], v178, s[40:43], s54 offen offset:1024 sc1
    v_dot2_f32_bf16 v76, v208, s89, 0
    v_dot2_f32_bf16 v76, v209, s89, v76
    v_dot2_f32_bf16 v76, v210, s89, v76
    v_dot2_f32_bf16 v76, v211, s89, v76
    v_dot2_f32_bf16 v76, v212, s89, v76
    v_dot2_f32_bf16 v76, v213, s89, v76
    v_dot2_f32_bf16 v76, v214, s89, v76
    v_dot2_f32_bf16 v76, v215, s89, v76
    s_nop 2
    v_add_f32_dpp v76, v76, v76 row_ror:8 row_mask:0xf bank_mask:0xf
    s_nop 1
    v_add_f32_dpp v76, v76, v76 row_ror:4 row_mask:0xf bank_mask:0xf
    s_nop 1
    v_add_f32_dpp v76, v76, v76 row_ror:2 row_mask:0xf bank_mask:0xf
    s_nop 1
    v_add_f32_dpp v76, v76, v76 row_ror:1 row_mask:0xf bank_mask:0xf
    v_mov_b32 v4, v76
    s_nop 1
    v_permlane16_swap_b32 v76, v4
    v_add_f32 v76, v76, v4
    v_mov_b32 v4, v76
    s_nop 1
    v_permlane32_swap_b32 v76, v4
    v_add_f32_e64 v76, v76, v4
    s_mov_b32 s88, 0
    s_waitcnt vmcnt(6)
    v_pk_add_f32 v[108:109], v[112:113], v[116:117]
    v_pk_add_f32 v[110:111], v[114:115], v[118:119]
    s_waitcnt vmcnt(5)
    v_pk_add_f32 v[108:109], v[108:109], v[120:121]
    v_pk_add_f32 v[110:111], v[110:111], v[122:123]
    s_waitcnt vmcnt(4)
    v_pk_add_f32 v[108:109], v[108:109], v[124:125]
    v_pk_add_f32 v[110:111], v[110:111], v[126:127]
    s_waitcnt vmcnt(3)
    v_pk_add_f32 v[108:109], v[108:109], v[128:129]
    v_pk_add_f32 v[110:111], v[110:111], v[130:131]
    s_waitcnt vmcnt(2)
    v_pk_add_f32 v[108:109], v[108:109], v[132:133]
    v_pk_add_f32 v[110:111], v[110:111], v[134:135]
    s_waitcnt vmcnt(1)
    v_pk_add_f32 v[108:109], v[108:109], v[136:137]
    v_pk_add_f32 v[110:111], v[110:111], v[138:139]
    s_waitcnt vmcnt(0)
    v_pk_add_f32 v[108:109], v[108:109], v[140:141]
    v_pk_add_f32 v[110:111], v[110:111], v[142:143]
    v_cmp_u_f32 vcc, v111, v111
    v_mov_b32 v4, v108
    v_mov_b32 v5, v109
    v_mov_b32 v6, v110
    s_cbranch_vccnz L_s3_63
L_s3ok_64:
    v_permlane32_swap_b32 v108, v4
    v_permlane32_swap_b32 v109, v5
    v_permlane32_swap_b32 v110, v6
    s_barrier
    v_add_f32 v108, v108, v4
    v_add_f32 v109, v109, v5
    v_add_f32 v110, v110, v6
    v_mul_f32 v108, 0x3a800000, v108
    v_mul_f32 v109, 0x3a800000, v109
    v_fma_f32 v4, -v108, v108, v109
    v_max_f32_e64 v4, 0, v4
    v_cvt_pk_bf16_f32 v116, v108, v108
    v_and_b32_e64 v116, s90, v116
    v_cvt_pk_bf16_f32 v4, v4, v4
    v_and_b32_e64 v4, s90, v4
    v_add_f32 v4, 0x3727c5ac, v4
    v_cvt_pk_bf16_f32 v4, v4, v4
    v_and_b32 v4, s90, v4
    v_sqrt_f32_e64 v4, v4
    s_nop 0
    v_cvt_pk_bf16_f32 v4, v4, v4
    v_and_b32 v4, s90, v4
    v_rcp_f32 v118, v4
    v_fma_f32 v120, -v116, v76, v110
    v_mul_f32 v119, v116, v118
    v_mul_f32 v120, v120, v118
    v_and_b32 v6, 3, v1
    v_lshlrev_b32 v6, 2, v6
    v_max_f32_dpp v4, v120, v120 row_ror:8 row_mask:0xf bank_mask:0xf
    s_lshl_b32 s83, s62, 12
    v_cmp_gt_u32 s[84:85], 32, v1
    v_max_f32_dpp v4, v4, v4 row_ror:4 row_mask:0xf bank_mask:0xf
    s_lshl_b32 s55, 1, s62
    s_sub_u32 s55, s55, 1
    v_max_f32_dpp v4, v4, v4 row_ror:2 row_mask:0xf bank_mask:0xf
    s_nop 1
    v_max_f32_dpp v4, v4, v4 row_ror:1 row_mask:0xf bank_mask:0xf
    v_mov_b32 v5, v4
    s_nop 1
    v_permlane16_swap_b32 v4, v5
    v_max_f32 v4, v4, v5
    v_cmp_eq_f32_e64 vcc, v4, v120
    ds_write_b32 v7, v4 offset:25600
    s_ff1_i32_b32 s77, vcc_lo
    s_and_b32 s77, s77, 31
    s_bfe_u32 s79, s77, 0x30001
    s_lshl3_add_u32 s79, s77, s79
    s_lshl4_add_u32 s79, s79, s83
    v_xor_b32_e64 v176, s79, v176
    ds_read_b32 v182, v176 offset:0
    s_waitcnt lgkmcnt(1)
    s_barrier
    ds_read_b32 v8, v6 offset:25600
    v_readlane_b32 s80, v118, s77
    v_readlane_b32 s81, v119, s77
    s_add_u32 s79, s82, s77
    v_writelane_b32 v4, s79, 33
    v_mov_b32 v5, s81
    s_waitcnt lgkmcnt(1)
    v_lshlrev_b32 v184, 16, v182
    v_and_b32_e64 v185, s90, v182
    v_fma_f32 v184, v184, s80, -v5
    v_fma_f32 v185, v185, s80, -v5
    v_cvt_pk_bf16_f32 v184, v184, v185
    v_cndmask_b32 v184, v4, v184, s[84:85]
    s_waitcnt lgkmcnt(0)
    v_cmp_eq_f32 s[56:57], v8, v4
    v_cmp_gt_f32 vcc, v8, v4
    s_and_b32 s56, s56, s55
    s_or_b32 s56, s56, vcc_lo
    s_cbranch_scc1 L_nopub_73
    buffer_store_dword v184, v177, s[40:43], s99 offen offset:0 sc1
L_nopub_73:
    v_lshlrev_b32 v16, 16, v88
    v_and_b32_e64 v17, s90, v88
    v_pk_fma_f32 v[144:145], v[16:17], v[118:119], v[118:119] op_sel:[0,0,1] op_sel_hi:[1,0,1] neg_lo:[0,0,1] neg_hi:[0,0,1]
    v_cvt_pk_bf16_f32 v124, v144, v145
    v_lshlrev_b32 v144, 16, v124
    v_and_b32 v145, s90, v124
    v_pk_add_f32 v[144:145], v[144:145], v[16:17]
    v_cvt_pk_bf16_f32 v124, v144, v145
    v_lshlrev_b32 v18, 16, v89
    v_and_b32 v19, s90, v89
    v_pk_fma_f32 v[146:147], v[18:19], v[118:119], v[118:119] op_sel:[0,0,1] op_sel_hi:[1,0,1] neg_lo:[0,0,1] neg_hi:[0,0,1]
    v_cvt_pk_bf16_f32 v125, v146, v147
    v_lshlrev_b32 v146, 16, v125
    v_and_b32 v147, s90, v125
    v_pk_add_f32 v[146:147], v[146:147], v[18:19]
    v_cvt_pk_bf16_f32 v125, v146, v147
    ds_write_b64 v64, v[124:125]
    v_lshlrev_b32 v20, 16, v90
    v_and_b32 v21, s90, v90
    v_pk_fma_f32 v[148:149], v[20:21], v[118:119], v[118:119] op_sel:[0,0,1] op_sel_hi:[1,0,1] neg_lo:[0,0,1] neg_hi:[0,0,1]
    v_cvt_pk_bf16_f32 v126, v148, v149
    v_lshlrev_b32 v148, 16, v126
    v_and_b32 v149, s90, v126
    v_pk_add_f32 v[148:149], v[148:149], v[20:21]
    v_cvt_pk_bf16_f32 v126, v148, v149
    v_lshlrev_b32 v22, 16, v91
    v_and_b32 v23, s90, v91
    v_pk_fma_f32 v[150:151], v[22:23], v[118:119], v[118:119] op_sel:[0,0,1] op_sel_hi:[1,0,1] neg_lo:[0,0,1] neg_hi:[0,0,1]
    v_cvt_pk_bf16_f32 v127, v150, v151
    v_lshlrev_b32 v150, 16, v127
    v_and_b32 v151, s90, v127
    v_pk_add_f32 v[150:151], v[150:151], v[22:23]
    v_cvt_pk_bf16_f32 v127, v150, v151
    ds_write_b64 v65, v[126:127]
    v_lshlrev_b32 v24, 16, v92
    v_and_b32 v25, s90, v92
    v_pk_fma_f32 v[152:153], v[24:25], v[118:119], v[118:119] op_sel:[0,0,1] op_sel_hi:[1,0,1] neg_lo:[0,0,1] neg_hi:[0,0,1]
    v_cvt_pk_bf16_f32 v128, v152, v153
    v_lshlrev_b32 v152, 16, v128
    v_and_b32 v153, s90, v128
    v_pk_add_f32 v[152:153], v[152:153], v[24:25]
    v_cvt_pk_bf16_f32 v128, v152, v153
    v_lshlrev_b32 v26, 16, v93
    v_and_b32 v27, s90, v93
    v_pk_fma_f32 v[154:155], v[26:27], v[118:119], v[118:119] op_sel:[0,0,1] op_sel_hi:[1,0,1] neg_lo:[0,0,1] neg_hi:[0,0,1]
    v_cvt_pk_bf16_f32 v129, v154, v155
    v_lshlrev_b32 v154, 16, v129
    v_and_b32 v155, s90, v129
    v_pk_add_f32 v[154:155], v[154:155], v[26:27]
    v_cvt_pk_bf16_f32 v129, v154, v155
    ds_write_b64 v66, v[128:129]
    v_lshlrev_b32 v28, 16, v94
    v_and_b32 v29, s90, v94
    v_pk_fma_f32 v[156:157], v[28:29], v[118:119], v[118:119] op_sel:[0,0,1] op_sel_hi:[1,0,1] neg_lo:[0,0,1] neg_hi:[0,0,1]
    v_cvt_pk_bf16_f32 v130, v156, v157
    v_lshlrev_b32 v156, 16, v130
    v_and_b32 v157, s90, v130
    v_pk_add_f32 v[156:157], v[156:157], v[28:29]
    v_cvt_pk_bf16_f32 v130, v156, v157
    v_lshlrev_b32 v30, 16, v95
    v_and_b32 v31, s90, v95
    v_pk_fma_f32 v[158:159], v[30:31], v[118:119], v[118:119] op_sel:[0,0,1] op_sel_hi:[1,0,1] neg_lo:[0,0,1] neg_hi:[0,0,1]
    v_cvt_pk_bf16_f32 v131, v158, v159
    v_lshlrev_b32 v158, 16, v131
    v_and_b32 v159, s90, v131
    v_pk_add_f32 v[158:159], v[158:159], v[30:31]
    v_cvt_pk_bf16_f32 v131, v158, v159
    ds_write_b64 v67, v[130:131]
    v_and_b32 v7, 15, v1
    v_lshlrev_b32 v7, 3, v7
    s_cmp_eq_u32 s62, 0
    s_cbranch_scc0 L_nos4_74
    s_mul_i32 s76, s98, 9344
    s_add_u32 s76, s76, 8388608
    s_mov_b32 s88, 0
L_poll_75:
    buffer_load_dwordx2 v[196:197], v179, s[40:43], s76 offen offset:256 sc1
    buffer_load_dwordx4 v[188:191], v180, s[40:43], s76 offen offset:0 sc1
    buffer_load_dwordx4 v[192:195], v180, s[40:43], s76 offen offset:64 sc1
    s_waitcnt vmcnt(0)
    v_max3_u32 v4, v196, v197, v188
    v_max3_u32 v4, v4, v189, v190
    v_max3_u32 v4, v4, v191, v192
    v_max3_u32 v4, v4, v193, v194
    v_max_u32 v4, v4, v195
    v_cmp_eq_u32_e64 vcc, -1, v4
    s_nop 0
    s_cbranch_vccz L_ok_76
    s_add_u32 s88, s88, 1
    s_cmp_lt_u32 s88, 65536
    s_cbranch_scc1 L_poll_75
L_ok_76:
    ds_write_b128 v12, v[188:191] offset:28672
    ds_write_b128 v12, v[192:195] offset:29696
    ds_write_b64 v7, v[196:197] offset:25728
L_nos4_74:
    s_waitcnt lgkmcnt(0)
    s_barrier
    ds_read_b64 v[8:9], v7 offset:25728
    s_waitcnt lgkmcnt(0)
    v_max_f32_dpp v4, v8, v8 row_ror:8 row_mask:0xf bank_mask:0xf
    s_nop 1
    v_max_f32_dpp v4, v4, v4 row_ror:4 row_mask:0xf bank_mask:0xf
    s_nop 1
    v_max_f32_dpp v4, v4, v4 row_ror:2 row_mask:0xf bank_mask:0xf
    s_nop 1
    v_max_f32_dpp v4, v4, v4 row_ror:1 row_mask:0xf bank_mask:0xf
    v_cmp_eq_f32 vcc, v4, v8
    s_nop 0
    s_ff1_i32_b32 s92, vcc_lo
    s_and_b32 s92, s92, 15
    s_nop 3
    v_readlane_b32 s91, v9, s92
    s_nop 0
    s_cmp_eq_u32 s91, s79
    s_cbranch_scc0 L_noh_77
    s_mov_b32 exec_hi, 0
    buffer_store_dword v182, v177, s[40:43], s99 offen offset:128 sc1
    s_mov_b64 exec, -1
L_noh_77:
    s_sub_u32 s77, s91, s82
    v_lshrrev_b32 v7, 3, v1
    v_sub_u32 v5, s77, v7
    v_mov_b32 v6, 2146435072
    v_and_b32 v8, 7, v1
    v_lshrrev_b32 v9, 4, v1
    v_xor_b32 v8, v8, v9
    v_lshlrev_b32 v8, 4, v8
    v_lshl_add_u32 v7, v7, 11, v8
    v_xor_b32 v8, 64, v7
    s_lshl_b32 s76, s82, 11
    s_lshl_b32 s79, s98, 7
    s_add_u32 s76, s76, s79
    v_cmp_eq_u32 vcc, 0, v5
    s_nop 1
    v_cndmask_b32 v200, v7, v6, vcc
    v_cmp_eq_u32 vcc, 8, v5
    s_nop 1
    v_cndmask_b32 v201, v8, v6, vcc
    v_cmp_eq_u32 vcc, 16, v5
    s_nop 1
    v_cndmask_b32 v202, v7, v6, vcc
    v_cmp_eq_u32 vcc, 24, v5
    s_nop 1
    v_cndmask_b32 v203, v8, v6, vcc
    v_lshlrev_b32 v32, 16, v96
    v_and_b32 v33, s90, v96
    v_pk_fma_f32 v[160:161], v[32:33], v[118:119], v[118:119] op_sel:[0,0,1] op_sel_hi:[1,0,1] neg_lo:[0,0,1] neg_hi:[0,0,1]
    v_cvt_pk_bf16_f32 v132, v160, v161
    v_lshlrev_b32 v160, 16, v132
    v_and_b32 v161, s90, v132
    v_pk_add_f32 v[160:161], v[160:161], v[32:33]
    v_cvt_pk_bf16_f32 v132, v160, v161
    v_lshlrev_b32 v34, 16, v97
    v_and_b32 v35, s90, v97
    v_pk_fma_f32 v[162:163], v[34:35], v[118:119], v[118:119] op_sel:[0,0,1] op_sel_hi:[1,0,1] neg_lo:[0,0,1] neg_hi:[0,0,1]
    v_cvt_pk_bf16_f32 v133, v162, v163
    v_lshlrev_b32 v162, 16, v133
    v_and_b32 v163, s90, v133
    v_pk_add_f32 v[162:163], v[162:163], v[34:35]
    v_cvt_pk_bf16_f32 v133, v162, v163
    ds_write_b64 v68, v[132:133]
    v_lshlrev_b32 v36, 16, v98
    v_and_b32 v37, s90, v98
    v_pk_fma_f32 v[164:165], v[36:37], v[118:119], v[118:119] op_sel:[0,0,1] op_sel_hi:[1,0,1] neg_lo:[0,0,1] neg_hi:[0,0,1]
    v_cvt_pk_bf16_f32 v134, v164, v165
    v_lshlrev_b32 v164, 16, v134
    v_and_b32 v165, s90, v134
    v_pk_add_f32 v[164:165], v[164:165], v[36:37]
    v_cvt_pk_bf16_f32 v134, v164, v165
    v_lshlrev_b32 v38, 16, v99
    v_and_b32 v39, s90, v99
    v_pk_fma_f32 v[166:167], v[38:39], v[118:119], v[118:119] op_sel:[0,0,1] op_sel_hi:[1,0,1] neg_lo:[0,0,1] neg_hi:[0,0,1]
    v_cvt_pk_bf16_f32 v135, v166, v167
    v_lshlrev_b32 v166, 16, v135
    v_and_b32 v167, s90, v135
    v_pk_add_f32 v[166:167], v[166:167], v[38:39]
    v_cvt_pk_bf16_f32 v135, v166, v167
    ds_write_b64 v69, v[134:135]
    s_lshl_b32 s77, s62, 12
    s_add_u32 s77, s77, 0
    v_add_u32 v4, s77, v12
    s_barrier
    v_lshlrev_b32 v40, 16, v100
    v_and_b32 v41, s90, v100
    v_pk_fma_f32 v[168:169], v[40:41], v[118:119], v[118:119] op_sel:[0,0,1] op_sel_hi:[1,0,1] neg_lo:[0,0,1] neg_hi:[0,0,1]
    v_cvt_pk_bf16_f32 v136, v168, v169
    v_lshlrev_b32 v168, 16, v136
    v_and_b32 v169, s90, v136
    v_pk_add_f32 v[168:169], v[168:169], v[40:41]
    v_cvt_pk_bf16_f32 v136, v168, v169
    v_lshlrev_b32 v42, 16, v101
    v_and_b32 v43, s90, v101
    v_pk_fma_f32 v[170:171], v[42:43], v[118:119], v[118:119] op_sel:[0,0,1] op_sel_hi:[1,0,1] neg_lo:[0,0,1] neg_hi:[0,0,1]
    v_cvt_pk_bf16_f32 v137, v170, v171
    v_lshlrev_b32 v170, 16, v137
    v_and_b32 v171, s90, v137
    v_pk_add_f32 v[170:171], v[170:171], v[42:43]
    v_cvt_pk_bf16_f32 v137, v170, v171
    ds_write_b64 v70, v[136:137]
    v_lshlrev_b32 v44, 16, v102
    v_and_b32 v45, s90, v102
    v_pk_fma_f32 v[172:173], v[44:45], v[118:119], v[118:119] op_sel:[0,0,1] op_sel_hi:[1,0,1] neg_lo:[0,0,1] neg_hi:[0,0,1]
    v_cvt_pk_bf16_f32 v138, v172, v173
    v_lshlrev_b32 v172, 16, v138
    v_and_b32 v173, s90, v138
    v_pk_add_f32 v[172:173], v[172:173], v[44:45]
    v_cvt_pk_bf16_f32 v138, v172, v173
    v_lshlrev_b32 v46, 16, v103
    v_and_b32 v47, s90, v103
    v_pk_fma_f32 v[174:175], v[46:47], v[118:119], v[118:119] op_sel:[0,0,1] op_sel_hi:[1,0,1] neg_lo:[0,0,1] neg_hi:[0,0,1]
    v_cvt_pk_bf16_f32 v139, v174, v175
    v_lshlrev_b32 v174, 16, v139
    v_and_b32 v175, s90, v139
    v_pk_add_f32 v[174:175], v[174:175], v[46:47]
    v_cvt_pk_bf16_f32 v139, v174, v175
    ds_write_b64 v71, v[138:139]
    s_waitcnt lgkmcnt(0)
    ds_read_b128 v[48:51], v4 offset:0
    ds_read_b128 v[52:55], v4 offset:1024
    ds_read_b128 v[56:59], v4 offset:2048
    ds_read_b128 v[60:63], v4 offset:3072
    s_waitcnt lgkmcnt(3)
    buffer_store_dwordx4 v[48:51], v200, s[44:47], s76 offen sc1
    s_add_u32 s76, s76, 16384
    s_waitcnt lgkmcnt(2)
    buffer_store_dwordx4 v[52:55], v201, s[44:47], s76 offen sc1
    s_add_u32 s76, s76, 16384
    s_waitcnt lgkmcnt(1)
    buffer_store_dwordx4 v[56:59], v202, s[44:47], s76 offen sc1
    s_add_u32 s76, s76, 16384
    s_waitcnt lgkmcnt(0)
    buffer_store_dwordx4 v[60:63], v203, s[44:47], s76 offen sc1
L_cfin:
L_end:
    s_endpgm
L_tr0:
    s_call_b64 s[54:55], L_stall
    s_branch L_bk0
L_tr1:
    s_call_b64 s[54:55], L_stall
    s_branch L_bk1
L_tr2:
    s_call_b64 s[54:55], L_stall
    s_branch L_bk2
L_tr3:
    s_call_b64 s[54:55], L_stall
    s_branch L_bk3
L_tr4:
    s_call_b64 s[54:55], L_stall
    s_branch L_bk4
L_tr5:
    s_call_b64 s[54:55], L_stall
    s_branch L_bk5
L_tr6:
    s_call_b64 s[54:55], L_stall
    s_branch L_bk6
L_tr7:
    s_call_b64 s[54:55], L_stall
    s_branch L_bk7
L_tr8:
    s_call_b64 s[54:55], L_stall
    s_branch L_bk8
L_tr9:
    s_call_b64 s[54:55], L_stall
    s_branch L_bk9
L_tr10:
    s_call_b64 s[54:55], L_stall
    s_branch L_bk10
L_tr11:
    s_call_b64 s[54:55], L_stall
    s_branch L_bk11
L_tr12:
    s_call_b64 s[54:55], L_stall
    s_branch L_bk12
L_tr13:
    s_call_b64 s[54:55], L_stall
    s_branch L_bk13
L_tr14:
    s_call_b64 s[54:55], L_stall
    s_branch L_bk14
L_tr15:
    s_call_b64 s[54:55], L_stall
    s_branch L_bk15
L_stall:
    s_cmp_eq_u32 s53, 0
    s_cbranch_scc0 L_sent_59
    s_waitcnt vmcnt(0)
    s_mov_b64 exec, 1
    ds_add_u32 v8, v74 offset:25988
    s_mov_b64 exec, -1
    s_mov_b32 s53, 1
L_sent_59:
    s_mov_b32 s88, 0
L_stall1:
    ds_read_b32 v79, v8 offset:25984
    s_waitcnt lgkmcnt(0)
    v_readfirstlane_b32 s76, v79
    s_nop 0
    s_and_b32 s76, s76, s52
    s_cbranch_scc1 L_stall2
    s_add_u32 s88, s88, 1
    s_cmp_lt_u32 s88, 1048576
    s_cbranch_scc1 L_stall1
    s_mov_b32 s76, s52
L_stall2:
    s_setpc_b64 s[54:55]
L_s3_63:
    v_cmp_eq_u32_e64 vcc, -1, v115
    s_nop 0
    s_cbranch_vccz L_s3skip_65
    buffer_load_dwordx4 v[112:115], v178, s[40:43], s78 offen offset:1024 sc1
L_s3skip_65:
    v_cmp_eq_u32_e64 vcc, -1, v119
    s_nop 0
    s_cbranch_vccz L_s3skip_66
    buffer_load_dwordx4 v[116:119], v178, s[40:43], s48 offen offset:1024 sc1
L_s3skip_66:
    v_cmp_eq_u32_e64 vcc, -1, v123
    s_nop 0
    s_cbranch_vccz L_s3skip_67
    buffer_load_dwordx4 v[120:123], v178, s[40:43], s49 offen offset:1024 sc1
L_s3skip_67:
    v_cmp_eq_u32_e64 vcc, -1, v127
    s_nop 0
    s_cbranch_vccz L_s3skip_68
    buffer_load_dwordx4 v[124:127], v178, s[40:43], s50 offen offset:1024 sc1
L_s3skip_68:
    v_cmp_eq_u32_e64 vcc, -1, v131
    s_nop 0
    s_cbranch_vccz L_s3skip_69
    buffer_load_dwordx4 v[128:131], v178, s[40:43], s51 offen offset:1024 sc1
L_s3skip_69:
    v_cmp_eq_u32_e64 vcc, -1, v135
    s_nop 0
    s_cbranch_vccz L_s3skip_70
    buffer_load_dwordx4 v[132:135], v178, s[40:43], s52 offen offset:1024 sc1
L_s3skip_70:
    v_cmp_eq_u32_e64 vcc, -1, v139
    s_nop 0
    s_cbranch_vccz L_s3skip_71
    buffer_load_dwordx4 v[136:139], v178, s[40:43], s53 offen offset:1024 sc1
L_s3skip_71:
    v_cmp_eq_u32_e64 vcc, -1, v143
    s_nop 0
    s_cbranch_vccz L_s3skip_72
    buffer_load_dwordx4 v[140:143], v178, s[40:43], s54 offen offset:1024 sc1
L_s3skip_72:
    s_waitcnt vmcnt(0)
    v_pk_add_f32 v[108:109], v[112:113], v[116:117]
    v_pk_add_f32 v[110:111], v[114:115], v[118:119]
    v_pk_add_f32 v[108:109], v[108:109], v[120:121]
    v_pk_add_f32 v[110:111], v[110:111], v[122:123]
    v_pk_add_f32 v[108:109], v[108:109], v[124:125]
    v_pk_add_f32 v[110:111], v[110:111], v[126:127]
    v_pk_add_f32 v[108:109], v[108:109], v[128:129]
    v_pk_add_f32 v[110:111], v[110:111], v[130:131]
    v_pk_add_f32 v[108:109], v[108:109], v[132:133]
    v_pk_add_f32 v[110:111], v[110:111], v[134:135]
    v_pk_add_f32 v[108:109], v[108:109], v[136:137]
    v_pk_add_f32 v[110:111], v[110:111], v[138:139]
    v_pk_add_f32 v[108:109], v[108:109], v[140:141]
    v_pk_add_f32 v[110:111], v[110:111], v[142:143]
    v_cmp_u_f32 vcc, v111, v111
    v_mov_b32 v4, v108
    v_mov_b32 v5, v109
    v_mov_b32_e64 v6, v110
    s_cbranch_vccz L_s3ok_64
    s_add_u32 s88, s88, 1
    s_cmp_lt_u32 s88, 65536
    s_cbranch_scc1 L_s3_63
    s_branch L_s3ok_64
L_code_end:
s_endpgm
.p2align 7
.type L_table,@object
L_table:
.long 0x650c3824, 0xfedba97, 0x50102, 0x3006
.long 0x650c3824, 0xfedba97, 0x510200, 0x3060
.long 0x641d0935, 0xfecba87, 0x5020001, 0x3600
.long 0x76543218, 0xfedcba9, 0x15000002, 0x6300
.long 0x641d0935, 0xfecba87, 0x25100, 0x3006
.long 0x54e2a160, 0xfdcb987, 0x502001, 0x3060
.long 0x54e2a160, 0xfdcb987, 0x5002010, 0x3600
.long 0x54f3b271, 0xedca986, 0x50201000, 0x6300
.long 0x54f3b271, 0xedca986, 0x152000, 0x3006
.long 0x650c3824, 0xfedba97, 0x520010, 0x3060
.long 0x650c3824, 0xfedba97, 0x5020001, 0x3600
.long 0x76543218, 0xfedcba9, 0x50000012, 0x6300
.long 0x641d0935, 0xfecba87, 0x25010, 0x3006
.long 0x641d0935, 0xfecba87, 0x510020, 0x3060
.long 0x54e2a160, 0xfdcb987, 0x5100002, 0x3600
.long 0x54e2a160, 0xfdcb987, 0x50001002, 0x6300
.long 0x641d0935, 0xfecba87, 0x500210, 0x3060
.long 0x641d0935, 0xfecba87, 0x5010200, 0x3600
.long 0x54e2a160, 0xfdcb987, 0x50100002, 0x6300
.long 0x76543209, 0xfedcba8, 0x15002, 0x3006
.long 0x54e2a160, 0xfdcb987, 0x501002, 0x3060
.long 0x54f3b271, 0xedca986, 0x5000120, 0x3600
.long 0x54f3b271, 0xedca986, 0x50000012, 0x6300
.long 0x650c3824, 0xfedba97, 0x15200, 0x3006
.long 0x650c3824, 0xfedba97, 0x520100, 0x3060
.long 0x641d0935, 0xfecba87, 0x5001200, 0x3600
.long 0x641d0935, 0xfecba87, 0x50020001, 0x6300
.long 0x76543209, 0xfedcba8, 0x25001, 0x3006
.long 0x54e2a160, 0xfdcb987, 0x502100, 0x3060
.long 0x54e2a160, 0xfdcb987, 0x5002010, 0x3600
.long 0x54f3b271, 0xedca986, 0x50001002, 0x6300
.long 0x54f3b271, 0xedca986, 0x152000, 0x3006
.long 0x54e2a160, 0xfdcb987, 0x5001002, 0x3600
.long 0x54e2a160, 0xfdcb987, 0x50000012, 0x6300
.long 0x54f3b271, 0xedca986, 0x51020, 0x3006
.long 0x765431a0, 0xfedcb98, 0x150200, 0x3060
.long 0x54f3b271, 0xedca986, 0x5102000, 0x3600
.long 0x650c3824, 0xfedba97, 0x50000102, 0x6300
.long 0x650c3824, 0xfedba97, 0x15020, 0x3006
.long 0x641d0935, 0xfecba87, 0x510200, 0x3060
.long 0x641d0935, 0xfecba87, 0x5020100, 0x3600
.long 0x54e2a160, 0xfdcb987, 0x50100002, 0x6300
.long 0x54e2a160, 0xfdcb987, 0x250001, 0x3006
.long 0x765431a0, 0xfedcb98, 0x251000, 0x3060
.long 0x54f3b271, 0xedca986, 0x5200010, 0x3600
.long 0x54f3b271, 0xedca986, 0x50200001, 0x6300
.long 0x650c3824, 0xfedba97, 0x50021, 0x3006
.long 0x650c3824, 0xfedba97, 0x520010, 0x3060
.long 0x54f3b271, 0xedca986, 0x50200010, 0x6300
.long 0x54f3b271, 0xedca986, 0x152000, 0x3006
.long 0x650c3824, 0xfedba97, 0x500102, 0x3060
.long 0x765421b0, 0xfedca98, 0x2500010, 0x3600
.long 0x650c3824, 0xfedba97, 0x50010200, 0x6300
.long 0x641d0935, 0xfecba87, 0x15200, 0x3006
.long 0x641d0935, 0xfecba87, 0x520001, 0x3060
.long 0x54e2a160, 0xfdcb987, 0x5100020, 0x3600
.long 0x54e2a160, 0xfdcb987, 0x50001020, 0x6300
.long 0x54f3b271, 0xedca986, 0x52001, 0x3006
.long 0x54f3b271, 0xedca986, 0x500102, 0x3060
.long 0x765421b0, 0xfedca98, 0x1500020, 0x3600
.long 0x650c3824, 0xfedba97, 0x50000021, 0x6300
.long 0x650c3824, 0xfedba97, 0x521000, 0x3006
.long 0x641d0935, 0xfecba87, 0x520100, 0x3060
.long 0x641d0935, 0xfecba87, 0x5001002, 0x3600
.long 0x650c3824, 0xfedba97, 0x50021, 0x3006
.long 0x650c3824, 0xfedba97, 0x520010, 0x3060
.long 0x641d0935, 0xfecba87, 0x5010002, 0x3600
.long 0x76532c10, 0xfedba98, 0x15002000, 0x6300
.long 0x641d0935, 0xfecba87, 0x50021, 0x3006
.long 0x54e2a160, 0xfdcb987, 0x251000, 0x3060
.long 0x54e2a160, 0xfdcb987, 0x5000012, 0x3600
.long 0x54f3b271, 0xedca986, 0x50100002, 0x6300
.long 0x54f3b271, 0xedca986, 0x51020, 0x3006
.long 0x650c3824, 0xfedba97, 0x510200, 0x3060
.long 0x650c3824, 0xfedba97, 0x5000102, 0x3600
.long 0x76532c10, 0xfedba98, 0x50000210, 0x6300
.long 0x641d0935, 0xfecba87, 0x50210, 0x3006
.long 0x641d0935, 0xfecba87, 0x520100, 0x3060
.long 0x54e2a160, 0xfdcb987, 0x5100020, 0x3600
.long 0x54e2a160, 0xfdcb987, 0x50000021, 0x6300
.long 0x641d0935, 0xfecba87, 0x500120, 0x3060
.long 0x641d0935, 0xfecba87, 0x5000012, 0x3600
.long 0x54e2a160, 0xfdcb987, 0x50002010, 0x6300
.long 0x76432d10, 0xfecba98, 0x150002, 0x3006
.long 0x54e2a160, 0xfdcb987, 0x510020, 0x3060
.long 0x54f3b271, 0xedca986, 0x5201000, 0x3600
.long 0x54f3b271, 0xedca986, 0x50100020, 0x6300
.long 0x650c3824, 0xfedba97, 0x50102, 0x3006
.long 0x650c3824, 0xfedba97, 0x510200, 0x3060
.long 0x641d0935, 0xfecba87, 0x5000021, 0x3600
.long 0x641d0935, 0xfecba87, 0x50010020, 0x6300
.long 0x76432d10, 0xfecba98, 0x50201, 0x3006
.long 0x54e2a160, 0xfdcb987, 0x251000, 0x3060
.long 0x54e2a160, 0xfdcb987, 0x5100002, 0x3600
.long 0x54f3b271, 0xedca986, 0x50200010, 0x6300
.long 0x54f3b271, 0xedca986, 0x250001, 0x3006
.long 0x54e2a160, 0xfdcb987, 0x5001020, 0x3600
.long 0x54e2a160, 0xfdcb987, 0x50002100, 0x6300
.long 0x54f3b271, 0xedca986, 0x250100, 0x3006
.long 0x7543e210, 0xfdcba98, 0x1502000, 0x3060
.long 0x54f3b271, 0xedca986, 0x5200010, 0x3600
.long 0x650c3824, 0xfedba97, 0x50000201, 0x6300
.long 0x650c3824, 0xfedba97, 0x15200, 0x3006
.long 0x641d0935, 0xfecba87, 0x500120, 0x3060
.long 0x641d0935, 0xfecba87, 0x5010200, 0x3600
.long 0x54e2a160, 0xfdcb987, 0x50100020, 0x6300
.long 0x54e2a160, 0xfdcb987, 0x52010, 0x3006
.long 0x7543e210, 0xfdcba98, 0x500021, 0x3060
.long 0x54f3b271, 0xedca986, 0x5100020, 0x3600
.long 0x54f3b271, 0xedca986, 0x50001020, 0x6300
.long 0x650c3824, 0xfedba97, 0x51200, 0x3006
.long 0x650c3824, 0xfedba97, 0x500120, 0x3060
.long 0x54f3b271, 0xedca986, 0x50000102, 0x6300
.long 0x54f3b271, 0xedca986, 0x50012, 0x3006
.long 0x650c3824, 0xfedba97, 0x500120, 0x3060
.long 0x6543f210, 0xedcba98, 0x15200000, 0x3600
.long 0x650c3824, 0xfedba97, 0x50001020, 0x6300
.long 0x641d0935, 0xfecba87, 0x15002, 0x3006
.long 0x641d0935, 0xfecba87, 0x500102, 0x3060
.long 0x54e2a160, 0xfdcb987, 0x5102000, 0x3600
.long 0x54e2a160, 0xfdcb987, 0x50201000, 0x6300
.long 0x54f3b271, 0xedca986, 0x150020, 0x3006
.long 0x54f3b271, 0xedca986, 0x501020, 0x3060
.long 0x6543f210, 0xedcba98, 0x25000010, 0x3600
.long 0x650c3824, 0xfedba97, 0x50000201, 0x6300
.long 0x650c3824, 0xfedba97, 0x15200, 0x3006
.long 0x641d0935, 0xfecba87, 0x501200, 0x3060
.long 0x641d0935, 0xfecba87, 0x5000201, 0x3600
.long 0x650c3824, 0xfedba97, 0x50210, 0x3006
.long 0x650c3824, 0xfedba97, 0x510002, 0x3060
.long 0x641d0935, 0xfecba87, 0x5000120, 0x3600
.long 0x76543218, 0xfedcba9, 0x25000010, 0x6300
.long 0x641d0935, 0xfecba87, 0x50210, 0x3006
.long 0x54e2a160, 0xfdcb987, 0x150002, 0x3060
.long 0x54e2a160, 0xfdcb987, 0x5200010, 0x3600
.long 0x54f3b271, 0xedca986, 0x50102000, 0x6300
.long 0x54f3b271, 0xedca986, 0x251000, 0x3006
.long 0x650c3824, 0xfedba97, 0x500120, 0x3060
.long 0x650c3824, 0xfedba97, 0x5000021, 0x3600
.long 0x76543218, 0xfedcba9, 0x15002000, 0x6300
.long 0x641d0935, 0xfecba87, 0x50021, 0x3006
.long 0x641d0935, 0xfecba87, 0x510200, 0x3060
.long 0x54e2a160, 0xfdcb987, 0x5201000, 0x3600
.long 0x54e2a160, 0xfdcb987, 0x50200001, 0x6300
.long 0x641d0935, 0xfecba87, 0x500102, 0x3060
.long 0x641d0935, 0xfecba87, 0x5020010, 0x3600
.long 0x54e2a160, 0xfdcb987, 0x50201000, 0x6300
.long 0x76543209, 0xfedcba8, 0x215000, 0x3006
.long 0x54e2a160, 0xfdcb987, 0x502010, 0x3060
.long 0x54f3b271, 0xedca986, 0x5001002, 0x3600
.long 0x54f3b271, 0xedca986, 0x50200001, 0x6300
.long 0x650c3824, 0xfedba97, 0x50120, 0x3006
.long 0x650c3824, 0xfedba97, 0x510002, 0x3060
.long 0x641d0935, 0xfecba87, 0x5020001, 0x3600
.long 0x641d0935, 0xfecba87, 0x50010200, 0x6300
.long 0x76543209, 0xfedcba8, 0x50102, 0x3006
.long 0x54e2a160, 0xfdcb987, 0x150020, 0x3060
.long 0x54e2a160, 0xfdcb987, 0x5000021, 0x3600
.long 0x54f3b271, 0xedca986, 0x50102000, 0x6300
.long 0x54f3b271, 0xedca986, 0x50012, 0x3006
.long 0x54e2a160, 0xfdcb987, 0x5002010, 0x3600
.long 0x54e2a160, 0xfdcb987, 0x50001020, 0x6300
.long 0x54f3b271, 0xedca986, 0x150002, 0x3006
.long 0x765431a0, 0xfedcb98, 0x500021, 0x3060
.long 0x54f3b271, 0xedca986, 0x5001020, 0x3600
.long 0x650c3824, 0xfedba97, 0x50020001, 0x6300
.long 0x650c3824, 0xfedba97, 0x15002, 0x3006
.long 0x641d0935, 0xfecba87, 0x520100, 0x3060
.long 0x641d0935, 0xfecba87, 0x5010020, 0x3600
.long 0x54e2a160, 0xfdcb987, 0x50002100, 0x6300
.long 0x54e2a160, 0xfdcb987, 0x150002, 0x3006
.long 0x765431a0, 0xfedcb98, 0x150020, 0x3060
.long 0x54f3b271, 0xedca986, 0x5000102, 0x3600
.long 0x54f3b271, 0xedca986, 0x50002010, 0x6300
.long 0x650c3824, 0xfedba97, 0x50102, 0x3006
.long 0x650c3824, 0xfedba97, 0x501002, 0x3060
.long 0x54f3b271, 0xedca986, 0x50102000, 0x6300
.long 0x54f3b271, 0xedca986, 0x250001, 0x3006
.long 0x650c3824, 0xfedba97, 0x520001, 0x3060
.long 0x765421b0, 0xfedca98, 0x1500020, 0x3600
.long 0x650c3824, 0xfedba97, 0x50000102, 0x6300
.long 0x641d0935, 0xfecba87, 0x51020, 0x3006
.long 0x641d0935, 0xfecba87, 0x510020, 0x3060
.long 0x54e2a160, 0xfdcb987, 0x5001002, 0x3600
.long 0x54e2a160, 0xfdcb987, 0x50102000, 0x6300
.long 0x54f3b271, 0xedca986, 0x51002, 0x3006
.long 0x54f3b271, 0xedca986, 0x502010, 0x3060
.long 0x765421b0, 0xfedca98, 0x5100002, 0x3600
.long 0x650c3824, 0xfedba97, 0x50020010, 0x6300
.long 0x650c3824, 0xfedba97, 0x15002, 0x3006
.long 0x641d0935, 0xfecba87, 0x500102, 0x3060
.long 0x641d0935, 0xfecba87, 0x5020010, 0x3600
.long 0x650c3824, 0xfedba97, 0x521000, 0x3006
.long 0x650c3824, 0xfedba97, 0x500021, 0x3060
.long 0x641d0935, 0xfecba87, 0x5000201, 0x3600
.long 0x76532c10, 0xfedba98, 0x15000200, 0x6300
.long 0x641d0935, 0xfecba87, 0x15002, 0x3006
.long 0x54e2a160, 0xfdcb987, 0x501020, 0x3060
.long 0x54e2a160, 0xfdcb987, 0x5000120, 0x3600
.long 0x54f3b271, 0xedca986, 0x50100020, 0x6300
.long 0x54f3b271, 0xedca986, 0x51002, 0x3006
.long 0x650c3824, 0xfedba97, 0x500102, 0x3060
.long 0x650c3824, 0xfedba97, 0x5000210, 0x3600
.long 0x76532c10, 0xfedba98, 0x25000100, 0x6300
.long 0x641d0935, 0xfecba87, 0x50102, 0x3006
.long 0x641d0935, 0xfecba87, 0x501002, 0x3060
.long 0x54e2a160, 0xfdcb987, 0x5002010, 0x3600
.long 0x54e2a160, 0xfdcb987, 0x50102000, 0x6300
.long 0x641d0935, 0xfecba87, 0x520001, 0x3060
.long 0x641d0935, 0xfecba87, 0x5010020, 0x3600
.long 0x54e2a160, 0xfdcb987, 0x50100020, 0x6300
.long 0x76432d10, 0xfecba98, 0x50201, 0x3006
.long 0x54e2a160, 0xfdcb987, 0x251000, 0x3060
.long 0x54f3b271, 0xedca986, 0x5002001, 0x3600
.long 0x54f3b271, 0xedca986, 0x50002010, 0x6300
.long 0x650c3824, 0xfedba97, 0x25100, 0x3006
.long 0x650c3824, 0xfedba97, 0x510020, 0x3060
.long 0x641d0935, 0xfecba87, 0x5000102, 0x3600
.long 0x641d0935, 0xfecba87, 0x50000012, 0x6300
.long 0x76432d10, 0xfecba98, 0x152000, 0x3006
.long 0x54e2a160, 0xfdcb987, 0x500012, 0x3060
.long 0x54e2a160, 0xfdcb987, 0x5210000, 0x3600
.long 0x54f3b271, 0xedca986, 0x50001020, 0x6300
.long 0x54f3b271, 0xedca986, 0x150020, 0x3006
.long 0x54e2a160, 0xfdcb987, 0x5200010, 0x3600
.long 0x54e2a160, 0xfdcb987, 0x50201000, 0x6300
.long 0x54f3b271, 0xedca986, 0x52100, 0x3006
.long 0x7543e210, 0xfdcba98, 0x520001, 0x3060
.long 0x54f3b271, 0xedca986, 0x5100002, 0x3600
.long 0x650c3824, 0xfedba97, 0x50000120, 0x6300
.long 0x650c3824, 0xfedba97, 0x521000, 0x3006
.long 0x641d0935, 0xfecba87, 0x500102, 0x3060
.long 0x641d0935, 0xfecba87, 0x5010002, 0x3600
.long 0x54e2a160, 0xfdcb987, 0x51200000, 0x6300
.long 0x54e2a160, 0xfdcb987, 0x150020, 0x3006
.long 0x7543e210, 0xfdcba98, 0x502010, 0x3060
.long 0x54f3b271, 0xedca986, 0x5002010, 0x3600
.long 0x54f3b271, 0xedca986, 0x50001002, 0x6300
.long 0x650c3824, 0xfedba97, 0x1025000, 0x3006
.long 0x650c3824, 0xfedba97, 0x510200, 0x3060
.long 0x54f3b271, 0xedca986, 0x50100020, 0x6300
.long 0x54f3b271, 0xedca986, 0x51020, 0x3006
.long 0x650c3824, 0xfedba97, 0x510200, 0x3060
.long 0x6543f210, 0xedcba98, 0x5102000, 0x3600
.long 0x650c3824, 0xfedba97, 0x15020000, 0x6300
.long 0x641d0935, 0xfecba87, 0x25100, 0x3006
.long 0x641d0935, 0xfecba87, 0x500210, 0x3060
.long 0x54e2a160, 0xfdcb987, 0x5201000, 0x3600
.long 0x54e2a160, 0xfdcb987, 0x50100002, 0x6300
.long 0x54f3b271, 0xedca986, 0x250001, 0x3006
.long 0x54f3b271, 0xedca986, 0x250010, 0x3060
.long 0x6543f210, 0xedcba98, 0x5002001, 0x3600
.long 0x650c3824, 0xfedba97, 0x50000012, 0x6300
.long 0x650c3824, 0xfedba97, 0x50120, 0x3006
.long 0x641d0935, 0xfecba87, 0x510020, 0x3060
.long 0x641d0935, 0xfecba87, 0x5000021, 0x3600
.fill 1, 4, 0
.size L_table, .-L_table
.section .rodata,"a"
.p2align 6
.amdhsa_kernel sequential_preLN__linear_kernel_hedgehog__moe_arch_mod__prompt_kernel
  .amdhsa_next_free_vgpr 256
  .amdhsa_next_free_sgpr 102
  .amdhsa_accum_offset 256
  .amdhsa_group_segment_fixed_size 0
  .amdhsa_kernarg_size 96
  .amdhsa_user_sgpr_count 2
  .amdhsa_user_sgpr_kernarg_segment_ptr 1
  .amdhsa_system_sgpr_workgroup_id_x 1
  .amdhsa_float_denorm_mode_32 3
.end_amdhsa_kernel
```

```asm
; @launch grid=(256,1,1) block=(512,1,1) lds=163840
.amdgcn_target "amdgcn-amd-amdhsa--gfx950"
.text
.globl sequential_preLN__linear_kernel_hedgehog__moe_arch_mod__prompt_kernel
.p2align 8
.type sequential_preLN__linear_kernel_hedgehog__moe_arch_mod__prompt_kernel,@function
sequential_preLN__linear_kernel_hedgehog__moe_arch_mod__prompt_kernel:
    s_cmp_ge_u32 s2, 256
    s_cbranch_scc1 L_end
    s_load_dwordx2 s[28:29], s[0:1], 0
    s_load_dwordx2 s[32:33], s[0:1], 8
    s_load_dwordx4 s[8:11], s[0:1], 16
    s_load_dwordx16 s[12:27], s[0:1], 32
    v_lshrrev_b32 v4, 6, v0
    v_and_b32 v1, 63, v0
    v_readfirstlane_b32 s79, v4
    s_and_b32 s76, s2, 7
    s_lshr_b32 s77, s2, 3
    s_and_b32 s60, s77, 15
    s_lshl_b32 s76, s76, 3
    s_bfe_u32 s77, s2, 0x10007
    s_lshl2_add_u32 s76, s77, s76
    s_mov_b32 s80, 0x654210b3
    s_mov_b32 s81, 0xfedca987
    s_lshr_b64 s[80:81], s[80:81], s76
    s_and_b32 s61, s80, 15
    s_and_b32 s62, s79, 3
    s_cmp_ge_u32 s79, 4
    s_cbranch_scc1 L_compute
    s_setprio 3
    s_getpc_b64 s[66:67]
L_pc:
    s_lshr_b32 s76, s2, 3
    s_lshl2_add_u32 s76, s76, s62
    s_mul_i32 s76, s76, 256
    v_lshl_add_u32 v91, v1, 7, s76
    s_mov_b64 exec, 3
    global_load_dword v27, v91, s[66:67]
    s_mov_b64 exec, -1
    s_add_u32 s84, s60, s2
    s_and_b32 s84, s84, 3
    s_and_b32 s76, s60, 7
    s_and_b32 s77, s61, 7
    s_cmp_eq_u32 s77, 3
    s_cselect_b32 s84, s76, s84
    v_lshrrev_b32 v4, 3, v1
    v_and_b32 v5, 7, v1
    v_lshrrev_b32_e64 v6, 4, v1
    s_lshl2_add_u32 s76, s60, s62
    s_lshl_b32 s76, s76, 16
    s_mul_i32 s70, s62, 10240
    v_xor_b32 v7, v5, v6
    v_lshlrev_b32 v7, 4, v7
    v_lshl_add_u32 v78, v4, 11, v7
    v_add_u32 v16, s76, v78
    v_xor_b32 v7, 64, v16
    v_add_u32 v17, 15360, v7
    v_add_u32 v18, 30720, v16
    v_add_u32 v19, 46080, v7
    s_mov_b32 s30, 4194304
    s_mov_b32 s31, 0x20000
    s_and_b32 s72, s84, 15
    s_mov_b32 m0, s70
    s_lshl_b32 s71, s72, 7
    s_waitcnt lgkmcnt(0)
    buffer_load_dwordx4 v16, s[28:31], s71 offen offset:0 lds
    s_mul_i32 s72, s72, 393216
    s_lshr_b64 s[84:85], s[84:85], 4
    buffer_load_dwordx4 v17, s[28:31], s71 offen offset:1024 lds
    buffer_load_dwordx4 v18, s[28:31], s71 offen offset:2048 lds
    buffer_load_dwordx4 v19, s[28:31], s71 offen offset:3072 lds
    v_and_b32 v6, 1, v6
    v_lshlrev_b32 v6, 2, v6
    v_xor_b32 v8, v5, v6
    v_lshlrev_b32 v8, 4, v8
    s_lshl_b32 s76, s61, 7
    s_mul_i32 s77, s62, 98304
    s_add_u32 s76, s76, s77
    v_mul_u32_u24 v7, 6144, v4
    v_add3_u32 v20, v7, v8, s76
    v_xor_b32 v7, 32, v20
    s_mov_b32 s34, 6291456
    s_mov_b32 s35, 0x20000
    s_add_u32 m0, s70, 4096
    s_nop 0
    buffer_load_dwordx4 v20, s[32:35], s72 offen offset:0 lds
    v_add_u32 v21, 48128, v7
    buffer_load_dwordx4 v21, s[32:35], s72 offen offset:1024 lds
    v_add_u32 v22, 0, v20
    buffer_load_dwordx4 v22, s[32:35], s72 offen offset:2048 lds
    v_add_u32 v23, 48128, v7
    buffer_load_dwordx4 v23, s[32:35], s72 offen offset:3072 lds
    v_add_u32 v24, 4096, v20
    s_add_u32 m0, s70, 8192
    s_nop 0
    buffer_load_dwordx4 v24, s[32:35], s72 offen offset:0 lds
    v_add_u32 v25, 52224, v7
    buffer_load_dwordx4 v25, s[32:35], s72 offen offset:1024 lds
    s_add_u32 s70, s70, 40960
    s_cmp_ge_u32 s70, 122880
    s_cselect_b32 s76, 122880, 0
    s_sub_u32 s70, s70, s76
    s_lshl_b32 s76, s60, 8
    s_lshl_b32 s77, s61, 4
    s_add_u32 s76, s76, s77
    s_add_u32 s76, s76, 29184
    s_load_dwordx4 s[84:87], s[66:67], s76
    v_lshl_add_u32 v26, v4, 11, v8
    v_xor_b32 v79, 64, v78
    s_and_b32 s63, s62, 1
    s_lshr_b32 s64, s62, 1
    s_lshl_b32 s73, s60, 4
    s_add_u32 s73, s73, s61
    s_mul_i32 s73, s73, 28800
    s_add_u32 s76, s2, 7
    s_and_b32 s76, s76, 7
    s_bfe_u32 s77, s2, 0x10003
    s_lshl1_add_u32 s97, s76, s77
    s_lshr_b32 s98, s2, 4
    s_lshl_b32 s99, s97, 4
    s_add_u32 s99, s99, s98
    s_mul_i32 s99, s99, 9344
    s_add_u32 s99, s99, 8388608
    s_lshr_b32 s65, s97, 1
    s_lshl_b32 s76, s97, 3
    s_add_u32 s65, s65, s76
    s_mul_i32 s76, s98, 4
    s_add_u32 s65, s65, s76
    s_and_b32 s65, s65, 15
    s_mov_b32 s89, 0x3f803f80
    s_mov_b32 s90, 0xffff0000
    v_and_b32 v2, 31, v1
    v_lshrrev_b32 v3, 5, v1
    v_lshlrev_b32 v12, 4, v1
    v_lshrrev_b32 v4, 3, v1
    v_mul_u32_u24 v13, 460800, v4
    v_and_b32_e64 v4, 7, v1
    v_lshl_add_u32 v13, v4, 4, v13
    s_lshl_b32 s76, s98, 7
    s_lshl_b32 s77, s62, 15
    s_add_u32 s76, s76, s77
    v_add_u32_e64 v26, s76, v26
    s_mov_b32 s40, s26
    s_and_b32 s41, s27, 0xffff
    s_mov_b32 s42, 33554432
    s_mov_b32 s43, 0x20000
    s_mov_b32 s56, s8
    s_and_b32 s57, s9, 0xffff
    s_mov_b32 s58, 65536
    s_mov_b32 s59, 0x20000
    v_mov_b32 v28, -1
    v_mov_b32 v29, -1
    v_mov_b32 v30, -1
    v_mov_b32_e64 v31, -1
    s_waitcnt lgkmcnt(0)
    s_and_b32 s72, s84, 15
    s_mov_b32 m0, s70
    s_lshl_b32 s71, s72, 7
    buffer_load_dwordx4 v16, s[28:31], s71 offen offset:0 lds
    s_mul_i32 s72, s72, 393216
    s_lshr_b64 s[84:85], s[84:85], 4
    buffer_load_dwordx4 v17, s[28:31], s71 offen offset:1024 lds
    buffer_load_dwordx4 v18, s[28:31], s71 offen offset:2048 lds
    buffer_load_dwordx4 v19, s[28:31], s71 offen offset:3072 lds
    s_add_u32 m0, s70, 4096
    s_nop 0
    buffer_load_dwordx4 v20, s[32:35], s72 offen offset:0 lds
    buffer_load_dwordx4 v21, s[32:35], s72 offen offset:1024 lds
    buffer_load_dwordx4 v22, s[32:35], s72 offen offset:2048 lds
    buffer_load_dwordx4 v23, s[32:35], s72 offen offset:3072 lds
    s_add_u32 m0, s70, 8192
    s_nop 0
    buffer_load_dwordx4 v24, s[32:35], s72 offen offset:0 lds
    buffer_load_dwordx4 v25, s[32:35], s72 offen offset:1024 lds
    s_add_u32 s70, s70, 40960
    s_cmp_ge_u32 s70, 122880
    s_cselect_b32 s76, 122880, 0
    s_sub_u32 s70, s70, s76
    s_lshl_b32 s77, s62, 10
    s_add_u32 s76, s77, s73
    buffer_store_dwordx4 v[28:31], v12, s[40:43], s76 offen sc1
    s_lshl_b32 s76, s61, 12
    s_add_u32 s76, s76, s77
    s_add_u32 m0, s77, 122880
    s_nop 0
    buffer_load_dwordx4 v12, s[56:59], s76 offen lds
    v_mov_b32 v4, 13631488
    buffer_load_dwordx2 v[88:89], v4, s[40:43], 0 offen
    s_setprio 0
    s_waitcnt vmcnt(13)
    s_barrier
    s_and_b32 s72, s84, 15
    s_mov_b32 m0, s70
    s_lshl_b32 s71, s72, 7
    buffer_load_dwordx4 v16, s[28:31], s71 offen offset:0 lds
    s_mul_i32 s72, s72, 393216
    s_lshr_b64 s[84:85], s[84:85], 4
    buffer_load_dwordx4 v17, s[28:31], s71 offen offset:1024 lds
    buffer_load_dwordx4 v18, s[28:31], s71 offen offset:2048 lds
    buffer_load_dwordx4 v19, s[28:31], s71 offen offset:3072 lds
    s_add_u32 m0, s70, 4096
    s_nop 0
    buffer_load_dwordx4 v20, s[32:35], s72 offen offset:0 lds
    buffer_load_dwordx4 v21, s[32:35], s72 offen offset:1024 lds
    buffer_load_dwordx4 v22, s[32:35], s72 offen offset:2048 lds
    buffer_load_dwordx4 v23, s[32:35], s72 offen offset:3072 lds
    s_add_u32 m0, s70, 8192
    s_nop 0
    buffer_load_dwordx4 v24, s[32:35], s72 offen offset:0 lds
    buffer_load_dwordx4 v25, s[32:35], s72 offen offset:1024 lds
    s_add_u32 s70, s70, 40960
    s_cmp_ge_u32 s70, 122880
    s_cselect_b32 s76, 122880, 0
    s_sub_u32 s70, s70, s76
    s_mov_b32 s36, s10
    s_and_b32 s37, s11, 0xffff
    s_mov_b32 s38, 2097152
    s_mov_b32 s39, 0x20000
    s_mov_b32 s44, s22
    s_and_b32 s45, s23, 0xffff
    s_mov_b32 s46, 4194304
    s_mov_b32 s47, 0x20000
    s_mov_b32 s52, s20
    s_and_b32 s53, s21, 0xffff
    s_mov_b32 s54, 7340032
    s_mov_b32 s55, 0x20000
    s_cmp_eq_u32 s64, 0
    s_cselect_b32 s48, s16, s18
    s_cselect_b32 s49, s17, s19
    s_and_b32 s49, s49, 0xffff
    s_mov_b32 s51, 0x20000
    s_cmp_lt_u32 s97, 14
    s_cselect_b32 s50, 7340032, 0
    s_cselect_b32 s54, 7340032, 0
    v_bfe_u32 v4, v2, 1, 3
    v_xor_b32 v4, v4, v3
    v_lshlrev_b32 v4, 4, v4
    v_lshl_add_u32 v72, v2, 7, v4
    v_bfe_u32 v4, v1, 2, 2
    v_lshl_add_u32 v5, v3, 3, v4
    v_lshlrev_b32 v5, 7, v5
    v_lshrrev_b32 v4, 1, v4
    v_xor_b32_e64 v4, s64, v4
    v_lshl_add_u32 v5, v4, 6, v5
    v_bfe_u32 v4, v1, 4, 1
    v_xor_b32_e64 v4, v4, v3
    v_lshl_add_u32 v5, v4, 5, v5
    v_and_b32_e64 v4, 3, v1
    v_lshl_add_u32 v5, v4, 3, v5
    s_mul_i32 s76, s62, 10240
    s_sub_u32 s76, 4096, s76
    v_add_u32_e64 v73, s76, v5
    v_mul_u32_u24 v74, 28800, v3
    v_lshl_add_u32 v74, v2, 3, v74
    v_lshrrev_b32 v4, 4, v1
    v_and_b32 v5, 15, v1
    v_mul_u32_u24 v75, 460800, v4
    v_lshl_add_u32 v75, v5, 4, v75
    v_lshrrev_b32 v4, 4, v1
    v_and_b32 v5, 15, v1
    v_mul_u32_u24 v76, 114688, v4
    v_lshl_add_u32 v76, v5, 4, v76
    v_lshlrev_b32_e64 v77, 4, v2
    v_lshl_add_u32 v77, v3, 11, v77
    s_mul_i32 s75, s98, 458752
    s_lshl_b32 s77, s97, 9
    s_add_u32 s75, s75, s77
    s_lshl_b32 s77, s63, 8
    s_add_u32 s75, s75, s77
    s_lshl_b32 s96, s97, 19
    s_lshl_b32 s77, s98, 15
    s_add_u32 s96, s96, s77
    s_lshl_b32 s77, s62, 9
    s_add_u32 s96, s96, s77
    s_mov_b32 s68, 1
    s_getreg_b32 s101, hwreg(HW_REG_XCC_ID, 0, 4)
    s_lshl_b32 s76, s61, 8
    s_add_u32 s76, s76, 12582912
    s_lshl_b32 s77, s60, 8
    s_add_u32 s77, s77, 12586752
    s_lshr_b32 s78, s97, 1
    s_lshl_b32 s78, s78, 9
    s_add_u32 s78, s78, 12590592
    v_mov_b32 v4, s76
    v_mov_b32 v5, s77
    v_mov_b32 v6, s78
    v_cmp_gt_u32 vcc, 16, v1
    s_nop 1
    v_cndmask_b32 v4, v5, v4, vcc
    v_cmp_gt_u32 vcc, 32, v1
    s_nop 1
    v_cndmask_b32 v4, v6, v4, vcc
    v_add_u32 v90, v4, v12
    s_waitcnt vmcnt(10)
    s_barrier
L_hloop:
    s_and_b32 s77, s86, 15
    s_cbranch_scc1 L_event
L_evret:
    s_and_b32 s72, s84, 15
    s_mov_b32 m0, s70
    s_lshl_b32 s71, s72, 7
    buffer_load_dwordx4 v16, s[28:31], s71 offen offset:0 lds
    s_mul_i32 s72, s72, 393216
    s_lshr_b64 s[84:85], s[84:85], 4
    buffer_load_dwordx4 v17, s[28:31], s71 offen offset:1024 lds
    buffer_load_dwordx4 v18, s[28:31], s71 offen offset:2048 lds
    buffer_load_dwordx4 v19, s[28:31], s71 offen offset:3072 lds
    s_add_u32 m0, s70, 4096
    s_nop 0
    buffer_load_dwordx4 v20, s[32:35], s72 offen offset:0 lds
    buffer_load_dwordx4 v21, s[32:35], s72 offen offset:1024 lds
    buffer_load_dwordx4 v22, s[32:35], s72 offen offset:2048 lds
    buffer_load_dwordx4 v23, s[32:35], s72 offen offset:3072 lds
    s_add_u32 m0, s70, 8192
    s_nop 0
    buffer_load_dwordx4 v24, s[32:35], s72 offen offset:0 lds
    buffer_load_dwordx4 v25, s[32:35], s72 offen offset:1024 lds
    s_add_u32 s70, s70, 40960
    s_cmp_ge_u32 s70, 122880
    s_cselect_b32 s76, 122880, 0
    s_sub_u32 s70, s70, s76
    s_waitcnt vmcnt(10)
L_hbar:
    s_lshr_b64 s[86:87], s[86:87], 4
    s_add_u32 s68, s68, 1
    s_cmp_lt_u32 s68, 14
    s_barrier
    s_cbranch_scc1 L_hloop
    v_add_co_u32 v88, vcc, 1, v88
    s_nop 1
    v_addc_co_u32 v89, vcc, 0, v89, vcc
    v_cmp_ne_u64 vcc, v[92:93], v[88:89]
    s_nop 0
    s_cbranch_vccz L_hello_ok_1
    s_mov_b32 s88, 0
L_spin_2:
    buffer_load_dwordx4 v[92:95], v90, s[40:43], 0 offen sc1
    s_waitcnt vmcnt(0)
    v_cmp_ne_u64 vcc, v[92:93], v[88:89]
    s_nop 0
    s_cbranch_vccz L_hello_ok_1
    s_add_u32 s88, s88, 1
    s_cmp_lt_u32 s88, 65536
    s_cbranch_scc1 L_spin_2
L_hello_ok_1:
    v_cmp_ne_u32_e64 vcc, s101, v94
    s_nop 0
    s_and_b32 s76, vcc_lo, 0xffff
    s_cselect_b32 s100, 0, 1
    s_cmp_eq_u32 vcc_hi, 0
    s_cselect_b32 s76, 2, 0
    s_or_b32 s100, s100, s76
    v_mov_b32 v4, s100
    v_mov_b32 v5, 0
    ds_write_b32 v5, v4 offset:53248
    s_lshl_b32 s81, s62, 8
    s_mul_i32 s80, s60, 460800
    s_add_u32 s80, s80, s81
    buffer_load_dwordx2 v[32:33], v74, s[40:43], s80 offen offset:0 sc1
    s_add_u32 s80, s80, 57600
    buffer_load_dwordx2 v[34:35], v74, s[40:43], s80 offen offset:0 sc1
    s_add_u32 s80, s80, 57600
    buffer_load_dwordx2 v[36:37], v74, s[40:43], s80 offen offset:0 sc1
    s_add_u32 s80, s80, 57600
    buffer_load_dwordx2 v[38:39], v74, s[40:43], s80 offen offset:0 sc1
    s_add_u32 s80, s80, 57600
    buffer_load_dwordx2 v[40:41], v74, s[40:43], s80 offen offset:0 sc1
    s_add_u32 s80, s80, 57600
    buffer_load_dwordx2 v[42:43], v74, s[40:43], s80 offen offset:0 sc1
    s_add_u32 s80, s80, 57600
    buffer_load_dwordx2 v[44:45], v74, s[40:43], s80 offen offset:0 sc1
    s_add_u32 s80, s80, 57600
    buffer_load_dwordx2 v[46:47], v74, s[40:43], s80 offen offset:0 sc1
    s_mul_i32 s80, s61, 28800
    s_add_u32 s80, s80, s81
    buffer_load_dwordx4 v[48:51], v75, s[40:43], s80 offen offset:1024 sc1
    s_add_u32 s80, s80, 1843200
    buffer_load_dwordx4 v[52:55], v75, s[40:43], s80 offen offset:1024 sc1
    s_add_u32 s80, s80, 1843200
    buffer_load_dwordx4 v[56:59], v75, s[40:43], s80 offen offset:1024 sc1
    s_add_u32 s80, s80, 1843200
    buffer_load_dwordx4 v[60:63], v75, s[40:43], s80 offen offset:1024 sc1
    v_bfe_u32 v10, v1, 4, 1
    v_lshl_add_u32 v10, v10, 1, v3
    v_min_u32 v10, 2, v10
    v_and_b32 v7, 15, v1
    v_lshlrev_b32_e64 v7, 3, v7
    s_lshl_b32 s76, s62, 7
    v_lshl_add_u32 v10, v10, 9, v7
    v_add_u32_e64 v64, s76, v10
    v_lshl_add_u32 v65, v2, 3, s81
    s_waitcnt vmcnt(12)
    s_barrier
    s_mul_i32 s78, s62, 2048
    s_add_u32 s78, s78, s99
    s_add_u32 s78, s78, 1024
    v_lshlrev_b32 v11, 7, v1
    s_mov_b64 exec, 65535
    buffer_load_dword v27, v11, s[40:43], s78 offen sc1
    s_mov_b64 exec, -1
    buffer_load_dwordx4 v[152:155], v76, s[48:51], s75 offen nt
    s_add_u32 s75, s75, 7168
    s_add_u32 s78, s65, 0
    s_and_b32 s78, s78, 15
    s_lshl_b32 s78, s78, 17
    s_lshl_b32 s79, s62, 11
    s_add_u32 m0, s79, 57344
    s_add_u32 s79, s78, 15360
    buffer_load_dwordx4 v26, s[36:39], s78 offen lds
    buffer_load_dwordx4 v26, s[36:39], s79 offen offset:1024 lds
    s_add_u32 s78, s65, 1
    s_and_b32 s78, s78, 15
    s_lshl_b32 s78, s78, 17
    s_lshl_b32 s79, s62, 11
    s_add_u32 m0, s79, 65536
    s_add_u32 s79, s78, 15360
    buffer_load_dwordx4 v26, s[36:39], s78 offen lds
    buffer_load_dwordx4 v26, s[36:39], s79 offen offset:1024 lds
    s_setprio 3
    s_mov_b32 s88, 0
    s_waitcnt vmcnt(10)
    s_branch L_g1first_3
L_g1_4:
    s_mul_i32 s80, s60, 460800
    s_add_u32 s80, s80, s81
    buffer_load_dwordx2 v[32:33], v74, s[40:43], s80 offen offset:0 sc1
    s_add_u32 s80, s80, 57600
    buffer_load_dwordx2 v[34:35], v74, s[40:43], s80 offen offset:0 sc1
    s_add_u32 s80, s80, 57600
    buffer_load_dwordx2 v[36:37], v74, s[40:43], s80 offen offset:0 sc1
    s_add_u32 s80, s80, 57600
    buffer_load_dwordx2 v[38:39], v74, s[40:43], s80 offen offset:0 sc1
    s_add_u32 s80, s80, 57600
    buffer_load_dwordx2 v[40:41], v74, s[40:43], s80 offen offset:0 sc1
    s_add_u32 s80, s80, 57600
    buffer_load_dwordx2 v[42:43], v74, s[40:43], s80 offen offset:0 sc1
    s_add_u32 s80, s80, 57600
    buffer_load_dwordx2 v[44:45], v74, s[40:43], s80 offen offset:0 sc1
    s_add_u32 s80, s80, 57600
    buffer_load_dwordx2 v[46:47], v74, s[40:43], s80 offen offset:0 sc1
    s_waitcnt vmcnt(0)
L_g1first_3:
    v_max3_u32 v4, v32, v34, v36
    v_max3_u32 v4, v4, v38, v40
    v_max3_u32 v4, v4, v42, v44
    v_max_u32 v4, v4, v46
    v_cmp_eq_u32 vcc, -1, v4
    s_nop 0
    s_cbranch_vccz L_ok_5
    s_add_u32 s88, s88, 1
    s_cmp_lt_u32 s88, 65536
    s_cbranch_scc1 L_g1_4
L_ok_5:
    v_add_f32 v32, v32, v40
    v_add_f32 v33, v33, v41
    v_add_f32 v34, v34, v42
    v_add_f32 v35, v35, v43
    v_add_f32 v36, v36, v44
    v_add_f32 v37, v37, v45
    v_add_f32 v38, v38, v46
    v_add_f32 v39, v39, v47
    v_add_f32 v32, v32, v36
    v_add_f32 v33, v33, v37
    v_add_f32 v34, v34, v38
    v_add_f32 v35, v35, v39
    v_add_f32 v32, v32, v34
    v_add_f32 v33, v33, v35
    v_mov_b32 v5, v32
    v_mov_b32_e64 v6, v33
    s_add_u32 s78, s65, 2
    s_and_b32 s78, s78, 15
    s_lshl_b32 s78, s78, 17
    s_lshl_b32 s79, s62, 11
    s_add_u32 m0, s79, 73728
    s_add_u32 s79, s78, 15360
    buffer_load_dwordx4 v26, s[36:39], s78 offen lds
    buffer_load_dwordx4 v26, s[36:39], s79 offen offset:1024 lds
    v_permlane32_swap_b32 v32, v5
    v_permlane32_swap_b32 v33, v6
    v_add_f32 v32, v32, v5
    v_add_f32 v33, v33, v6
    v_mul_f32 v32, 0x3a800000, v32
    v_mul_f32 v33, 0x3a800000, v33
    v_fma_f32 v7, -v32, v32, v33
    v_max_f32_e64 v7, 0, v7
    v_cvt_pk_bf16_f32 v5, v32, v32
    v_and_b32_e64 v5, s90, v5
    v_cvt_pk_bf16_f32 v7, v7, v7
    v_and_b32_e64 v7, s90, v7
    v_add_f32 v7, 0x3727c5ac, v7
    v_cvt_pk_bf16_f32 v7, v7, v7
    v_and_b32 v7, s90, v7
    v_sqrt_f32_e64 v7, v7
    s_nop 0
    v_cvt_pk_bf16_f32 v7, v7, v7
    v_and_b32 v7, s90, v7
    v_rcp_f32 v9, v7
    v_xor_b32 v5, 0x80000000, v5
    v_cvt_pk_bf16_f32 v8, v5, v5
    ds_write_b64 v65, v[8:9] offset:49152
    s_mov_b32 s88, 0
    s_waitcnt vmcnt(8)
    s_branch L_g1first_6
L_g1_7:
    s_mul_i32 s80, s61, 28800
    s_add_u32 s80, s80, s81
    buffer_load_dwordx4 v[48:51], v75, s[40:43], s80 offen offset:1024 sc1
    s_add_u32 s80, s80, 1843200
    buffer_load_dwordx4 v[52:55], v75, s[40:43], s80 offen offset:1024 sc1
    s_add_u32 s80, s80, 1843200
    buffer_load_dwordx4 v[56:59], v75, s[40:43], s80 offen offset:1024 sc1
    s_add_u32 s80, s80, 1843200
    buffer_load_dwordx4 v[60:63], v75, s[40:43], s80 offen offset:1024 sc1
    s_waitcnt vmcnt(0)
L_g1first_6:
    v_max3_u32 v4, v48, v50, v52
    v_max3_u32 v4, v4, v54, v56
    v_max3_u32 v4, v4, v58, v60
    v_max_u32 v4, v4, v62
    v_cmp_eq_u32 vcc, -1, v4
    s_nop 0
    s_cbranch_vccz L_ok_8
    s_add_u32 s88, s88, 1
    s_cmp_lt_u32 s88, 65536
    s_cbranch_scc1 L_g1_7
L_ok_8:
    v_add_f32 v48, v48, v56
    v_add_f32 v49, v49, v57
    v_add_f32 v50, v50, v58
    v_add_f32 v51, v51, v59
    v_add_f32 v52, v52, v60
    v_add_f32 v53, v53, v61
    v_add_f32 v54, v54, v62
    v_add_f32 v55, v55, v63
    v_add_f32 v48, v48, v52
    v_add_f32 v49, v49, v53
    v_add_f32 v50, v50, v54
    v_add_f32 v51, v51, v55
    v_add_f32 v49, v49, v51
    v_mov_b32 v51, v49
    v_permlane32_swap_b32 v48, v50
    s_nop 0
    v_permlane32_swap_b32 v49, v51
    v_add_f32 v48, v48, v50
    v_add_f32 v49, v49, v51
    s_nop 1
    v_permlane16_swap_b32 v48, v49
    v_add_f32_e64 v48, v48, v49
    v_cvt_pk_bf16_f32 v49, v48, v48
    v_and_b32 v49, s90, v49
    v_sub_f32 v49, v48, v49
    v_cvt_pk_bf16_f32 v50, v48, v49
    v_and_b32 v51, s90, v50
    v_sub_f32 v49, v49, v51
    v_cvt_pk_bf16_f32 v51, v49, 0
    ds_write_b64 v64, v[50:51] offset:50176
    s_setprio 0
    s_waitcnt lgkmcnt(0)
    s_barrier
    s_add_u32 s78, s65, 3
    s_and_b32 s78, s78, 15
    s_lshl_b32 s78, s78, 17
    s_lshl_b32 s79, s62, 11
    s_add_u32 m0, s79, 81920
    s_add_u32 s79, s78, 15360
    buffer_load_dwordx4 v26, s[36:39], s78 offen lds
    buffer_load_dwordx4 v26, s[36:39], s79 offen offset:1024 lds
    s_add_u32 s78, s65, 4
    s_and_b32 s78, s78, 15
    s_lshl_b32 s78, s78, 17
    s_lshl_b32 s79, s62, 11
    s_add_u32 m0, s79, 90112
    s_add_u32 s79, s78, 15360
    buffer_load_dwordx4 v26, s[36:39], s78 offen lds
    buffer_load_dwordx4 v26, s[36:39], s79 offen offset:1024 lds
    s_lshl_b32 s78, s62, 11
    s_add_u32 s79, s78, s99
    s_bitcmp1_b32 s100, 0
    s_cbranch_scc1 L_loc_9
    buffer_store_dwordx4 v[28:31], v12, s[40:43], s79 offen offset:1024 sc1
    buffer_store_dwordx4 v[28:31], v12, s[40:43], s79 offen offset:2048 sc1
    s_branch L_pubd_10
L_loc_9:
    buffer_store_dwordx4 v[28:31], v12, s[40:43], s79 offen offset:1024
    buffer_store_dwordx4 v[28:31], v12, s[40:43], s79 offen offset:2048
L_pubd_10:
    s_lshl_b32 s79, s62, 8
    s_add_u32 s79, s79, s99
    s_mov_b64 exec, 0xffff
    buffer_store_dwordx4 v[28:31], v12, s[40:43], s79 offen sc1
    s_mov_b64 exec, -1
    s_add_u32 s78, s65, 5
    s_and_b32 s78, s78, 15
    s_lshl_b32 s78, s78, 17
    s_lshl_b32 s79, s62, 11
    s_add_u32 m0, s79, 98304
    s_add_u32 s79, s78, 15360
    buffer_load_dwordx4 v26, s[36:39], s78 offen lds
    buffer_load_dwordx4 v26, s[36:39], s79 offen offset:1024 lds
    s_add_u32 s78, s65, 6
    s_and_b32 s78, s78, 15
    s_lshl_b32 s78, s78, 17
    s_lshl_b32 s79, s62, 11
    s_add_u32 m0, s79, 106496
    s_add_u32 s79, s78, 15360
    buffer_load_dwordx4 v26, s[36:39], s78 offen lds
    buffer_load_dwordx4 v26, s[36:39], s79 offen offset:1024 lds
    s_add_u32 s78, s65, 7
    s_and_b32 s78, s78, 15
    s_lshl_b32 s78, s78, 17
    s_lshl_b32 s79, s62, 11
    s_add_u32 m0, s79, 114688
    s_add_u32 s79, s78, 15360
    buffer_load_dwordx4 v26, s[36:39], s78 offen lds
    buffer_load_dwordx4 v26, s[36:39], s79 offen offset:1024 lds
    s_mul_i32 s78, s62, 384
    s_add_u32 s78, s78, s73
    s_add_u32 s78, s78, 2048
    v_lshlrev_b32 v11, 7, v1
    s_mov_b64 exec, 7
    buffer_load_dword v27, v11, s[40:43], s78 offen sc1
    s_mov_b64 exec, -1
    s_waitcnt vmcnt(7)
    s_lshl_b32 s76, s62, 2
    s_add_u32 s76, s76, s73
    v_mov_b32 v4, 0
    s_mov_b64 exec, 1
    s_bitcmp1_b32 s100, 0
    s_cbranch_scc1 L_loc_11
    buffer_store_dword v4, v4, s[40:43], s76 offen offset:2560 sc1
    s_branch L_pubd_12
L_loc_11:
    buffer_store_dword v4, v4, s[40:43], s76 offen offset:2560
L_pubd_12:
    s_mov_b64 exec, -1
    s_add_u32 s78, s65, 8
    s_and_b32 s78, s78, 15
    s_lshl_b32 s78, s78, 17
    s_lshl_b32 s79, s62, 11
    s_add_u32 m0, s79, 122880
    s_add_u32 s79, s78, 15360
    buffer_load_dwordx4 v26, s[36:39], s78 offen lds
    buffer_load_dwordx4 v26, s[36:39], s79 offen offset:1024 lds
    s_add_u32 s78, s65, 9
    s_and_b32 s78, s78, 15
    s_lshl_b32 s78, s78, 17
    s_lshl_b32 s79, s62, 11
    s_add_u32 m0, s79, 131072
    s_add_u32 s79, s78, 15360
    buffer_load_dwordx4 v26, s[36:39], s78 offen lds
    buffer_load_dwordx4 v26, s[36:39], s79 offen offset:1024 lds
    s_add_u32 s78, s65, 10
    s_and_b32 s78, s78, 15
    s_lshl_b32 s78, s78, 17
    s_lshl_b32 s79, s62, 11
    s_add_u32 m0, s79, 139264
    s_add_u32 s79, s78, 15360
    buffer_load_dwordx4 v26, s[36:39], s78 offen lds
    buffer_load_dwordx4 v26, s[36:39], s79 offen offset:1024 lds
    v_and_b32_e64 v65, 15, v1
    v_mul_u32_u24 v65, 460800, v65
    s_mul_i32 s80, s61, 28800
    s_lshl_b32 s82, s62, 2
    s_add_u32 s82, s82, s80
    v_bfe_u32 v4, v1, 4, 1
    v_lshl_add_u32 v4, v4, 1, v3
    s_lshl_b32 s77, s62, 6
    v_lshl_add_u32 v66, v4, 1, s77
    v_bfe_u32 v4, v1, 2, 1
    v_lshl_add_u32 v66, v4, 5, v66
    v_bfe_u32 v4, v1, 0, 1
    v_lshl_add_u32 v66, v4, 4, v66
    v_bfe_u32 v4, v1, 1, 1
    v_lshl_add_u32 v66, v4, 3, v66
    s_lshl_b32 s83, s62, 7
    s_add_u32 s81, s83, s80
    s_add_u32 s68, s81, 3686400
    s_add_u32 s83, s83, s73
    v_and_b32 v4, 7, v1
    v_lshrrev_b32 v5, 4, v1
    v_lshlrev_b32_e64 v5, 2, v5
    v_lshl_add_u32 v67, v4, 4, v5
    v_bfe_u32 v5, v1, 3, 1
    v_lshrrev_b32_e64 v6, 4, v1
    v_lshl_add_u32 v5, v5, 4, v6
    v_mul_u32_u24 v5, 9344, v5
    v_lshl_add_u32 v61, v4, 4, v5
    s_lshr_b32 s69, s97, 1
    s_lshr_b32 s76, s2, 7
    s_lshl2_add_u32 s69, s69, s76
    s_mul_i32 s69, s69, 74752
    s_add_u32 s69, s69, 8389632
    s_barrier
    s_add_u32 s78, s65, 11
    s_and_b32 s78, s78, 15
    s_lshl_b32 s78, s78, 17
    s_lshl_b32 s79, s62, 11
    s_add_u32 m0, s79, 147456
    s_add_u32 s79, s78, 15360
    buffer_load_dwordx4 v26, s[36:39], s78 offen lds
    buffer_load_dwordx4 v26, s[36:39], s79 offen offset:1024 lds
    s_add_u32 s78, s65, 12
    s_and_b32 s78, s78, 15
    s_lshl_b32 s78, s78, 17
    s_lshl_b32 s79, s62, 11
    s_add_u32 m0, s79, 155648
    s_add_u32 s79, s78, 15360
    buffer_load_dwordx4 v26, s[36:39], s78 offen lds
    buffer_load_dwordx4 v26, s[36:39], s79 offen offset:1024 lds
    buffer_load_dword v64, v65, s[40:43], s82 offen offset:2560 sc1
    s_barrier
    s_setprio 3
    v_mov_b32 v4, s89
    v_lshlrev_b32 v5, 2, v1
    ds_write_b32 v5, v4 offset:24832
    v_mov_b32 v70, 0
    v_mov_b32 v71, 0
    ds_write_b64 v70, v[70:71] offset:25984
    s_mov_b32 s88, 0
    s_branch L_p2first_13
L_p2_14:
    buffer_load_dword v64, v65, s[40:43], s82 offen offset:2560 sc1
L_p2first_13:
    s_waitcnt vmcnt(0)
    v_cmp_eq_u32_e64 vcc, -1, v64
    s_nop 0
    s_cbranch_vccz L_ok_15
    s_add_u32 s88, s88, 1
    s_cmp_lt_u32 s88, 65536
    s_cbranch_scc1 L_p2_14
L_ok_15:
    s_add_u32 s78, s65, 13
    s_and_b32 s78, s78, 15
    s_lshl_b32 s78, s78, 17
    s_lshl_b32 s79, s62, 11
    s_add_u32 m0, s79, 32768
    s_add_u32 s79, s78, 15360
    buffer_load_dwordx4 v26, s[36:39], s78 offen lds
    buffer_load_dwordx4 v26, s[36:39], s79 offen offset:1024 lds
    s_add_u32 s78, s65, 14
    s_and_b32 s78, s78, 15
    s_lshl_b32 s78, s78, 17
    s_lshl_b32 s79, s62, 11
    s_add_u32 m0, s79, 40960
    s_add_u32 s79, s78, 15360
    buffer_load_dwordx4 v26, s[36:39], s78 offen lds
    buffer_load_dwordx4 v26, s[36:39], s79 offen offset:1024 lds
    s_add_u32 s78, s65, 15
    s_and_b32 s78, s78, 15
    s_lshl_b32 s78, s78, 17
    s_lshl_b32 s79, s62, 11
    s_add_u32 m0, s79, 49152
    s_add_u32 s79, s78, 15360
    buffer_load_dwordx4 v26, s[36:39], s78 offen lds
    buffer_load_dwordx4 v26, s[36:39], s79 offen offset:1024 lds
    s_lshl_b32 s76, s62, 11
    s_lshl_b32 s77, s60, 7
    s_add_u32 s76, s76, s77
    s_add_u32 s76, s76, s69
    s_add_u32 s77, s76, 37376
    s_mov_b32 s78, 0x00003f80
    s_mov_b32 s79, 0x3f800000
    s_mov_b32 s88, 0
L_poll_16:
    buffer_load_dwordx4 v[32:35], v61, s[40:43], s76 offen sc1
    buffer_load_dwordx4 v[36:39], v61, s[40:43], s77 offen sc1
    s_waitcnt vmcnt(0)
    v_max_u32 v4, v32, v36
    v_cmp_eq_u32_e64 vcc, -1, v4
    s_nop 0
    s_cbranch_vccz L_ok_17
    s_add_u32 s88, s88, 1
    s_cmp_lt_u32 s88, 65536
    s_cbranch_scc1 L_poll_16
L_ok_17:
    v_dot2_f32_bf16 v48, v32, s78, 0
    v_dot2_f32_bf16 v49, v32, s79, 0
    v_dot2_f32_bf16 v50, v33, s78, 0
    v_dot2_f32_bf16 v51, v33, s79, 0
    v_dot2_f32_bf16 v52, v34, s78, 0
    v_dot2_f32_bf16 v53, v34, s79, 0
    v_dot2_f32_bf16 v54, v35, s78, 0
    v_dot2_f32_bf16 v55, v35, s79, 0
    v_dot2_f32_bf16 v48, v36, s78, v48
    v_dot2_f32_bf16 v49, v36, s79, v49
    v_dot2_f32_bf16 v50, v37, s78, v50
    v_dot2_f32_bf16 v51, v37, s79, v51
    v_dot2_f32_bf16 v52, v38, s78, v52
    v_dot2_f32_bf16 v53, v38, s79, v53
    v_dot2_f32_bf16 v54, v39, s78, v54
    v_dot2_f32_bf16 v55, v39, s79, v55
    buffer_load_dwordx4 v[40:43], v13, s[40:43], s81 offen offset:2048 sc1
    buffer_load_dwordx4 v[44:47], v13, s[40:43], s68 offen offset:2048 sc1
    v_permlane32_swap_b32 v48, v52
    v_permlane32_swap_b32 v49, v53
    v_permlane32_swap_b32 v50, v54
    v_permlane32_swap_b32 v51, v55
    v_add_f32 v48, v48, v52
    v_add_f32 v49, v49, v53
    v_add_f32 v50, v50, v54
    v_add_f32 v51, v51, v55
    s_nop 0
    v_permlane16_swap_b32 v48, v50
    v_permlane16_swap_b32 v49, v51
    v_add_f32 v48, v48, v50
    v_add_f32_e64 v49, v49, v51
    s_nop 0
    v_add_f32_dpp v48, v48, v48 row_ror:8 row_mask:0xf bank_mask:0xf
    v_add_f32_dpp v49, v49, v49 row_ror:8 row_mask:0xf bank_mask:0xf
    v_cvt_pk_bf16_f32 v48, v48, v49
    s_bitcmp1_b32 s100, 0
    s_cbranch_scc1 L_loc_18
    buffer_store_dword v48, v67, s[40:43], s83 offen offset:3072 sc1
    s_branch L_pubd_19
L_loc_18:
    buffer_store_dword v48, v67, s[40:43], s83 offen offset:3072
L_pubd_19:
    s_mov_b32 s88, 0
    s_waitcnt vmcnt(1)
    s_branch L_zfirst_20
L_z_21:
    buffer_load_dwordx4 v[40:43], v13, s[40:43], s81 offen offset:2048 sc1
    buffer_load_dwordx4 v[44:47], v13, s[40:43], s68 offen offset:2048 sc1
    s_waitcnt vmcnt(0)
L_zfirst_20:
    v_max3_u32 v4, v40, v41, v42
    v_max3_u32 v4, v4, v43, v44
    v_max3_u32 v4, v4, v45, v46
    v_max_u32 v4, v4, v47
    v_cmp_eq_u32 vcc, -1, v4
    s_nop 0
    s_cbranch_vccz L_ok_22
    s_add_u32 s88, s88, 1
    s_cmp_lt_u32 s88, 65536
    s_cbranch_scc1 L_z_21
L_ok_22:
    v_add_f32 v40, v40, v44
    v_add_f32 v41, v41, v45
    v_add_f32 v42, v42, v46
    v_add_f32 v43, v43, v47
    v_permlane32_swap_b32 v40, v41
    s_nop 0
    v_permlane32_swap_b32 v42, v43
    v_add_f32 v40, v40, v41
    v_add_f32 v42, v42, v43
    s_nop 1
    v_permlane16_swap_b32 v40, v42
    v_add_f32 v40, v40, v42
    s_nop 1
    v_add_f32_dpp v40, v40, v40 row_ror:8 row_mask:0xf bank_mask:0xf
    v_cvt_pk_bf16_f32 v40, v40, v40
    ds_write_b16 v66, v40 offset:24576
    s_waitcnt lgkmcnt(0)
    s_barrier
    s_setprio 0
    s_mov_b64 exec, 3
    global_load_dword v27, v91, s[66:67]
    s_mov_b64 exec, -1
    s_lshl_b32 s78, s97, 18
    s_lshl_b32 s79, s62, 16
    s_add_u32 s78, s78, s79
    s_lshl_b32 s79, s98, 7
    s_add_u32 s78, s78, s79
    s_lshl_b32 s79, s62, 12
    s_add_u32 m0, s79, 0
    s_nop 0
    buffer_load_dwordx4 v78, s[28:31], s78 offen offset:0 lds
    s_add_u32 s78, s78, 15360
    buffer_load_dwordx4 v79, s[28:31], s78 offen offset:1024 lds
    s_add_u32 s78, s78, 15360
    buffer_load_dwordx4 v78, s[28:31], s78 offen offset:2048 lds
    s_add_u32 s78, s78, 15360
    buffer_load_dwordx4 v79, s[28:31], s78 offen offset:3072 lds
    s_barrier
    s_lshl4_add_u32 s76, s97, s98
    s_mul_i32 s76, s76, 28800
    s_add_u32 s20, s26, s76
    s_addc_u32 s21, s27, 0
    s_cmp_eq_u32 s62, 0
    s_cbranch_scc0 L_now0_25
    s_sleep 4
    s_load_dwordx16 s[4:19], s[20:21], 3584 glc
    s_waitcnt lgkmcnt(0)
    s_and_b64 s[4:5], s[4:5], s[6:7]
    s_and_b64 s[4:5], s[4:5], s[8:9]
    s_and_b64 s[4:5], s[4:5], s[10:11]
    s_and_b64 s[4:5], s[4:5], s[12:13]
    s_and_b64 s[4:5], s[4:5], s[14:15]
    s_and_b64 s[4:5], s[4:5], s[16:17]
    s_and_b64 s[4:5], s[4:5], s[18:19]
    s_nand_b32 s4, s4, s5
    s_and_b32 s4, s4, 0xffff
    s_mul_i32 s4, s4, 0x10001
    s_lshr_b32 s4, s4, s65
    s_and_b32 s77, s4, 0xffff
    v_mov_b32_e64 v69, s77
    ds_write_b32 v70, v69 offset:25984
L_now0_25:
    s_waitcnt vmcnt(0) lgkmcnt(0)
    s_barrier
    s_cmp_eq_u32 s62, 0
    s_cbranch_scc0 L_now1_23
    s_mov_b32 s88, 0
L_spin_26:
    s_load_dwordx16 s[4:19], s[20:21], 3584 glc
    s_waitcnt lgkmcnt(0)
    s_and_b64 s[4:5], s[4:5], s[6:7]
    s_and_b64 s[4:5], s[4:5], s[8:9]
    s_and_b64 s[4:5], s[4:5], s[10:11]
    s_and_b64 s[4:5], s[4:5], s[12:13]
    s_and_b64 s[4:5], s[4:5], s[14:15]
    s_and_b64 s[4:5], s[4:5], s[16:17]
    s_and_b64 s[4:5], s[4:5], s[18:19]
    s_nand_b32 s4, s4, s5
    s_and_b32 s4, s4, 0xffff
    s_mul_i32 s4, s4, 0x10001
    s_lshr_b32 s4, s4, s65
    s_and_b32 s77, s4, 0xffff
    v_mov_b32 v69, s77
    ds_write_b32 v70, v69 offset:25984
    s_cmp_eq_u32 s77, 0xffff
    s_cbranch_scc1 L_s2done_24
    s_add_u32 s88, s88, 1
    s_cmp_lt_u32 s88, 65536
    s_cbranch_scc1 L_spin_26
    s_branch L_s2done_24
L_now1_23:
    s_cmp_eq_u32 s62, 1
    s_cbranch_scc0 L_s2done_24
    s_lshl_b32 s77, 1, s61
    s_not_b32 s77, s77
    v_mov_b32_e64 v4, s77
    v_mul_u32_u24 v5, 28800, v1
    s_mul_i32 s76, s60, 460800
    s_lshl2_add_u32 s76, s61, s76
    s_mov_b32 s88, 0
L_spin_27:
    ds_read_b32 v69, v70 offset:25988
    s_waitcnt lgkmcnt(0)
    v_cmp_eq_u32_e64 vcc, 4, v69
    s_nop 0
    s_cbranch_vccnz L_drained_28
    s_add_u32 s88, s88, 1
    s_cmp_lt_u32 s88, 1048576
    s_cbranch_scc1 L_spin_27
L_drained_28:
    s_mov_b64 exec, 0xffff
    buffer_store_dword v4, v5, s[40:43], s76 offen offset:3584 sc1
    s_mov_b64 exec, -1
L_s2done_24:
    s_waitcnt vmcnt(0)
    v_lshlrev_b32 v17, 5, v2
    v_lshl_add_u32 v17, v3, 4, v17
    v_and_b32 v4, 15, v1
    v_lshrrev_b32 v5, 1, v4
    v_and_b32 v4, 1, v4
    v_lshlrev_b32 v4, 5, v4
    v_lshl_add_u32 v16, v5, 7, v4
    v_lshrrev_b32 v4, 3, v1
    v_and_b32 v5, 7, v1
    v_lshlrev_b32_e64 v5, 4, v5
    v_mul_u32_u24 v18, 9344, v4
    v_add_u32_e64 v18, v18, v5
    v_bfe_u32 v6, v1, 4, 1
    v_lshl_add_u32 v6, v6, 1, v3
    v_lshl_add_u32 v19, v6, 2, v5
    s_mul_i32 s84, s97, 149504
    s_lshl_b32 s77, s98, 7
    s_add_u32 s84, s84, s77
    s_add_u32 s84, s84, 8388608
    s_lshl_b32 s85, s62, 10
    s_add_u32 s85, s85, s99
    s_add_u32 s85, s85, 5120
    s_and_b32 s87, s97, 1
    s_lshl_b32 s87, s87, 4
    s_add_u32 s87, s87, s98
    s_lshr_b32 s86, s97, 1
    s_mul_i32 s86, s86, 299008
    s_lshl_b32 s77, s87, 7
    s_add_u32 s86, s86, s77
    s_add_u32 s86, s86, 8393728
    s_lshl_b32 s78, s62, 11
    s_add_u32 s79, s78, s99
    s_bitcmp1_b32 s100, 1
    s_cbranch_scc1 L_loc_29
    buffer_store_dwordx4 v[28:31], v12, s[40:43], s79 offen offset:1024 sc1
    buffer_store_dwordx4 v[28:31], v12, s[40:43], s79 offen offset:2048 sc1
    s_branch L_pubd_30
L_loc_29:
    buffer_store_dwordx4 v[28:31], v12, s[40:43], s79 offen offset:1024
    buffer_store_dwordx4 v[28:31], v12, s[40:43], s79 offen offset:2048
L_pubd_30:
    s_lshl4_add_u32 s78, s97, s98
    s_lshl4_add_u32 s78, s78, s62
    s_add_u32 s78, s78, 12591116
    s_waitcnt vmcnt(0)
    s_mov_b64 exec, 1
    s_bitcmp1_b32 s100, 1
    s_cbranch_scc1 L_loc_31
    buffer_store_byte v28, v70, s[40:43], s78 offen sc1
    s_branch L_pubd_32
L_loc_31:
    buffer_store_byte v28, v70, s[40:43], s78 offen
L_pubd_32:
    s_mov_b64 exec, -1
    s_cmp_eq_u32 s62, 0
    s_cbranch_scc0 L_nop3c_33
    s_mov_b32 exec_lo, 0
    s_mov_b32 s88, 0
L_spin_34:
    buffer_load_dword v4, v90, s[40:43], 0 offen offset:12 sc1
    s_waitcnt vmcnt(0)
    v_cmp_ne_u32 vcc, -1, v4
    s_nop 0
    s_cbranch_vccz L_p3ok_35
    s_add_u32 s88, s88, 1
    s_cmp_lt_u32 s88, 65536
    s_cbranch_scc1 L_spin_34
L_p3ok_35:
    s_mov_b64 exec, -1
L_nop3c_33:
    s_barrier
    buffer_load_dwordx4 v[156:159], v76, s[48:51], s75 offen nt
    s_add_u32 s75, s75, 7168
    buffer_load_dwordx4 v[32:35], v77, s[52:55], s96 offen nt
    s_add_u32 s96, s96, 4096
    buffer_load_dwordx4 v[36:39], v77, s[52:55], s96 offen nt
    s_add_u32 s96, s96, 4096
    buffer_load_dwordx4 v[40:43], v77, s[52:55], s96 offen nt
    s_add_u32 s96, s96, 4096
    buffer_load_dwordx4 v[44:47], v77, s[52:55], s96 offen nt
    s_add_u32 s96, s96, 4096
    s_barrier
    buffer_load_dwordx4 v[48:51], v77, s[52:55], s96 offen nt
    s_add_u32 s96, s96, 4096
    buffer_load_dwordx4 v[52:55], v77, s[52:55], s96 offen nt
    s_add_u32 s96, s96, 4096
    buffer_load_dwordx4 v[56:59], v77, s[52:55], s96 offen nt
    s_add_u32 s96, s96, 4096
    buffer_load_dwordx4 v[60:63], v77, s[52:55], s96 offen nt
    s_add_u32 s96, s96, 4096
    s_barrier
    s_waitcnt vmcnt(8)
    s_mov_b32 s78, 0x05040100
    s_mov_b32 s79, 0x07060302
    v_perm_b32 v160, v100, v96, s78
    v_perm_b32 v164, v100, v96, s79
    v_perm_b32 v168, v101, v97, s78
    v_perm_b32 v172, v101, v97, s79
    v_perm_b32 v176, v102, v98, s78
    v_perm_b32 v180, v102, v98, s79
    v_perm_b32 v184, v103, v99, s78
    v_perm_b32 v188, v103, v99, s79
    v_perm_b32 v161, v108, v104, s78
    v_perm_b32 v165, v108, v104, s79
    v_perm_b32 v169, v109, v105, s78
    v_perm_b32 v173, v109, v105, s79
    v_perm_b32 v177, v110, v106, s78
    v_perm_b32 v181, v110, v106, s79
    v_perm_b32 v185, v111, v107, s78
    v_perm_b32 v189, v111, v107, s79
    v_perm_b32 v162, v116, v112, s78
    v_perm_b32 v166, v116, v112, s79
    v_perm_b32 v170, v117, v113, s78
    v_perm_b32 v174, v117, v113, s79
    v_perm_b32 v178, v118, v114, s78
    v_perm_b32 v182, v118, v114, s79
    v_perm_b32 v186, v119, v115, s78
    v_perm_b32 v190, v119, v115, s79
    v_perm_b32 v163, v124, v120, s78
    v_perm_b32 v167, v124, v120, s79
    v_perm_b32 v171, v125, v121, s78
    v_perm_b32 v175, v125, v121, s79
    v_perm_b32 v179, v126, v122, s78
    v_perm_b32 v183, v126, v122, s79
    v_perm_b32 v187, v127, v123, s78
    v_perm_b32 v191, v127, v123, s79
    v_perm_b32 v192, v132, v128, s78
    v_perm_b32 v196, v132, v128, s79
    v_perm_b32 v200, v133, v129, s78
    v_perm_b32 v204, v133, v129, s79
    v_perm_b32 v208, v134, v130, s78
    v_perm_b32 v212, v134, v130, s79
    v_perm_b32 v216, v135, v131, s78
    v_perm_b32 v220, v135, v131, s79
    v_perm_b32 v193, v140, v136, s78
    v_perm_b32 v197, v140, v136, s79
    v_perm_b32 v201, v141, v137, s78
    v_perm_b32 v205, v141, v137, s79
    v_perm_b32 v209, v142, v138, s78
    v_perm_b32 v213, v142, v138, s79
    v_perm_b32 v217, v143, v139, s78
    v_perm_b32 v221, v143, v139, s79
    v_perm_b32 v194, v148, v144, s78
    v_perm_b32 v198, v148, v144, s79
    v_perm_b32 v202, v149, v145, s78
    v_perm_b32 v206, v149, v145, s79
    v_perm_b32 v210, v150, v146, s78
    v_perm_b32 v214, v150, v146, s79
    v_perm_b32 v218, v151, v147, s78
    v_perm_b32 v222, v151, v147, s79
    v_perm_b32 v195, v156, v152, s78
    v_perm_b32 v199, v156, v152, s79
    v_perm_b32 v203, v157, v153, s78
    v_perm_b32 v207, v157, v153, s79
    v_perm_b32 v211, v158, v154, s78
    v_perm_b32 v215, v158, v154, s79
    v_perm_b32 v219, v159, v155, s78
    v_perm_b32 v223, v159, v155, s79
    s_waitcnt vmcnt(0)
    s_mov_b32 s78, 0x05040100
    s_mov_b32 s79, 0x07060302
    v_permlane32_swap_b32 v32, v34
    v_permlane32_swap_b32 v33, v35
    v_permlane32_swap_b32 v36, v38
    v_permlane32_swap_b32 v37, v39
    v_permlane32_swap_b32 v40, v42
    v_permlane32_swap_b32 v41, v43
    v_permlane32_swap_b32 v44, v46
    v_permlane32_swap_b32 v45, v47
    v_permlane32_swap_b32 v48, v50
    v_permlane32_swap_b32 v49, v51
    v_permlane32_swap_b32 v52, v54
    v_permlane32_swap_b32 v53, v55
    v_permlane32_swap_b32 v56, v58
    v_permlane32_swap_b32 v57, v59
    v_permlane32_swap_b32 v60, v62
    v_permlane32_swap_b32_e64 v61, v63
    v_perm_b32 v224, v34, v32, s78
    v_perm_b32 v225, v34, v32, s79
    v_perm_b32 v226, v35, v33, s78
    v_perm_b32 v227, v35, v33, s79
    v_perm_b32 v228, v38, v36, s78
    v_perm_b32 v229, v38, v36, s79
    v_perm_b32 v230, v39, v37, s78
    v_perm_b32 v231, v39, v37, s79
    v_perm_b32 v232, v42, v40, s78
    v_perm_b32 v233, v42, v40, s79
    v_perm_b32 v234, v43, v41, s78
    v_perm_b32 v235, v43, v41, s79
    v_perm_b32 v236, v46, v44, s78
    v_perm_b32 v237, v46, v44, s79
    v_perm_b32 v238, v47, v45, s78
    v_perm_b32 v239, v47, v45, s79
    v_perm_b32 v240, v50, v48, s78
    v_perm_b32 v241, v50, v48, s79
    v_perm_b32 v242, v51, v49, s78
    v_perm_b32 v243, v51, v49, s79
    v_perm_b32 v244, v54, v52, s78
    v_perm_b32 v245, v54, v52, s79
    v_perm_b32 v246, v55, v53, s78
    v_perm_b32 v247, v55, v53, s79
    v_perm_b32 v248, v58, v56, s78
    v_perm_b32 v249, v58, v56, s79
    v_perm_b32 v250, v59, v57, s78
    v_perm_b32 v251, v59, v57, s79
    v_perm_b32 v252, v62, v60, s78
    v_perm_b32 v253, v62, v60, s79
    v_perm_b32 v254, v63, v61, s78
    v_perm_b32 v255, v63, v61, s79
    v_and_b32 v5, 15, v1
    v_lshlrev_b32 v5, 3, v5
    s_lshl_b32 s76, s63, 10
    s_lshl_b32 s77, s64, 6
    s_add_u32 s76, s76, s77
    s_add_u32 s76, s76, s99
    s_mov_b64 s[80:81], 0xffff
    s_add_u32 s68, s84, 74752
    s_add_u32 s69, s86, 74752
    s_add_u32 s70, s86, 149504
    s_add_u32 s71, s86, 224256
    s_setprio 3
    s_barrier
    ds_read_b128 v[64:67], v12 offset:28672
    ds_read_b128 v[68:71], v12 offset:29696
    ds_read_b64 v[8:9], v5 offset:25728
    s_waitcnt lgkmcnt(2)
    v_mfma_f32_16x16x32_bf16 v[96:99], v[64:67], v[160:163], 0
    v_mfma_f32_16x16x32_bf16 v[100:103], v[64:67], v[164:167], 0
    s_waitcnt lgkmcnt(0)
    v_max_f32_dpp v4, v8, v8 row_ror:8 row_mask:0xf bank_mask:0xf
    v_mfma_f32_16x16x32_bf16 v[104:107], v[64:67], v[168:171], 0
    v_mfma_f32_16x16x32_bf16 v[108:111], v[64:67], v[172:175], 0
    v_max_f32_dpp v4, v4, v4 row_ror:4 row_mask:0xf bank_mask:0xf
    v_mfma_f32_16x16x32_bf16 v[112:115], v[64:67], v[176:179], 0
    v_mfma_f32_16x16x32_bf16 v[116:119], v[64:67], v[180:183], 0
    v_max_f32_dpp v4, v4, v4 row_ror:2 row_mask:0xf bank_mask:0xf
    v_mfma_f32_16x16x32_bf16 v[120:123], v[64:67], v[184:187], 0
    v_mfma_f32_16x16x32_bf16 v[124:127], v[64:67], v[188:191], 0
    v_max_f32_dpp v4, v4, v4 row_ror:1 row_mask:0xf bank_mask:0xf
    v_mfma_f32_16x16x32_bf16 v[96:99], v[68:71], v[192:195], v[96:99]
    v_cmp_eq_f32_e64 vcc, v4, v8
    v_mfma_f32_16x16x32_bf16 v[100:103], v[68:71], v[196:199], v[100:103]
    s_ff1_i32_b32 s92, vcc_lo
    s_and_b32 s92, s92, 15
    v_mfma_f32_16x16x32_bf16 v[104:107], v[68:71], v[200:203], v[104:107]
    s_lshr_b32 s78, s92, 2
    s_lshl_b32 s78, s78, 4
    v_mfma_f32_16x16x32_bf16 v[108:111], v[68:71], v[204:207], v[108:111]
    s_and_b32 s77, s92, 3
    v_mfma_f32_16x16x32_bf16 v[112:115], v[68:71], v[208:211], v[112:115]
    v_readlane_b32 s91, v9, s92
    v_readlane_b32 s93, v8, s92
    v_mfma_f32_16x16x32_bf16 v[116:119], v[68:71], v[212:215], v[116:119]
    v_mfma_f32_16x16x32_bf16 v[120:123], v[68:71], v[216:219], v[120:123]
    v_mfma_f32_16x16x32_bf16 v[124:127], v[68:71], v[220:223], v[124:127]
    s_cmp_ge_u32 s97, 14
    s_cbranch_scc1 L_final
    s_cmp_eq_u32 s77, 0
    s_cbranch_scc0 L_sel_37
    v_mov_b32 v64, v96
    v_mov_b32 v65, v100
    v_mov_b32 v66, v104
    v_mov_b32 v67, v108
    v_mov_b32 v68, v112
    v_mov_b32 v69, v116
    v_mov_b32 v70, v120
    v_mov_b32 v71, v124
    s_branch L_seldone_36
L_sel_37:
    s_cmp_eq_u32 s77, 1
    s_cbranch_scc0 L_sel_38
    v_mov_b32 v64, v97
    v_mov_b32 v65, v101
    v_mov_b32 v66, v105
    v_mov_b32 v67, v109
    v_mov_b32 v68, v113
    v_mov_b32 v69, v117
    v_mov_b32 v70, v121
    v_mov_b32 v71, v125
    s_branch L_seldone_36
L_sel_38:
    s_cmp_eq_u32 s77, 2
    s_cbranch_scc0 L_sel_39
    v_mov_b32 v64, v98
    v_mov_b32 v65, v102
    v_mov_b32 v66, v106
    v_mov_b32 v67, v110
    v_mov_b32 v68, v114
    v_mov_b32 v69, v118
    v_mov_b32 v70, v122
    v_mov_b32 v71, v126
    s_branch L_seldone_36
L_sel_39:
    v_mov_b32 v64, v99
    v_mov_b32 v65, v103
    v_mov_b32 v66, v107
    v_mov_b32 v67, v111
    v_mov_b32 v68, v115
    v_mov_b32 v69, v119
    v_mov_b32 v70, v123
    v_mov_b32_e64 v71, v127
L_seldone_36:
    s_lshl_b64 exec, s[80:81], s78
    s_bitcmp1_b32 s100, 1
    s_cbranch_scc1 L_loc_41
    buffer_store_dwordx4 v[64:67], v16, s[40:43], s76 offen offset:3072 sc1
    buffer_store_dwordx4 v[68:71], v16, s[40:43], s76 offen offset:3088 sc1
    s_branch L_pubd_42
L_loc_41:
    buffer_store_dwordx4 v[64:67], v16, s[40:43], s76 offen offset:3072
    buffer_store_dwordx4 v[68:71], v16, s[40:43], s76 offen offset:3088
L_pubd_42:
    s_mov_b64 exec, -1
    s_mov_b32 s88, 0
L_poll_43:
    buffer_load_dwordx4 v[128:131], v18, s[40:43], s84 offen offset:3072 sc1
    buffer_load_dwordx4 v[132:135], v18, s[40:43], s68 offen offset:3072 sc1
    s_waitcnt vmcnt(0)
    v_max_u32 v4, v128, v132
    v_cmp_eq_u32_e64 vcc, -1, v4
    s_nop 0
    s_cbranch_vccz L_ok_44
    s_add_u32 s88, s88, 1
    s_cmp_lt_u32 s88, 65536
    s_cbranch_scc1 L_poll_43
L_ok_44:
    v_pk_add_f32 v[48:49], v[128:129], v[132:133]
    v_pk_add_f32 v[50:51], v[130:131], v[134:135]
    s_nop 0
    v_permlane32_swap_b32 v48, v49
    v_permlane32_swap_b32 v50, v51
    v_add_f32 v48, v48, v49
    v_add_f32 v50, v50, v51
    s_nop 1
    v_permlane16_swap_b32 v48, v50
    v_add_f32 v48, v48, v50
    s_nop 1
    v_add_f32_dpp v48, v48, v48 row_ror:8 row_mask:0xf bank_mask:0xf
    v_cvt_pk_bf16_f32 v48, v48, v48
    v_and_b32_e64 v48, s90, v48
    v_mul_f32 v4, 0xbfb8aa3b, v48
    v_exp_f32_e64 v4, v4
    v_mov_b32_dpp v49, v48 row_ror:12 row_mask:0xf bank_mask:0xf
    v_add_f32 v4, 1.0, v4
    v_rcp_f32 v4, v4
    s_nop 0
    v_mul_f32 v4, v4, v48
    v_cvt_pk_bf16_f32 v4, v4, v4
    v_and_b32 v4, s90, v4
    v_mul_f32 v4, v4, v49
    v_mov_b32 v5, v4
    s_nop 1
    v_permlane32_swap_b32_e64 v4, v5
    v_cvt_pk_bf16_f32 v4, v4, v5
    s_nop 0
    v_readlane_b32 s76, v4, 0
    v_readlane_b32 s77, v4, 16
    v_readlane_b32 s78, v4, 1
    v_readlane_b32 s79, v4, 17
    v_readlane_b32 s80, v4, 2
    v_readlane_b32 s81, v4, 18
    v_readlane_b32 s82, v4, 3
    v_readlane_b32 s83, v4, 19
    v_dot2_f32_bf16 v40, v224, s76, 0
    v_dot2_f32_bf16 v41, v225, s76, 0
    v_dot2_f32_bf16 v42, v226, s76, 0
    v_dot2_f32_bf16 v43, v227, s76, 0
    v_dot2_f32_bf16 v40, v228, s77, v40
    v_dot2_f32_bf16 v41, v229, s77, v41
    v_dot2_f32_bf16 v42, v230, s77, v42
    v_dot2_f32_bf16 v43, v231, s77, v43
    v_dot2_f32_bf16 v40, v232, s78, v40
    v_dot2_f32_bf16 v41, v233, s78, v41
    v_dot2_f32_bf16 v42, v234, s78, v42
    v_dot2_f32_bf16 v43, v235, s78, v43
    v_dot2_f32_bf16 v40, v236, s79, v40
    v_dot2_f32_bf16 v41, v237, s79, v41
    v_dot2_f32_bf16 v42, v238, s79, v42
    v_dot2_f32_bf16 v43, v239, s79, v43
    v_dot2_f32_bf16 v40, v240, s80, v40
    v_dot2_f32_bf16 v41, v241, s80, v41
    v_dot2_f32_bf16 v42, v242, s80, v42
    v_dot2_f32_bf16 v43, v243, s80, v43
    v_dot2_f32_bf16 v40, v244, s81, v40
    v_dot2_f32_bf16 v41, v245, s81, v41
    v_dot2_f32_bf16 v42, v246, s81, v42
    v_dot2_f32_bf16 v43, v247, s81, v43
    v_dot2_f32_bf16 v40, v248, s82, v40
    v_dot2_f32_bf16 v41, v249, s82, v41
    v_dot2_f32_bf16 v42, v250, s82, v42
    v_dot2_f32_bf16 v43, v251, s82, v43
    v_dot2_f32_bf16 v40, v252, s83, v40
    v_dot2_f32_bf16 v41, v253, s83, v41
    v_dot2_f32_bf16 v42, v254, s83, v42
    v_dot2_f32_bf16 v43, v255, s83, v43
    s_bitcmp1_b32 s100, 1
    s_cbranch_scc1 L_loc_45
    s_nop 0
    buffer_store_dwordx4 v[40:43], v17, s[40:43], s85 offen sc1
    s_branch L_pubd_46
L_loc_45:
    s_nop 0
    buffer_store_dwordx4 v[40:43], v17, s[40:43], s85 offen
L_pubd_46:
    s_cmp_eq_u32 s62, 0
    s_cbranch_scc0 L_hby
    s_mov_b32 s88, 0
L_poll_47:
    buffer_load_dwordx4 v[136:139], v18, s[40:43], s86 offen sc1
    buffer_load_dwordx4 v[140:143], v18, s[40:43], s69 offen sc1
    buffer_load_dwordx4 v[144:147], v18, s[40:43], s70 offen sc1
    buffer_load_dwordx4 v[148:151], v18, s[40:43], s71 offen sc1
    s_waitcnt vmcnt(0)
    v_max3_u32 v4, v136, v140, v144
    v_max_u32 v4, v4, v148
    v_cmp_eq_u32_e64 vcc, -1, v4
    s_nop 0
    s_cbranch_vccz L_ok_48
    s_add_u32 s88, s88, 1
    s_cmp_lt_u32 s88, 65536
    s_cbranch_scc1 L_poll_47
L_ok_48:
    v_pk_add_f32 v[48:49], v[136:137], v[144:145]
    v_pk_add_f32 v[50:51], v[138:139], v[146:147]
    v_pk_add_f32 v[52:53], v[140:141], v[148:149]
    v_pk_add_f32 v[54:55], v[142:143], v[150:151]
    v_pk_add_f32 v[48:49], v[48:49], v[52:53]
    v_pk_add_f32 v[50:51], v[50:51], v[54:55]
    s_nop 0
    v_permlane32_swap_b32 v48, v49
    v_permlane32_swap_b32 v50, v51
    v_add_f32 v48, v48, v49
    v_add_f32 v50, v50, v51
    s_nop 1
    v_permlane16_swap_b32 v48, v50
    v_add_f32 v48, v48, v50
    s_nop 1
    v_add_f32_dpp v48, v48, v48 row_ror:8 row_mask:0xf bank_mask:0xf
    buffer_store_dword v48, v19, s[40:43], s99 offen offset:512 sc1
L_hby:
    s_barrier
    s_branch L_hfin
L_final:
    s_barrier
    s_cmp_eq_u32 s62, 1
    s_cbranch_scc0 L_noep_49
    s_cmp_eq_u32 s87, 0
    s_cbranch_scc0 L_noep_49
    v_mov_b32 v4, 13631488
    s_mov_b64 exec, 1
    buffer_store_dwordx2 v[88:89], v4, s[40:43], 0 offen sc1
    s_mov_b64 exec, -1
L_noep_49:
    s_cmp_eq_u32 s62, 0
    s_cbranch_scc0 L_hfin
    v_mov_b32 v8, s93
    v_cvt_pk_bf16_f32 v8, v8, v8
    v_and_b32_e64 v8, s90, v8
    v_mul_f32 v8, 0xbfb8aa3b, v8
    v_exp_f32 v8, v8
    s_nop 0
    v_add_f32 v8, 1.0, v8
    v_rcp_f32_e64 v8, v8
    s_nop 0
    v_cvt_pk_bf16_f32 v8, v8, v8
    v_and_b32 v8, s90, v8
    s_lshl_b32 s76, s92, 4
    s_lshr_b32 s77, s87, 1
    s_add_u32 s76, s76, s77
    s_mul_i32 s76, s76, 9344
    s_add_u32 s76, s76, 8388608
    s_and_b32 s77, s87, 1
    s_lshl_b32 s77, s77, 5
    s_add_u32 s76, s76, s77
    v_and_b32 v10, 1, v1
    v_lshlrev_b32_e64 v10, 6, v10
    v_bfe_u32 v4, v1, 1, 2
    v_lshl_add_u32 v10, v4, 3, v10
    v_bfe_u32 v4, v1, 4, 1
    v_lshl_add_u32 v10, v4, 2, v10
    v_lshrrev_b32_e64 v4, 3, v1
    v_mul_u32_u24 v6, 299008, v4
    v_and_b32_e64 v5, 7, v1
    v_lshl_add_u32 v6, v5, 4, v6
    v_mov_b32 v7, 2146435072
    v_cmp_gt_u32 vcc, 56, v1
    s_nop 1
    v_cndmask_b32_e64 v6, v7, v6, vcc
    s_mul_i32 s79, s87, 9344
    s_add_u32 s79, s79, 8388608
    s_lshl_b32 s80, s91, 11
    s_lshl_b32 s77, s87, 6
    s_add_u32 s80, s80, s77
    s_sleep 16
    s_mov_b32 s88, 0
L_spin_50:
    buffer_load_dword v64, v10, s[40:43], s76 offen offset:0 sc1
    buffer_load_dword v65, v10, s[40:43], s76 offen offset:128 sc1
    s_waitcnt vmcnt(0)
    v_max_u32 v4, v64, v65
    v_cmp_eq_u32_e64 vcc, -1, v4
    s_nop 0
    s_cbranch_vccz L_ok_51
    s_add_u32 s88, s88, 1
    s_cmp_lt_u32 s88, 65536
    s_cbranch_scc1 L_spin_50
L_ok_51:
    v_lshlrev_b32 v4, 4, v3
    v_lshrrev_b32 v64, v4, v64
    v_lshrrev_b32 v65, v4, v65
    v_lshlrev_b32 v64, 16, v64
    v_lshlrev_b32 v65, 16, v65
    v_lshrrev_b32 v9, 1, v19
    s_mov_b32 s88, 0
    buffer_load_dwordx4 v[128:131], v6, s[40:43], s79 offen offset:512 sc1
    s_sleep 3
    buffer_load_dwordx4 v[128:131], v6, s[40:43], s79 offen offset:512 sc1
    s_sleep 3
L_poll_52:
    buffer_load_dwordx4 v[128:131], v6, s[40:43], s79 offen offset:512 sc1
    s_waitcnt vmcnt(2)
    v_max3_u32 v4, v128, v129, v130
    v_max_u32 v4, v4, v131
    v_cmp_eq_u32 vcc, -1, v4
    s_nop 0
    s_cbranch_vccz L_ok_53
    s_add_u32 s88, s88, 1
    s_cmp_lt_u32 s88, 65536
    s_cbranch_scc1 L_poll_52
L_ok_53:
    v_mov_b32 v48, v128
    v_mov_b32 v49, v129
    v_mov_b32 v50, v130
    v_mov_b32 v51, v131
    v_permlane32_swap_b32 v48, v49
    s_nop 0
    v_permlane32_swap_b32 v50, v51
    v_add_f32 v48, v48, v49
    v_add_f32 v50, v50, v51
    s_nop 1
    v_permlane16_swap_b32 v48, v50
    v_add_f32 v48, v48, v50
    s_nop 1
    v_add_f32_dpp v48, v48, v48 row_ror:8 row_mask:0xf bank_mask:0xf
    v_cvt_pk_bf16_f32 v48, v48, v48
    v_and_b32 v48, s90, v48
    v_mul_f32 v48, v48, v8
    v_cvt_pk_bf16_f32 v48, v48, v48
    v_and_b32 v48, s90, v48
    v_add_f32 v48, v48, v64
    v_cvt_pk_bf16_f32 v48, v48, v48
    v_and_b32 v48, s90, v48
    v_add_f32 v48, v48, v65
    v_cvt_pk_bf16_f32 v48, v48, v48
    s_mov_b32 exec_lo, 0x00ff00ff
    s_mov_b32 exec_hi, 0x00ff00ff
    buffer_store_short v48, v9, s[44:47], s80 offen sc1
    s_mov_b64 exec, -1
L_hfin:
    s_endpgm
L_event:
    s_cmp_eq_u32 s77, 3
    s_cbranch_scc0 L_ev1
    buffer_load_dwordx4 v[92:95], v90, s[40:43], 0 offen sc1
    s_mov_b64 exec, 3
    global_load_dword v27, v91, s[66:67]
    s_mov_b64 exec, -1
    s_branch L_evret
L_ev1:
    s_cmp_eq_u32 s77, 5
    s_cbranch_scc0 L_ev_54
    s_and_b32 s72, s84, 15
    s_mov_b32 m0, s70
    s_lshl_b32 s71, s72, 7
    buffer_load_dwordx4 v16, s[28:31], s71 offen offset:0 lds
    s_mul_i32 s72, s72, 393216
    s_lshr_b64 s[84:85], s[84:85], 4
    buffer_load_dwordx4 v17, s[28:31], s71 offen offset:1024 lds
    buffer_load_dwordx4 v18, s[28:31], s71 offen offset:2048 lds
    buffer_load_dwordx4 v19, s[28:31], s71 offen offset:3072 lds
    s_add_u32 m0, s70, 4096
    s_nop 0
    buffer_load_dwordx4 v20, s[32:35], s72 offen offset:0 lds
    buffer_load_dwordx4 v21, s[32:35], s72 offen offset:1024 lds
    buffer_load_dwordx4 v22, s[32:35], s72 offen offset:2048 lds
    buffer_load_dwordx4 v23, s[32:35], s72 offen offset:3072 lds
    s_add_u32 m0, s70, 8192
    s_nop 0
    buffer_load_dwordx4 v24, s[32:35], s72 offen offset:0 lds
    buffer_load_dwordx4 v25, s[32:35], s72 offen offset:1024 lds
    s_add_u32 s70, s70, 40960
    s_cmp_ge_u32 s70, 122880
    s_cselect_b32 s76, 122880, 0
    s_sub_u32 s70, s70, s76
    buffer_load_dwordx4 v[96:99], v76, s[48:51], s75 offen nt
    s_add_u32 s75, s75, 7168
    buffer_load_dwordx4 v[100:103], v76, s[48:51], s75 offen nt
    s_add_u32 s75, s75, 7168
    buffer_load_dwordx4 v[104:107], v76, s[48:51], s75 offen nt
    s_add_u32 s75, s75, 7168
    buffer_load_dwordx4 v[108:111], v76, s[48:51], s75 offen nt
    s_add_u32 s75, s75, 7168
    buffer_load_dwordx4 v[128:131], v76, s[48:51], s75 offen nt
    s_add_u32 s75, s75, 7168
    buffer_load_dwordx4 v[132:135], v76, s[48:51], s75 offen nt
    s_add_u32 s75, s75, 7168
    buffer_load_dwordx4 v[136:139], v76, s[48:51], s75 offen nt
    s_add_u32 s75, s75, 7168
    buffer_load_dwordx4 v[140:143], v76, s[48:51], s75 offen nt
    s_add_u32 s75, s75, 7168
    s_waitcnt vmcnt(18)
    s_branch L_hbar
L_ev_54:
    s_cmp_eq_u32 s77, 6
    s_cbranch_scc0 L_ev_55
    s_and_b32 s72, s84, 15
    s_mov_b32 m0, s70
    s_lshl_b32 s71, s72, 7
    buffer_load_dwordx4 v16, s[28:31], s71 offen offset:0 lds
    s_mul_i32 s72, s72, 393216
    s_lshr_b64 s[84:85], s[84:85], 4
    buffer_load_dwordx4 v17, s[28:31], s71 offen offset:1024 lds
    buffer_load_dwordx4 v18, s[28:31], s71 offen offset:2048 lds
    buffer_load_dwordx4 v19, s[28:31], s71 offen offset:3072 lds
    s_add_u32 m0, s70, 4096
    s_nop 0
    buffer_load_dwordx4 v20, s[32:35], s72 offen offset:0 lds
    buffer_load_dwordx4 v21, s[32:35], s72 offen offset:1024 lds
    buffer_load_dwordx4 v22, s[32:35], s72 offen offset:2048 lds
    buffer_load_dwordx4 v23, s[32:35], s72 offen offset:3072 lds
    s_add_u32 m0, s70, 8192
    s_nop 0
    buffer_load_dwordx4 v24, s[32:35], s72 offen offset:0 lds
    buffer_load_dwordx4 v25, s[32:35], s72 offen offset:1024 lds
    s_add_u32 s70, s70, 40960
    s_cmp_ge_u32 s70, 122880
    s_cselect_b32 s76, 122880, 0
    s_sub_u32 s70, s70, s76
    s_lshr_b32 s78, s2, 3
    s_lshl2_add_u32 s78, s78, s62
    s_lshl_b32 s78, s78, 14
    v_lshlrev_b32_e64 v11, 10, v1
    s_mov_b64 exec, 65535
    buffer_load_dword v27, v11, s[36:39], s78 offen offset:384
    s_mov_b64 exec, -1
    s_lshl_b32 s78, s62, 9
    v_lshl_add_u32 v11, v1, 7, s78
    s_mov_b64 exec, 15
    global_load_dword v27, v11, s[14:15]
    s_mov_b64 exec, -1
    buffer_load_dwordx4 v[112:115], v76, s[48:51], s75 offen nt
    s_add_u32 s75, s75, 7168
    buffer_load_dwordx4 v[116:119], v76, s[48:51], s75 offen nt
    s_add_u32 s75, s75, 7168
    buffer_load_dwordx4 v[120:123], v76, s[48:51], s75 offen nt
    s_add_u32 s75, s75, 7168
    buffer_load_dwordx4 v[124:127], v76, s[48:51], s75 offen nt
    s_add_u32 s75, s75, 7168
    buffer_load_dwordx4 v[144:147], v76, s[48:51], s75 offen nt
    s_add_u32 s75, s75, 7168
    buffer_load_dwordx4 v[148:151], v76, s[48:51], s75 offen nt
    s_add_u32 s75, s75, 7168
    s_waitcnt vmcnt(18)
    s_branch L_hbar
L_ev_55:
    s_add_u32 s78, s70, 40960
    s_cmp_ge_u32 s78, 122880
    s_cselect_b32 s76, 122880, 0
    s_sub_u32 s78, s78, s76
    s_cmp_eq_u32 s77, 2
    s_cbranch_scc1 L_evw
    v_add_u32 v4, s78, v72
    v_xor_b32 v5, 32, v4
    v_xor_b32 v6, 64, v4
    v_xor_b32 v7, 96, v4
    s_and_b32 s72, s84, 15
    s_mov_b32 m0, s70
    s_lshl_b32 s71, s72, 7
    buffer_load_dwordx4 v16, s[28:31], s71 offen offset:0 lds
    s_mul_i32 s72, s72, 393216
    s_lshr_b64 s[84:85], s[84:85], 4
    ds_read_b128 v[32:35], v4
    ds_read_b128 v[36:39], v5
    ds_read_b128 v[40:43], v6
    ds_read_b128 v[44:47], v7
    buffer_load_dwordx4 v17, s[28:31], s71 offen offset:1024 lds
    s_lshl_b32 s79, s62, 8
    s_add_u32 s79, s79, s73
    s_waitcnt lgkmcnt(0)
    v_lshlrev_b32 v80, 16, v32
    v_and_b32 v82, s90, v32
    v_mul_f32 v81, v80, v80
    v_mul_f32 v83, v82, v82
    v_lshlrev_b32 v10, 16, v33
    v_and_b32 v11, s90, v33
    v_add_f32 v80, v80, v10
    v_add_f32 v82, v82, v11
    v_fmac_f32 v81, v10, v10
    v_fmac_f32 v83, v11, v11
    v_lshlrev_b32 v8, 16, v34
    v_and_b32_e64 v9, s90, v34
    buffer_load_dwordx4 v18, s[28:31], s71 offen offset:2048 lds
    v_add_f32 v80, v80, v8
    v_add_f32 v82, v82, v9
    v_fmac_f32 v81, v8, v8
    v_fmac_f32 v83, v9, v9
    v_lshlrev_b32 v10, 16, v35
    v_and_b32 v11, s90, v35
    v_add_f32 v80, v80, v10
    v_add_f32 v82, v82, v11
    v_fmac_f32 v81, v10, v10
    v_fmac_f32 v83, v11, v11
    v_lshlrev_b32 v8, 16, v36
    v_and_b32 v9, s90, v36
    buffer_load_dwordx4 v19, s[28:31], s71 offen offset:3072 lds
    v_add_f32 v80, v80, v8
    v_add_f32 v82, v82, v9
    v_fmac_f32 v81, v8, v8
    v_fmac_f32 v83, v9, v9
    v_lshlrev_b32 v10, 16, v37
    v_and_b32 v11, s90, v37
    v_add_f32 v80, v80, v10
    v_add_f32 v82, v82, v11
    v_fmac_f32 v81, v10, v10
    v_fmac_f32 v83, v11, v11
    v_lshlrev_b32 v8, 16, v38
    v_and_b32 v9, s90, v38
    s_add_u32 m0, s70, 4096
    s_nop 0
    buffer_load_dwordx4 v20, s[32:35], s72 offen offset:0 lds
    v_add_f32 v80, v80, v8
    v_add_f32 v82, v82, v9
    v_fmac_f32 v81, v8, v8
    v_fmac_f32 v83, v9, v9
    v_lshlrev_b32 v10, 16, v39
    v_and_b32 v11, s90, v39
    v_add_f32 v80, v80, v10
    v_add_f32 v82, v82, v11
    v_fmac_f32 v81, v10, v10
    v_fmac_f32 v83, v11, v11
    v_lshlrev_b32 v8, 16, v40
    v_and_b32_e64 v9, s90, v40
    buffer_load_dwordx4 v21, s[32:35], s72 offen offset:1024 lds
    v_add_f32 v80, v80, v8
    v_add_f32 v82, v82, v9
    v_fmac_f32 v81, v8, v8
    v_fmac_f32 v83, v9, v9
    v_lshlrev_b32 v10, 16, v41
    v_and_b32 v11, s90, v41
    v_add_f32 v80, v80, v10
    v_add_f32 v82, v82, v11
    v_fmac_f32 v81, v10, v10
    v_fmac_f32 v83, v11, v11
    v_lshlrev_b32 v8, 16, v42
    v_and_b32 v9, s90, v42
    buffer_load_dwordx4 v22, s[32:35], s72 offen offset:2048 lds
    v_add_f32 v80, v80, v8
    v_add_f32 v82, v82, v9
    v_fmac_f32 v81, v8, v8
    v_fmac_f32 v83, v9, v9
    v_lshlrev_b32 v10, 16, v43
    v_and_b32 v11, s90, v43
    v_add_f32 v80, v80, v10
    v_add_f32 v82, v82, v11
    v_fmac_f32 v81, v10, v10
    v_fmac_f32 v83, v11, v11
    v_lshlrev_b32 v8, 16, v44
    v_and_b32 v9, s90, v44
    buffer_load_dwordx4 v23, s[32:35], s72 offen offset:3072 lds
    v_add_f32 v80, v80, v8
    v_add_f32 v82, v82, v9
    v_fmac_f32 v81, v8, v8
    v_fmac_f32 v83, v9, v9
    v_lshlrev_b32 v10, 16, v45
    v_and_b32 v11, s90, v45
    v_add_f32 v80, v80, v10
    v_add_f32 v82, v82, v11
    v_fmac_f32 v81, v10, v10
    v_fmac_f32 v83, v11, v11
    v_lshlrev_b32 v8, 16, v46
    v_and_b32 v9, s90, v46
    s_add_u32 m0, s70, 8192
    s_nop 0
    buffer_load_dwordx4 v24, s[32:35], s72 offen offset:0 lds
    v_add_f32 v80, v80, v8
    v_add_f32 v82, v82, v9
    v_fmac_f32 v81, v8, v8
    v_fmac_f32 v83, v9, v9
    v_lshlrev_b32 v10, 16, v47
    v_and_b32 v11, s90, v47
    v_add_f32 v80, v80, v10
    v_add_f32 v82, v82, v11
    v_fmac_f32 v81, v10, v10
    v_fmac_f32_e64 v83, v11, v11
    buffer_load_dwordx4 v25, s[32:35], s72 offen offset:1024 lds
    s_add_u32 s70, s70, 40960
    s_cmp_ge_u32 s70, 122880
    s_cselect_b32 s76, 122880, 0
    s_sub_u32 s70, s70, s76
    v_add_f32 v80, v80, v82
    v_add_f32 v81, v81, v83
    v_mov_b32 v82, v80
    v_mov_b32 v83, v81
    s_nop 0
    v_permlane32_swap_b32 v80, v82
    v_permlane32_swap_b32 v81, v83
    v_add_f32 v80, v80, v82
    v_add_f32_e64 v81, v81, v83
    s_mov_b32 exec_hi, 0
    buffer_store_dwordx2 v[80:81], v74, s[40:43], s79 offen offset:0 sc1
    s_mov_b64 exec, -1
    s_waitcnt vmcnt(11)
    s_branch L_hbar
L_evw:
    s_mul_i32 s79, s63, 2048
    s_add_u32 s79, s79, s78
    v_add_u32_e64 v4, s79, v73
    s_mul_i32 s79, s63, 20480
    s_add_u32 s79, s79, s78
    v_add_u32_e64 v5, s79, v73
    s_and_b32 s72, s84, 15
    s_mov_b32 m0, s70
    s_lshl_b32 s71, s72, 7
    buffer_load_dwordx4 v16, s[28:31], s71 offen offset:0 lds
    s_mul_i32 s72, s72, 393216
    s_lshr_b64 s[84:85], s[84:85], 4
    ds_read_b64_tr_b16 v[32:33], v4 offset:0
    ds_read_b64_tr_b16 v[34:35], v4 offset:512
    ds_read_b64_tr_b16 v[36:37], v4 offset:10240
    ds_read_b64_tr_b16 v[38:39], v4 offset:10752
    ds_read_b64_tr_b16 v[40:41], v4 offset:20480
    ds_read_b64_tr_b16 v[42:43], v4 offset:20992
    ds_read_b64_tr_b16 v[44:45], v4 offset:30720
    ds_read_b64_tr_b16 v[46:47], v4 offset:31232
    ds_read_b64_tr_b16 v[48:49], v5 offset:4096
    ds_read_b64_tr_b16 v[50:51], v5 offset:4608
    ds_read_b64_tr_b16 v[52:53], v5 offset:14336
    ds_read_b64_tr_b16 v[54:55], v5 offset:14848
    buffer_load_dwordx4 v17, s[28:31], s71 offen offset:1024 lds
    s_lshl_b32 s79, s64, 9
    s_lshl_b32 s80, s63, 3
    s_add_u32 s79, s79, s80
    s_add_u32 s79, s79, s73
    s_waitcnt lgkmcnt(0)
    v_lshlrev_b32 v80, 16, v32
    v_and_b32 v82, s90, v32
    v_lshlrev_b32 v10, 16, v33
    v_and_b32 v11, s90, v33
    v_add_f32 v80, v80, v10
    v_add_f32 v82, v82, v11
    v_lshlrev_b32 v8, 16, v34
    v_and_b32 v9, s90, v34
    v_add_f32 v80, v80, v8
    v_add_f32 v82, v82, v9
    v_lshlrev_b32 v10, 16, v35
    v_and_b32 v11, s90, v35
    buffer_load_dwordx4 v18, s[28:31], s71 offen offset:2048 lds
    v_add_f32 v80, v80, v10
    v_add_f32 v82, v82, v11
    v_lshlrev_b32 v8, 16, v36
    v_and_b32 v9, s90, v36
    v_add_f32 v80, v80, v8
    v_add_f32 v82, v82, v9
    v_lshlrev_b32 v10, 16, v37
    v_and_b32 v11, s90, v37
    v_add_f32 v80, v80, v10
    v_add_f32 v82, v82, v11
    v_lshlrev_b32 v8, 16, v38
    v_and_b32 v9, s90, v38
    buffer_load_dwordx4 v19, s[28:31], s71 offen offset:3072 lds
    v_add_f32 v80, v80, v8
    v_add_f32 v82, v82, v9
    v_lshlrev_b32 v10, 16, v39
    v_and_b32 v11, s90, v39
    v_add_f32 v80, v80, v10
    v_add_f32 v82, v82, v11
    v_lshlrev_b32 v8, 16, v40
    v_and_b32 v9, s90, v40
    v_add_f32 v80, v80, v8
    v_add_f32 v82, v82, v9
    v_lshlrev_b32 v10, 16, v41
    v_and_b32 v11, s90, v41
    s_add_u32 m0, s70, 4096
    s_nop 0
    buffer_load_dwordx4 v20, s[32:35], s72 offen offset:0 lds
    v_add_f32 v80, v80, v10
    v_add_f32 v82, v82, v11
    v_lshlrev_b32 v8, 16, v42
    v_and_b32 v9, s90, v42
    v_add_f32 v80, v80, v8
    v_add_f32 v82, v82, v9
    v_lshlrev_b32 v10, 16, v43
    v_and_b32 v11, s90, v43
    v_add_f32 v80, v80, v10
    v_add_f32 v82, v82, v11
    v_lshlrev_b32 v8, 16, v44
    v_and_b32_e64 v9, s90, v44
    buffer_load_dwordx4 v21, s[32:35], s72 offen offset:1024 lds
    v_add_f32 v80, v80, v8
    v_add_f32 v82, v82, v9
    v_lshlrev_b32 v10, 16, v45
    v_and_b32 v11, s90, v45
    v_add_f32 v80, v80, v10
    v_add_f32 v82, v82, v11
    v_lshlrev_b32 v8, 16, v46
    v_and_b32 v9, s90, v46
    v_add_f32 v80, v80, v8
    v_add_f32 v82, v82, v9
    v_lshlrev_b32 v10, 16, v47
    v_and_b32 v11, s90, v47
    buffer_load_dwordx4 v22, s[32:35], s72 offen offset:2048 lds
    v_add_f32 v80, v80, v10
    v_add_f32 v82, v82, v11
    v_lshlrev_b32 v81, 16, v48
    v_and_b32 v83, s90, v48
    v_lshlrev_b32 v10, 16, v49
    v_and_b32 v11, s90, v49
    v_add_f32 v81, v81, v10
    v_add_f32 v83, v83, v11
    v_lshlrev_b32 v8, 16, v50
    v_and_b32 v9, s90, v50
    v_add_f32 v81, v81, v8
    v_add_f32 v83, v83, v9
    buffer_load_dwordx4 v23, s[32:35], s72 offen offset:3072 lds
    v_lshlrev_b32 v10, 16, v51
    v_and_b32 v11, s90, v51
    v_add_f32 v81, v81, v10
    v_add_f32 v83, v83, v11
    v_lshlrev_b32 v8, 16, v52
    v_and_b32 v9, s90, v52
    v_add_f32 v81, v81, v8
    v_add_f32 v83, v83, v9
    v_lshlrev_b32 v10, 16, v53
    v_and_b32 v11, s90, v53
    v_add_f32 v81, v81, v10
    v_add_f32 v83, v83, v11
    s_add_u32 m0, s70, 8192
    s_nop 0
    buffer_load_dwordx4 v24, s[32:35], s72 offen offset:0 lds
    v_lshlrev_b32 v8, 16, v54
    v_and_b32 v9, s90, v54
    v_add_f32 v81, v81, v8
    v_add_f32 v83, v83, v9
    v_lshlrev_b32 v10, 16, v55
    v_and_b32 v11, s90, v55
    v_add_f32 v81, v81, v10
    v_add_f32_e64 v83, v83, v11
    buffer_load_dwordx4 v25, s[32:35], s72 offen offset:1024 lds
    s_add_u32 s70, s70, 40960
    s_cmp_ge_u32 s70, 122880
    s_cselect_b32 s76, 122880, 0
    s_sub_u32 s70, s70, s76
    v_add_f32 v80, v80, v82
    v_add_f32 v81, v81, v83
    v_mov_b32 v82, v80
    v_mov_b32 v83, v81
    s_nop 0
    v_permlane32_swap_b32 v80, v82
    v_permlane32_swap_b32 v81, v83
    v_add_f32 v80, v80, v82
    v_add_f32_e64 v81, v81, v83
    s_mov_b32 exec_hi, 0
    buffer_store_dwordx2 v[80:81], v12, s[40:43], s79 offen offset:1024 sc1
    s_mov_b64 exec, -1
    s_waitcnt vmcnt(11)
    s_branch L_hbar
L_compute:
    s_setprio 2
    s_and_b32 s63, s62, 1
    s_lshr_b32 s64, s62, 1
    s_lshl_b32 s73, s60, 4
    s_add_u32 s73, s73, s61
    s_mul_i32 s73, s73, 28800
    s_add_u32 s76, s2, 7
    s_and_b32 s76, s76, 7
    s_bfe_u32 s77, s2, 0x10003
    s_lshl1_add_u32 s97, s76, s77
    s_lshr_b32 s98, s2, 4
    s_lshl_b32 s99, s97, 4
    s_add_u32 s99, s99, s98
    s_mul_i32 s99, s99, 9344
    s_add_u32 s99, s99, 8388608
    s_lshr_b32 s65, s97, 1
    s_lshl_b32 s76, s97, 3
    s_add_u32 s65, s65, s76
    s_mul_i32 s76, s98, 4
    s_add_u32 s65, s65, s76
    s_and_b32 s65, s65, 15
    s_mov_b32 s89, 0x3f803f80
    s_mov_b32 s90, 0xffff0000
    v_and_b32 v2, 31, v1
    v_lshrrev_b32 v3, 5, v1
    v_lshlrev_b32 v12, 4, v1
    v_lshrrev_b32 v4, 3, v1
    v_mul_u32_u24 v13, 460800, v4
    v_and_b32_e64 v4, 7, v1
    v_lshl_add_u32 v13, v4, 4, v13
    v_and_b32 v10, 15, v1
    v_lshrrev_b32 v11, 4, v1
    s_mul_i32 s76, s63, 20480
    v_lshrrev_b32 v4, 1, v10
    v_xor_b32 v4, v4, v11
    v_lshlrev_b32_e64 v4, 4, v4
    v_lshl_add_u32 v4, v10, 7, v4
    v_add_u32 v192, s76, v4
    v_xor_b32 v193, 64, v192
    v_bfe_u32 v4, v1, 2, 2
    v_and_b32_e64 v6, 1, v11
    v_lshl_add_u32 v5, v6, 3, v4
    v_lshlrev_b32 v5, 7, v5
    v_lshrrev_b32 v4, 1, v4
    v_xor_b32_e64 v4, s64, v4
    v_lshl_add_u32 v5, v4, 6, v5
    v_lshl_add_u32 v5, v6, 5, v5
    v_and_b32_e64 v4, 3, v1
    v_lshl_add_u32 v5, v4, 3, v5
    v_mul_u32_u24 v4, 10240, v3
    v_add_u32_e64 v5, v5, v4
    v_add_u32 v194, 4096, v5
    v_xor_b32_e64 v195, 32, v194
    v_add_u32 v196, 40960, v192
    v_add_u32 v197, 40960, v193
    v_add_u32 v198, 40960, v194
    v_add_u32 v199, 40960, v195
    v_add_u32 v200, 81920, v192
    v_add_u32 v201, 81920, v193
    v_add_u32 v202, 81920, v194
    v_add_u32 v203, 81920, v195
    v_bfe_u32 v4, v1, 2, 2
    v_lshl_add_u32 v4, v3, 3, v4
    v_lshlrev_b32 v4, 6, v4
    v_and_b32 v5, 1, v11
    v_lshl_add_u32 v4, v5, 5, v4
    v_and_b32_e64 v5, 3, v1
    v_lshl_add_u32 v4, v5, 3, v4
    s_lshl_b32 s76, s64, 11
    s_add_u32 s76, s76, 122880
    v_add_u32_e64 v212, s76, v4
    s_lshl_b32 s76, s63, 9
    v_lshl_add_u32 v213, v10, 3, s76
    v_lshl_add_u32 v214, v2, 3, s76
    s_lshl_b32 s76, s64, 8
    v_lshl_add_u32 v215, v10, 3, s76
    v_bfe_u32 v4, v10, 1, 1
    v_xor_b32 v4, s64, v4
    v_lshrrev_b32 v5, 2, v10
    v_xor_b32 v5, v5, v3
    v_xor_b32 v6, v10, v11
    v_and_b32 v6, 1, v6
    v_lshlrev_b32_e64 v4, 6, v4
    v_lshl_add_u32 v4, v5, 4, v4
    v_lshl_add_u32 v4, v6, 3, v4
    v_lshl_add_u32 v4, v10, 7, v4
    s_lshl_b32 s76, s63, 13
    v_add_u32 v216, s76, v4
    v_bfe_u32 v4, v2, 1, 1
    v_bfe_u32 v5, v2, 2, 2
    v_and_b32 v6, 1, v2
    v_xor_b32 v6, v6, v3
    v_lshlrev_b32_e64 v4, 6, v4
    v_lshl_add_u32 v4, v5, 4, v4
    v_lshl_add_u32 v4, v6, 3, v4
    v_lshl_add_u32 v4, v2, 7, v4
    s_lshl_b32 s77, s64, 14
    s_add_u32 s76, s76, s77
    v_add_u32_e64 v217, s76, v4
    v_bfe_u32 v4, v1, 2, 2
    v_lshl_add_u32 v5, v3, 3, v4
    v_lshlrev_b32 v5, 7, v5
    v_lshrrev_b32 v6, 1, v4
    v_lshl_add_u32 v5, v6, 6, v5
    v_bfe_u32 v6, v1, 4, 1
    v_xor_b32_e64 v6, v6, v3
    v_lshl_add_u32 v5, v6, 5, v5
    v_bfe_u32 v6, v1, 1, 1
    v_lshl_add_u32 v5, v6, 4, v5
    v_xor_b32 v6, v1, v4
    v_and_b32 v6, 1, v6
    v_lshl_add_u32 v5, v6, 3, v5
    s_lshl_b32 s76, s63, 6
    s_or_b32 s76, s76, s77
    v_xor_b32 v218, s76, v5
    s_lshl_b32 s76, s64, 6
    v_xor_b32_e64 v220, s76, v5
    v_xor_b32 v219, 528, v218
    v_xor_b32 v221, 528, v220
    v_cmp_gt_u32 s[86:87], 16, v1
    s_waitcnt lgkmcnt(0)
    s_mov_b32 s40, s26
    s_and_b32 s41, s27, 0xffff
    s_mov_b32 s42, 33554432
    s_mov_b32 s43, 0x20000
    s_mov_b32 s44, s22
    s_and_b32 s45, s23, 0xffff
    s_mov_b32 s46, 4194304
    s_mov_b32 s47, 0x20000
    s_mov_b32 s68, 0
    s_getreg_b32 s101, hwreg(HW_REG_XCC_ID, 0, 4)
    v_mov_b32 v9, 13631488
    s_lshl_b32 s76, s61, 8
    s_lshl4_add_u32 s76, s60, s76
    s_add_u32 s76, s76, 12582912
    v_mov_b32 v8, s76
    s_lshl_b32 s76, s60, 8
    s_lshl4_add_u32 s76, s61, s76
    s_add_u32 s76, s76, 12587008
    v_writelane_b32 v8, s76, 1
    s_lshl_b32 s76, s97, 8
    s_lshl4_add_u32 s76, s98, s76
    s_add_u32 s76, s76, 12591104
    v_writelane_b32 v8, s76, 2
    v_mov_b32 v6, s101
    v_mov_b32 v7, 0
    v_mov_b32_e64 v10, 0
    s_cmp_eq_u32 s62, 0
    s_cbranch_scc0 L_noep
    buffer_load_dwordx2 v[4:5], v9, s[40:43], 0 offen
L_noep:
    s_barrier
    ds_read_b128 v[112:115], v192 offset:0
    ds_read_b64_tr_b16 v[128:129], v194 offset:0
    ds_read_b64_tr_b16 v[130:131], v194 offset:512
    ds_read_b128 v[116:119], v192 offset:2048
    ds_read_b128 v[120:123], v192 offset:10240
    ds_read_b128 v[124:127], v192 offset:12288
    ds_read_b64_tr_b16 v[132:133], v195 offset:0
    ds_read_b64_tr_b16 v[134:135], v195 offset:512
    ds_read_b64_tr_b16 v[136:137], v194 offset:2048
    ds_read_b64_tr_b16 v[138:139], v194 offset:2560
    ds_read_b64_tr_b16 v[140:141], v195 offset:2048
    ds_read_b64_tr_b16 v[142:143], v195 offset:2560
    ds_read_b64_tr_b16 v[144:145], v194 offset:4096
    ds_read_b64_tr_b16 v[146:147], v194 offset:4608
    s_waitcnt lgkmcnt(8)
    ds_read_b64_tr_b16 v[148:149], v195 offset:4096
    ds_read_b64_tr_b16 v[150:151], v195 offset:4608
    v_mfma_f32_16x16x32_bf16 v[16:19], v[128:131], v[112:115], 0
    ds_read_b128 v[152:155], v193 offset:0
    v_mfma_f32_16x16x32_bf16 v[20:23], v[128:131], v[116:119], 0
    ds_read_b64_tr_b16 v[168:169], v194 offset:20480
    v_mfma_f32_16x16x32_bf16 v[24:27], v[128:131], v[120:123], 0
    ds_read_b64_tr_b16 v[170:171], v194 offset:20992
    v_mfma_f32_16x16x32_bf16 v[28:31], v[128:131], v[124:127], 0
    ds_read_b128 v[156:159], v193 offset:2048
    s_waitcnt lgkmcnt(4)
    v_mfma_f32_16x16x32_bf16 v[32:35], v[132:135], v[112:115], 0
    ds_read_b128 v[160:163], v193 offset:10240
    v_mfma_f32_16x16x32_bf16 v[36:39], v[132:135], v[116:119], 0
    ds_read_b128 v[164:167], v193 offset:12288
    v_mfma_f32_16x16x32_bf16 v[40:43], v[132:135], v[120:123], 0
    ds_read_b64_tr_b16 v[172:173], v195 offset:20480
    v_mfma_f32_16x16x32_bf16 v[44:47], v[132:135], v[124:127], 0
    ds_read_b64_tr_b16 v[174:175], v195 offset:20992
    v_mfma_f32_16x16x32_bf16 v[48:51], v[136:139], v[112:115], 0
    ds_read_b64_tr_b16 v[176:177], v194 offset:22528
    v_mfma_f32_16x16x32_bf16 v[52:55], v[136:139], v[116:119], 0
    ds_read_b64_tr_b16 v[178:179], v194 offset:23040
    v_mfma_f32_16x16x32_bf16 v[56:59], v[136:139], v[120:123], 0
    ds_read_b64_tr_b16 v[180:181], v195 offset:22528
    v_mfma_f32_16x16x32_bf16 v[60:63], v[136:139], v[124:127], 0
    ds_read_b64_tr_b16 v[182:183], v195 offset:23040
    v_mfma_f32_16x16x32_bf16 v[64:67], v[140:143], v[112:115], 0
    ds_read_b64_tr_b16 v[184:185], v194 offset:24576
    v_mfma_f32_16x16x32_bf16 v[68:71], v[140:143], v[116:119], 0
    ds_read_b64_tr_b16 v[186:187], v194 offset:25088
    v_mfma_f32_16x16x32_bf16 v[72:75], v[140:143], v[120:123], 0
    ds_read_b64_tr_b16 v[188:189], v195 offset:24576
    v_mfma_f32_16x16x32_bf16 v[76:79], v[140:143], v[124:127], 0
    ds_read_b64_tr_b16 v[190:191], v195 offset:25088
    v_mfma_f32_16x16x32_bf16 v[80:83], v[144:147], v[112:115], 0
    v_mfma_f32_16x16x32_bf16 v[84:87], v[144:147], v[116:119], 0
    v_mfma_f32_16x16x32_bf16 v[88:91], v[144:147], v[120:123], 0
    v_mfma_f32_16x16x32_bf16 v[92:95], v[144:147], v[124:127], 0
    v_mfma_f32_16x16x32_bf16 v[96:99], v[148:151], v[112:115], 0
    v_mfma_f32_16x16x32_bf16 v[100:103], v[148:151], v[116:119], 0
    v_mfma_f32_16x16x32_bf16 v[104:107], v[148:151], v[120:123], 0
    v_mfma_f32_16x16x32_bf16 v[108:111], v[148:151], v[124:127], 0
    s_waitcnt lgkmcnt(0)
    v_mfma_f32_16x16x32_bf16 v[16:19], v[168:171], v[152:155], v[16:19]
    s_barrier
    v_mfma_f32_16x16x32_bf16 v[20:23], v[168:171], v[156:159], v[20:23]
    ds_read_b128 v[112:115], v196 offset:0
    ds_read_b64_tr_b16 v[204:205], v212 offset:0
    ds_read_b64_tr_b16 v[206:207], v212 offset:256
    ds_read_b64_tr_b16 v[208:209], v212 offset:1024
    ds_read_b64_tr_b16 v[210:211], v212 offset:1280
    v_mfma_f32_16x16x32_bf16 v[24:27], v[168:171], v[160:163], v[24:27]
    ds_read_b64_tr_b16 v[128:129], v198 offset:0
    s_cmp_eq_u32 s62, 0
    s_cbranch_scc0 L_cloop
    s_waitcnt vmcnt(0)
    v_add_co_u32 v4, vcc, 1, v4
    s_nop 1
    v_addc_co_u32 v5, vcc, 0, v5, vcc
    s_mov_b64 exec, 7
    buffer_store_dwordx4 v[4:7], v8, s[40:43], 0 offen sc1
    s_mov_b64 exec, -1
.p2align 3
L_cloop:
    v_mfma_f32_16x16x32_bf16 v[28:31], v[168:171], v[164:167], v[28:31]
    ds_read_b64_tr_b16 v[130:131], v198 offset:512
    v_mfma_f32_16x16x32_bf16 v[32:35], v[172:175], v[152:155], v[32:35]
    ds_read_b128 v[116:119], v196 offset:2048
    v_mfma_f32_16x16x32_bf16 v[36:39], v[172:175], v[156:159], v[36:39]
    ds_read_b128 v[120:123], v196 offset:10240
    v_mfma_f32_16x16x32_bf16 v[40:43], v[172:175], v[160:163], v[40:43]
    ds_read_b128 v[124:127], v196 offset:12288
    v_mfma_f32_16x16x32_bf16 v[44:47], v[172:175], v[164:167], v[44:47]
    ds_read_b64_tr_b16 v[132:133], v199 offset:0
    v_mfma_f32_16x16x32_bf16 v[48:51], v[176:179], v[152:155], v[48:51]
    ds_read_b64_tr_b16 v[134:135], v199 offset:512
    v_mfma_f32_16x16x32_bf16 v[52:55], v[176:179], v[156:159], v[52:55]
    ds_read_b64_tr_b16 v[136:137], v198 offset:2048
    v_mfma_f32_16x16x32_bf16 v[56:59], v[176:179], v[160:163], v[56:59]
    ds_read_b64_tr_b16 v[138:139], v198 offset:2560
    v_mfma_f32_16x16x32_bf16 v[60:63], v[176:179], v[164:167], v[60:63]
    ds_read_b64_tr_b16 v[140:141], v199 offset:2048
    v_mfma_f32_16x16x32_bf16 v[64:67], v[180:183], v[152:155], v[64:67]
    ds_read_b64_tr_b16 v[142:143], v199 offset:2560
    v_mfma_f32_16x16x32_bf16 v[68:71], v[180:183], v[156:159], v[68:71]
    ds_read_b64_tr_b16 v[144:145], v198 offset:4096
    v_mfma_f32_16x16x32_bf16 v[72:75], v[180:183], v[160:163], v[72:75]
    ds_read_b64_tr_b16 v[146:147], v198 offset:4608
    v_mfma_f32_16x16x32_bf16 v[76:79], v[180:183], v[164:167], v[76:79]
    ds_read_b64_tr_b16 v[148:149], v199 offset:4096
    v_mfma_f32_16x16x32_bf16 v[80:83], v[184:187], v[152:155], v[80:83]
    ds_read_b64_tr_b16 v[150:151], v199 offset:4608
    v_mfma_f32_16x16x32_bf16 v[84:87], v[184:187], v[156:159], v[84:87]
    v_mfma_f32_16x16x32_bf16 v[88:91], v[184:187], v[160:163], v[88:91]
    v_mfma_f32_16x16x32_bf16 v[92:95], v[184:187], v[164:167], v[92:95]
    v_mfma_f32_16x16x32_bf16 v[96:99], v[188:191], v[152:155], v[96:99]
    v_mfma_f32_16x16x32_bf16 v[100:103], v[188:191], v[156:159], v[100:103]
    v_mfma_f32_16x16x32_bf16 v[104:107], v[188:191], v[160:163], v[104:107]
    v_mfma_f32_16x16x32_bf16 v[108:111], v[188:191], v[164:167], v[108:111]
    s_waitcnt lgkmcnt(0)
    v_mfma_f32_16x16x32_bf16 v[16:19], v[128:131], v[112:115], v[16:19]
    ds_read_b128 v[152:155], v197 offset:0
    v_mfma_f32_16x16x32_bf16 v[20:23], v[128:131], v[116:119], v[20:23]
    ds_read_b64_tr_b16 v[168:169], v198 offset:20480
    v_mfma_f32_16x16x32_bf16 v[24:27], v[128:131], v[120:123], v[24:27]
    ds_read_b64_tr_b16 v[170:171], v198 offset:20992
    v_mfma_f32_16x16x32_bf16 v[28:31], v[128:131], v[124:127], v[28:31]
    ds_read_b128 v[156:159], v197 offset:2048
    v_mfma_f32_16x16x32_bf16 v[32:35], v[132:135], v[112:115], v[32:35]
    ds_read_b128 v[160:163], v197 offset:10240
    v_mfma_f32_16x16x32_bf16 v[36:39], v[132:135], v[116:119], v[36:39]
    ds_read_b128 v[164:167], v197 offset:12288
    v_mfma_f32_16x16x32_bf16 v[40:43], v[132:135], v[120:123], v[40:43]
    ds_read_b64_tr_b16 v[172:173], v199 offset:20480
    v_mfma_f32_16x16x32_bf16 v[44:47], v[132:135], v[124:127], v[44:47]
    ds_read_b64_tr_b16 v[174:175], v199 offset:20992
    v_mfma_f32_16x16x32_bf16 v[48:51], v[136:139], v[112:115], v[48:51]
    ds_read_b64_tr_b16 v[176:177], v198 offset:22528
    v_mfma_f32_16x16x32_bf16 v[52:55], v[136:139], v[116:119], v[52:55]
    ds_read_b64_tr_b16 v[178:179], v198 offset:23040
    v_mfma_f32_16x16x32_bf16 v[56:59], v[136:139], v[120:123], v[56:59]
    ds_read_b64_tr_b16 v[180:181], v199 offset:22528
    v_mfma_f32_16x16x32_bf16 v[60:63], v[136:139], v[124:127], v[60:63]
    ds_read_b64_tr_b16 v[182:183], v199 offset:23040
    v_mfma_f32_16x16x32_bf16 v[64:67], v[140:143], v[112:115], v[64:67]
    ds_read_b64_tr_b16 v[184:185], v198 offset:24576
    v_mfma_f32_16x16x32_bf16 v[68:71], v[140:143], v[116:119], v[68:71]
    ds_read_b64_tr_b16 v[186:187], v198 offset:25088
    v_mfma_f32_16x16x32_bf16 v[72:75], v[140:143], v[120:123], v[72:75]
    ds_read_b64_tr_b16 v[188:189], v199 offset:24576
    v_mfma_f32_16x16x32_bf16 v[76:79], v[140:143], v[124:127], v[76:79]
    ds_read_b64_tr_b16 v[190:191], v199 offset:25088
    v_mfma_f32_16x16x32_bf16 v[80:83], v[144:147], v[112:115], v[80:83]
    v_mfma_f32_16x16x32_bf16 v[84:87], v[144:147], v[116:119], v[84:87]
    v_mfma_f32_16x16x32_bf16 v[88:91], v[144:147], v[120:123], v[88:91]
    v_mfma_f32_16x16x32_bf16 v[92:95], v[144:147], v[124:127], v[92:95]
    v_mfma_f32_16x16x32_bf16 v[96:99], v[148:151], v[112:115], v[96:99]
    v_mfma_f32_16x16x32_bf16 v[100:103], v[148:151], v[116:119], v[100:103]
    v_mfma_f32_16x16x32_bf16 v[104:107], v[148:151], v[120:123], v[104:107]
    v_mfma_f32_16x16x32_bf16 v[108:111], v[148:151], v[124:127], v[108:111]
    s_waitcnt lgkmcnt(0)
    v_mfma_f32_16x16x32_bf16 v[16:19], v[168:171], v[152:155], v[16:19]
    s_barrier
    v_mfma_f32_16x16x32_bf16 v[20:23], v[168:171], v[156:159], v[20:23]
    ds_read_b128 v[112:115], v200 offset:0
    v_mfma_f32_16x16x32_bf16 v[24:27], v[168:171], v[160:163], v[24:27]
    ds_read_b64_tr_b16 v[128:129], v202 offset:0
    v_mfma_f32_16x16x32_bf16 v[28:31], v[168:171], v[164:167], v[28:31]
    ds_read_b64_tr_b16 v[130:131], v202 offset:512
    v_mfma_f32_16x16x32_bf16 v[32:35], v[172:175], v[152:155], v[32:35]
    ds_read_b128 v[116:119], v200 offset:2048
    v_mfma_f32_16x16x32_bf16 v[36:39], v[172:175], v[156:159], v[36:39]
    ds_read_b128 v[120:123], v200 offset:10240
    v_mfma_f32_16x16x32_bf16 v[40:43], v[172:175], v[160:163], v[40:43]
    ds_read_b128 v[124:127], v200 offset:12288
    v_mfma_f32_16x16x32_bf16 v[44:47], v[172:175], v[164:167], v[44:47]
    ds_read_b64_tr_b16 v[132:133], v203 offset:0
    v_mfma_f32_16x16x32_bf16 v[48:51], v[176:179], v[152:155], v[48:51]
    ds_read_b64_tr_b16 v[134:135], v203 offset:512
    v_mfma_f32_16x16x32_bf16 v[52:55], v[176:179], v[156:159], v[52:55]
    ds_read_b64_tr_b16 v[136:137], v202 offset:2048
    v_mfma_f32_16x16x32_bf16 v[56:59], v[176:179], v[160:163], v[56:59]
    ds_read_b64_tr_b16 v[138:139], v202 offset:2560
    v_mfma_f32_16x16x32_bf16 v[60:63], v[176:179], v[164:167], v[60:63]
    ds_read_b64_tr_b16 v[140:141], v203 offset:2048
    v_mfma_f32_16x16x32_bf16 v[64:67], v[180:183], v[152:155], v[64:67]
    ds_read_b64_tr_b16 v[142:143], v203 offset:2560
    v_mfma_f32_16x16x32_bf16 v[68:71], v[180:183], v[156:159], v[68:71]
    ds_read_b64_tr_b16 v[144:145], v202 offset:4096
    v_mfma_f32_16x16x32_bf16 v[72:75], v[180:183], v[160:163], v[72:75]
    ds_read_b64_tr_b16 v[146:147], v202 offset:4608
    v_mfma_f32_16x16x32_bf16 v[76:79], v[180:183], v[164:167], v[76:79]
    ds_read_b64_tr_b16 v[148:149], v203 offset:4096
    v_mfma_f32_16x16x32_bf16 v[80:83], v[184:187], v[152:155], v[80:83]
    ds_read_b64_tr_b16 v[150:151], v203 offset:4608
    v_mfma_f32_16x16x32_bf16 v[84:87], v[184:187], v[156:159], v[84:87]
    v_mfma_f32_16x16x32_bf16 v[88:91], v[184:187], v[160:163], v[88:91]
    v_mfma_f32_16x16x32_bf16 v[92:95], v[184:187], v[164:167], v[92:95]
    v_mfma_f32_16x16x32_bf16 v[96:99], v[188:191], v[152:155], v[96:99]
    v_mfma_f32_16x16x32_bf16 v[100:103], v[188:191], v[156:159], v[100:103]
    v_mfma_f32_16x16x32_bf16 v[104:107], v[188:191], v[160:163], v[104:107]
    v_mfma_f32_16x16x32_bf16 v[108:111], v[188:191], v[164:167], v[108:111]
    s_waitcnt lgkmcnt(0)
    v_mfma_f32_16x16x32_bf16 v[16:19], v[128:131], v[112:115], v[16:19]
    ds_read_b128 v[152:155], v201 offset:0
    v_mfma_f32_16x16x32_bf16 v[20:23], v[128:131], v[116:119], v[20:23]
    ds_read_b64_tr_b16 v[168:169], v202 offset:20480
    v_mfma_f32_16x16x32_bf16 v[24:27], v[128:131], v[120:123], v[24:27]
    ds_read_b64_tr_b16 v[170:171], v202 offset:20992
    v_mfma_f32_16x16x32_bf16 v[28:31], v[128:131], v[124:127], v[28:31]
    ds_read_b128 v[156:159], v201 offset:2048
    v_mfma_f32_16x16x32_bf16 v[32:35], v[132:135], v[112:115], v[32:35]
    ds_read_b128 v[160:163], v201 offset:10240
    v_mfma_f32_16x16x32_bf16 v[36:39], v[132:135], v[116:119], v[36:39]
    ds_read_b128 v[164:167], v201 offset:12288
    v_mfma_f32_16x16x32_bf16 v[40:43], v[132:135], v[120:123], v[40:43]
    ds_read_b64_tr_b16 v[172:173], v203 offset:20480
    v_mfma_f32_16x16x32_bf16 v[44:47], v[132:135], v[124:127], v[44:47]
    ds_read_b64_tr_b16 v[174:175], v203 offset:20992
    v_mfma_f32_16x16x32_bf16 v[48:51], v[136:139], v[112:115], v[48:51]
    ds_read_b64_tr_b16 v[176:177], v202 offset:22528
    v_mfma_f32_16x16x32_bf16 v[52:55], v[136:139], v[116:119], v[52:55]
    ds_read_b64_tr_b16 v[178:179], v202 offset:23040
    v_mfma_f32_16x16x32_bf16 v[56:59], v[136:139], v[120:123], v[56:59]
    ds_read_b64_tr_b16 v[180:181], v203 offset:22528
    v_mfma_f32_16x16x32_bf16 v[60:63], v[136:139], v[124:127], v[60:63]
    ds_read_b64_tr_b16 v[182:183], v203 offset:23040
    v_mfma_f32_16x16x32_bf16 v[64:67], v[140:143], v[112:115], v[64:67]
    ds_read_b64_tr_b16 v[184:185], v202 offset:24576
    v_mfma_f32_16x16x32_bf16 v[68:71], v[140:143], v[116:119], v[68:71]
    ds_read_b64_tr_b16 v[186:187], v202 offset:25088
    v_mfma_f32_16x16x32_bf16 v[72:75], v[140:143], v[120:123], v[72:75]
    ds_read_b64_tr_b16 v[188:189], v203 offset:24576
    v_mfma_f32_16x16x32_bf16 v[76:79], v[140:143], v[124:127], v[76:79]
    ds_read_b64_tr_b16 v[190:191], v203 offset:25088
    v_mfma_f32_16x16x32_bf16 v[80:83], v[144:147], v[112:115], v[80:83]
    v_mfma_f32_16x16x32_bf16 v[84:87], v[144:147], v[116:119], v[84:87]
    v_mfma_f32_16x16x32_bf16 v[88:91], v[144:147], v[120:123], v[88:91]
    v_mfma_f32_16x16x32_bf16 v[92:95], v[144:147], v[124:127], v[92:95]
    v_mfma_f32_16x16x32_bf16 v[96:99], v[148:151], v[112:115], v[96:99]
    v_mfma_f32_16x16x32_bf16 v[100:103], v[148:151], v[116:119], v[100:103]
    v_mfma_f32_16x16x32_bf16 v[104:107], v[148:151], v[120:123], v[104:107]
    v_mfma_f32_16x16x32_bf16 v[108:111], v[148:151], v[124:127], v[108:111]
    s_waitcnt lgkmcnt(0)
    v_mfma_f32_16x16x32_bf16 v[16:19], v[168:171], v[152:155], v[16:19]
    s_barrier
    v_mfma_f32_16x16x32_bf16 v[20:23], v[168:171], v[156:159], v[20:23]
    ds_read_b128 v[112:115], v192 offset:0
    v_mfma_f32_16x16x32_bf16 v[24:27], v[168:171], v[160:163], v[24:27]
    ds_read_b64_tr_b16 v[128:129], v194 offset:0
    v_mfma_f32_16x16x32_bf16 v[28:31], v[168:171], v[164:167], v[28:31]
    ds_read_b64_tr_b16 v[130:131], v194 offset:512
    v_mfma_f32_16x16x32_bf16 v[32:35], v[172:175], v[152:155], v[32:35]
    ds_read_b128 v[116:119], v192 offset:2048
    v_mfma_f32_16x16x32_bf16 v[36:39], v[172:175], v[156:159], v[36:39]
    ds_read_b128 v[120:123], v192 offset:10240
    v_mfma_f32_16x16x32_bf16 v[40:43], v[172:175], v[160:163], v[40:43]
    ds_read_b128 v[124:127], v192 offset:12288
    v_mfma_f32_16x16x32_bf16 v[44:47], v[172:175], v[164:167], v[44:47]
    ds_read_b64_tr_b16 v[132:133], v195 offset:0
    v_mfma_f32_16x16x32_bf16 v[48:51], v[176:179], v[152:155], v[48:51]
    ds_read_b64_tr_b16 v[134:135], v195 offset:512
    v_mfma_f32_16x16x32_bf16 v[52:55], v[176:179], v[156:159], v[52:55]
    ds_read_b64_tr_b16 v[136:137], v194 offset:2048
    v_mfma_f32_16x16x32_bf16 v[56:59], v[176:179], v[160:163], v[56:59]
    ds_read_b64_tr_b16 v[138:139], v194 offset:2560
    v_mfma_f32_16x16x32_bf16 v[60:63], v[176:179], v[164:167], v[60:63]
    ds_read_b64_tr_b16 v[140:141], v195 offset:2048
    v_mfma_f32_16x16x32_bf16 v[64:67], v[180:183], v[152:155], v[64:67]
    ds_read_b64_tr_b16 v[142:143], v195 offset:2560
    v_mfma_f32_16x16x32_bf16 v[68:71], v[180:183], v[156:159], v[68:71]
    ds_read_b64_tr_b16 v[144:145], v194 offset:4096
    v_mfma_f32_16x16x32_bf16 v[72:75], v[180:183], v[160:163], v[72:75]
    ds_read_b64_tr_b16 v[146:147], v194 offset:4608
    v_mfma_f32_16x16x32_bf16 v[76:79], v[180:183], v[164:167], v[76:79]
    ds_read_b64_tr_b16 v[148:149], v195 offset:4096
    v_mfma_f32_16x16x32_bf16 v[80:83], v[184:187], v[152:155], v[80:83]
    ds_read_b64_tr_b16 v[150:151], v195 offset:4608
    v_mfma_f32_16x16x32_bf16 v[84:87], v[184:187], v[156:159], v[84:87]
    v_mfma_f32_16x16x32_bf16 v[88:91], v[184:187], v[160:163], v[88:91]
    v_mfma_f32_16x16x32_bf16 v[92:95], v[184:187], v[164:167], v[92:95]
    v_mfma_f32_16x16x32_bf16 v[96:99], v[188:191], v[152:155], v[96:99]
    v_mfma_f32_16x16x32_bf16 v[100:103], v[188:191], v[156:159], v[100:103]
    v_mfma_f32_16x16x32_bf16 v[104:107], v[188:191], v[160:163], v[104:107]
    v_mfma_f32_16x16x32_bf16 v[108:111], v[188:191], v[164:167], v[108:111]
    s_waitcnt lgkmcnt(0)
    v_mfma_f32_16x16x32_bf16 v[16:19], v[128:131], v[112:115], v[16:19]
    ds_read_b128 v[152:155], v193 offset:0
    v_mfma_f32_16x16x32_bf16 v[20:23], v[128:131], v[116:119], v[20:23]
    ds_read_b64_tr_b16 v[168:169], v194 offset:20480
    v_mfma_f32_16x16x32_bf16 v[24:27], v[128:131], v[120:123], v[24:27]
    ds_read_b64_tr_b16 v[170:171], v194 offset:20992
    v_mfma_f32_16x16x32_bf16 v[28:31], v[128:131], v[124:127], v[28:31]
    ds_read_b128 v[156:159], v193 offset:2048
    v_mfma_f32_16x16x32_bf16 v[32:35], v[132:135], v[112:115], v[32:35]
    ds_read_b128 v[160:163], v193 offset:10240
    v_mfma_f32_16x16x32_bf16 v[36:39], v[132:135], v[116:119], v[36:39]
    ds_read_b128 v[164:167], v193 offset:12288
    v_mfma_f32_16x16x32_bf16 v[40:43], v[132:135], v[120:123], v[40:43]
    ds_read_b64_tr_b16 v[172:173], v195 offset:20480
    v_mfma_f32_16x16x32_bf16 v[44:47], v[132:135], v[124:127], v[44:47]
    ds_read_b64_tr_b16 v[174:175], v195 offset:20992
    v_mfma_f32_16x16x32_bf16 v[48:51], v[136:139], v[112:115], v[48:51]
    ds_read_b64_tr_b16 v[176:177], v194 offset:22528
    v_mfma_f32_16x16x32_bf16 v[52:55], v[136:139], v[116:119], v[52:55]
    ds_read_b64_tr_b16 v[178:179], v194 offset:23040
    v_mfma_f32_16x16x32_bf16 v[56:59], v[136:139], v[120:123], v[56:59]
    ds_read_b64_tr_b16 v[180:181], v195 offset:22528
    v_mfma_f32_16x16x32_bf16 v[60:63], v[136:139], v[124:127], v[60:63]
    ds_read_b64_tr_b16 v[182:183], v195 offset:23040
    v_mfma_f32_16x16x32_bf16 v[64:67], v[140:143], v[112:115], v[64:67]
    ds_read_b64_tr_b16 v[184:185], v194 offset:24576
    v_mfma_f32_16x16x32_bf16 v[68:71], v[140:143], v[116:119], v[68:71]
    ds_read_b64_tr_b16 v[186:187], v194 offset:25088
    v_mfma_f32_16x16x32_bf16 v[72:75], v[140:143], v[120:123], v[72:75]
    ds_read_b64_tr_b16 v[188:189], v195 offset:24576
    v_mfma_f32_16x16x32_bf16 v[76:79], v[140:143], v[124:127], v[76:79]
    ds_read_b64_tr_b16 v[190:191], v195 offset:25088
    v_mfma_f32_16x16x32_bf16 v[80:83], v[144:147], v[112:115], v[80:83]
    v_mfma_f32_16x16x32_bf16 v[84:87], v[144:147], v[116:119], v[84:87]
    v_mfma_f32_16x16x32_bf16 v[88:91], v[144:147], v[120:123], v[88:91]
    v_mfma_f32_16x16x32_bf16 v[92:95], v[144:147], v[124:127], v[92:95]
    v_mfma_f32_16x16x32_bf16 v[96:99], v[148:151], v[112:115], v[96:99]
    s_add_u32 s68, s68, 1
    s_cmp_lt_u32 s68, 5
    v_mfma_f32_16x16x32_bf16 v[100:103], v[148:151], v[116:119], v[100:103]
    v_mfma_f32_16x16x32_bf16 v[104:107], v[148:151], v[120:123], v[104:107]
    v_mfma_f32_16x16x32_bf16 v[108:111], v[148:151], v[124:127], v[108:111]
    s_waitcnt lgkmcnt(0)
    v_mfma_f32_16x16x32_bf16 v[16:19], v[168:171], v[152:155], v[16:19]
    s_cbranch_scc0 L_cexit
    s_barrier
    v_mfma_f32_16x16x32_bf16 v[20:23], v[168:171], v[156:159], v[20:23]
    ds_read_b128 v[112:115], v196 offset:0
    v_mfma_f32_16x16x32_bf16 v[24:27], v[168:171], v[160:163], v[24:27]
    ds_read_b64_tr_b16 v[128:129], v198 offset:0
    s_branch L_cloop
L_cexit:
    v_mfma_f32_16x16x32_bf16 v[20:23], v[168:171], v[156:159], v[20:23]
    v_mfma_f32_16x16x32_bf16 v[24:27], v[168:171], v[160:163], v[24:27]
    v_mfma_f32_16x16x32_bf16 v[28:31], v[168:171], v[164:167], v[28:31]
    v_mfma_f32_16x16x32_bf16 v[32:35], v[172:175], v[152:155], v[32:35]
    v_mfma_f32_16x16x32_bf16 v[36:39], v[172:175], v[156:159], v[36:39]
    v_mfma_f32_16x16x32_bf16 v[40:43], v[172:175], v[160:163], v[40:43]
    v_mfma_f32_16x16x32_bf16 v[44:47], v[172:175], v[164:167], v[44:47]
    v_mfma_f32_16x16x32_bf16 v[48:51], v[176:179], v[152:155], v[48:51]
    v_mfma_f32_16x16x32_bf16 v[52:55], v[176:179], v[156:159], v[52:55]
    v_mfma_f32_16x16x32_bf16 v[56:59], v[176:179], v[160:163], v[56:59]
    s_barrier
    ds_read_b32 v11, v10 offset:53248
    ds_read_b64 v[222:223], v213 offset:49152
    ds_read_b64 v[224:225], v213 offset:49280
    v_mfma_f32_16x16x32_bf16 v[60:63], v[176:179], v[164:167], v[60:63]
    ds_read_b64 v[226:227], v213 offset:49408
    ds_read_b64 v[228:229], v213 offset:49536
    v_mfma_f32_16x16x32_bf16 v[64:67], v[180:183], v[152:155], v[64:67]
    ds_read_b64 v[238:239], v215 offset:50176
    ds_read_b64 v[240:241], v215 offset:50304
    v_mfma_f32_16x16x32_bf16 v[68:71], v[180:183], v[156:159], v[68:71]
    ds_read_b64 v[242:243], v215 offset:50688
    ds_read_b64 v[244:245], v215 offset:50816
    v_mfma_f32_16x16x32_bf16 v[72:75], v[180:183], v[160:163], v[72:75]
    ds_read_b64 v[246:247], v215 offset:51200
    ds_read_b64 v[248:249], v215 offset:51328
    v_mfma_f32_16x16x32_bf16 v[76:79], v[180:183], v[164:167], v[76:79]
    ds_read_b32 v250, v214 offset:49156
    ds_read_b32 v252, v214 offset:49412
    v_mfma_f32_16x16x32_bf16 v[80:83], v[184:187], v[152:155], v[80:83]
    s_waitcnt lgkmcnt(8)
    v_readfirstlane_b32 s100, v11
    v_mov_b32_e64 v230, v223
    v_cndmask_b32 v222, 0, v222, s[86:87]
    v_mfma_f32_16x16x32_bf16 v[84:87], v[184:187], v[156:159], v[84:87]
    v_mov_b32_e64 v232, v225
    v_cndmask_b32 v224, 0, v224, s[86:87]
    v_mov_b32_e64 v234, v227
    v_cndmask_b32 v226, 0, v226, s[86:87]
    v_mfma_f32_16x16x32_bf16 v[88:91], v[184:187], v[160:163], v[88:91]
    v_mov_b32_e64 v236, v229
    v_cndmask_b32 v228, 0, v228, s[86:87]
    v_mov_b32 v223, v222
    v_mov_b32 v225, v224
    v_mfma_f32_16x16x32_bf16 v[92:95], v[184:187], v[164:167], v[92:95]
    v_mov_b32 v227, v226
    v_mov_b32_e64 v229, v228
    s_waitcnt lgkmcnt(0)
    v_mul_f32 v251, 0x3fb8aa3b, v250
    v_mfma_f32_16x16x32_bf16 v[96:99], v[188:191], v[152:155], v[96:99]
    v_mul_f32 v253, 0x3fb8aa3b, v252
    v_mfma_f32_16x16x32_bf16 v[100:103], v[188:191], v[156:159], v[100:103]
    v_mfma_f32_16x16x32_bf16 v[104:107], v[188:191], v[160:163], v[104:107]
    v_mfma_f32_16x16x32_bf16 v[108:111], v[188:191], v[164:167], v[108:111]
    v_mfma_f32_16x16x16_bf16 v[48:51], v[242:243], v[222:223], v[48:51]
    v_xor_b32 v168, 0, v217
    v_xor_b32 v169, 16, v217
    v_mfma_f32_16x16x16_bf16 v[52:55], v[242:243], v[224:225], v[52:55]
    v_xor_b32 v170, 32, v217
    v_xor_b32 v171, 48, v217
    v_mfma_f32_16x16x16_bf16 v[64:67], v[244:245], v[222:223], v[64:67]
    v_xor_b32_e64 v172, 64, v217
    v_xor_b32 v173, 80, v217
    v_mfma_f32_16x16x16_bf16 v[68:71], v[244:245], v[224:225], v[68:71]
    v_xor_b32 v174, 96, v217
    v_xor_b32 v175, 112, v217
    v_mfma_f32_16x16x16_bf16 v[56:59], v[242:243], v[226:227], v[56:59]
    v_xor_b32_e64 v4, 32, v216
    v_mfma_f32_16x16x16_bf16 v[60:63], v[242:243], v[228:229], v[60:63]
    v_mfma_f32_16x16x16_bf16 v[72:75], v[244:245], v[226:227], v[72:75]
    v_mfma_f32_16x16x16_bf16 v[76:79], v[244:245], v[228:229], v[76:79]
    v_mfma_f32_16x16x16_bf16 v[80:83], v[246:247], v[222:223], v[80:83]
    v_cvt_pk_bf16_f32 v112, v48, v49
    v_cvt_pk_bf16_f32 v113, v50, v51
    v_mfma_f32_16x16x16_bf16 v[84:87], v[246:247], v[224:225], v[84:87]
    v_cvt_pk_bf16_f32 v114, v52, v53
    v_cvt_pk_bf16_f32 v115, v54, v55
    v_mfma_f32_16x16x16_bf16 v[88:91], v[246:247], v[226:227], v[88:91]
    v_cvt_pk_bf16_f32 v116, v64, v65
    v_cvt_pk_bf16_f32 v117, v66, v67
    v_mfma_f32_16x16x16_bf16 v[92:95], v[246:247], v[228:229], v[92:95]
    v_cvt_pk_bf16_f32 v118, v68, v69
    v_cvt_pk_bf16_f32 v119, v70, v71
    v_mfma_f32_16x16x16_bf16 v[96:99], v[248:249], v[222:223], v[96:99]
    v_cvt_pk_bf16_f32 v120, v56, v57
    v_cvt_pk_bf16_f32 v121, v58, v59
    v_mfma_f32_16x16x16_bf16 v[100:103], v[248:249], v[224:225], v[100:103]
    v_cvt_pk_bf16_f32 v122, v60, v61
    v_cvt_pk_bf16_f32 v123, v62, v63
    v_mfma_f32_16x16x16_bf16 v[104:107], v[248:249], v[226:227], v[104:107]
    v_permlane16_swap_b32 v112, v114
    v_permlane16_swap_b32 v113, v115
    v_mfma_f32_16x16x16_bf16 v[108:111], v[248:249], v[228:229], v[108:111]
    v_permlane16_swap_b32 v116, v118
    v_permlane16_swap_b32 v117, v119
    v_cvt_pk_bf16_f32 v124, v72, v73
    v_cvt_pk_bf16_f32 v125, v74, v75
    v_cvt_pk_bf16_f32 v126, v76, v77
    v_cvt_pk_bf16_f32 v127, v78, v79
    v_permlane16_swap_b32 v120, v122
    v_permlane16_swap_b32 v121, v123
    v_permlane16_swap_b32 v124, v126
    v_permlane16_swap_b32 v125, v127
    v_mfma_f32_32x32x16_bf16 v[48:63], v[204:207], v[112:115], 0
    v_mul_f32 v80, v80, v230
    v_mul_f32 v81, v81, v230
    v_mul_f32 v82, v82, v230
    v_mul_f32 v83, v83, v230
    v_cvt_pk_bf16_f32 v80, v80, v81
    v_cvt_pk_bf16_f32 v81, v82, v83
    v_mfma_f32_32x32x16_bf16 v[64:79], v[204:207], v[120:123], 0
    v_mul_f32 v96, v96, v230
    v_mul_f32 v97, v97, v230
    v_mul_f32 v98, v98, v230
    v_mul_f32 v99, v99, v230
    v_cvt_pk_bf16_f32 v96, v96, v97
    v_cvt_pk_bf16_f32 v97, v98, v99
    v_mfma_f32_32x32x16_bf16 v[48:63], v[208:211], v[116:119], v[48:63]
    v_mul_f32 v84, v84, v232
    v_mul_f32 v85, v85, v232
    v_mul_f32 v86, v86, v232
    v_mul_f32 v87, v87, v232
    v_cvt_pk_bf16_f32 v84, v84, v85
    v_cvt_pk_bf16_f32 v85, v86, v87
    v_mfma_f32_32x32x16_bf16 v[64:79], v[208:211], v[124:127], v[64:79]
    v_mul_f32 v100, v100, v232
    v_mul_f32 v101, v101, v232
    v_mul_f32 v102, v102, v232
    v_mul_f32 v103, v103, v232
    v_cvt_pk_bf16_f32 v100, v100, v101
    v_cvt_pk_bf16_f32 v101, v102, v103
    v_mul_f32 v88, v88, v234
    v_mul_f32 v89, v89, v234
    v_mul_f32 v90, v90, v234
    v_mul_f32 v91, v91, v234
    v_cvt_pk_bf16_f32 v88, v88, v89
    v_cvt_pk_bf16_f32 v89, v90, v91
    v_mul_f32 v104, v104, v234
    v_mul_f32 v105, v105, v234
    v_mul_f32 v106, v106, v234
    v_mul_f32 v107, v107, v234
    v_cvt_pk_bf16_f32 v104, v104, v105
    v_cvt_pk_bf16_f32 v105, v106, v107
    v_mul_f32 v92, v92, v236
    v_mul_f32 v93, v93, v236
    v_mul_f32 v94, v94, v236
    v_mul_f32 v95, v95, v236
    v_cvt_pk_bf16_f32 v92, v92, v93
    v_cvt_pk_bf16_f32 v93, v94, v95
    v_mul_f32 v108, v108, v236
    v_mul_f32 v109, v109, v236
    v_mul_f32 v110, v110, v236
    v_mul_f32 v111, v111, v236
    v_cvt_pk_bf16_f32 v108, v108, v109
    v_cvt_pk_bf16_f32 v109, v110, v111
    v_max3_f32 v160, v48, v49, v50
    v_min3_f32 v162, v48, v49, v50
    v_max3_f32 v160, v160, v51, v52
    v_min3_f32 v162, v162, v51, v52
    v_max3_f32 v160, v160, v53, v54
    v_min3_f32 v162, v162, v53, v54
    v_max3_f32 v160, v160, v55, v56
    v_min3_f32 v162, v162, v55, v56
    v_max3_f32 v160, v160, v57, v58
    v_min3_f32 v162, v162, v57, v58
    v_max3_f32 v160, v160, v59, v60
    v_min3_f32 v162, v162, v59, v60
    v_max3_f32 v160, v160, v61, v62
    v_min3_f32 v162, v162, v61, v62
    v_max_f32 v160, v160, v63
    v_min_f32 v162, v162, v63
    v_max3_f32 v164, v64, v65, v66
    v_min3_f32 v166, v64, v65, v66
    v_max3_f32 v164, v164, v67, v68
    v_min3_f32 v166, v166, v67, v68
    v_max3_f32 v164, v164, v69, v70
    v_min3_f32 v166, v166, v69, v70
    v_max3_f32 v164, v164, v71, v72
    v_min3_f32 v166, v166, v71, v72
    v_max3_f32 v164, v164, v73, v74
    v_min3_f32 v166, v166, v73, v74
    v_max3_f32 v164, v164, v75, v76
    v_min3_f32 v166, v166, v75, v76
    v_max3_f32 v164, v164, v77, v78
    v_min3_f32 v166, v166, v77, v78
    v_max_f32 v164, v164, v79
    v_min_f32 v166, v166, v79
    v_mov_b32 v161, v160
    v_mov_b32 v163, v162
    v_mov_b32 v165, v164
    v_mov_b32 v167, v166
    v_permlane32_swap_b32 v160, v161
    v_permlane32_swap_b32 v162, v163
    v_permlane32_swap_b32 v164, v165
    v_permlane32_swap_b32 v166, v167
    v_max_f32 v160, v160, v161
    v_min_f32 v162, v162, v163
    v_max_f32 v164, v164, v165
    v_min_f32 v166, v166, v167
    v_mul_f32 v160, v160, v251
    v_mul_f32 v162, v162, v251
    v_mul_f32 v164, v164, v253
    v_mul_f32 v166, v166, v253
    v_pk_fma_f32 v[128:129], v[48:49], v[250:251], v[160:161] op_sel:[0,1,0] op_sel_hi:[1,1,0] neg_lo:[0,0,1] neg_hi:[0,0,1]
    v_pk_fma_f32 v[48:49], v[48:49], v[250:251], v[162:163] op_sel:[0,1,0] op_sel_hi:[1,1,0] neg_lo:[0,1,0] neg_hi:[0,1,0]
    v_pk_fma_f32 v[130:131], v[50:51], v[250:251], v[160:161] op_sel:[0,1,0] op_sel_hi:[1,1,0] neg_lo:[0,0,1] neg_hi:[0,0,1]
    v_pk_fma_f32 v[50:51], v[50:51], v[250:251], v[162:163] op_sel:[0,1,0] op_sel_hi:[1,1,0] neg_lo:[0,1,0] neg_hi:[0,1,0]
    v_pk_fma_f32 v[132:133], v[52:53], v[250:251], v[160:161] op_sel:[0,1,0] op_sel_hi:[1,1,0] neg_lo:[0,0,1] neg_hi:[0,0,1]
    v_pk_fma_f32 v[52:53], v[52:53], v[250:251], v[162:163] op_sel:[0,1,0] op_sel_hi:[1,1,0] neg_lo:[0,1,0] neg_hi:[0,1,0]
    v_pk_fma_f32 v[134:135], v[54:55], v[250:251], v[160:161] op_sel:[0,1,0] op_sel_hi:[1,1,0] neg_lo:[0,0,1] neg_hi:[0,0,1]
    v_pk_fma_f32 v[54:55], v[54:55], v[250:251], v[162:163] op_sel:[0,1,0] op_sel_hi:[1,1,0] neg_lo:[0,1,0] neg_hi:[0,1,0]
    v_pk_fma_f32 v[136:137], v[56:57], v[250:251], v[160:161] op_sel:[0,1,0] op_sel_hi:[1,1,0] neg_lo:[0,0,1] neg_hi:[0,0,1]
    v_pk_fma_f32 v[56:57], v[56:57], v[250:251], v[162:163] op_sel:[0,1,0] op_sel_hi:[1,1,0] neg_lo:[0,1,0] neg_hi:[0,1,0]
    v_pk_fma_f32 v[138:139], v[58:59], v[250:251], v[160:161] op_sel:[0,1,0] op_sel_hi:[1,1,0] neg_lo:[0,0,1] neg_hi:[0,0,1]
    v_pk_fma_f32 v[58:59], v[58:59], v[250:251], v[162:163] op_sel:[0,1,0] op_sel_hi:[1,1,0] neg_lo:[0,1,0] neg_hi:[0,1,0]
    v_pk_fma_f32 v[140:141], v[60:61], v[250:251], v[160:161] op_sel:[0,1,0] op_sel_hi:[1,1,0] neg_lo:[0,0,1] neg_hi:[0,0,1]
    v_pk_fma_f32 v[60:61], v[60:61], v[250:251], v[162:163] op_sel:[0,1,0] op_sel_hi:[1,1,0] neg_lo:[0,1,0] neg_hi:[0,1,0]
    v_pk_fma_f32 v[142:143], v[62:63], v[250:251], v[160:161] op_sel:[0,1,0] op_sel_hi:[1,1,0] neg_lo:[0,0,1] neg_hi:[0,0,1]
    v_pk_fma_f32 v[62:63], v[62:63], v[250:251], v[162:163] op_sel:[0,1,0] op_sel_hi:[1,1,0] neg_lo:[0,1,0] neg_hi:[0,1,0]
    v_pk_fma_f32 v[144:145], v[64:65], v[252:253], v[164:165] op_sel:[0,1,0] op_sel_hi:[1,1,0] neg_lo:[0,0,1] neg_hi:[0,0,1]
    v_pk_fma_f32 v[64:65], v[64:65], v[252:253], v[166:167] op_sel:[0,1,0] op_sel_hi:[1,1,0] neg_lo:[0,1,0] neg_hi:[0,1,0]
    v_pk_fma_f32 v[146:147], v[66:67], v[252:253], v[164:165] op_sel:[0,1,0] op_sel_hi:[1,1,0] neg_lo:[0,0,1] neg_hi:[0,0,1]
    v_pk_fma_f32 v[66:67], v[66:67], v[252:253], v[166:167] op_sel:[0,1,0] op_sel_hi:[1,1,0] neg_lo:[0,1,0] neg_hi:[0,1,0]
    v_pk_fma_f32 v[148:149], v[68:69], v[252:253], v[164:165] op_sel:[0,1,0] op_sel_hi:[1,1,0] neg_lo:[0,0,1] neg_hi:[0,0,1]
    v_pk_fma_f32 v[68:69], v[68:69], v[252:253], v[166:167] op_sel:[0,1,0] op_sel_hi:[1,1,0] neg_lo:[0,1,0] neg_hi:[0,1,0]
    v_pk_fma_f32 v[150:151], v[70:71], v[252:253], v[164:165] op_sel:[0,1,0] op_sel_hi:[1,1,0] neg_lo:[0,0,1] neg_hi:[0,0,1]
    v_pk_fma_f32 v[70:71], v[70:71], v[252:253], v[166:167] op_sel:[0,1,0] op_sel_hi:[1,1,0] neg_lo:[0,1,0] neg_hi:[0,1,0]
    v_pk_fma_f32 v[152:153], v[72:73], v[252:253], v[164:165] op_sel:[0,1,0] op_sel_hi:[1,1,0] neg_lo:[0,0,1] neg_hi:[0,0,1]
    v_pk_fma_f32 v[72:73], v[72:73], v[252:253], v[166:167] op_sel:[0,1,0] op_sel_hi:[1,1,0] neg_lo:[0,1,0] neg_hi:[0,1,0]
    v_pk_fma_f32 v[154:155], v[74:75], v[252:253], v[164:165] op_sel:[0,1,0] op_sel_hi:[1,1,0] neg_lo:[0,0,1] neg_hi:[0,0,1]
    v_pk_fma_f32 v[74:75], v[74:75], v[252:253], v[166:167] op_sel:[0,1,0] op_sel_hi:[1,1,0] neg_lo:[0,1,0] neg_hi:[0,1,0]
    v_pk_fma_f32 v[156:157], v[76:77], v[252:253], v[164:165] op_sel:[0,1,0] op_sel_hi:[1,1,0] neg_lo:[0,0,1] neg_hi:[0,0,1]
    v_pk_fma_f32 v[76:77], v[76:77], v[252:253], v[166:167] op_sel:[0,1,0] op_sel_hi:[1,1,0] neg_lo:[0,1,0] neg_hi:[0,1,0]
    v_pk_fma_f32 v[158:159], v[78:79], v[252:253], v[164:165] op_sel:[0,1,0] op_sel_hi:[1,1,0] neg_lo:[0,0,1] neg_hi:[0,0,1]
    v_pk_fma_f32 v[78:79], v[78:79], v[252:253], v[166:167] op_sel:[0,1,0] op_sel_hi:[1,1,0] neg_lo:[0,1,0] neg_hi:[0,1,0]
    v_exp_f32_e64 v128, v128
    v_mfma_f32_16x16x16_bf16 v[16:19], v[238:239], v[222:223], v[16:19]
    v_exp_f32 v144, v144
    v_exp_f32 v129, v129
    v_exp_f32_e64 v145, v145
    v_mfma_f32_16x16x16_bf16 v[20:23], v[238:239], v[224:225], v[20:23]
    ds_write2st64_b64 v216, v[80:81], v[84:85] offset0:64 offset1:68
    v_exp_f32 v130, v130
    v_exp_f32 v146, v146
    v_exp_f32_e64 v131, v131
    v_mfma_f32_16x16x16_bf16 v[24:27], v[238:239], v[226:227], v[24:27]
    v_exp_f32 v147, v147
    v_exp_f32 v132, v132
    v_exp_f32_e64 v148, v148
    v_mfma_f32_16x16x16_bf16 v[28:31], v[238:239], v[228:229], v[28:31]
    ds_write2st64_b64 v4, v[96:97], v[100:101] offset0:64 offset1:68
    v_exp_f32 v133, v133
    v_exp_f32 v149, v149
    v_exp_f32_e64 v134, v134
    v_mfma_f32_16x16x16_bf16 v[32:35], v[240:241], v[222:223], v[32:35]
    v_exp_f32 v150, v150
    v_exp_f32 v135, v135
    v_exp_f32_e64 v151, v151
    v_mfma_f32_16x16x16_bf16 v[36:39], v[240:241], v[224:225], v[36:39]
    ds_write2st64_b64 v216, v[88:89], v[92:93] offset0:72 offset1:76
    v_exp_f32 v136, v136
    v_exp_f32 v152, v152
    v_exp_f32_e64 v137, v137
    v_mfma_f32_16x16x16_bf16 v[40:43], v[240:241], v[226:227], v[40:43]
    v_exp_f32 v153, v153
    v_exp_f32 v138, v138
    v_exp_f32_e64 v154, v154
    v_mfma_f32_16x16x16_bf16 v[44:47], v[240:241], v[228:229], v[44:47]
    ds_write2st64_b64 v4, v[104:105], v[108:109] offset0:72 offset1:76
    v_exp_f32 v139, v139
    v_exp_f32 v155, v155
    v_exp_f32 v140, v140
    v_exp_f32 v156, v156
    v_exp_f32 v141, v141
    v_exp_f32 v157, v157
    v_exp_f32 v142, v142
    v_exp_f32 v158, v158
    v_exp_f32 v143, v143
    v_exp_f32 v159, v159
    v_pk_add_f32 v[176:177], v[128:129], v[130:131]
    v_pk_add_f32 v[178:179], v[144:145], v[146:147]
    v_pk_add_f32 v[176:177], v[176:177], v[132:133]
    v_pk_add_f32 v[178:179], v[178:179], v[148:149]
    v_pk_add_f32 v[176:177], v[176:177], v[134:135]
    v_pk_add_f32 v[178:179], v[178:179], v[150:151]
    v_pk_add_f32 v[176:177], v[176:177], v[136:137]
    v_pk_add_f32 v[178:179], v[178:179], v[152:153]
    v_pk_add_f32 v[176:177], v[176:177], v[138:139]
    v_pk_add_f32 v[178:179], v[178:179], v[154:155]
    v_pk_add_f32 v[176:177], v[176:177], v[140:141]
    v_pk_add_f32 v[178:179], v[178:179], v[156:157]
    v_pk_add_f32 v[176:177], v[176:177], v[142:143]
    v_pk_add_f32 v[178:179], v[178:179], v[158:159]
    v_exp_f32 v48, v48
    v_add_f32 v176, v176, v177
    v_add_f32 v178, v178, v179
    v_exp_f32 v64, v64
    v_mov_b32 v177, v176
    v_mov_b32 v179, v178
    v_exp_f32 v49, v49
    v_permlane32_swap_b32 v176, v177
    v_permlane32_swap_b32 v178, v179
    v_exp_f32 v65, v65
    v_add_f32 v176, v176, v177
    v_add_f32 v178, v178, v179
    v_exp_f32 v50, v50
    v_rcp_f32 v176, v176
    v_rcp_f32 v178, v178
    v_exp_f32 v66, v66
    v_exp_f32 v51, v51
    v_exp_f32 v67, v67
    v_exp_f32 v52, v52
    v_exp_f32 v68, v68
    v_exp_f32 v53, v53
    v_exp_f32 v69, v69
    v_exp_f32 v54, v54
    v_exp_f32 v70, v70
    v_exp_f32 v55, v55
    v_exp_f32 v71, v71
    v_exp_f32 v56, v56
    v_exp_f32 v72, v72
    v_exp_f32 v57, v57
    v_exp_f32 v73, v73
    v_exp_f32 v58, v58
    v_exp_f32 v74, v74
    v_exp_f32 v59, v59
    v_exp_f32 v75, v75
    v_exp_f32 v60, v60
    v_exp_f32 v76, v76
    v_exp_f32 v61, v61
    v_exp_f32 v77, v77
    v_exp_f32 v62, v62
    v_exp_f32 v78, v78
    v_exp_f32 v63, v63
    v_exp_f32 v79, v79
    v_pk_add_f32 v[180:181], v[48:49], v[50:51]
    v_pk_add_f32 v[182:183], v[64:65], v[66:67]
    v_pk_add_f32 v[180:181], v[180:181], v[52:53]
    v_pk_add_f32 v[182:183], v[182:183], v[68:69]
    v_pk_add_f32 v[180:181], v[180:181], v[54:55]
    v_pk_add_f32 v[182:183], v[182:183], v[70:71]
    v_pk_add_f32 v[180:181], v[180:181], v[56:57]
    v_pk_add_f32 v[182:183], v[182:183], v[72:73]
    v_pk_add_f32 v[180:181], v[180:181], v[58:59]
    v_pk_add_f32 v[182:183], v[182:183], v[74:75]
    v_pk_add_f32 v[180:181], v[180:181], v[60:61]
    v_pk_add_f32 v[182:183], v[182:183], v[76:77]
    v_pk_add_f32 v[180:181], v[180:181], v[62:63]
    v_pk_add_f32 v[182:183], v[182:183], v[78:79]
    v_add_f32 v180, v180, v181
    v_add_f32 v182, v182, v183
    v_mov_b32 v181, v180
    v_mov_b32 v183, v182
    v_pk_mul_f32 v[128:129], v[128:129], v[176:177] op_sel_hi:[1,0]
    v_pk_mul_f32 v[130:131], v[130:131], v[176:177] op_sel_hi:[1,0]
    v_cvt_pk_bf16_f32 v128, v128, v129
    v_permlane32_swap_b32 v180, v181
    v_permlane32_swap_b32 v182, v183
    v_cvt_pk_bf16_f32 v129, v130, v131
    v_pk_mul_f32 v[144:145], v[144:145], v[178:179] op_sel_hi:[1,0]
    v_pk_mul_f32 v[146:147], v[146:147], v[178:179] op_sel_hi:[1,0]
    v_cvt_pk_bf16_f32 v144, v144, v145
    v_cvt_pk_bf16_f32 v145, v146, v147
    v_add_f32 v180, v180, v181
    v_add_f32 v182, v182, v183
    ds_write2st64_b64 v168, v[128:129], v[144:145] offset0:0 offset1:8
    v_pk_mul_f32 v[132:133], v[132:133], v[176:177] op_sel_hi:[1,0]
    v_pk_mul_f32 v[134:135], v[134:135], v[176:177] op_sel_hi:[1,0]
    v_cvt_pk_bf16_f32 v132, v132, v133
    v_cvt_pk_bf16_f32 v133, v134, v135
    v_pk_mul_f32 v[148:149], v[148:149], v[178:179] op_sel_hi:[1,0]
    v_rcp_f32 v180, v180
    v_rcp_f32 v182, v182
    v_pk_mul_f32 v[150:151], v[150:151], v[178:179] op_sel_hi:[1,0]
    v_cvt_pk_bf16_f32 v148, v148, v149
    v_cvt_pk_bf16_f32 v149, v150, v151
    ds_write2st64_b64 v169, v[132:133], v[148:149] offset0:0 offset1:8
    v_pk_mul_f32 v[136:137], v[136:137], v[176:177] op_sel_hi:[1,0]
    v_pk_mul_f32 v[138:139], v[138:139], v[176:177] op_sel_hi:[1,0]
    v_cvt_pk_bf16_f32 v136, v136, v137
    v_cvt_pk_bf16_f32 v137, v138, v139
    v_pk_mul_f32 v[152:153], v[152:153], v[178:179] op_sel_hi:[1,0]
    v_pk_mul_f32 v[154:155], v[154:155], v[178:179] op_sel_hi:[1,0]
    v_cvt_pk_bf16_f32 v152, v152, v153
    v_cvt_pk_bf16_f32 v153, v154, v155
    ds_write2st64_b64 v170, v[136:137], v[152:153] offset0:0 offset1:8
    v_pk_mul_f32 v[140:141], v[140:141], v[176:177] op_sel_hi:[1,0]
    v_pk_mul_f32 v[142:143], v[142:143], v[176:177] op_sel_hi:[1,0]
    v_cvt_pk_bf16_f32 v140, v140, v141
    v_cvt_pk_bf16_f32 v141, v142, v143
    v_pk_mul_f32 v[156:157], v[156:157], v[178:179] op_sel_hi:[1,0]
    v_pk_mul_f32 v[158:159], v[158:159], v[178:179] op_sel_hi:[1,0]
    v_cvt_pk_bf16_f32 v156, v156, v157
    v_cvt_pk_bf16_f32 v157, v158, v159
    ds_write2st64_b64 v171, v[140:141], v[156:157] offset0:0 offset1:8
    v_pk_mul_f32 v[48:49], v[48:49], v[180:181] op_sel_hi:[1,0]
    v_pk_mul_f32 v[50:51], v[50:51], v[180:181] op_sel_hi:[1,0]
    v_cvt_pk_bf16_f32 v48, v48, v49
    v_cvt_pk_bf16_f32 v49, v50, v51
    v_pk_mul_f32 v[64:65], v[64:65], v[182:183] op_sel_hi:[1,0]
    v_pk_mul_f32 v[66:67], v[66:67], v[182:183] op_sel_hi:[1,0]
    v_cvt_pk_bf16_f32 v64, v64, v65
    v_cvt_pk_bf16_f32 v65, v66, v67
    ds_write2st64_b64 v172, v[48:49], v[64:65] offset0:0 offset1:8
    v_pk_mul_f32 v[52:53], v[52:53], v[180:181] op_sel_hi:[1,0]
    v_pk_mul_f32 v[54:55], v[54:55], v[180:181] op_sel_hi:[1,0]
    v_cvt_pk_bf16_f32 v52, v52, v53
    v_cvt_pk_bf16_f32 v53, v54, v55
    v_pk_mul_f32 v[68:69], v[68:69], v[182:183] op_sel_hi:[1,0]
    v_pk_mul_f32 v[70:71], v[70:71], v[182:183] op_sel_hi:[1,0]
    v_cvt_pk_bf16_f32 v68, v68, v69
    v_cvt_pk_bf16_f32 v69, v70, v71
    ds_write2st64_b64 v173, v[52:53], v[68:69] offset0:0 offset1:8
    v_pk_mul_f32 v[56:57], v[56:57], v[180:181] op_sel_hi:[1,0]
    v_pk_mul_f32 v[58:59], v[58:59], v[180:181] op_sel_hi:[1,0]
    v_cvt_pk_bf16_f32 v56, v56, v57
    v_cvt_pk_bf16_f32 v57, v58, v59
    v_pk_mul_f32 v[72:73], v[72:73], v[182:183] op_sel_hi:[1,0]
    v_pk_mul_f32 v[74:75], v[74:75], v[182:183] op_sel_hi:[1,0]
    v_cvt_pk_bf16_f32 v72, v72, v73
    v_cvt_pk_bf16_f32 v73, v74, v75
    ds_write2st64_b64 v174, v[56:57], v[72:73] offset0:0 offset1:8
    v_pk_mul_f32 v[60:61], v[60:61], v[180:181] op_sel_hi:[1,0]
    v_pk_mul_f32 v[62:63], v[62:63], v[180:181] op_sel_hi:[1,0]
    v_cvt_pk_bf16_f32 v60, v60, v61
    v_cvt_pk_bf16_f32 v61, v62, v63
    v_pk_mul_f32 v[76:77], v[76:77], v[182:183] op_sel_hi:[1,0]
    v_pk_mul_f32 v[78:79], v[78:79], v[182:183] op_sel_hi:[1,0]
    v_cvt_pk_bf16_f32 v76, v76, v77
    v_cvt_pk_bf16_f32 v77, v78, v79
    ds_write2st64_b64 v175, v[60:61], v[76:77] offset0:0 offset1:8
    s_waitcnt lgkmcnt(0)
    s_barrier
    ds_read_b64_tr_b16 v[112:113], v218 offset:0
    ds_read_b64_tr_b16 v[114:115], v219 offset:0
    ds_read_b64_tr_b16 v[144:145], v220 offset:32768
    ds_read_b64_tr_b16 v[146:147], v221 offset:32768
    ds_read_b64_tr_b16 v[116:117], v218 offset:2048
    ds_read_b64_tr_b16 v[118:119], v219 offset:2048
    ds_read_b64_tr_b16 v[148:149], v220 offset:34816
    ds_read_b64_tr_b16 v[150:151], v221 offset:34816
    ds_read_b64_tr_b16 v[120:121], v218 offset:4096
    ds_read_b64_tr_b16 v[122:123], v219 offset:4096
    ds_read_b64_tr_b16 v[152:153], v220 offset:36864
    ds_read_b64_tr_b16 v[154:155], v221 offset:36864
    v_cvt_pk_bf16_f32 v176, v16, v17
    v_cvt_pk_bf16_f32 v177, v18, v19
    v_cvt_pk_bf16_f32 v178, v20, v21
    v_cvt_pk_bf16_f32 v179, v22, v23
    v_cvt_pk_bf16_f32 v180, v32, v33
    v_cvt_pk_bf16_f32 v181, v34, v35
    v_cvt_pk_bf16_f32 v182, v36, v37
    v_cvt_pk_bf16_f32 v183, v38, v39
    v_cvt_pk_bf16_f32 v184, v24, v25
    v_cvt_pk_bf16_f32 v185, v26, v27
    v_cvt_pk_bf16_f32 v186, v28, v29
    v_cvt_pk_bf16_f32 v187, v30, v31
    v_cvt_pk_bf16_f32 v188, v40, v41
    v_cvt_pk_bf16_f32 v189, v42, v43
    v_cvt_pk_bf16_f32 v190, v44, v45
    v_cvt_pk_bf16_f32 v191, v46, v47
    s_waitcnt lgkmcnt(8)
    v_mfma_f32_32x32x16_bf16 v[48:63], v[112:115], v[144:147], 0
    ds_read_b64_tr_b16 v[124:125], v218 offset:6144
    ds_read_b64_tr_b16 v[126:127], v219 offset:6144
    ds_read_b64_tr_b16 v[156:157], v220 offset:38912
    ds_read_b64_tr_b16 v[158:159], v221 offset:38912
    s_waitcnt lgkmcnt(8)
    v_mfma_f32_32x32x16_bf16 v[48:63], v[116:119], v[148:151], v[48:63]
    ds_read_b64_tr_b16 v[128:129], v218 offset:8192
    ds_read_b64_tr_b16 v[130:131], v219 offset:8192
    ds_read_b64_tr_b16 v[160:161], v220 offset:40960
    ds_read_b64_tr_b16 v[162:163], v221 offset:40960
    s_waitcnt lgkmcnt(8)
    v_mfma_f32_32x32x16_bf16 v[48:63], v[120:123], v[152:155], v[48:63]
    ds_read_b64_tr_b16 v[132:133], v218 offset:10240
    ds_read_b64_tr_b16 v[134:135], v219 offset:10240
    ds_read_b64_tr_b16 v[164:165], v220 offset:43008
    ds_read_b64_tr_b16 v[166:167], v221 offset:43008
    s_waitcnt lgkmcnt(8)
    v_mfma_f32_32x32x16_bf16 v[48:63], v[124:127], v[156:159], v[48:63]
    ds_read_b64_tr_b16 v[136:137], v218 offset:12288
    ds_read_b64_tr_b16 v[138:139], v219 offset:12288
    ds_read_b64_tr_b16 v[168:169], v220 offset:45056
    ds_read_b64_tr_b16 v[170:171], v221 offset:45056
    s_waitcnt lgkmcnt(8)
    v_mfma_f32_32x32x16_bf16 v[48:63], v[128:131], v[160:163], v[48:63]
    ds_read_b64_tr_b16 v[140:141], v218 offset:14336
    ds_read_b64_tr_b16 v[142:143], v219 offset:14336
    ds_read_b64_tr_b16 v[172:173], v220 offset:47104
    ds_read_b64_tr_b16 v[174:175], v221 offset:47104
    s_waitcnt lgkmcnt(8)
    v_mfma_f32_32x32x16_bf16 v[48:63], v[132:135], v[164:167], v[48:63]
    v_permlane16_swap_b32 v176, v178
    v_permlane16_swap_b32_e64 v177, v179
    s_waitcnt lgkmcnt(4)
    v_mfma_f32_32x32x16_bf16 v[48:63], v[136:139], v[168:171], v[48:63]
    v_permlane16_swap_b32 v180, v182
    v_permlane16_swap_b32 v181, v183
    v_permlane16_swap_b32 v184, v186
    s_waitcnt lgkmcnt(0)
    v_mfma_f32_32x32x16_bf16 v[48:63], v[140:143], v[172:175], v[48:63]
    s_barrier
    v_permlane16_swap_b32 v185, v187
    v_permlane16_swap_b32 v188, v190
    v_permlane16_swap_b32 v189, v191
    s_lshl_b32 s76, s62, 11
    s_add_u32 s76, s76, s99
    v_mfma_f32_32x32x16_bf16 v[16:31], v[204:207], v[176:179], 0
    s_add_u32 s76, s76, 1024
    s_lshl_b32 s77, s62, 7
    s_add_u32 s77, s77, s73
    v_lshlrev_b32_e64 v4, 2, v2
    v_mfma_f32_32x32x16_bf16 v[32:47], v[204:207], v[184:187], 0
    v_cvt_pk_bf16_f32 v64, v48, v49
    v_cvt_pk_bf16_f32 v65, v50, v51
    v_cvt_pk_bf16_f32 v66, v52, v53
    v_cvt_pk_bf16_f32 v67, v54, v55
    v_cvt_pk_bf16_f32 v68, v56, v57
    v_mfma_f32_32x32x16_bf16 v[16:31], v[208:211], v[180:183], v[16:31]
    v_cvt_pk_bf16_f32 v69, v58, v59
    v_cvt_pk_bf16_f32 v70, v60, v61
    v_cvt_pk_bf16_f32 v71, v62, v63
    s_bitcmp1_b32 s100, 0
    s_cbranch_scc1 L_loc_56
    buffer_store_dwordx4 v[64:67], v12, s[40:43], s76 offen offset:0 sc1
    buffer_store_dwordx4 v[68:71], v12, s[40:43], s76 offen offset:1024 sc1
    s_branch L_pubd_57
L_loc_56:
    buffer_store_dwordx4 v[64:67], v12, s[40:43], s76 offen offset:0
    buffer_store_dwordx4 v[68:71], v12, s[40:43], s76 offen offset:1024
L_pubd_57:
    v_mfma_f32_32x32x16_bf16 v[32:47], v[208:211], v[188:191], v[32:47]
    v_and_b32 v216, 1, v1
    v_lshlrev_b32_e64 v216, 8, v216
    v_lshl_add_u32 v216, v3, 4, v216
    s_lshl_b32 s76, s64, 7
    v_add_u32 v216, s76, v216
    s_mul_i32 s78, s61, 28800
    s_lshl_b32 s79, s64, 8
    s_add_u32 s78, s78, s79
    s_add_u32 s79, s78, 3686400
    v_dot2_f32_bf16 v72, v112, s89, 0
    v_dot2_f32_bf16 v73, v113, s89, 0
    v_dot2_f32_bf16 v72, v114, s89, v72
    v_dot2_f32_bf16 v73, v115, s89, v73
    v_dot2_f32_bf16 v72, v116, s89, v72
    v_dot2_f32_bf16 v73, v117, s89, v73
    v_dot2_f32_bf16 v72, v118, s89, v72
    v_dot2_f32_bf16 v73, v119, s89, v73
    v_dot2_f32_bf16 v72, v120, s89, v72
    v_dot2_f32_bf16 v73, v121, s89, v73
    v_dot2_f32_bf16 v72, v122, s89, v72
    v_dot2_f32_bf16 v73, v123, s89, v73
    v_dot2_f32_bf16 v72, v124, s89, v72
    v_dot2_f32_bf16 v73, v125, s89, v73
    v_dot2_f32_bf16 v72, v126, s89, v72
    v_dot2_f32_bf16 v73, v127, s89, v73
    v_dot2_f32_bf16 v72, v128, s89, v72
    v_dot2_f32_bf16 v73, v129, s89, v73
    v_dot2_f32_bf16 v72, v130, s89, v72
    v_dot2_f32_bf16 v73, v131, s89, v73
    v_dot2_f32_bf16 v72, v132, s89, v72
    v_dot2_f32_bf16 v73, v133, s89, v73
    v_dot2_f32_bf16 v72, v134, s89, v72
    v_dot2_f32_bf16 v73, v135, s89, v73
    v_dot2_f32_bf16 v72, v136, s89, v72
    v_dot2_f32_bf16 v73, v137, s89, v73
    v_dot2_f32_bf16 v72, v138, s89, v72
    v_dot2_f32_bf16 v73, v139, s89, v73
    v_dot2_f32_bf16 v72, v140, s89, v72
    v_dot2_f32_bf16 v73, v141, s89, v73
    v_dot2_f32_bf16 v72, v142, s89, v72
    v_dot2_f32_bf16 v73, v143, s89, v73
    s_lshl_b32 s76, s98, 7
    v_lshl_add_u32 v10, v3, 3, s76
    v_lshlrev_b32 v11, 5, v1
    v_add_f32 v72, v72, v73
    v_mov_b32 v73, v72
    s_nop 1
    v_permlane32_swap_b32 v72, v73
    v_add_f32 v72, v72, v73
    s_mov_b32 exec_hi, 0
    s_bitcmp1_b32 s100, 0
    s_cbranch_scc1 L_loc_58
    buffer_store_dword v72, v4, s[40:43], s77 offen offset:2048 sc1
    s_branch L_pubd_59
L_loc_58:
    buffer_store_dword v72, v4, s[40:43], s77 offen offset:2048
L_pubd_59:
    s_mov_b64 exec, -1
    v_max3_f32 v160, v16, v17, v18
    v_min3_f32 v162, v16, v17, v18
    v_max3_f32 v160, v160, v19, v20
    v_min3_f32 v162, v162, v19, v20
    v_max3_f32 v160, v160, v21, v22
    v_min3_f32 v162, v162, v21, v22
    v_max3_f32 v160, v160, v23, v24
    v_min3_f32 v162, v162, v23, v24
    v_max3_f32 v160, v160, v25, v26
    v_min3_f32 v162, v162, v25, v26
    v_max3_f32 v160, v160, v27, v28
    v_min3_f32 v162, v162, v27, v28
    v_max3_f32 v160, v160, v29, v30
    v_min3_f32 v162, v162, v29, v30
    v_max_f32 v160, v160, v31
    v_min_f32 v162, v162, v31
    v_max3_f32 v164, v32, v33, v34
    v_min3_f32 v166, v32, v33, v34
    v_max3_f32 v164, v164, v35, v36
    v_min3_f32 v166, v166, v35, v36
    v_max3_f32 v164, v164, v37, v38
    v_min3_f32 v166, v166, v37, v38
    v_max3_f32 v164, v164, v39, v40
    v_min3_f32 v166, v166, v39, v40
    v_max3_f32 v164, v164, v41, v42
    v_min3_f32 v166, v166, v41, v42
    v_max3_f32 v164, v164, v43, v44
    v_min3_f32 v166, v166, v43, v44
    v_max3_f32 v164, v164, v45, v46
    v_min3_f32 v166, v166, v45, v46
    v_max_f32 v164, v164, v47
    v_min_f32 v166, v166, v47
    v_mov_b32 v161, v160
    v_mov_b32 v163, v162
    v_mov_b32 v165, v164
    v_mov_b32 v167, v166
    v_permlane32_swap_b32 v160, v161
    v_permlane32_swap_b32 v162, v163
    v_permlane32_swap_b32 v164, v165
    v_permlane32_swap_b32 v166, v167
    v_max_f32 v160, v160, v161
    v_min_f32 v162, v162, v163
    v_max_f32 v164, v164, v165
    v_min_f32 v166, v166, v167
    v_mul_f32 v160, v160, v251
    v_mul_f32 v162, v162, v251
    v_mul_f32 v164, v164, v253
    v_mul_f32 v166, v166, v253
    v_pk_fma_f32 v[128:129], v[16:17], v[250:251], v[160:161] op_sel:[0,1,0] op_sel_hi:[1,1,0] neg_lo:[0,0,1] neg_hi:[0,0,1]
    v_pk_fma_f32 v[16:17], v[16:17], v[250:251], v[162:163] op_sel:[0,1,0] op_sel_hi:[1,1,0] neg_lo:[0,1,0] neg_hi:[0,1,0]
    v_pk_fma_f32 v[130:131], v[18:19], v[250:251], v[160:161] op_sel:[0,1,0] op_sel_hi:[1,1,0] neg_lo:[0,0,1] neg_hi:[0,0,1]
    v_pk_fma_f32 v[18:19], v[18:19], v[250:251], v[162:163] op_sel:[0,1,0] op_sel_hi:[1,1,0] neg_lo:[0,1,0] neg_hi:[0,1,0]
    v_pk_fma_f32 v[132:133], v[20:21], v[250:251], v[160:161] op_sel:[0,1,0] op_sel_hi:[1,1,0] neg_lo:[0,0,1] neg_hi:[0,0,1]
    v_pk_fma_f32 v[20:21], v[20:21], v[250:251], v[162:163] op_sel:[0,1,0] op_sel_hi:[1,1,0] neg_lo:[0,1,0] neg_hi:[0,1,0]
    v_pk_fma_f32 v[134:135], v[22:23], v[250:251], v[160:161] op_sel:[0,1,0] op_sel_hi:[1,1,0] neg_lo:[0,0,1] neg_hi:[0,0,1]
    v_pk_fma_f32 v[22:23], v[22:23], v[250:251], v[162:163] op_sel:[0,1,0] op_sel_hi:[1,1,0] neg_lo:[0,1,0] neg_hi:[0,1,0]
    v_pk_fma_f32 v[136:137], v[24:25], v[250:251], v[160:161] op_sel:[0,1,0] op_sel_hi:[1,1,0] neg_lo:[0,0,1] neg_hi:[0,0,1]
    v_pk_fma_f32 v[24:25], v[24:25], v[250:251], v[162:163] op_sel:[0,1,0] op_sel_hi:[1,1,0] neg_lo:[0,1,0] neg_hi:[0,1,0]
    v_pk_fma_f32 v[138:139], v[26:27], v[250:251], v[160:161] op_sel:[0,1,0] op_sel_hi:[1,1,0] neg_lo:[0,0,1] neg_hi:[0,0,1]
    v_pk_fma_f32 v[26:27], v[26:27], v[250:251], v[162:163] op_sel:[0,1,0] op_sel_hi:[1,1,0] neg_lo:[0,1,0] neg_hi:[0,1,0]
    v_pk_fma_f32 v[140:141], v[28:29], v[250:251], v[160:161] op_sel:[0,1,0] op_sel_hi:[1,1,0] neg_lo:[0,0,1] neg_hi:[0,0,1]
    v_pk_fma_f32 v[28:29], v[28:29], v[250:251], v[162:163] op_sel:[0,1,0] op_sel_hi:[1,1,0] neg_lo:[0,1,0] neg_hi:[0,1,0]
    v_pk_fma_f32 v[142:143], v[30:31], v[250:251], v[160:161] op_sel:[0,1,0] op_sel_hi:[1,1,0] neg_lo:[0,0,1] neg_hi:[0,0,1]
    v_pk_fma_f32 v[30:31], v[30:31], v[250:251], v[162:163] op_sel:[0,1,0] op_sel_hi:[1,1,0] neg_lo:[0,1,0] neg_hi:[0,1,0]
    v_pk_fma_f32 v[144:145], v[32:33], v[252:253], v[164:165] op_sel:[0,1,0] op_sel_hi:[1,1,0] neg_lo:[0,0,1] neg_hi:[0,0,1]
    v_pk_fma_f32 v[32:33], v[32:33], v[252:253], v[166:167] op_sel:[0,1,0] op_sel_hi:[1,1,0] neg_lo:[0,1,0] neg_hi:[0,1,0]
    v_pk_fma_f32 v[146:147], v[34:35], v[252:253], v[164:165] op_sel:[0,1,0] op_sel_hi:[1,1,0] neg_lo:[0,0,1] neg_hi:[0,0,1]
    v_pk_fma_f32 v[34:35], v[34:35], v[252:253], v[166:167] op_sel:[0,1,0] op_sel_hi:[1,1,0] neg_lo:[0,1,0] neg_hi:[0,1,0]
    v_pk_fma_f32 v[148:149], v[36:37], v[252:253], v[164:165] op_sel:[0,1,0] op_sel_hi:[1,1,0] neg_lo:[0,0,1] neg_hi:[0,0,1]
    v_pk_fma_f32 v[36:37], v[36:37], v[252:253], v[166:167] op_sel:[0,1,0] op_sel_hi:[1,1,0] neg_lo:[0,1,0] neg_hi:[0,1,0]
    v_pk_fma_f32 v[150:151], v[38:39], v[252:253], v[164:165] op_sel:[0,1,0] op_sel_hi:[1,1,0] neg_lo:[0,0,1] neg_hi:[0,0,1]
    v_pk_fma_f32 v[38:39], v[38:39], v[252:253], v[166:167] op_sel:[0,1,0] op_sel_hi:[1,1,0] neg_lo:[0,1,0] neg_hi:[0,1,0]
    v_pk_fma_f32 v[152:153], v[40:41], v[252:253], v[164:165] op_sel:[0,1,0] op_sel_hi:[1,1,0] neg_lo:[0,0,1] neg_hi:[0,0,1]
    v_pk_fma_f32 v[40:41], v[40:41], v[252:253], v[166:167] op_sel:[0,1,0] op_sel_hi:[1,1,0] neg_lo:[0,1,0] neg_hi:[0,1,0]
    v_pk_fma_f32 v[154:155], v[42:43], v[252:253], v[164:165] op_sel:[0,1,0] op_sel_hi:[1,1,0] neg_lo:[0,0,1] neg_hi:[0,0,1]
    v_pk_fma_f32 v[42:43], v[42:43], v[252:253], v[166:167] op_sel:[0,1,0] op_sel_hi:[1,1,0] neg_lo:[0,1,0] neg_hi:[0,1,0]
    v_pk_fma_f32 v[156:157], v[44:45], v[252:253], v[164:165] op_sel:[0,1,0] op_sel_hi:[1,1,0] neg_lo:[0,0,1] neg_hi:[0,0,1]
    v_pk_fma_f32 v[44:45], v[44:45], v[252:253], v[166:167] op_sel:[0,1,0] op_sel_hi:[1,1,0] neg_lo:[0,1,0] neg_hi:[0,1,0]
    v_pk_fma_f32 v[158:159], v[46:47], v[252:253], v[164:165] op_sel:[0,1,0] op_sel_hi:[1,1,0] neg_lo:[0,0,1] neg_hi:[0,0,1]
    v_pk_fma_f32 v[46:47], v[46:47], v[252:253], v[166:167] op_sel:[0,1,0] op_sel_hi:[1,1,0] neg_lo:[0,1,0] neg_hi:[0,1,0]
    v_exp_f32 v128, v128
    v_exp_f32 v16, v16
    v_exp_f32 v129, v129
    v_exp_f32 v17, v17
    v_exp_f32 v130, v130
    v_exp_f32 v18, v18
    v_exp_f32 v131, v131
    v_exp_f32 v19, v19
    v_exp_f32 v132, v132
    v_exp_f32 v20, v20
    v_exp_f32 v133, v133
    v_exp_f32 v21, v21
    v_exp_f32 v134, v134
    v_exp_f32 v22, v22
    v_exp_f32 v135, v135
    v_exp_f32 v23, v23
    v_exp_f32 v136, v136
    v_exp_f32 v24, v24
    v_exp_f32 v137, v137
    v_exp_f32 v25, v25
    v_exp_f32 v138, v138
    v_exp_f32 v26, v26
    v_exp_f32 v139, v139
    v_exp_f32 v27, v27
    v_exp_f32 v140, v140
    v_exp_f32 v28, v28
    v_exp_f32 v141, v141
    v_exp_f32 v29, v29
    v_exp_f32 v142, v142
    v_exp_f32 v30, v30
    v_exp_f32 v143, v143
    v_exp_f32 v31, v31
    v_cvt_pk_bf16_f32 v218, v128, v129
    v_cvt_pk_bf16_f32 v219, v130, v131
    v_cvt_pk_bf16_f32 v220, v132, v133
    v_cvt_pk_bf16_f32 v221, v134, v135
    v_cvt_pk_bf16_f32 v222, v136, v137
    v_cvt_pk_bf16_f32 v223, v138, v139
    v_cvt_pk_bf16_f32 v224, v140, v141
    v_cvt_pk_bf16_f32 v225, v142, v143
    v_cvt_pk_bf16_f32 v226, v16, v17
    v_cvt_pk_bf16_f32 v227, v18, v19
    v_cvt_pk_bf16_f32 v228, v20, v21
    v_cvt_pk_bf16_f32 v229, v22, v23
    v_cvt_pk_bf16_f32 v230, v24, v25
    v_cvt_pk_bf16_f32 v231, v26, v27
    v_cvt_pk_bf16_f32 v232, v28, v29
    v_cvt_pk_bf16_f32 v233, v30, v31
    v_exp_f32 v144, v144
    v_exp_f32 v32, v32
    v_exp_f32 v145, v145
    v_exp_f32 v33, v33
    v_exp_f32 v146, v146
    v_exp_f32 v34, v34
    v_exp_f32 v147, v147
    v_exp_f32_e64 v35, v35
    s_barrier
    buffer_load_dwordx4 v[48:51], v13, s[40:43], s78 offen offset:3072 sc1
    buffer_load_dwordx4 v[52:55], v13, s[40:43], s79 offen offset:3072 sc1
    buffer_load_dwordx4 v[56:59], v13, s[40:43], s78 offen offset:3200 sc1
    buffer_load_dwordx4 v[60:63], v13, s[40:43], s79 offen offset:3200 sc1
    ds_read_b128 v[168:171], v216 offset:24576
    ds_read_b128 v[172:175], v216 offset:24608
    ds_read_b128 v[176:179], v216 offset:24640
    ds_read_b128 v[180:183], v216 offset:24672
    v_exp_f32 v148, v148
    v_exp_f32 v36, v36
    v_exp_f32 v149, v149
    v_exp_f32 v37, v37
    v_exp_f32 v150, v150
    v_exp_f32 v38, v38
    v_exp_f32 v151, v151
    v_exp_f32 v39, v39
    v_exp_f32 v152, v152
    v_exp_f32_e64 v40, v40
    s_waitcnt lgkmcnt(0)
    v_mfma_f32_32x32x16_bf16 v[64:79], v[168:171], v[218:221], 0
    v_exp_f32 v153, v153
    v_exp_f32 v41, v41
    v_exp_f32_e64 v154, v154
    v_mfma_f32_32x32x16_bf16 v[80:95], v[176:179], v[226:229], 0
    v_exp_f32 v42, v42
    v_exp_f32 v155, v155
    v_exp_f32_e64 v43, v43
    v_mfma_f32_32x32x16_bf16 v[64:79], v[172:175], v[222:225], v[64:79]
    v_exp_f32 v156, v156
    v_exp_f32 v44, v44
    v_exp_f32_e64 v157, v157
    v_mfma_f32_32x32x16_bf16 v[80:95], v[180:183], v[230:233], v[80:95]
    v_exp_f32 v45, v45
    v_exp_f32 v158, v158
    v_exp_f32 v46, v46
    v_exp_f32 v159, v159
    v_exp_f32_e64 v47, v47
    v_cvt_pk_bf16_f32 v234, v144, v145
    v_cvt_pk_bf16_f32 v235, v146, v147
    v_cvt_pk_bf16_f32 v236, v148, v149
    v_cvt_pk_bf16_f32 v237, v150, v151
    v_cvt_pk_bf16_f32 v238, v152, v153
    v_cvt_pk_bf16_f32 v239, v154, v155
    v_cvt_pk_bf16_f32 v240, v156, v157
    v_cvt_pk_bf16_f32 v241, v158, v159
    v_cvt_pk_bf16_f32 v242, v32, v33
    v_cvt_pk_bf16_f32 v243, v34, v35
    v_cvt_pk_bf16_f32 v244, v36, v37
    v_cvt_pk_bf16_f32 v245, v38, v39
    v_cvt_pk_bf16_f32 v246, v40, v41
    v_cvt_pk_bf16_f32 v247, v42, v43
    v_cvt_pk_bf16_f32 v248, v44, v45
    v_cvt_pk_bf16_f32 v249, v46, v47
    v_mfma_f32_32x32x16_bf16 v[96:111], v[168:171], v[234:237], 0
    v_rcp_f32 v184, v65
    v_rcp_f32 v185, v81
    v_mul_f32 v6, v64, v184
    v_fmac_f32 v6, v80, v185
    v_add_f32 v6, 0x358637bd, v6
    v_mfma_f32_32x32x16_bf16 v[112:127], v[176:179], v[242:245], 0
    v_rcp_f32 v6, v6
    v_mov_b32 v8, 0
    v_mul_f32 v184, v184, v6
    v_mul_f32_e64 v185, v185, v6
    s_lshl4_add_u32 s76, s60, s61
    v_mfma_f32_32x32x16_bf16 v[96:111], v[172:175], v[238:241], v[96:111]
    s_mul_i32 s76, s76, 32768
    s_lshl2_add_u32 s77, s63, s64
    s_lshl_b32 s77, s77, 12
    s_add_u32 s76, s76, s77
    s_add_u32 s76, s76, 16777216
    v_mfma_f32_32x32x16_bf16 v[112:127], v[180:183], v[246:249], v[112:127]
    s_add_u32 s77, s76, 8192
    v_add_u32 v14, 128, v12
    v_cmp_gt_u32 vcc, 24, v1
    s_nop 0
    s_nop 0
    v_cndmask_b32_e64 v14, v14, v12, vcc
    s_mov_b32 s88, 0
    s_branch L_pfirst_61
L_poll_60:
    buffer_load_dwordx4 v[48:51], v13, s[40:43], s78 offen offset:3072 sc1
    buffer_load_dwordx4 v[52:55], v13, s[40:43], s79 offen offset:3072 sc1
    buffer_load_dwordx4 v[56:59], v13, s[40:43], s78 offen offset:3200 sc1
    buffer_load_dwordx4 v[60:63], v13, s[40:43], s79 offen offset:3200 sc1
L_pfirst_61:
    s_waitcnt vmcnt(0)
    v_max3_u32 v9, v48, v49, v50
    v_max3_u32 v9, v9, v51, v52
    v_max3_u32 v9, v9, v53, v54
    v_max3_u32 v9, v9, v55, v56
    v_max3_u32 v9, v9, v57, v58
    v_max3_u32 v9, v9, v59, v60
    v_max3_u32 v9, v9, v61, v62
    v_max_u32 v9, v9, v63
    v_cmp_eq_u32 vcc, -1, v9
    s_nop 0
    s_cbranch_vccz L_ok_62
    s_add_u32 s88, s88, 1
    s_cmp_lt_u32 s88, 65536
    s_cbranch_scc1 L_poll_60
L_ok_62:
    v_mfma_f32_32x32x16_bf16 v[16:31], v[48:51], v[218:221], 0
    s_barrier
    v_rcp_f32 v186, v97
    v_rcp_f32 v187, v113
    v_mul_f32 v7, v96, v186
    v_fmac_f32 v7, v112, v187
    v_mfma_f32_32x32x16_bf16 v[128:143], v[56:59], v[226:229], 0
    v_add_f32 v7, 0x358637bd, v7
    v_rcp_f32 v7, v7
    v_mov_b32 v8, 0
    v_mul_f32_e64 v186, v186, v7
    v_mfma_f32_32x32x16_bf16 v[16:31], v[52:55], v[222:225], v[16:31]
    v_mul_f32_e64 v187, v187, v7
    global_load_dwordx2 v[192:193], v10, s[14:15] offset:0
    global_load_dwordx2 v[194:195], v10, s[14:15] offset:16
    global_load_dwordx2 v[196:197], v10, s[14:15] offset:32
    v_mfma_f32_32x32x16_bf16 v[128:143], v[60:63], v[230:233], v[128:143]
    global_load_dwordx2 v[198:199], v10, s[14:15] offset:48
    global_load_dwordx2 v[200:201], v10, s[14:15] offset:64
    global_load_dwordx2 v[202:203], v10, s[14:15] offset:80
    global_load_dwordx2 v[204:205], v10, s[14:15] offset:96
    v_mfma_f32_32x32x16_bf16 v[32:47], v[48:51], v[234:237], 0
    global_load_dwordx2 v[206:207], v10, s[14:15] offset:112
    global_load_dwordx4 v[208:211], v11, s[14:15] offset:0
    global_load_dwordx4 v[212:215], v11, s[14:15] offset:16
    v_mfma_f32_32x32x16_bf16 v[144:159], v[56:59], v[242:245], 0
    v_mul_f32 v16, v16, v184
    v_mul_f32 v17, v17, v184
    v_mul_f32 v18, v18, v184
    v_mul_f32 v19, v19, v184
    v_mul_f32 v20, v20, v184
    v_mul_f32 v21, v21, v184
    v_mfma_f32_32x32x16_bf16 v[32:47], v[52:55], v[238:241], v[32:47]
    v_mul_f32 v22, v22, v184
    v_mul_f32 v23, v23, v184
    v_mul_f32 v24, v24, v184
    v_mul_f32 v25, v25, v184
    v_mul_f32 v26, v26, v184
    v_mul_f32 v27, v27, v184
    v_mfma_f32_32x32x16_bf16 v[144:159], v[60:63], v[246:249], v[144:159]
    v_mul_f32 v28, v28, v184
    v_mul_f32 v29, v29, v184
    v_mul_f32 v30, v30, v184
    v_mul_f32 v31, v31, v184
    v_fmac_f32 v16, v128, v185
    v_fmac_f32 v17, v129, v185
    v_cvt_pk_bf16_f32 v64, v16, v17
    v_fmac_f32 v18, v130, v185
    v_fmac_f32 v19, v131, v185
    v_cvt_pk_bf16_f32 v65, v18, v19
    v_fmac_f32 v20, v132, v185
    v_fmac_f32 v21, v133, v185
    v_cvt_pk_bf16_f32 v66, v20, v21
    v_fmac_f32 v22, v134, v185
    v_fmac_f32 v23, v135, v185
    v_cvt_pk_bf16_f32 v67, v22, v23
    buffer_store_dwordx4 v[64:67], v14, s[40:43], s76 offen offset:0 sc1
    v_fmac_f32 v24, v136, v185
    v_fmac_f32 v25, v137, v185
    v_cvt_pk_bf16_f32 v68, v24, v25
    v_fmac_f32 v26, v138, v185
    v_fmac_f32 v27, v139, v185
    v_cvt_pk_bf16_f32 v69, v26, v27
    v_fmac_f32 v28, v140, v185
    v_fmac_f32 v29, v141, v185
    v_cvt_pk_bf16_f32 v70, v28, v29
    v_fmac_f32 v30, v142, v185
    v_fmac_f32 v31, v143, v185
    v_cvt_pk_bf16_f32 v71, v30, v31
    buffer_store_dwordx4 v[68:71], v14, s[40:43], s76 offen offset:2048 sc1
    v_pk_mul_f32 v[32:33], v[32:33], v[186:187] op_sel_hi:[1,0]
    v_pk_fma_f32 v[32:33], v[144:145], v[186:187], v[32:33] op_sel:[0,1,0] op_sel_hi:[1,1,1]
    v_cvt_pk_bf16_f32 v72, v32, v33
    v_pk_mul_f32 v[34:35], v[34:35], v[186:187] op_sel_hi:[1,0]
    v_pk_fma_f32 v[34:35], v[146:147], v[186:187], v[34:35] op_sel:[0,1,0] op_sel_hi:[1,1,1]
    v_cvt_pk_bf16_f32 v73, v34, v35
    v_pk_mul_f32 v[36:37], v[36:37], v[186:187] op_sel_hi:[1,0]
    v_pk_fma_f32 v[36:37], v[148:149], v[186:187], v[36:37] op_sel:[0,1,0] op_sel_hi:[1,1,1]
    v_cvt_pk_bf16_f32 v74, v36, v37
    v_pk_mul_f32 v[38:39], v[38:39], v[186:187] op_sel_hi:[1,0]
    v_pk_fma_f32 v[38:39], v[150:151], v[186:187], v[38:39] op_sel:[0,1,0] op_sel_hi:[1,1,1]
    v_cvt_pk_bf16_f32 v75, v38, v39
    buffer_store_dwordx4 v[72:75], v14, s[40:43], s77 offen offset:0 sc1
    v_pk_mul_f32 v[40:41], v[40:41], v[186:187] op_sel_hi:[1,0]
    v_pk_fma_f32 v[40:41], v[152:153], v[186:187], v[40:41] op_sel:[0,1,0] op_sel_hi:[1,1,1]
    v_cvt_pk_bf16_f32 v76, v40, v41
    v_pk_mul_f32 v[42:43], v[42:43], v[186:187] op_sel_hi:[1,0]
    v_pk_fma_f32 v[42:43], v[154:155], v[186:187], v[42:43] op_sel:[0,1,0] op_sel_hi:[1,1,1]
    v_cvt_pk_bf16_f32 v77, v42, v43
    v_pk_mul_f32 v[44:45], v[44:45], v[186:187] op_sel_hi:[1,0]
    v_pk_fma_f32 v[44:45], v[156:157], v[186:187], v[44:45] op_sel:[0,1,0] op_sel_hi:[1,1,1]
    v_cvt_pk_bf16_f32 v78, v44, v45
    v_pk_mul_f32 v[46:47], v[46:47], v[186:187] op_sel_hi:[1,0]
    v_pk_fma_f32 v[46:47], v[158:159], v[186:187], v[46:47] op_sel:[0,1,0] op_sel_hi:[1,1,1]
    v_cvt_pk_bf16_f32 v79, v46, v47
    buffer_store_dwordx4 v[76:79], v14, s[40:43], s77 offen offset:2048 sc1
    v_bfe_u32 v4, v2, 1, 3
    v_lshlrev_b32_e64 v4, 4, v4
    v_lshl_add_u32 v4, v3, 3, v4
    v_lshl_add_u32 v4, v2, 7, v4
    s_lshl_b32 s76, s62, 12
    s_add_u32 s77, s76, 0
    v_add_u32 v64, s77, v4
    v_xor_b32 v65, 16, v64
    v_xor_b32 v66, 32, v64
    v_xor_b32 v67, 48, v64
    v_xor_b32_e64 v68, 64, v64
    v_xor_b32 v69, 80, v64
    v_xor_b32 v70, 96, v64
    v_xor_b32 v71, 112, v64
    v_bfe_u32 v4, v1, 2, 2
    v_lshl_add_u32 v5, v3, 2, v4
    v_lshlrev_b32 v5, 7, v5
    v_lshrrev_b32 v4, 1, v4
    v_lshl_add_u32 v5, v4, 6, v5
    v_bfe_u32 v4, v1, 4, 1
    v_lshl_add_u32 v5, v4, 5, v5
    v_and_b32_e64 v4, 3, v1
    v_lshl_add_u32 v5, v4, 3, v5
    v_add_u32 v72, 32768, v5
    v_xor_b32_e64 v73, 64, v72
    s_mul_i32 s80, s97, 524288
    s_mul_i32 s76, s62, 8192
    s_add_u32 s80, s80, s76
    s_add_u32 s80, s80, 16777216
    v_add_u32 v78, 4096, v14
    v_mov_b32 v74, 1
    s_mov_b32 s52, 0xffff
    s_mov_b32 s53, 0
    s_barrier
    ds_read_b32 v79, v8 offset:25984
    ds_read_b64 v[88:89], v64
    ds_read_b64 v[90:91], v65
    ds_read_b64 v[92:93], v66
    ds_read_b64 v[94:95], v67
    ds_read_b64 v[96:97], v68
    ds_read_b64 v[98:99], v69
    ds_read_b64 v[100:101], v70
    ds_read_b64 v[102:103], v71
    s_waitcnt lgkmcnt(8)
    v_readfirstlane_b32 s76, v79
    s_nop 0
    s_and_b32 s76, s76, s52
    s_cbranch_scc0 L_tr0
L_bk0:
    s_ff1_i32_b32 s76, s76
    s_bitset0_b32 s52, s76
    s_add_u32 s77, s76, s65
    s_and_b32 s77, s77, 15
    s_mul_i32 s77, s77, 32768
    s_add_u32 s28, s77, s80
    s_add_u32 s76, s76, 3
    s_and_b32 s76, s76, 15
    s_lshl_b32 s4, s76, 13
    buffer_load_dwordx4 v[128:131], v14, s[40:43], s28 offen offset:0 sc1
    buffer_load_dwordx4 v[132:135], v14, s[40:43], s28 offen offset:2048 sc1
    buffer_load_dwordx4 v[136:139], v78, s[40:43], s28 offen offset:0 sc1
    buffer_load_dwordx4 v[140:143], v78, s[40:43], s28 offen offset:2048 sc1
    v_readfirstlane_b32 s76, v79
    s_nop 0
    s_and_b32 s76, s76, s52
    s_cbranch_scc0 L_tr1
L_bk1:
    s_ff1_i32_b32 s76, s76
    s_bitset0_b32 s52, s76
    s_add_u32 s77, s76, s65
    s_and_b32 s77, s77, 15
    s_mul_i32 s77, s77, 32768
    s_add_u32 s29, s77, s80
    s_add_u32 s76, s76, 3
    s_and_b32 s76, s76, 15
    s_lshl_b32 s5, s76, 13
    buffer_load_dwordx4 v[144:147], v14, s[40:43], s29 offen offset:0 sc1
    buffer_load_dwordx4 v[148:151], v14, s[40:43], s29 offen offset:2048 sc1
    v_add_u32 v80, s4, v72
    v_add_u32 v81, s4, v73
    s_waitcnt lgkmcnt(0)
    v_lshlrev_b32 v16, 16, v88
    v_and_b32 v17, s90, v88
    v_lshlrev_b32 v18, 16, v89
    v_and_b32 v19, s90, v89
    v_lshlrev_b32 v20, 16, v90
    v_and_b32 v21, s90, v90
    v_lshlrev_b32 v22, 16, v91
    v_and_b32 v23, s90, v91
    v_lshlrev_b32 v24, 16, v92
    v_and_b32 v25, s90, v92
    v_lshlrev_b32 v26, 16, v93
    v_and_b32 v27, s90, v93
    v_lshlrev_b32 v28, 16, v94
    v_and_b32 v29, s90, v94
    v_lshlrev_b32 v30, 16, v95
    v_and_b32 v31, s90, v95
    v_lshlrev_b32 v32, 16, v96
    v_and_b32 v33, s90, v96
    v_lshlrev_b32 v34, 16, v97
    v_and_b32 v35, s90, v97
    v_lshlrev_b32 v36, 16, v98
    v_and_b32 v37, s90, v98
    v_lshlrev_b32 v38, 16, v99
    v_and_b32 v39, s90, v99
    v_lshlrev_b32 v40, 16, v100
    v_and_b32 v41, s90, v100
    v_lshlrev_b32 v42, 16, v101
    v_and_b32 v43, s90, v101
    v_lshlrev_b32 v44, 16, v102
    v_and_b32 v45, s90, v102
    v_lshlrev_b32 v46, 16, v103
    v_and_b32 v47, s90, v103
    s_cmp_eq_u32 s53, 0
    s_cbranch_scc0 L_sent_63
    s_waitcnt vmcnt(6)
    s_mov_b64 exec, 1
    ds_add_u32 v8, v74 offset:25988
    s_mov_b64 exec, -1
    s_mov_b32 s53, 1
L_sent_63:
    ds_read_b32 v79, v8 offset:25984
    ds_read_b64_tr_b16 v[104:105], v80 offset:0
    ds_read_b64_tr_b16 v[106:107], v80 offset:1024
    ds_read_b64_tr_b16 v[108:109], v81 offset:0
    ds_read_b64_tr_b16 v[110:111], v81 offset:1024
    ds_read_b64_tr_b16 v[112:113], v80 offset:2048
    ds_read_b64_tr_b16 v[114:115], v80 offset:3072
    ds_read_b64_tr_b16 v[116:117], v81 offset:2048
    ds_read_b64_tr_b16 v[118:119], v81 offset:3072
    s_waitcnt vmcnt(5) lgkmcnt(4)
    v_mfma_f32_32x32x16_bf16 v[16:31], v[104:107], v[128:131], v[16:31]
    ds_read_b64_tr_b16 v[120:121], v80 offset:4096
    ds_read_b64_tr_b16 v[122:123], v80 offset:5120
    buffer_load_dwordx4 v[152:155], v78, s[40:43], s29 offen offset:0 sc1
    v_mfma_f32_32x32x16_bf16 v[32:47], v[108:111], v[128:131], v[32:47]
    ds_read_b64_tr_b16 v[124:125], v81 offset:4096
    ds_read_b64_tr_b16 v[126:127], v81 offset:5120
    buffer_load_dwordx4 v[156:159], v78, s[40:43], s29 offen offset:2048 sc1
    v_readfirstlane_b32 s76, v79
    s_nop 0
    s_and_b32 s76, s76, s52
    s_cbranch_scc0 L_tr2
L_bk2:
    s_ff1_i32_b32 s76, s76
    s_bitset0_b32 s52, s76
    s_add_u32 s77, s76, s65
    s_and_b32 s77, s77, 15
    s_mul_i32 s77, s77, 32768
    s_add_u32 s30, s77, s80
    s_waitcnt vmcnt(6) lgkmcnt(4)
    v_mfma_f32_32x32x16_bf16 v[16:31], v[112:115], v[132:135], v[16:31]
    ds_read_b32 v79, v8 offset:25984
    ds_read_b64_tr_b16 v[104:105], v80 offset:6144
    ds_read_b64_tr_b16 v[106:107], v80 offset:7168
    buffer_load_dwordx4 v[160:163], v14, s[40:43], s30 offen offset:0 sc1
    s_add_u32 s76, s76, 3
    s_and_b32 s76, s76, 15
    s_lshl_b32 s6, s76, 13
    v_mfma_f32_32x32x16_bf16 v[32:47], v[116:119], v[132:135], v[32:47]
    ds_read_b64_tr_b16 v[108:109], v81 offset:6144
    ds_read_b64_tr_b16 v[110:111], v81 offset:7168
    buffer_load_dwordx4 v[164:167], v14, s[40:43], s30 offen offset:2048 sc1
    v_add_u32 v82, s5, v72
    v_add_u32_e64 v83, s5, v73
    s_waitcnt vmcnt(7) lgkmcnt(4)
    v_mfma_f32_32x32x16_bf16 v[16:31], v[120:123], v[136:139], v[16:31]
    ds_read_b64_tr_b16 v[112:113], v82 offset:0
    ds_read_b64_tr_b16 v[114:115], v82 offset:1024
    buffer_load_dwordx4 v[168:171], v78, s[40:43], s30 offen offset:0 sc1
    v_mfma_f32_32x32x16_bf16 v[32:47], v[124:127], v[136:139], v[32:47]
    ds_read_b64_tr_b16 v[116:117], v83 offset:0
    ds_read_b64_tr_b16 v[118:119], v83 offset:1024
    buffer_load_dwordx4 v[172:175], v78, s[40:43], s30 offen offset:2048 sc1
    v_readfirstlane_b32 s76, v79
    s_nop 0
    s_and_b32 s76, s76, s52
    s_cbranch_scc0 L_tr3
L_bk3:
    s_ff1_i32_b32 s76, s76
    s_bitset0_b32 s52, s76
    s_add_u32 s77, s76, s65
    s_and_b32 s77, s77, 15
    s_mul_i32 s77, s77, 32768
    s_add_u32 s31, s77, s80
    s_waitcnt vmcnt(8) lgkmcnt(4)
    v_mfma_f32_32x32x16_bf16 v[16:31], v[104:107], v[140:143], v[16:31]
    ds_read_b32 v79, v8 offset:25984
    ds_read_b64_tr_b16 v[120:121], v82 offset:2048
    ds_read_b64_tr_b16 v[122:123], v82 offset:3072
    buffer_load_dwordx4 v[176:179], v14, s[40:43], s31 offen offset:0 sc1
    s_add_u32 s76, s76, 3
    s_and_b32 s76, s76, 15
    s_lshl_b32 s7, s76, 13
    v_mfma_f32_32x32x16_bf16 v[32:47], v[108:111], v[140:143], v[32:47]
    ds_read_b64_tr_b16 v[124:125], v83 offset:2048
    ds_read_b64_tr_b16 v[126:127], v83 offset:3072
    buffer_load_dwordx4 v[180:183], v14, s[40:43], s31 offen offset:2048 sc1
    s_waitcnt vmcnt(9) lgkmcnt(4)
    v_mfma_f32_32x32x16_bf16 v[16:31], v[112:115], v[144:147], v[16:31]
    ds_read_b64_tr_b16 v[104:105], v82 offset:4096
    ds_read_b64_tr_b16 v[106:107], v82 offset:5120
    buffer_load_dwordx4 v[184:187], v78, s[40:43], s31 offen offset:0 sc1
    v_mfma_f32_32x32x16_bf16 v[32:47], v[116:119], v[144:147], v[32:47]
    ds_read_b64_tr_b16 v[108:109], v83 offset:4096
    ds_read_b64_tr_b16 v[110:111], v83 offset:5120
    buffer_load_dwordx4 v[188:191], v78, s[40:43], s31 offen offset:2048 sc1
    v_readfirstlane_b32 s76, v79
    s_nop 0
    s_and_b32 s76, s76, s52
    s_cbranch_scc0 L_tr4
L_bk4:
    s_ff1_i32_b32 s76, s76
    s_bitset0_b32 s52, s76
    s_add_u32 s77, s76, s65
    s_and_b32 s77, s77, 15
    s_mul_i32 s77, s77, 32768
    s_add_u32 s32, s77, s80
    s_waitcnt vmcnt(10) lgkmcnt(4)
    v_mfma_f32_32x32x16_bf16 v[16:31], v[120:123], v[148:151], v[16:31]
    ds_read_b64_tr_b16 v[112:113], v82 offset:6144
    ds_read_b64_tr_b16 v[114:115], v82 offset:7168
    buffer_load_dwordx4 v[128:131], v14, s[40:43], s32 offen offset:0 sc1
    s_add_u32 s76, s76, 3
    s_and_b32 s76, s76, 15
    s_lshl_b32 s8, s76, 13
    v_mfma_f32_32x32x16_bf16 v[32:47], v[124:127], v[148:151], v[32:47]
    ds_read_b64_tr_b16 v[116:117], v83 offset:6144
    ds_read_b64_tr_b16 v[118:119], v83 offset:7168
    buffer_load_dwordx4 v[132:135], v14, s[40:43], s32 offen offset:2048 sc1
    v_add_u32 v80, s6, v72
    v_add_u32 v81, s6, v73
    s_waitcnt vmcnt(11) lgkmcnt(4)
    v_mfma_f32_32x32x16_bf16 v[16:31], v[104:107], v[152:155], v[16:31]
    ds_read_b32 v79, v8 offset:25984
    ds_read_b64_tr_b16 v[120:121], v80 offset:0
    ds_read_b64_tr_b16 v[122:123], v80 offset:1024
    buffer_load_dwordx4 v[136:139], v78, s[40:43], s32 offen offset:0 sc1
    v_mfma_f32_32x32x16_bf16 v[32:47], v[108:111], v[152:155], v[32:47]
    ds_read_b64_tr_b16 v[124:125], v81 offset:0
    ds_read_b64_tr_b16 v[126:127], v81 offset:1024
    s_waitcnt vmcnt(11) lgkmcnt(4)
    v_mfma_f32_32x32x16_bf16 v[16:31], v[112:115], v[156:159], v[16:31]
    ds_read_b64_tr_b16 v[104:105], v80 offset:2048
    ds_read_b64_tr_b16 v[106:107], v80 offset:3072
    buffer_load_dwordx4 v[140:143], v78, s[40:43], s32 offen offset:2048 sc1
    v_mfma_f32_32x32x16_bf16 v[32:47], v[116:119], v[156:159], v[32:47]
    ds_read_b64_tr_b16 v[108:109], v81 offset:2048
    ds_read_b64_tr_b16 v[110:111], v81 offset:3072
    v_readfirstlane_b32 s76, v79
    s_nop 0
    s_and_b32 s76, s76, s52
    s_cbranch_scc0 L_tr5
L_bk5:
    s_ff1_i32_b32 s76, s76
    s_bitset0_b32 s52, s76
    s_add_u32 s77, s76, s65
    s_and_b32 s77, s77, 15
    s_mul_i32 s77, s77, 32768
    s_add_u32 s33, s77, s80
    s_waitcnt vmcnt(11) lgkmcnt(4)
    v_mfma_f32_32x32x16_bf16 v[16:31], v[120:123], v[160:163], v[16:31]
    ds_read_b64_tr_b16 v[112:113], v80 offset:4096
    ds_read_b64_tr_b16 v[114:115], v80 offset:5120
    buffer_load_dwordx4 v[144:147], v14, s[40:43], s33 offen offset:0 sc1
    s_add_u32 s76, s76, 3
    s_and_b32 s76, s76, 15
    s_lshl_b32 s9, s76, 13
    v_mfma_f32_32x32x16_bf16 v[32:47], v[124:127], v[160:163], v[32:47]
    ds_read_b64_tr_b16 v[116:117], v81 offset:4096
    ds_read_b64_tr_b16 v[118:119], v81 offset:5120
    s_waitcnt vmcnt(11) lgkmcnt(4)
    v_mfma_f32_32x32x16_bf16 v[16:31], v[104:107], v[164:167], v[16:31]
    ds_read_b64_tr_b16 v[120:121], v80 offset:6144
    ds_read_b64_tr_b16 v[122:123], v80 offset:7168
    buffer_load_dwordx4 v[148:151], v14, s[40:43], s33 offen offset:2048 sc1
    v_mfma_f32_32x32x16_bf16 v[32:47], v[108:111], v[164:167], v[32:47]
    ds_read_b64_tr_b16 v[124:125], v81 offset:6144
    ds_read_b64_tr_b16 v[126:127], v81 offset:7168
    v_add_u32 v82, s7, v72
    v_add_u32 v83, s7, v73
    s_waitcnt vmcnt(11) lgkmcnt(4)
    v_mfma_f32_32x32x16_bf16 v[16:31], v[112:115], v[168:171], v[16:31]
    ds_read_b32 v79, v8 offset:25984
    ds_read_b64_tr_b16 v[104:105], v82 offset:0
    ds_read_b64_tr_b16 v[106:107], v82 offset:1024
    buffer_load_dwordx4 v[152:155], v78, s[40:43], s33 offen offset:0 sc1
    v_mfma_f32_32x32x16_bf16 v[32:47], v[116:119], v[168:171], v[32:47]
    ds_read_b64_tr_b16 v[108:109], v83 offset:0
    ds_read_b64_tr_b16 v[110:111], v83 offset:1024
    s_waitcnt vmcnt(11) lgkmcnt(4)
    v_mfma_f32_32x32x16_bf16 v[16:31], v[120:123], v[172:175], v[16:31]
    ds_read_b64_tr_b16 v[112:113], v82 offset:2048
    ds_read_b64_tr_b16 v[114:115], v82 offset:3072
    buffer_load_dwordx4 v[156:159], v78, s[40:43], s33 offen offset:2048 sc1
    v_mfma_f32_32x32x16_bf16 v[32:47], v[124:127], v[172:175], v[32:47]
    ds_read_b64_tr_b16 v[116:117], v83 offset:2048
    ds_read_b64_tr_b16 v[118:119], v83 offset:3072
    v_readfirstlane_b32 s76, v79
    s_nop 0
    s_and_b32 s76, s76, s52
    s_cbranch_scc0 L_tr6
L_bk6:
    s_ff1_i32_b32 s76, s76
    s_bitset0_b32 s52, s76
    s_add_u32 s77, s76, s65
    s_and_b32 s77, s77, 15
    s_mul_i32 s77, s77, 32768
    s_add_u32 s34, s77, s80
    s_waitcnt vmcnt(11) lgkmcnt(4)
    v_mfma_f32_32x32x16_bf16 v[16:31], v[104:107], v[176:179], v[16:31]
    ds_read_b64_tr_b16 v[120:121], v82 offset:4096
    ds_read_b64_tr_b16 v[122:123], v82 offset:5120
    buffer_load_dwordx4 v[160:163], v14, s[40:43], s34 offen offset:0 sc1
    s_add_u32 s76, s76, 3
    s_and_b32 s76, s76, 15
    s_lshl_b32 s10, s76, 13
    v_mfma_f32_32x32x16_bf16 v[32:47], v[108:111], v[176:179], v[32:47]
    ds_read_b64_tr_b16 v[124:125], v83 offset:4096
    ds_read_b64_tr_b16 v[126:127], v83 offset:5120
    s_waitcnt vmcnt(11) lgkmcnt(4)
    v_mfma_f32_32x32x16_bf16 v[16:31], v[112:115], v[180:183], v[16:31]
    ds_read_b64_tr_b16 v[104:105], v82 offset:6144
    ds_read_b64_tr_b16 v[106:107], v82 offset:7168
    buffer_load_dwordx4 v[164:167], v14, s[40:43], s34 offen offset:2048 sc1
    v_mfma_f32_32x32x16_bf16 v[32:47], v[116:119], v[180:183], v[32:47]
    ds_read_b64_tr_b16 v[108:109], v83 offset:6144
    ds_read_b64_tr_b16 v[110:111], v83 offset:7168
    v_add_u32 v80, s8, v72
    v_add_u32 v81, s8, v73
    s_waitcnt vmcnt(11) lgkmcnt(4)
    v_mfma_f32_32x32x16_bf16 v[16:31], v[120:123], v[184:187], v[16:31]
    ds_read_b32 v79, v8 offset:25984
    ds_read_b64_tr_b16 v[112:113], v80 offset:0
    ds_read_b64_tr_b16 v[114:115], v80 offset:1024
    buffer_load_dwordx4 v[168:171], v78, s[40:43], s34 offen offset:0 sc1
    v_mfma_f32_32x32x16_bf16 v[32:47], v[124:127], v[184:187], v[32:47]
    ds_read_b64_tr_b16 v[116:117], v81 offset:0
    ds_read_b64_tr_b16 v[118:119], v81 offset:1024
    s_waitcnt vmcnt(11) lgkmcnt(4)
    v_mfma_f32_32x32x16_bf16 v[16:31], v[104:107], v[188:191], v[16:31]
    ds_read_b64_tr_b16 v[120:121], v80 offset:2048
    ds_read_b64_tr_b16 v[122:123], v80 offset:3072
    buffer_load_dwordx4 v[172:175], v78, s[40:43], s34 offen offset:2048 sc1
    v_mfma_f32_32x32x16_bf16 v[32:47], v[108:111], v[188:191], v[32:47]
    ds_read_b64_tr_b16 v[124:125], v81 offset:2048
    ds_read_b64_tr_b16 v[126:127], v81 offset:3072
    v_readfirstlane_b32 s76, v79
    s_nop 0
    s_and_b32 s76, s76, s52
    s_cbranch_scc0 L_tr7
L_bk7:
    s_ff1_i32_b32 s76, s76
    s_bitset0_b32 s52, s76
    s_add_u32 s77, s76, s65
    s_and_b32 s77, s77, 15
    s_mul_i32 s77, s77, 32768
    s_add_u32 s35, s77, s80
    s_waitcnt vmcnt(11) lgkmcnt(4)
    v_mfma_f32_32x32x16_bf16 v[16:31], v[112:115], v[128:131], v[16:31]
    ds_read_b64_tr_b16 v[104:105], v80 offset:4096
    ds_read_b64_tr_b16 v[106:107], v80 offset:5120
    buffer_load_dwordx4 v[176:179], v14, s[40:43], s35 offen offset:0 sc1
    s_add_u32 s76, s76, 3
    s_and_b32 s76, s76, 15
    s_lshl_b32 s11, s76, 13
    v_mfma_f32_32x32x16_bf16 v[32:47], v[116:119], v[128:131], v[32:47]
    ds_read_b64_tr_b16 v[108:109], v81 offset:4096
    ds_read_b64_tr_b16 v[110:111], v81 offset:5120
    s_waitcnt vmcnt(11) lgkmcnt(4)
    v_mfma_f32_32x32x16_bf16 v[16:31], v[120:123], v[132:135], v[16:31]
    ds_read_b64_tr_b16 v[112:113], v80 offset:6144
    ds_read_b64_tr_b16 v[114:115], v80 offset:7168
    buffer_load_dwordx4 v[180:183], v14, s[40:43], s35 offen offset:2048 sc1
    v_mfma_f32_32x32x16_bf16 v[32:47], v[124:127], v[132:135], v[32:47]
    ds_read_b64_tr_b16 v[116:117], v81 offset:6144
    ds_read_b64_tr_b16 v[118:119], v81 offset:7168
    v_add_u32 v82, s9, v72
    v_add_u32 v83, s9, v73
    s_waitcnt vmcnt(11) lgkmcnt(4)
    v_mfma_f32_32x32x16_bf16 v[16:31], v[104:107], v[136:139], v[16:31]
    ds_read_b32 v79, v8 offset:25984
    ds_read_b64_tr_b16 v[120:121], v82 offset:0
    ds_read_b64_tr_b16 v[122:123], v82 offset:1024
    buffer_load_dwordx4 v[184:187], v78, s[40:43], s35 offen offset:0 sc1
    v_mfma_f32_32x32x16_bf16 v[32:47], v[108:111], v[136:139], v[32:47]
    ds_read_b64_tr_b16 v[124:125], v83 offset:0
    ds_read_b64_tr_b16 v[126:127], v83 offset:1024
    s_waitcnt vmcnt(11) lgkmcnt(4)
    v_mfma_f32_32x32x16_bf16 v[16:31], v[112:115], v[140:143], v[16:31]
    ds_read_b64_tr_b16 v[104:105], v82 offset:2048
    ds_read_b64_tr_b16 v[106:107], v82 offset:3072
    buffer_load_dwordx4 v[188:191], v78, s[40:43], s35 offen offset:2048 sc1
    v_mfma_f32_32x32x16_bf16 v[32:47], v[116:119], v[140:143], v[32:47]
    ds_read_b64_tr_b16 v[108:109], v83 offset:2048
    ds_read_b64_tr_b16 v[110:111], v83 offset:3072
    v_readfirstlane_b32 s76, v79
    s_nop 0
    s_and_b32 s76, s76, s52
    s_cbranch_scc0 L_tr8
L_bk8:
    s_ff1_i32_b32 s76, s76
    s_bitset0_b32 s52, s76
    s_add_u32 s77, s76, s65
    s_and_b32 s77, s77, 15
    s_mul_i32 s77, s77, 32768
    s_add_u32 s36, s77, s80
    s_waitcnt vmcnt(11) lgkmcnt(4)
    v_mfma_f32_32x32x16_bf16 v[16:31], v[120:123], v[144:147], v[16:31]
    ds_read_b64_tr_b16 v[112:113], v82 offset:4096
    ds_read_b64_tr_b16 v[114:115], v82 offset:5120
    buffer_load_dwordx4 v[128:131], v14, s[40:43], s36 offen offset:0 sc1
    s_add_u32 s76, s76, 3
    s_and_b32 s76, s76, 15
    s_lshl_b32 s12, s76, 13
    v_mfma_f32_32x32x16_bf16 v[32:47], v[124:127], v[144:147], v[32:47]
    ds_read_b64_tr_b16 v[116:117], v83 offset:4096
    ds_read_b64_tr_b16 v[118:119], v83 offset:5120
    s_waitcnt vmcnt(11) lgkmcnt(4)
    v_mfma_f32_32x32x16_bf16 v[16:31], v[104:107], v[148:151], v[16:31]
    ds_read_b64_tr_b16 v[120:121], v82 offset:6144
    ds_read_b64_tr_b16 v[122:123], v82 offset:7168
    buffer_load_dwordx4 v[132:135], v14, s[40:43], s36 offen offset:2048 sc1
    v_mfma_f32_32x32x16_bf16 v[32:47], v[108:111], v[148:151], v[32:47]
    ds_read_b64_tr_b16 v[124:125], v83 offset:6144
    ds_read_b64_tr_b16 v[126:127], v83 offset:7168
    v_add_u32 v80, s10, v72
    v_add_u32 v81, s10, v73
    s_waitcnt vmcnt(11) lgkmcnt(4)
    v_mfma_f32_32x32x16_bf16 v[16:31], v[112:115], v[152:155], v[16:31]
    ds_read_b32 v79, v8 offset:25984
    ds_read_b64_tr_b16 v[104:105], v80 offset:0
    ds_read_b64_tr_b16 v[106:107], v80 offset:1024
    buffer_load_dwordx4 v[136:139], v78, s[40:43], s36 offen offset:0 sc1
    v_mfma_f32_32x32x16_bf16 v[32:47], v[116:119], v[152:155], v[32:47]
    ds_read_b64_tr_b16 v[108:109], v81 offset:0
    ds_read_b64_tr_b16 v[110:111], v81 offset:1024
    s_waitcnt vmcnt(11) lgkmcnt(4)
    v_mfma_f32_32x32x16_bf16 v[16:31], v[120:123], v[156:159], v[16:31]
    ds_read_b64_tr_b16 v[112:113], v80 offset:2048
    ds_read_b64_tr_b16 v[114:115], v80 offset:3072
    buffer_load_dwordx4 v[140:143], v78, s[40:43], s36 offen offset:2048 sc1
    v_mfma_f32_32x32x16_bf16 v[32:47], v[124:127], v[156:159], v[32:47]
    ds_read_b64_tr_b16 v[116:117], v81 offset:2048
    ds_read_b64_tr_b16 v[118:119], v81 offset:3072
    v_readfirstlane_b32 s76, v79
    s_nop 0
    s_and_b32 s76, s76, s52
    s_cbranch_scc0 L_tr9
L_bk9:
    s_ff1_i32_b32 s76, s76
    s_bitset0_b32 s52, s76
    s_add_u32 s77, s76, s65
    s_and_b32 s77, s77, 15
    s_mul_i32 s77, s77, 32768
    s_add_u32 s37, s77, s80
    s_waitcnt vmcnt(11) lgkmcnt(4)
    v_mfma_f32_32x32x16_bf16 v[16:31], v[104:107], v[160:163], v[16:31]
    ds_read_b64_tr_b16 v[120:121], v80 offset:4096
    ds_read_b64_tr_b16 v[122:123], v80 offset:5120
    buffer_load_dwordx4 v[144:147], v14, s[40:43], s37 offen offset:0 sc1
    s_add_u32 s76, s76, 3
    s_and_b32 s76, s76, 15
    s_lshl_b32 s13, s76, 13
    v_mfma_f32_32x32x16_bf16 v[32:47], v[108:111], v[160:163], v[32:47]
    ds_read_b64_tr_b16 v[124:125], v81 offset:4096
    ds_read_b64_tr_b16 v[126:127], v81 offset:5120
    s_waitcnt vmcnt(11) lgkmcnt(4)
    v_mfma_f32_32x32x16_bf16 v[16:31], v[112:115], v[164:167], v[16:31]
    ds_read_b64_tr_b16 v[104:105], v80 offset:6144
    ds_read_b64_tr_b16 v[106:107], v80 offset:7168
    buffer_load_dwordx4 v[148:151], v14, s[40:43], s37 offen offset:2048 sc1
    v_mfma_f32_32x32x16_bf16 v[32:47], v[116:119], v[164:167], v[32:47]
    ds_read_b64_tr_b16 v[108:109], v81 offset:6144
    ds_read_b64_tr_b16 v[110:111], v81 offset:7168
    v_add_u32 v82, s11, v72
    v_add_u32 v83, s11, v73
    s_waitcnt vmcnt(11) lgkmcnt(4)
    v_mfma_f32_32x32x16_bf16 v[16:31], v[120:123], v[168:171], v[16:31]
    ds_read_b32 v79, v8 offset:25984
    ds_read_b64_tr_b16 v[112:113], v82 offset:0
    ds_read_b64_tr_b16 v[114:115], v82 offset:1024
    buffer_load_dwordx4 v[152:155], v78, s[40:43], s37 offen offset:0 sc1
    v_mfma_f32_32x32x16_bf16 v[32:47], v[124:127], v[168:171], v[32:47]
    ds_read_b64_tr_b16 v[116:117], v83 offset:0
    ds_read_b64_tr_b16 v[118:119], v83 offset:1024
    s_waitcnt vmcnt(11) lgkmcnt(4)
    v_mfma_f32_32x32x16_bf16 v[16:31], v[104:107], v[172:175], v[16:31]
    ds_read_b64_tr_b16 v[120:121], v82 offset:2048
    ds_read_b64_tr_b16 v[122:123], v82 offset:3072
    buffer_load_dwordx4 v[156:159], v78, s[40:43], s37 offen offset:2048 sc1
    v_mfma_f32_32x32x16_bf16 v[32:47], v[108:111], v[172:175], v[32:47]
    ds_read_b64_tr_b16 v[124:125], v83 offset:2048
    ds_read_b64_tr_b16 v[126:127], v83 offset:3072
    v_readfirstlane_b32 s76, v79
    s_nop 0
    s_and_b32 s76, s76, s52
    s_cbranch_scc0 L_tr10
L_bk10:
    s_ff1_i32_b32 s76, s76
    s_bitset0_b32 s52, s76
    s_add_u32 s77, s76, s65
    s_and_b32 s77, s77, 15
    s_mul_i32 s77, s77, 32768
    s_add_u32 s38, s77, s80
    s_waitcnt vmcnt(11) lgkmcnt(4)
    v_mfma_f32_32x32x16_bf16 v[16:31], v[112:115], v[176:179], v[16:31]
    ds_read_b64_tr_b16 v[104:105], v82 offset:4096
    ds_read_b64_tr_b16 v[106:107], v82 offset:5120
    buffer_load_dwordx4 v[160:163], v14, s[40:43], s38 offen offset:0 sc1
    s_add_u32 s76, s76, 3
    s_and_b32 s76, s76, 15
    s_lshl_b32 s14, s76, 13
    v_mfma_f32_32x32x16_bf16 v[32:47], v[116:119], v[176:179], v[32:47]
    ds_read_b64_tr_b16 v[108:109], v83 offset:4096
    ds_read_b64_tr_b16 v[110:111], v83 offset:5120
    s_waitcnt vmcnt(11) lgkmcnt(4)
    v_mfma_f32_32x32x16_bf16 v[16:31], v[120:123], v[180:183], v[16:31]
    ds_read_b64_tr_b16 v[112:113], v82 offset:6144
    ds_read_b64_tr_b16 v[114:115], v82 offset:7168
    buffer_load_dwordx4 v[164:167], v14, s[40:43], s38 offen offset:2048 sc1
    v_mfma_f32_32x32x16_bf16 v[32:47], v[124:127], v[180:183], v[32:47]
    ds_read_b64_tr_b16 v[116:117], v83 offset:6144
    ds_read_b64_tr_b16 v[118:119], v83 offset:7168
    v_add_u32 v80, s12, v72
    v_add_u32 v81, s12, v73
    s_waitcnt vmcnt(11) lgkmcnt(4)
    v_mfma_f32_32x32x16_bf16 v[16:31], v[104:107], v[184:187], v[16:31]
    ds_read_b32 v79, v8 offset:25984
    ds_read_b64_tr_b16 v[120:121], v80 offset:0
    ds_read_b64_tr_b16 v[122:123], v80 offset:1024
    buffer_load_dwordx4 v[168:171], v78, s[40:43], s38 offen offset:0 sc1
    v_mfma_f32_32x32x16_bf16 v[32:47], v[108:111], v[184:187], v[32:47]
    ds_read_b64_tr_b16 v[124:125], v81 offset:0
    ds_read_b64_tr_b16 v[126:127], v81 offset:1024
    s_waitcnt vmcnt(11) lgkmcnt(4)
    v_mfma_f32_32x32x16_bf16 v[16:31], v[112:115], v[188:191], v[16:31]
    ds_read_b64_tr_b16 v[104:105], v80 offset:2048
    ds_read_b64_tr_b16 v[106:107], v80 offset:3072
    buffer_load_dwordx4 v[172:175], v78, s[40:43], s38 offen offset:2048 sc1
    v_mfma_f32_32x32x16_bf16 v[32:47], v[116:119], v[188:191], v[32:47]
    ds_read_b64_tr_b16 v[108:109], v81 offset:2048
    ds_read_b64_tr_b16 v[110:111], v81 offset:3072
    v_readfirstlane_b32 s76, v79
    s_nop 0
    s_and_b32 s76, s76, s52
    s_cbranch_scc0 L_tr11
L_bk11:
    s_ff1_i32_b32 s76, s76
    s_bitset0_b32 s52, s76
    s_add_u32 s77, s76, s65
    s_and_b32 s77, s77, 15
    s_mul_i32 s77, s77, 32768
    s_add_u32 s39, s77, s80
    s_waitcnt vmcnt(11) lgkmcnt(4)
    v_mfma_f32_32x32x16_bf16 v[16:31], v[120:123], v[128:131], v[16:31]
    ds_read_b64_tr_b16 v[112:113], v80 offset:4096
    ds_read_b64_tr_b16 v[114:115], v80 offset:5120
    buffer_load_dwordx4 v[176:179], v14, s[40:43], s39 offen offset:0 sc1
    s_add_u32 s76, s76, 3
    s_and_b32 s76, s76, 15
    s_lshl_b32 s15, s76, 13
    v_mfma_f32_32x32x16_bf16 v[32:47], v[124:127], v[128:131], v[32:47]
    ds_read_b64_tr_b16 v[116:117], v81 offset:4096
    ds_read_b64_tr_b16 v[118:119], v81 offset:5120
    s_waitcnt vmcnt(11) lgkmcnt(4)
    v_mfma_f32_32x32x16_bf16 v[16:31], v[104:107], v[132:135], v[16:31]
    ds_read_b64_tr_b16 v[120:121], v80 offset:6144
    ds_read_b64_tr_b16 v[122:123], v80 offset:7168
    buffer_load_dwordx4 v[180:183], v14, s[40:43], s39 offen offset:2048 sc1
    v_mfma_f32_32x32x16_bf16 v[32:47], v[108:111], v[132:135], v[32:47]
    ds_read_b64_tr_b16 v[124:125], v81 offset:6144
    ds_read_b64_tr_b16 v[126:127], v81 offset:7168
    v_add_u32 v82, s13, v72
    v_add_u32 v83, s13, v73
    s_waitcnt vmcnt(11) lgkmcnt(4)
    v_mfma_f32_32x32x16_bf16 v[16:31], v[112:115], v[136:139], v[16:31]
    ds_read_b32 v79, v8 offset:25984
    ds_read_b64_tr_b16 v[104:105], v82 offset:0
    ds_read_b64_tr_b16 v[106:107], v82 offset:1024
    buffer_load_dwordx4 v[184:187], v78, s[40:43], s39 offen offset:0 sc1
    v_mfma_f32_32x32x16_bf16 v[32:47], v[116:119], v[136:139], v[32:47]
    ds_read_b64_tr_b16 v[108:109], v83 offset:0
    ds_read_b64_tr_b16 v[110:111], v83 offset:1024
    s_waitcnt vmcnt(11) lgkmcnt(4)
    v_mfma_f32_32x32x16_bf16 v[16:31], v[120:123], v[140:143], v[16:31]
    ds_read_b64_tr_b16 v[112:113], v82 offset:2048
    ds_read_b64_tr_b16 v[114:115], v82 offset:3072
    buffer_load_dwordx4 v[188:191], v78, s[40:43], s39 offen offset:2048 sc1
    v_mfma_f32_32x32x16_bf16 v[32:47], v[124:127], v[140:143], v[32:47]
    ds_read_b64_tr_b16 v[116:117], v83 offset:2048
    ds_read_b64_tr_b16 v[118:119], v83 offset:3072
    v_readfirstlane_b32 s76, v79
    s_nop 0
    s_and_b32 s76, s76, s52
    s_cbranch_scc0 L_tr12
L_bk12:
    s_ff1_i32_b32 s76, s76
    s_bitset0_b32 s52, s76
    s_add_u32 s77, s76, s65
    s_and_b32 s77, s77, 15
    s_mul_i32 s77, s77, 32768
    s_add_u32 s48, s77, s80
    s_waitcnt vmcnt(11) lgkmcnt(4)
    v_mfma_f32_32x32x16_bf16 v[16:31], v[104:107], v[144:147], v[16:31]
    ds_read_b64_tr_b16 v[120:121], v82 offset:4096
    ds_read_b64_tr_b16 v[122:123], v82 offset:5120
    buffer_load_dwordx4 v[128:131], v14, s[40:43], s48 offen offset:0 sc1
    s_add_u32 s76, s76, 3
    s_and_b32 s76, s76, 15
    s_lshl_b32 s16, s76, 13
    v_mfma_f32_32x32x16_bf16 v[32:47], v[108:111], v[144:147], v[32:47]
    ds_read_b64_tr_b16 v[124:125], v83 offset:4096
    ds_read_b64_tr_b16 v[126:127], v83 offset:5120
    s_waitcnt vmcnt(11) lgkmcnt(4)
    v_mfma_f32_32x32x16_bf16 v[16:31], v[112:115], v[148:151], v[16:31]
    ds_read_b64_tr_b16 v[104:105], v82 offset:6144
    ds_read_b64_tr_b16 v[106:107], v82 offset:7168
    buffer_load_dwordx4 v[132:135], v14, s[40:43], s48 offen offset:2048 sc1
    v_mfma_f32_32x32x16_bf16 v[32:47], v[116:119], v[148:151], v[32:47]
    ds_read_b64_tr_b16 v[108:109], v83 offset:6144
    ds_read_b64_tr_b16 v[110:111], v83 offset:7168
    v_add_u32 v80, s14, v72
    v_add_u32 v81, s14, v73
    s_waitcnt vmcnt(11) lgkmcnt(4)
    v_mfma_f32_32x32x16_bf16 v[16:31], v[120:123], v[152:155], v[16:31]
    ds_read_b32 v79, v8 offset:25984
    ds_read_b64_tr_b16 v[112:113], v80 offset:0
    ds_read_b64_tr_b16 v[114:115], v80 offset:1024
    buffer_load_dwordx4 v[136:139], v78, s[40:43], s48 offen offset:0 sc1
    v_mfma_f32_32x32x16_bf16 v[32:47], v[124:127], v[152:155], v[32:47]
    ds_read_b64_tr_b16 v[116:117], v81 offset:0
    ds_read_b64_tr_b16 v[118:119], v81 offset:1024
    s_waitcnt vmcnt(11) lgkmcnt(4)
    v_mfma_f32_32x32x16_bf16 v[16:31], v[104:107], v[156:159], v[16:31]
    ds_read_b64_tr_b16 v[120:121], v80 offset:2048
    ds_read_b64_tr_b16 v[122:123], v80 offset:3072
    buffer_load_dwordx4 v[140:143], v78, s[40:43], s48 offen offset:2048 sc1
    v_mfma_f32_32x32x16_bf16 v[32:47], v[108:111], v[156:159], v[32:47]
    ds_read_b64_tr_b16 v[124:125], v81 offset:2048
    ds_read_b64_tr_b16 v[126:127], v81 offset:3072
    v_readfirstlane_b32 s76, v79
    s_nop 0
    s_and_b32 s76, s76, s52
    s_cbranch_scc0 L_tr13
L_bk13:
    s_ff1_i32_b32 s76, s76
    s_bitset0_b32 s52, s76
    s_add_u32 s77, s76, s65
    s_and_b32 s77, s77, 15
    s_mul_i32 s77, s77, 32768
    s_add_u32 s49, s77, s80
    s_waitcnt vmcnt(11) lgkmcnt(4)
    v_mfma_f32_32x32x16_bf16 v[16:31], v[112:115], v[160:163], v[16:31]
    ds_read_b64_tr_b16 v[104:105], v80 offset:4096
    ds_read_b64_tr_b16 v[106:107], v80 offset:5120
    buffer_load_dwordx4 v[144:147], v14, s[40:43], s49 offen offset:0 sc1
    s_add_u32 s76, s76, 3
    s_and_b32 s76, s76, 15
    s_lshl_b32 s17, s76, 13
    v_mfma_f32_32x32x16_bf16 v[32:47], v[116:119], v[160:163], v[32:47]
    ds_read_b64_tr_b16 v[108:109], v81 offset:4096
    ds_read_b64_tr_b16 v[110:111], v81 offset:5120
    s_waitcnt vmcnt(11) lgkmcnt(4)
    v_mfma_f32_32x32x16_bf16 v[16:31], v[120:123], v[164:167], v[16:31]
    ds_read_b64_tr_b16 v[112:113], v80 offset:6144
    ds_read_b64_tr_b16 v[114:115], v80 offset:7168
    buffer_load_dwordx4 v[148:151], v14, s[40:43], s49 offen offset:2048 sc1
    v_mfma_f32_32x32x16_bf16 v[32:47], v[124:127], v[164:167], v[32:47]
    ds_read_b64_tr_b16 v[116:117], v81 offset:6144
    ds_read_b64_tr_b16 v[118:119], v81 offset:7168
    v_add_u32 v82, s15, v72
    v_add_u32 v83, s15, v73
    s_waitcnt vmcnt(11) lgkmcnt(4)
    v_mfma_f32_32x32x16_bf16 v[16:31], v[104:107], v[168:171], v[16:31]
    ds_read_b32 v79, v8 offset:25984
    ds_read_b64_tr_b16 v[120:121], v82 offset:0
    ds_read_b64_tr_b16 v[122:123], v82 offset:1024
    buffer_load_dwordx4 v[152:155], v78, s[40:43], s49 offen offset:0 sc1
    v_mfma_f32_32x32x16_bf16 v[32:47], v[108:111], v[168:171], v[32:47]
    ds_read_b64_tr_b16 v[124:125], v83 offset:0
    ds_read_b64_tr_b16 v[126:127], v83 offset:1024
    s_waitcnt vmcnt(11) lgkmcnt(4)
    v_mfma_f32_32x32x16_bf16 v[16:31], v[112:115], v[172:175], v[16:31]
    ds_read_b64_tr_b16 v[104:105], v82 offset:2048
    ds_read_b64_tr_b16 v[106:107], v82 offset:3072
    buffer_load_dwordx4 v[156:159], v78, s[40:43], s49 offen offset:2048 sc1
    v_mfma_f32_32x32x16_bf16 v[32:47], v[116:119], v[172:175], v[32:47]
    ds_read_b64_tr_b16 v[108:109], v83 offset:2048
    ds_read_b64_tr_b16 v[110:111], v83 offset:3072
    v_readfirstlane_b32 s76, v79
    s_nop 0
    s_and_b32 s76, s76, s52
    s_cbranch_scc0 L_tr14
L_bk14:
    s_ff1_i32_b32 s76, s76
    s_bitset0_b32 s52, s76
    s_add_u32 s77, s76, s65
    s_and_b32 s77, s77, 15
    s_mul_i32 s77, s77, 32768
    s_add_u32 s50, s77, s80
    s_waitcnt vmcnt(11) lgkmcnt(4)
    v_mfma_f32_32x32x16_bf16 v[16:31], v[120:123], v[176:179], v[16:31]
    ds_read_b64_tr_b16 v[112:113], v82 offset:4096
    ds_read_b64_tr_b16 v[114:115], v82 offset:5120
    buffer_load_dwordx4 v[160:163], v14, s[40:43], s50 offen offset:0 sc1
    s_add_u32 s76, s76, 3
    s_and_b32 s76, s76, 15
    s_lshl_b32 s18, s76, 13
    v_mfma_f32_32x32x16_bf16 v[32:47], v[124:127], v[176:179], v[32:47]
    ds_read_b64_tr_b16 v[116:117], v83 offset:4096
    ds_read_b64_tr_b16 v[118:119], v83 offset:5120
    s_waitcnt vmcnt(11) lgkmcnt(4)
    v_mfma_f32_32x32x16_bf16 v[16:31], v[104:107], v[180:183], v[16:31]
    ds_read_b64_tr_b16 v[120:121], v82 offset:6144
    ds_read_b64_tr_b16 v[122:123], v82 offset:7168
    buffer_load_dwordx4 v[164:167], v14, s[40:43], s50 offen offset:2048 sc1
    v_mfma_f32_32x32x16_bf16 v[32:47], v[108:111], v[180:183], v[32:47]
    ds_read_b64_tr_b16 v[124:125], v83 offset:6144
    ds_read_b64_tr_b16 v[126:127], v83 offset:7168
    v_add_u32 v80, s16, v72
    v_add_u32 v81, s16, v73
    s_waitcnt vmcnt(11) lgkmcnt(4)
    v_mfma_f32_32x32x16_bf16 v[16:31], v[112:115], v[184:187], v[16:31]
    ds_read_b32 v79, v8 offset:25984
    ds_read_b64_tr_b16 v[104:105], v80 offset:0
    ds_read_b64_tr_b16 v[106:107], v80 offset:1024
    buffer_load_dwordx4 v[168:171], v78, s[40:43], s50 offen offset:0 sc1
    v_mfma_f32_32x32x16_bf16 v[32:47], v[116:119], v[184:187], v[32:47]
    ds_read_b64_tr_b16 v[108:109], v81 offset:0
    ds_read_b64_tr_b16 v[110:111], v81 offset:1024
    s_waitcnt vmcnt(11) lgkmcnt(4)
    v_mfma_f32_32x32x16_bf16 v[16:31], v[120:123], v[188:191], v[16:31]
    ds_read_b64_tr_b16 v[112:113], v80 offset:2048
    ds_read_b64_tr_b16 v[114:115], v80 offset:3072
    buffer_load_dwordx4 v[172:175], v78, s[40:43], s50 offen offset:2048 sc1
    v_mfma_f32_32x32x16_bf16 v[32:47], v[124:127], v[188:191], v[32:47]
    ds_read_b64_tr_b16 v[116:117], v81 offset:2048
    ds_read_b64_tr_b16 v[118:119], v81 offset:3072
    v_readfirstlane_b32 s76, v79
    s_nop 0
    s_and_b32 s76, s76, s52
    s_cbranch_scc0 L_tr15
L_bk15:
    s_ff1_i32_b32 s76, s76
    s_bitset0_b32 s52, s76
    s_add_u32 s77, s76, s65
    s_and_b32 s77, s77, 15
    s_mul_i32 s77, s77, 32768
    s_add_u32 s51, s77, s80
    s_waitcnt vmcnt(11) lgkmcnt(4)
    v_mfma_f32_32x32x16_bf16 v[16:31], v[104:107], v[128:131], v[16:31]
    ds_read_b64_tr_b16 v[120:121], v80 offset:4096
    ds_read_b64_tr_b16 v[122:123], v80 offset:5120
    buffer_load_dwordx4 v[176:179], v14, s[40:43], s51 offen offset:0 sc1
    s_add_u32 s76, s76, 3
    s_and_b32 s76, s76, 15
    s_lshl_b32 s19, s76, 13
    v_mfma_f32_32x32x16_bf16 v[32:47], v[108:111], v[128:131], v[32:47]
    ds_read_b64_tr_b16 v[124:125], v81 offset:4096
    ds_read_b64_tr_b16 v[126:127], v81 offset:5120
    s_waitcnt vmcnt(11) lgkmcnt(4)
    v_mfma_f32_32x32x16_bf16 v[16:31], v[112:115], v[132:135], v[16:31]
    ds_read_b64_tr_b16 v[104:105], v80 offset:6144
    ds_read_b64_tr_b16 v[106:107], v80 offset:7168
    buffer_load_dwordx4 v[180:183], v14, s[40:43], s51 offen offset:2048 sc1
    v_mfma_f32_32x32x16_bf16 v[32:47], v[116:119], v[132:135], v[32:47]
    ds_read_b64_tr_b16 v[108:109], v81 offset:6144
    ds_read_b64_tr_b16 v[110:111], v81 offset:7168
    v_add_u32 v82, s17, v72
    v_add_u32 v83, s17, v73
    s_waitcnt vmcnt(11) lgkmcnt(4)
    v_mfma_f32_32x32x16_bf16 v[16:31], v[120:123], v[136:139], v[16:31]
    ds_read_b64_tr_b16 v[112:113], v82 offset:0
    ds_read_b64_tr_b16 v[114:115], v82 offset:1024
    buffer_load_dwordx4 v[184:187], v78, s[40:43], s51 offen offset:0 sc1
    v_mfma_f32_32x32x16_bf16 v[32:47], v[124:127], v[136:139], v[32:47]
    ds_read_b64_tr_b16 v[116:117], v83 offset:0
    ds_read_b64_tr_b16 v[118:119], v83 offset:1024
    s_waitcnt vmcnt(11) lgkmcnt(4)
    v_mfma_f32_32x32x16_bf16 v[16:31], v[104:107], v[140:143], v[16:31]
    ds_read_b64_tr_b16 v[120:121], v82 offset:2048
    ds_read_b64_tr_b16 v[122:123], v82 offset:3072
    buffer_load_dwordx4 v[188:191], v78, s[40:43], s51 offen offset:2048 sc1
    s_barrier
    v_mfma_f32_32x32x16_bf16 v[32:47], v[108:111], v[140:143], v[32:47]
    ds_read_b64_tr_b16 v[124:125], v83 offset:2048
    ds_read_b64_tr_b16 v[126:127], v83 offset:3072
    s_waitcnt vmcnt(11) lgkmcnt(4)
    v_mfma_f32_32x32x16_bf16 v[16:31], v[112:115], v[144:147], v[16:31]
    ds_read_b64_tr_b16 v[104:105], v82 offset:4096
    ds_read_b64_tr_b16 v[106:107], v82 offset:5120
    v_mfma_f32_32x32x16_bf16 v[32:47], v[116:119], v[144:147], v[32:47]
    ds_read_b64_tr_b16 v[108:109], v83 offset:4096
    ds_read_b64_tr_b16 v[110:111], v83 offset:5120
    s_waitcnt vmcnt(10) lgkmcnt(4)
    v_mfma_f32_32x32x16_bf16 v[16:31], v[120:123], v[148:151], v[16:31]
    ds_read_b64_tr_b16 v[112:113], v82 offset:6144
    ds_read_b64_tr_b16 v[114:115], v82 offset:7168
    v_mfma_f32_32x32x16_bf16 v[32:47], v[124:127], v[148:151], v[32:47]
    ds_read_b64_tr_b16 v[116:117], v83 offset:6144
    ds_read_b64_tr_b16 v[118:119], v83 offset:7168
    v_add_u32 v80, s18, v72
    v_add_u32_e64 v81, s18, v73
    s_waitcnt vmcnt(9) lgkmcnt(4)
    v_mfma_f32_32x32x16_bf16 v[16:31], v[104:107], v[152:155], v[16:31]
    ds_read_b64_tr_b16 v[120:121], v80 offset:0
    ds_read_b64_tr_b16 v[122:123], v80 offset:1024
    v_mfma_f32_32x32x16_bf16 v[32:47], v[108:111], v[152:155], v[32:47]
    ds_read_b64_tr_b16 v[124:125], v81 offset:0
    ds_read_b64_tr_b16 v[126:127], v81 offset:1024
    s_waitcnt vmcnt(8) lgkmcnt(4)
    v_mfma_f32_32x32x16_bf16 v[16:31], v[112:115], v[156:159], v[16:31]
    ds_read_b64_tr_b16 v[104:105], v80 offset:2048
    ds_read_b64_tr_b16 v[106:107], v80 offset:3072
    v_mfma_f32_32x32x16_bf16 v[32:47], v[116:119], v[156:159], v[32:47]
    ds_read_b64_tr_b16 v[108:109], v81 offset:2048
    ds_read_b64_tr_b16 v[110:111], v81 offset:3072
    s_waitcnt vmcnt(7) lgkmcnt(4)
    v_mfma_f32_32x32x16_bf16 v[16:31], v[120:123], v[160:163], v[16:31]
    ds_read_b64_tr_b16 v[112:113], v80 offset:4096
    ds_read_b64_tr_b16 v[114:115], v80 offset:5120
    v_mfma_f32_32x32x16_bf16 v[32:47], v[124:127], v[160:163], v[32:47]
    ds_read_b64_tr_b16 v[116:117], v81 offset:4096
    ds_read_b64_tr_b16 v[118:119], v81 offset:5120
    s_waitcnt vmcnt(6) lgkmcnt(4)
    v_mfma_f32_32x32x16_bf16 v[16:31], v[104:107], v[164:167], v[16:31]
    ds_read_b64_tr_b16 v[120:121], v80 offset:6144
    ds_read_b64_tr_b16 v[122:123], v80 offset:7168
    v_mfma_f32_32x32x16_bf16 v[32:47], v[108:111], v[164:167], v[32:47]
    ds_read_b64_tr_b16 v[124:125], v81 offset:6144
    ds_read_b64_tr_b16 v[126:127], v81 offset:7168
    v_add_u32 v82, s19, v72
    v_add_u32 v83, s19, v73
    s_waitcnt vmcnt(5) lgkmcnt(4)
    v_mfma_f32_32x32x16_bf16 v[16:31], v[112:115], v[168:171], v[16:31]
    ds_read_b64_tr_b16 v[104:105], v82 offset:0
    ds_read_b64_tr_b16 v[106:107], v82 offset:1024
    v_mfma_f32_32x32x16_bf16 v[32:47], v[116:119], v[168:171], v[32:47]
    ds_read_b64_tr_b16 v[108:109], v83 offset:0
    ds_read_b64_tr_b16 v[110:111], v83 offset:1024
    s_waitcnt vmcnt(4) lgkmcnt(4)
    v_mfma_f32_32x32x16_bf16 v[16:31], v[120:123], v[172:175], v[16:31]
    ds_read_b64_tr_b16 v[112:113], v82 offset:2048
    ds_read_b64_tr_b16 v[114:115], v82 offset:3072
    v_mfma_f32_32x32x16_bf16 v[32:47], v[124:127], v[172:175], v[32:47]
    ds_read_b64_tr_b16 v[116:117], v83 offset:2048
    ds_read_b64_tr_b16 v[118:119], v83 offset:3072
    s_waitcnt vmcnt(3) lgkmcnt(4)
    v_mfma_f32_32x32x16_bf16 v[16:31], v[104:107], v[176:179], v[16:31]
    ds_read_b64_tr_b16 v[120:121], v82 offset:4096
    ds_read_b64_tr_b16 v[122:123], v82 offset:5120
    v_mfma_f32_32x32x16_bf16 v[32:47], v[108:111], v[176:179], v[32:47]
    ds_read_b64_tr_b16 v[124:125], v83 offset:4096
    ds_read_b64_tr_b16 v[126:127], v83 offset:5120
    s_waitcnt vmcnt(2) lgkmcnt(4)
    v_mfma_f32_32x32x16_bf16 v[16:31], v[112:115], v[180:183], v[16:31]
    ds_read_b64_tr_b16 v[104:105], v82 offset:6144
    ds_read_b64_tr_b16 v[106:107], v82 offset:7168
    v_mfma_f32_32x32x16_bf16 v[32:47], v[116:119], v[180:183], v[32:47]
    ds_read_b64_tr_b16 v[108:109], v83 offset:6144
    ds_read_b64_tr_b16 v[110:111], v83 offset:7168
    s_waitcnt vmcnt(1) lgkmcnt(4)
    v_mfma_f32_32x32x16_bf16 v[16:31], v[120:123], v[184:187], v[16:31]
    v_mfma_f32_32x32x16_bf16 v[32:47], v[124:127], v[184:187], v[32:47]
    s_waitcnt vmcnt(0) lgkmcnt(0)
    v_mfma_f32_32x32x16_bf16 v[16:31], v[104:107], v[188:191], v[16:31]
    v_mfma_f32_32x32x16_bf16 v[32:47], v[108:111], v[188:191], v[32:47]
    s_nop 10
    v_cvt_pk_bf16_f32 v88, v16, v17
    v_cvt_pk_bf16_f32 v89, v18, v19
    v_cvt_pk_bf16_f32 v90, v20, v21
    v_cvt_pk_bf16_f32 v91, v22, v23
    v_cvt_pk_bf16_f32 v92, v24, v25
    v_cvt_pk_bf16_f32 v93, v26, v27
    v_cvt_pk_bf16_f32 v94, v28, v29
    v_cvt_pk_bf16_f32 v95, v30, v31
    v_cvt_pk_bf16_f32 v96, v32, v33
    v_cvt_pk_bf16_f32 v97, v34, v35
    v_cvt_pk_bf16_f32 v98, v36, v37
    v_cvt_pk_bf16_f32 v99, v38, v39
    v_cvt_pk_bf16_f32 v100, v40, v41
    v_cvt_pk_bf16_f32 v101, v42, v43
    v_cvt_pk_bf16_f32 v102, v44, v45
    v_cvt_pk_bf16_f32 v103, v46, v47
    v_dot2_f32_bf16 v104, v88, s89, 0
    v_dot2_f32_bf16 v105, v88, v88, 0
    v_dot2_f32_bf16 v106, v88, v192, 0
    v_dot2_f32_bf16 v104, v89, s89, v104
    v_dot2_f32_bf16 v105, v89, v89, v105
    v_dot2_f32_bf16 v106, v89, v193, v106
    v_dot2_f32_bf16 v104, v90, s89, v104
    v_dot2_f32_bf16 v105, v90, v90, v105
    v_dot2_f32_bf16 v106, v90, v194, v106
    v_dot2_f32_bf16 v104, v91, s89, v104
    v_dot2_f32_bf16 v105, v91, v91, v105
    v_dot2_f32_bf16 v106, v91, v195, v106
    v_dot2_f32_bf16 v104, v92, s89, v104
    v_dot2_f32_bf16 v105, v92, v92, v105
    v_dot2_f32_bf16 v106, v92, v196, v106
    v_dot2_f32_bf16 v104, v93, s89, v104
    v_dot2_f32_bf16 v105, v93, v93, v105
    v_dot2_f32_bf16 v106, v93, v197, v106
    v_dot2_f32_bf16 v104, v94, s89, v104
    v_dot2_f32_bf16 v105, v94, v94, v105
    v_dot2_f32_bf16 v106, v94, v198, v106
    v_dot2_f32_bf16 v104, v95, s89, v104
    v_dot2_f32_bf16 v105, v95, v95, v105
    v_dot2_f32_bf16 v106, v95, v199, v106
    v_dot2_f32_bf16 v104, v96, s89, v104
    v_dot2_f32_bf16 v105, v96, v96, v105
    v_dot2_f32_bf16 v106, v96, v200, v106
    v_dot2_f32_bf16 v104, v97, s89, v104
    v_dot2_f32_bf16 v105, v97, v97, v105
    v_dot2_f32_bf16 v106, v97, v201, v106
    v_dot2_f32_bf16 v104, v98, s89, v104
    v_dot2_f32_bf16 v105, v98, v98, v105
    v_dot2_f32_bf16 v106, v98, v202, v106
    v_dot2_f32_bf16 v104, v99, s89, v104
    v_dot2_f32_bf16 v105, v99, v99, v105
    v_dot2_f32_bf16 v106, v99, v203, v106
    v_dot2_f32_bf16 v104, v100, s89, v104
    v_dot2_f32_bf16 v105, v100, v100, v105
    v_dot2_f32_bf16 v106, v100, v204, v106
    v_dot2_f32_bf16 v104, v101, s89, v104
    v_dot2_f32_bf16 v105, v101, v101, v105
    v_dot2_f32_bf16 v106, v101, v205, v106
    v_dot2_f32_bf16 v104, v102, s89, v104
    v_dot2_f32_bf16 v105, v102, v102, v105
    v_dot2_f32_bf16 v106, v102, v206, v106
    v_dot2_f32_bf16 v104, v103, s89, v104
    v_dot2_f32_bf16 v105, v103, v103, v105
    v_dot2_f32_bf16 v106, v103, v207, v106
    s_lshl_b32 s76, s62, 9
    s_add_u32 s77, s76, s99
    v_mov_b32 v107, 0
    v_mov_b32 v4, v104
    v_mov_b32 v5, v105
    v_mov_b32 v6, v106
    v_permlane32_swap_b32 v104, v4
    v_permlane32_swap_b32 v105, v5
    v_permlane32_swap_b32 v106, v6
    v_add_f32 v104, v104, v4
    v_add_f32 v105, v105, v5
    v_add_f32_e64 v106, v106, v6
    s_mov_b32 exec_hi, 0
    s_bitcmp1_b32 s100, 1
    s_cbranch_scc1 L_loc_65
    buffer_store_dwordx4 v[104:107], v12, s[40:43], s77 offen offset:1024 sc1
    s_branch L_pubd_66
L_loc_65:
    buffer_store_dwordx4 v[104:107], v12, s[40:43], s77 offen offset:1024
L_pubd_66:
    s_mov_b64 exec, -1
    ds_write_b64 v64, v[88:89]
    ds_write_b64 v65, v[90:91]
    ds_write_b64 v66, v[92:93]
    ds_write_b64 v67, v[94:95]
    ds_write_b64 v68, v[96:97]
    ds_write_b64 v69, v[98:99]
    ds_write_b64 v70, v[100:101]
    ds_write_b64 v71, v[102:103]
    v_bfe_u32 v4, v1, 1, 3
    v_bfe_u32 v5, v1, 4, 1
    v_lshlrev_b32_e64 v176, 4, v4
    v_lshl_add_u32 v176, v5, 3, v176
    v_and_b32_e64 v5, 1, v1
    v_lshl_add_u32 v176, v5, 2, v176
    v_lshlrev_b32_e64 v177, 2, v2
    v_lshl_add_u32 v177, v3, 8, v177
    v_and_b32 v4, 15, v1
    v_lshrrev_b32 v5, 4, v1
    v_mul_u32_u24 v179, 149504, v4
    v_lshl_add_u32 v180, v5, 4, v179
    s_lshl_b32 s82, s97, 7
    s_lshl_b32 s79, s62, 5
    s_add_u32 s82, s82, s79
    s_lshl_b32 s79, s62, 2
    v_mov_b32_e64 v7, s79
    v_mul_u32_u24 v178, 9344, v3
    v_lshl_add_u32 v178, v2, 4, v178
    s_mul_i32 s78, s97, 149504
    s_add_u32 s78, s78, s76
    s_add_u32 s78, s78, 8388608
    s_add_u32 s48, s78, 18688
    s_add_u32 s49, s48, 18688
    s_add_u32 s50, s49, 18688
    s_add_u32 s51, s50, 18688
    s_add_u32 s52, s51, 18688
    s_add_u32 s53, s52, 18688
    s_add_u32 s54, s53, 18688
    buffer_load_dwordx4 v[112:115], v178, s[40:43], s78 offen offset:1024 sc1
    buffer_load_dwordx4 v[116:119], v178, s[40:43], s48 offen offset:1024 sc1
    buffer_load_dwordx4 v[120:123], v178, s[40:43], s49 offen offset:1024 sc1
    buffer_load_dwordx4 v[124:127], v178, s[40:43], s50 offen offset:1024 sc1
    buffer_load_dwordx4 v[128:131], v178, s[40:43], s51 offen offset:1024 sc1
    buffer_load_dwordx4 v[132:135], v178, s[40:43], s52 offen offset:1024 sc1
    buffer_load_dwordx4 v[136:139], v178, s[40:43], s53 offen offset:1024 sc1
    buffer_load_dwordx4 v[140:143], v178, s[40:43], s54 offen offset:1024 sc1
    v_dot2_f32_bf16 v76, v208, s89, 0
    v_dot2_f32_bf16 v76, v209, s89, v76
    v_dot2_f32_bf16 v76, v210, s89, v76
    v_dot2_f32_bf16 v76, v211, s89, v76
    v_dot2_f32_bf16 v76, v212, s89, v76
    v_dot2_f32_bf16 v76, v213, s89, v76
    v_dot2_f32_bf16 v76, v214, s89, v76
    v_dot2_f32_bf16 v76, v215, s89, v76
    s_nop 2
    v_add_f32_dpp v76, v76, v76 row_ror:8 row_mask:0xf bank_mask:0xf
    s_nop 1
    v_add_f32_dpp v76, v76, v76 row_ror:4 row_mask:0xf bank_mask:0xf
    s_nop 1
    v_add_f32_dpp v76, v76, v76 row_ror:2 row_mask:0xf bank_mask:0xf
    s_nop 1
    v_add_f32_dpp v76, v76, v76 row_ror:1 row_mask:0xf bank_mask:0xf
    v_mov_b32 v4, v76
    s_nop 1
    v_permlane16_swap_b32 v76, v4
    v_add_f32 v76, v76, v4
    v_mov_b32 v4, v76
    s_nop 1
    v_permlane32_swap_b32 v76, v4
    v_add_f32_e64 v76, v76, v4
    s_mov_b32 s88, 0
    s_waitcnt vmcnt(6)
    v_pk_add_f32 v[108:109], v[112:113], v[116:117]
    v_pk_add_f32 v[110:111], v[114:115], v[118:119]
    s_waitcnt vmcnt(5)
    v_pk_add_f32 v[108:109], v[108:109], v[120:121]
    v_pk_add_f32 v[110:111], v[110:111], v[122:123]
    s_waitcnt vmcnt(4)
    v_pk_add_f32 v[108:109], v[108:109], v[124:125]
    v_pk_add_f32 v[110:111], v[110:111], v[126:127]
    s_waitcnt vmcnt(3)
    v_pk_add_f32 v[108:109], v[108:109], v[128:129]
    v_pk_add_f32 v[110:111], v[110:111], v[130:131]
    s_waitcnt vmcnt(2)
    v_pk_add_f32 v[108:109], v[108:109], v[132:133]
    v_pk_add_f32 v[110:111], v[110:111], v[134:135]
    s_waitcnt vmcnt(1)
    v_pk_add_f32 v[108:109], v[108:109], v[136:137]
    v_pk_add_f32 v[110:111], v[110:111], v[138:139]
    s_waitcnt vmcnt(0)
    v_pk_add_f32 v[108:109], v[108:109], v[140:141]
    v_pk_add_f32 v[110:111], v[110:111], v[142:143]
    v_cmp_u_f32 vcc, v111, v111
    v_mov_b32 v4, v108
    v_mov_b32 v5, v109
    v_mov_b32 v6, v110
    s_cbranch_vccnz L_s3_68
L_s3ok_69:
    v_permlane32_swap_b32 v108, v4
    v_permlane32_swap_b32 v109, v5
    v_permlane32_swap_b32 v110, v6
    s_barrier
    v_add_f32 v108, v108, v4
    v_add_f32 v109, v109, v5
    v_add_f32 v110, v110, v6
    v_mul_f32 v108, 0x3a800000, v108
    v_mul_f32 v109, 0x3a800000, v109
    v_fma_f32 v4, -v108, v108, v109
    v_max_f32_e64 v4, 0, v4
    v_cvt_pk_bf16_f32 v116, v108, v108
    v_and_b32_e64 v116, s90, v116
    v_cvt_pk_bf16_f32 v4, v4, v4
    v_and_b32_e64 v4, s90, v4
    v_add_f32 v4, 0x3727c5ac, v4
    v_cvt_pk_bf16_f32 v4, v4, v4
    v_and_b32 v4, s90, v4
    v_sqrt_f32_e64 v4, v4
    s_nop 0
    v_cvt_pk_bf16_f32 v4, v4, v4
    v_and_b32 v4, s90, v4
    v_rcp_f32 v118, v4
    v_fma_f32 v120, -v116, v76, v110
    v_mul_f32 v119, v116, v118
    v_mul_f32 v120, v120, v118
    v_and_b32 v6, 3, v1
    v_lshlrev_b32 v6, 2, v6
    v_max_f32_dpp v4, v120, v120 row_ror:8 row_mask:0xf bank_mask:0xf
    s_lshl_b32 s83, s62, 12
    v_cmp_gt_u32 s[84:85], 32, v1
    v_max_f32_dpp v4, v4, v4 row_ror:4 row_mask:0xf bank_mask:0xf
    s_lshl_b32 s55, 1, s62
    s_sub_u32 s55, s55, 1
    v_max_f32_dpp v4, v4, v4 row_ror:2 row_mask:0xf bank_mask:0xf
    s_nop 1
    v_max_f32_dpp v4, v4, v4 row_ror:1 row_mask:0xf bank_mask:0xf
    v_mov_b32 v5, v4
    s_nop 1
    v_permlane16_swap_b32 v4, v5
    v_max_f32 v4, v4, v5
    v_cmp_eq_f32_e64 vcc, v4, v120
    ds_write_b32 v7, v4 offset:25600
    s_ff1_i32_b32 s77, vcc_lo
    s_and_b32 s77, s77, 31
    s_bfe_u32 s79, s77, 0x30001
    s_lshl3_add_u32 s79, s77, s79
    s_lshl4_add_u32 s79, s79, s83
    v_xor_b32_e64 v176, s79, v176
    ds_read_b32 v182, v176 offset:0
    s_waitcnt lgkmcnt(1)
    s_barrier
    ds_read_b32 v8, v6 offset:25600
    v_readlane_b32 s80, v118, s77
    v_readlane_b32 s81, v119, s77
    s_add_u32 s79, s82, s77
    v_writelane_b32 v4, s79, 33
    v_mov_b32 v5, s81
    s_waitcnt lgkmcnt(1)
    v_lshlrev_b32 v184, 16, v182
    v_and_b32_e64 v185, s90, v182
    v_fma_f32 v184, v184, s80, -v5
    v_fma_f32 v185, v185, s80, -v5
    v_cvt_pk_bf16_f32 v184, v184, v185
    v_cndmask_b32 v184, v4, v184, s[84:85]
    s_waitcnt lgkmcnt(0)
    v_cmp_eq_f32 s[56:57], v8, v4
    v_cmp_gt_f32 vcc, v8, v4
    s_and_b32 s56, s56, s55
    s_or_b32 s56, s56, vcc_lo
    s_cbranch_scc1 L_nopub_78
    buffer_store_dword v184, v177, s[40:43], s99 offen offset:0 sc1
L_nopub_78:
    v_lshlrev_b32 v16, 16, v88
    v_and_b32_e64 v17, s90, v88
    v_pk_fma_f32 v[144:145], v[16:17], v[118:119], v[118:119] op_sel:[0,0,1] op_sel_hi:[1,0,1] neg_lo:[0,0,1] neg_hi:[0,0,1]
    v_cvt_pk_bf16_f32 v124, v144, v145
    v_lshlrev_b32 v144, 16, v124
    v_and_b32 v145, s90, v124
    v_pk_add_f32 v[144:145], v[144:145], v[16:17]
    v_cvt_pk_bf16_f32 v124, v144, v145
    v_lshlrev_b32 v18, 16, v89
    v_and_b32 v19, s90, v89
    v_pk_fma_f32 v[146:147], v[18:19], v[118:119], v[118:119] op_sel:[0,0,1] op_sel_hi:[1,0,1] neg_lo:[0,0,1] neg_hi:[0,0,1]
    v_cvt_pk_bf16_f32 v125, v146, v147
    v_lshlrev_b32 v146, 16, v125
    v_and_b32 v147, s90, v125
    v_pk_add_f32 v[146:147], v[146:147], v[18:19]
    v_cvt_pk_bf16_f32 v125, v146, v147
    ds_write_b64 v64, v[124:125]
    v_lshlrev_b32 v20, 16, v90
    v_and_b32 v21, s90, v90
    v_pk_fma_f32 v[148:149], v[20:21], v[118:119], v[118:119] op_sel:[0,0,1] op_sel_hi:[1,0,1] neg_lo:[0,0,1] neg_hi:[0,0,1]
    v_cvt_pk_bf16_f32 v126, v148, v149
    v_lshlrev_b32 v148, 16, v126
    v_and_b32 v149, s90, v126
    v_pk_add_f32 v[148:149], v[148:149], v[20:21]
    v_cvt_pk_bf16_f32 v126, v148, v149
    v_lshlrev_b32 v22, 16, v91
    v_and_b32 v23, s90, v91
    v_pk_fma_f32 v[150:151], v[22:23], v[118:119], v[118:119] op_sel:[0,0,1] op_sel_hi:[1,0,1] neg_lo:[0,0,1] neg_hi:[0,0,1]
    v_cvt_pk_bf16_f32 v127, v150, v151
    v_lshlrev_b32 v150, 16, v127
    v_and_b32 v151, s90, v127
    v_pk_add_f32 v[150:151], v[150:151], v[22:23]
    v_cvt_pk_bf16_f32 v127, v150, v151
    ds_write_b64 v65, v[126:127]
    v_lshlrev_b32 v24, 16, v92
    v_and_b32 v25, s90, v92
    v_pk_fma_f32 v[152:153], v[24:25], v[118:119], v[118:119] op_sel:[0,0,1] op_sel_hi:[1,0,1] neg_lo:[0,0,1] neg_hi:[0,0,1]
    v_cvt_pk_bf16_f32 v128, v152, v153
    v_lshlrev_b32 v152, 16, v128
    v_and_b32 v153, s90, v128
    v_pk_add_f32 v[152:153], v[152:153], v[24:25]
    v_cvt_pk_bf16_f32 v128, v152, v153
    v_lshlrev_b32 v26, 16, v93
    v_and_b32 v27, s90, v93
    v_pk_fma_f32 v[154:155], v[26:27], v[118:119], v[118:119] op_sel:[0,0,1] op_sel_hi:[1,0,1] neg_lo:[0,0,1] neg_hi:[0,0,1]
    v_cvt_pk_bf16_f32 v129, v154, v155
    v_lshlrev_b32 v154, 16, v129
    v_and_b32 v155, s90, v129
    v_pk_add_f32 v[154:155], v[154:155], v[26:27]
    v_cvt_pk_bf16_f32 v129, v154, v155
    ds_write_b64 v66, v[128:129]
    v_lshlrev_b32 v28, 16, v94
    v_and_b32 v29, s90, v94
    v_pk_fma_f32 v[156:157], v[28:29], v[118:119], v[118:119] op_sel:[0,0,1] op_sel_hi:[1,0,1] neg_lo:[0,0,1] neg_hi:[0,0,1]
    v_cvt_pk_bf16_f32 v130, v156, v157
    v_lshlrev_b32 v156, 16, v130
    v_and_b32 v157, s90, v130
    v_pk_add_f32 v[156:157], v[156:157], v[28:29]
    v_cvt_pk_bf16_f32 v130, v156, v157
    v_lshlrev_b32 v30, 16, v95
    v_and_b32 v31, s90, v95
    v_pk_fma_f32 v[158:159], v[30:31], v[118:119], v[118:119] op_sel:[0,0,1] op_sel_hi:[1,0,1] neg_lo:[0,0,1] neg_hi:[0,0,1]
    v_cvt_pk_bf16_f32 v131, v158, v159
    v_lshlrev_b32 v158, 16, v131
    v_and_b32 v159, s90, v131
    v_pk_add_f32 v[158:159], v[158:159], v[30:31]
    v_cvt_pk_bf16_f32 v131, v158, v159
    ds_write_b64 v67, v[130:131]
    v_and_b32 v7, 15, v1
    v_lshlrev_b32 v7, 3, v7
    s_cmp_eq_u32 s62, 0
    s_cbranch_scc0 L_nos4_79
    s_mul_i32 s76, s98, 9344
    s_add_u32 s76, s76, 8388608
    s_mov_b32 s88, 0
L_poll_80:
    buffer_load_dwordx2 v[196:197], v179, s[40:43], s76 offen offset:256 sc1
    buffer_load_dwordx4 v[188:191], v180, s[40:43], s76 offen offset:0 sc1
    buffer_load_dwordx4 v[192:195], v180, s[40:43], s76 offen offset:64 sc1
    s_waitcnt vmcnt(0)
    v_max3_u32 v4, v196, v197, v188
    v_max3_u32 v4, v4, v189, v190
    v_max3_u32 v4, v4, v191, v192
    v_max3_u32 v4, v4, v193, v194
    v_max_u32 v4, v4, v195
    v_cmp_eq_u32_e64 vcc, -1, v4
    s_nop 0
    s_cbranch_vccz L_ok_81
    s_add_u32 s88, s88, 1
    s_cmp_lt_u32 s88, 65536
    s_cbranch_scc1 L_poll_80
L_ok_81:
    ds_write_b128 v12, v[188:191] offset:28672
    ds_write_b128 v12, v[192:195] offset:29696
    ds_write_b64 v7, v[196:197] offset:25728
L_nos4_79:
    s_waitcnt lgkmcnt(0)
    s_barrier
    ds_read_b64 v[8:9], v7 offset:25728
    s_waitcnt lgkmcnt(0)
    v_max_f32_dpp v4, v8, v8 row_ror:8 row_mask:0xf bank_mask:0xf
    s_nop 1
    v_max_f32_dpp v4, v4, v4 row_ror:4 row_mask:0xf bank_mask:0xf
    s_nop 1
    v_max_f32_dpp v4, v4, v4 row_ror:2 row_mask:0xf bank_mask:0xf
    s_nop 1
    v_max_f32_dpp v4, v4, v4 row_ror:1 row_mask:0xf bank_mask:0xf
    v_cmp_eq_f32 vcc, v4, v8
    s_nop 0
    s_ff1_i32_b32 s92, vcc_lo
    s_and_b32 s92, s92, 15
    s_nop 3
    v_readlane_b32 s91, v9, s92
    s_nop 0
    s_cmp_eq_u32 s91, s79
    s_cbranch_scc0 L_noh_82
    s_mov_b32 exec_hi, 0
    buffer_store_dword v182, v177, s[40:43], s99 offen offset:128 sc1
    s_mov_b64 exec, -1
L_noh_82:
    s_sub_u32 s77, s91, s82
    v_lshrrev_b32 v7, 3, v1
    v_sub_u32 v5, s77, v7
    v_mov_b32 v6, 2146435072
    v_and_b32 v8, 7, v1
    v_lshrrev_b32 v9, 4, v1
    v_xor_b32 v8, v8, v9
    v_lshlrev_b32 v8, 4, v8
    v_lshl_add_u32 v7, v7, 11, v8
    v_xor_b32 v8, 64, v7
    s_lshl_b32 s76, s82, 11
    s_lshl_b32 s79, s98, 7
    s_add_u32 s76, s76, s79
    v_cmp_eq_u32 vcc, 0, v5
    s_nop 1
    v_cndmask_b32 v200, v7, v6, vcc
    v_cmp_eq_u32 vcc, 8, v5
    s_nop 1
    v_cndmask_b32 v201, v8, v6, vcc
    v_cmp_eq_u32 vcc, 16, v5
    s_nop 1
    v_cndmask_b32 v202, v7, v6, vcc
    v_cmp_eq_u32 vcc, 24, v5
    s_nop 1
    v_cndmask_b32 v203, v8, v6, vcc
    v_lshlrev_b32 v32, 16, v96
    v_and_b32 v33, s90, v96
    v_pk_fma_f32 v[160:161], v[32:33], v[118:119], v[118:119] op_sel:[0,0,1] op_sel_hi:[1,0,1] neg_lo:[0,0,1] neg_hi:[0,0,1]
    v_cvt_pk_bf16_f32 v132, v160, v161
    v_lshlrev_b32 v160, 16, v132
    v_and_b32 v161, s90, v132
    v_pk_add_f32 v[160:161], v[160:161], v[32:33]
    v_cvt_pk_bf16_f32 v132, v160, v161
    v_lshlrev_b32 v34, 16, v97
    v_and_b32 v35, s90, v97
    v_pk_fma_f32 v[162:163], v[34:35], v[118:119], v[118:119] op_sel:[0,0,1] op_sel_hi:[1,0,1] neg_lo:[0,0,1] neg_hi:[0,0,1]
    v_cvt_pk_bf16_f32 v133, v162, v163
    v_lshlrev_b32 v162, 16, v133
    v_and_b32 v163, s90, v133
    v_pk_add_f32 v[162:163], v[162:163], v[34:35]
    v_cvt_pk_bf16_f32 v133, v162, v163
    ds_write_b64 v68, v[132:133]
    v_lshlrev_b32 v36, 16, v98
    v_and_b32 v37, s90, v98
    v_pk_fma_f32 v[164:165], v[36:37], v[118:119], v[118:119] op_sel:[0,0,1] op_sel_hi:[1,0,1] neg_lo:[0,0,1] neg_hi:[0,0,1]
    v_cvt_pk_bf16_f32 v134, v164, v165
    v_lshlrev_b32 v164, 16, v134
    v_and_b32 v165, s90, v134
    v_pk_add_f32 v[164:165], v[164:165], v[36:37]
    v_cvt_pk_bf16_f32 v134, v164, v165
    v_lshlrev_b32 v38, 16, v99
    v_and_b32 v39, s90, v99
    v_pk_fma_f32 v[166:167], v[38:39], v[118:119], v[118:119] op_sel:[0,0,1] op_sel_hi:[1,0,1] neg_lo:[0,0,1] neg_hi:[0,0,1]
    v_cvt_pk_bf16_f32 v135, v166, v167
    v_lshlrev_b32 v166, 16, v135
    v_and_b32 v167, s90, v135
    v_pk_add_f32 v[166:167], v[166:167], v[38:39]
    v_cvt_pk_bf16_f32 v135, v166, v167
    ds_write_b64 v69, v[134:135]
    s_lshl_b32 s77, s62, 12
    s_add_u32 s77, s77, 0
    v_add_u32 v4, s77, v12
    s_barrier
    v_lshlrev_b32 v40, 16, v100
    v_and_b32 v41, s90, v100
    v_pk_fma_f32 v[168:169], v[40:41], v[118:119], v[118:119] op_sel:[0,0,1] op_sel_hi:[1,0,1] neg_lo:[0,0,1] neg_hi:[0,0,1]
    v_cvt_pk_bf16_f32 v136, v168, v169
    v_lshlrev_b32 v168, 16, v136
    v_and_b32 v169, s90, v136
    v_pk_add_f32 v[168:169], v[168:169], v[40:41]
    v_cvt_pk_bf16_f32 v136, v168, v169
    v_lshlrev_b32 v42, 16, v101
    v_and_b32 v43, s90, v101
    v_pk_fma_f32 v[170:171], v[42:43], v[118:119], v[118:119] op_sel:[0,0,1] op_sel_hi:[1,0,1] neg_lo:[0,0,1] neg_hi:[0,0,1]
    v_cvt_pk_bf16_f32 v137, v170, v171
    v_lshlrev_b32 v170, 16, v137
    v_and_b32 v171, s90, v137
    v_pk_add_f32 v[170:171], v[170:171], v[42:43]
    v_cvt_pk_bf16_f32 v137, v170, v171
    ds_write_b64 v70, v[136:137]
    v_lshlrev_b32 v44, 16, v102
    v_and_b32 v45, s90, v102
    v_pk_fma_f32 v[172:173], v[44:45], v[118:119], v[118:119] op_sel:[0,0,1] op_sel_hi:[1,0,1] neg_lo:[0,0,1] neg_hi:[0,0,1]
    v_cvt_pk_bf16_f32 v138, v172, v173
    v_lshlrev_b32 v172, 16, v138
    v_and_b32 v173, s90, v138
    v_pk_add_f32 v[172:173], v[172:173], v[44:45]
    v_cvt_pk_bf16_f32 v138, v172, v173
    v_lshlrev_b32 v46, 16, v103
    v_and_b32 v47, s90, v103
    v_pk_fma_f32 v[174:175], v[46:47], v[118:119], v[118:119] op_sel:[0,0,1] op_sel_hi:[1,0,1] neg_lo:[0,0,1] neg_hi:[0,0,1]
    v_cvt_pk_bf16_f32 v139, v174, v175
    v_lshlrev_b32 v174, 16, v139
    v_and_b32 v175, s90, v139
    v_pk_add_f32 v[174:175], v[174:175], v[46:47]
    v_cvt_pk_bf16_f32 v139, v174, v175
    ds_write_b64 v71, v[138:139]
    s_waitcnt lgkmcnt(0)
    ds_read_b128 v[48:51], v4 offset:0
    ds_read_b128 v[52:55], v4 offset:1024
    ds_read_b128 v[56:59], v4 offset:2048
    ds_read_b128 v[60:63], v4 offset:3072
    s_waitcnt lgkmcnt(3)
    buffer_store_dwordx4 v[48:51], v200, s[44:47], s76 offen sc1
    s_add_u32 s76, s76, 16384
    s_waitcnt lgkmcnt(2)
    buffer_store_dwordx4 v[52:55], v201, s[44:47], s76 offen sc1
    s_add_u32 s76, s76, 16384
    s_waitcnt lgkmcnt(1)
    buffer_store_dwordx4 v[56:59], v202, s[44:47], s76 offen sc1
    s_add_u32 s76, s76, 16384
    s_waitcnt lgkmcnt(0)
    buffer_store_dwordx4 v[60:63], v203, s[44:47], s76 offen sc1
L_cfin:
L_end:
    s_endpgm
L_tr0:
    s_call_b64 s[54:55], L_stall
    s_branch L_bk0
L_tr1:
    s_call_b64 s[54:55], L_stall
    s_branch L_bk1
L_tr2:
    s_call_b64 s[54:55], L_stall
    s_branch L_bk2
L_tr3:
    s_call_b64 s[54:55], L_stall
    s_branch L_bk3
L_tr4:
    s_call_b64 s[54:55], L_stall
    s_branch L_bk4
L_tr5:
    s_call_b64 s[54:55], L_stall
    s_branch L_bk5
L_tr6:
    s_call_b64 s[54:55], L_stall
    s_branch L_bk6
L_tr7:
    s_call_b64 s[54:55], L_stall
    s_branch L_bk7
L_tr8:
    s_call_b64 s[54:55], L_stall
    s_branch L_bk8
L_tr9:
    s_call_b64 s[54:55], L_stall
    s_branch L_bk9
L_tr10:
    s_call_b64 s[54:55], L_stall
    s_branch L_bk10
L_tr11:
    s_call_b64 s[54:55], L_stall
    s_branch L_bk11
L_tr12:
    s_call_b64 s[54:55], L_stall
    s_branch L_bk12
L_tr13:
    s_call_b64 s[54:55], L_stall
    s_branch L_bk13
L_tr14:
    s_call_b64 s[54:55], L_stall
    s_branch L_bk14
L_tr15:
    s_call_b64 s[54:55], L_stall
    s_branch L_bk15
L_stall:
    s_cmp_eq_u32 s53, 0
    s_cbranch_scc0 L_sent_64
    s_waitcnt vmcnt(0)
    s_mov_b64 exec, 1
    ds_add_u32 v8, v74 offset:25988
    s_mov_b64 exec, -1
    s_mov_b32 s53, 1
L_sent_64:
    s_mov_b32 s88, 0
L_stall1:
    ds_read_b32 v79, v8 offset:25984
    s_waitcnt lgkmcnt(0)
    v_readfirstlane_b32 s76, v79
    s_nop 0
    s_and_b32 s76, s76, s52
    s_cbranch_scc1 L_stall2
    s_add_u32 s88, s88, 1
    s_cmp_lt_u32 s88, 1048576
    s_cbranch_scc1 L_stall1
    s_mov_b32 s76, s52
L_stall2:
    s_setpc_b64 s[54:55]
L_s3_68:
    v_cmp_eq_u32_e64 vcc, -1, v115
    s_nop 0
    s_cbranch_vccz L_s3skip_70
    buffer_load_dwordx4 v[112:115], v178, s[40:43], s78 offen offset:1024 sc1
L_s3skip_70:
    v_cmp_eq_u32_e64 vcc, -1, v119
    s_nop 0
    s_cbranch_vccz L_s3skip_71
    buffer_load_dwordx4 v[116:119], v178, s[40:43], s48 offen offset:1024 sc1
L_s3skip_71:
    v_cmp_eq_u32_e64 vcc, -1, v123
    s_nop 0
    s_cbranch_vccz L_s3skip_72
    buffer_load_dwordx4 v[120:123], v178, s[40:43], s49 offen offset:1024 sc1
L_s3skip_72:
    v_cmp_eq_u32_e64 vcc, -1, v127
    s_nop 0
    s_cbranch_vccz L_s3skip_73
    buffer_load_dwordx4 v[124:127], v178, s[40:43], s50 offen offset:1024 sc1
L_s3skip_73:
    v_cmp_eq_u32_e64 vcc, -1, v131
    s_nop 0
    s_cbranch_vccz L_s3skip_74
    buffer_load_dwordx4 v[128:131], v178, s[40:43], s51 offen offset:1024 sc1
L_s3skip_74:
    v_cmp_eq_u32_e64 vcc, -1, v135
    s_nop 0
    s_cbranch_vccz L_s3skip_75
    buffer_load_dwordx4 v[132:135], v178, s[40:43], s52 offen offset:1024 sc1
L_s3skip_75:
    v_cmp_eq_u32_e64 vcc, -1, v139
    s_nop 0
    s_cbranch_vccz L_s3skip_76
    buffer_load_dwordx4 v[136:139], v178, s[40:43], s53 offen offset:1024 sc1
L_s3skip_76:
    v_cmp_eq_u32_e64 vcc, -1, v143
    s_nop 0
    s_cbranch_vccz L_s3skip_77
    buffer_load_dwordx4 v[140:143], v178, s[40:43], s54 offen offset:1024 sc1
L_s3skip_77:
    s_waitcnt vmcnt(0)
    v_pk_add_f32 v[108:109], v[112:113], v[116:117]
    v_pk_add_f32 v[110:111], v[114:115], v[118:119]
    v_pk_add_f32 v[108:109], v[108:109], v[120:121]
    v_pk_add_f32 v[110:111], v[110:111], v[122:123]
    v_pk_add_f32 v[108:109], v[108:109], v[124:125]
    v_pk_add_f32 v[110:111], v[110:111], v[126:127]
    v_pk_add_f32 v[108:109], v[108:109], v[128:129]
    v_pk_add_f32 v[110:111], v[110:111], v[130:131]
    v_pk_add_f32 v[108:109], v[108:109], v[132:133]
    v_pk_add_f32 v[110:111], v[110:111], v[134:135]
    v_pk_add_f32 v[108:109], v[108:109], v[136:137]
    v_pk_add_f32 v[110:111], v[110:111], v[138:139]
    v_pk_add_f32 v[108:109], v[108:109], v[140:141]
    v_pk_add_f32 v[110:111], v[110:111], v[142:143]
    v_cmp_u_f32 vcc, v111, v111
    v_mov_b32 v4, v108
    v_mov_b32 v5, v109
    v_mov_b32_e64 v6, v110
    s_cbranch_vccz L_s3ok_69
    s_add_u32 s88, s88, 1
    s_cmp_lt_u32 s88, 65536
    s_cbranch_scc1 L_s3_68
    s_branch L_s3ok_69
L_code_end:
s_endpgm
.p2align 7
.type L_table,@object
L_table:
.long 0x650c3824, 0xfedba97, 0x50102, 0x3006
.long 0x650c3824, 0xfedba97, 0x510200, 0x3060
.long 0x641d0935, 0xfecba87, 0x5020001, 0x3600
.long 0x76543218, 0xfedcba9, 0x15000002, 0x6300
.long 0x641d0935, 0xfecba87, 0x25100, 0x3006
.long 0x54e2a160, 0xfdcb987, 0x502001, 0x3060
.long 0x54e2a160, 0xfdcb987, 0x5002010, 0x3600
.long 0x54f3b271, 0xedca986, 0x50201000, 0x6300
.long 0x54f3b271, 0xedca986, 0x152000, 0x3006
.long 0x650c3824, 0xfedba97, 0x520010, 0x3060
.long 0x650c3824, 0xfedba97, 0x5020001, 0x3600
.long 0x76543218, 0xfedcba9, 0x50000012, 0x6300
.long 0x641d0935, 0xfecba87, 0x25010, 0x3006
.long 0x641d0935, 0xfecba87, 0x510020, 0x3060
.long 0x54e2a160, 0xfdcb987, 0x5100002, 0x3600
.long 0x54e2a160, 0xfdcb987, 0x50001002, 0x6300
.long 0x641d0935, 0xfecba87, 0x500210, 0x3060
.long 0x641d0935, 0xfecba87, 0x5010200, 0x3600
.long 0x54e2a160, 0xfdcb987, 0x50100002, 0x6300
.long 0x76543209, 0xfedcba8, 0x15002, 0x3006
.long 0x54e2a160, 0xfdcb987, 0x501002, 0x3060
.long 0x54f3b271, 0xedca986, 0x5000120, 0x3600
.long 0x54f3b271, 0xedca986, 0x50000012, 0x6300
.long 0x650c3824, 0xfedba97, 0x15200, 0x3006
.long 0x650c3824, 0xfedba97, 0x520100, 0x3060
.long 0x641d0935, 0xfecba87, 0x5001200, 0x3600
.long 0x641d0935, 0xfecba87, 0x50020001, 0x6300
.long 0x76543209, 0xfedcba8, 0x25001, 0x3006
.long 0x54e2a160, 0xfdcb987, 0x502100, 0x3060
.long 0x54e2a160, 0xfdcb987, 0x5002010, 0x3600
.long 0x54f3b271, 0xedca986, 0x50001002, 0x6300
.long 0x54f3b271, 0xedca986, 0x152000, 0x3006
.long 0x54e2a160, 0xfdcb987, 0x5001002, 0x3600
.long 0x54e2a160, 0xfdcb987, 0x50000012, 0x6300
.long 0x54f3b271, 0xedca986, 0x51020, 0x3006
.long 0x765431a0, 0xfedcb98, 0x150200, 0x3060
.long 0x54f3b271, 0xedca986, 0x5102000, 0x3600
.long 0x650c3824, 0xfedba97, 0x50000102, 0x6300
.long 0x650c3824, 0xfedba97, 0x15020, 0x3006
.long 0x641d0935, 0xfecba87, 0x510200, 0x3060
.long 0x641d0935, 0xfecba87, 0x5020100, 0x3600
.long 0x54e2a160, 0xfdcb987, 0x50100002, 0x6300
.long 0x54e2a160, 0xfdcb987, 0x250001, 0x3006
.long 0x765431a0, 0xfedcb98, 0x251000, 0x3060
.long 0x54f3b271, 0xedca986, 0x5200010, 0x3600
.long 0x54f3b271, 0xedca986, 0x50200001, 0x6300
.long 0x650c3824, 0xfedba97, 0x50021, 0x3006
.long 0x650c3824, 0xfedba97, 0x520010, 0x3060
.long 0x54f3b271, 0xedca986, 0x50200010, 0x6300
.long 0x54f3b271, 0xedca986, 0x152000, 0x3006
.long 0x650c3824, 0xfedba97, 0x500102, 0x3060
.long 0x765421b0, 0xfedca98, 0x2500010, 0x3600
.long 0x650c3824, 0xfedba97, 0x50010200, 0x6300
.long 0x641d0935, 0xfecba87, 0x15200, 0x3006
.long 0x641d0935, 0xfecba87, 0x520001, 0x3060
.long 0x54e2a160, 0xfdcb987, 0x5100020, 0x3600
.long 0x54e2a160, 0xfdcb987, 0x50001020, 0x6300
.long 0x54f3b271, 0xedca986, 0x52001, 0x3006
.long 0x54f3b271, 0xedca986, 0x500102, 0x3060
.long 0x765421b0, 0xfedca98, 0x1500020, 0x3600
.long 0x650c3824, 0xfedba97, 0x50000021, 0x6300
.long 0x650c3824, 0xfedba97, 0x521000, 0x3006
.long 0x641d0935, 0xfecba87, 0x520100, 0x3060
.long 0x641d0935, 0xfecba87, 0x5001002, 0x3600
.long 0x650c3824, 0xfedba97, 0x50021, 0x3006
.long 0x650c3824, 0xfedba97, 0x520010, 0x3060
.long 0x641d0935, 0xfecba87, 0x5010002, 0x3600
.long 0x76532c10, 0xfedba98, 0x15002000, 0x6300
.long 0x641d0935, 0xfecba87, 0x50021, 0x3006
.long 0x54e2a160, 0xfdcb987, 0x251000, 0x3060
.long 0x54e2a160, 0xfdcb987, 0x5000012, 0x3600
.long 0x54f3b271, 0xedca986, 0x50100002, 0x6300
.long 0x54f3b271, 0xedca986, 0x51020, 0x3006
.long 0x650c3824, 0xfedba97, 0x510200, 0x3060
.long 0x650c3824, 0xfedba97, 0x5000102, 0x3600
.long 0x76532c10, 0xfedba98, 0x50000210, 0x6300
.long 0x641d0935, 0xfecba87, 0x50210, 0x3006
.long 0x641d0935, 0xfecba87, 0x520100, 0x3060
.long 0x54e2a160, 0xfdcb987, 0x5100020, 0x3600
.long 0x54e2a160, 0xfdcb987, 0x50000021, 0x6300
.long 0x641d0935, 0xfecba87, 0x500120, 0x3060
.long 0x641d0935, 0xfecba87, 0x5000012, 0x3600
.long 0x54e2a160, 0xfdcb987, 0x50002010, 0x6300
.long 0x76432d10, 0xfecba98, 0x150002, 0x3006
.long 0x54e2a160, 0xfdcb987, 0x510020, 0x3060
.long 0x54f3b271, 0xedca986, 0x5201000, 0x3600
.long 0x54f3b271, 0xedca986, 0x50100020, 0x6300
.long 0x650c3824, 0xfedba97, 0x50102, 0x3006
.long 0x650c3824, 0xfedba97, 0x510200, 0x3060
.long 0x641d0935, 0xfecba87, 0x5000021, 0x3600
.long 0x641d0935, 0xfecba87, 0x50010020, 0x6300
.long 0x76432d10, 0xfecba98, 0x50201, 0x3006
.long 0x54e2a160, 0xfdcb987, 0x251000, 0x3060
.long 0x54e2a160, 0xfdcb987, 0x5100002, 0x3600
.long 0x54f3b271, 0xedca986, 0x50200010, 0x6300
.long 0x54f3b271, 0xedca986, 0x250001, 0x3006
.long 0x54e2a160, 0xfdcb987, 0x5001020, 0x3600
.long 0x54e2a160, 0xfdcb987, 0x50002100, 0x6300
.long 0x54f3b271, 0xedca986, 0x250100, 0x3006
.long 0x7543e210, 0xfdcba98, 0x1502000, 0x3060
.long 0x54f3b271, 0xedca986, 0x5200010, 0x3600
.long 0x650c3824, 0xfedba97, 0x50000201, 0x6300
.long 0x650c3824, 0xfedba97, 0x15200, 0x3006
.long 0x641d0935, 0xfecba87, 0x500120, 0x3060
.long 0x641d0935, 0xfecba87, 0x5010200, 0x3600
.long 0x54e2a160, 0xfdcb987, 0x50100020, 0x6300
.long 0x54e2a160, 0xfdcb987, 0x52010, 0x3006
.long 0x7543e210, 0xfdcba98, 0x500021, 0x3060
.long 0x54f3b271, 0xedca986, 0x5100020, 0x3600
.long 0x54f3b271, 0xedca986, 0x50001020, 0x6300
.long 0x650c3824, 0xfedba97, 0x51200, 0x3006
.long 0x650c3824, 0xfedba97, 0x500120, 0x3060
.long 0x54f3b271, 0xedca986, 0x50000102, 0x6300
.long 0x54f3b271, 0xedca986, 0x50012, 0x3006
.long 0x650c3824, 0xfedba97, 0x500120, 0x3060
.long 0x6543f210, 0xedcba98, 0x15200000, 0x3600
.long 0x650c3824, 0xfedba97, 0x50001020, 0x6300
.long 0x641d0935, 0xfecba87, 0x15002, 0x3006
.long 0x641d0935, 0xfecba87, 0x500102, 0x3060
.long 0x54e2a160, 0xfdcb987, 0x5102000, 0x3600
.long 0x54e2a160, 0xfdcb987, 0x50201000, 0x6300
.long 0x54f3b271, 0xedca986, 0x150020, 0x3006
.long 0x54f3b271, 0xedca986, 0x501020, 0x3060
.long 0x6543f210, 0xedcba98, 0x25000010, 0x3600
.long 0x650c3824, 0xfedba97, 0x50000201, 0x6300
.long 0x650c3824, 0xfedba97, 0x15200, 0x3006
.long 0x641d0935, 0xfecba87, 0x501200, 0x3060
.long 0x641d0935, 0xfecba87, 0x5000201, 0x3600
.long 0x650c3824, 0xfedba97, 0x50210, 0x3006
.long 0x650c3824, 0xfedba97, 0x510002, 0x3060
.long 0x641d0935, 0xfecba87, 0x5000120, 0x3600
.long 0x76543218, 0xfedcba9, 0x25000010, 0x6300
.long 0x641d0935, 0xfecba87, 0x50210, 0x3006
.long 0x54e2a160, 0xfdcb987, 0x150002, 0x3060
.long 0x54e2a160, 0xfdcb987, 0x5200010, 0x3600
.long 0x54f3b271, 0xedca986, 0x50102000, 0x6300
.long 0x54f3b271, 0xedca986, 0x251000, 0x3006
.long 0x650c3824, 0xfedba97, 0x500120, 0x3060
.long 0x650c3824, 0xfedba97, 0x5000021, 0x3600
.long 0x76543218, 0xfedcba9, 0x15002000, 0x6300
.long 0x641d0935, 0xfecba87, 0x50021, 0x3006
.long 0x641d0935, 0xfecba87, 0x510200, 0x3060
.long 0x54e2a160, 0xfdcb987, 0x5201000, 0x3600
.long 0x54e2a160, 0xfdcb987, 0x50200001, 0x6300
.long 0x641d0935, 0xfecba87, 0x500102, 0x3060
.long 0x641d0935, 0xfecba87, 0x5020010, 0x3600
.long 0x54e2a160, 0xfdcb987, 0x50201000, 0x6300
.long 0x76543209, 0xfedcba8, 0x215000, 0x3006
.long 0x54e2a160, 0xfdcb987, 0x502010, 0x3060
.long 0x54f3b271, 0xedca986, 0x5001002, 0x3600
.long 0x54f3b271, 0xedca986, 0x50200001, 0x6300
.long 0x650c3824, 0xfedba97, 0x50120, 0x3006
.long 0x650c3824, 0xfedba97, 0x510002, 0x3060
.long 0x641d0935, 0xfecba87, 0x5020001, 0x3600
.long 0x641d0935, 0xfecba87, 0x50010200, 0x6300
.long 0x76543209, 0xfedcba8, 0x50102, 0x3006
.long 0x54e2a160, 0xfdcb987, 0x150020, 0x3060
.long 0x54e2a160, 0xfdcb987, 0x5000021, 0x3600
.long 0x54f3b271, 0xedca986, 0x50102000, 0x6300
.long 0x54f3b271, 0xedca986, 0x50012, 0x3006
.long 0x54e2a160, 0xfdcb987, 0x5002010, 0x3600
.long 0x54e2a160, 0xfdcb987, 0x50001020, 0x6300
.long 0x54f3b271, 0xedca986, 0x150002, 0x3006
.long 0x765431a0, 0xfedcb98, 0x500021, 0x3060
.long 0x54f3b271, 0xedca986, 0x5001020, 0x3600
.long 0x650c3824, 0xfedba97, 0x50020001, 0x6300
.long 0x650c3824, 0xfedba97, 0x15002, 0x3006
.long 0x641d0935, 0xfecba87, 0x520100, 0x3060
.long 0x641d0935, 0xfecba87, 0x5010020, 0x3600
.long 0x54e2a160, 0xfdcb987, 0x50002100, 0x6300
.long 0x54e2a160, 0xfdcb987, 0x150002, 0x3006
.long 0x765431a0, 0xfedcb98, 0x150020, 0x3060
.long 0x54f3b271, 0xedca986, 0x5000102, 0x3600
.long 0x54f3b271, 0xedca986, 0x50002010, 0x6300
.long 0x650c3824, 0xfedba97, 0x50102, 0x3006
.long 0x650c3824, 0xfedba97, 0x501002, 0x3060
.long 0x54f3b271, 0xedca986, 0x50102000, 0x6300
.long 0x54f3b271, 0xedca986, 0x250001, 0x3006
.long 0x650c3824, 0xfedba97, 0x520001, 0x3060
.long 0x765421b0, 0xfedca98, 0x1500020, 0x3600
.long 0x650c3824, 0xfedba97, 0x50000102, 0x6300
.long 0x641d0935, 0xfecba87, 0x51020, 0x3006
.long 0x641d0935, 0xfecba87, 0x510020, 0x3060
.long 0x54e2a160, 0xfdcb987, 0x5001002, 0x3600
.long 0x54e2a160, 0xfdcb987, 0x50102000, 0x6300
.long 0x54f3b271, 0xedca986, 0x51002, 0x3006
.long 0x54f3b271, 0xedca986, 0x502010, 0x3060
.long 0x765421b0, 0xfedca98, 0x5100002, 0x3600
.long 0x650c3824, 0xfedba97, 0x50020010, 0x6300
.long 0x650c3824, 0xfedba97, 0x15002, 0x3006
.long 0x641d0935, 0xfecba87, 0x500102, 0x3060
.long 0x641d0935, 0xfecba87, 0x5020010, 0x3600
.long 0x650c3824, 0xfedba97, 0x521000, 0x3006
.long 0x650c3824, 0xfedba97, 0x500021, 0x3060
.long 0x641d0935, 0xfecba87, 0x5000201, 0x3600
.long 0x76532c10, 0xfedba98, 0x15000200, 0x6300
.long 0x641d0935, 0xfecba87, 0x15002, 0x3006
.long 0x54e2a160, 0xfdcb987, 0x501020, 0x3060
.long 0x54e2a160, 0xfdcb987, 0x5000120, 0x3600
.long 0x54f3b271, 0xedca986, 0x50100020, 0x6300
.long 0x54f3b271, 0xedca986, 0x51002, 0x3006
.long 0x650c3824, 0xfedba97, 0x500102, 0x3060
.long 0x650c3824, 0xfedba97, 0x5000210, 0x3600
.long 0x76532c10, 0xfedba98, 0x25000100, 0x6300
.long 0x641d0935, 0xfecba87, 0x50102, 0x3006
.long 0x641d0935, 0xfecba87, 0x501002, 0x3060
.long 0x54e2a160, 0xfdcb987, 0x5002010, 0x3600
.long 0x54e2a160, 0xfdcb987, 0x50102000, 0x6300
.long 0x641d0935, 0xfecba87, 0x520001, 0x3060
.long 0x641d0935, 0xfecba87, 0x5010020, 0x3600
.long 0x54e2a160, 0xfdcb987, 0x50100020, 0x6300
.long 0x76432d10, 0xfecba98, 0x50201, 0x3006
.long 0x54e2a160, 0xfdcb987, 0x251000, 0x3060
.long 0x54f3b271, 0xedca986, 0x5002001, 0x3600
.long 0x54f3b271, 0xedca986, 0x50002010, 0x6300
.long 0x650c3824, 0xfedba97, 0x25100, 0x3006
.long 0x650c3824, 0xfedba97, 0x510020, 0x3060
.long 0x641d0935, 0xfecba87, 0x5000102, 0x3600
.long 0x641d0935, 0xfecba87, 0x50000012, 0x6300
.long 0x76432d10, 0xfecba98, 0x152000, 0x3006
.long 0x54e2a160, 0xfdcb987, 0x500012, 0x3060
.long 0x54e2a160, 0xfdcb987, 0x5210000, 0x3600
.long 0x54f3b271, 0xedca986, 0x50001020, 0x6300
.long 0x54f3b271, 0xedca986, 0x150020, 0x3006
.long 0x54e2a160, 0xfdcb987, 0x5200010, 0x3600
.long 0x54e2a160, 0xfdcb987, 0x50201000, 0x6300
.long 0x54f3b271, 0xedca986, 0x52100, 0x3006
.long 0x7543e210, 0xfdcba98, 0x520001, 0x3060
.long 0x54f3b271, 0xedca986, 0x5100002, 0x3600
.long 0x650c3824, 0xfedba97, 0x50000120, 0x6300
.long 0x650c3824, 0xfedba97, 0x521000, 0x3006
.long 0x641d0935, 0xfecba87, 0x500102, 0x3060
.long 0x641d0935, 0xfecba87, 0x5010002, 0x3600
.long 0x54e2a160, 0xfdcb987, 0x51200000, 0x6300
.long 0x54e2a160, 0xfdcb987, 0x150020, 0x3006
.long 0x7543e210, 0xfdcba98, 0x502010, 0x3060
.long 0x54f3b271, 0xedca986, 0x5002010, 0x3600
.long 0x54f3b271, 0xedca986, 0x50001002, 0x6300
.long 0x650c3824, 0xfedba97, 0x1025000, 0x3006
.long 0x650c3824, 0xfedba97, 0x510200, 0x3060
.long 0x54f3b271, 0xedca986, 0x50100020, 0x6300
.long 0x54f3b271, 0xedca986, 0x51020, 0x3006
.long 0x650c3824, 0xfedba97, 0x510200, 0x3060
.long 0x6543f210, 0xedcba98, 0x5102000, 0x3600
.long 0x650c3824, 0xfedba97, 0x15020000, 0x6300
.long 0x641d0935, 0xfecba87, 0x25100, 0x3006
.long 0x641d0935, 0xfecba87, 0x500210, 0x3060
.long 0x54e2a160, 0xfdcb987, 0x5201000, 0x3600
.long 0x54e2a160, 0xfdcb987, 0x50100002, 0x6300
.long 0x54f3b271, 0xedca986, 0x250001, 0x3006
.long 0x54f3b271, 0xedca986, 0x250010, 0x3060
.long 0x6543f210, 0xedcba98, 0x5002001, 0x3600
.long 0x650c3824, 0xfedba97, 0x50000012, 0x6300
.long 0x650c3824, 0xfedba97, 0x50120, 0x3006
.long 0x641d0935, 0xfecba87, 0x510020, 0x3060
.long 0x641d0935, 0xfecba87, 0x5000021, 0x3600
.fill 1, 4, 0
.size L_table, .-L_table
.section .rodata,"a"
.p2align 6
.amdhsa_kernel sequential_preLN__linear_kernel_hedgehog__moe_arch_mod__prompt_kernel
  .amdhsa_next_free_vgpr 256
  .amdhsa_next_free_sgpr 102
  .amdhsa_accum_offset 256
  .amdhsa_group_segment_fixed_size 0
  .amdhsa_kernarg_size 96
  .amdhsa_user_sgpr_count 2
  .amdhsa_user_sgpr_kernarg_segment_ptr 1
  .amdhsa_system_sgpr_workgroup_id_x 1
  .amdhsa_float_denorm_mode_32 3
.end_amdhsa_kernel
```

```asm
; @launch grid=(256,1,1) block=(512,1,1) lds=163840
.amdgcn_target "amdgcn-amd-amdhsa--gfx950"
.text
.globl sequential_preLN__linear_kernel_hedgehog__moe_arch_mod__prompt_kernel
.p2align 8
.type sequential_preLN__linear_kernel_hedgehog__moe_arch_mod__prompt_kernel,@function
sequential_preLN__linear_kernel_hedgehog__moe_arch_mod__prompt_kernel:
    s_cmp_ge_u32 s2, 256
    s_cbranch_scc1 L_end
    s_load_dwordx2 s[28:29], s[0:1], 0
    s_load_dwordx2 s[32:33], s[0:1], 8
    s_load_dwordx4 s[8:11], s[0:1], 16
    s_load_dwordx16 s[12:27], s[0:1], 32
    v_lshrrev_b32 v4, 6, v0
    v_and_b32 v1, 63, v0
    v_readfirstlane_b32 s79, v4
    s_and_b32 s76, s2, 7
    s_lshr_b32 s77, s2, 3
    s_and_b32 s60, s77, 15
    s_lshl_b32 s76, s76, 3
    s_bfe_u32 s77, s2, 0x10007
    s_lshl2_add_u32 s76, s77, s76
    s_mov_b32 s80, 0x654210b3
    s_mov_b32 s81, 0xfedca987
    s_lshr_b64 s[80:81], s[80:81], s76
    s_and_b32 s61, s80, 15
    s_and_b32 s62, s79, 3
    s_cmp_ge_u32 s79, 4
    s_cbranch_scc1 L_compute
    s_setprio 3
    s_getpc_b64 s[66:67]
L_pc:
    s_lshr_b32 s76, s2, 3
    s_lshl2_add_u32 s76, s76, s62
    s_mul_i32 s76, s76, 256
    v_lshl_add_u32 v91, v1, 7, s76
    s_mov_b64 exec, 3
    global_load_dword v27, v91, s[66:67]
    s_mov_b64 exec, -1
    s_add_u32 s84, s60, s2
    s_and_b32 s84, s84, 3
    s_and_b32 s76, s60, 7
    s_and_b32 s77, s61, 7
    s_cmp_eq_u32 s77, 3
    s_cselect_b32 s84, s76, s84
    v_lshrrev_b32 v4, 3, v1
    v_and_b32 v5, 7, v1
    v_lshrrev_b32_e64 v6, 4, v1
    s_lshl2_add_u32 s76, s60, s62
    s_lshl_b32 s76, s76, 16
    s_mul_i32 s70, s62, 10240
    v_xor_b32 v7, v5, v6
    v_lshlrev_b32 v7, 4, v7
    v_lshl_add_u32 v78, v4, 11, v7
    v_add_u32 v16, s76, v78
    v_xor_b32 v7, 64, v16
    v_add_u32 v17, 15360, v7
    v_add_u32 v18, 30720, v16
    v_add_u32 v19, 46080, v7
    s_mov_b32 s30, 4194304
    s_mov_b32 s31, 0x20000
    s_and_b32 s72, s84, 15
    s_mov_b32 m0, s70
    s_lshl_b32 s71, s72, 7
    s_waitcnt lgkmcnt(0)
    buffer_load_dwordx4 v16, s[28:31], s71 offen offset:0 lds
    s_mul_i32 s72, s72, 393216
    s_lshr_b64 s[84:85], s[84:85], 4
    buffer_load_dwordx4 v17, s[28:31], s71 offen offset:1024 lds
    buffer_load_dwordx4 v18, s[28:31], s71 offen offset:2048 lds
    buffer_load_dwordx4 v19, s[28:31], s71 offen offset:3072 lds
    v_and_b32 v6, 1, v6
    v_lshlrev_b32 v6, 2, v6
    v_xor_b32 v8, v5, v6
    v_lshlrev_b32 v8, 4, v8
    s_lshl_b32 s76, s61, 7
    s_mul_i32 s77, s62, 98304
    s_add_u32 s76, s76, s77
    v_mul_u32_u24 v7, 6144, v4
    v_add3_u32 v20, v7, v8, s76
    v_xor_b32 v7, 32, v20
    s_mov_b32 s34, 6291456
    s_mov_b32 s35, 0x20000
    s_add_u32 m0, s70, 4096
    s_nop 0
    buffer_load_dwordx4 v20, s[32:35], s72 offen offset:0 lds
    v_add_u32 v21, 48128, v7
    buffer_load_dwordx4 v21, s[32:35], s72 offen offset:1024 lds
    v_add_u32 v22, 0, v20
    buffer_load_dwordx4 v22, s[32:35], s72 offen offset:2048 lds
    v_add_u32 v23, 48128, v7
    buffer_load_dwordx4 v23, s[32:35], s72 offen offset:3072 lds
    v_add_u32 v24, 4096, v20
    s_add_u32 m0, s70, 8192
    s_nop 0
    buffer_load_dwordx4 v24, s[32:35], s72 offen offset:0 lds
    v_add_u32 v25, 52224, v7
    buffer_load_dwordx4 v25, s[32:35], s72 offen offset:1024 lds
    s_add_u32 s70, s70, 40960
    s_cmp_ge_u32 s70, 122880
    s_cselect_b32 s76, 122880, 0
    s_sub_u32 s70, s70, s76
    s_lshl_b32 s76, s60, 8
    s_lshl_b32 s77, s61, 4
    s_add_u32 s76, s76, s77
    s_add_u32 s76, s76, 30336
    s_load_dwordx4 s[84:87], s[66:67], s76
    v_lshl_add_u32 v26, v4, 11, v8
    v_xor_b32 v79, 64, v78
    s_and_b32 s63, s62, 1
    s_lshr_b32 s64, s62, 1
    s_lshl_b32 s73, s60, 4
    s_add_u32 s73, s73, s61
    s_mul_i32 s73, s73, 28800
    s_add_u32 s76, s2, 7
    s_and_b32 s76, s76, 7
    s_bfe_u32 s77, s2, 0x10003
    s_lshl1_add_u32 s97, s76, s77
    s_lshr_b32 s98, s2, 4
    s_lshl_b32 s99, s97, 4
    s_add_u32 s99, s99, s98
    s_mul_i32 s99, s99, 9344
    s_add_u32 s99, s99, 8388608
    s_lshr_b32 s65, s97, 1
    s_lshl_b32 s76, s97, 3
    s_add_u32 s65, s65, s76
    s_mul_i32 s76, s98, 4
    s_add_u32 s65, s65, s76
    s_and_b32 s65, s65, 15
    s_mov_b32 s89, 0x3f803f80
    s_mov_b32 s90, 0xffff0000
    v_and_b32 v2, 31, v1
    v_lshrrev_b32 v3, 5, v1
    v_lshlrev_b32 v12, 4, v1
    v_lshrrev_b32 v4, 3, v1
    v_mul_u32_u24 v13, 460800, v4
    v_and_b32_e64 v4, 7, v1
    v_lshl_add_u32 v13, v4, 4, v13
    s_lshl_b32 s76, s98, 7
    s_lshl_b32 s77, s62, 15
    s_add_u32 s76, s76, s77
    v_add_u32_e64 v26, s76, v26
    s_mov_b32 s40, s26
    s_and_b32 s41, s27, 0xffff
    s_mov_b32 s42, 33554432
    s_mov_b32 s43, 0x20000
    s_mov_b32 s56, s8
    s_and_b32 s57, s9, 0xffff
    s_mov_b32 s58, 65536
    s_mov_b32 s59, 0x20000
    v_mov_b32 v28, -1
    v_mov_b32 v29, -1
    v_mov_b32 v30, -1
    v_mov_b32_e64 v31, -1
    s_waitcnt lgkmcnt(0)
    s_and_b32 s72, s84, 15
    s_mov_b32 m0, s70
    s_lshl_b32 s71, s72, 7
    buffer_load_dwordx4 v16, s[28:31], s71 offen offset:0 lds
    s_mul_i32 s72, s72, 393216
    s_lshr_b64 s[84:85], s[84:85], 4
    buffer_load_dwordx4 v17, s[28:31], s71 offen offset:1024 lds
    buffer_load_dwordx4 v18, s[28:31], s71 offen offset:2048 lds
    buffer_load_dwordx4 v19, s[28:31], s71 offen offset:3072 lds
    s_add_u32 m0, s70, 4096
    s_nop 0
    buffer_load_dwordx4 v20, s[32:35], s72 offen offset:0 lds
    buffer_load_dwordx4 v21, s[32:35], s72 offen offset:1024 lds
    buffer_load_dwordx4 v22, s[32:35], s72 offen offset:2048 lds
    buffer_load_dwordx4 v23, s[32:35], s72 offen offset:3072 lds
    s_add_u32 m0, s70, 8192
    s_nop 0
    buffer_load_dwordx4 v24, s[32:35], s72 offen offset:0 lds
    buffer_load_dwordx4 v25, s[32:35], s72 offen offset:1024 lds
    s_add_u32 s70, s70, 40960
    s_cmp_ge_u32 s70, 122880
    s_cselect_b32 s76, 122880, 0
    s_sub_u32 s70, s70, s76
    s_lshl_b32 s77, s62, 10
    s_add_u32 s76, s77, s73
    buffer_store_dwordx4 v[28:31], v12, s[40:43], s76 offen sc1
    s_lshl_b32 s76, s61, 12
    s_add_u32 s76, s76, s77
    s_add_u32 m0, s77, 122880
    s_nop 0
    buffer_load_dwordx4 v12, s[56:59], s76 offen lds
    v_mov_b32 v4, 13631488
    buffer_load_dwordx2 v[88:89], v4, s[40:43], 0 offen
    s_setprio 0
    s_waitcnt vmcnt(13)
    s_barrier
    s_and_b32 s72, s84, 15
    s_mov_b32 m0, s70
    s_lshl_b32 s71, s72, 7
    buffer_load_dwordx4 v16, s[28:31], s71 offen offset:0 lds
    s_mul_i32 s72, s72, 393216
    s_lshr_b64 s[84:85], s[84:85], 4
    buffer_load_dwordx4 v17, s[28:31], s71 offen offset:1024 lds
    buffer_load_dwordx4 v18, s[28:31], s71 offen offset:2048 lds
    buffer_load_dwordx4 v19, s[28:31], s71 offen offset:3072 lds
    s_add_u32 m0, s70, 4096
    s_nop 0
    buffer_load_dwordx4 v20, s[32:35], s72 offen offset:0 lds
    buffer_load_dwordx4 v21, s[32:35], s72 offen offset:1024 lds
    buffer_load_dwordx4 v22, s[32:35], s72 offen offset:2048 lds
    buffer_load_dwordx4 v23, s[32:35], s72 offen offset:3072 lds
    s_add_u32 m0, s70, 8192
    s_nop 0
    buffer_load_dwordx4 v24, s[32:35], s72 offen offset:0 lds
    buffer_load_dwordx4 v25, s[32:35], s72 offen offset:1024 lds
    s_add_u32 s70, s70, 40960
    s_cmp_ge_u32 s70, 122880
    s_cselect_b32 s76, 122880, 0
    s_sub_u32 s70, s70, s76
    s_mov_b32 s36, s10
    s_and_b32 s37, s11, 0xffff
    s_mov_b32 s38, 2097152
    s_mov_b32 s39, 0x20000
    s_mov_b32 s44, s22
    s_and_b32 s45, s23, 0xffff
    s_mov_b32 s46, 4194304
    s_mov_b32 s47, 0x20000
    s_mov_b32 s52, s20
    s_and_b32 s53, s21, 0xffff
    s_mov_b32 s54, 7340032
    s_mov_b32 s55, 0x20000
    s_cmp_eq_u32 s64, 0
    s_cselect_b32 s48, s16, s18
    s_cselect_b32 s49, s17, s19
    s_and_b32 s49, s49, 0xffff
    s_mov_b32 s51, 0x20000
    s_cmp_lt_u32 s97, 14
    s_cselect_b32 s50, 7340032, 0
    s_cselect_b32 s54, 7340032, 0
    v_bfe_u32 v4, v2, 1, 3
    v_xor_b32 v4, v4, v3
    v_lshlrev_b32 v4, 4, v4
    v_lshl_add_u32 v72, v2, 7, v4
    v_bfe_u32 v4, v1, 2, 2
    v_lshl_add_u32 v5, v3, 3, v4
    v_lshlrev_b32 v5, 7, v5
    v_lshrrev_b32 v4, 1, v4
    v_xor_b32_e64 v4, s64, v4
    v_lshl_add_u32 v5, v4, 6, v5
    v_bfe_u32 v4, v1, 4, 1
    v_xor_b32_e64 v4, v4, v3
    v_lshl_add_u32 v5, v4, 5, v5
    v_and_b32_e64 v4, 3, v1
    v_lshl_add_u32 v5, v4, 3, v5
    s_mul_i32 s76, s62, 10240
    s_sub_u32 s76, 4096, s76
    v_add_u32_e64 v73, s76, v5
    v_mul_u32_u24 v74, 28800, v3
    v_lshl_add_u32 v74, v2, 3, v74
    v_lshrrev_b32 v4, 4, v1
    v_and_b32 v5, 15, v1
    v_mul_u32_u24 v75, 460800, v4
    v_lshl_add_u32 v75, v5, 4, v75
    v_lshrrev_b32 v4, 4, v1
    v_and_b32 v5, 15, v1
    v_mul_u32_u24 v76, 114688, v4
    v_lshl_add_u32 v76, v5, 4, v76
    v_lshlrev_b32_e64 v77, 4, v2
    v_lshl_add_u32 v77, v3, 11, v77
    s_mul_i32 s75, s98, 458752
    s_lshl_b32 s77, s97, 9
    s_add_u32 s75, s75, s77
    s_lshl_b32 s77, s63, 8
    s_add_u32 s75, s75, s77
    s_lshl_b32 s96, s97, 19
    s_lshl_b32 s77, s98, 15
    s_add_u32 s96, s96, s77
    s_lshl_b32 s77, s62, 9
    s_add_u32 s96, s96, s77
    s_mov_b32 s68, 1
    s_getreg_b32 s101, hwreg(HW_REG_XCC_ID, 0, 4)
    s_lshl_b32 s76, s61, 8
    s_add_u32 s76, s76, 12582912
    s_lshl_b32 s77, s60, 8
    s_add_u32 s77, s77, 12586752
    s_lshr_b32 s78, s97, 1
    s_lshl_b32 s78, s78, 9
    s_add_u32 s78, s78, 12590592
    v_mov_b32 v4, s76
    v_mov_b32 v5, s77
    v_mov_b32 v6, s78
    v_cmp_gt_u32 vcc, 16, v1
    s_nop 1
    v_cndmask_b32 v4, v5, v4, vcc
    v_cmp_gt_u32 vcc, 32, v1
    s_nop 1
    v_cndmask_b32 v4, v6, v4, vcc
    v_add_u32 v90, v4, v12
    s_waitcnt vmcnt(10)
    s_barrier
L_hloop:
    s_and_b32 s77, s86, 15
    s_cbranch_scc1 L_event
L_evret:
    s_and_b32 s72, s84, 15
    s_mov_b32 m0, s70
    s_lshl_b32 s71, s72, 7
    buffer_load_dwordx4 v16, s[28:31], s71 offen offset:0 lds
    s_mul_i32 s72, s72, 393216
    s_lshr_b64 s[84:85], s[84:85], 4
    buffer_load_dwordx4 v17, s[28:31], s71 offen offset:1024 lds
    buffer_load_dwordx4 v18, s[28:31], s71 offen offset:2048 lds
    buffer_load_dwordx4 v19, s[28:31], s71 offen offset:3072 lds
    s_add_u32 m0, s70, 4096
    s_nop 0
    buffer_load_dwordx4 v20, s[32:35], s72 offen offset:0 lds
    buffer_load_dwordx4 v21, s[32:35], s72 offen offset:1024 lds
    buffer_load_dwordx4 v22, s[32:35], s72 offen offset:2048 lds
    buffer_load_dwordx4 v23, s[32:35], s72 offen offset:3072 lds
    s_add_u32 m0, s70, 8192
    s_nop 0
    buffer_load_dwordx4 v24, s[32:35], s72 offen offset:0 lds
    buffer_load_dwordx4 v25, s[32:35], s72 offen offset:1024 lds
    s_add_u32 s70, s70, 40960
    s_cmp_ge_u32 s70, 122880
    s_cselect_b32 s76, 122880, 0
    s_sub_u32 s70, s70, s76
    s_waitcnt vmcnt(10)
L_hbar:
    s_lshr_b64 s[86:87], s[86:87], 4
    s_add_u32 s68, s68, 1
    s_cmp_lt_u32 s68, 14
    s_barrier
    s_cbranch_scc1 L_hloop
    v_add_co_u32 v88, vcc, 1, v88
    s_nop 1
    v_addc_co_u32 v89, vcc, 0, v89, vcc
    v_cmp_ne_u64 vcc, v[92:93], v[88:89]
    s_nop 0
    s_cbranch_vccz L_hello_ok_1
    s_mov_b32 s88, 0
L_spin_2:
    buffer_load_dwordx4 v[92:95], v90, s[40:43], 0 offen sc1
    s_waitcnt vmcnt(0)
    v_cmp_ne_u64 vcc, v[92:93], v[88:89]
    s_nop 0
    s_cbranch_vccz L_hello_ok_1
    s_add_u32 s88, s88, 1
    s_cmp_lt_u32 s88, 65536
    s_cbranch_scc1 L_spin_2
L_hello_ok_1:
    v_cmp_ne_u32_e64 vcc, s101, v94
    s_nop 0
    s_and_b32 s76, vcc_lo, 0xffff
    s_cselect_b32 s100, 0, 1
    s_cmp_eq_u32 vcc_hi, 0
    s_cselect_b32 s76, 2, 0
    s_or_b32 s100, s100, s76
    v_mov_b32 v4, s100
    v_mov_b32 v5, 0
    ds_write_b32 v5, v4 offset:53248
    s_lshl_b32 s81, s62, 8
    s_mul_i32 s80, s60, 460800
    s_add_u32 s80, s80, s81
    buffer_load_dwordx2 v[32:33], v74, s[40:43], s80 offen offset:0 sc1
    s_add_u32 s80, s80, 57600
    buffer_load_dwordx2 v[34:35], v74, s[40:43], s80 offen offset:0 sc1
    s_add_u32 s80, s80, 57600
    buffer_load_dwordx2 v[36:37], v74, s[40:43], s80 offen offset:0 sc1
    s_add_u32 s80, s80, 57600
    buffer_load_dwordx2 v[38:39], v74, s[40:43], s80 offen offset:0 sc1
    s_add_u32 s80, s80, 57600
    buffer_load_dwordx2 v[40:41], v74, s[40:43], s80 offen offset:0 sc1
    s_add_u32 s80, s80, 57600
    buffer_load_dwordx2 v[42:43], v74, s[40:43], s80 offen offset:0 sc1
    s_add_u32 s80, s80, 57600
    buffer_load_dwordx2 v[44:45], v74, s[40:43], s80 offen offset:0 sc1
    s_add_u32 s80, s80, 57600
    buffer_load_dwordx2 v[46:47], v74, s[40:43], s80 offen offset:0 sc1
    s_mul_i32 s80, s61, 28800
    s_add_u32 s80, s80, s81
    buffer_load_dwordx4 v[48:51], v75, s[40:43], s80 offen offset:1024 sc1
    s_add_u32 s80, s80, 1843200
    buffer_load_dwordx4 v[52:55], v75, s[40:43], s80 offen offset:1024 sc1
    s_add_u32 s80, s80, 1843200
    buffer_load_dwordx4 v[56:59], v75, s[40:43], s80 offen offset:1024 sc1
    s_add_u32 s80, s80, 1843200
    buffer_load_dwordx4 v[60:63], v75, s[40:43], s80 offen offset:1024 sc1
    v_bfe_u32 v10, v1, 4, 1
    v_lshl_add_u32 v10, v10, 1, v3
    v_min_u32 v10, 2, v10
    v_and_b32 v7, 15, v1
    v_lshlrev_b32_e64 v7, 3, v7
    s_lshl_b32 s76, s62, 7
    v_lshl_add_u32 v10, v10, 9, v7
    v_add_u32_e64 v64, s76, v10
    v_lshl_add_u32 v65, v2, 3, s81
    s_waitcnt vmcnt(12)
    s_barrier
    s_mul_i32 s78, s62, 2048
    s_add_u32 s78, s78, s99
    s_add_u32 s78, s78, 1024
    v_lshlrev_b32 v11, 7, v1
    s_mov_b64 exec, 65535
    buffer_load_dword v27, v11, s[40:43], s78 offen sc1
    s_mov_b64 exec, -1
    buffer_load_dwordx4 v[152:155], v76, s[48:51], s75 offen nt
    s_add_u32 s75, s75, 7168
    s_add_u32 s78, s65, 0
    s_and_b32 s78, s78, 15
    s_lshl_b32 s78, s78, 17
    s_lshl_b32 s79, s62, 11
    s_add_u32 m0, s79, 57344
    s_add_u32 s79, s78, 15360
    buffer_load_dwordx4 v26, s[36:39], s78 offen lds
    buffer_load_dwordx4 v26, s[36:39], s79 offen offset:1024 lds
    s_add_u32 s78, s65, 1
    s_and_b32 s78, s78, 15
    s_lshl_b32 s78, s78, 17
    s_lshl_b32 s79, s62, 11
    s_add_u32 m0, s79, 65536
    s_add_u32 s79, s78, 15360
    buffer_load_dwordx4 v26, s[36:39], s78 offen lds
    buffer_load_dwordx4 v26, s[36:39], s79 offen offset:1024 lds
    s_setprio 3
    s_mov_b32 s88, 0
    s_waitcnt vmcnt(10)
    s_branch L_g1first_3
L_g1_4:
    s_mul_i32 s80, s60, 460800
    s_add_u32 s80, s80, s81
    buffer_load_dwordx2 v[32:33], v74, s[40:43], s80 offen offset:0 sc1
    s_add_u32 s80, s80, 57600
    buffer_load_dwordx2 v[34:35], v74, s[40:43], s80 offen offset:0 sc1
    s_add_u32 s80, s80, 57600
    buffer_load_dwordx2 v[36:37], v74, s[40:43], s80 offen offset:0 sc1
    s_add_u32 s80, s80, 57600
    buffer_load_dwordx2 v[38:39], v74, s[40:43], s80 offen offset:0 sc1
    s_add_u32 s80, s80, 57600
    buffer_load_dwordx2 v[40:41], v74, s[40:43], s80 offen offset:0 sc1
    s_add_u32 s80, s80, 57600
    buffer_load_dwordx2 v[42:43], v74, s[40:43], s80 offen offset:0 sc1
    s_add_u32 s80, s80, 57600
    buffer_load_dwordx2 v[44:45], v74, s[40:43], s80 offen offset:0 sc1
    s_add_u32 s80, s80, 57600
    buffer_load_dwordx2 v[46:47], v74, s[40:43], s80 offen offset:0 sc1
    s_waitcnt vmcnt(0)
L_g1first_3:
    v_max3_u32 v4, v32, v34, v36
    v_max3_u32 v4, v4, v38, v40
    v_max3_u32 v4, v4, v42, v44
    v_max_u32 v4, v4, v46
    v_cmp_eq_u32 vcc, -1, v4
    s_nop 0
    s_cbranch_vccz L_ok_5
    s_add_u32 s88, s88, 1
    s_cmp_lt_u32 s88, 65536
    s_cbranch_scc1 L_g1_4
L_ok_5:
    v_add_f32 v32, v32, v40
    v_add_f32 v33, v33, v41
    v_add_f32 v34, v34, v42
    v_add_f32 v35, v35, v43
    v_add_f32 v36, v36, v44
    v_add_f32 v37, v37, v45
    v_add_f32 v38, v38, v46
    v_add_f32 v39, v39, v47
    v_add_f32 v32, v32, v36
    v_add_f32 v33, v33, v37
    v_add_f32 v34, v34, v38
    v_add_f32 v35, v35, v39
    v_add_f32 v32, v32, v34
    v_add_f32 v33, v33, v35
    v_mov_b32 v5, v32
    v_mov_b32_e64 v6, v33
    s_add_u32 s78, s65, 2
    s_and_b32 s78, s78, 15
    s_lshl_b32 s78, s78, 17
    s_lshl_b32 s79, s62, 11
    s_add_u32 m0, s79, 73728
    s_add_u32 s79, s78, 15360
    buffer_load_dwordx4 v26, s[36:39], s78 offen lds
    buffer_load_dwordx4 v26, s[36:39], s79 offen offset:1024 lds
    v_permlane32_swap_b32 v32, v5
    v_permlane32_swap_b32 v33, v6
    v_add_f32 v32, v32, v5
    v_add_f32 v33, v33, v6
    v_mul_f32 v32, 0x3a800000, v32
    v_mul_f32 v33, 0x3a800000, v33
    v_fma_f32 v7, -v32, v32, v33
    v_max_f32_e64 v7, 0, v7
    v_cvt_pk_bf16_f32 v5, v32, v32
    v_and_b32_e64 v5, s90, v5
    v_cvt_pk_bf16_f32 v7, v7, v7
    v_and_b32_e64 v7, s90, v7
    v_add_f32 v7, 0x3727c5ac, v7
    v_cvt_pk_bf16_f32 v7, v7, v7
    v_and_b32 v7, s90, v7
    v_sqrt_f32_e64 v7, v7
    s_nop 0
    v_cvt_pk_bf16_f32 v7, v7, v7
    v_and_b32 v7, s90, v7
    v_rcp_f32 v9, v7
    v_xor_b32 v5, 0x80000000, v5
    v_cvt_pk_bf16_f32 v8, v5, v5
    ds_write_b64 v65, v[8:9] offset:49152
    s_mov_b32 s88, 0
    s_waitcnt vmcnt(8)
    s_branch L_g1first_6
L_g1_7:
    s_mul_i32 s80, s61, 28800
    s_add_u32 s80, s80, s81
    buffer_load_dwordx4 v[48:51], v75, s[40:43], s80 offen offset:1024 sc1
    s_add_u32 s80, s80, 1843200
    buffer_load_dwordx4 v[52:55], v75, s[40:43], s80 offen offset:1024 sc1
    s_add_u32 s80, s80, 1843200
    buffer_load_dwordx4 v[56:59], v75, s[40:43], s80 offen offset:1024 sc1
    s_add_u32 s80, s80, 1843200
    buffer_load_dwordx4 v[60:63], v75, s[40:43], s80 offen offset:1024 sc1
    s_waitcnt vmcnt(0)
L_g1first_6:
    v_max3_u32 v4, v48, v50, v52
    v_max3_u32 v4, v4, v54, v56
    v_max3_u32 v4, v4, v58, v60
    v_max_u32 v4, v4, v62
    v_cmp_eq_u32 vcc, -1, v4
    s_nop 0
    s_cbranch_vccz L_ok_8
    s_add_u32 s88, s88, 1
    s_cmp_lt_u32 s88, 65536
    s_cbranch_scc1 L_g1_7
L_ok_8:
    v_add_f32 v48, v48, v56
    v_add_f32 v49, v49, v57
    v_add_f32 v50, v50, v58
    v_add_f32 v51, v51, v59
    v_add_f32 v52, v52, v60
    v_add_f32 v53, v53, v61
    v_add_f32 v54, v54, v62
    v_add_f32 v55, v55, v63
    v_add_f32 v48, v48, v52
    v_add_f32 v49, v49, v53
    v_add_f32 v50, v50, v54
    v_add_f32 v51, v51, v55
    v_add_f32 v49, v49, v51
    v_mov_b32 v51, v49
    v_permlane32_swap_b32 v48, v50
    s_nop 0
    v_permlane32_swap_b32 v49, v51
    v_add_f32 v48, v48, v50
    v_add_f32 v49, v49, v51
    s_nop 1
    v_permlane16_swap_b32 v48, v49
    v_add_f32_e64 v48, v48, v49
    v_cvt_pk_bf16_f32 v49, v48, v48
    v_and_b32 v49, s90, v49
    v_sub_f32 v49, v48, v49
    v_cvt_pk_bf16_f32 v50, v48, v49
    v_and_b32 v51, s90, v50
    v_sub_f32 v49, v49, v51
    v_cvt_pk_bf16_f32 v51, v49, 0
    ds_write_b64 v64, v[50:51] offset:50176
    s_setprio 0
    s_waitcnt lgkmcnt(0)
    s_barrier
    s_add_u32 s78, s65, 3
    s_and_b32 s78, s78, 15
    s_lshl_b32 s78, s78, 17
    s_lshl_b32 s79, s62, 11
    s_add_u32 m0, s79, 81920
    s_add_u32 s79, s78, 15360
    buffer_load_dwordx4 v26, s[36:39], s78 offen lds
    buffer_load_dwordx4 v26, s[36:39], s79 offen offset:1024 lds
    s_add_u32 s78, s65, 4
    s_and_b32 s78, s78, 15
    s_lshl_b32 s78, s78, 17
    s_lshl_b32 s79, s62, 11
    s_add_u32 m0, s79, 90112
    s_add_u32 s79, s78, 15360
    buffer_load_dwordx4 v26, s[36:39], s78 offen lds
    buffer_load_dwordx4 v26, s[36:39], s79 offen offset:1024 lds
    s_lshl_b32 s78, s62, 11
    s_add_u32 s79, s78, s99
    s_bitcmp1_b32 s100, 0
    s_cbranch_scc1 L_loc_9
    buffer_store_dwordx4 v[28:31], v12, s[40:43], s79 offen offset:1024 sc1
    buffer_store_dwordx4 v[28:31], v12, s[40:43], s79 offen offset:2048 sc1
    s_branch L_pubd_10
L_loc_9:
    buffer_store_dwordx4 v[28:31], v12, s[40:43], s79 offen offset:1024
    buffer_store_dwordx4 v[28:31], v12, s[40:43], s79 offen offset:2048
L_pubd_10:
    s_lshl_b32 s79, s62, 8
    s_add_u32 s79, s79, s99
    s_mov_b64 exec, 0xffff
    buffer_store_dwordx4 v[28:31], v12, s[40:43], s79 offen sc1
    s_mov_b64 exec, -1
    s_add_u32 s78, s65, 5
    s_and_b32 s78, s78, 15
    s_lshl_b32 s78, s78, 17
    s_lshl_b32 s79, s62, 11
    s_add_u32 m0, s79, 98304
    s_add_u32 s79, s78, 15360
    buffer_load_dwordx4 v26, s[36:39], s78 offen lds
    buffer_load_dwordx4 v26, s[36:39], s79 offen offset:1024 lds
    s_add_u32 s78, s65, 6
    s_and_b32 s78, s78, 15
    s_lshl_b32 s78, s78, 17
    s_lshl_b32 s79, s62, 11
    s_add_u32 m0, s79, 106496
    s_add_u32 s79, s78, 15360
    buffer_load_dwordx4 v26, s[36:39], s78 offen lds
    buffer_load_dwordx4 v26, s[36:39], s79 offen offset:1024 lds
    s_add_u32 s78, s65, 7
    s_and_b32 s78, s78, 15
    s_lshl_b32 s78, s78, 17
    s_lshl_b32 s79, s62, 11
    s_add_u32 m0, s79, 114688
    s_add_u32 s79, s78, 15360
    buffer_load_dwordx4 v26, s[36:39], s78 offen lds
    buffer_load_dwordx4 v26, s[36:39], s79 offen offset:1024 lds
    s_mul_i32 s78, s62, 384
    s_add_u32 s78, s78, s73
    s_add_u32 s78, s78, 2048
    v_lshlrev_b32 v11, 7, v1
    s_mov_b64 exec, 7
    buffer_load_dword v27, v11, s[40:43], s78 offen sc1
    s_mov_b64 exec, -1
    s_waitcnt vmcnt(7)
    s_lshl_b32 s76, s62, 2
    s_add_u32 s76, s76, s73
    v_mov_b32 v4, 0
    s_mov_b64 exec, 1
    s_bitcmp1_b32 s100, 0
    s_cbranch_scc1 L_loc_11
    buffer_store_dword v4, v4, s[40:43], s76 offen offset:2560 sc1
    s_branch L_pubd_12
L_loc_11:
    buffer_store_dword v4, v4, s[40:43], s76 offen offset:2560
L_pubd_12:
    s_mov_b64 exec, -1
    s_add_u32 s78, s65, 8
    s_and_b32 s78, s78, 15
    s_lshl_b32 s78, s78, 17
    s_lshl_b32 s79, s62, 11
    s_add_u32 m0, s79, 122880
    s_add_u32 s79, s78, 15360
    buffer_load_dwordx4 v26, s[36:39], s78 offen lds
    buffer_load_dwordx4 v26, s[36:39], s79 offen offset:1024 lds
    s_add_u32 s78, s65, 9
    s_and_b32 s78, s78, 15
    s_lshl_b32 s78, s78, 17
    s_lshl_b32 s79, s62, 11
    s_add_u32 m0, s79, 131072
    s_add_u32 s79, s78, 15360
    buffer_load_dwordx4 v26, s[36:39], s78 offen lds
    buffer_load_dwordx4 v26, s[36:39], s79 offen offset:1024 lds
    s_add_u32 s78, s65, 10
    s_and_b32 s78, s78, 15
    s_lshl_b32 s78, s78, 17
    s_lshl_b32 s79, s62, 11
    s_add_u32 m0, s79, 139264
    s_add_u32 s79, s78, 15360
    buffer_load_dwordx4 v26, s[36:39], s78 offen lds
    buffer_load_dwordx4 v26, s[36:39], s79 offen offset:1024 lds
    v_and_b32_e64 v65, 15, v1
    v_mul_u32_u24 v65, 460800, v65
    s_mul_i32 s80, s61, 28800
    s_lshl_b32 s82, s62, 2
    s_add_u32 s82, s82, s80
    v_bfe_u32 v4, v1, 4, 1
    v_lshl_add_u32 v4, v4, 1, v3
    s_lshl_b32 s77, s62, 6
    v_lshl_add_u32 v66, v4, 1, s77
    v_bfe_u32 v4, v1, 2, 1
    v_lshl_add_u32 v66, v4, 5, v66
    v_bfe_u32 v4, v1, 0, 1
    v_lshl_add_u32 v66, v4, 4, v66
    v_bfe_u32 v4, v1, 1, 1
    v_lshl_add_u32 v66, v4, 3, v66
    s_lshl_b32 s83, s62, 7
    s_add_u32 s81, s83, s80
    s_add_u32 s68, s81, 3686400
    s_add_u32 s83, s83, s73
    v_and_b32 v4, 7, v1
    v_lshrrev_b32 v5, 4, v1
    v_lshlrev_b32_e64 v5, 2, v5
    v_lshl_add_u32 v67, v4, 4, v5
    v_bfe_u32 v5, v1, 3, 1
    v_lshrrev_b32_e64 v6, 4, v1
    v_lshl_add_u32 v5, v5, 4, v6
    v_mul_u32_u24 v5, 9344, v5
    v_lshl_add_u32 v61, v4, 4, v5
    s_lshr_b32 s69, s97, 1
    s_lshr_b32 s76, s2, 7
    s_lshl2_add_u32 s69, s69, s76
    s_mul_i32 s69, s69, 74752
    s_add_u32 s69, s69, 8389632
    s_barrier
    s_add_u32 s78, s65, 11
    s_and_b32 s78, s78, 15
    s_lshl_b32 s78, s78, 17
    s_lshl_b32 s79, s62, 11
    s_add_u32 m0, s79, 147456
    s_add_u32 s79, s78, 15360
    buffer_load_dwordx4 v26, s[36:39], s78 offen lds
    buffer_load_dwordx4 v26, s[36:39], s79 offen offset:1024 lds
    s_add_u32 s78, s65, 12
    s_and_b32 s78, s78, 15
    s_lshl_b32 s78, s78, 17
    s_lshl_b32 s79, s62, 11
    s_add_u32 m0, s79, 155648
    s_add_u32 s79, s78, 15360
    buffer_load_dwordx4 v26, s[36:39], s78 offen lds
    buffer_load_dwordx4 v26, s[36:39], s79 offen offset:1024 lds
    buffer_load_dword v64, v65, s[40:43], s82 offen offset:2560 sc1
    s_barrier
    s_setprio 3
    v_mov_b32 v4, s89
    v_lshlrev_b32 v5, 2, v1
    ds_write_b32 v5, v4 offset:24832
    v_mov_b32 v70, 0
    v_mov_b32 v71, 0
    ds_write_b64 v70, v[70:71] offset:25984
    s_mov_b32 s88, 0
    s_branch L_p2first_13
L_p2_14:
    buffer_load_dword v64, v65, s[40:43], s82 offen offset:2560 sc1
L_p2first_13:
    s_waitcnt vmcnt(0)
    v_cmp_eq_u32_e64 vcc, -1, v64
    s_nop 0
    s_cbranch_vccz L_ok_15
    s_add_u32 s88, s88, 1
    s_cmp_lt_u32 s88, 65536
    s_cbranch_scc1 L_p2_14
L_ok_15:
    s_add_u32 s78, s65, 13
    s_and_b32 s78, s78, 15
    s_lshl_b32 s78, s78, 17
    s_lshl_b32 s79, s62, 11
    s_add_u32 m0, s79, 32768
    s_add_u32 s79, s78, 15360
    buffer_load_dwordx4 v26, s[36:39], s78 offen lds
    buffer_load_dwordx4 v26, s[36:39], s79 offen offset:1024 lds
    s_add_u32 s78, s65, 14
    s_and_b32 s78, s78, 15
    s_lshl_b32 s78, s78, 17
    s_lshl_b32 s79, s62, 11
    s_add_u32 m0, s79, 40960
    s_add_u32 s79, s78, 15360
    buffer_load_dwordx4 v26, s[36:39], s78 offen lds
    buffer_load_dwordx4 v26, s[36:39], s79 offen offset:1024 lds
    s_add_u32 s78, s65, 15
    s_and_b32 s78, s78, 15
    s_lshl_b32 s78, s78, 17
    s_lshl_b32 s79, s62, 11
    s_add_u32 m0, s79, 49152
    s_add_u32 s79, s78, 15360
    buffer_load_dwordx4 v26, s[36:39], s78 offen lds
    buffer_load_dwordx4 v26, s[36:39], s79 offen offset:1024 lds
    s_lshl_b32 s76, s62, 11
    s_lshl_b32 s77, s60, 7
    s_add_u32 s76, s76, s77
    s_add_u32 s76, s76, s69
    s_add_u32 s77, s76, 37376
    s_mov_b32 s78, 0x00003f80
    s_mov_b32 s79, 0x3f800000
    s_mov_b32 s88, 0
L_poll_16:
    buffer_load_dwordx4 v[32:35], v61, s[40:43], s76 offen sc1
    buffer_load_dwordx4 v[36:39], v61, s[40:43], s77 offen sc1
    s_waitcnt vmcnt(0)
    v_max_u32 v4, v32, v36
    v_cmp_eq_u32_e64 vcc, -1, v4
    s_nop 0
    s_cbranch_vccz L_ok_17
    s_add_u32 s88, s88, 1
    s_cmp_lt_u32 s88, 65536
    s_cbranch_scc1 L_poll_16
L_ok_17:
    v_dot2_f32_bf16 v48, v32, s78, 0
    v_dot2_f32_bf16 v49, v32, s79, 0
    v_dot2_f32_bf16 v50, v33, s78, 0
    v_dot2_f32_bf16 v51, v33, s79, 0
    v_dot2_f32_bf16 v52, v34, s78, 0
    v_dot2_f32_bf16 v53, v34, s79, 0
    v_dot2_f32_bf16 v54, v35, s78, 0
    v_dot2_f32_bf16 v55, v35, s79, 0
    v_dot2_f32_bf16 v48, v36, s78, v48
    v_dot2_f32_bf16 v49, v36, s79, v49
    v_dot2_f32_bf16 v50, v37, s78, v50
    v_dot2_f32_bf16 v51, v37, s79, v51
    v_dot2_f32_bf16 v52, v38, s78, v52
    v_dot2_f32_bf16 v53, v38, s79, v53
    v_dot2_f32_bf16 v54, v39, s78, v54
    v_dot2_f32_bf16 v55, v39, s79, v55
    buffer_load_dwordx4 v[40:43], v13, s[40:43], s81 offen offset:2048 sc1
    buffer_load_dwordx4 v[44:47], v13, s[40:43], s68 offen offset:2048 sc1
    v_permlane32_swap_b32 v48, v52
    v_permlane32_swap_b32 v49, v53
    v_permlane32_swap_b32 v50, v54
    v_permlane32_swap_b32 v51, v55
    v_add_f32 v48, v48, v52
    v_add_f32 v49, v49, v53
    v_add_f32 v50, v50, v54
    v_add_f32 v51, v51, v55
    s_nop 0
    v_permlane16_swap_b32 v48, v50
    v_permlane16_swap_b32 v49, v51
    v_add_f32 v48, v48, v50
    v_add_f32_e64 v49, v49, v51
    s_nop 0
    v_add_f32_dpp v48, v48, v48 row_ror:8 row_mask:0xf bank_mask:0xf
    v_add_f32_dpp v49, v49, v49 row_ror:8 row_mask:0xf bank_mask:0xf
    v_cvt_pk_bf16_f32 v48, v48, v49
    s_bitcmp1_b32 s100, 0
    s_cbranch_scc1 L_loc_18
    buffer_store_dword v48, v67, s[40:43], s83 offen offset:3072 sc1
    s_branch L_pubd_19
L_loc_18:
    buffer_store_dword v48, v67, s[40:43], s83 offen offset:3072
L_pubd_19:
    s_mov_b32 s88, 0
    s_waitcnt vmcnt(1)
    s_branch L_zfirst_20
L_z_21:
    buffer_load_dwordx4 v[40:43], v13, s[40:43], s81 offen offset:2048 sc1
    buffer_load_dwordx4 v[44:47], v13, s[40:43], s68 offen offset:2048 sc1
    s_waitcnt vmcnt(0)
L_zfirst_20:
    v_max3_u32 v4, v40, v41, v42
    v_max3_u32 v4, v4, v43, v44
    v_max3_u32 v4, v4, v45, v46
    v_max_u32 v4, v4, v47
    v_cmp_eq_u32 vcc, -1, v4
    s_nop 0
    s_cbranch_vccz L_ok_22
    s_add_u32 s88, s88, 1
    s_cmp_lt_u32 s88, 65536
    s_cbranch_scc1 L_z_21
L_ok_22:
    v_add_f32 v40, v40, v44
    v_add_f32 v41, v41, v45
    v_add_f32 v42, v42, v46
    v_add_f32 v43, v43, v47
    v_permlane32_swap_b32 v40, v41
    s_nop 0
    v_permlane32_swap_b32 v42, v43
    v_add_f32 v40, v40, v41
    v_add_f32 v42, v42, v43
    s_nop 1
    v_permlane16_swap_b32 v40, v42
    v_add_f32 v40, v40, v42
    s_nop 1
    v_add_f32_dpp v40, v40, v40 row_ror:8 row_mask:0xf bank_mask:0xf
    v_cvt_pk_bf16_f32 v40, v40, v40
    ds_write_b16 v66, v40 offset:24576
    s_waitcnt lgkmcnt(0)
    s_barrier
    s_setprio 0
    s_mov_b64 exec, 3
    global_load_dword v27, v91, s[66:67]
    s_mov_b64 exec, -1
    s_lshl_b32 s78, s97, 18
    s_lshl_b32 s79, s62, 16
    s_add_u32 s78, s78, s79
    s_lshl_b32 s79, s98, 7
    s_add_u32 s78, s78, s79
    s_lshl_b32 s79, s62, 12
    s_add_u32 m0, s79, 0
    s_nop 0
    buffer_load_dwordx4 v78, s[28:31], s78 offen offset:0 lds
    s_add_u32 s78, s78, 15360
    buffer_load_dwordx4 v79, s[28:31], s78 offen offset:1024 lds
    s_add_u32 s78, s78, 15360
    buffer_load_dwordx4 v78, s[28:31], s78 offen offset:2048 lds
    s_add_u32 s78, s78, 15360
    buffer_load_dwordx4 v79, s[28:31], s78 offen offset:3072 lds
    s_barrier
    s_lshl4_add_u32 s76, s97, s98
    s_mul_i32 s76, s76, 28800
    s_add_u32 s20, s26, s76
    s_addc_u32 s21, s27, 0
    s_cmp_eq_u32 s62, 0
    s_cbranch_scc0 L_now0_25
    s_sleep 4
    s_load_dwordx16 s[4:19], s[20:21], 3584 glc
    s_waitcnt lgkmcnt(0)
    s_and_b64 s[4:5], s[4:5], s[6:7]
    s_and_b64 s[4:5], s[4:5], s[8:9]
    s_and_b64 s[4:5], s[4:5], s[10:11]
    s_and_b64 s[4:5], s[4:5], s[12:13]
    s_and_b64 s[4:5], s[4:5], s[14:15]
    s_and_b64 s[4:5], s[4:5], s[16:17]
    s_and_b64 s[4:5], s[4:5], s[18:19]
    s_nand_b32 s4, s4, s5
    s_and_b32 s4, s4, 0xffff
    s_mul_i32 s4, s4, 0x10001
    s_lshr_b32 s4, s4, s65
    s_and_b32 s77, s4, 0xffff
    v_mov_b32_e64 v69, s77
    ds_write_b32 v70, v69 offset:25984
L_now0_25:
    s_waitcnt vmcnt(0) lgkmcnt(0)
    s_barrier
    s_cmp_eq_u32 s62, 0
    s_cbranch_scc0 L_now1_23
    s_mov_b32 s88, 0
L_spin_26:
    s_load_dwordx16 s[4:19], s[20:21], 3584 glc
    s_waitcnt lgkmcnt(0)
    s_and_b64 s[4:5], s[4:5], s[6:7]
    s_and_b64 s[4:5], s[4:5], s[8:9]
    s_and_b64 s[4:5], s[4:5], s[10:11]
    s_and_b64 s[4:5], s[4:5], s[12:13]
    s_and_b64 s[4:5], s[4:5], s[14:15]
    s_and_b64 s[4:5], s[4:5], s[16:17]
    s_and_b64 s[4:5], s[4:5], s[18:19]
    s_nand_b32 s4, s4, s5
    s_and_b32 s4, s4, 0xffff
    s_mul_i32 s4, s4, 0x10001
    s_lshr_b32 s4, s4, s65
    s_and_b32 s77, s4, 0xffff
    v_mov_b32 v69, s77
    ds_write_b32 v70, v69 offset:25984
    s_cmp_eq_u32 s77, 0xffff
    s_cbranch_scc1 L_s2done_24
    s_add_u32 s88, s88, 1
    s_cmp_lt_u32 s88, 65536
    s_cbranch_scc1 L_spin_26
    s_branch L_s2done_24
L_now1_23:
    s_cmp_eq_u32 s62, 1
    s_cbranch_scc0 L_s2done_24
    s_lshl_b32 s77, 1, s61
    s_not_b32 s77, s77
    v_mov_b32_e64 v4, s77
    v_mul_u32_u24 v5, 28800, v1
    s_mul_i32 s76, s60, 460800
    s_lshl2_add_u32 s76, s61, s76
    s_mov_b32 s88, 0
L_spin_27:
    ds_read_b32 v69, v70 offset:25988
    s_waitcnt lgkmcnt(0)
    v_cmp_eq_u32_e64 vcc, 4, v69
    s_nop 0
    s_cbranch_vccnz L_drained_28
    s_add_u32 s88, s88, 1
    s_cmp_lt_u32 s88, 1048576
    s_cbranch_scc1 L_spin_27
L_drained_28:
    s_mov_b64 exec, 0xffff
    buffer_store_dword v4, v5, s[40:43], s76 offen offset:3584 sc1
    s_mov_b64 exec, -1
L_s2done_24:
    s_waitcnt vmcnt(0)
    v_lshlrev_b32 v17, 5, v2
    v_lshl_add_u32 v17, v3, 4, v17
    v_and_b32 v4, 15, v1
    v_lshrrev_b32 v5, 1, v4
    v_and_b32 v4, 1, v4
    v_lshlrev_b32 v4, 5, v4
    v_lshl_add_u32 v16, v5, 7, v4
    v_lshrrev_b32 v4, 3, v1
    v_and_b32 v5, 7, v1
    v_lshlrev_b32_e64 v5, 4, v5
    v_mul_u32_u24 v18, 9344, v4
    v_add_u32_e64 v18, v18, v5
    v_bfe_u32 v6, v1, 4, 1
    v_lshl_add_u32 v6, v6, 1, v3
    v_lshl_add_u32 v19, v6, 2, v5
    s_mul_i32 s84, s97, 149504
    s_lshl_b32 s77, s98, 7
    s_add_u32 s84, s84, s77
    s_add_u32 s84, s84, 8388608
    s_lshl_b32 s85, s62, 10
    s_add_u32 s85, s85, s99
    s_add_u32 s85, s85, 5120
    s_and_b32 s87, s97, 1
    s_lshl_b32 s87, s87, 4
    s_add_u32 s87, s87, s98
    s_lshr_b32 s86, s97, 1
    s_mul_i32 s86, s86, 299008
    s_lshl_b32 s77, s87, 7
    s_add_u32 s86, s86, s77
    s_add_u32 s86, s86, 8393728
    s_lshl_b32 s78, s62, 11
    s_add_u32 s79, s78, s99
    s_bitcmp1_b32 s100, 1
    s_cbranch_scc1 L_loc_29
    buffer_store_dwordx4 v[28:31], v12, s[40:43], s79 offen offset:1024 sc1
    buffer_store_dwordx4 v[28:31], v12, s[40:43], s79 offen offset:2048 sc1
    s_branch L_pubd_30
L_loc_29:
    buffer_store_dwordx4 v[28:31], v12, s[40:43], s79 offen offset:1024
    buffer_store_dwordx4 v[28:31], v12, s[40:43], s79 offen offset:2048
L_pubd_30:
    s_lshl4_add_u32 s78, s97, s98
    s_lshl4_add_u32 s78, s78, s62
    s_add_u32 s78, s78, 12591116
    s_waitcnt vmcnt(0)
    s_mov_b64 exec, 1
    s_bitcmp1_b32 s100, 1
    s_cbranch_scc1 L_loc_31
    buffer_store_byte v28, v70, s[40:43], s78 offen sc1
    s_branch L_pubd_32
L_loc_31:
    buffer_store_byte v28, v70, s[40:43], s78 offen
L_pubd_32:
    s_mov_b64 exec, -1
    s_cmp_eq_u32 s62, 0
    s_cbranch_scc0 L_nop3c_33
    s_mov_b32 exec_lo, 0
    s_mov_b32 s88, 0
L_spin_34:
    buffer_load_dword v4, v90, s[40:43], 0 offen offset:12 sc1
    s_waitcnt vmcnt(0)
    v_cmp_ne_u32 vcc, -1, v4
    s_nop 0
    s_cbranch_vccz L_p3ok_35
    s_add_u32 s88, s88, 1
    s_cmp_lt_u32 s88, 65536
    s_cbranch_scc1 L_spin_34
L_p3ok_35:
    s_mov_b64 exec, -1
L_nop3c_33:
    s_barrier
    buffer_load_dwordx4 v[156:159], v76, s[48:51], s75 offen nt
    s_add_u32 s75, s75, 7168
    buffer_load_dwordx4 v[32:35], v77, s[52:55], s96 offen nt
    s_add_u32 s96, s96, 4096
    buffer_load_dwordx4 v[36:39], v77, s[52:55], s96 offen nt
    s_add_u32 s96, s96, 4096
    buffer_load_dwordx4 v[40:43], v77, s[52:55], s96 offen nt
    s_add_u32 s96, s96, 4096
    buffer_load_dwordx4 v[44:47], v77, s[52:55], s96 offen nt
    s_add_u32 s96, s96, 4096
    v_mul_u32_u24 v20, 149504, v1
    s_mul_i32 s72, s98, 9344
    s_lshl2_add_u32 s72, s97, s72
    s_add_u32 s72, s72, 8388608
    s_barrier
    s_cmp_eq_u32 s62, 1
    s_cbranch_scc0 L_nopre_36
    s_mov_b64 exec, 0xffff
    buffer_store_dword v70, v20, s[40:43], s72 offen offset:768 sc1
    s_mov_b64 exec, -1
L_nopre_36:
    buffer_load_dwordx4 v[48:51], v77, s[52:55], s96 offen nt
    s_add_u32 s96, s96, 4096
    buffer_load_dwordx4 v[52:55], v77, s[52:55], s96 offen nt
    s_add_u32 s96, s96, 4096
    buffer_load_dwordx4 v[56:59], v77, s[52:55], s96 offen nt
    s_add_u32 s96, s96, 4096
    buffer_load_dwordx4 v[60:63], v77, s[52:55], s96 offen nt
    s_add_u32 s96, s96, 4096
    s_barrier
    s_waitcnt vmcnt(8)
    s_mov_b32 s78, 0x05040100
    s_mov_b32 s79, 0x07060302
    v_perm_b32 v160, v100, v96, s78
    v_perm_b32 v164, v100, v96, s79
    v_perm_b32 v168, v101, v97, s78
    v_perm_b32 v172, v101, v97, s79
    v_perm_b32 v176, v102, v98, s78
    v_perm_b32 v180, v102, v98, s79
    v_perm_b32 v184, v103, v99, s78
    v_perm_b32 v188, v103, v99, s79
    v_perm_b32 v161, v108, v104, s78
    v_perm_b32 v165, v108, v104, s79
    v_perm_b32 v169, v109, v105, s78
    v_perm_b32 v173, v109, v105, s79
    v_perm_b32 v177, v110, v106, s78
    v_perm_b32 v181, v110, v106, s79
    v_perm_b32 v185, v111, v107, s78
    v_perm_b32 v189, v111, v107, s79
    v_perm_b32 v162, v116, v112, s78
    v_perm_b32 v166, v116, v112, s79
    v_perm_b32 v170, v117, v113, s78
    v_perm_b32 v174, v117, v113, s79
    v_perm_b32 v178, v118, v114, s78
    v_perm_b32 v182, v118, v114, s79
    v_perm_b32 v186, v119, v115, s78
    v_perm_b32 v190, v119, v115, s79
    v_perm_b32 v163, v124, v120, s78
    v_perm_b32 v167, v124, v120, s79
    v_perm_b32 v171, v125, v121, s78
    v_perm_b32 v175, v125, v121, s79
    v_perm_b32 v179, v126, v122, s78
    v_perm_b32 v183, v126, v122, s79
    v_perm_b32 v187, v127, v123, s78
    v_perm_b32 v191, v127, v123, s79
    v_perm_b32 v192, v132, v128, s78
    v_perm_b32 v196, v132, v128, s79
    v_perm_b32 v200, v133, v129, s78
    v_perm_b32 v204, v133, v129, s79
    v_perm_b32 v208, v134, v130, s78
    v_perm_b32 v212, v134, v130, s79
    v_perm_b32 v216, v135, v131, s78
    v_perm_b32 v220, v135, v131, s79
    v_perm_b32 v193, v140, v136, s78
    v_perm_b32 v197, v140, v136, s79
    v_perm_b32 v201, v141, v137, s78
    v_perm_b32 v205, v141, v137, s79
    v_perm_b32 v209, v142, v138, s78
    v_perm_b32 v213, v142, v138, s79
    v_perm_b32 v217, v143, v139, s78
    v_perm_b32 v221, v143, v139, s79
    v_perm_b32 v194, v148, v144, s78
    v_perm_b32 v198, v148, v144, s79
    v_perm_b32 v202, v149, v145, s78
    v_perm_b32 v206, v149, v145, s79
    v_perm_b32 v210, v150, v146, s78
    v_perm_b32 v214, v150, v146, s79
    v_perm_b32 v218, v151, v147, s78
    v_perm_b32 v222, v151, v147, s79
    v_perm_b32 v195, v156, v152, s78
    v_perm_b32 v199, v156, v152, s79
    v_perm_b32 v203, v157, v153, s78
    v_perm_b32 v207, v157, v153, s79
    v_perm_b32 v211, v158, v154, s78
    v_perm_b32 v215, v158, v154, s79
    v_perm_b32 v219, v159, v155, s78
    v_perm_b32 v223, v159, v155, s79
    s_waitcnt vmcnt(0)
    s_mov_b32 s78, 0x05040100
    s_mov_b32 s79, 0x07060302
    v_permlane32_swap_b32 v32, v34
    v_permlane32_swap_b32 v33, v35
    v_permlane32_swap_b32 v36, v38
    v_permlane32_swap_b32 v37, v39
    v_permlane32_swap_b32 v40, v42
    v_permlane32_swap_b32 v41, v43
    v_permlane32_swap_b32 v44, v46
    v_permlane32_swap_b32 v45, v47
    v_permlane32_swap_b32 v48, v50
    v_permlane32_swap_b32 v49, v51
    v_permlane32_swap_b32 v52, v54
    v_permlane32_swap_b32 v53, v55
    v_permlane32_swap_b32 v56, v58
    v_permlane32_swap_b32 v57, v59
    v_permlane32_swap_b32 v60, v62
    v_permlane32_swap_b32_e64 v61, v63
    v_perm_b32 v224, v34, v32, s78
    v_perm_b32 v225, v34, v32, s79
    v_perm_b32 v226, v35, v33, s78
    v_perm_b32 v227, v35, v33, s79
    v_perm_b32 v228, v38, v36, s78
    v_perm_b32 v229, v38, v36, s79
    v_perm_b32 v230, v39, v37, s78
    v_perm_b32 v231, v39, v37, s79
    v_perm_b32 v232, v42, v40, s78
    v_perm_b32 v233, v42, v40, s79
    v_perm_b32 v234, v43, v41, s78
    v_perm_b32 v235, v43, v41, s79
    v_perm_b32 v236, v46, v44, s78
    v_perm_b32 v237, v46, v44, s79
    v_perm_b32 v238, v47, v45, s78
    v_perm_b32 v239, v47, v45, s79
    v_perm_b32 v240, v50, v48, s78
    v_perm_b32 v241, v50, v48, s79
    v_perm_b32 v242, v51, v49, s78
    v_perm_b32 v243, v51, v49, s79
    v_perm_b32 v244, v54, v52, s78
    v_perm_b32 v245, v54, v52, s79
    v_perm_b32 v246, v55, v53, s78
    v_perm_b32 v247, v55, v53, s79
    v_perm_b32 v248, v58, v56, s78
    v_perm_b32 v249, v58, v56, s79
    v_perm_b32 v250, v59, v57, s78
    v_perm_b32 v251, v59, v57, s79
    v_perm_b32 v252, v62, v60, s78
    v_perm_b32 v253, v62, v60, s79
    v_perm_b32 v254, v63, v61, s78
    v_perm_b32 v255, v63, v61, s79
    v_and_b32 v5, 15, v1
    v_lshlrev_b32 v5, 3, v5
    s_lshl_b32 s76, s63, 10
    s_lshl_b32 s77, s64, 6
    s_add_u32 s76, s76, s77
    s_add_u32 s76, s76, s99
    s_mov_b64 s[80:81], 0xffff
    s_add_u32 s68, s84, 74752
    s_add_u32 s69, s86, 74752
    s_add_u32 s70, s86, 149504
    s_add_u32 s71, s86, 224256
    s_setprio 3
    s_barrier
    ds_read_b128 v[64:67], v12 offset:28672
    ds_read_b128 v[68:71], v12 offset:29696
    ds_read_b64 v[8:9], v5 offset:25728
    s_waitcnt lgkmcnt(2)
    v_mfma_f32_16x16x32_bf16 v[96:99], v[64:67], v[160:163], 0
    v_mfma_f32_16x16x32_bf16 v[100:103], v[64:67], v[164:167], 0
    s_waitcnt lgkmcnt(0)
    v_max_f32_dpp v4, v8, v8 row_ror:8 row_mask:0xf bank_mask:0xf
    v_mfma_f32_16x16x32_bf16 v[104:107], v[64:67], v[168:171], 0
    v_mfma_f32_16x16x32_bf16 v[108:111], v[64:67], v[172:175], 0
    v_max_f32_dpp v4, v4, v4 row_ror:4 row_mask:0xf bank_mask:0xf
    v_mfma_f32_16x16x32_bf16 v[112:115], v[64:67], v[176:179], 0
    v_mfma_f32_16x16x32_bf16 v[116:119], v[64:67], v[180:183], 0
    v_max_f32_dpp v4, v4, v4 row_ror:2 row_mask:0xf bank_mask:0xf
    v_mfma_f32_16x16x32_bf16 v[120:123], v[64:67], v[184:187], 0
    v_mfma_f32_16x16x32_bf16 v[124:127], v[64:67], v[188:191], 0
    v_max_f32_dpp v4, v4, v4 row_ror:1 row_mask:0xf bank_mask:0xf
    v_mfma_f32_16x16x32_bf16 v[96:99], v[68:71], v[192:195], v[96:99]
    v_cmp_eq_f32_e64 vcc, v4, v8
    v_mfma_f32_16x16x32_bf16 v[100:103], v[68:71], v[196:199], v[100:103]
    s_ff1_i32_b32 s92, vcc_lo
    s_and_b32 s92, s92, 15
    v_mfma_f32_16x16x32_bf16 v[104:107], v[68:71], v[200:203], v[104:107]
    s_lshr_b32 s78, s92, 2
    s_lshl_b32 s78, s78, 4
    v_mfma_f32_16x16x32_bf16 v[108:111], v[68:71], v[204:207], v[108:111]
    s_and_b32 s77, s92, 3
    v_mfma_f32_16x16x32_bf16 v[112:115], v[68:71], v[208:211], v[112:115]
    v_readlane_b32 s91, v9, s92
    v_readlane_b32 s93, v8, s92
    v_mfma_f32_16x16x32_bf16 v[116:119], v[68:71], v[212:215], v[116:119]
    v_mfma_f32_16x16x32_bf16 v[120:123], v[68:71], v[216:219], v[120:123]
    v_mfma_f32_16x16x32_bf16 v[124:127], v[68:71], v[220:223], v[124:127]
    s_cmp_ge_u32 s97, 14
    s_cbranch_scc1 L_final
    s_cmp_eq_u32 s77, 0
    s_cbranch_scc0 L_sel_38
    v_mov_b32 v64, v96
    v_mov_b32 v65, v100
    v_mov_b32 v66, v104
    v_mov_b32 v67, v108
    v_mov_b32 v68, v112
    v_mov_b32 v69, v116
    v_mov_b32 v70, v120
    v_mov_b32 v71, v124
    s_branch L_seldone_37
L_sel_38:
    s_cmp_eq_u32 s77, 1
    s_cbranch_scc0 L_sel_39
    v_mov_b32 v64, v97
    v_mov_b32 v65, v101
    v_mov_b32 v66, v105
    v_mov_b32 v67, v109
    v_mov_b32 v68, v113
    v_mov_b32 v69, v117
    v_mov_b32 v70, v121
    v_mov_b32 v71, v125
    s_branch L_seldone_37
L_sel_39:
    s_cmp_eq_u32 s77, 2
    s_cbranch_scc0 L_sel_40
    v_mov_b32 v64, v98
    v_mov_b32 v65, v102
    v_mov_b32 v66, v106
    v_mov_b32 v67, v110
    v_mov_b32 v68, v114
    v_mov_b32 v69, v118
    v_mov_b32 v70, v122
    v_mov_b32 v71, v126
    s_branch L_seldone_37
L_sel_40:
    v_mov_b32 v64, v99
    v_mov_b32 v65, v103
    v_mov_b32 v66, v107
    v_mov_b32 v67, v111
    v_mov_b32 v68, v115
    v_mov_b32 v69, v119
    v_mov_b32 v70, v123
    v_mov_b32_e64 v71, v127
L_seldone_37:
    s_lshl_b64 exec, s[80:81], s78
    s_bitcmp1_b32 s100, 1
    s_cbranch_scc1 L_loc_42
    buffer_store_dwordx4 v[64:67], v16, s[40:43], s76 offen offset:3072 sc1
    buffer_store_dwordx4 v[68:71], v16, s[40:43], s76 offen offset:3088 sc1
    s_branch L_pubd_43
L_loc_42:
    buffer_store_dwordx4 v[64:67], v16, s[40:43], s76 offen offset:3072
    buffer_store_dwordx4 v[68:71], v16, s[40:43], s76 offen offset:3088
L_pubd_43:
    s_mov_b64 exec, -1
    s_mov_b32 s88, 0
L_poll_44:
    buffer_load_dwordx4 v[128:131], v18, s[40:43], s84 offen offset:3072 sc1
    buffer_load_dwordx4 v[132:135], v18, s[40:43], s68 offen offset:3072 sc1
    s_waitcnt vmcnt(0)
    v_max_u32 v4, v128, v132
    v_cmp_eq_u32_e64 vcc, -1, v4
    s_nop 0
    s_cbranch_vccz L_ok_45
    s_add_u32 s88, s88, 1
    s_cmp_lt_u32 s88, 65536
    s_cbranch_scc1 L_poll_44
L_ok_45:
    v_pk_add_f32 v[48:49], v[128:129], v[132:133]
    v_pk_add_f32 v[50:51], v[130:131], v[134:135]
    s_nop 0
    v_permlane32_swap_b32 v48, v49
    v_permlane32_swap_b32 v50, v51
    v_add_f32 v48, v48, v49
    v_add_f32 v50, v50, v51
    s_nop 1
    v_permlane16_swap_b32 v48, v50
    v_add_f32 v48, v48, v50
    s_nop 1
    v_add_f32_dpp v48, v48, v48 row_ror:8 row_mask:0xf bank_mask:0xf
    v_cvt_pk_bf16_f32 v48, v48, v48
    v_and_b32_e64 v48, s90, v48
    v_mul_f32 v4, 0xbfb8aa3b, v48
    v_exp_f32_e64 v4, v4
    v_mov_b32_dpp v49, v48 row_ror:12 row_mask:0xf bank_mask:0xf
    v_add_f32 v4, 1.0, v4
    v_rcp_f32 v4, v4
    s_nop 0
    v_mul_f32 v4, v4, v48
    v_cvt_pk_bf16_f32 v4, v4, v4
    v_and_b32 v4, s90, v4
    v_mul_f32 v4, v4, v49
    v_mov_b32 v5, v4
    s_nop 1
    v_permlane32_swap_b32_e64 v4, v5
    v_cvt_pk_bf16_f32 v4, v4, v5
    s_nop 0
    v_readlane_b32 s76, v4, 0
    v_readlane_b32 s77, v4, 16
    v_readlane_b32 s78, v4, 1
    v_readlane_b32 s79, v4, 17
    v_readlane_b32 s80, v4, 2
    v_readlane_b32 s81, v4, 18
    v_readlane_b32 s82, v4, 3
    v_readlane_b32 s83, v4, 19
    v_dot2_f32_bf16 v40, v224, s76, 0
    v_dot2_f32_bf16 v41, v225, s76, 0
    v_dot2_f32_bf16 v42, v226, s76, 0
    v_dot2_f32_bf16 v43, v227, s76, 0
    v_dot2_f32_bf16 v40, v228, s77, v40
    v_dot2_f32_bf16 v41, v229, s77, v41
    v_dot2_f32_bf16 v42, v230, s77, v42
    v_dot2_f32_bf16 v43, v231, s77, v43
    v_dot2_f32_bf16 v40, v232, s78, v40
    v_dot2_f32_bf16 v41, v233, s78, v41
    v_dot2_f32_bf16 v42, v234, s78, v42
    v_dot2_f32_bf16 v43, v235, s78, v43
    v_dot2_f32_bf16 v40, v236, s79, v40
    v_dot2_f32_bf16 v41, v237, s79, v41
    v_dot2_f32_bf16 v42, v238, s79, v42
    v_dot2_f32_bf16 v43, v239, s79, v43
    v_dot2_f32_bf16 v40, v240, s80, v40
    v_dot2_f32_bf16 v41, v241, s80, v41
    v_dot2_f32_bf16 v42, v242, s80, v42
    v_dot2_f32_bf16 v43, v243, s80, v43
    v_dot2_f32_bf16 v40, v244, s81, v40
    v_dot2_f32_bf16 v41, v245, s81, v41
    v_dot2_f32_bf16 v42, v246, s81, v42
    v_dot2_f32_bf16 v43, v247, s81, v43
    v_dot2_f32_bf16 v40, v248, s82, v40
    v_dot2_f32_bf16 v41, v249, s82, v41
    v_dot2_f32_bf16 v42, v250, s82, v42
    v_dot2_f32_bf16 v43, v251, s82, v43
    v_dot2_f32_bf16 v40, v252, s83, v40
    v_dot2_f32_bf16 v41, v253, s83, v41
    v_dot2_f32_bf16 v42, v254, s83, v42
    v_dot2_f32_bf16 v43, v255, s83, v43
    s_bitcmp1_b32 s100, 1
    s_cbranch_scc1 L_loc_46
    s_nop 0
    buffer_store_dwordx4 v[40:43], v17, s[40:43], s85 offen sc1
    s_branch L_pubd_47
L_loc_46:
    s_nop 0
    buffer_store_dwordx4 v[40:43], v17, s[40:43], s85 offen
L_pubd_47:
    s_cmp_eq_u32 s62, 0
    s_cbranch_scc0 L_hby
    s_mov_b32 s88, 0
L_poll_48:
    buffer_load_dwordx4 v[136:139], v18, s[40:43], s86 offen sc1
    buffer_load_dwordx4 v[140:143], v18, s[40:43], s69 offen sc1
    buffer_load_dwordx4 v[144:147], v18, s[40:43], s70 offen sc1
    buffer_load_dwordx4 v[148:151], v18, s[40:43], s71 offen sc1
    s_waitcnt vmcnt(0)
    v_max3_u32 v4, v136, v140, v144
    v_max_u32 v4, v4, v148
    v_cmp_eq_u32_e64 vcc, -1, v4
    s_nop 0
    s_cbranch_vccz L_ok_49
    s_add_u32 s88, s88, 1
    s_cmp_lt_u32 s88, 65536
    s_cbranch_scc1 L_poll_48
L_ok_49:
    v_pk_add_f32 v[48:49], v[136:137], v[144:145]
    v_pk_add_f32 v[50:51], v[138:139], v[146:147]
    v_pk_add_f32 v[52:53], v[140:141], v[148:149]
    v_pk_add_f32 v[54:55], v[142:143], v[150:151]
    v_pk_add_f32 v[48:49], v[48:49], v[52:53]
    v_pk_add_f32 v[50:51], v[50:51], v[54:55]
    s_nop 0
    v_permlane32_swap_b32 v48, v49
    v_permlane32_swap_b32 v50, v51
    v_add_f32 v48, v48, v49
    v_add_f32 v50, v50, v51
    s_nop 1
    v_permlane16_swap_b32 v48, v50
    v_add_f32 v48, v48, v50
    s_nop 1
    v_add_f32_dpp v48, v48, v48 row_ror:8 row_mask:0xf bank_mask:0xf
    buffer_store_dword v48, v19, s[40:43], s99 offen offset:512 sc1
L_hby:
    s_barrier
    s_lshl2_add_u32 s72, s87, s62
    s_cmp_eq_u32 s72, 0
    s_cbranch_scc0 L_nowb_50
    s_waitcnt vmcnt(0)
    buffer_wbl2 sc1
L_nowb_50:
    s_branch L_hfin
L_final:
    s_barrier
    s_lshl2_add_u32 s72, s87, s62
    s_cmp_eq_u32 s72, 3
    s_cbranch_scc0 L_nowb_51
    s_waitcnt vmcnt(0)
    buffer_wbl2 sc1
L_nowb_51:
    s_cmp_eq_u32 s62, 1
    s_cbranch_scc0 L_noep_52
    s_cmp_eq_u32 s87, 0
    s_cbranch_scc0 L_noep_52
    v_mov_b32 v4, 13631488
    s_mov_b64 exec, 1
    buffer_store_dwordx2 v[88:89], v4, s[40:43], 0 offen sc1
    s_mov_b64 exec, -1
L_noep_52:
    s_cmp_eq_u32 s62, 0
    s_cbranch_scc0 L_hfin
    v_mov_b32 v8, s93
    v_cvt_pk_bf16_f32 v8, v8, v8
    v_and_b32_e64 v8, s90, v8
    v_mul_f32 v8, 0xbfb8aa3b, v8
    v_exp_f32 v8, v8
    s_nop 0
    v_add_f32 v8, 1.0, v8
    v_rcp_f32_e64 v8, v8
    s_nop 0
    v_cvt_pk_bf16_f32 v8, v8, v8
    v_and_b32 v8, s90, v8
    s_lshl_b32 s76, s92, 4
    s_lshr_b32 s77, s87, 1
    s_add_u32 s76, s76, s77
    s_mul_i32 s76, s76, 9344
    s_add_u32 s76, s76, 8388608
    s_and_b32 s77, s87, 1
    s_lshl_b32 s77, s77, 5
    s_add_u32 s76, s76, s77
    v_and_b32 v10, 1, v1
    v_lshlrev_b32_e64 v10, 6, v10
    v_bfe_u32 v4, v1, 1, 2
    v_lshl_add_u32 v10, v4, 3, v10
    v_bfe_u32 v4, v1, 4, 1
    v_lshl_add_u32 v10, v4, 2, v10
    v_lshrrev_b32_e64 v4, 3, v1
    v_mul_u32_u24 v6, 299008, v4
    v_and_b32_e64 v5, 7, v1
    v_lshl_add_u32 v6, v5, 4, v6
    v_mov_b32 v7, 2146435072
    v_cmp_gt_u32 vcc, 56, v1
    s_nop 1
    v_cndmask_b32_e64 v6, v7, v6, vcc
    s_mul_i32 s79, s87, 9344
    s_add_u32 s79, s79, 8388608
    s_lshl_b32 s80, s91, 11
    s_lshl_b32 s77, s87, 6
    s_add_u32 s80, s80, s77
    s_sleep 16
    s_mov_b32 s88, 0
L_spin_53:
    buffer_load_dword v64, v10, s[40:43], s76 offen offset:0 sc1
    buffer_load_dword v65, v10, s[40:43], s76 offen offset:128 sc1
    s_waitcnt vmcnt(0)
    v_max_u32 v4, v64, v65
    v_cmp_eq_u32_e64 vcc, -1, v4
    s_nop 0
    s_cbranch_vccz L_ok_54
    s_add_u32 s88, s88, 1
    s_cmp_lt_u32 s88, 65536
    s_cbranch_scc1 L_spin_53
L_ok_54:
    v_lshlrev_b32 v4, 4, v3
    v_lshrrev_b32 v64, v4, v64
    v_lshrrev_b32 v65, v4, v65
    v_lshlrev_b32 v64, 16, v64
    v_lshlrev_b32 v65, 16, v65
    v_lshrrev_b32 v9, 1, v19
    s_mov_b32 s88, 0
    buffer_load_dwordx4 v[128:131], v6, s[40:43], s79 offen offset:512 sc1
    s_sleep 3
    buffer_load_dwordx4 v[128:131], v6, s[40:43], s79 offen offset:512 sc1
    s_sleep 3
L_poll_55:
    buffer_load_dwordx4 v[128:131], v6, s[40:43], s79 offen offset:512 sc1
    s_waitcnt vmcnt(2)
    v_max3_u32 v4, v128, v129, v130
    v_max_u32 v4, v4, v131
    v_cmp_eq_u32 vcc, -1, v4
    s_nop 0
    s_cbranch_vccz L_ok_56
    s_add_u32 s88, s88, 1
    s_cmp_lt_u32 s88, 65536
    s_cbranch_scc1 L_poll_55
L_ok_56:
    v_mov_b32 v48, v128
    v_mov_b32 v49, v129
    v_mov_b32 v50, v130
    v_mov_b32 v51, v131
    v_permlane32_swap_b32 v48, v49
    s_nop 0
    v_permlane32_swap_b32 v50, v51
    v_add_f32 v48, v48, v49
    v_add_f32 v50, v50, v51
    s_nop 1
    v_permlane16_swap_b32 v48, v50
    v_add_f32 v48, v48, v50
    s_nop 1
    v_add_f32_dpp v48, v48, v48 row_ror:8 row_mask:0xf bank_mask:0xf
    v_cvt_pk_bf16_f32 v48, v48, v48
    v_and_b32 v48, s90, v48
    v_mul_f32 v48, v48, v8
    v_cvt_pk_bf16_f32 v48, v48, v48
    v_and_b32 v48, s90, v48
    v_add_f32 v48, v48, v64
    v_cvt_pk_bf16_f32 v48, v48, v48
    v_and_b32 v48, s90, v48
    v_add_f32 v48, v48, v65
    v_cvt_pk_bf16_f32 v48, v48, v48
    s_mov_b32 exec_lo, 0x00ff00ff
    s_mov_b32 exec_hi, 0x00ff00ff
    buffer_store_short v48, v9, s[44:47], s80 offen sc1
    s_mov_b64 exec, -1
L_hfin:
    s_endpgm
L_event:
    s_cmp_eq_u32 s77, 3
    s_cbranch_scc0 L_ev1
    buffer_load_dwordx4 v[92:95], v90, s[40:43], 0 offen sc1
    s_mov_b64 exec, 3
    global_load_dword v27, v91, s[66:67]
    s_mov_b64 exec, -1
    s_branch L_evret
L_ev1:
    s_cmp_eq_u32 s77, 5
    s_cbranch_scc0 L_ev_57
    s_and_b32 s72, s84, 15
    s_mov_b32 m0, s70
    s_lshl_b32 s71, s72, 7
    buffer_load_dwordx4 v16, s[28:31], s71 offen offset:0 lds
    s_mul_i32 s72, s72, 393216
    s_lshr_b64 s[84:85], s[84:85], 4
    buffer_load_dwordx4 v17, s[28:31], s71 offen offset:1024 lds
    buffer_load_dwordx4 v18, s[28:31], s71 offen offset:2048 lds
    buffer_load_dwordx4 v19, s[28:31], s71 offen offset:3072 lds
    s_add_u32 m0, s70, 4096
    s_nop 0
    buffer_load_dwordx4 v20, s[32:35], s72 offen offset:0 lds
    buffer_load_dwordx4 v21, s[32:35], s72 offen offset:1024 lds
    buffer_load_dwordx4 v22, s[32:35], s72 offen offset:2048 lds
    buffer_load_dwordx4 v23, s[32:35], s72 offen offset:3072 lds
    s_add_u32 m0, s70, 8192
    s_nop 0
    buffer_load_dwordx4 v24, s[32:35], s72 offen offset:0 lds
    buffer_load_dwordx4 v25, s[32:35], s72 offen offset:1024 lds
    s_add_u32 s70, s70, 40960
    s_cmp_ge_u32 s70, 122880
    s_cselect_b32 s76, 122880, 0
    s_sub_u32 s70, s70, s76
    buffer_load_dwordx4 v[96:99], v76, s[48:51], s75 offen nt
    s_add_u32 s75, s75, 7168
    buffer_load_dwordx4 v[100:103], v76, s[48:51], s75 offen nt
    s_add_u32 s75, s75, 7168
    buffer_load_dwordx4 v[104:107], v76, s[48:51], s75 offen nt
    s_add_u32 s75, s75, 7168
    buffer_load_dwordx4 v[108:111], v76, s[48:51], s75 offen nt
    s_add_u32 s75, s75, 7168
    buffer_load_dwordx4 v[128:131], v76, s[48:51], s75 offen nt
    s_add_u32 s75, s75, 7168
    buffer_load_dwordx4 v[132:135], v76, s[48:51], s75 offen nt
    s_add_u32 s75, s75, 7168
    buffer_load_dwordx4 v[136:139], v76, s[48:51], s75 offen nt
    s_add_u32 s75, s75, 7168
    buffer_load_dwordx4 v[140:143], v76, s[48:51], s75 offen nt
    s_add_u32 s75, s75, 7168
    s_waitcnt vmcnt(18)
    s_branch L_hbar
L_ev_57:
    s_cmp_eq_u32 s77, 6
    s_cbranch_scc0 L_ev_58
    s_and_b32 s72, s84, 15
    s_mov_b32 m0, s70
    s_lshl_b32 s71, s72, 7
    buffer_load_dwordx4 v16, s[28:31], s71 offen offset:0 lds
    s_mul_i32 s72, s72, 393216
    s_lshr_b64 s[84:85], s[84:85], 4
    buffer_load_dwordx4 v17, s[28:31], s71 offen offset:1024 lds
    buffer_load_dwordx4 v18, s[28:31], s71 offen offset:2048 lds
    buffer_load_dwordx4 v19, s[28:31], s71 offen offset:3072 lds
    s_add_u32 m0, s70, 4096
    s_nop 0
    buffer_load_dwordx4 v20, s[32:35], s72 offen offset:0 lds
    buffer_load_dwordx4 v21, s[32:35], s72 offen offset:1024 lds
    buffer_load_dwordx4 v22, s[32:35], s72 offen offset:2048 lds
    buffer_load_dwordx4 v23, s[32:35], s72 offen offset:3072 lds
    s_add_u32 m0, s70, 8192
    s_nop 0
    buffer_load_dwordx4 v24, s[32:35], s72 offen offset:0 lds
    buffer_load_dwordx4 v25, s[32:35], s72 offen offset:1024 lds
    s_add_u32 s70, s70, 40960
    s_cmp_ge_u32 s70, 122880
    s_cselect_b32 s76, 122880, 0
    s_sub_u32 s70, s70, s76
    s_lshr_b32 s78, s2, 3
    s_lshl2_add_u32 s78, s78, s62
    s_lshl_b32 s78, s78, 14
    v_lshlrev_b32_e64 v11, 10, v1
    s_mov_b64 exec, 65535
    buffer_load_dword v27, v11, s[36:39], s78 offen offset:384
    s_mov_b64 exec, -1
    s_lshl_b32 s78, s62, 9
    v_lshl_add_u32 v11, v1, 7, s78
    s_mov_b64 exec, 15
    global_load_dword v27, v11, s[14:15]
    s_mov_b64 exec, -1
    buffer_load_dwordx4 v[112:115], v76, s[48:51], s75 offen nt
    s_add_u32 s75, s75, 7168
    buffer_load_dwordx4 v[116:119], v76, s[48:51], s75 offen nt
    s_add_u32 s75, s75, 7168
    buffer_load_dwordx4 v[120:123], v76, s[48:51], s75 offen nt
    s_add_u32 s75, s75, 7168
    buffer_load_dwordx4 v[124:127], v76, s[48:51], s75 offen nt
    s_add_u32 s75, s75, 7168
    buffer_load_dwordx4 v[144:147], v76, s[48:51], s75 offen nt
    s_add_u32 s75, s75, 7168
    buffer_load_dwordx4 v[148:151], v76, s[48:51], s75 offen nt
    s_add_u32 s75, s75, 7168
    s_waitcnt vmcnt(18)
    s_branch L_hbar
L_ev_58:
    s_add_u32 s78, s70, 40960
    s_cmp_ge_u32 s78, 122880
    s_cselect_b32 s76, 122880, 0
    s_sub_u32 s78, s78, s76
    s_cmp_eq_u32 s77, 2
    s_cbranch_scc1 L_evw
    v_add_u32 v4, s78, v72
    v_xor_b32 v5, 32, v4
    v_xor_b32 v6, 64, v4
    v_xor_b32 v7, 96, v4
    s_and_b32 s72, s84, 15
    s_mov_b32 m0, s70
    s_lshl_b32 s71, s72, 7
    buffer_load_dwordx4 v16, s[28:31], s71 offen offset:0 lds
    s_mul_i32 s72, s72, 393216
    s_lshr_b64 s[84:85], s[84:85], 4
    ds_read_b128 v[32:35], v4
    ds_read_b128 v[36:39], v5
    ds_read_b128 v[40:43], v6
    ds_read_b128 v[44:47], v7
    buffer_load_dwordx4 v17, s[28:31], s71 offen offset:1024 lds
    s_lshl_b32 s79, s62, 8
    s_add_u32 s79, s79, s73
    s_waitcnt lgkmcnt(0)
    v_lshlrev_b32 v80, 16, v32
    v_and_b32 v82, s90, v32
    v_mul_f32 v81, v80, v80
    v_mul_f32 v83, v82, v82
    v_lshlrev_b32 v10, 16, v33
    v_and_b32 v11, s90, v33
    v_add_f32 v80, v80, v10
    v_add_f32 v82, v82, v11
    v_fmac_f32 v81, v10, v10
    v_fmac_f32 v83, v11, v11
    v_lshlrev_b32 v8, 16, v34
    v_and_b32_e64 v9, s90, v34
    buffer_load_dwordx4 v18, s[28:31], s71 offen offset:2048 lds
    v_add_f32 v80, v80, v8
    v_add_f32 v82, v82, v9
    v_fmac_f32 v81, v8, v8
    v_fmac_f32 v83, v9, v9
    v_lshlrev_b32 v10, 16, v35
    v_and_b32 v11, s90, v35
    v_add_f32 v80, v80, v10
    v_add_f32 v82, v82, v11
    v_fmac_f32 v81, v10, v10
    v_fmac_f32 v83, v11, v11
    v_lshlrev_b32 v8, 16, v36
    v_and_b32 v9, s90, v36
    buffer_load_dwordx4 v19, s[28:31], s71 offen offset:3072 lds
    v_add_f32 v80, v80, v8
    v_add_f32 v82, v82, v9
    v_fmac_f32 v81, v8, v8
    v_fmac_f32 v83, v9, v9
    v_lshlrev_b32 v10, 16, v37
    v_and_b32 v11, s90, v37
    v_add_f32 v80, v80, v10
    v_add_f32 v82, v82, v11
    v_fmac_f32 v81, v10, v10
    v_fmac_f32 v83, v11, v11
    v_lshlrev_b32 v8, 16, v38
    v_and_b32 v9, s90, v38
    s_add_u32 m0, s70, 4096
    s_nop 0
    buffer_load_dwordx4 v20, s[32:35], s72 offen offset:0 lds
    v_add_f32 v80, v80, v8
    v_add_f32 v82, v82, v9
    v_fmac_f32 v81, v8, v8
    v_fmac_f32 v83, v9, v9
    v_lshlrev_b32 v10, 16, v39
    v_and_b32 v11, s90, v39
    v_add_f32 v80, v80, v10
    v_add_f32 v82, v82, v11
    v_fmac_f32 v81, v10, v10
    v_fmac_f32 v83, v11, v11
    v_lshlrev_b32 v8, 16, v40
    v_and_b32_e64 v9, s90, v40
    buffer_load_dwordx4 v21, s[32:35], s72 offen offset:1024 lds
    v_add_f32 v80, v80, v8
    v_add_f32 v82, v82, v9
    v_fmac_f32 v81, v8, v8
    v_fmac_f32 v83, v9, v9
    v_lshlrev_b32 v10, 16, v41
    v_and_b32 v11, s90, v41
    v_add_f32 v80, v80, v10
    v_add_f32 v82, v82, v11
    v_fmac_f32 v81, v10, v10
    v_fmac_f32 v83, v11, v11
    v_lshlrev_b32 v8, 16, v42
    v_and_b32 v9, s90, v42
    buffer_load_dwordx4 v22, s[32:35], s72 offen offset:2048 lds
    v_add_f32 v80, v80, v8
    v_add_f32 v82, v82, v9
    v_fmac_f32 v81, v8, v8
    v_fmac_f32 v83, v9, v9
    v_lshlrev_b32 v10, 16, v43
    v_and_b32 v11, s90, v43
    v_add_f32 v80, v80, v10
    v_add_f32 v82, v82, v11
    v_fmac_f32 v81, v10, v10
    v_fmac_f32 v83, v11, v11
    v_lshlrev_b32 v8, 16, v44
    v_and_b32 v9, s90, v44
    buffer_load_dwordx4 v23, s[32:35], s72 offen offset:3072 lds
    v_add_f32 v80, v80, v8
    v_add_f32 v82, v82, v9
    v_fmac_f32 v81, v8, v8
    v_fmac_f32 v83, v9, v9
    v_lshlrev_b32 v10, 16, v45
    v_and_b32 v11, s90, v45
    v_add_f32 v80, v80, v10
    v_add_f32 v82, v82, v11
    v_fmac_f32 v81, v10, v10
    v_fmac_f32 v83, v11, v11
    v_lshlrev_b32 v8, 16, v46
    v_and_b32 v9, s90, v46
    s_add_u32 m0, s70, 8192
    s_nop 0
    buffer_load_dwordx4 v24, s[32:35], s72 offen offset:0 lds
    v_add_f32 v80, v80, v8
    v_add_f32 v82, v82, v9
    v_fmac_f32 v81, v8, v8
    v_fmac_f32 v83, v9, v9
    v_lshlrev_b32 v10, 16, v47
    v_and_b32 v11, s90, v47
    v_add_f32 v80, v80, v10
    v_add_f32 v82, v82, v11
    v_fmac_f32 v81, v10, v10
    v_fmac_f32_e64 v83, v11, v11
    buffer_load_dwordx4 v25, s[32:35], s72 offen offset:1024 lds
    s_add_u32 s70, s70, 40960
    s_cmp_ge_u32 s70, 122880
    s_cselect_b32 s76, 122880, 0
    s_sub_u32 s70, s70, s76
    v_add_f32 v80, v80, v82
    v_add_f32 v81, v81, v83
    v_mov_b32 v82, v80
    v_mov_b32 v83, v81
    s_nop 0
    v_permlane32_swap_b32 v80, v82
    v_permlane32_swap_b32 v81, v83
    v_add_f32 v80, v80, v82
    v_add_f32_e64 v81, v81, v83
    s_mov_b32 exec_hi, 0
    buffer_store_dwordx2 v[80:81], v74, s[40:43], s79 offen offset:0 sc1
    s_mov_b64 exec, -1
    s_waitcnt vmcnt(11)
    s_branch L_hbar
L_evw:
    s_mul_i32 s79, s63, 2048
    s_add_u32 s79, s79, s78
    v_add_u32_e64 v4, s79, v73
    s_mul_i32 s79, s63, 20480
    s_add_u32 s79, s79, s78
    v_add_u32_e64 v5, s79, v73
    s_and_b32 s72, s84, 15
    s_mov_b32 m0, s70
    s_lshl_b32 s71, s72, 7
    buffer_load_dwordx4 v16, s[28:31], s71 offen offset:0 lds
    s_mul_i32 s72, s72, 393216
    s_lshr_b64 s[84:85], s[84:85], 4
    ds_read_b64_tr_b16 v[32:33], v4 offset:0
    ds_read_b64_tr_b16 v[34:35], v4 offset:512
    ds_read_b64_tr_b16 v[36:37], v4 offset:10240
    ds_read_b64_tr_b16 v[38:39], v4 offset:10752
    ds_read_b64_tr_b16 v[40:41], v4 offset:20480
    ds_read_b64_tr_b16 v[42:43], v4 offset:20992
    ds_read_b64_tr_b16 v[44:45], v4 offset:30720
    ds_read_b64_tr_b16 v[46:47], v4 offset:31232
    ds_read_b64_tr_b16 v[48:49], v5 offset:4096
    ds_read_b64_tr_b16 v[50:51], v5 offset:4608
    ds_read_b64_tr_b16 v[52:53], v5 offset:14336
    ds_read_b64_tr_b16 v[54:55], v5 offset:14848
    buffer_load_dwordx4 v17, s[28:31], s71 offen offset:1024 lds
    s_lshl_b32 s79, s64, 9
    s_lshl_b32 s80, s63, 3
    s_add_u32 s79, s79, s80
    s_add_u32 s79, s79, s73
    s_waitcnt lgkmcnt(0)
    v_lshlrev_b32 v80, 16, v32
    v_and_b32 v82, s90, v32
    v_lshlrev_b32 v10, 16, v33
    v_and_b32 v11, s90, v33
    v_add_f32 v80, v80, v10
    v_add_f32 v82, v82, v11
    v_lshlrev_b32 v8, 16, v34
    v_and_b32 v9, s90, v34
    v_add_f32 v80, v80, v8
    v_add_f32 v82, v82, v9
    v_lshlrev_b32 v10, 16, v35
    v_and_b32 v11, s90, v35
    buffer_load_dwordx4 v18, s[28:31], s71 offen offset:2048 lds
    v_add_f32 v80, v80, v10
    v_add_f32 v82, v82, v11
    v_lshlrev_b32 v8, 16, v36
    v_and_b32 v9, s90, v36
    v_add_f32 v80, v80, v8
    v_add_f32 v82, v82, v9
    v_lshlrev_b32 v10, 16, v37
    v_and_b32 v11, s90, v37
    v_add_f32 v80, v80, v10
    v_add_f32 v82, v82, v11
    v_lshlrev_b32 v8, 16, v38
    v_and_b32 v9, s90, v38
    buffer_load_dwordx4 v19, s[28:31], s71 offen offset:3072 lds
    v_add_f32 v80, v80, v8
    v_add_f32 v82, v82, v9
    v_lshlrev_b32 v10, 16, v39
    v_and_b32 v11, s90, v39
    v_add_f32 v80, v80, v10
    v_add_f32 v82, v82, v11
    v_lshlrev_b32 v8, 16, v40
    v_and_b32 v9, s90, v40
    v_add_f32 v80, v80, v8
    v_add_f32 v82, v82, v9
    v_lshlrev_b32 v10, 16, v41
    v_and_b32 v11, s90, v41
    s_add_u32 m0, s70, 4096
    s_nop 0
    buffer_load_dwordx4 v20, s[32:35], s72 offen offset:0 lds
    v_add_f32 v80, v80, v10
    v_add_f32 v82, v82, v11
    v_lshlrev_b32 v8, 16, v42
    v_and_b32 v9, s90, v42
    v_add_f32 v80, v80, v8
    v_add_f32 v82, v82, v9
    v_lshlrev_b32 v10, 16, v43
    v_and_b32 v11, s90, v43
    v_add_f32 v80, v80, v10
    v_add_f32 v82, v82, v11
    v_lshlrev_b32 v8, 16, v44
    v_and_b32_e64 v9, s90, v44
    buffer_load_dwordx4 v21, s[32:35], s72 offen offset:1024 lds
    v_add_f32 v80, v80, v8
    v_add_f32 v82, v82, v9
    v_lshlrev_b32 v10, 16, v45
    v_and_b32 v11, s90, v45
    v_add_f32 v80, v80, v10
    v_add_f32 v82, v82, v11
    v_lshlrev_b32 v8, 16, v46
    v_and_b32 v9, s90, v46
    v_add_f32 v80, v80, v8
    v_add_f32 v82, v82, v9
    v_lshlrev_b32 v10, 16, v47
    v_and_b32 v11, s90, v47
    buffer_load_dwordx4 v22, s[32:35], s72 offen offset:2048 lds
    v_add_f32 v80, v80, v10
    v_add_f32 v82, v82, v11
    v_lshlrev_b32 v81, 16, v48
    v_and_b32 v83, s90, v48
    v_lshlrev_b32 v10, 16, v49
    v_and_b32 v11, s90, v49
    v_add_f32 v81, v81, v10
    v_add_f32 v83, v83, v11
    v_lshlrev_b32 v8, 16, v50
    v_and_b32 v9, s90, v50
    v_add_f32 v81, v81, v8
    v_add_f32 v83, v83, v9
    buffer_load_dwordx4 v23, s[32:35], s72 offen offset:3072 lds
    v_lshlrev_b32 v10, 16, v51
    v_and_b32 v11, s90, v51
    v_add_f32 v81, v81, v10
    v_add_f32 v83, v83, v11
    v_lshlrev_b32 v8, 16, v52
    v_and_b32 v9, s90, v52
    v_add_f32 v81, v81, v8
    v_add_f32 v83, v83, v9
    v_lshlrev_b32 v10, 16, v53
    v_and_b32 v11, s90, v53
    v_add_f32 v81, v81, v10
    v_add_f32 v83, v83, v11
    s_add_u32 m0, s70, 8192
    s_nop 0
    buffer_load_dwordx4 v24, s[32:35], s72 offen offset:0 lds
    v_lshlrev_b32 v8, 16, v54
    v_and_b32 v9, s90, v54
    v_add_f32 v81, v81, v8
    v_add_f32 v83, v83, v9
    v_lshlrev_b32 v10, 16, v55
    v_and_b32 v11, s90, v55
    v_add_f32 v81, v81, v10
    v_add_f32_e64 v83, v83, v11
    buffer_load_dwordx4 v25, s[32:35], s72 offen offset:1024 lds
    s_add_u32 s70, s70, 40960
    s_cmp_ge_u32 s70, 122880
    s_cselect_b32 s76, 122880, 0
    s_sub_u32 s70, s70, s76
    v_add_f32 v80, v80, v82
    v_add_f32 v81, v81, v83
    v_mov_b32 v82, v80
    v_mov_b32 v83, v81
    s_nop 0
    v_permlane32_swap_b32 v80, v82
    v_permlane32_swap_b32 v81, v83
    v_add_f32 v80, v80, v82
    v_add_f32_e64 v81, v81, v83
    s_mov_b32 exec_hi, 0
    buffer_store_dwordx2 v[80:81], v12, s[40:43], s79 offen offset:1024 sc1
    s_mov_b64 exec, -1
    s_waitcnt vmcnt(11)
    s_branch L_hbar
L_compute:
    s_setprio 2
    s_and_b32 s63, s62, 1
    s_lshr_b32 s64, s62, 1
    s_lshl_b32 s73, s60, 4
    s_add_u32 s73, s73, s61
    s_mul_i32 s73, s73, 28800
    s_add_u32 s76, s2, 7
    s_and_b32 s76, s76, 7
    s_bfe_u32 s77, s2, 0x10003
    s_lshl1_add_u32 s97, s76, s77
    s_lshr_b32 s98, s2, 4
    s_lshl_b32 s99, s97, 4
    s_add_u32 s99, s99, s98
    s_mul_i32 s99, s99, 9344
    s_add_u32 s99, s99, 8388608
    s_lshr_b32 s65, s97, 1
    s_lshl_b32 s76, s97, 3
    s_add_u32 s65, s65, s76
    s_mul_i32 s76, s98, 4
    s_add_u32 s65, s65, s76
    s_and_b32 s65, s65, 15
    s_mov_b32 s89, 0x3f803f80
    s_mov_b32 s90, 0xffff0000
    v_and_b32 v2, 31, v1
    v_lshrrev_b32 v3, 5, v1
    v_lshlrev_b32 v12, 4, v1
    v_lshrrev_b32 v4, 3, v1
    v_mul_u32_u24 v13, 460800, v4
    v_and_b32_e64 v4, 7, v1
    v_lshl_add_u32 v13, v4, 4, v13
    v_and_b32 v10, 15, v1
    v_lshrrev_b32 v11, 4, v1
    s_mul_i32 s76, s63, 20480
    v_lshrrev_b32 v4, 1, v10
    v_xor_b32 v4, v4, v11
    v_lshlrev_b32_e64 v4, 4, v4
    v_lshl_add_u32 v4, v10, 7, v4
    v_add_u32 v192, s76, v4
    v_xor_b32 v193, 64, v192
    v_bfe_u32 v4, v1, 2, 2
    v_and_b32_e64 v6, 1, v11
    v_lshl_add_u32 v5, v6, 3, v4
    v_lshlrev_b32 v5, 7, v5
    v_lshrrev_b32 v4, 1, v4
    v_xor_b32_e64 v4, s64, v4
    v_lshl_add_u32 v5, v4, 6, v5
    v_lshl_add_u32 v5, v6, 5, v5
    v_and_b32_e64 v4, 3, v1
    v_lshl_add_u32 v5, v4, 3, v5
    v_mul_u32_u24 v4, 10240, v3
    v_add_u32_e64 v5, v5, v4
    v_add_u32 v194, 4096, v5
    v_xor_b32_e64 v195, 32, v194
    v_add_u32 v196, 40960, v192
    v_add_u32 v197, 40960, v193
    v_add_u32 v198, 40960, v194
    v_add_u32 v199, 40960, v195
    v_add_u32 v200, 81920, v192
    v_add_u32 v201, 81920, v193
    v_add_u32 v202, 81920, v194
    v_add_u32 v203, 81920, v195
    v_bfe_u32 v4, v1, 2, 2
    v_lshl_add_u32 v4, v3, 3, v4
    v_lshlrev_b32 v4, 6, v4
    v_and_b32 v5, 1, v11
    v_lshl_add_u32 v4, v5, 5, v4
    v_and_b32_e64 v5, 3, v1
    v_lshl_add_u32 v4, v5, 3, v4
    s_lshl_b32 s76, s64, 11
    s_add_u32 s76, s76, 122880
    v_add_u32_e64 v212, s76, v4
    s_lshl_b32 s76, s63, 9
    v_lshl_add_u32 v213, v10, 3, s76
    v_lshl_add_u32 v214, v2, 3, s76
    s_lshl_b32 s76, s64, 8
    v_lshl_add_u32 v215, v10, 3, s76
    v_bfe_u32 v4, v10, 1, 1
    v_xor_b32 v4, s64, v4
    v_lshrrev_b32 v5, 2, v10
    v_xor_b32 v5, v5, v3
    v_xor_b32 v6, v10, v11
    v_and_b32 v6, 1, v6
    v_lshlrev_b32_e64 v4, 6, v4
    v_lshl_add_u32 v4, v5, 4, v4
    v_lshl_add_u32 v4, v6, 3, v4
    v_lshl_add_u32 v4, v10, 7, v4
    s_lshl_b32 s76, s63, 13
    v_add_u32 v216, s76, v4
    v_bfe_u32 v4, v2, 1, 1
    v_bfe_u32 v5, v2, 2, 2
    v_and_b32 v6, 1, v2
    v_xor_b32 v6, v6, v3
    v_lshlrev_b32_e64 v4, 6, v4
    v_lshl_add_u32 v4, v5, 4, v4
    v_lshl_add_u32 v4, v6, 3, v4
    v_lshl_add_u32 v4, v2, 7, v4
    s_lshl_b32 s77, s64, 14
    s_add_u32 s76, s76, s77
    v_add_u32_e64 v217, s76, v4
    v_bfe_u32 v4, v1, 2, 2
    v_lshl_add_u32 v5, v3, 3, v4
    v_lshlrev_b32 v5, 7, v5
    v_lshrrev_b32 v6, 1, v4
    v_lshl_add_u32 v5, v6, 6, v5
    v_bfe_u32 v6, v1, 4, 1
    v_xor_b32_e64 v6, v6, v3
    v_lshl_add_u32 v5, v6, 5, v5
    v_bfe_u32 v6, v1, 1, 1
    v_lshl_add_u32 v5, v6, 4, v5
    v_xor_b32 v6, v1, v4
    v_and_b32 v6, 1, v6
    v_lshl_add_u32 v5, v6, 3, v5
    s_lshl_b32 s76, s63, 6
    s_or_b32 s76, s76, s77
    v_xor_b32 v218, s76, v5
    s_lshl_b32 s76, s64, 6
    v_xor_b32_e64 v220, s76, v5
    v_xor_b32 v219, 528, v218
    v_xor_b32 v221, 528, v220
    v_cmp_gt_u32 s[86:87], 16, v1
    s_waitcnt lgkmcnt(0)
    s_mov_b32 s40, s26
    s_and_b32 s41, s27, 0xffff
    s_mov_b32 s42, 33554432
    s_mov_b32 s43, 0x20000
    s_mov_b32 s44, s22
    s_and_b32 s45, s23, 0xffff
    s_mov_b32 s46, 4194304
    s_mov_b32 s47, 0x20000
    s_mov_b32 s68, 0
    s_getreg_b32 s101, hwreg(HW_REG_XCC_ID, 0, 4)
    v_mov_b32 v9, 13631488
    s_lshl_b32 s76, s61, 8
    s_lshl4_add_u32 s76, s60, s76
    s_add_u32 s76, s76, 12582912
    v_mov_b32 v8, s76
    s_lshl_b32 s76, s60, 8
    s_lshl4_add_u32 s76, s61, s76
    s_add_u32 s76, s76, 12587008
    v_writelane_b32 v8, s76, 1
    s_lshl_b32 s76, s97, 8
    s_lshl4_add_u32 s76, s98, s76
    s_add_u32 s76, s76, 12591104
    v_writelane_b32 v8, s76, 2
    v_mov_b32 v6, s101
    v_mov_b32 v7, 0
    v_mov_b32_e64 v10, 0
    s_cmp_eq_u32 s62, 0
    s_cbranch_scc0 L_noep
    buffer_load_dwordx2 v[4:5], v9, s[40:43], 0 offen
L_noep:
    s_barrier
    ds_read_b128 v[112:115], v192 offset:0
    ds_read_b64_tr_b16 v[128:129], v194 offset:0
    ds_read_b64_tr_b16 v[130:131], v194 offset:512
    ds_read_b128 v[116:119], v192 offset:2048
    ds_read_b128 v[120:123], v192 offset:10240
    ds_read_b128 v[124:127], v192 offset:12288
    ds_read_b64_tr_b16 v[132:133], v195 offset:0
    ds_read_b64_tr_b16 v[134:135], v195 offset:512
    ds_read_b64_tr_b16 v[136:137], v194 offset:2048
    ds_read_b64_tr_b16 v[138:139], v194 offset:2560
    ds_read_b64_tr_b16 v[140:141], v195 offset:2048
    ds_read_b64_tr_b16 v[142:143], v195 offset:2560
    ds_read_b64_tr_b16 v[144:145], v194 offset:4096
    ds_read_b64_tr_b16 v[146:147], v194 offset:4608
    s_waitcnt lgkmcnt(8)
    ds_read_b64_tr_b16 v[148:149], v195 offset:4096
    ds_read_b64_tr_b16 v[150:151], v195 offset:4608
    v_mfma_f32_16x16x32_bf16 v[16:19], v[128:131], v[112:115], 0
    ds_read_b128 v[152:155], v193 offset:0
    v_mfma_f32_16x16x32_bf16 v[20:23], v[128:131], v[116:119], 0
    ds_read_b64_tr_b16 v[168:169], v194 offset:20480
    v_mfma_f32_16x16x32_bf16 v[24:27], v[128:131], v[120:123], 0
    ds_read_b64_tr_b16 v[170:171], v194 offset:20992
    v_mfma_f32_16x16x32_bf16 v[28:31], v[128:131], v[124:127], 0
    ds_read_b128 v[156:159], v193 offset:2048
    s_waitcnt lgkmcnt(4)
    v_mfma_f32_16x16x32_bf16 v[32:35], v[132:135], v[112:115], 0
    ds_read_b128 v[160:163], v193 offset:10240
    v_mfma_f32_16x16x32_bf16 v[36:39], v[132:135], v[116:119], 0
    ds_read_b128 v[164:167], v193 offset:12288
    v_mfma_f32_16x16x32_bf16 v[40:43], v[132:135], v[120:123], 0
    ds_read_b64_tr_b16 v[172:173], v195 offset:20480
    v_mfma_f32_16x16x32_bf16 v[44:47], v[132:135], v[124:127], 0
    ds_read_b64_tr_b16 v[174:175], v195 offset:20992
    v_mfma_f32_16x16x32_bf16 v[48:51], v[136:139], v[112:115], 0
    ds_read_b64_tr_b16 v[176:177], v194 offset:22528
    v_mfma_f32_16x16x32_bf16 v[52:55], v[136:139], v[116:119], 0
    ds_read_b64_tr_b16 v[178:179], v194 offset:23040
    v_mfma_f32_16x16x32_bf16 v[56:59], v[136:139], v[120:123], 0
    ds_read_b64_tr_b16 v[180:181], v195 offset:22528
    v_mfma_f32_16x16x32_bf16 v[60:63], v[136:139], v[124:127], 0
    ds_read_b64_tr_b16 v[182:183], v195 offset:23040
    v_mfma_f32_16x16x32_bf16 v[64:67], v[140:143], v[112:115], 0
    ds_read_b64_tr_b16 v[184:185], v194 offset:24576
    v_mfma_f32_16x16x32_bf16 v[68:71], v[140:143], v[116:119], 0
    ds_read_b64_tr_b16 v[186:187], v194 offset:25088
    v_mfma_f32_16x16x32_bf16 v[72:75], v[140:143], v[120:123], 0
    ds_read_b64_tr_b16 v[188:189], v195 offset:24576
    v_mfma_f32_16x16x32_bf16 v[76:79], v[140:143], v[124:127], 0
    ds_read_b64_tr_b16 v[190:191], v195 offset:25088
    v_mfma_f32_16x16x32_bf16 v[80:83], v[144:147], v[112:115], 0
    v_mfma_f32_16x16x32_bf16 v[84:87], v[144:147], v[116:119], 0
    v_mfma_f32_16x16x32_bf16 v[88:91], v[144:147], v[120:123], 0
    v_mfma_f32_16x16x32_bf16 v[92:95], v[144:147], v[124:127], 0
    v_mfma_f32_16x16x32_bf16 v[96:99], v[148:151], v[112:115], 0
    v_mfma_f32_16x16x32_bf16 v[100:103], v[148:151], v[116:119], 0
    v_mfma_f32_16x16x32_bf16 v[104:107], v[148:151], v[120:123], 0
    v_mfma_f32_16x16x32_bf16 v[108:111], v[148:151], v[124:127], 0
    s_waitcnt lgkmcnt(0)
    v_mfma_f32_16x16x32_bf16 v[16:19], v[168:171], v[152:155], v[16:19]
    s_barrier
    v_mfma_f32_16x16x32_bf16 v[20:23], v[168:171], v[156:159], v[20:23]
    ds_read_b128 v[112:115], v196 offset:0
    ds_read_b64_tr_b16 v[204:205], v212 offset:0
    ds_read_b64_tr_b16 v[206:207], v212 offset:256
    ds_read_b64_tr_b16 v[208:209], v212 offset:1024
    ds_read_b64_tr_b16 v[210:211], v212 offset:1280
    v_mfma_f32_16x16x32_bf16 v[24:27], v[168:171], v[160:163], v[24:27]
    ds_read_b64_tr_b16 v[128:129], v198 offset:0
    s_cmp_eq_u32 s62, 0
    s_cbranch_scc0 L_cloop
    s_waitcnt vmcnt(0)
    v_add_co_u32 v4, vcc, 1, v4
    s_nop 1
    v_addc_co_u32 v5, vcc, 0, v5, vcc
    s_mov_b64 exec, 7
    buffer_store_dwordx4 v[4:7], v8, s[40:43], 0 offen sc1
    s_mov_b64 exec, -1
.p2align 3
L_cloop:
    v_mfma_f32_16x16x32_bf16 v[28:31], v[168:171], v[164:167], v[28:31]
    ds_read_b64_tr_b16 v[130:131], v198 offset:512
    v_mfma_f32_16x16x32_bf16 v[32:35], v[172:175], v[152:155], v[32:35]
    ds_read_b128 v[116:119], v196 offset:2048
    v_mfma_f32_16x16x32_bf16 v[36:39], v[172:175], v[156:159], v[36:39]
    ds_read_b128 v[120:123], v196 offset:10240
    v_mfma_f32_16x16x32_bf16 v[40:43], v[172:175], v[160:163], v[40:43]
    ds_read_b128 v[124:127], v196 offset:12288
    v_mfma_f32_16x16x32_bf16 v[44:47], v[172:175], v[164:167], v[44:47]
    ds_read_b64_tr_b16 v[132:133], v199 offset:0
    v_mfma_f32_16x16x32_bf16 v[48:51], v[176:179], v[152:155], v[48:51]
    ds_read_b64_tr_b16 v[134:135], v199 offset:512
    v_mfma_f32_16x16x32_bf16 v[52:55], v[176:179], v[156:159], v[52:55]
    ds_read_b64_tr_b16 v[136:137], v198 offset:2048
    v_mfma_f32_16x16x32_bf16 v[56:59], v[176:179], v[160:163], v[56:59]
    ds_read_b64_tr_b16 v[138:139], v198 offset:2560
    v_mfma_f32_16x16x32_bf16 v[60:63], v[176:179], v[164:167], v[60:63]
    ds_read_b64_tr_b16 v[140:141], v199 offset:2048
    v_mfma_f32_16x16x32_bf16 v[64:67], v[180:183], v[152:155], v[64:67]
    ds_read_b64_tr_b16 v[142:143], v199 offset:2560
    v_mfma_f32_16x16x32_bf16 v[68:71], v[180:183], v[156:159], v[68:71]
    ds_read_b64_tr_b16 v[144:145], v198 offset:4096
    v_mfma_f32_16x16x32_bf16 v[72:75], v[180:183], v[160:163], v[72:75]
    ds_read_b64_tr_b16 v[146:147], v198 offset:4608
    v_mfma_f32_16x16x32_bf16 v[76:79], v[180:183], v[164:167], v[76:79]
    ds_read_b64_tr_b16 v[148:149], v199 offset:4096
    v_mfma_f32_16x16x32_bf16 v[80:83], v[184:187], v[152:155], v[80:83]
    ds_read_b64_tr_b16 v[150:151], v199 offset:4608
    v_mfma_f32_16x16x32_bf16 v[84:87], v[184:187], v[156:159], v[84:87]
    v_mfma_f32_16x16x32_bf16 v[88:91], v[184:187], v[160:163], v[88:91]
    v_mfma_f32_16x16x32_bf16 v[92:95], v[184:187], v[164:167], v[92:95]
    v_mfma_f32_16x16x32_bf16 v[96:99], v[188:191], v[152:155], v[96:99]
    v_mfma_f32_16x16x32_bf16 v[100:103], v[188:191], v[156:159], v[100:103]
    v_mfma_f32_16x16x32_bf16 v[104:107], v[188:191], v[160:163], v[104:107]
    v_mfma_f32_16x16x32_bf16 v[108:111], v[188:191], v[164:167], v[108:111]
    s_waitcnt lgkmcnt(0)
    v_mfma_f32_16x16x32_bf16 v[16:19], v[128:131], v[112:115], v[16:19]
    ds_read_b128 v[152:155], v197 offset:0
    v_mfma_f32_16x16x32_bf16 v[20:23], v[128:131], v[116:119], v[20:23]
    ds_read_b64_tr_b16 v[168:169], v198 offset:20480
    v_mfma_f32_16x16x32_bf16 v[24:27], v[128:131], v[120:123], v[24:27]
    ds_read_b64_tr_b16 v[170:171], v198 offset:20992
    v_mfma_f32_16x16x32_bf16 v[28:31], v[128:131], v[124:127], v[28:31]
    ds_read_b128 v[156:159], v197 offset:2048
    v_mfma_f32_16x16x32_bf16 v[32:35], v[132:135], v[112:115], v[32:35]
    ds_read_b128 v[160:163], v197 offset:10240
    v_mfma_f32_16x16x32_bf16 v[36:39], v[132:135], v[116:119], v[36:39]
    ds_read_b128 v[164:167], v197 offset:12288
    v_mfma_f32_16x16x32_bf16 v[40:43], v[132:135], v[120:123], v[40:43]
    ds_read_b64_tr_b16 v[172:173], v199 offset:20480
    v_mfma_f32_16x16x32_bf16 v[44:47], v[132:135], v[124:127], v[44:47]
    ds_read_b64_tr_b16 v[174:175], v199 offset:20992
    v_mfma_f32_16x16x32_bf16 v[48:51], v[136:139], v[112:115], v[48:51]
    ds_read_b64_tr_b16 v[176:177], v198 offset:22528
    v_mfma_f32_16x16x32_bf16 v[52:55], v[136:139], v[116:119], v[52:55]
    ds_read_b64_tr_b16 v[178:179], v198 offset:23040
    v_mfma_f32_16x16x32_bf16 v[56:59], v[136:139], v[120:123], v[56:59]
    ds_read_b64_tr_b16 v[180:181], v199 offset:22528
    v_mfma_f32_16x16x32_bf16 v[60:63], v[136:139], v[124:127], v[60:63]
    ds_read_b64_tr_b16 v[182:183], v199 offset:23040
    v_mfma_f32_16x16x32_bf16 v[64:67], v[140:143], v[112:115], v[64:67]
    ds_read_b64_tr_b16 v[184:185], v198 offset:24576
    v_mfma_f32_16x16x32_bf16 v[68:71], v[140:143], v[116:119], v[68:71]
    ds_read_b64_tr_b16 v[186:187], v198 offset:25088
    v_mfma_f32_16x16x32_bf16 v[72:75], v[140:143], v[120:123], v[72:75]
    ds_read_b64_tr_b16 v[188:189], v199 offset:24576
    v_mfma_f32_16x16x32_bf16 v[76:79], v[140:143], v[124:127], v[76:79]
    ds_read_b64_tr_b16 v[190:191], v199 offset:25088
    v_mfma_f32_16x16x32_bf16 v[80:83], v[144:147], v[112:115], v[80:83]
    v_mfma_f32_16x16x32_bf16 v[84:87], v[144:147], v[116:119], v[84:87]
    v_mfma_f32_16x16x32_bf16 v[88:91], v[144:147], v[120:123], v[88:91]
    v_mfma_f32_16x16x32_bf16 v[92:95], v[144:147], v[124:127], v[92:95]
    v_mfma_f32_16x16x32_bf16 v[96:99], v[148:151], v[112:115], v[96:99]
    v_mfma_f32_16x16x32_bf16 v[100:103], v[148:151], v[116:119], v[100:103]
    v_mfma_f32_16x16x32_bf16 v[104:107], v[148:151], v[120:123], v[104:107]
    v_mfma_f32_16x16x32_bf16 v[108:111], v[148:151], v[124:127], v[108:111]
    s_waitcnt lgkmcnt(0)
    v_mfma_f32_16x16x32_bf16 v[16:19], v[168:171], v[152:155], v[16:19]
    s_barrier
    v_mfma_f32_16x16x32_bf16 v[20:23], v[168:171], v[156:159], v[20:23]
    ds_read_b128 v[112:115], v200 offset:0
    v_mfma_f32_16x16x32_bf16 v[24:27], v[168:171], v[160:163], v[24:27]
    ds_read_b64_tr_b16 v[128:129], v202 offset:0
    v_mfma_f32_16x16x32_bf16 v[28:31], v[168:171], v[164:167], v[28:31]
    ds_read_b64_tr_b16 v[130:131], v202 offset:512
    v_mfma_f32_16x16x32_bf16 v[32:35], v[172:175], v[152:155], v[32:35]
    ds_read_b128 v[116:119], v200 offset:2048
    v_mfma_f32_16x16x32_bf16 v[36:39], v[172:175], v[156:159], v[36:39]
    ds_read_b128 v[120:123], v200 offset:10240
    v_mfma_f32_16x16x32_bf16 v[40:43], v[172:175], v[160:163], v[40:43]
    ds_read_b128 v[124:127], v200 offset:12288
    v_mfma_f32_16x16x32_bf16 v[44:47], v[172:175], v[164:167], v[44:47]
    ds_read_b64_tr_b16 v[132:133], v203 offset:0
    v_mfma_f32_16x16x32_bf16 v[48:51], v[176:179], v[152:155], v[48:51]
    ds_read_b64_tr_b16 v[134:135], v203 offset:512
    v_mfma_f32_16x16x32_bf16 v[52:55], v[176:179], v[156:159], v[52:55]
    ds_read_b64_tr_b16 v[136:137], v202 offset:2048
    v_mfma_f32_16x16x32_bf16 v[56:59], v[176:179], v[160:163], v[56:59]
    ds_read_b64_tr_b16 v[138:139], v202 offset:2560
    v_mfma_f32_16x16x32_bf16 v[60:63], v[176:179], v[164:167], v[60:63]
    ds_read_b64_tr_b16 v[140:141], v203 offset:2048
    v_mfma_f32_16x16x32_bf16 v[64:67], v[180:183], v[152:155], v[64:67]
    ds_read_b64_tr_b16 v[142:143], v203 offset:2560
    v_mfma_f32_16x16x32_bf16 v[68:71], v[180:183], v[156:159], v[68:71]
    ds_read_b64_tr_b16 v[144:145], v202 offset:4096
    v_mfma_f32_16x16x32_bf16 v[72:75], v[180:183], v[160:163], v[72:75]
    ds_read_b64_tr_b16 v[146:147], v202 offset:4608
    v_mfma_f32_16x16x32_bf16 v[76:79], v[180:183], v[164:167], v[76:79]
    ds_read_b64_tr_b16 v[148:149], v203 offset:4096
    v_mfma_f32_16x16x32_bf16 v[80:83], v[184:187], v[152:155], v[80:83]
    ds_read_b64_tr_b16 v[150:151], v203 offset:4608
    v_mfma_f32_16x16x32_bf16 v[84:87], v[184:187], v[156:159], v[84:87]
    v_mfma_f32_16x16x32_bf16 v[88:91], v[184:187], v[160:163], v[88:91]
    v_mfma_f32_16x16x32_bf16 v[92:95], v[184:187], v[164:167], v[92:95]
    v_mfma_f32_16x16x32_bf16 v[96:99], v[188:191], v[152:155], v[96:99]
    v_mfma_f32_16x16x32_bf16 v[100:103], v[188:191], v[156:159], v[100:103]
    v_mfma_f32_16x16x32_bf16 v[104:107], v[188:191], v[160:163], v[104:107]
    v_mfma_f32_16x16x32_bf16 v[108:111], v[188:191], v[164:167], v[108:111]
    s_waitcnt lgkmcnt(0)
    v_mfma_f32_16x16x32_bf16 v[16:19], v[128:131], v[112:115], v[16:19]
    ds_read_b128 v[152:155], v201 offset:0
    v_mfma_f32_16x16x32_bf16 v[20:23], v[128:131], v[116:119], v[20:23]
    ds_read_b64_tr_b16 v[168:169], v202 offset:20480
    v_mfma_f32_16x16x32_bf16 v[24:27], v[128:131], v[120:123], v[24:27]
    ds_read_b64_tr_b16 v[170:171], v202 offset:20992
    v_mfma_f32_16x16x32_bf16 v[28:31], v[128:131], v[124:127], v[28:31]
    ds_read_b128 v[156:159], v201 offset:2048
    v_mfma_f32_16x16x32_bf16 v[32:35], v[132:135], v[112:115], v[32:35]
    ds_read_b128 v[160:163], v201 offset:10240
    v_mfma_f32_16x16x32_bf16 v[36:39], v[132:135], v[116:119], v[36:39]
    ds_read_b128 v[164:167], v201 offset:12288
    v_mfma_f32_16x16x32_bf16 v[40:43], v[132:135], v[120:123], v[40:43]
    ds_read_b64_tr_b16 v[172:173], v203 offset:20480
    v_mfma_f32_16x16x32_bf16 v[44:47], v[132:135], v[124:127], v[44:47]
    ds_read_b64_tr_b16 v[174:175], v203 offset:20992
    v_mfma_f32_16x16x32_bf16 v[48:51], v[136:139], v[112:115], v[48:51]
    ds_read_b64_tr_b16 v[176:177], v202 offset:22528
    v_mfma_f32_16x16x32_bf16 v[52:55], v[136:139], v[116:119], v[52:55]
    ds_read_b64_tr_b16 v[178:179], v202 offset:23040
    v_mfma_f32_16x16x32_bf16 v[56:59], v[136:139], v[120:123], v[56:59]
    ds_read_b64_tr_b16 v[180:181], v203 offset:22528
    v_mfma_f32_16x16x32_bf16 v[60:63], v[136:139], v[124:127], v[60:63]
    ds_read_b64_tr_b16 v[182:183], v203 offset:23040
    v_mfma_f32_16x16x32_bf16 v[64:67], v[140:143], v[112:115], v[64:67]
    ds_read_b64_tr_b16 v[184:185], v202 offset:24576
    v_mfma_f32_16x16x32_bf16 v[68:71], v[140:143], v[116:119], v[68:71]
    ds_read_b64_tr_b16 v[186:187], v202 offset:25088
    v_mfma_f32_16x16x32_bf16 v[72:75], v[140:143], v[120:123], v[72:75]
    ds_read_b64_tr_b16 v[188:189], v203 offset:24576
    v_mfma_f32_16x16x32_bf16 v[76:79], v[140:143], v[124:127], v[76:79]
    ds_read_b64_tr_b16 v[190:191], v203 offset:25088
    v_mfma_f32_16x16x32_bf16 v[80:83], v[144:147], v[112:115], v[80:83]
    v_mfma_f32_16x16x32_bf16 v[84:87], v[144:147], v[116:119], v[84:87]
    v_mfma_f32_16x16x32_bf16 v[88:91], v[144:147], v[120:123], v[88:91]
    v_mfma_f32_16x16x32_bf16 v[92:95], v[144:147], v[124:127], v[92:95]
    v_mfma_f32_16x16x32_bf16 v[96:99], v[148:151], v[112:115], v[96:99]
    v_mfma_f32_16x16x32_bf16 v[100:103], v[148:151], v[116:119], v[100:103]
    v_mfma_f32_16x16x32_bf16 v[104:107], v[148:151], v[120:123], v[104:107]
    v_mfma_f32_16x16x32_bf16 v[108:111], v[148:151], v[124:127], v[108:111]
    s_waitcnt lgkmcnt(0)
    v_mfma_f32_16x16x32_bf16 v[16:19], v[168:171], v[152:155], v[16:19]
    s_barrier
    v_mfma_f32_16x16x32_bf16 v[20:23], v[168:171], v[156:159], v[20:23]
    ds_read_b128 v[112:115], v192 offset:0
    v_mfma_f32_16x16x32_bf16 v[24:27], v[168:171], v[160:163], v[24:27]
    ds_read_b64_tr_b16 v[128:129], v194 offset:0
    v_mfma_f32_16x16x32_bf16 v[28:31], v[168:171], v[164:167], v[28:31]
    ds_read_b64_tr_b16 v[130:131], v194 offset:512
    v_mfma_f32_16x16x32_bf16 v[32:35], v[172:175], v[152:155], v[32:35]
    ds_read_b128 v[116:119], v192 offset:2048
    v_mfma_f32_16x16x32_bf16 v[36:39], v[172:175], v[156:159], v[36:39]
    ds_read_b128 v[120:123], v192 offset:10240
    v_mfma_f32_16x16x32_bf16 v[40:43], v[172:175], v[160:163], v[40:43]
    ds_read_b128 v[124:127], v192 offset:12288
    v_mfma_f32_16x16x32_bf16 v[44:47], v[172:175], v[164:167], v[44:47]
    ds_read_b64_tr_b16 v[132:133], v195 offset:0
    v_mfma_f32_16x16x32_bf16 v[48:51], v[176:179], v[152:155], v[48:51]
    ds_read_b64_tr_b16 v[134:135], v195 offset:512
    v_mfma_f32_16x16x32_bf16 v[52:55], v[176:179], v[156:159], v[52:55]
    ds_read_b64_tr_b16 v[136:137], v194 offset:2048
    v_mfma_f32_16x16x32_bf16 v[56:59], v[176:179], v[160:163], v[56:59]
    ds_read_b64_tr_b16 v[138:139], v194 offset:2560
    v_mfma_f32_16x16x32_bf16 v[60:63], v[176:179], v[164:167], v[60:63]
    ds_read_b64_tr_b16 v[140:141], v195 offset:2048
    v_mfma_f32_16x16x32_bf16 v[64:67], v[180:183], v[152:155], v[64:67]
    ds_read_b64_tr_b16 v[142:143], v195 offset:2560
    v_mfma_f32_16x16x32_bf16 v[68:71], v[180:183], v[156:159], v[68:71]
    ds_read_b64_tr_b16 v[144:145], v194 offset:4096
    v_mfma_f32_16x16x32_bf16 v[72:75], v[180:183], v[160:163], v[72:75]
    ds_read_b64_tr_b16 v[146:147], v194 offset:4608
    v_mfma_f32_16x16x32_bf16 v[76:79], v[180:183], v[164:167], v[76:79]
    ds_read_b64_tr_b16 v[148:149], v195 offset:4096
    v_mfma_f32_16x16x32_bf16 v[80:83], v[184:187], v[152:155], v[80:83]
    ds_read_b64_tr_b16 v[150:151], v195 offset:4608
    v_mfma_f32_16x16x32_bf16 v[84:87], v[184:187], v[156:159], v[84:87]
    v_mfma_f32_16x16x32_bf16 v[88:91], v[184:187], v[160:163], v[88:91]
    v_mfma_f32_16x16x32_bf16 v[92:95], v[184:187], v[164:167], v[92:95]
    v_mfma_f32_16x16x32_bf16 v[96:99], v[188:191], v[152:155], v[96:99]
    v_mfma_f32_16x16x32_bf16 v[100:103], v[188:191], v[156:159], v[100:103]
    v_mfma_f32_16x16x32_bf16 v[104:107], v[188:191], v[160:163], v[104:107]
    v_mfma_f32_16x16x32_bf16 v[108:111], v[188:191], v[164:167], v[108:111]
    s_waitcnt lgkmcnt(0)
    v_mfma_f32_16x16x32_bf16 v[16:19], v[128:131], v[112:115], v[16:19]
    ds_read_b128 v[152:155], v193 offset:0
    v_mfma_f32_16x16x32_bf16 v[20:23], v[128:131], v[116:119], v[20:23]
    ds_read_b64_tr_b16 v[168:169], v194 offset:20480
    v_mfma_f32_16x16x32_bf16 v[24:27], v[128:131], v[120:123], v[24:27]
    ds_read_b64_tr_b16 v[170:171], v194 offset:20992
    v_mfma_f32_16x16x32_bf16 v[28:31], v[128:131], v[124:127], v[28:31]
    ds_read_b128 v[156:159], v193 offset:2048
    v_mfma_f32_16x16x32_bf16 v[32:35], v[132:135], v[112:115], v[32:35]
    ds_read_b128 v[160:163], v193 offset:10240
    v_mfma_f32_16x16x32_bf16 v[36:39], v[132:135], v[116:119], v[36:39]
    ds_read_b128 v[164:167], v193 offset:12288
    v_mfma_f32_16x16x32_bf16 v[40:43], v[132:135], v[120:123], v[40:43]
    ds_read_b64_tr_b16 v[172:173], v195 offset:20480
    v_mfma_f32_16x16x32_bf16 v[44:47], v[132:135], v[124:127], v[44:47]
    ds_read_b64_tr_b16 v[174:175], v195 offset:20992
    v_mfma_f32_16x16x32_bf16 v[48:51], v[136:139], v[112:115], v[48:51]
    ds_read_b64_tr_b16 v[176:177], v194 offset:22528
    v_mfma_f32_16x16x32_bf16 v[52:55], v[136:139], v[116:119], v[52:55]
    ds_read_b64_tr_b16 v[178:179], v194 offset:23040
    v_mfma_f32_16x16x32_bf16 v[56:59], v[136:139], v[120:123], v[56:59]
    ds_read_b64_tr_b16 v[180:181], v195 offset:22528
    v_mfma_f32_16x16x32_bf16 v[60:63], v[136:139], v[124:127], v[60:63]
    ds_read_b64_tr_b16 v[182:183], v195 offset:23040
    v_mfma_f32_16x16x32_bf16 v[64:67], v[140:143], v[112:115], v[64:67]
    ds_read_b64_tr_b16 v[184:185], v194 offset:24576
    v_mfma_f32_16x16x32_bf16 v[68:71], v[140:143], v[116:119], v[68:71]
    ds_read_b64_tr_b16 v[186:187], v194 offset:25088
    v_mfma_f32_16x16x32_bf16 v[72:75], v[140:143], v[120:123], v[72:75]
    ds_read_b64_tr_b16 v[188:189], v195 offset:24576
    v_mfma_f32_16x16x32_bf16 v[76:79], v[140:143], v[124:127], v[76:79]
    ds_read_b64_tr_b16 v[190:191], v195 offset:25088
    v_mfma_f32_16x16x32_bf16 v[80:83], v[144:147], v[112:115], v[80:83]
    v_mfma_f32_16x16x32_bf16 v[84:87], v[144:147], v[116:119], v[84:87]
    v_mfma_f32_16x16x32_bf16 v[88:91], v[144:147], v[120:123], v[88:91]
    v_mfma_f32_16x16x32_bf16 v[92:95], v[144:147], v[124:127], v[92:95]
    v_mfma_f32_16x16x32_bf16 v[96:99], v[148:151], v[112:115], v[96:99]
    s_add_u32 s68, s68, 1
    s_cmp_lt_u32 s68, 5
    v_mfma_f32_16x16x32_bf16 v[100:103], v[148:151], v[116:119], v[100:103]
    v_mfma_f32_16x16x32_bf16 v[104:107], v[148:151], v[120:123], v[104:107]
    v_mfma_f32_16x16x32_bf16 v[108:111], v[148:151], v[124:127], v[108:111]
    s_waitcnt lgkmcnt(0)
    v_mfma_f32_16x16x32_bf16 v[16:19], v[168:171], v[152:155], v[16:19]
    s_cbranch_scc0 L_cexit
    s_barrier
    v_mfma_f32_16x16x32_bf16 v[20:23], v[168:171], v[156:159], v[20:23]
    ds_read_b128 v[112:115], v196 offset:0
    v_mfma_f32_16x16x32_bf16 v[24:27], v[168:171], v[160:163], v[24:27]
    ds_read_b64_tr_b16 v[128:129], v198 offset:0
    s_branch L_cloop
L_cexit:
    v_mfma_f32_16x16x32_bf16 v[20:23], v[168:171], v[156:159], v[20:23]
    v_mfma_f32_16x16x32_bf16 v[24:27], v[168:171], v[160:163], v[24:27]
    v_mfma_f32_16x16x32_bf16 v[28:31], v[168:171], v[164:167], v[28:31]
    v_mfma_f32_16x16x32_bf16 v[32:35], v[172:175], v[152:155], v[32:35]
    v_mfma_f32_16x16x32_bf16 v[36:39], v[172:175], v[156:159], v[36:39]
    v_mfma_f32_16x16x32_bf16 v[40:43], v[172:175], v[160:163], v[40:43]
    v_mfma_f32_16x16x32_bf16 v[44:47], v[172:175], v[164:167], v[44:47]
    v_mfma_f32_16x16x32_bf16 v[48:51], v[176:179], v[152:155], v[48:51]
    v_mfma_f32_16x16x32_bf16 v[52:55], v[176:179], v[156:159], v[52:55]
    v_mfma_f32_16x16x32_bf16 v[56:59], v[176:179], v[160:163], v[56:59]
    s_barrier
    ds_read_b32 v11, v10 offset:53248
    ds_read_b64 v[222:223], v213 offset:49152
    ds_read_b64 v[224:225], v213 offset:49280
    v_mfma_f32_16x16x32_bf16 v[60:63], v[176:179], v[164:167], v[60:63]
    ds_read_b64 v[226:227], v213 offset:49408
    ds_read_b64 v[228:229], v213 offset:49536
    v_mfma_f32_16x16x32_bf16 v[64:67], v[180:183], v[152:155], v[64:67]
    ds_read_b64 v[238:239], v215 offset:50176
    ds_read_b64 v[240:241], v215 offset:50304
    v_mfma_f32_16x16x32_bf16 v[68:71], v[180:183], v[156:159], v[68:71]
    ds_read_b64 v[242:243], v215 offset:50688
    ds_read_b64 v[244:245], v215 offset:50816
    v_mfma_f32_16x16x32_bf16 v[72:75], v[180:183], v[160:163], v[72:75]
    ds_read_b64 v[246:247], v215 offset:51200
    ds_read_b64 v[248:249], v215 offset:51328
    v_mfma_f32_16x16x32_bf16 v[76:79], v[180:183], v[164:167], v[76:79]
    ds_read_b32 v250, v214 offset:49156
    ds_read_b32 v252, v214 offset:49412
    v_mfma_f32_16x16x32_bf16 v[80:83], v[184:187], v[152:155], v[80:83]
    s_waitcnt lgkmcnt(8)
    v_readfirstlane_b32 s100, v11
    v_mov_b32_e64 v230, v223
    v_cndmask_b32 v222, 0, v222, s[86:87]
    v_mfma_f32_16x16x32_bf16 v[84:87], v[184:187], v[156:159], v[84:87]
    v_mov_b32_e64 v232, v225
    v_cndmask_b32 v224, 0, v224, s[86:87]
    v_mov_b32_e64 v234, v227
    v_cndmask_b32 v226, 0, v226, s[86:87]
    v_mfma_f32_16x16x32_bf16 v[88:91], v[184:187], v[160:163], v[88:91]
    v_mov_b32_e64 v236, v229
    v_cndmask_b32 v228, 0, v228, s[86:87]
    v_mov_b32 v223, v222
    v_mov_b32 v225, v224
    v_mfma_f32_16x16x32_bf16 v[92:95], v[184:187], v[164:167], v[92:95]
    v_mov_b32 v227, v226
    v_mov_b32_e64 v229, v228
    s_waitcnt lgkmcnt(0)
    v_mul_f32 v251, 0x3fb8aa3b, v250
    v_mfma_f32_16x16x32_bf16 v[96:99], v[188:191], v[152:155], v[96:99]
    v_mul_f32 v253, 0x3fb8aa3b, v252
    v_mfma_f32_16x16x32_bf16 v[100:103], v[188:191], v[156:159], v[100:103]
    v_mfma_f32_16x16x32_bf16 v[104:107], v[188:191], v[160:163], v[104:107]
    v_mfma_f32_16x16x32_bf16 v[108:111], v[188:191], v[164:167], v[108:111]
    v_mfma_f32_16x16x16_bf16 v[48:51], v[242:243], v[222:223], v[48:51]
    v_xor_b32 v168, 0, v217
    v_xor_b32 v169, 16, v217
    v_mfma_f32_16x16x16_bf16 v[52:55], v[242:243], v[224:225], v[52:55]
    v_xor_b32 v170, 32, v217
    v_xor_b32 v171, 48, v217
    v_mfma_f32_16x16x16_bf16 v[64:67], v[244:245], v[222:223], v[64:67]
    v_xor_b32_e64 v172, 64, v217
    v_xor_b32 v173, 80, v217
    v_mfma_f32_16x16x16_bf16 v[68:71], v[244:245], v[224:225], v[68:71]
    v_xor_b32 v174, 96, v217
    v_xor_b32 v175, 112, v217
    v_mfma_f32_16x16x16_bf16 v[56:59], v[242:243], v[226:227], v[56:59]
    v_xor_b32_e64 v4, 32, v216
    v_mfma_f32_16x16x16_bf16 v[60:63], v[242:243], v[228:229], v[60:63]
    v_mfma_f32_16x16x16_bf16 v[72:75], v[244:245], v[226:227], v[72:75]
    v_mfma_f32_16x16x16_bf16 v[76:79], v[244:245], v[228:229], v[76:79]
    v_mfma_f32_16x16x16_bf16 v[80:83], v[246:247], v[222:223], v[80:83]
    v_cvt_pk_bf16_f32 v112, v48, v49
    v_cvt_pk_bf16_f32 v113, v50, v51
    v_mfma_f32_16x16x16_bf16 v[84:87], v[246:247], v[224:225], v[84:87]
    v_cvt_pk_bf16_f32 v114, v52, v53
    v_cvt_pk_bf16_f32 v115, v54, v55
    v_mfma_f32_16x16x16_bf16 v[88:91], v[246:247], v[226:227], v[88:91]
    v_cvt_pk_bf16_f32 v116, v64, v65
    v_cvt_pk_bf16_f32 v117, v66, v67
    v_mfma_f32_16x16x16_bf16 v[92:95], v[246:247], v[228:229], v[92:95]
    v_cvt_pk_bf16_f32 v118, v68, v69
    v_cvt_pk_bf16_f32 v119, v70, v71
    v_mfma_f32_16x16x16_bf16 v[96:99], v[248:249], v[222:223], v[96:99]
    v_cvt_pk_bf16_f32 v120, v56, v57
    v_cvt_pk_bf16_f32 v121, v58, v59
    v_mfma_f32_16x16x16_bf16 v[100:103], v[248:249], v[224:225], v[100:103]
    v_cvt_pk_bf16_f32 v122, v60, v61
    v_cvt_pk_bf16_f32 v123, v62, v63
    v_mfma_f32_16x16x16_bf16 v[104:107], v[248:249], v[226:227], v[104:107]
    v_permlane16_swap_b32 v112, v114
    v_permlane16_swap_b32 v113, v115
    v_mfma_f32_16x16x16_bf16 v[108:111], v[248:249], v[228:229], v[108:111]
    v_permlane16_swap_b32 v116, v118
    v_permlane16_swap_b32 v117, v119
    v_cvt_pk_bf16_f32 v124, v72, v73
    v_cvt_pk_bf16_f32 v125, v74, v75
    v_cvt_pk_bf16_f32 v126, v76, v77
    v_cvt_pk_bf16_f32 v127, v78, v79
    v_permlane16_swap_b32 v120, v122
    v_permlane16_swap_b32 v121, v123
    v_permlane16_swap_b32 v124, v126
    v_permlane16_swap_b32 v125, v127
    v_mfma_f32_32x32x16_bf16 v[48:63], v[204:207], v[112:115], 0
    v_mul_f32 v80, v80, v230
    v_mul_f32 v81, v81, v230
    v_mul_f32 v82, v82, v230
    v_mul_f32 v83, v83, v230
    v_cvt_pk_bf16_f32 v80, v80, v81
    v_cvt_pk_bf16_f32 v81, v82, v83
    v_mfma_f32_32x32x16_bf16 v[64:79], v[204:207], v[120:123], 0
    v_mul_f32 v96, v96, v230
    v_mul_f32 v97, v97, v230
    v_mul_f32 v98, v98, v230
    v_mul_f32 v99, v99, v230
    v_cvt_pk_bf16_f32 v96, v96, v97
    v_cvt_pk_bf16_f32 v97, v98, v99
    v_mfma_f32_32x32x16_bf16 v[48:63], v[208:211], v[116:119], v[48:63]
    v_mul_f32 v84, v84, v232
    v_mul_f32 v85, v85, v232
    v_mul_f32 v86, v86, v232
    v_mul_f32 v87, v87, v232
    v_cvt_pk_bf16_f32 v84, v84, v85
    v_cvt_pk_bf16_f32 v85, v86, v87
    v_mfma_f32_32x32x16_bf16 v[64:79], v[208:211], v[124:127], v[64:79]
    v_mul_f32 v100, v100, v232
    v_mul_f32 v101, v101, v232
    v_mul_f32 v102, v102, v232
    v_mul_f32 v103, v103, v232
    v_cvt_pk_bf16_f32 v100, v100, v101
    v_cvt_pk_bf16_f32 v101, v102, v103
    v_mul_f32 v88, v88, v234
    v_mul_f32 v89, v89, v234
    v_mul_f32 v90, v90, v234
    v_mul_f32 v91, v91, v234
    v_cvt_pk_bf16_f32 v88, v88, v89
    v_cvt_pk_bf16_f32 v89, v90, v91
    v_mul_f32 v104, v104, v234
    v_mul_f32 v105, v105, v234
    v_mul_f32 v106, v106, v234
    v_mul_f32 v107, v107, v234
    v_cvt_pk_bf16_f32 v104, v104, v105
    v_cvt_pk_bf16_f32 v105, v106, v107
    v_mul_f32 v92, v92, v236
    v_mul_f32 v93, v93, v236
    v_mul_f32 v94, v94, v236
    v_mul_f32 v95, v95, v236
    v_cvt_pk_bf16_f32 v92, v92, v93
    v_cvt_pk_bf16_f32 v93, v94, v95
    v_mul_f32 v108, v108, v236
    v_mul_f32 v109, v109, v236
    v_mul_f32 v110, v110, v236
    v_mul_f32 v111, v111, v236
    v_cvt_pk_bf16_f32 v108, v108, v109
    v_cvt_pk_bf16_f32 v109, v110, v111
    v_max3_f32 v160, v48, v49, v50
    v_min3_f32 v162, v48, v49, v50
    v_max3_f32 v160, v160, v51, v52
    v_min3_f32 v162, v162, v51, v52
    v_max3_f32 v160, v160, v53, v54
    v_min3_f32 v162, v162, v53, v54
    v_max3_f32 v160, v160, v55, v56
    v_min3_f32 v162, v162, v55, v56
    v_max3_f32 v160, v160, v57, v58
    v_min3_f32 v162, v162, v57, v58
    v_max3_f32 v160, v160, v59, v60
    v_min3_f32 v162, v162, v59, v60
    v_max3_f32 v160, v160, v61, v62
    v_min3_f32 v162, v162, v61, v62
    v_max_f32 v160, v160, v63
    v_min_f32 v162, v162, v63
    v_max3_f32 v164, v64, v65, v66
    v_min3_f32 v166, v64, v65, v66
    v_max3_f32 v164, v164, v67, v68
    v_min3_f32 v166, v166, v67, v68
    v_max3_f32 v164, v164, v69, v70
    v_min3_f32 v166, v166, v69, v70
    v_max3_f32 v164, v164, v71, v72
    v_min3_f32 v166, v166, v71, v72
    v_max3_f32 v164, v164, v73, v74
    v_min3_f32 v166, v166, v73, v74
    v_max3_f32 v164, v164, v75, v76
    v_min3_f32 v166, v166, v75, v76
    v_max3_f32 v164, v164, v77, v78
    v_min3_f32 v166, v166, v77, v78
    v_max_f32 v164, v164, v79
    v_min_f32 v166, v166, v79
    v_mov_b32 v161, v160
    v_mov_b32 v163, v162
    v_mov_b32 v165, v164
    v_mov_b32 v167, v166
    v_permlane32_swap_b32 v160, v161
    v_permlane32_swap_b32 v162, v163
    v_permlane32_swap_b32 v164, v165
    v_permlane32_swap_b32 v166, v167
    v_max_f32 v160, v160, v161
    v_min_f32 v162, v162, v163
    v_max_f32 v164, v164, v165
    v_min_f32 v166, v166, v167
    v_mul_f32 v160, v160, v251
    v_mul_f32 v162, v162, v251
    v_mul_f32 v164, v164, v253
    v_mul_f32 v166, v166, v253
    v_pk_fma_f32 v[128:129], v[48:49], v[250:251], v[160:161] op_sel:[0,1,0] op_sel_hi:[1,1,0] neg_lo:[0,0,1] neg_hi:[0,0,1]
    v_pk_fma_f32 v[48:49], v[48:49], v[250:251], v[162:163] op_sel:[0,1,0] op_sel_hi:[1,1,0] neg_lo:[0,1,0] neg_hi:[0,1,0]
    v_pk_fma_f32 v[130:131], v[50:51], v[250:251], v[160:161] op_sel:[0,1,0] op_sel_hi:[1,1,0] neg_lo:[0,0,1] neg_hi:[0,0,1]
    v_pk_fma_f32 v[50:51], v[50:51], v[250:251], v[162:163] op_sel:[0,1,0] op_sel_hi:[1,1,0] neg_lo:[0,1,0] neg_hi:[0,1,0]
    v_pk_fma_f32 v[132:133], v[52:53], v[250:251], v[160:161] op_sel:[0,1,0] op_sel_hi:[1,1,0] neg_lo:[0,0,1] neg_hi:[0,0,1]
    v_pk_fma_f32 v[52:53], v[52:53], v[250:251], v[162:163] op_sel:[0,1,0] op_sel_hi:[1,1,0] neg_lo:[0,1,0] neg_hi:[0,1,0]
    v_pk_fma_f32 v[134:135], v[54:55], v[250:251], v[160:161] op_sel:[0,1,0] op_sel_hi:[1,1,0] neg_lo:[0,0,1] neg_hi:[0,0,1]
    v_pk_fma_f32 v[54:55], v[54:55], v[250:251], v[162:163] op_sel:[0,1,0] op_sel_hi:[1,1,0] neg_lo:[0,1,0] neg_hi:[0,1,0]
    v_pk_fma_f32 v[136:137], v[56:57], v[250:251], v[160:161] op_sel:[0,1,0] op_sel_hi:[1,1,0] neg_lo:[0,0,1] neg_hi:[0,0,1]
    v_pk_fma_f32 v[56:57], v[56:57], v[250:251], v[162:163] op_sel:[0,1,0] op_sel_hi:[1,1,0] neg_lo:[0,1,0] neg_hi:[0,1,0]
    v_pk_fma_f32 v[138:139], v[58:59], v[250:251], v[160:161] op_sel:[0,1,0] op_sel_hi:[1,1,0] neg_lo:[0,0,1] neg_hi:[0,0,1]
    v_pk_fma_f32 v[58:59], v[58:59], v[250:251], v[162:163] op_sel:[0,1,0] op_sel_hi:[1,1,0] neg_lo:[0,1,0] neg_hi:[0,1,0]
    v_pk_fma_f32 v[140:141], v[60:61], v[250:251], v[160:161] op_sel:[0,1,0] op_sel_hi:[1,1,0] neg_lo:[0,0,1] neg_hi:[0,0,1]
    v_pk_fma_f32 v[60:61], v[60:61], v[250:251], v[162:163] op_sel:[0,1,0] op_sel_hi:[1,1,0] neg_lo:[0,1,0] neg_hi:[0,1,0]
    v_pk_fma_f32 v[142:143], v[62:63], v[250:251], v[160:161] op_sel:[0,1,0] op_sel_hi:[1,1,0] neg_lo:[0,0,1] neg_hi:[0,0,1]
    v_pk_fma_f32 v[62:63], v[62:63], v[250:251], v[162:163] op_sel:[0,1,0] op_sel_hi:[1,1,0] neg_lo:[0,1,0] neg_hi:[0,1,0]
    v_pk_fma_f32 v[144:145], v[64:65], v[252:253], v[164:165] op_sel:[0,1,0] op_sel_hi:[1,1,0] neg_lo:[0,0,1] neg_hi:[0,0,1]
    v_pk_fma_f32 v[64:65], v[64:65], v[252:253], v[166:167] op_sel:[0,1,0] op_sel_hi:[1,1,0] neg_lo:[0,1,0] neg_hi:[0,1,0]
    v_pk_fma_f32 v[146:147], v[66:67], v[252:253], v[164:165] op_sel:[0,1,0] op_sel_hi:[1,1,0] neg_lo:[0,0,1] neg_hi:[0,0,1]
    v_pk_fma_f32 v[66:67], v[66:67], v[252:253], v[166:167] op_sel:[0,1,0] op_sel_hi:[1,1,0] neg_lo:[0,1,0] neg_hi:[0,1,0]
    v_pk_fma_f32 v[148:149], v[68:69], v[252:253], v[164:165] op_sel:[0,1,0] op_sel_hi:[1,1,0] neg_lo:[0,0,1] neg_hi:[0,0,1]
    v_pk_fma_f32 v[68:69], v[68:69], v[252:253], v[166:167] op_sel:[0,1,0] op_sel_hi:[1,1,0] neg_lo:[0,1,0] neg_hi:[0,1,0]
    v_pk_fma_f32 v[150:151], v[70:71], v[252:253], v[164:165] op_sel:[0,1,0] op_sel_hi:[1,1,0] neg_lo:[0,0,1] neg_hi:[0,0,1]
    v_pk_fma_f32 v[70:71], v[70:71], v[252:253], v[166:167] op_sel:[0,1,0] op_sel_hi:[1,1,0] neg_lo:[0,1,0] neg_hi:[0,1,0]
    v_pk_fma_f32 v[152:153], v[72:73], v[252:253], v[164:165] op_sel:[0,1,0] op_sel_hi:[1,1,0] neg_lo:[0,0,1] neg_hi:[0,0,1]
    v_pk_fma_f32 v[72:73], v[72:73], v[252:253], v[166:167] op_sel:[0,1,0] op_sel_hi:[1,1,0] neg_lo:[0,1,0] neg_hi:[0,1,0]
    v_pk_fma_f32 v[154:155], v[74:75], v[252:253], v[164:165] op_sel:[0,1,0] op_sel_hi:[1,1,0] neg_lo:[0,0,1] neg_hi:[0,0,1]
    v_pk_fma_f32 v[74:75], v[74:75], v[252:253], v[166:167] op_sel:[0,1,0] op_sel_hi:[1,1,0] neg_lo:[0,1,0] neg_hi:[0,1,0]
    v_pk_fma_f32 v[156:157], v[76:77], v[252:253], v[164:165] op_sel:[0,1,0] op_sel_hi:[1,1,0] neg_lo:[0,0,1] neg_hi:[0,0,1]
    v_pk_fma_f32 v[76:77], v[76:77], v[252:253], v[166:167] op_sel:[0,1,0] op_sel_hi:[1,1,0] neg_lo:[0,1,0] neg_hi:[0,1,0]
    v_pk_fma_f32 v[158:159], v[78:79], v[252:253], v[164:165] op_sel:[0,1,0] op_sel_hi:[1,1,0] neg_lo:[0,0,1] neg_hi:[0,0,1]
    v_pk_fma_f32 v[78:79], v[78:79], v[252:253], v[166:167] op_sel:[0,1,0] op_sel_hi:[1,1,0] neg_lo:[0,1,0] neg_hi:[0,1,0]
    v_exp_f32_e64 v128, v128
    v_mfma_f32_16x16x16_bf16 v[16:19], v[238:239], v[222:223], v[16:19]
    v_exp_f32 v144, v144
    v_exp_f32 v129, v129
    v_exp_f32_e64 v145, v145
    v_mfma_f32_16x16x16_bf16 v[20:23], v[238:239], v[224:225], v[20:23]
    ds_write2st64_b64 v216, v[80:81], v[84:85] offset0:64 offset1:68
    v_exp_f32 v130, v130
    v_exp_f32 v146, v146
    v_exp_f32_e64 v131, v131
    v_mfma_f32_16x16x16_bf16 v[24:27], v[238:239], v[226:227], v[24:27]
    v_exp_f32 v147, v147
    v_exp_f32 v132, v132
    v_exp_f32_e64 v148, v148
    v_mfma_f32_16x16x16_bf16 v[28:31], v[238:239], v[228:229], v[28:31]
    ds_write2st64_b64 v4, v[96:97], v[100:101] offset0:64 offset1:68
    v_exp_f32 v133, v133
    v_exp_f32 v149, v149
    v_exp_f32_e64 v134, v134
    v_mfma_f32_16x16x16_bf16 v[32:35], v[240:241], v[222:223], v[32:35]
    v_exp_f32 v150, v150
    v_exp_f32 v135, v135
    v_exp_f32_e64 v151, v151
    v_mfma_f32_16x16x16_bf16 v[36:39], v[240:241], v[224:225], v[36:39]
    ds_write2st64_b64 v216, v[88:89], v[92:93] offset0:72 offset1:76
    v_exp_f32 v136, v136
    v_exp_f32 v152, v152
    v_exp_f32_e64 v137, v137
    v_mfma_f32_16x16x16_bf16 v[40:43], v[240:241], v[226:227], v[40:43]
    v_exp_f32 v153, v153
    v_exp_f32 v138, v138
    v_exp_f32_e64 v154, v154
    v_mfma_f32_16x16x16_bf16 v[44:47], v[240:241], v[228:229], v[44:47]
    ds_write2st64_b64 v4, v[104:105], v[108:109] offset0:72 offset1:76
    v_exp_f32 v139, v139
    v_exp_f32 v155, v155
    v_exp_f32 v140, v140
    v_exp_f32 v156, v156
    v_exp_f32 v141, v141
    v_exp_f32 v157, v157
    v_exp_f32 v142, v142
    v_exp_f32 v158, v158
    v_exp_f32 v143, v143
    v_exp_f32 v159, v159
    v_pk_add_f32 v[176:177], v[128:129], v[130:131]
    v_pk_add_f32 v[178:179], v[144:145], v[146:147]
    v_pk_add_f32 v[176:177], v[176:177], v[132:133]
    v_pk_add_f32 v[178:179], v[178:179], v[148:149]
    v_pk_add_f32 v[176:177], v[176:177], v[134:135]
    v_pk_add_f32 v[178:179], v[178:179], v[150:151]
    v_pk_add_f32 v[176:177], v[176:177], v[136:137]
    v_pk_add_f32 v[178:179], v[178:179], v[152:153]
    v_pk_add_f32 v[176:177], v[176:177], v[138:139]
    v_pk_add_f32 v[178:179], v[178:179], v[154:155]
    v_pk_add_f32 v[176:177], v[176:177], v[140:141]
    v_pk_add_f32 v[178:179], v[178:179], v[156:157]
    v_pk_add_f32 v[176:177], v[176:177], v[142:143]
    v_pk_add_f32 v[178:179], v[178:179], v[158:159]
    v_exp_f32 v48, v48
    v_add_f32 v176, v176, v177
    v_add_f32 v178, v178, v179
    v_exp_f32 v64, v64
    v_mov_b32 v177, v176
    v_mov_b32 v179, v178
    v_exp_f32 v49, v49
    v_permlane32_swap_b32 v176, v177
    v_permlane32_swap_b32 v178, v179
    v_exp_f32 v65, v65
    v_add_f32 v176, v176, v177
    v_add_f32 v178, v178, v179
    v_exp_f32 v50, v50
    v_rcp_f32 v176, v176
    v_rcp_f32 v178, v178
    v_exp_f32 v66, v66
    v_exp_f32 v51, v51
    v_exp_f32 v67, v67
    v_exp_f32 v52, v52
    v_exp_f32 v68, v68
    v_exp_f32 v53, v53
    v_exp_f32 v69, v69
    v_exp_f32 v54, v54
    v_exp_f32 v70, v70
    v_exp_f32 v55, v55
    v_exp_f32 v71, v71
    v_exp_f32 v56, v56
    v_exp_f32 v72, v72
    v_exp_f32 v57, v57
    v_exp_f32 v73, v73
    v_exp_f32 v58, v58
    v_exp_f32 v74, v74
    v_exp_f32 v59, v59
    v_exp_f32 v75, v75
    v_exp_f32 v60, v60
    v_exp_f32 v76, v76
    v_exp_f32 v61, v61
    v_exp_f32 v77, v77
    v_exp_f32 v62, v62
    v_exp_f32 v78, v78
    v_exp_f32 v63, v63
    v_exp_f32 v79, v79
    v_pk_add_f32 v[180:181], v[48:49], v[50:51]
    v_pk_add_f32 v[182:183], v[64:65], v[66:67]
    v_pk_add_f32 v[180:181], v[180:181], v[52:53]
    v_pk_add_f32 v[182:183], v[182:183], v[68:69]
    v_pk_add_f32 v[180:181], v[180:181], v[54:55]
    v_pk_add_f32 v[182:183], v[182:183], v[70:71]
    v_pk_add_f32 v[180:181], v[180:181], v[56:57]
    v_pk_add_f32 v[182:183], v[182:183], v[72:73]
    v_pk_add_f32 v[180:181], v[180:181], v[58:59]
    v_pk_add_f32 v[182:183], v[182:183], v[74:75]
    v_pk_add_f32 v[180:181], v[180:181], v[60:61]
    v_pk_add_f32 v[182:183], v[182:183], v[76:77]
    v_pk_add_f32 v[180:181], v[180:181], v[62:63]
    v_pk_add_f32 v[182:183], v[182:183], v[78:79]
    v_add_f32 v180, v180, v181
    v_add_f32 v182, v182, v183
    v_mov_b32 v181, v180
    v_mov_b32 v183, v182
    v_pk_mul_f32 v[128:129], v[128:129], v[176:177] op_sel_hi:[1,0]
    v_pk_mul_f32 v[130:131], v[130:131], v[176:177] op_sel_hi:[1,0]
    v_cvt_pk_bf16_f32 v128, v128, v129
    v_permlane32_swap_b32 v180, v181
    v_permlane32_swap_b32 v182, v183
    v_cvt_pk_bf16_f32 v129, v130, v131
    v_pk_mul_f32 v[144:145], v[144:145], v[178:179] op_sel_hi:[1,0]
    v_pk_mul_f32 v[146:147], v[146:147], v[178:179] op_sel_hi:[1,0]
    v_cvt_pk_bf16_f32 v144, v144, v145
    v_cvt_pk_bf16_f32 v145, v146, v147
    v_add_f32 v180, v180, v181
    v_add_f32 v182, v182, v183
    ds_write2st64_b64 v168, v[128:129], v[144:145] offset0:0 offset1:8
    v_pk_mul_f32 v[132:133], v[132:133], v[176:177] op_sel_hi:[1,0]
    v_pk_mul_f32 v[134:135], v[134:135], v[176:177] op_sel_hi:[1,0]
    v_cvt_pk_bf16_f32 v132, v132, v133
    v_cvt_pk_bf16_f32 v133, v134, v135
    v_pk_mul_f32 v[148:149], v[148:149], v[178:179] op_sel_hi:[1,0]
    v_rcp_f32 v180, v180
    v_rcp_f32 v182, v182
    v_pk_mul_f32 v[150:151], v[150:151], v[178:179] op_sel_hi:[1,0]
    v_cvt_pk_bf16_f32 v148, v148, v149
    v_cvt_pk_bf16_f32 v149, v150, v151
    ds_write2st64_b64 v169, v[132:133], v[148:149] offset0:0 offset1:8
    v_pk_mul_f32 v[136:137], v[136:137], v[176:177] op_sel_hi:[1,0]
    v_pk_mul_f32 v[138:139], v[138:139], v[176:177] op_sel_hi:[1,0]
    v_cvt_pk_bf16_f32 v136, v136, v137
    v_cvt_pk_bf16_f32 v137, v138, v139
    v_pk_mul_f32 v[152:153], v[152:153], v[178:179] op_sel_hi:[1,0]
    v_pk_mul_f32 v[154:155], v[154:155], v[178:179] op_sel_hi:[1,0]
    v_cvt_pk_bf16_f32 v152, v152, v153
    v_cvt_pk_bf16_f32 v153, v154, v155
    ds_write2st64_b64 v170, v[136:137], v[152:153] offset0:0 offset1:8
    v_pk_mul_f32 v[140:141], v[140:141], v[176:177] op_sel_hi:[1,0]
    v_pk_mul_f32 v[142:143], v[142:143], v[176:177] op_sel_hi:[1,0]
    v_cvt_pk_bf16_f32 v140, v140, v141
    v_cvt_pk_bf16_f32 v141, v142, v143
    v_pk_mul_f32 v[156:157], v[156:157], v[178:179] op_sel_hi:[1,0]
    v_pk_mul_f32 v[158:159], v[158:159], v[178:179] op_sel_hi:[1,0]
    v_cvt_pk_bf16_f32 v156, v156, v157
    v_cvt_pk_bf16_f32 v157, v158, v159
    ds_write2st64_b64 v171, v[140:141], v[156:157] offset0:0 offset1:8
    v_pk_mul_f32 v[48:49], v[48:49], v[180:181] op_sel_hi:[1,0]
    v_pk_mul_f32 v[50:51], v[50:51], v[180:181] op_sel_hi:[1,0]
    v_cvt_pk_bf16_f32 v48, v48, v49
    v_cvt_pk_bf16_f32 v49, v50, v51
    v_pk_mul_f32 v[64:65], v[64:65], v[182:183] op_sel_hi:[1,0]
    v_pk_mul_f32 v[66:67], v[66:67], v[182:183] op_sel_hi:[1,0]
    v_cvt_pk_bf16_f32 v64, v64, v65
    v_cvt_pk_bf16_f32 v65, v66, v67
    ds_write2st64_b64 v172, v[48:49], v[64:65] offset0:0 offset1:8
    v_pk_mul_f32 v[52:53], v[52:53], v[180:181] op_sel_hi:[1,0]
    v_pk_mul_f32 v[54:55], v[54:55], v[180:181] op_sel_hi:[1,0]
    v_cvt_pk_bf16_f32 v52, v52, v53
    v_cvt_pk_bf16_f32 v53, v54, v55
    v_pk_mul_f32 v[68:69], v[68:69], v[182:183] op_sel_hi:[1,0]
    v_pk_mul_f32 v[70:71], v[70:71], v[182:183] op_sel_hi:[1,0]
    v_cvt_pk_bf16_f32 v68, v68, v69
    v_cvt_pk_bf16_f32 v69, v70, v71
    ds_write2st64_b64 v173, v[52:53], v[68:69] offset0:0 offset1:8
    v_pk_mul_f32 v[56:57], v[56:57], v[180:181] op_sel_hi:[1,0]
    v_pk_mul_f32 v[58:59], v[58:59], v[180:181] op_sel_hi:[1,0]
    v_cvt_pk_bf16_f32 v56, v56, v57
    v_cvt_pk_bf16_f32 v57, v58, v59
    v_pk_mul_f32 v[72:73], v[72:73], v[182:183] op_sel_hi:[1,0]
    v_pk_mul_f32 v[74:75], v[74:75], v[182:183] op_sel_hi:[1,0]
    v_cvt_pk_bf16_f32 v72, v72, v73
    v_cvt_pk_bf16_f32 v73, v74, v75
    ds_write2st64_b64 v174, v[56:57], v[72:73] offset0:0 offset1:8
    v_pk_mul_f32 v[60:61], v[60:61], v[180:181] op_sel_hi:[1,0]
    v_pk_mul_f32 v[62:63], v[62:63], v[180:181] op_sel_hi:[1,0]
    v_cvt_pk_bf16_f32 v60, v60, v61
    v_cvt_pk_bf16_f32 v61, v62, v63
    v_pk_mul_f32 v[76:77], v[76:77], v[182:183] op_sel_hi:[1,0]
    v_pk_mul_f32 v[78:79], v[78:79], v[182:183] op_sel_hi:[1,0]
    v_cvt_pk_bf16_f32 v76, v76, v77
    v_cvt_pk_bf16_f32 v77, v78, v79
    ds_write2st64_b64 v175, v[60:61], v[76:77] offset0:0 offset1:8
    s_waitcnt lgkmcnt(0)
    s_barrier
    ds_read_b64_tr_b16 v[112:113], v218 offset:0
    ds_read_b64_tr_b16 v[114:115], v219 offset:0
    ds_read_b64_tr_b16 v[144:145], v220 offset:32768
    ds_read_b64_tr_b16 v[146:147], v221 offset:32768
    ds_read_b64_tr_b16 v[116:117], v218 offset:2048
    ds_read_b64_tr_b16 v[118:119], v219 offset:2048
    ds_read_b64_tr_b16 v[148:149], v220 offset:34816
    ds_read_b64_tr_b16 v[150:151], v221 offset:34816
    ds_read_b64_tr_b16 v[120:121], v218 offset:4096
    ds_read_b64_tr_b16 v[122:123], v219 offset:4096
    ds_read_b64_tr_b16 v[152:153], v220 offset:36864
    ds_read_b64_tr_b16 v[154:155], v221 offset:36864
    v_cvt_pk_bf16_f32 v176, v16, v17
    v_cvt_pk_bf16_f32 v177, v18, v19
    v_cvt_pk_bf16_f32 v178, v20, v21
    v_cvt_pk_bf16_f32 v179, v22, v23
    v_cvt_pk_bf16_f32 v180, v32, v33
    v_cvt_pk_bf16_f32 v181, v34, v35
    v_cvt_pk_bf16_f32 v182, v36, v37
    v_cvt_pk_bf16_f32 v183, v38, v39
    v_cvt_pk_bf16_f32 v184, v24, v25
    v_cvt_pk_bf16_f32 v185, v26, v27
    v_cvt_pk_bf16_f32 v186, v28, v29
    v_cvt_pk_bf16_f32 v187, v30, v31
    v_cvt_pk_bf16_f32 v188, v40, v41
    v_cvt_pk_bf16_f32 v189, v42, v43
    v_cvt_pk_bf16_f32 v190, v44, v45
    v_cvt_pk_bf16_f32 v191, v46, v47
    s_waitcnt lgkmcnt(8)
    v_mfma_f32_32x32x16_bf16 v[48:63], v[112:115], v[144:147], 0
    ds_read_b64_tr_b16 v[124:125], v218 offset:6144
    ds_read_b64_tr_b16 v[126:127], v219 offset:6144
    ds_read_b64_tr_b16 v[156:157], v220 offset:38912
    ds_read_b64_tr_b16 v[158:159], v221 offset:38912
    s_waitcnt lgkmcnt(8)
    v_mfma_f32_32x32x16_bf16 v[48:63], v[116:119], v[148:151], v[48:63]
    ds_read_b64_tr_b16 v[128:129], v218 offset:8192
    ds_read_b64_tr_b16 v[130:131], v219 offset:8192
    ds_read_b64_tr_b16 v[160:161], v220 offset:40960
    ds_read_b64_tr_b16 v[162:163], v221 offset:40960
    s_waitcnt lgkmcnt(8)
    v_mfma_f32_32x32x16_bf16 v[48:63], v[120:123], v[152:155], v[48:63]
    ds_read_b64_tr_b16 v[132:133], v218 offset:10240
    ds_read_b64_tr_b16 v[134:135], v219 offset:10240
    ds_read_b64_tr_b16 v[164:165], v220 offset:43008
    ds_read_b64_tr_b16 v[166:167], v221 offset:43008
    s_waitcnt lgkmcnt(8)
    v_mfma_f32_32x32x16_bf16 v[48:63], v[124:127], v[156:159], v[48:63]
    ds_read_b64_tr_b16 v[136:137], v218 offset:12288
    ds_read_b64_tr_b16 v[138:139], v219 offset:12288
    ds_read_b64_tr_b16 v[168:169], v220 offset:45056
    ds_read_b64_tr_b16 v[170:171], v221 offset:45056
    s_waitcnt lgkmcnt(8)
    v_mfma_f32_32x32x16_bf16 v[48:63], v[128:131], v[160:163], v[48:63]
    ds_read_b64_tr_b16 v[140:141], v218 offset:14336
    ds_read_b64_tr_b16 v[142:143], v219 offset:14336
    ds_read_b64_tr_b16 v[172:173], v220 offset:47104
    ds_read_b64_tr_b16 v[174:175], v221 offset:47104
    s_waitcnt lgkmcnt(8)
    v_mfma_f32_32x32x16_bf16 v[48:63], v[132:135], v[164:167], v[48:63]
    v_permlane16_swap_b32 v176, v178
    v_permlane16_swap_b32_e64 v177, v179
    s_waitcnt lgkmcnt(4)
    v_mfma_f32_32x32x16_bf16 v[48:63], v[136:139], v[168:171], v[48:63]
    v_permlane16_swap_b32 v180, v182
    v_permlane16_swap_b32 v181, v183
    v_permlane16_swap_b32 v184, v186
    s_waitcnt lgkmcnt(0)
    v_mfma_f32_32x32x16_bf16 v[48:63], v[140:143], v[172:175], v[48:63]
    s_barrier
    v_permlane16_swap_b32 v185, v187
    v_permlane16_swap_b32 v188, v190
    v_permlane16_swap_b32 v189, v191
    s_lshl_b32 s76, s62, 11
    s_add_u32 s76, s76, s99
    v_mfma_f32_32x32x16_bf16 v[16:31], v[204:207], v[176:179], 0
    s_add_u32 s76, s76, 1024
    s_lshl_b32 s77, s62, 7
    s_add_u32 s77, s77, s73
    v_lshlrev_b32_e64 v4, 2, v2
    v_mfma_f32_32x32x16_bf16 v[32:47], v[204:207], v[184:187], 0
    v_cvt_pk_bf16_f32 v64, v48, v49
    v_cvt_pk_bf16_f32 v65, v50, v51
    v_cvt_pk_bf16_f32 v66, v52, v53
    v_cvt_pk_bf16_f32 v67, v54, v55
    v_cvt_pk_bf16_f32 v68, v56, v57
    v_mfma_f32_32x32x16_bf16 v[16:31], v[208:211], v[180:183], v[16:31]
    v_cvt_pk_bf16_f32 v69, v58, v59
    v_cvt_pk_bf16_f32 v70, v60, v61
    v_cvt_pk_bf16_f32 v71, v62, v63
    s_bitcmp1_b32 s100, 0
    s_cbranch_scc1 L_loc_59
    buffer_store_dwordx4 v[64:67], v12, s[40:43], s76 offen offset:0 sc1
    buffer_store_dwordx4 v[68:71], v12, s[40:43], s76 offen offset:1024 sc1
    s_branch L_pubd_60
L_loc_59:
    buffer_store_dwordx4 v[64:67], v12, s[40:43], s76 offen offset:0
    buffer_store_dwordx4 v[68:71], v12, s[40:43], s76 offen offset:1024
L_pubd_60:
    v_mfma_f32_32x32x16_bf16 v[32:47], v[208:211], v[188:191], v[32:47]
    v_and_b32 v216, 1, v1
    v_lshlrev_b32_e64 v216, 8, v216
    v_lshl_add_u32 v216, v3, 4, v216
    s_lshl_b32 s76, s64, 7
    v_add_u32 v216, s76, v216
    s_mul_i32 s78, s61, 28800
    s_lshl_b32 s79, s64, 8
    s_add_u32 s78, s78, s79
    s_add_u32 s79, s78, 3686400
    v_dot2_f32_bf16 v72, v112, s89, 0
    v_dot2_f32_bf16 v73, v113, s89, 0
    v_dot2_f32_bf16 v72, v114, s89, v72
    v_dot2_f32_bf16 v73, v115, s89, v73
    v_dot2_f32_bf16 v72, v116, s89, v72
    v_dot2_f32_bf16 v73, v117, s89, v73
    v_dot2_f32_bf16 v72, v118, s89, v72
    v_dot2_f32_bf16 v73, v119, s89, v73
    v_dot2_f32_bf16 v72, v120, s89, v72
    v_dot2_f32_bf16 v73, v121, s89, v73
    v_dot2_f32_bf16 v72, v122, s89, v72
    v_dot2_f32_bf16 v73, v123, s89, v73
    v_dot2_f32_bf16 v72, v124, s89, v72
    v_dot2_f32_bf16 v73, v125, s89, v73
    v_dot2_f32_bf16 v72, v126, s89, v72
    v_dot2_f32_bf16 v73, v127, s89, v73
    v_dot2_f32_bf16 v72, v128, s89, v72
    v_dot2_f32_bf16 v73, v129, s89, v73
    v_dot2_f32_bf16 v72, v130, s89, v72
    v_dot2_f32_bf16 v73, v131, s89, v73
    v_dot2_f32_bf16 v72, v132, s89, v72
    v_dot2_f32_bf16 v73, v133, s89, v73
    v_dot2_f32_bf16 v72, v134, s89, v72
    v_dot2_f32_bf16 v73, v135, s89, v73
    v_dot2_f32_bf16 v72, v136, s89, v72
    v_dot2_f32_bf16 v73, v137, s89, v73
    v_dot2_f32_bf16 v72, v138, s89, v72
    v_dot2_f32_bf16 v73, v139, s89, v73
    v_dot2_f32_bf16 v72, v140, s89, v72
    v_dot2_f32_bf16 v73, v141, s89, v73
    v_dot2_f32_bf16 v72, v142, s89, v72
    v_dot2_f32_bf16 v73, v143, s89, v73
    s_lshl_b32 s76, s98, 7
    v_lshl_add_u32 v10, v3, 3, s76
    v_lshlrev_b32 v11, 5, v1
    v_add_f32 v72, v72, v73
    v_mov_b32 v73, v72
    s_nop 1
    v_permlane32_swap_b32 v72, v73
    v_add_f32 v72, v72, v73
    s_mov_b32 exec_hi, 0
    s_bitcmp1_b32 s100, 0
    s_cbranch_scc1 L_loc_61
    buffer_store_dword v72, v4, s[40:43], s77 offen offset:2048 sc1
    s_branch L_pubd_62
L_loc_61:
    buffer_store_dword v72, v4, s[40:43], s77 offen offset:2048
L_pubd_62:
    s_mov_b64 exec, -1
    v_max3_f32 v160, v16, v17, v18
    v_min3_f32 v162, v16, v17, v18
    v_max3_f32 v160, v160, v19, v20
    v_min3_f32 v162, v162, v19, v20
    v_max3_f32 v160, v160, v21, v22
    v_min3_f32 v162, v162, v21, v22
    v_max3_f32 v160, v160, v23, v24
    v_min3_f32 v162, v162, v23, v24
    v_max3_f32 v160, v160, v25, v26
    v_min3_f32 v162, v162, v25, v26
    v_max3_f32 v160, v160, v27, v28
    v_min3_f32 v162, v162, v27, v28
    v_max3_f32 v160, v160, v29, v30
    v_min3_f32 v162, v162, v29, v30
    v_max_f32 v160, v160, v31
    v_min_f32 v162, v162, v31
    v_max3_f32 v164, v32, v33, v34
    v_min3_f32 v166, v32, v33, v34
    v_max3_f32 v164, v164, v35, v36
    v_min3_f32 v166, v166, v35, v36
    v_max3_f32 v164, v164, v37, v38
    v_min3_f32 v166, v166, v37, v38
    v_max3_f32 v164, v164, v39, v40
    v_min3_f32 v166, v166, v39, v40
    v_max3_f32 v164, v164, v41, v42
    v_min3_f32 v166, v166, v41, v42
    v_max3_f32 v164, v164, v43, v44
    v_min3_f32 v166, v166, v43, v44
    v_max3_f32 v164, v164, v45, v46
    v_min3_f32 v166, v166, v45, v46
    v_max_f32 v164, v164, v47
    v_min_f32 v166, v166, v47
    v_mov_b32 v161, v160
    v_mov_b32 v163, v162
    v_mov_b32 v165, v164
    v_mov_b32 v167, v166
    v_permlane32_swap_b32 v160, v161
    v_permlane32_swap_b32 v162, v163
    v_permlane32_swap_b32 v164, v165
    v_permlane32_swap_b32 v166, v167
    v_max_f32 v160, v160, v161
    v_min_f32 v162, v162, v163
    v_max_f32 v164, v164, v165
    v_min_f32 v166, v166, v167
    v_mul_f32 v160, v160, v251
    v_mul_f32 v162, v162, v251
    v_mul_f32 v164, v164, v253
    v_mul_f32 v166, v166, v253
    v_pk_fma_f32 v[128:129], v[16:17], v[250:251], v[160:161] op_sel:[0,1,0] op_sel_hi:[1,1,0] neg_lo:[0,0,1] neg_hi:[0,0,1]
    v_pk_fma_f32 v[16:17], v[16:17], v[250:251], v[162:163] op_sel:[0,1,0] op_sel_hi:[1,1,0] neg_lo:[0,1,0] neg_hi:[0,1,0]
    v_pk_fma_f32 v[130:131], v[18:19], v[250:251], v[160:161] op_sel:[0,1,0] op_sel_hi:[1,1,0] neg_lo:[0,0,1] neg_hi:[0,0,1]
    v_pk_fma_f32 v[18:19], v[18:19], v[250:251], v[162:163] op_sel:[0,1,0] op_sel_hi:[1,1,0] neg_lo:[0,1,0] neg_hi:[0,1,0]
    v_pk_fma_f32 v[132:133], v[20:21], v[250:251], v[160:161] op_sel:[0,1,0] op_sel_hi:[1,1,0] neg_lo:[0,0,1] neg_hi:[0,0,1]
    v_pk_fma_f32 v[20:21], v[20:21], v[250:251], v[162:163] op_sel:[0,1,0] op_sel_hi:[1,1,0] neg_lo:[0,1,0] neg_hi:[0,1,0]
    v_pk_fma_f32 v[134:135], v[22:23], v[250:251], v[160:161] op_sel:[0,1,0] op_sel_hi:[1,1,0] neg_lo:[0,0,1] neg_hi:[0,0,1]
    v_pk_fma_f32 v[22:23], v[22:23], v[250:251], v[162:163] op_sel:[0,1,0] op_sel_hi:[1,1,0] neg_lo:[0,1,0] neg_hi:[0,1,0]
    v_pk_fma_f32 v[136:137], v[24:25], v[250:251], v[160:161] op_sel:[0,1,0] op_sel_hi:[1,1,0] neg_lo:[0,0,1] neg_hi:[0,0,1]
    v_pk_fma_f32 v[24:25], v[24:25], v[250:251], v[162:163] op_sel:[0,1,0] op_sel_hi:[1,1,0] neg_lo:[0,1,0] neg_hi:[0,1,0]
    v_pk_fma_f32 v[138:139], v[26:27], v[250:251], v[160:161] op_sel:[0,1,0] op_sel_hi:[1,1,0] neg_lo:[0,0,1] neg_hi:[0,0,1]
    v_pk_fma_f32 v[26:27], v[26:27], v[250:251], v[162:163] op_sel:[0,1,0] op_sel_hi:[1,1,0] neg_lo:[0,1,0] neg_hi:[0,1,0]
    v_pk_fma_f32 v[140:141], v[28:29], v[250:251], v[160:161] op_sel:[0,1,0] op_sel_hi:[1,1,0] neg_lo:[0,0,1] neg_hi:[0,0,1]
    v_pk_fma_f32 v[28:29], v[28:29], v[250:251], v[162:163] op_sel:[0,1,0] op_sel_hi:[1,1,0] neg_lo:[0,1,0] neg_hi:[0,1,0]
    v_pk_fma_f32 v[142:143], v[30:31], v[250:251], v[160:161] op_sel:[0,1,0] op_sel_hi:[1,1,0] neg_lo:[0,0,1] neg_hi:[0,0,1]
    v_pk_fma_f32 v[30:31], v[30:31], v[250:251], v[162:163] op_sel:[0,1,0] op_sel_hi:[1,1,0] neg_lo:[0,1,0] neg_hi:[0,1,0]
    v_pk_fma_f32 v[144:145], v[32:33], v[252:253], v[164:165] op_sel:[0,1,0] op_sel_hi:[1,1,0] neg_lo:[0,0,1] neg_hi:[0,0,1]
    v_pk_fma_f32 v[32:33], v[32:33], v[252:253], v[166:167] op_sel:[0,1,0] op_sel_hi:[1,1,0] neg_lo:[0,1,0] neg_hi:[0,1,0]
    v_pk_fma_f32 v[146:147], v[34:35], v[252:253], v[164:165] op_sel:[0,1,0] op_sel_hi:[1,1,0] neg_lo:[0,0,1] neg_hi:[0,0,1]
    v_pk_fma_f32 v[34:35], v[34:35], v[252:253], v[166:167] op_sel:[0,1,0] op_sel_hi:[1,1,0] neg_lo:[0,1,0] neg_hi:[0,1,0]
    v_pk_fma_f32 v[148:149], v[36:37], v[252:253], v[164:165] op_sel:[0,1,0] op_sel_hi:[1,1,0] neg_lo:[0,0,1] neg_hi:[0,0,1]
    v_pk_fma_f32 v[36:37], v[36:37], v[252:253], v[166:167] op_sel:[0,1,0] op_sel_hi:[1,1,0] neg_lo:[0,1,0] neg_hi:[0,1,0]
    v_pk_fma_f32 v[150:151], v[38:39], v[252:253], v[164:165] op_sel:[0,1,0] op_sel_hi:[1,1,0] neg_lo:[0,0,1] neg_hi:[0,0,1]
    v_pk_fma_f32 v[38:39], v[38:39], v[252:253], v[166:167] op_sel:[0,1,0] op_sel_hi:[1,1,0] neg_lo:[0,1,0] neg_hi:[0,1,0]
    v_pk_fma_f32 v[152:153], v[40:41], v[252:253], v[164:165] op_sel:[0,1,0] op_sel_hi:[1,1,0] neg_lo:[0,0,1] neg_hi:[0,0,1]
    v_pk_fma_f32 v[40:41], v[40:41], v[252:253], v[166:167] op_sel:[0,1,0] op_sel_hi:[1,1,0] neg_lo:[0,1,0] neg_hi:[0,1,0]
    v_pk_fma_f32 v[154:155], v[42:43], v[252:253], v[164:165] op_sel:[0,1,0] op_sel_hi:[1,1,0] neg_lo:[0,0,1] neg_hi:[0,0,1]
    v_pk_fma_f32 v[42:43], v[42:43], v[252:253], v[166:167] op_sel:[0,1,0] op_sel_hi:[1,1,0] neg_lo:[0,1,0] neg_hi:[0,1,0]
    v_pk_fma_f32 v[156:157], v[44:45], v[252:253], v[164:165] op_sel:[0,1,0] op_sel_hi:[1,1,0] neg_lo:[0,0,1] neg_hi:[0,0,1]
    v_pk_fma_f32 v[44:45], v[44:45], v[252:253], v[166:167] op_sel:[0,1,0] op_sel_hi:[1,1,0] neg_lo:[0,1,0] neg_hi:[0,1,0]
    v_pk_fma_f32 v[158:159], v[46:47], v[252:253], v[164:165] op_sel:[0,1,0] op_sel_hi:[1,1,0] neg_lo:[0,0,1] neg_hi:[0,0,1]
    v_pk_fma_f32 v[46:47], v[46:47], v[252:253], v[166:167] op_sel:[0,1,0] op_sel_hi:[1,1,0] neg_lo:[0,1,0] neg_hi:[0,1,0]
    v_exp_f32 v128, v128
    v_exp_f32 v16, v16
    v_exp_f32 v129, v129
    v_exp_f32 v17, v17
    v_exp_f32 v130, v130
    v_exp_f32 v18, v18
    v_exp_f32 v131, v131
    v_exp_f32 v19, v19
    v_exp_f32 v132, v132
    v_exp_f32 v20, v20
    v_exp_f32 v133, v133
    v_exp_f32 v21, v21
    v_exp_f32 v134, v134
    v_exp_f32 v22, v22
    v_exp_f32 v135, v135
    v_exp_f32 v23, v23
    v_exp_f32 v136, v136
    v_exp_f32 v24, v24
    v_exp_f32 v137, v137
    v_exp_f32 v25, v25
    v_exp_f32 v138, v138
    v_exp_f32 v26, v26
    v_exp_f32 v139, v139
    v_exp_f32 v27, v27
    v_exp_f32 v140, v140
    v_exp_f32 v28, v28
    v_exp_f32 v141, v141
    v_exp_f32 v29, v29
    v_exp_f32 v142, v142
    v_exp_f32 v30, v30
    v_exp_f32 v143, v143
    v_exp_f32 v31, v31
    v_cvt_pk_bf16_f32 v218, v128, v129
    v_cvt_pk_bf16_f32 v219, v130, v131
    v_cvt_pk_bf16_f32 v220, v132, v133
    v_cvt_pk_bf16_f32 v221, v134, v135
    v_cvt_pk_bf16_f32 v222, v136, v137
    v_cvt_pk_bf16_f32 v223, v138, v139
    v_cvt_pk_bf16_f32 v224, v140, v141
    v_cvt_pk_bf16_f32 v225, v142, v143
    v_cvt_pk_bf16_f32 v226, v16, v17
    v_cvt_pk_bf16_f32 v227, v18, v19
    v_cvt_pk_bf16_f32 v228, v20, v21
    v_cvt_pk_bf16_f32 v229, v22, v23
    v_cvt_pk_bf16_f32 v230, v24, v25
    v_cvt_pk_bf16_f32 v231, v26, v27
    v_cvt_pk_bf16_f32 v232, v28, v29
    v_cvt_pk_bf16_f32 v233, v30, v31
    v_exp_f32 v144, v144
    v_exp_f32 v32, v32
    v_exp_f32 v145, v145
    v_exp_f32 v33, v33
    v_exp_f32 v146, v146
    v_exp_f32 v34, v34
    v_exp_f32 v147, v147
    v_exp_f32_e64 v35, v35
    s_barrier
    buffer_load_dwordx4 v[48:51], v13, s[40:43], s78 offen offset:3072 sc1
    buffer_load_dwordx4 v[52:55], v13, s[40:43], s79 offen offset:3072 sc1
    buffer_load_dwordx4 v[56:59], v13, s[40:43], s78 offen offset:3200 sc1
    buffer_load_dwordx4 v[60:63], v13, s[40:43], s79 offen offset:3200 sc1
    ds_read_b128 v[168:171], v216 offset:24576
    ds_read_b128 v[172:175], v216 offset:24608
    ds_read_b128 v[176:179], v216 offset:24640
    ds_read_b128 v[180:183], v216 offset:24672
    v_exp_f32 v148, v148
    v_exp_f32 v36, v36
    v_exp_f32 v149, v149
    v_exp_f32 v37, v37
    v_exp_f32 v150, v150
    v_exp_f32 v38, v38
    v_exp_f32 v151, v151
    v_exp_f32 v39, v39
    v_exp_f32 v152, v152
    v_exp_f32_e64 v40, v40
    s_waitcnt lgkmcnt(0)
    v_mfma_f32_32x32x16_bf16 v[64:79], v[168:171], v[218:221], 0
    v_exp_f32 v153, v153
    v_exp_f32 v41, v41
    v_exp_f32_e64 v154, v154
    v_mfma_f32_32x32x16_bf16 v[80:95], v[176:179], v[226:229], 0
    v_exp_f32 v42, v42
    v_exp_f32 v155, v155
    v_exp_f32_e64 v43, v43
    v_mfma_f32_32x32x16_bf16 v[64:79], v[172:175], v[222:225], v[64:79]
    v_exp_f32 v156, v156
    v_exp_f32 v44, v44
    v_exp_f32_e64 v157, v157
    v_mfma_f32_32x32x16_bf16 v[80:95], v[180:183], v[230:233], v[80:95]
    v_exp_f32 v45, v45
    v_exp_f32 v158, v158
    v_exp_f32 v46, v46
    v_exp_f32 v159, v159
    v_exp_f32_e64 v47, v47
    v_cvt_pk_bf16_f32 v234, v144, v145
    v_cvt_pk_bf16_f32 v235, v146, v147
    v_cvt_pk_bf16_f32 v236, v148, v149
    v_cvt_pk_bf16_f32 v237, v150, v151
    v_cvt_pk_bf16_f32 v238, v152, v153
    v_cvt_pk_bf16_f32 v239, v154, v155
    v_cvt_pk_bf16_f32 v240, v156, v157
    v_cvt_pk_bf16_f32 v241, v158, v159
    v_cvt_pk_bf16_f32 v242, v32, v33
    v_cvt_pk_bf16_f32 v243, v34, v35
    v_cvt_pk_bf16_f32 v244, v36, v37
    v_cvt_pk_bf16_f32 v245, v38, v39
    v_cvt_pk_bf16_f32 v246, v40, v41
    v_cvt_pk_bf16_f32 v247, v42, v43
    v_cvt_pk_bf16_f32 v248, v44, v45
    v_cvt_pk_bf16_f32 v249, v46, v47
    v_mfma_f32_32x32x16_bf16 v[96:111], v[168:171], v[234:237], 0
    v_rcp_f32 v184, v65
    v_rcp_f32 v185, v81
    v_mul_f32 v6, v64, v184
    v_fmac_f32 v6, v80, v185
    v_add_f32 v6, 0x358637bd, v6
    v_mfma_f32_32x32x16_bf16 v[112:127], v[176:179], v[242:245], 0
    v_rcp_f32 v6, v6
    v_mov_b32 v8, 0
    v_mul_f32 v184, v184, v6
    v_mul_f32_e64 v185, v185, v6
    s_lshl4_add_u32 s76, s60, s61
    v_mfma_f32_32x32x16_bf16 v[96:111], v[172:175], v[238:241], v[96:111]
    s_mul_i32 s76, s76, 32768
    s_lshl2_add_u32 s77, s63, s64
    s_lshl_b32 s77, s77, 12
    s_add_u32 s76, s76, s77
    s_add_u32 s76, s76, 16777216
    v_mfma_f32_32x32x16_bf16 v[112:127], v[180:183], v[246:249], v[112:127]
    s_add_u32 s77, s76, 8192
    v_add_u32 v14, 128, v12
    v_cmp_gt_u32 vcc, 24, v1
    s_nop 0
    s_nop 0
    v_cndmask_b32_e64 v14, v14, v12, vcc
    s_mov_b32 s88, 0
    s_branch L_pfirst_64
L_poll_63:
    buffer_load_dwordx4 v[48:51], v13, s[40:43], s78 offen offset:3072 sc1
    buffer_load_dwordx4 v[52:55], v13, s[40:43], s79 offen offset:3072 sc1
    buffer_load_dwordx4 v[56:59], v13, s[40:43], s78 offen offset:3200 sc1
    buffer_load_dwordx4 v[60:63], v13, s[40:43], s79 offen offset:3200 sc1
L_pfirst_64:
    s_waitcnt vmcnt(0)
    v_max3_u32 v9, v48, v49, v50
    v_max3_u32 v9, v9, v51, v52
    v_max3_u32 v9, v9, v53, v54
    v_max3_u32 v9, v9, v55, v56
    v_max3_u32 v9, v9, v57, v58
    v_max3_u32 v9, v9, v59, v60
    v_max3_u32 v9, v9, v61, v62
    v_max_u32 v9, v9, v63
    v_cmp_eq_u32 vcc, -1, v9
    s_nop 0
    s_cbranch_vccz L_ok_65
    s_add_u32 s88, s88, 1
    s_cmp_lt_u32 s88, 65536
    s_cbranch_scc1 L_poll_63
L_ok_65:
    v_mfma_f32_32x32x16_bf16 v[16:31], v[48:51], v[218:221], 0
    s_barrier
    v_rcp_f32 v186, v97
    v_rcp_f32 v187, v113
    v_mul_f32 v7, v96, v186
    v_fmac_f32 v7, v112, v187
    v_mfma_f32_32x32x16_bf16 v[128:143], v[56:59], v[226:229], 0
    v_add_f32 v7, 0x358637bd, v7
    v_rcp_f32 v7, v7
    v_mov_b32 v8, 0
    v_mul_f32_e64 v186, v186, v7
    v_mfma_f32_32x32x16_bf16 v[16:31], v[52:55], v[222:225], v[16:31]
    v_mul_f32_e64 v187, v187, v7
    global_load_dwordx2 v[192:193], v10, s[14:15] offset:0
    global_load_dwordx2 v[194:195], v10, s[14:15] offset:16
    global_load_dwordx2 v[196:197], v10, s[14:15] offset:32
    v_mfma_f32_32x32x16_bf16 v[128:143], v[60:63], v[230:233], v[128:143]
    global_load_dwordx2 v[198:199], v10, s[14:15] offset:48
    global_load_dwordx2 v[200:201], v10, s[14:15] offset:64
    global_load_dwordx2 v[202:203], v10, s[14:15] offset:80
    global_load_dwordx2 v[204:205], v10, s[14:15] offset:96
    v_mfma_f32_32x32x16_bf16 v[32:47], v[48:51], v[234:237], 0
    global_load_dwordx2 v[206:207], v10, s[14:15] offset:112
    global_load_dwordx4 v[208:211], v11, s[14:15] offset:0
    global_load_dwordx4 v[212:215], v11, s[14:15] offset:16
    v_mfma_f32_32x32x16_bf16 v[144:159], v[56:59], v[242:245], 0
    v_mul_f32 v16, v16, v184
    v_mul_f32 v17, v17, v184
    v_mul_f32 v18, v18, v184
    v_mul_f32 v19, v19, v184
    v_mul_f32 v20, v20, v184
    v_mul_f32 v21, v21, v184
    v_mfma_f32_32x32x16_bf16 v[32:47], v[52:55], v[238:241], v[32:47]
    v_mul_f32 v22, v22, v184
    v_mul_f32 v23, v23, v184
    v_mul_f32 v24, v24, v184
    v_mul_f32 v25, v25, v184
    v_mul_f32 v26, v26, v184
    v_mul_f32 v27, v27, v184
    v_mfma_f32_32x32x16_bf16 v[144:159], v[60:63], v[246:249], v[144:159]
    v_mul_f32 v28, v28, v184
    v_mul_f32 v29, v29, v184
    v_mul_f32 v30, v30, v184
    v_mul_f32 v31, v31, v184
    v_fmac_f32 v16, v128, v185
    v_fmac_f32 v17, v129, v185
    v_cvt_pk_bf16_f32 v64, v16, v17
    v_fmac_f32 v18, v130, v185
    v_fmac_f32 v19, v131, v185
    v_cvt_pk_bf16_f32 v65, v18, v19
    v_fmac_f32 v20, v132, v185
    v_fmac_f32 v21, v133, v185
    v_cvt_pk_bf16_f32 v66, v20, v21
    v_fmac_f32 v22, v134, v185
    v_fmac_f32 v23, v135, v185
    v_cvt_pk_bf16_f32 v67, v22, v23
    buffer_store_dwordx4 v[64:67], v14, s[40:43], s76 offen offset:0 sc1
    v_fmac_f32 v24, v136, v185
    v_fmac_f32 v25, v137, v185
    v_cvt_pk_bf16_f32 v68, v24, v25
    v_fmac_f32 v26, v138, v185
    v_fmac_f32 v27, v139, v185
    v_cvt_pk_bf16_f32 v69, v26, v27
    v_fmac_f32 v28, v140, v185
    v_fmac_f32 v29, v141, v185
    v_cvt_pk_bf16_f32 v70, v28, v29
    v_fmac_f32 v30, v142, v185
    v_fmac_f32 v31, v143, v185
    v_cvt_pk_bf16_f32 v71, v30, v31
    buffer_store_dwordx4 v[68:71], v14, s[40:43], s76 offen offset:2048 sc1
    v_pk_mul_f32 v[32:33], v[32:33], v[186:187] op_sel_hi:[1,0]
    v_pk_fma_f32 v[32:33], v[144:145], v[186:187], v[32:33] op_sel:[0,1,0] op_sel_hi:[1,1,1]
    v_cvt_pk_bf16_f32 v72, v32, v33
    v_pk_mul_f32 v[34:35], v[34:35], v[186:187] op_sel_hi:[1,0]
    v_pk_fma_f32 v[34:35], v[146:147], v[186:187], v[34:35] op_sel:[0,1,0] op_sel_hi:[1,1,1]
    v_cvt_pk_bf16_f32 v73, v34, v35
    v_pk_mul_f32 v[36:37], v[36:37], v[186:187] op_sel_hi:[1,0]
    v_pk_fma_f32 v[36:37], v[148:149], v[186:187], v[36:37] op_sel:[0,1,0] op_sel_hi:[1,1,1]
    v_cvt_pk_bf16_f32 v74, v36, v37
    v_pk_mul_f32 v[38:39], v[38:39], v[186:187] op_sel_hi:[1,0]
    v_pk_fma_f32 v[38:39], v[150:151], v[186:187], v[38:39] op_sel:[0,1,0] op_sel_hi:[1,1,1]
    v_cvt_pk_bf16_f32 v75, v38, v39
    buffer_store_dwordx4 v[72:75], v14, s[40:43], s77 offen offset:0 sc1
    v_pk_mul_f32 v[40:41], v[40:41], v[186:187] op_sel_hi:[1,0]
    v_pk_fma_f32 v[40:41], v[152:153], v[186:187], v[40:41] op_sel:[0,1,0] op_sel_hi:[1,1,1]
    v_cvt_pk_bf16_f32 v76, v40, v41
    v_pk_mul_f32 v[42:43], v[42:43], v[186:187] op_sel_hi:[1,0]
    v_pk_fma_f32 v[42:43], v[154:155], v[186:187], v[42:43] op_sel:[0,1,0] op_sel_hi:[1,1,1]
    v_cvt_pk_bf16_f32 v77, v42, v43
    v_pk_mul_f32 v[44:45], v[44:45], v[186:187] op_sel_hi:[1,0]
    v_pk_fma_f32 v[44:45], v[156:157], v[186:187], v[44:45] op_sel:[0,1,0] op_sel_hi:[1,1,1]
    v_cvt_pk_bf16_f32 v78, v44, v45
    v_pk_mul_f32 v[46:47], v[46:47], v[186:187] op_sel_hi:[1,0]
    v_pk_fma_f32 v[46:47], v[158:159], v[186:187], v[46:47] op_sel:[0,1,0] op_sel_hi:[1,1,1]
    v_cvt_pk_bf16_f32 v79, v46, v47
    buffer_store_dwordx4 v[76:79], v14, s[40:43], s77 offen offset:2048 sc1
    v_bfe_u32 v4, v2, 1, 3
    v_lshlrev_b32_e64 v4, 4, v4
    v_lshl_add_u32 v4, v3, 3, v4
    v_lshl_add_u32 v4, v2, 7, v4
    s_lshl_b32 s76, s62, 12
    s_add_u32 s77, s76, 0
    v_add_u32 v64, s77, v4
    v_xor_b32 v65, 16, v64
    v_xor_b32 v66, 32, v64
    v_xor_b32 v67, 48, v64
    v_xor_b32_e64 v68, 64, v64
    v_xor_b32 v69, 80, v64
    v_xor_b32 v70, 96, v64
    v_xor_b32 v71, 112, v64
    v_bfe_u32 v4, v1, 2, 2
    v_lshl_add_u32 v5, v3, 2, v4
    v_lshlrev_b32 v5, 7, v5
    v_lshrrev_b32 v4, 1, v4
    v_lshl_add_u32 v5, v4, 6, v5
    v_bfe_u32 v4, v1, 4, 1
    v_lshl_add_u32 v5, v4, 5, v5
    v_and_b32_e64 v4, 3, v1
    v_lshl_add_u32 v5, v4, 3, v5
    v_add_u32 v72, 32768, v5
    v_xor_b32_e64 v73, 64, v72
    s_mul_i32 s80, s97, 524288
    s_mul_i32 s76, s62, 8192
    s_add_u32 s80, s80, s76
    s_add_u32 s80, s80, 16777216
    v_add_u32 v78, 4096, v14
    v_mov_b32 v74, 1
    s_mov_b32 s52, 0xffff
    s_mov_b32 s53, 0
    s_barrier
    ds_read_b32 v79, v8 offset:25984
    ds_read_b64 v[88:89], v64
    ds_read_b64 v[90:91], v65
    ds_read_b64 v[92:93], v66
    ds_read_b64 v[94:95], v67
    ds_read_b64 v[96:97], v68
    ds_read_b64 v[98:99], v69
    ds_read_b64 v[100:101], v70
    ds_read_b64 v[102:103], v71
    s_waitcnt lgkmcnt(8)
    v_readfirstlane_b32 s76, v79
    s_nop 0
    s_and_b32 s76, s76, s52
    s_cbranch_scc0 L_tr0
L_bk0:
    s_ff1_i32_b32 s76, s76
    s_bitset0_b32 s52, s76
    s_add_u32 s77, s76, s65
    s_and_b32 s77, s77, 15
    s_mul_i32 s77, s77, 32768
    s_add_u32 s28, s77, s80
    s_add_u32 s76, s76, 3
    s_and_b32 s76, s76, 15
    s_lshl_b32 s4, s76, 13
    buffer_load_dwordx4 v[128:131], v14, s[40:43], s28 offen offset:0 sc1
    buffer_load_dwordx4 v[132:135], v14, s[40:43], s28 offen offset:2048 sc1
    buffer_load_dwordx4 v[136:139], v78, s[40:43], s28 offen offset:0 sc1
    buffer_load_dwordx4 v[140:143], v78, s[40:43], s28 offen offset:2048 sc1
    v_readfirstlane_b32 s76, v79
    s_nop 0
    s_and_b32 s76, s76, s52
    s_cbranch_scc0 L_tr1
L_bk1:
    s_ff1_i32_b32 s76, s76
    s_bitset0_b32 s52, s76
    s_add_u32 s77, s76, s65
    s_and_b32 s77, s77, 15
    s_mul_i32 s77, s77, 32768
    s_add_u32 s29, s77, s80
    s_add_u32 s76, s76, 3
    s_and_b32 s76, s76, 15
    s_lshl_b32 s5, s76, 13
    buffer_load_dwordx4 v[144:147], v14, s[40:43], s29 offen offset:0 sc1
    buffer_load_dwordx4 v[148:151], v14, s[40:43], s29 offen offset:2048 sc1
    v_add_u32 v80, s4, v72
    v_add_u32 v81, s4, v73
    s_waitcnt lgkmcnt(0)
    v_lshlrev_b32 v16, 16, v88
    v_and_b32 v17, s90, v88
    v_lshlrev_b32 v18, 16, v89
    v_and_b32 v19, s90, v89
    v_lshlrev_b32 v20, 16, v90
    v_and_b32 v21, s90, v90
    v_lshlrev_b32 v22, 16, v91
    v_and_b32 v23, s90, v91
    v_lshlrev_b32 v24, 16, v92
    v_and_b32 v25, s90, v92
    v_lshlrev_b32 v26, 16, v93
    v_and_b32 v27, s90, v93
    v_lshlrev_b32 v28, 16, v94
    v_and_b32 v29, s90, v94
    v_lshlrev_b32 v30, 16, v95
    v_and_b32 v31, s90, v95
    v_lshlrev_b32 v32, 16, v96
    v_and_b32 v33, s90, v96
    v_lshlrev_b32 v34, 16, v97
    v_and_b32 v35, s90, v97
    v_lshlrev_b32 v36, 16, v98
    v_and_b32 v37, s90, v98
    v_lshlrev_b32 v38, 16, v99
    v_and_b32 v39, s90, v99
    v_lshlrev_b32 v40, 16, v100
    v_and_b32 v41, s90, v100
    v_lshlrev_b32 v42, 16, v101
    v_and_b32 v43, s90, v101
    v_lshlrev_b32 v44, 16, v102
    v_and_b32 v45, s90, v102
    v_lshlrev_b32 v46, 16, v103
    v_and_b32 v47, s90, v103
    s_cmp_eq_u32 s53, 0
    s_cbranch_scc0 L_sent_66
    s_waitcnt vmcnt(6)
    s_mov_b64 exec, 1
    ds_add_u32 v8, v74 offset:25988
    s_mov_b64 exec, -1
    s_mov_b32 s53, 1
L_sent_66:
    ds_read_b32 v79, v8 offset:25984
    ds_read_b64_tr_b16 v[104:105], v80 offset:0
    ds_read_b64_tr_b16 v[106:107], v80 offset:1024
    ds_read_b64_tr_b16 v[108:109], v81 offset:0
    ds_read_b64_tr_b16 v[110:111], v81 offset:1024
    ds_read_b64_tr_b16 v[112:113], v80 offset:2048
    ds_read_b64_tr_b16 v[114:115], v80 offset:3072
    ds_read_b64_tr_b16 v[116:117], v81 offset:2048
    ds_read_b64_tr_b16 v[118:119], v81 offset:3072
    s_waitcnt vmcnt(5) lgkmcnt(4)
    v_mfma_f32_32x32x16_bf16 v[16:31], v[104:107], v[128:131], v[16:31]
    ds_read_b64_tr_b16 v[120:121], v80 offset:4096
    ds_read_b64_tr_b16 v[122:123], v80 offset:5120
    buffer_load_dwordx4 v[152:155], v78, s[40:43], s29 offen offset:0 sc1
    v_mfma_f32_32x32x16_bf16 v[32:47], v[108:111], v[128:131], v[32:47]
    ds_read_b64_tr_b16 v[124:125], v81 offset:4096
    ds_read_b64_tr_b16 v[126:127], v81 offset:5120
    buffer_load_dwordx4 v[156:159], v78, s[40:43], s29 offen offset:2048 sc1
    v_readfirstlane_b32 s76, v79
    s_nop 0
    s_and_b32 s76, s76, s52
    s_cbranch_scc0 L_tr2
L_bk2:
    s_ff1_i32_b32 s76, s76
    s_bitset0_b32 s52, s76
    s_add_u32 s77, s76, s65
    s_and_b32 s77, s77, 15
    s_mul_i32 s77, s77, 32768
    s_add_u32 s30, s77, s80
    s_waitcnt vmcnt(6) lgkmcnt(4)
    v_mfma_f32_32x32x16_bf16 v[16:31], v[112:115], v[132:135], v[16:31]
    ds_read_b32 v79, v8 offset:25984
    ds_read_b64_tr_b16 v[104:105], v80 offset:6144
    ds_read_b64_tr_b16 v[106:107], v80 offset:7168
    buffer_load_dwordx4 v[160:163], v14, s[40:43], s30 offen offset:0 sc1
    s_add_u32 s76, s76, 3
    s_and_b32 s76, s76, 15
    s_lshl_b32 s6, s76, 13
    v_mfma_f32_32x32x16_bf16 v[32:47], v[116:119], v[132:135], v[32:47]
    ds_read_b64_tr_b16 v[108:109], v81 offset:6144
    ds_read_b64_tr_b16 v[110:111], v81 offset:7168
    buffer_load_dwordx4 v[164:167], v14, s[40:43], s30 offen offset:2048 sc1
    v_add_u32 v82, s5, v72
    v_add_u32_e64 v83, s5, v73
    s_waitcnt vmcnt(7) lgkmcnt(4)
    v_mfma_f32_32x32x16_bf16 v[16:31], v[120:123], v[136:139], v[16:31]
    ds_read_b64_tr_b16 v[112:113], v82 offset:0
    ds_read_b64_tr_b16 v[114:115], v82 offset:1024
    buffer_load_dwordx4 v[168:171], v78, s[40:43], s30 offen offset:0 sc1
    v_mfma_f32_32x32x16_bf16 v[32:47], v[124:127], v[136:139], v[32:47]
    ds_read_b64_tr_b16 v[116:117], v83 offset:0
    ds_read_b64_tr_b16 v[118:119], v83 offset:1024
    buffer_load_dwordx4 v[172:175], v78, s[40:43], s30 offen offset:2048 sc1
    v_readfirstlane_b32 s76, v79
    s_nop 0
    s_and_b32 s76, s76, s52
    s_cbranch_scc0 L_tr3
L_bk3:
    s_ff1_i32_b32 s76, s76
    s_bitset0_b32 s52, s76
    s_add_u32 s77, s76, s65
    s_and_b32 s77, s77, 15
    s_mul_i32 s77, s77, 32768
    s_add_u32 s31, s77, s80
    s_waitcnt vmcnt(8) lgkmcnt(4)
    v_mfma_f32_32x32x16_bf16 v[16:31], v[104:107], v[140:143], v[16:31]
    ds_read_b32 v79, v8 offset:25984
    ds_read_b64_tr_b16 v[120:121], v82 offset:2048
    ds_read_b64_tr_b16 v[122:123], v82 offset:3072
    buffer_load_dwordx4 v[176:179], v14, s[40:43], s31 offen offset:0 sc1
    s_add_u32 s76, s76, 3
    s_and_b32 s76, s76, 15
    s_lshl_b32 s7, s76, 13
    v_mfma_f32_32x32x16_bf16 v[32:47], v[108:111], v[140:143], v[32:47]
    ds_read_b64_tr_b16 v[124:125], v83 offset:2048
    ds_read_b64_tr_b16 v[126:127], v83 offset:3072
    buffer_load_dwordx4 v[180:183], v14, s[40:43], s31 offen offset:2048 sc1
    s_waitcnt vmcnt(9) lgkmcnt(4)
    v_mfma_f32_32x32x16_bf16 v[16:31], v[112:115], v[144:147], v[16:31]
    ds_read_b64_tr_b16 v[104:105], v82 offset:4096
    ds_read_b64_tr_b16 v[106:107], v82 offset:5120
    buffer_load_dwordx4 v[184:187], v78, s[40:43], s31 offen offset:0 sc1
    v_mfma_f32_32x32x16_bf16 v[32:47], v[116:119], v[144:147], v[32:47]
    ds_read_b64_tr_b16 v[108:109], v83 offset:4096
    ds_read_b64_tr_b16 v[110:111], v83 offset:5120
    buffer_load_dwordx4 v[188:191], v78, s[40:43], s31 offen offset:2048 sc1
    v_readfirstlane_b32 s76, v79
    s_nop 0
    s_and_b32 s76, s76, s52
    s_cbranch_scc0 L_tr4
L_bk4:
    s_ff1_i32_b32 s76, s76
    s_bitset0_b32 s52, s76
    s_add_u32 s77, s76, s65
    s_and_b32 s77, s77, 15
    s_mul_i32 s77, s77, 32768
    s_add_u32 s32, s77, s80
    s_waitcnt vmcnt(10) lgkmcnt(4)
    v_mfma_f32_32x32x16_bf16 v[16:31], v[120:123], v[148:151], v[16:31]
    ds_read_b64_tr_b16 v[112:113], v82 offset:6144
    ds_read_b64_tr_b16 v[114:115], v82 offset:7168
    buffer_load_dwordx4 v[128:131], v14, s[40:43], s32 offen offset:0 sc1
    s_add_u32 s76, s76, 3
    s_and_b32 s76, s76, 15
    s_lshl_b32 s8, s76, 13
    v_mfma_f32_32x32x16_bf16 v[32:47], v[124:127], v[148:151], v[32:47]
    ds_read_b64_tr_b16 v[116:117], v83 offset:6144
    ds_read_b64_tr_b16 v[118:119], v83 offset:7168
    buffer_load_dwordx4 v[132:135], v14, s[40:43], s32 offen offset:2048 sc1
    v_add_u32 v80, s6, v72
    v_add_u32 v81, s6, v73
    s_waitcnt vmcnt(11) lgkmcnt(4)
    v_mfma_f32_32x32x16_bf16 v[16:31], v[104:107], v[152:155], v[16:31]
    ds_read_b32 v79, v8 offset:25984
    ds_read_b64_tr_b16 v[120:121], v80 offset:0
    ds_read_b64_tr_b16 v[122:123], v80 offset:1024
    buffer_load_dwordx4 v[136:139], v78, s[40:43], s32 offen offset:0 sc1
    v_mfma_f32_32x32x16_bf16 v[32:47], v[108:111], v[152:155], v[32:47]
    ds_read_b64_tr_b16 v[124:125], v81 offset:0
    ds_read_b64_tr_b16 v[126:127], v81 offset:1024
    s_waitcnt vmcnt(11) lgkmcnt(4)
    v_mfma_f32_32x32x16_bf16 v[16:31], v[112:115], v[156:159], v[16:31]
    ds_read_b64_tr_b16 v[104:105], v80 offset:2048
    ds_read_b64_tr_b16 v[106:107], v80 offset:3072
    buffer_load_dwordx4 v[140:143], v78, s[40:43], s32 offen offset:2048 sc1
    v_mfma_f32_32x32x16_bf16 v[32:47], v[116:119], v[156:159], v[32:47]
    ds_read_b64_tr_b16 v[108:109], v81 offset:2048
    ds_read_b64_tr_b16 v[110:111], v81 offset:3072
    v_readfirstlane_b32 s76, v79
    s_nop 0
    s_and_b32 s76, s76, s52
    s_cbranch_scc0 L_tr5
L_bk5:
    s_ff1_i32_b32 s76, s76
    s_bitset0_b32 s52, s76
    s_add_u32 s77, s76, s65
    s_and_b32 s77, s77, 15
    s_mul_i32 s77, s77, 32768
    s_add_u32 s33, s77, s80
    s_waitcnt vmcnt(11) lgkmcnt(4)
    v_mfma_f32_32x32x16_bf16 v[16:31], v[120:123], v[160:163], v[16:31]
    ds_read_b64_tr_b16 v[112:113], v80 offset:4096
    ds_read_b64_tr_b16 v[114:115], v80 offset:5120
    buffer_load_dwordx4 v[144:147], v14, s[40:43], s33 offen offset:0 sc1
    s_add_u32 s76, s76, 3
    s_and_b32 s76, s76, 15
    s_lshl_b32 s9, s76, 13
    v_mfma_f32_32x32x16_bf16 v[32:47], v[124:127], v[160:163], v[32:47]
    ds_read_b64_tr_b16 v[116:117], v81 offset:4096
    ds_read_b64_tr_b16 v[118:119], v81 offset:5120
    s_waitcnt vmcnt(11) lgkmcnt(4)
    v_mfma_f32_32x32x16_bf16 v[16:31], v[104:107], v[164:167], v[16:31]
    ds_read_b64_tr_b16 v[120:121], v80 offset:6144
    ds_read_b64_tr_b16 v[122:123], v80 offset:7168
    buffer_load_dwordx4 v[148:151], v14, s[40:43], s33 offen offset:2048 sc1
    v_mfma_f32_32x32x16_bf16 v[32:47], v[108:111], v[164:167], v[32:47]
    ds_read_b64_tr_b16 v[124:125], v81 offset:6144
    ds_read_b64_tr_b16 v[126:127], v81 offset:7168
    v_add_u32 v82, s7, v72
    v_add_u32 v83, s7, v73
    s_waitcnt vmcnt(11) lgkmcnt(4)
    v_mfma_f32_32x32x16_bf16 v[16:31], v[112:115], v[168:171], v[16:31]
    ds_read_b32 v79, v8 offset:25984
    ds_read_b64_tr_b16 v[104:105], v82 offset:0
    ds_read_b64_tr_b16 v[106:107], v82 offset:1024
    buffer_load_dwordx4 v[152:155], v78, s[40:43], s33 offen offset:0 sc1
    v_mfma_f32_32x32x16_bf16 v[32:47], v[116:119], v[168:171], v[32:47]
    ds_read_b64_tr_b16 v[108:109], v83 offset:0
    ds_read_b64_tr_b16 v[110:111], v83 offset:1024
    s_waitcnt vmcnt(11) lgkmcnt(4)
    v_mfma_f32_32x32x16_bf16 v[16:31], v[120:123], v[172:175], v[16:31]
    ds_read_b64_tr_b16 v[112:113], v82 offset:2048
    ds_read_b64_tr_b16 v[114:115], v82 offset:3072
    buffer_load_dwordx4 v[156:159], v78, s[40:43], s33 offen offset:2048 sc1
    v_mfma_f32_32x32x16_bf16 v[32:47], v[124:127], v[172:175], v[32:47]
    ds_read_b64_tr_b16 v[116:117], v83 offset:2048
    ds_read_b64_tr_b16 v[118:119], v83 offset:3072
    v_readfirstlane_b32 s76, v79
    s_nop 0
    s_and_b32 s76, s76, s52
    s_cbranch_scc0 L_tr6
L_bk6:
    s_ff1_i32_b32 s76, s76
    s_bitset0_b32 s52, s76
    s_add_u32 s77, s76, s65
    s_and_b32 s77, s77, 15
    s_mul_i32 s77, s77, 32768
    s_add_u32 s34, s77, s80
    s_waitcnt vmcnt(11) lgkmcnt(4)
    v_mfma_f32_32x32x16_bf16 v[16:31], v[104:107], v[176:179], v[16:31]
    ds_read_b64_tr_b16 v[120:121], v82 offset:4096
    ds_read_b64_tr_b16 v[122:123], v82 offset:5120
    buffer_load_dwordx4 v[160:163], v14, s[40:43], s34 offen offset:0 sc1
    s_add_u32 s76, s76, 3
    s_and_b32 s76, s76, 15
    s_lshl_b32 s10, s76, 13
    v_mfma_f32_32x32x16_bf16 v[32:47], v[108:111], v[176:179], v[32:47]
    ds_read_b64_tr_b16 v[124:125], v83 offset:4096
    ds_read_b64_tr_b16 v[126:127], v83 offset:5120
    s_waitcnt vmcnt(11) lgkmcnt(4)
    v_mfma_f32_32x32x16_bf16 v[16:31], v[112:115], v[180:183], v[16:31]
    ds_read_b64_tr_b16 v[104:105], v82 offset:6144
    ds_read_b64_tr_b16 v[106:107], v82 offset:7168
    buffer_load_dwordx4 v[164:167], v14, s[40:43], s34 offen offset:2048 sc1
    v_mfma_f32_32x32x16_bf16 v[32:47], v[116:119], v[180:183], v[32:47]
    ds_read_b64_tr_b16 v[108:109], v83 offset:6144
    ds_read_b64_tr_b16 v[110:111], v83 offset:7168
    v_add_u32 v80, s8, v72
    v_add_u32 v81, s8, v73
    s_waitcnt vmcnt(11) lgkmcnt(4)
    v_mfma_f32_32x32x16_bf16 v[16:31], v[120:123], v[184:187], v[16:31]
    ds_read_b32 v79, v8 offset:25984
    ds_read_b64_tr_b16 v[112:113], v80 offset:0
    ds_read_b64_tr_b16 v[114:115], v80 offset:1024
    buffer_load_dwordx4 v[168:171], v78, s[40:43], s34 offen offset:0 sc1
    v_mfma_f32_32x32x16_bf16 v[32:47], v[124:127], v[184:187], v[32:47]
    ds_read_b64_tr_b16 v[116:117], v81 offset:0
    ds_read_b64_tr_b16 v[118:119], v81 offset:1024
    s_waitcnt vmcnt(11) lgkmcnt(4)
    v_mfma_f32_32x32x16_bf16 v[16:31], v[104:107], v[188:191], v[16:31]
    ds_read_b64_tr_b16 v[120:121], v80 offset:2048
    ds_read_b64_tr_b16 v[122:123], v80 offset:3072
    buffer_load_dwordx4 v[172:175], v78, s[40:43], s34 offen offset:2048 sc1
    v_mfma_f32_32x32x16_bf16 v[32:47], v[108:111], v[188:191], v[32:47]
    ds_read_b64_tr_b16 v[124:125], v81 offset:2048
    ds_read_b64_tr_b16 v[126:127], v81 offset:3072
    v_readfirstlane_b32 s76, v79
    s_nop 0
    s_and_b32 s76, s76, s52
    s_cbranch_scc0 L_tr7
L_bk7:
    s_ff1_i32_b32 s76, s76
    s_bitset0_b32 s52, s76
    s_add_u32 s77, s76, s65
    s_and_b32 s77, s77, 15
    s_mul_i32 s77, s77, 32768
    s_add_u32 s35, s77, s80
    s_waitcnt vmcnt(11) lgkmcnt(4)
    v_mfma_f32_32x32x16_bf16 v[16:31], v[112:115], v[128:131], v[16:31]
    ds_read_b64_tr_b16 v[104:105], v80 offset:4096
    ds_read_b64_tr_b16 v[106:107], v80 offset:5120
    buffer_load_dwordx4 v[176:179], v14, s[40:43], s35 offen offset:0 sc1
    s_add_u32 s76, s76, 3
    s_and_b32 s76, s76, 15
    s_lshl_b32 s11, s76, 13
    v_mfma_f32_32x32x16_bf16 v[32:47], v[116:119], v[128:131], v[32:47]
    ds_read_b64_tr_b16 v[108:109], v81 offset:4096
    ds_read_b64_tr_b16 v[110:111], v81 offset:5120
    s_waitcnt vmcnt(11) lgkmcnt(4)
    v_mfma_f32_32x32x16_bf16 v[16:31], v[120:123], v[132:135], v[16:31]
    ds_read_b64_tr_b16 v[112:113], v80 offset:6144
    ds_read_b64_tr_b16 v[114:115], v80 offset:7168
    buffer_load_dwordx4 v[180:183], v14, s[40:43], s35 offen offset:2048 sc1
    v_mfma_f32_32x32x16_bf16 v[32:47], v[124:127], v[132:135], v[32:47]
    ds_read_b64_tr_b16 v[116:117], v81 offset:6144
    ds_read_b64_tr_b16 v[118:119], v81 offset:7168
    v_add_u32 v82, s9, v72
    v_add_u32 v83, s9, v73
    s_waitcnt vmcnt(11) lgkmcnt(4)
    v_mfma_f32_32x32x16_bf16 v[16:31], v[104:107], v[136:139], v[16:31]
    ds_read_b32 v79, v8 offset:25984
    ds_read_b64_tr_b16 v[120:121], v82 offset:0
    ds_read_b64_tr_b16 v[122:123], v82 offset:1024
    buffer_load_dwordx4 v[184:187], v78, s[40:43], s35 offen offset:0 sc1
    v_mfma_f32_32x32x16_bf16 v[32:47], v[108:111], v[136:139], v[32:47]
    ds_read_b64_tr_b16 v[124:125], v83 offset:0
    ds_read_b64_tr_b16 v[126:127], v83 offset:1024
    s_waitcnt vmcnt(11) lgkmcnt(4)
    v_mfma_f32_32x32x16_bf16 v[16:31], v[112:115], v[140:143], v[16:31]
    ds_read_b64_tr_b16 v[104:105], v82 offset:2048
    ds_read_b64_tr_b16 v[106:107], v82 offset:3072
    buffer_load_dwordx4 v[188:191], v78, s[40:43], s35 offen offset:2048 sc1
    v_mfma_f32_32x32x16_bf16 v[32:47], v[116:119], v[140:143], v[32:47]
    ds_read_b64_tr_b16 v[108:109], v83 offset:2048
    ds_read_b64_tr_b16 v[110:111], v83 offset:3072
    v_readfirstlane_b32 s76, v79
    s_nop 0
    s_and_b32 s76, s76, s52
    s_cbranch_scc0 L_tr8
L_bk8:
    s_ff1_i32_b32 s76, s76
    s_bitset0_b32 s52, s76
    s_add_u32 s77, s76, s65
    s_and_b32 s77, s77, 15
    s_mul_i32 s77, s77, 32768
    s_add_u32 s36, s77, s80
    s_waitcnt vmcnt(11) lgkmcnt(4)
    v_mfma_f32_32x32x16_bf16 v[16:31], v[120:123], v[144:147], v[16:31]
    ds_read_b64_tr_b16 v[112:113], v82 offset:4096
    ds_read_b64_tr_b16 v[114:115], v82 offset:5120
    buffer_load_dwordx4 v[128:131], v14, s[40:43], s36 offen offset:0 sc1
    s_add_u32 s76, s76, 3
    s_and_b32 s76, s76, 15
    s_lshl_b32 s12, s76, 13
    v_mfma_f32_32x32x16_bf16 v[32:47], v[124:127], v[144:147], v[32:47]
    ds_read_b64_tr_b16 v[116:117], v83 offset:4096
    ds_read_b64_tr_b16 v[118:119], v83 offset:5120
    s_waitcnt vmcnt(11) lgkmcnt(4)
    v_mfma_f32_32x32x16_bf16 v[16:31], v[104:107], v[148:151], v[16:31]
    ds_read_b64_tr_b16 v[120:121], v82 offset:6144
    ds_read_b64_tr_b16 v[122:123], v82 offset:7168
    buffer_load_dwordx4 v[132:135], v14, s[40:43], s36 offen offset:2048 sc1
    v_mfma_f32_32x32x16_bf16 v[32:47], v[108:111], v[148:151], v[32:47]
    ds_read_b64_tr_b16 v[124:125], v83 offset:6144
    ds_read_b64_tr_b16 v[126:127], v83 offset:7168
    v_add_u32 v80, s10, v72
    v_add_u32 v81, s10, v73
    s_waitcnt vmcnt(11) lgkmcnt(4)
    v_mfma_f32_32x32x16_bf16 v[16:31], v[112:115], v[152:155], v[16:31]
    ds_read_b32 v79, v8 offset:25984
    ds_read_b64_tr_b16 v[104:105], v80 offset:0
    ds_read_b64_tr_b16 v[106:107], v80 offset:1024
    buffer_load_dwordx4 v[136:139], v78, s[40:43], s36 offen offset:0 sc1
    v_mfma_f32_32x32x16_bf16 v[32:47], v[116:119], v[152:155], v[32:47]
    ds_read_b64_tr_b16 v[108:109], v81 offset:0
    ds_read_b64_tr_b16 v[110:111], v81 offset:1024
    s_waitcnt vmcnt(11) lgkmcnt(4)
    v_mfma_f32_32x32x16_bf16 v[16:31], v[120:123], v[156:159], v[16:31]
    ds_read_b64_tr_b16 v[112:113], v80 offset:2048
    ds_read_b64_tr_b16 v[114:115], v80 offset:3072
    buffer_load_dwordx4 v[140:143], v78, s[40:43], s36 offen offset:2048 sc1
    v_mfma_f32_32x32x16_bf16 v[32:47], v[124:127], v[156:159], v[32:47]
    ds_read_b64_tr_b16 v[116:117], v81 offset:2048
    ds_read_b64_tr_b16 v[118:119], v81 offset:3072
    v_readfirstlane_b32 s76, v79
    s_nop 0
    s_and_b32 s76, s76, s52
    s_cbranch_scc0 L_tr9
L_bk9:
    s_ff1_i32_b32 s76, s76
    s_bitset0_b32 s52, s76
    s_add_u32 s77, s76, s65
    s_and_b32 s77, s77, 15
    s_mul_i32 s77, s77, 32768
    s_add_u32 s37, s77, s80
    s_waitcnt vmcnt(11) lgkmcnt(4)
    v_mfma_f32_32x32x16_bf16 v[16:31], v[104:107], v[160:163], v[16:31]
    ds_read_b64_tr_b16 v[120:121], v80 offset:4096
    ds_read_b64_tr_b16 v[122:123], v80 offset:5120
    buffer_load_dwordx4 v[144:147], v14, s[40:43], s37 offen offset:0 sc1
    s_add_u32 s76, s76, 3
    s_and_b32 s76, s76, 15
    s_lshl_b32 s13, s76, 13
    v_mfma_f32_32x32x16_bf16 v[32:47], v[108:111], v[160:163], v[32:47]
    ds_read_b64_tr_b16 v[124:125], v81 offset:4096
    ds_read_b64_tr_b16 v[126:127], v81 offset:5120
    s_waitcnt vmcnt(11) lgkmcnt(4)
    v_mfma_f32_32x32x16_bf16 v[16:31], v[112:115], v[164:167], v[16:31]
    ds_read_b64_tr_b16 v[104:105], v80 offset:6144
    ds_read_b64_tr_b16 v[106:107], v80 offset:7168
    buffer_load_dwordx4 v[148:151], v14, s[40:43], s37 offen offset:2048 sc1
    v_mfma_f32_32x32x16_bf16 v[32:47], v[116:119], v[164:167], v[32:47]
    ds_read_b64_tr_b16 v[108:109], v81 offset:6144
    ds_read_b64_tr_b16 v[110:111], v81 offset:7168
    v_add_u32 v82, s11, v72
    v_add_u32 v83, s11, v73
    s_waitcnt vmcnt(11) lgkmcnt(4)
    v_mfma_f32_32x32x16_bf16 v[16:31], v[120:123], v[168:171], v[16:31]
    ds_read_b32 v79, v8 offset:25984
    ds_read_b64_tr_b16 v[112:113], v82 offset:0
    ds_read_b64_tr_b16 v[114:115], v82 offset:1024
    buffer_load_dwordx4 v[152:155], v78, s[40:43], s37 offen offset:0 sc1
    v_mfma_f32_32x32x16_bf16 v[32:47], v[124:127], v[168:171], v[32:47]
    ds_read_b64_tr_b16 v[116:117], v83 offset:0
    ds_read_b64_tr_b16 v[118:119], v83 offset:1024
    s_waitcnt vmcnt(11) lgkmcnt(4)
    v_mfma_f32_32x32x16_bf16 v[16:31], v[104:107], v[172:175], v[16:31]
    ds_read_b64_tr_b16 v[120:121], v82 offset:2048
    ds_read_b64_tr_b16 v[122:123], v82 offset:3072
    buffer_load_dwordx4 v[156:159], v78, s[40:43], s37 offen offset:2048 sc1
    v_mfma_f32_32x32x16_bf16 v[32:47], v[108:111], v[172:175], v[32:47]
    ds_read_b64_tr_b16 v[124:125], v83 offset:2048
    ds_read_b64_tr_b16 v[126:127], v83 offset:3072
    v_readfirstlane_b32 s76, v79
    s_nop 0
    s_and_b32 s76, s76, s52
    s_cbranch_scc0 L_tr10
L_bk10:
    s_ff1_i32_b32 s76, s76
    s_bitset0_b32 s52, s76
    s_add_u32 s77, s76, s65
    s_and_b32 s77, s77, 15
    s_mul_i32 s77, s77, 32768
    s_add_u32 s38, s77, s80
    s_waitcnt vmcnt(11) lgkmcnt(4)
    v_mfma_f32_32x32x16_bf16 v[16:31], v[112:115], v[176:179], v[16:31]
    ds_read_b64_tr_b16 v[104:105], v82 offset:4096
    ds_read_b64_tr_b16 v[106:107], v82 offset:5120
    buffer_load_dwordx4 v[160:163], v14, s[40:43], s38 offen offset:0 sc1
    s_add_u32 s76, s76, 3
    s_and_b32 s76, s76, 15
    s_lshl_b32 s14, s76, 13
    v_mfma_f32_32x32x16_bf16 v[32:47], v[116:119], v[176:179], v[32:47]
    ds_read_b64_tr_b16 v[108:109], v83 offset:4096
    ds_read_b64_tr_b16 v[110:111], v83 offset:5120
    s_waitcnt vmcnt(11) lgkmcnt(4)
    v_mfma_f32_32x32x16_bf16 v[16:31], v[120:123], v[180:183], v[16:31]
    ds_read_b64_tr_b16 v[112:113], v82 offset:6144
    ds_read_b64_tr_b16 v[114:115], v82 offset:7168
    buffer_load_dwordx4 v[164:167], v14, s[40:43], s38 offen offset:2048 sc1
    v_mfma_f32_32x32x16_bf16 v[32:47], v[124:127], v[180:183], v[32:47]
    ds_read_b64_tr_b16 v[116:117], v83 offset:6144
    ds_read_b64_tr_b16 v[118:119], v83 offset:7168
    v_add_u32 v80, s12, v72
    v_add_u32 v81, s12, v73
    s_waitcnt vmcnt(11) lgkmcnt(4)
    v_mfma_f32_32x32x16_bf16 v[16:31], v[104:107], v[184:187], v[16:31]
    ds_read_b32 v79, v8 offset:25984
    ds_read_b64_tr_b16 v[120:121], v80 offset:0
    ds_read_b64_tr_b16 v[122:123], v80 offset:1024
    buffer_load_dwordx4 v[168:171], v78, s[40:43], s38 offen offset:0 sc1
    v_mfma_f32_32x32x16_bf16 v[32:47], v[108:111], v[184:187], v[32:47]
    ds_read_b64_tr_b16 v[124:125], v81 offset:0
    ds_read_b64_tr_b16 v[126:127], v81 offset:1024
    s_waitcnt vmcnt(11) lgkmcnt(4)
    v_mfma_f32_32x32x16_bf16 v[16:31], v[112:115], v[188:191], v[16:31]
    ds_read_b64_tr_b16 v[104:105], v80 offset:2048
    ds_read_b64_tr_b16 v[106:107], v80 offset:3072
    buffer_load_dwordx4 v[172:175], v78, s[40:43], s38 offen offset:2048 sc1
    v_mfma_f32_32x32x16_bf16 v[32:47], v[116:119], v[188:191], v[32:47]
    ds_read_b64_tr_b16 v[108:109], v81 offset:2048
    ds_read_b64_tr_b16 v[110:111], v81 offset:3072
    v_readfirstlane_b32 s76, v79
    s_nop 0
    s_and_b32 s76, s76, s52
    s_cbranch_scc0 L_tr11
L_bk11:
    s_ff1_i32_b32 s76, s76
    s_bitset0_b32 s52, s76
    s_add_u32 s77, s76, s65
    s_and_b32 s77, s77, 15
    s_mul_i32 s77, s77, 32768
    s_add_u32 s39, s77, s80
    s_waitcnt vmcnt(11) lgkmcnt(4)
    v_mfma_f32_32x32x16_bf16 v[16:31], v[120:123], v[128:131], v[16:31]
    ds_read_b64_tr_b16 v[112:113], v80 offset:4096
    ds_read_b64_tr_b16 v[114:115], v80 offset:5120
    buffer_load_dwordx4 v[176:179], v14, s[40:43], s39 offen offset:0 sc1
    s_add_u32 s76, s76, 3
    s_and_b32 s76, s76, 15
    s_lshl_b32 s15, s76, 13
    v_mfma_f32_32x32x16_bf16 v[32:47], v[124:127], v[128:131], v[32:47]
    ds_read_b64_tr_b16 v[116:117], v81 offset:4096
    ds_read_b64_tr_b16 v[118:119], v81 offset:5120
    s_waitcnt vmcnt(11) lgkmcnt(4)
    v_mfma_f32_32x32x16_bf16 v[16:31], v[104:107], v[132:135], v[16:31]
    ds_read_b64_tr_b16 v[120:121], v80 offset:6144
    ds_read_b64_tr_b16 v[122:123], v80 offset:7168
    buffer_load_dwordx4 v[180:183], v14, s[40:43], s39 offen offset:2048 sc1
    v_mfma_f32_32x32x16_bf16 v[32:47], v[108:111], v[132:135], v[32:47]
    ds_read_b64_tr_b16 v[124:125], v81 offset:6144
    ds_read_b64_tr_b16 v[126:127], v81 offset:7168
    v_add_u32 v82, s13, v72
    v_add_u32 v83, s13, v73
    s_waitcnt vmcnt(11) lgkmcnt(4)
    v_mfma_f32_32x32x16_bf16 v[16:31], v[112:115], v[136:139], v[16:31]
    ds_read_b32 v79, v8 offset:25984
    ds_read_b64_tr_b16 v[104:105], v82 offset:0
    ds_read_b64_tr_b16 v[106:107], v82 offset:1024
    buffer_load_dwordx4 v[184:187], v78, s[40:43], s39 offen offset:0 sc1
    v_mfma_f32_32x32x16_bf16 v[32:47], v[116:119], v[136:139], v[32:47]
    ds_read_b64_tr_b16 v[108:109], v83 offset:0
    ds_read_b64_tr_b16 v[110:111], v83 offset:1024
    s_waitcnt vmcnt(11) lgkmcnt(4)
    v_mfma_f32_32x32x16_bf16 v[16:31], v[120:123], v[140:143], v[16:31]
    ds_read_b64_tr_b16 v[112:113], v82 offset:2048
    ds_read_b64_tr_b16 v[114:115], v82 offset:3072
    buffer_load_dwordx4 v[188:191], v78, s[40:43], s39 offen offset:2048 sc1
    v_mfma_f32_32x32x16_bf16 v[32:47], v[124:127], v[140:143], v[32:47]
    ds_read_b64_tr_b16 v[116:117], v83 offset:2048
    ds_read_b64_tr_b16 v[118:119], v83 offset:3072
    v_readfirstlane_b32 s76, v79
    s_nop 0
    s_and_b32 s76, s76, s52
    s_cbranch_scc0 L_tr12
L_bk12:
    s_ff1_i32_b32 s76, s76
    s_bitset0_b32 s52, s76
    s_add_u32 s77, s76, s65
    s_and_b32 s77, s77, 15
    s_mul_i32 s77, s77, 32768
    s_add_u32 s48, s77, s80
    s_waitcnt vmcnt(11) lgkmcnt(4)
    v_mfma_f32_32x32x16_bf16 v[16:31], v[104:107], v[144:147], v[16:31]
    ds_read_b64_tr_b16 v[120:121], v82 offset:4096
    ds_read_b64_tr_b16 v[122:123], v82 offset:5120
    buffer_load_dwordx4 v[128:131], v14, s[40:43], s48 offen offset:0 sc1
    s_add_u32 s76, s76, 3
    s_and_b32 s76, s76, 15
    s_lshl_b32 s16, s76, 13
    v_mfma_f32_32x32x16_bf16 v[32:47], v[108:111], v[144:147], v[32:47]
    ds_read_b64_tr_b16 v[124:125], v83 offset:4096
    ds_read_b64_tr_b16 v[126:127], v83 offset:5120
    s_waitcnt vmcnt(11) lgkmcnt(4)
    v_mfma_f32_32x32x16_bf16 v[16:31], v[112:115], v[148:151], v[16:31]
    ds_read_b64_tr_b16 v[104:105], v82 offset:6144
    ds_read_b64_tr_b16 v[106:107], v82 offset:7168
    buffer_load_dwordx4 v[132:135], v14, s[40:43], s48 offen offset:2048 sc1
    v_mfma_f32_32x32x16_bf16 v[32:47], v[116:119], v[148:151], v[32:47]
    ds_read_b64_tr_b16 v[108:109], v83 offset:6144
    ds_read_b64_tr_b16 v[110:111], v83 offset:7168
    v_add_u32 v80, s14, v72
    v_add_u32 v81, s14, v73
    s_waitcnt vmcnt(11) lgkmcnt(4)
    v_mfma_f32_32x32x16_bf16 v[16:31], v[120:123], v[152:155], v[16:31]
    ds_read_b32 v79, v8 offset:25984
    ds_read_b64_tr_b16 v[112:113], v80 offset:0
    ds_read_b64_tr_b16 v[114:115], v80 offset:1024
    buffer_load_dwordx4 v[136:139], v78, s[40:43], s48 offen offset:0 sc1
    v_mfma_f32_32x32x16_bf16 v[32:47], v[124:127], v[152:155], v[32:47]
    ds_read_b64_tr_b16 v[116:117], v81 offset:0
    ds_read_b64_tr_b16 v[118:119], v81 offset:1024
    s_waitcnt vmcnt(11) lgkmcnt(4)
    v_mfma_f32_32x32x16_bf16 v[16:31], v[104:107], v[156:159], v[16:31]
    ds_read_b64_tr_b16 v[120:121], v80 offset:2048
    ds_read_b64_tr_b16 v[122:123], v80 offset:3072
    buffer_load_dwordx4 v[140:143], v78, s[40:43], s48 offen offset:2048 sc1
    v_mfma_f32_32x32x16_bf16 v[32:47], v[108:111], v[156:159], v[32:47]
    ds_read_b64_tr_b16 v[124:125], v81 offset:2048
    ds_read_b64_tr_b16 v[126:127], v81 offset:3072
    v_readfirstlane_b32 s76, v79
    s_nop 0
    s_and_b32 s76, s76, s52
    s_cbranch_scc0 L_tr13
L_bk13:
    s_ff1_i32_b32 s76, s76
    s_bitset0_b32 s52, s76
    s_add_u32 s77, s76, s65
    s_and_b32 s77, s77, 15
    s_mul_i32 s77, s77, 32768
    s_add_u32 s49, s77, s80
    s_waitcnt vmcnt(11) lgkmcnt(4)
    v_mfma_f32_32x32x16_bf16 v[16:31], v[112:115], v[160:163], v[16:31]
    ds_read_b64_tr_b16 v[104:105], v80 offset:4096
    ds_read_b64_tr_b16 v[106:107], v80 offset:5120
    buffer_load_dwordx4 v[144:147], v14, s[40:43], s49 offen offset:0 sc1
    s_add_u32 s76, s76, 3
    s_and_b32 s76, s76, 15
    s_lshl_b32 s17, s76, 13
    v_mfma_f32_32x32x16_bf16 v[32:47], v[116:119], v[160:163], v[32:47]
    ds_read_b64_tr_b16 v[108:109], v81 offset:4096
    ds_read_b64_tr_b16 v[110:111], v81 offset:5120
    s_waitcnt vmcnt(11) lgkmcnt(4)
    v_mfma_f32_32x32x16_bf16 v[16:31], v[120:123], v[164:167], v[16:31]
    ds_read_b64_tr_b16 v[112:113], v80 offset:6144
    ds_read_b64_tr_b16 v[114:115], v80 offset:7168
    buffer_load_dwordx4 v[148:151], v14, s[40:43], s49 offen offset:2048 sc1
    v_mfma_f32_32x32x16_bf16 v[32:47], v[124:127], v[164:167], v[32:47]
    ds_read_b64_tr_b16 v[116:117], v81 offset:6144
    ds_read_b64_tr_b16 v[118:119], v81 offset:7168
    v_add_u32 v82, s15, v72
    v_add_u32 v83, s15, v73
    s_waitcnt vmcnt(11) lgkmcnt(4)
    v_mfma_f32_32x32x16_bf16 v[16:31], v[104:107], v[168:171], v[16:31]
    ds_read_b32 v79, v8 offset:25984
    ds_read_b64_tr_b16 v[120:121], v82 offset:0
    ds_read_b64_tr_b16 v[122:123], v82 offset:1024
    buffer_load_dwordx4 v[152:155], v78, s[40:43], s49 offen offset:0 sc1
    v_mfma_f32_32x32x16_bf16 v[32:47], v[108:111], v[168:171], v[32:47]
    ds_read_b64_tr_b16 v[124:125], v83 offset:0
    ds_read_b64_tr_b16 v[126:127], v83 offset:1024
    s_waitcnt vmcnt(11) lgkmcnt(4)
    v_mfma_f32_32x32x16_bf16 v[16:31], v[112:115], v[172:175], v[16:31]
    ds_read_b64_tr_b16 v[104:105], v82 offset:2048
    ds_read_b64_tr_b16 v[106:107], v82 offset:3072
    buffer_load_dwordx4 v[156:159], v78, s[40:43], s49 offen offset:2048 sc1
    v_mfma_f32_32x32x16_bf16 v[32:47], v[116:119], v[172:175], v[32:47]
    ds_read_b64_tr_b16 v[108:109], v83 offset:2048
    ds_read_b64_tr_b16 v[110:111], v83 offset:3072
    v_readfirstlane_b32 s76, v79
    s_nop 0
    s_and_b32 s76, s76, s52
    s_cbranch_scc0 L_tr14
L_bk14:
    s_ff1_i32_b32 s76, s76
    s_bitset0_b32 s52, s76
    s_add_u32 s77, s76, s65
    s_and_b32 s77, s77, 15
    s_mul_i32 s77, s77, 32768
    s_add_u32 s50, s77, s80
    s_waitcnt vmcnt(11) lgkmcnt(4)
    v_mfma_f32_32x32x16_bf16 v[16:31], v[120:123], v[176:179], v[16:31]
    ds_read_b64_tr_b16 v[112:113], v82 offset:4096
    ds_read_b64_tr_b16 v[114:115], v82 offset:5120
    buffer_load_dwordx4 v[160:163], v14, s[40:43], s50 offen offset:0 sc1
    s_add_u32 s76, s76, 3
    s_and_b32 s76, s76, 15
    s_lshl_b32 s18, s76, 13
    v_mfma_f32_32x32x16_bf16 v[32:47], v[124:127], v[176:179], v[32:47]
    ds_read_b64_tr_b16 v[116:117], v83 offset:4096
    ds_read_b64_tr_b16 v[118:119], v83 offset:5120
    s_waitcnt vmcnt(11) lgkmcnt(4)
    v_mfma_f32_32x32x16_bf16 v[16:31], v[104:107], v[180:183], v[16:31]
    ds_read_b64_tr_b16 v[120:121], v82 offset:6144
    ds_read_b64_tr_b16 v[122:123], v82 offset:7168
    buffer_load_dwordx4 v[164:167], v14, s[40:43], s50 offen offset:2048 sc1
    v_mfma_f32_32x32x16_bf16 v[32:47], v[108:111], v[180:183], v[32:47]
    ds_read_b64_tr_b16 v[124:125], v83 offset:6144
    ds_read_b64_tr_b16 v[126:127], v83 offset:7168
    v_add_u32 v80, s16, v72
    v_add_u32 v81, s16, v73
    s_waitcnt vmcnt(11) lgkmcnt(4)
    v_mfma_f32_32x32x16_bf16 v[16:31], v[112:115], v[184:187], v[16:31]
    ds_read_b32 v79, v8 offset:25984
    ds_read_b64_tr_b16 v[104:105], v80 offset:0
    ds_read_b64_tr_b16 v[106:107], v80 offset:1024
    buffer_load_dwordx4 v[168:171], v78, s[40:43], s50 offen offset:0 sc1
    v_mfma_f32_32x32x16_bf16 v[32:47], v[116:119], v[184:187], v[32:47]
    ds_read_b64_tr_b16 v[108:109], v81 offset:0
    ds_read_b64_tr_b16 v[110:111], v81 offset:1024
    s_waitcnt vmcnt(11) lgkmcnt(4)
    v_mfma_f32_32x32x16_bf16 v[16:31], v[120:123], v[188:191], v[16:31]
    ds_read_b64_tr_b16 v[112:113], v80 offset:2048
    ds_read_b64_tr_b16 v[114:115], v80 offset:3072
    buffer_load_dwordx4 v[172:175], v78, s[40:43], s50 offen offset:2048 sc1
    v_mfma_f32_32x32x16_bf16 v[32:47], v[124:127], v[188:191], v[32:47]
    ds_read_b64_tr_b16 v[116:117], v81 offset:2048
    ds_read_b64_tr_b16 v[118:119], v81 offset:3072
    v_readfirstlane_b32 s76, v79
    s_nop 0
    s_and_b32 s76, s76, s52
    s_cbranch_scc0 L_tr15
L_bk15:
    s_ff1_i32_b32 s76, s76
    s_bitset0_b32 s52, s76
    s_add_u32 s77, s76, s65
    s_and_b32 s77, s77, 15
    s_mul_i32 s77, s77, 32768
    s_add_u32 s51, s77, s80
    s_waitcnt vmcnt(11) lgkmcnt(4)
    v_mfma_f32_32x32x16_bf16 v[16:31], v[104:107], v[128:131], v[16:31]
    ds_read_b64_tr_b16 v[120:121], v80 offset:4096
    ds_read_b64_tr_b16 v[122:123], v80 offset:5120
    buffer_load_dwordx4 v[176:179], v14, s[40:43], s51 offen offset:0 sc1
    s_add_u32 s76, s76, 3
    s_and_b32 s76, s76, 15
    s_lshl_b32 s19, s76, 13
    v_mfma_f32_32x32x16_bf16 v[32:47], v[108:111], v[128:131], v[32:47]
    ds_read_b64_tr_b16 v[124:125], v81 offset:4096
    ds_read_b64_tr_b16 v[126:127], v81 offset:5120
    s_waitcnt vmcnt(11) lgkmcnt(4)
    v_mfma_f32_32x32x16_bf16 v[16:31], v[112:115], v[132:135], v[16:31]
    ds_read_b64_tr_b16 v[104:105], v80 offset:6144
    ds_read_b64_tr_b16 v[106:107], v80 offset:7168
    buffer_load_dwordx4 v[180:183], v14, s[40:43], s51 offen offset:2048 sc1
    v_mfma_f32_32x32x16_bf16 v[32:47], v[116:119], v[132:135], v[32:47]
    ds_read_b64_tr_b16 v[108:109], v81 offset:6144
    ds_read_b64_tr_b16 v[110:111], v81 offset:7168
    v_add_u32 v82, s17, v72
    v_add_u32 v83, s17, v73
    s_waitcnt vmcnt(11) lgkmcnt(4)
    v_mfma_f32_32x32x16_bf16 v[16:31], v[120:123], v[136:139], v[16:31]
    ds_read_b64_tr_b16 v[112:113], v82 offset:0
    ds_read_b64_tr_b16 v[114:115], v82 offset:1024
    buffer_load_dwordx4 v[184:187], v78, s[40:43], s51 offen offset:0 sc1
    v_mfma_f32_32x32x16_bf16 v[32:47], v[124:127], v[136:139], v[32:47]
    ds_read_b64_tr_b16 v[116:117], v83 offset:0
    ds_read_b64_tr_b16 v[118:119], v83 offset:1024
    s_waitcnt vmcnt(11) lgkmcnt(4)
    v_mfma_f32_32x32x16_bf16 v[16:31], v[104:107], v[140:143], v[16:31]
    ds_read_b64_tr_b16 v[120:121], v82 offset:2048
    ds_read_b64_tr_b16 v[122:123], v82 offset:3072
    buffer_load_dwordx4 v[188:191], v78, s[40:43], s51 offen offset:2048 sc1
    s_barrier
    v_mfma_f32_32x32x16_bf16 v[32:47], v[108:111], v[140:143], v[32:47]
    ds_read_b64_tr_b16 v[124:125], v83 offset:2048
    ds_read_b64_tr_b16 v[126:127], v83 offset:3072
    s_waitcnt vmcnt(11) lgkmcnt(4)
    v_mfma_f32_32x32x16_bf16 v[16:31], v[112:115], v[144:147], v[16:31]
    ds_read_b64_tr_b16 v[104:105], v82 offset:4096
    ds_read_b64_tr_b16 v[106:107], v82 offset:5120
    v_mfma_f32_32x32x16_bf16 v[32:47], v[116:119], v[144:147], v[32:47]
    ds_read_b64_tr_b16 v[108:109], v83 offset:4096
    ds_read_b64_tr_b16 v[110:111], v83 offset:5120
    s_waitcnt vmcnt(10) lgkmcnt(4)
    v_mfma_f32_32x32x16_bf16 v[16:31], v[120:123], v[148:151], v[16:31]
    ds_read_b64_tr_b16 v[112:113], v82 offset:6144
    ds_read_b64_tr_b16 v[114:115], v82 offset:7168
    v_mfma_f32_32x32x16_bf16 v[32:47], v[124:127], v[148:151], v[32:47]
    ds_read_b64_tr_b16 v[116:117], v83 offset:6144
    ds_read_b64_tr_b16 v[118:119], v83 offset:7168
    v_add_u32 v80, s18, v72
    v_add_u32_e64 v81, s18, v73
    s_waitcnt vmcnt(9) lgkmcnt(4)
    v_mfma_f32_32x32x16_bf16 v[16:31], v[104:107], v[152:155], v[16:31]
    ds_read_b64_tr_b16 v[120:121], v80 offset:0
    ds_read_b64_tr_b16 v[122:123], v80 offset:1024
    v_mfma_f32_32x32x16_bf16 v[32:47], v[108:111], v[152:155], v[32:47]
    ds_read_b64_tr_b16 v[124:125], v81 offset:0
    ds_read_b64_tr_b16 v[126:127], v81 offset:1024
    s_waitcnt vmcnt(8) lgkmcnt(4)
    v_mfma_f32_32x32x16_bf16 v[16:31], v[112:115], v[156:159], v[16:31]
    ds_read_b64_tr_b16 v[104:105], v80 offset:2048
    ds_read_b64_tr_b16 v[106:107], v80 offset:3072
    v_mfma_f32_32x32x16_bf16 v[32:47], v[116:119], v[156:159], v[32:47]
    ds_read_b64_tr_b16 v[108:109], v81 offset:2048
    ds_read_b64_tr_b16 v[110:111], v81 offset:3072
    s_waitcnt vmcnt(7) lgkmcnt(4)
    v_mfma_f32_32x32x16_bf16 v[16:31], v[120:123], v[160:163], v[16:31]
    ds_read_b64_tr_b16 v[112:113], v80 offset:4096
    ds_read_b64_tr_b16 v[114:115], v80 offset:5120
    v_mfma_f32_32x32x16_bf16 v[32:47], v[124:127], v[160:163], v[32:47]
    ds_read_b64_tr_b16 v[116:117], v81 offset:4096
    ds_read_b64_tr_b16 v[118:119], v81 offset:5120
    s_waitcnt vmcnt(6) lgkmcnt(4)
    v_mfma_f32_32x32x16_bf16 v[16:31], v[104:107], v[164:167], v[16:31]
    ds_read_b64_tr_b16 v[120:121], v80 offset:6144
    ds_read_b64_tr_b16 v[122:123], v80 offset:7168
    v_mfma_f32_32x32x16_bf16 v[32:47], v[108:111], v[164:167], v[32:47]
    ds_read_b64_tr_b16 v[124:125], v81 offset:6144
    ds_read_b64_tr_b16 v[126:127], v81 offset:7168
    v_add_u32 v82, s19, v72
    v_add_u32 v83, s19, v73
    s_waitcnt vmcnt(5) lgkmcnt(4)
    v_mfma_f32_32x32x16_bf16 v[16:31], v[112:115], v[168:171], v[16:31]
    ds_read_b64_tr_b16 v[104:105], v82 offset:0
    ds_read_b64_tr_b16 v[106:107], v82 offset:1024
    v_mfma_f32_32x32x16_bf16 v[32:47], v[116:119], v[168:171], v[32:47]
    ds_read_b64_tr_b16 v[108:109], v83 offset:0
    ds_read_b64_tr_b16 v[110:111], v83 offset:1024
    s_waitcnt vmcnt(4) lgkmcnt(4)
    v_mfma_f32_32x32x16_bf16 v[16:31], v[120:123], v[172:175], v[16:31]
    ds_read_b64_tr_b16 v[112:113], v82 offset:2048
    ds_read_b64_tr_b16 v[114:115], v82 offset:3072
    v_mfma_f32_32x32x16_bf16 v[32:47], v[124:127], v[172:175], v[32:47]
    ds_read_b64_tr_b16 v[116:117], v83 offset:2048
    ds_read_b64_tr_b16 v[118:119], v83 offset:3072
    s_waitcnt vmcnt(3) lgkmcnt(4)
    v_mfma_f32_32x32x16_bf16 v[16:31], v[104:107], v[176:179], v[16:31]
    ds_read_b64_tr_b16 v[120:121], v82 offset:4096
    ds_read_b64_tr_b16 v[122:123], v82 offset:5120
    v_mfma_f32_32x32x16_bf16 v[32:47], v[108:111], v[176:179], v[32:47]
    ds_read_b64_tr_b16 v[124:125], v83 offset:4096
    ds_read_b64_tr_b16 v[126:127], v83 offset:5120
    s_waitcnt vmcnt(2) lgkmcnt(4)
    v_mfma_f32_32x32x16_bf16 v[16:31], v[112:115], v[180:183], v[16:31]
    ds_read_b64_tr_b16 v[104:105], v82 offset:6144
    ds_read_b64_tr_b16 v[106:107], v82 offset:7168
    v_mfma_f32_32x32x16_bf16 v[32:47], v[116:119], v[180:183], v[32:47]
    ds_read_b64_tr_b16 v[108:109], v83 offset:6144
    ds_read_b64_tr_b16 v[110:111], v83 offset:7168
    s_waitcnt vmcnt(1) lgkmcnt(4)
    v_mfma_f32_32x32x16_bf16 v[16:31], v[120:123], v[184:187], v[16:31]
    v_mfma_f32_32x32x16_bf16 v[32:47], v[124:127], v[184:187], v[32:47]
    s_waitcnt vmcnt(0) lgkmcnt(0)
    v_mfma_f32_32x32x16_bf16 v[16:31], v[104:107], v[188:191], v[16:31]
    v_mfma_f32_32x32x16_bf16 v[32:47], v[108:111], v[188:191], v[32:47]
    s_nop 10
    v_cvt_pk_bf16_f32 v88, v16, v17
    v_cvt_pk_bf16_f32 v89, v18, v19
    v_cvt_pk_bf16_f32 v90, v20, v21
    v_cvt_pk_bf16_f32 v91, v22, v23
    v_cvt_pk_bf16_f32 v92, v24, v25
    v_cvt_pk_bf16_f32 v93, v26, v27
    v_cvt_pk_bf16_f32 v94, v28, v29
    v_cvt_pk_bf16_f32 v95, v30, v31
    v_cvt_pk_bf16_f32 v96, v32, v33
    v_cvt_pk_bf16_f32 v97, v34, v35
    v_cvt_pk_bf16_f32 v98, v36, v37
    v_cvt_pk_bf16_f32 v99, v38, v39
    v_cvt_pk_bf16_f32 v100, v40, v41
    v_cvt_pk_bf16_f32 v101, v42, v43
    v_cvt_pk_bf16_f32 v102, v44, v45
    v_cvt_pk_bf16_f32 v103, v46, v47
    v_dot2_f32_bf16 v104, v88, s89, 0
    v_dot2_f32_bf16 v105, v88, v88, 0
    v_dot2_f32_bf16 v106, v88, v192, 0
    v_dot2_f32_bf16 v104, v89, s89, v104
    v_dot2_f32_bf16 v105, v89, v89, v105
    v_dot2_f32_bf16 v106, v89, v193, v106
    v_dot2_f32_bf16 v104, v90, s89, v104
    v_dot2_f32_bf16 v105, v90, v90, v105
    v_dot2_f32_bf16 v106, v90, v194, v106
    v_dot2_f32_bf16 v104, v91, s89, v104
    v_dot2_f32_bf16 v105, v91, v91, v105
    v_dot2_f32_bf16 v106, v91, v195, v106
    v_dot2_f32_bf16 v104, v92, s89, v104
    v_dot2_f32_bf16 v105, v92, v92, v105
    v_dot2_f32_bf16 v106, v92, v196, v106
    v_dot2_f32_bf16 v104, v93, s89, v104
    v_dot2_f32_bf16 v105, v93, v93, v105
    v_dot2_f32_bf16 v106, v93, v197, v106
    v_dot2_f32_bf16 v104, v94, s89, v104
    v_dot2_f32_bf16 v105, v94, v94, v105
    v_dot2_f32_bf16 v106, v94, v198, v106
    v_dot2_f32_bf16 v104, v95, s89, v104
    v_dot2_f32_bf16 v105, v95, v95, v105
    v_dot2_f32_bf16 v106, v95, v199, v106
    v_dot2_f32_bf16 v104, v96, s89, v104
    v_dot2_f32_bf16 v105, v96, v96, v105
    v_dot2_f32_bf16 v106, v96, v200, v106
    v_dot2_f32_bf16 v104, v97, s89, v104
    v_dot2_f32_bf16 v105, v97, v97, v105
    v_dot2_f32_bf16 v106, v97, v201, v106
    v_dot2_f32_bf16 v104, v98, s89, v104
    v_dot2_f32_bf16 v105, v98, v98, v105
    v_dot2_f32_bf16 v106, v98, v202, v106
    v_dot2_f32_bf16 v104, v99, s89, v104
    v_dot2_f32_bf16 v105, v99, v99, v105
    v_dot2_f32_bf16 v106, v99, v203, v106
    v_dot2_f32_bf16 v104, v100, s89, v104
    v_dot2_f32_bf16 v105, v100, v100, v105
    v_dot2_f32_bf16 v106, v100, v204, v106
    v_dot2_f32_bf16 v104, v101, s89, v104
    v_dot2_f32_bf16 v105, v101, v101, v105
    v_dot2_f32_bf16 v106, v101, v205, v106
    v_dot2_f32_bf16 v104, v102, s89, v104
    v_dot2_f32_bf16 v105, v102, v102, v105
    v_dot2_f32_bf16 v106, v102, v206, v106
    v_dot2_f32_bf16 v104, v103, s89, v104
    v_dot2_f32_bf16 v105, v103, v103, v105
    v_dot2_f32_bf16 v106, v103, v207, v106
    s_lshl_b32 s76, s62, 9
    s_add_u32 s77, s76, s99
    v_mov_b32 v107, 0
    v_mov_b32 v4, v104
    v_mov_b32 v5, v105
    v_mov_b32 v6, v106
    v_permlane32_swap_b32 v104, v4
    v_permlane32_swap_b32 v105, v5
    v_permlane32_swap_b32 v106, v6
    v_add_f32 v104, v104, v4
    v_add_f32 v105, v105, v5
    v_add_f32_e64 v106, v106, v6
    s_mov_b32 exec_hi, 0
    s_bitcmp1_b32 s100, 1
    s_cbranch_scc1 L_loc_68
    buffer_store_dwordx4 v[104:107], v12, s[40:43], s77 offen offset:1024 sc1
    s_branch L_pubd_69
L_loc_68:
    buffer_store_dwordx4 v[104:107], v12, s[40:43], s77 offen offset:1024
L_pubd_69:
    s_mov_b64 exec, -1
    ds_write_b64 v64, v[88:89]
    ds_write_b64 v65, v[90:91]
    ds_write_b64 v66, v[92:93]
    ds_write_b64 v67, v[94:95]
    ds_write_b64 v68, v[96:97]
    ds_write_b64 v69, v[98:99]
    ds_write_b64 v70, v[100:101]
    ds_write_b64 v71, v[102:103]
    v_bfe_u32 v4, v1, 1, 3
    v_bfe_u32 v5, v1, 4, 1
    v_lshlrev_b32_e64 v176, 4, v4
    v_lshl_add_u32 v176, v5, 3, v176
    v_and_b32_e64 v5, 1, v1
    v_lshl_add_u32 v176, v5, 2, v176
    v_lshlrev_b32_e64 v177, 2, v2
    v_lshl_add_u32 v177, v3, 8, v177
    v_and_b32 v4, 15, v1
    v_lshrrev_b32 v5, 4, v1
    v_mul_u32_u24 v179, 149504, v4
    v_lshl_add_u32 v180, v5, 4, v179
    s_lshl_b32 s82, s97, 7
    s_lshl_b32 s79, s62, 5
    s_add_u32 s82, s82, s79
    s_lshl_b32 s79, s62, 2
    v_mov_b32_e64 v7, s79
    v_mul_u32_u24 v178, 9344, v3
    v_lshl_add_u32 v178, v2, 4, v178
    s_mul_i32 s78, s97, 149504
    s_add_u32 s78, s78, s76
    s_add_u32 s78, s78, 8388608
    s_add_u32 s48, s78, 18688
    s_add_u32 s49, s48, 18688
    s_add_u32 s50, s49, 18688
    s_add_u32 s51, s50, 18688
    s_add_u32 s52, s51, 18688
    s_add_u32 s53, s52, 18688
    s_add_u32 s54, s53, 18688
    buffer_load_dwordx4 v[112:115], v178, s[40:43], s78 offen offset:1024 sc1
    buffer_load_dwordx4 v[116:119], v178, s[40:43], s48 offen offset:1024 sc1
    buffer_load_dwordx4 v[120:123], v178, s[40:43], s49 offen offset:1024 sc1
    buffer_load_dwordx4 v[124:127], v178, s[40:43], s50 offen offset:1024 sc1
    buffer_load_dwordx4 v[128:131], v178, s[40:43], s51 offen offset:1024 sc1
    buffer_load_dwordx4 v[132:135], v178, s[40:43], s52 offen offset:1024 sc1
    buffer_load_dwordx4 v[136:139], v178, s[40:43], s53 offen offset:1024 sc1
    buffer_load_dwordx4 v[140:143], v178, s[40:43], s54 offen offset:1024 sc1
    v_dot2_f32_bf16 v76, v208, s89, 0
    v_dot2_f32_bf16 v76, v209, s89, v76
    v_dot2_f32_bf16 v76, v210, s89, v76
    v_dot2_f32_bf16 v76, v211, s89, v76
    v_dot2_f32_bf16 v76, v212, s89, v76
    v_dot2_f32_bf16 v76, v213, s89, v76
    v_dot2_f32_bf16 v76, v214, s89, v76
    v_dot2_f32_bf16 v76, v215, s89, v76
    s_nop 2
    v_add_f32_dpp v76, v76, v76 row_ror:8 row_mask:0xf bank_mask:0xf
    s_nop 1
    v_add_f32_dpp v76, v76, v76 row_ror:4 row_mask:0xf bank_mask:0xf
    s_nop 1
    v_add_f32_dpp v76, v76, v76 row_ror:2 row_mask:0xf bank_mask:0xf
    s_nop 1
    v_add_f32_dpp v76, v76, v76 row_ror:1 row_mask:0xf bank_mask:0xf
    v_mov_b32 v4, v76
    s_nop 1
    v_permlane16_swap_b32 v76, v4
    v_add_f32 v76, v76, v4
    v_mov_b32 v4, v76
    s_nop 1
    v_permlane32_swap_b32 v76, v4
    v_add_f32_e64 v76, v76, v4
    s_mov_b32 s88, 0
    s_waitcnt vmcnt(6)
    v_pk_add_f32 v[108:109], v[112:113], v[116:117]
    v_pk_add_f32 v[110:111], v[114:115], v[118:119]
    s_waitcnt vmcnt(5)
    v_pk_add_f32 v[108:109], v[108:109], v[120:121]
    v_pk_add_f32 v[110:111], v[110:111], v[122:123]
    s_waitcnt vmcnt(4)
    v_pk_add_f32 v[108:109], v[108:109], v[124:125]
    v_pk_add_f32 v[110:111], v[110:111], v[126:127]
    s_waitcnt vmcnt(3)
    v_pk_add_f32 v[108:109], v[108:109], v[128:129]
    v_pk_add_f32 v[110:111], v[110:111], v[130:131]
    s_waitcnt vmcnt(2)
    v_pk_add_f32 v[108:109], v[108:109], v[132:133]
    v_pk_add_f32 v[110:111], v[110:111], v[134:135]
    s_waitcnt vmcnt(1)
    v_pk_add_f32 v[108:109], v[108:109], v[136:137]
    v_pk_add_f32 v[110:111], v[110:111], v[138:139]
    s_waitcnt vmcnt(0)
    v_pk_add_f32 v[108:109], v[108:109], v[140:141]
    v_pk_add_f32 v[110:111], v[110:111], v[142:143]
    v_cmp_u_f32 vcc, v111, v111
    v_mov_b32 v4, v108
    v_mov_b32 v5, v109
    v_mov_b32 v6, v110
    s_cbranch_vccnz L_s3_71
L_s3ok_72:
    v_permlane32_swap_b32 v108, v4
    v_permlane32_swap_b32 v109, v5
    v_permlane32_swap_b32 v110, v6
    s_barrier
    v_add_f32 v108, v108, v4
    v_add_f32 v109, v109, v5
    v_add_f32 v110, v110, v6
    v_mul_f32 v108, 0x3a800000, v108
    v_mul_f32 v109, 0x3a800000, v109
    v_fma_f32 v4, -v108, v108, v109
    v_max_f32_e64 v4, 0, v4
    v_cvt_pk_bf16_f32 v116, v108, v108
    v_and_b32_e64 v116, s90, v116
    v_cvt_pk_bf16_f32 v4, v4, v4
    v_and_b32_e64 v4, s90, v4
    v_add_f32 v4, 0x3727c5ac, v4
    v_cvt_pk_bf16_f32 v4, v4, v4
    v_and_b32 v4, s90, v4
    v_sqrt_f32_e64 v4, v4
    s_nop 0
    v_cvt_pk_bf16_f32 v4, v4, v4
    v_and_b32 v4, s90, v4
    v_rcp_f32 v118, v4
    v_fma_f32 v120, -v116, v76, v110
    v_mul_f32 v119, v116, v118
    v_mul_f32 v120, v120, v118
    v_and_b32 v6, 3, v1
    v_lshlrev_b32 v6, 2, v6
    v_max_f32_dpp v4, v120, v120 row_ror:8 row_mask:0xf bank_mask:0xf
    s_lshl_b32 s83, s62, 12
    v_cmp_gt_u32 s[84:85], 32, v1
    v_max_f32_dpp v4, v4, v4 row_ror:4 row_mask:0xf bank_mask:0xf
    s_lshl_b32 s55, 1, s62
    s_sub_u32 s55, s55, 1
    v_max_f32_dpp v4, v4, v4 row_ror:2 row_mask:0xf bank_mask:0xf
    s_nop 1
    v_max_f32_dpp v4, v4, v4 row_ror:1 row_mask:0xf bank_mask:0xf
    v_mov_b32 v5, v4
    s_nop 1
    v_permlane16_swap_b32 v4, v5
    v_max_f32 v4, v4, v5
    v_cmp_eq_f32_e64 vcc, v4, v120
    ds_write_b32 v7, v4 offset:25600
    s_ff1_i32_b32 s77, vcc_lo
    s_and_b32 s77, s77, 31
    s_bfe_u32 s79, s77, 0x30001
    s_lshl3_add_u32 s79, s77, s79
    s_lshl4_add_u32 s79, s79, s83
    v_xor_b32_e64 v176, s79, v176
    ds_read_b32 v182, v176 offset:0
    s_waitcnt lgkmcnt(1)
    s_barrier
    ds_read_b32 v8, v6 offset:25600
    v_readlane_b32 s80, v118, s77
    v_readlane_b32 s81, v119, s77
    s_add_u32 s79, s82, s77
    v_writelane_b32 v4, s79, 33
    v_mov_b32 v5, s81
    s_waitcnt lgkmcnt(1)
    v_lshlrev_b32 v184, 16, v182
    v_and_b32_e64 v185, s90, v182
    v_fma_f32 v184, v184, s80, -v5
    v_fma_f32 v185, v185, s80, -v5
    v_cvt_pk_bf16_f32 v184, v184, v185
    v_cndmask_b32 v184, v4, v184, s[84:85]
    s_waitcnt lgkmcnt(0)
    v_cmp_eq_f32 s[56:57], v8, v4
    v_cmp_gt_f32 vcc, v8, v4
    s_and_b32 s56, s56, s55
    s_or_b32 s56, s56, vcc_lo
    s_cbranch_scc1 L_nopub_81
    buffer_store_dword v184, v177, s[40:43], s99 offen offset:0 sc1
L_nopub_81:
    v_lshlrev_b32 v16, 16, v88
    v_and_b32_e64 v17, s90, v88
    v_pk_fma_f32 v[144:145], v[16:17], v[118:119], v[118:119] op_sel:[0,0,1] op_sel_hi:[1,0,1] neg_lo:[0,0,1] neg_hi:[0,0,1]
    v_cvt_pk_bf16_f32 v124, v144, v145
    v_lshlrev_b32 v144, 16, v124
    v_and_b32 v145, s90, v124
    v_pk_add_f32 v[144:145], v[144:145], v[16:17]
    v_cvt_pk_bf16_f32 v124, v144, v145
    v_lshlrev_b32 v18, 16, v89
    v_and_b32 v19, s90, v89
    v_pk_fma_f32 v[146:147], v[18:19], v[118:119], v[118:119] op_sel:[0,0,1] op_sel_hi:[1,0,1] neg_lo:[0,0,1] neg_hi:[0,0,1]
    v_cvt_pk_bf16_f32 v125, v146, v147
    v_lshlrev_b32 v146, 16, v125
    v_and_b32 v147, s90, v125
    v_pk_add_f32 v[146:147], v[146:147], v[18:19]
    v_cvt_pk_bf16_f32 v125, v146, v147
    ds_write_b64 v64, v[124:125]
    v_lshlrev_b32 v20, 16, v90
    v_and_b32 v21, s90, v90
    v_pk_fma_f32 v[148:149], v[20:21], v[118:119], v[118:119] op_sel:[0,0,1] op_sel_hi:[1,0,1] neg_lo:[0,0,1] neg_hi:[0,0,1]
    v_cvt_pk_bf16_f32 v126, v148, v149
    v_lshlrev_b32 v148, 16, v126
    v_and_b32 v149, s90, v126
    v_pk_add_f32 v[148:149], v[148:149], v[20:21]
    v_cvt_pk_bf16_f32 v126, v148, v149
    v_lshlrev_b32 v22, 16, v91
    v_and_b32 v23, s90, v91
    v_pk_fma_f32 v[150:151], v[22:23], v[118:119], v[118:119] op_sel:[0,0,1] op_sel_hi:[1,0,1] neg_lo:[0,0,1] neg_hi:[0,0,1]
    v_cvt_pk_bf16_f32 v127, v150, v151
    v_lshlrev_b32 v150, 16, v127
    v_and_b32 v151, s90, v127
    v_pk_add_f32 v[150:151], v[150:151], v[22:23]
    v_cvt_pk_bf16_f32 v127, v150, v151
    ds_write_b64 v65, v[126:127]
    s_cmp_eq_u32 s56, 0
    s_cbranch_scc1 L_stay_82
    s_cmp_gt_u32 s62, 1
    s_cbranch_scc0 L_stay_82
    s_mov_b32 s91, -1
    v_lshlrev_b32 v24, 16, v92
    v_and_b32_e64 v25, s90, v92
    v_pk_fma_f32 v[152:153], v[24:25], v[118:119], v[118:119] op_sel:[0,0,1] op_sel_hi:[1,0,1] neg_lo:[0,0,1] neg_hi:[0,0,1]
    v_cvt_pk_bf16_f32 v128, v152, v153
    v_lshlrev_b32 v152, 16, v128
    v_and_b32 v153, s90, v128
    v_pk_add_f32 v[152:153], v[152:153], v[24:25]
    v_cvt_pk_bf16_f32 v128, v152, v153
    v_lshlrev_b32 v26, 16, v93
    v_and_b32 v27, s90, v93
    v_pk_fma_f32 v[154:155], v[26:27], v[118:119], v[118:119] op_sel:[0,0,1] op_sel_hi:[1,0,1] neg_lo:[0,0,1] neg_hi:[0,0,1]
    v_cvt_pk_bf16_f32 v129, v154, v155
    v_lshlrev_b32 v154, 16, v129
    v_and_b32 v155, s90, v129
    v_pk_add_f32 v[154:155], v[154:155], v[26:27]
    v_cvt_pk_bf16_f32 v129, v154, v155
    ds_write_b64 v66, v[128:129]
    v_lshlrev_b32 v28, 16, v94
    v_and_b32 v29, s90, v94
    v_pk_fma_f32 v[156:157], v[28:29], v[118:119], v[118:119] op_sel:[0,0,1] op_sel_hi:[1,0,1] neg_lo:[0,0,1] neg_hi:[0,0,1]
    v_cvt_pk_bf16_f32 v130, v156, v157
    v_lshlrev_b32 v156, 16, v130
    v_and_b32 v157, s90, v130
    v_pk_add_f32 v[156:157], v[156:157], v[28:29]
    v_cvt_pk_bf16_f32 v130, v156, v157
    v_lshlrev_b32 v30, 16, v95
    v_and_b32 v31, s90, v95
    v_pk_fma_f32 v[158:159], v[30:31], v[118:119], v[118:119] op_sel:[0,0,1] op_sel_hi:[1,0,1] neg_lo:[0,0,1] neg_hi:[0,0,1]
    v_cvt_pk_bf16_f32 v131, v158, v159
    v_lshlrev_b32 v158, 16, v131
    v_and_b32 v159, s90, v131
    v_pk_add_f32 v[158:159], v[158:159], v[30:31]
    v_cvt_pk_bf16_f32 v131, v158, v159
    ds_write_b64 v67, v[130:131]
    v_lshlrev_b32 v32, 16, v96
    v_and_b32 v33, s90, v96
    v_pk_fma_f32 v[160:161], v[32:33], v[118:119], v[118:119] op_sel:[0,0,1] op_sel_hi:[1,0,1] neg_lo:[0,0,1] neg_hi:[0,0,1]
    v_cvt_pk_bf16_f32 v132, v160, v161
    v_lshlrev_b32 v160, 16, v132
    v_and_b32 v161, s90, v132
    v_pk_add_f32 v[160:161], v[160:161], v[32:33]
    v_cvt_pk_bf16_f32 v132, v160, v161
    v_lshlrev_b32 v34, 16, v97
    v_and_b32 v35, s90, v97
    v_pk_fma_f32 v[162:163], v[34:35], v[118:119], v[118:119] op_sel:[0,0,1] op_sel_hi:[1,0,1] neg_lo:[0,0,1] neg_hi:[0,0,1]
    v_cvt_pk_bf16_f32 v133, v162, v163
    v_lshlrev_b32 v162, 16, v133
    v_and_b32 v163, s90, v133
    v_pk_add_f32 v[162:163], v[162:163], v[34:35]
    v_cvt_pk_bf16_f32 v133, v162, v163
    ds_write_b64 v68, v[132:133]
    v_lshlrev_b32 v36, 16, v98
    v_and_b32 v37, s90, v98
    v_pk_fma_f32 v[164:165], v[36:37], v[118:119], v[118:119] op_sel:[0,0,1] op_sel_hi:[1,0,1] neg_lo:[0,0,1] neg_hi:[0,0,1]
    v_cvt_pk_bf16_f32 v134, v164, v165
    v_lshlrev_b32 v164, 16, v134
    v_and_b32 v165, s90, v134
    v_pk_add_f32 v[164:165], v[164:165], v[36:37]
    v_cvt_pk_bf16_f32 v134, v164, v165
    v_lshlrev_b32 v38, 16, v99
    v_and_b32 v39, s90, v99
    v_pk_fma_f32 v[166:167], v[38:39], v[118:119], v[118:119] op_sel:[0,0,1] op_sel_hi:[1,0,1] neg_lo:[0,0,1] neg_hi:[0,0,1]
    v_cvt_pk_bf16_f32 v135, v166, v167
    v_lshlrev_b32 v166, 16, v135
    v_and_b32 v167, s90, v135
    v_pk_add_f32 v[166:167], v[166:167], v[38:39]
    v_cvt_pk_bf16_f32 v135, v166, v167
    ds_write_b64 v69, v[134:135]
    v_lshlrev_b32 v40, 16, v100
    v_and_b32 v41, s90, v100
    v_pk_fma_f32 v[168:169], v[40:41], v[118:119], v[118:119] op_sel:[0,0,1] op_sel_hi:[1,0,1] neg_lo:[0,0,1] neg_hi:[0,0,1]
    v_cvt_pk_bf16_f32 v136, v168, v169
    v_lshlrev_b32 v168, 16, v136
    v_and_b32 v169, s90, v136
    v_pk_add_f32 v[168:169], v[168:169], v[40:41]
    v_cvt_pk_bf16_f32 v136, v168, v169
    v_lshlrev_b32 v42, 16, v101
    v_and_b32 v43, s90, v101
    v_pk_fma_f32 v[170:171], v[42:43], v[118:119], v[118:119] op_sel:[0,0,1] op_sel_hi:[1,0,1] neg_lo:[0,0,1] neg_hi:[0,0,1]
    v_cvt_pk_bf16_f32 v137, v170, v171
    v_lshlrev_b32 v170, 16, v137
    v_and_b32 v171, s90, v137
    v_pk_add_f32 v[170:171], v[170:171], v[42:43]
    v_cvt_pk_bf16_f32 v137, v170, v171
    ds_write_b64 v70, v[136:137]
    v_lshlrev_b32 v44, 16, v102
    v_and_b32 v45, s90, v102
    v_pk_fma_f32 v[172:173], v[44:45], v[118:119], v[118:119] op_sel:[0,0,1] op_sel_hi:[1,0,1] neg_lo:[0,0,1] neg_hi:[0,0,1]
    v_cvt_pk_bf16_f32 v138, v172, v173
    v_lshlrev_b32 v172, 16, v138
    v_and_b32 v173, s90, v138
    v_pk_add_f32 v[172:173], v[172:173], v[44:45]
    v_cvt_pk_bf16_f32 v138, v172, v173
    v_lshlrev_b32 v46, 16, v103
    v_and_b32 v47, s90, v103
    v_pk_fma_f32 v[174:175], v[46:47], v[118:119], v[118:119] op_sel:[0,0,1] op_sel_hi:[1,0,1] neg_lo:[0,0,1] neg_hi:[0,0,1]
    v_cvt_pk_bf16_f32 v139, v174, v175
    v_lshlrev_b32 v174, 16, v139
    v_and_b32 v175, s90, v139
    v_pk_add_f32 v[174:175], v[174:175], v[46:47]
    v_cvt_pk_bf16_f32 v139, v174, v175
    ds_write_b64 v71, v[138:139]
    s_sub_u32 s77, s91, s82
    v_lshrrev_b32 v7, 3, v1
    v_sub_u32_e64 v5, s77, v7
    v_mov_b32 v6, 2146435072
    v_and_b32 v8, 7, v1
    v_lshrrev_b32 v9, 4, v1
    v_xor_b32 v8, v8, v9
    v_lshlrev_b32 v8, 4, v8
    v_lshl_add_u32 v7, v7, 11, v8
    v_xor_b32 v8, 64, v7
    s_lshl_b32 s58, s82, 11
    s_lshl_b32 s59, s98, 7
    s_add_u32 s58, s58, s59
    v_cmp_eq_u32 vcc, 0, v5
    s_nop 1
    v_cndmask_b32 v200, v7, v6, vcc
    v_cmp_eq_u32 vcc, 8, v5
    s_nop 1
    v_cndmask_b32 v201, v8, v6, vcc
    v_cmp_eq_u32 vcc, 16, v5
    s_nop 1
    v_cndmask_b32 v202, v7, v6, vcc
    v_cmp_eq_u32 vcc, 24, v5
    s_nop 1
    v_cndmask_b32 v203, v8, v6, vcc
    s_lshl_b32 s77, s62, 12
    s_add_u32 s77, s77, 0
    v_add_u32 v4, s77, v12
    s_waitcnt lgkmcnt(0)
    ds_read_b128 v[48:51], v4 offset:0
    ds_read_b128 v[52:55], v4 offset:1024
    ds_read_b128 v[56:59], v4 offset:2048
    ds_read_b128 v[60:63], v4 offset:3072
    s_waitcnt lgkmcnt(3)
    buffer_store_dwordx4 v[48:51], v200, s[44:47], s58 offen sc1
    s_add_u32 s58, s58, 16384
    s_waitcnt lgkmcnt(2)
    buffer_store_dwordx4 v[52:55], v201, s[44:47], s58 offen sc1
    s_add_u32 s58, s58, 16384
    s_waitcnt lgkmcnt(1)
    buffer_store_dwordx4 v[56:59], v202, s[44:47], s58 offen sc1
    s_add_u32 s58, s58, 16384
    s_waitcnt lgkmcnt(0)
    buffer_store_dwordx4 v[60:63], v203, s[44:47], s58 offen sc1
    s_barrier
    s_barrier
    s_branch L_cdone
L_stay_82:
    v_and_b32 v7, 15, v1
    v_lshlrev_b32_e64 v7, 3, v7
    s_cmp_eq_u32 s62, 0
    s_cbranch_scc0 L_nos4_83
    s_mul_i32 s76, s98, 9344
    s_add_u32 s76, s76, 8388608
    s_add_u32 s20, s26, s99
    s_addc_u32 s21, s27, 0
    s_mov_b32 s88, 0
L_spin_84:
    s_load_dwordx16 s[4:19], s[20:21], 768 glc
    s_waitcnt lgkmcnt(0)
    s_or_b64 s[4:5], s[4:5], s[6:7]
    s_or_b64 s[4:5], s[4:5], s[8:9]
    s_or_b64 s[4:5], s[4:5], s[10:11]
    s_or_b64 s[4:5], s[4:5], s[12:13]
    s_or_b64 s[4:5], s[4:5], s[14:15]
    s_or_b64 s[4:5], s[4:5], s[16:17]
    s_or_b64 s[4:5], s[4:5], s[18:19]
    s_cbranch_scc0 L_gate_85
    s_add_u32 s88, s88, 1
    s_cmp_lt_u32 s88, 65536
    s_cbranch_scc1 L_spin_84
L_gate_85:
    s_mov_b32 s88, 0
L_poll_86:
    buffer_load_dwordx2 v[196:197], v179, s[40:43], s76 offen offset:256 sc1
    buffer_load_dwordx4 v[188:191], v180, s[40:43], s76 offen offset:0 sc1
    buffer_load_dwordx4 v[192:195], v180, s[40:43], s76 offen offset:64 sc1
    s_waitcnt vmcnt(0)
    v_max3_u32 v4, v196, v197, v188
    v_max3_u32 v4, v4, v189, v190
    v_max3_u32 v4, v4, v191, v192
    v_max3_u32 v4, v4, v193, v194
    v_max_u32 v4, v4, v195
    v_cmp_eq_u32_e64 vcc, -1, v4
    s_nop 0
    s_cbranch_vccz L_ok_87
    s_add_u32 s88, s88, 1
    s_cmp_lt_u32 s88, 65536
    s_cbranch_scc1 L_poll_86
L_ok_87:
    ds_write_b128 v12, v[188:191] offset:28672
    ds_write_b128 v12, v[192:195] offset:29696
    ds_write_b64 v7, v[196:197] offset:25728
L_nos4_83:
    s_waitcnt lgkmcnt(0)
    s_barrier
    ds_read_b64 v[8:9], v7 offset:25728
    s_waitcnt lgkmcnt(0)
    v_max_f32_dpp v4, v8, v8 row_ror:8 row_mask:0xf bank_mask:0xf
    s_nop 1
    v_max_f32_dpp v4, v4, v4 row_ror:4 row_mask:0xf bank_mask:0xf
    s_nop 1
    v_max_f32_dpp v4, v4, v4 row_ror:2 row_mask:0xf bank_mask:0xf
    s_nop 1
    v_max_f32_dpp v4, v4, v4 row_ror:1 row_mask:0xf bank_mask:0xf
    v_cmp_eq_f32 vcc, v4, v8
    s_nop 0
    s_ff1_i32_b32 s92, vcc_lo
    s_and_b32 s92, s92, 15
    s_nop 3
    v_readlane_b32 s91, v9, s92
    s_nop 0
    s_cmp_eq_u32 s91, s79
    s_cbranch_scc0 L_noh_88
    s_mov_b32 exec_hi, 0
    buffer_store_dword v182, v177, s[40:43], s99 offen offset:128 sc1
    s_mov_b64 exec, -1
L_noh_88:
    s_sub_u32 s77, s91, s82
    v_lshrrev_b32 v7, 3, v1
    v_sub_u32 v5, s77, v7
    v_mov_b32 v6, 2146435072
    v_and_b32 v8, 7, v1
    v_lshrrev_b32 v9, 4, v1
    v_xor_b32 v8, v8, v9
    v_lshlrev_b32 v8, 4, v8
    v_lshl_add_u32 v7, v7, 11, v8
    v_xor_b32 v8, 64, v7
    s_lshl_b32 s58, s82, 11
    s_lshl_b32 s59, s98, 7
    s_add_u32 s58, s58, s59
    v_cmp_eq_u32 vcc, 0, v5
    s_nop 1
    v_cndmask_b32 v200, v7, v6, vcc
    v_cmp_eq_u32 vcc, 8, v5
    s_nop 1
    v_cndmask_b32 v201, v8, v6, vcc
    v_cmp_eq_u32 vcc, 16, v5
    s_nop 1
    v_cndmask_b32 v202, v7, v6, vcc
    v_cmp_eq_u32 vcc, 24, v5
    s_nop 1
    v_cndmask_b32 v203, v8, v6, vcc
    s_lshl_b32 s77, s62, 12
    s_add_u32 s77, s77, 0
    v_add_u32 v4, s77, v12
    v_lshlrev_b32 v24, 16, v92
    v_and_b32_e64 v25, s90, v92
    v_pk_fma_f32 v[152:153], v[24:25], v[118:119], v[118:119] op_sel:[0,0,1] op_sel_hi:[1,0,1] neg_lo:[0,0,1] neg_hi:[0,0,1]
    v_cvt_pk_bf16_f32 v128, v152, v153
    v_lshlrev_b32 v152, 16, v128
    v_and_b32 v153, s90, v128
    v_pk_add_f32 v[152:153], v[152:153], v[24:25]
    v_cvt_pk_bf16_f32 v128, v152, v153
    v_lshlrev_b32 v26, 16, v93
    v_and_b32 v27, s90, v93
    v_pk_fma_f32 v[154:155], v[26:27], v[118:119], v[118:119] op_sel:[0,0,1] op_sel_hi:[1,0,1] neg_lo:[0,0,1] neg_hi:[0,0,1]
    v_cvt_pk_bf16_f32 v129, v154, v155
    v_lshlrev_b32 v154, 16, v129
    v_and_b32 v155, s90, v129
    v_pk_add_f32 v[154:155], v[154:155], v[26:27]
    v_cvt_pk_bf16_f32 v129, v154, v155
    ds_write_b64 v66, v[128:129]
    v_lshlrev_b32 v28, 16, v94
    v_and_b32 v29, s90, v94
    v_pk_fma_f32 v[156:157], v[28:29], v[118:119], v[118:119] op_sel:[0,0,1] op_sel_hi:[1,0,1] neg_lo:[0,0,1] neg_hi:[0,0,1]
    v_cvt_pk_bf16_f32 v130, v156, v157
    v_lshlrev_b32 v156, 16, v130
    v_and_b32 v157, s90, v130
    v_pk_add_f32 v[156:157], v[156:157], v[28:29]
    v_cvt_pk_bf16_f32 v130, v156, v157
    v_lshlrev_b32 v30, 16, v95
    v_and_b32 v31, s90, v95
    v_pk_fma_f32 v[158:159], v[30:31], v[118:119], v[118:119] op_sel:[0,0,1] op_sel_hi:[1,0,1] neg_lo:[0,0,1] neg_hi:[0,0,1]
    v_cvt_pk_bf16_f32 v131, v158, v159
    v_lshlrev_b32 v158, 16, v131
    v_and_b32 v159, s90, v131
    v_pk_add_f32 v[158:159], v[158:159], v[30:31]
    v_cvt_pk_bf16_f32 v131, v158, v159
    ds_write_b64 v67, v[130:131]
    v_lshlrev_b32 v32, 16, v96
    v_and_b32 v33, s90, v96
    v_pk_fma_f32 v[160:161], v[32:33], v[118:119], v[118:119] op_sel:[0,0,1] op_sel_hi:[1,0,1] neg_lo:[0,0,1] neg_hi:[0,0,1]
    v_cvt_pk_bf16_f32 v132, v160, v161
    v_lshlrev_b32 v160, 16, v132
    v_and_b32 v161, s90, v132
    v_pk_add_f32 v[160:161], v[160:161], v[32:33]
    v_cvt_pk_bf16_f32 v132, v160, v161
    v_lshlrev_b32 v34, 16, v97
    v_and_b32 v35, s90, v97
    v_pk_fma_f32 v[162:163], v[34:35], v[118:119], v[118:119] op_sel:[0,0,1] op_sel_hi:[1,0,1] neg_lo:[0,0,1] neg_hi:[0,0,1]
    v_cvt_pk_bf16_f32 v133, v162, v163
    v_lshlrev_b32 v162, 16, v133
    v_and_b32 v163, s90, v133
    v_pk_add_f32 v[162:163], v[162:163], v[34:35]
    v_cvt_pk_bf16_f32 v133, v162, v163
    ds_write_b64 v68, v[132:133]
    v_lshlrev_b32 v36, 16, v98
    v_and_b32 v37, s90, v98
    v_pk_fma_f32 v[164:165], v[36:37], v[118:119], v[118:119] op_sel:[0,0,1] op_sel_hi:[1,0,1] neg_lo:[0,0,1] neg_hi:[0,0,1]
    v_cvt_pk_bf16_f32 v134, v164, v165
    v_lshlrev_b32 v164, 16, v134
    v_and_b32 v165, s90, v134
    v_pk_add_f32 v[164:165], v[164:165], v[36:37]
    v_cvt_pk_bf16_f32 v134, v164, v165
    v_lshlrev_b32 v38, 16, v99
    v_and_b32 v39, s90, v99
    v_pk_fma_f32 v[166:167], v[38:39], v[118:119], v[118:119] op_sel:[0,0,1] op_sel_hi:[1,0,1] neg_lo:[0,0,1] neg_hi:[0,0,1]
    v_cvt_pk_bf16_f32 v135, v166, v167
    v_lshlrev_b32 v166, 16, v135
    v_and_b32 v167, s90, v135
    v_pk_add_f32 v[166:167], v[166:167], v[38:39]
    v_cvt_pk_bf16_f32 v135, v166, v167
    ds_write_b64 v69, v[134:135]
    v_lshlrev_b32 v40, 16, v100
    v_and_b32 v41, s90, v100
    v_pk_fma_f32 v[168:169], v[40:41], v[118:119], v[118:119] op_sel:[0,0,1] op_sel_hi:[1,0,1] neg_lo:[0,0,1] neg_hi:[0,0,1]
    v_cvt_pk_bf16_f32 v136, v168, v169
    v_lshlrev_b32 v168, 16, v136
    v_and_b32 v169, s90, v136
    v_pk_add_f32 v[168:169], v[168:169], v[40:41]
    v_cvt_pk_bf16_f32 v136, v168, v169
    v_lshlrev_b32 v42, 16, v101
    v_and_b32 v43, s90, v101
    v_pk_fma_f32 v[170:171], v[42:43], v[118:119], v[118:119] op_sel:[0,0,1] op_sel_hi:[1,0,1] neg_lo:[0,0,1] neg_hi:[0,0,1]
    v_cvt_pk_bf16_f32 v137, v170, v171
    v_lshlrev_b32 v170, 16, v137
    v_and_b32 v171, s90, v137
    v_pk_add_f32 v[170:171], v[170:171], v[42:43]
    v_cvt_pk_bf16_f32 v137, v170, v171
    ds_write_b64 v70, v[136:137]
    v_lshlrev_b32 v44, 16, v102
    v_and_b32 v45, s90, v102
    v_pk_fma_f32 v[172:173], v[44:45], v[118:119], v[118:119] op_sel:[0,0,1] op_sel_hi:[1,0,1] neg_lo:[0,0,1] neg_hi:[0,0,1]
    v_cvt_pk_bf16_f32 v138, v172, v173
    v_lshlrev_b32 v172, 16, v138
    v_and_b32 v173, s90, v138
    v_pk_add_f32 v[172:173], v[172:173], v[44:45]
    v_cvt_pk_bf16_f32 v138, v172, v173
    v_lshlrev_b32 v46, 16, v103
    v_and_b32 v47, s90, v103
    v_pk_fma_f32 v[174:175], v[46:47], v[118:119], v[118:119] op_sel:[0,0,1] op_sel_hi:[1,0,1] neg_lo:[0,0,1] neg_hi:[0,0,1]
    v_cvt_pk_bf16_f32 v139, v174, v175
    v_lshlrev_b32 v174, 16, v139
    v_and_b32 v175, s90, v139
    v_pk_add_f32 v[174:175], v[174:175], v[46:47]
    v_cvt_pk_bf16_f32 v139, v174, v175
    ds_write_b64 v71, v[138:139]
    s_barrier
    s_waitcnt lgkmcnt(0)
    ds_read_b128 v[48:51], v4 offset:0
    ds_read_b128 v[52:55], v4 offset:1024
    ds_read_b128 v[56:59], v4 offset:2048
    ds_read_b128 v[60:63], v4 offset:3072
    s_waitcnt lgkmcnt(3)
    buffer_store_dwordx4 v[48:51], v200, s[44:47], s58 offen sc1
    s_add_u32 s58, s58, 16384
    s_waitcnt lgkmcnt(2)
    buffer_store_dwordx4 v[52:55], v201, s[44:47], s58 offen sc1
    s_add_u32 s58, s58, 16384
    s_waitcnt lgkmcnt(1)
    buffer_store_dwordx4 v[56:59], v202, s[44:47], s58 offen sc1
    s_add_u32 s58, s58, 16384
    s_waitcnt lgkmcnt(0)
    buffer_store_dwordx4 v[60:63], v203, s[44:47], s58 offen sc1
L_cdone:
L_cfin:
L_end:
    s_endpgm
L_tr0:
    s_call_b64 s[54:55], L_stall
    s_branch L_bk0
L_tr1:
    s_call_b64 s[54:55], L_stall
    s_branch L_bk1
L_tr2:
    s_call_b64 s[54:55], L_stall
    s_branch L_bk2
L_tr3:
    s_call_b64 s[54:55], L_stall
    s_branch L_bk3
L_tr4:
    s_call_b64 s[54:55], L_stall
    s_branch L_bk4
L_tr5:
    s_call_b64 s[54:55], L_stall
    s_branch L_bk5
L_tr6:
    s_call_b64 s[54:55], L_stall
    s_branch L_bk6
L_tr7:
    s_call_b64 s[54:55], L_stall
    s_branch L_bk7
L_tr8:
    s_call_b64 s[54:55], L_stall
    s_branch L_bk8
L_tr9:
    s_call_b64 s[54:55], L_stall
    s_branch L_bk9
L_tr10:
    s_call_b64 s[54:55], L_stall
    s_branch L_bk10
L_tr11:
    s_call_b64 s[54:55], L_stall
    s_branch L_bk11
L_tr12:
    s_call_b64 s[54:55], L_stall
    s_branch L_bk12
L_tr13:
    s_call_b64 s[54:55], L_stall
    s_branch L_bk13
L_tr14:
    s_call_b64 s[54:55], L_stall
    s_branch L_bk14
L_tr15:
    s_call_b64 s[54:55], L_stall
    s_branch L_bk15
L_stall:
    s_cmp_eq_u32 s53, 0
    s_cbranch_scc0 L_sent_67
    s_waitcnt vmcnt(0)
    s_mov_b64 exec, 1
    ds_add_u32 v8, v74 offset:25988
    s_mov_b64 exec, -1
    s_mov_b32 s53, 1
L_sent_67:
    s_mov_b32 s88, 0
L_stall1:
    ds_read_b32 v79, v8 offset:25984
    s_waitcnt lgkmcnt(0)
    v_readfirstlane_b32 s76, v79
    s_nop 0
    s_and_b32 s76, s76, s52
    s_cbranch_scc1 L_stall2
    s_add_u32 s88, s88, 1
    s_cmp_lt_u32 s88, 1048576
    s_cbranch_scc1 L_stall1
    s_mov_b32 s76, s52
L_stall2:
    s_setpc_b64 s[54:55]
L_s3_71:
    v_cmp_eq_u32 vcc, -1, v115
    s_nop 0
    s_cbranch_vccz L_s3skip_73
    buffer_load_dwordx4 v[112:115], v178, s[40:43], s78 offen offset:1024 sc1
L_s3skip_73:
    v_cmp_eq_u32_e64 vcc, -1, v119
    s_nop 0
    s_cbranch_vccz L_s3skip_74
    buffer_load_dwordx4 v[116:119], v178, s[40:43], s48 offen offset:1024 sc1
L_s3skip_74:
    v_cmp_eq_u32_e64 vcc, -1, v123
    s_nop 0
    s_cbranch_vccz L_s3skip_75
    buffer_load_dwordx4 v[120:123], v178, s[40:43], s49 offen offset:1024 sc1
L_s3skip_75:
    v_cmp_eq_u32_e64 vcc, -1, v127
    s_nop 0
    s_cbranch_vccz L_s3skip_76
    buffer_load_dwordx4 v[124:127], v178, s[40:43], s50 offen offset:1024 sc1
L_s3skip_76:
    v_cmp_eq_u32_e64 vcc, -1, v131
    s_nop 0
    s_cbranch_vccz L_s3skip_77
    buffer_load_dwordx4 v[128:131], v178, s[40:43], s51 offen offset:1024 sc1
L_s3skip_77:
    v_cmp_eq_u32_e64 vcc, -1, v135
    s_nop 0
    s_cbranch_vccz L_s3skip_78
    buffer_load_dwordx4 v[132:135], v178, s[40:43], s52 offen offset:1024 sc1
L_s3skip_78:
    v_cmp_eq_u32_e64 vcc, -1, v139
    s_nop 0
    s_cbranch_vccz L_s3skip_79
    buffer_load_dwordx4 v[136:139], v178, s[40:43], s53 offen offset:1024 sc1
L_s3skip_79:
    v_cmp_eq_u32_e64 vcc, -1, v143
    s_nop 0
    s_cbranch_vccz L_s3skip_80
    buffer_load_dwordx4 v[140:143], v178, s[40:43], s54 offen offset:1024 sc1
L_s3skip_80:
    s_waitcnt vmcnt(0)
    v_pk_add_f32 v[108:109], v[112:113], v[116:117]
    v_pk_add_f32 v[110:111], v[114:115], v[118:119]
    v_pk_add_f32 v[108:109], v[108:109], v[120:121]
    v_pk_add_f32 v[110:111], v[110:111], v[122:123]
    v_pk_add_f32 v[108:109], v[108:109], v[124:125]
    v_pk_add_f32 v[110:111], v[110:111], v[126:127]
    v_pk_add_f32 v[108:109], v[108:109], v[128:129]
    v_pk_add_f32 v[110:111], v[110:111], v[130:131]
    v_pk_add_f32 v[108:109], v[108:109], v[132:133]
    v_pk_add_f32 v[110:111], v[110:111], v[134:135]
    v_pk_add_f32 v[108:109], v[108:109], v[136:137]
    v_pk_add_f32 v[110:111], v[110:111], v[138:139]
    v_pk_add_f32 v[108:109], v[108:109], v[140:141]
    v_pk_add_f32 v[110:111], v[110:111], v[142:143]
    v_cmp_u_f32 vcc, v111, v111
    v_mov_b32 v4, v108
    v_mov_b32 v5, v109
    v_mov_b32_e64 v6, v110
    s_cbranch_vccz L_s3ok_72
    s_add_u32 s88, s88, 1
    s_cmp_lt_u32 s88, 65536
    s_cbranch_scc1 L_s3_71
    s_branch L_s3ok_72
L_code_end:
s_endpgm
.p2align 7
.type L_table,@object
L_table:
.long 0x650c3824, 0xfedba97, 0x50102, 0x3006
.long 0x650c3824, 0xfedba97, 0x510200, 0x3060
.long 0x641d0935, 0xfecba87, 0x5020001, 0x3600
.long 0x76543218, 0xfedcba9, 0x15000002, 0x6300
.long 0x641d0935, 0xfecba87, 0x25100, 0x3006
.long 0x54e2a160, 0xfdcb987, 0x502001, 0x3060
.long 0x54e2a160, 0xfdcb987, 0x5002010, 0x3600
.long 0x54f3b271, 0xedca986, 0x50201000, 0x6300
.long 0x54f3b271, 0xedca986, 0x152000, 0x3006
.long 0x650c3824, 0xfedba97, 0x520010, 0x3060
.long 0x650c3824, 0xfedba97, 0x5020001, 0x3600
.long 0x76543218, 0xfedcba9, 0x50000012, 0x6300
.long 0x641d0935, 0xfecba87, 0x25010, 0x3006
.long 0x641d0935, 0xfecba87, 0x510020, 0x3060
.long 0x54e2a160, 0xfdcb987, 0x5100002, 0x3600
.long 0x54e2a160, 0xfdcb987, 0x50001002, 0x6300
.long 0x641d0935, 0xfecba87, 0x500210, 0x3060
.long 0x641d0935, 0xfecba87, 0x5010200, 0x3600
.long 0x54e2a160, 0xfdcb987, 0x50100002, 0x6300
.long 0x76543209, 0xfedcba8, 0x15002, 0x3006
.long 0x54e2a160, 0xfdcb987, 0x501002, 0x3060
.long 0x54f3b271, 0xedca986, 0x5000120, 0x3600
.long 0x54f3b271, 0xedca986, 0x50000012, 0x6300
.long 0x650c3824, 0xfedba97, 0x15200, 0x3006
.long 0x650c3824, 0xfedba97, 0x520100, 0x3060
.long 0x641d0935, 0xfecba87, 0x5001200, 0x3600
.long 0x641d0935, 0xfecba87, 0x50020001, 0x6300
.long 0x76543209, 0xfedcba8, 0x25001, 0x3006
.long 0x54e2a160, 0xfdcb987, 0x502100, 0x3060
.long 0x54e2a160, 0xfdcb987, 0x5002010, 0x3600
.long 0x54f3b271, 0xedca986, 0x50001002, 0x6300
.long 0x54f3b271, 0xedca986, 0x152000, 0x3006
.long 0x54e2a160, 0xfdcb987, 0x5001002, 0x3600
.long 0x54e2a160, 0xfdcb987, 0x50000012, 0x6300
.long 0x54f3b271, 0xedca986, 0x51020, 0x3006
.long 0x765431a0, 0xfedcb98, 0x150200, 0x3060
.long 0x54f3b271, 0xedca986, 0x5102000, 0x3600
.long 0x650c3824, 0xfedba97, 0x50000102, 0x6300
.long 0x650c3824, 0xfedba97, 0x15020, 0x3006
.long 0x641d0935, 0xfecba87, 0x510200, 0x3060
.long 0x641d0935, 0xfecba87, 0x5020100, 0x3600
.long 0x54e2a160, 0xfdcb987, 0x50100002, 0x6300
.long 0x54e2a160, 0xfdcb987, 0x250001, 0x3006
.long 0x765431a0, 0xfedcb98, 0x251000, 0x3060
.long 0x54f3b271, 0xedca986, 0x5200010, 0x3600
.long 0x54f3b271, 0xedca986, 0x50200001, 0x6300
.long 0x650c3824, 0xfedba97, 0x50021, 0x3006
.long 0x650c3824, 0xfedba97, 0x520010, 0x3060
.long 0x54f3b271, 0xedca986, 0x50200010, 0x6300
.long 0x54f3b271, 0xedca986, 0x152000, 0x3006
.long 0x650c3824, 0xfedba97, 0x500102, 0x3060
.long 0x765421b0, 0xfedca98, 0x2500010, 0x3600
.long 0x650c3824, 0xfedba97, 0x50010200, 0x6300
.long 0x641d0935, 0xfecba87, 0x15200, 0x3006
.long 0x641d0935, 0xfecba87, 0x520001, 0x3060
.long 0x54e2a160, 0xfdcb987, 0x5100020, 0x3600
.long 0x54e2a160, 0xfdcb987, 0x50001020, 0x6300
.long 0x54f3b271, 0xedca986, 0x52001, 0x3006
.long 0x54f3b271, 0xedca986, 0x500102, 0x3060
.long 0x765421b0, 0xfedca98, 0x1500020, 0x3600
.long 0x650c3824, 0xfedba97, 0x50000021, 0x6300
.long 0x650c3824, 0xfedba97, 0x521000, 0x3006
.long 0x641d0935, 0xfecba87, 0x520100, 0x3060
.long 0x641d0935, 0xfecba87, 0x5001002, 0x3600
.long 0x650c3824, 0xfedba97, 0x50021, 0x3006
.long 0x650c3824, 0xfedba97, 0x520010, 0x3060
.long 0x641d0935, 0xfecba87, 0x5010002, 0x3600
.long 0x76532c10, 0xfedba98, 0x15002000, 0x6300
.long 0x641d0935, 0xfecba87, 0x50021, 0x3006
.long 0x54e2a160, 0xfdcb987, 0x251000, 0x3060
.long 0x54e2a160, 0xfdcb987, 0x5000012, 0x3600
.long 0x54f3b271, 0xedca986, 0x50100002, 0x6300
.long 0x54f3b271, 0xedca986, 0x51020, 0x3006
.long 0x650c3824, 0xfedba97, 0x510200, 0x3060
.long 0x650c3824, 0xfedba97, 0x5000102, 0x3600
.long 0x76532c10, 0xfedba98, 0x50000210, 0x6300
.long 0x641d0935, 0xfecba87, 0x50210, 0x3006
.long 0x641d0935, 0xfecba87, 0x520100, 0x3060
.long 0x54e2a160, 0xfdcb987, 0x5100020, 0x3600
.long 0x54e2a160, 0xfdcb987, 0x50000021, 0x6300
.long 0x641d0935, 0xfecba87, 0x500120, 0x3060
.long 0x641d0935, 0xfecba87, 0x5000012, 0x3600
.long 0x54e2a160, 0xfdcb987, 0x50002010, 0x6300
.long 0x76432d10, 0xfecba98, 0x150002, 0x3006
.long 0x54e2a160, 0xfdcb987, 0x510020, 0x3060
.long 0x54f3b271, 0xedca986, 0x5201000, 0x3600
.long 0x54f3b271, 0xedca986, 0x50100020, 0x6300
.long 0x650c3824, 0xfedba97, 0x50102, 0x3006
.long 0x650c3824, 0xfedba97, 0x510200, 0x3060
.long 0x641d0935, 0xfecba87, 0x5000021, 0x3600
.long 0x641d0935, 0xfecba87, 0x50010020, 0x6300
.long 0x76432d10, 0xfecba98, 0x50201, 0x3006
.long 0x54e2a160, 0xfdcb987, 0x251000, 0x3060
.long 0x54e2a160, 0xfdcb987, 0x5100002, 0x3600
.long 0x54f3b271, 0xedca986, 0x50200010, 0x6300
.long 0x54f3b271, 0xedca986, 0x250001, 0x3006
.long 0x54e2a160, 0xfdcb987, 0x5001020, 0x3600
.long 0x54e2a160, 0xfdcb987, 0x50002100, 0x6300
.long 0x54f3b271, 0xedca986, 0x250100, 0x3006
.long 0x7543e210, 0xfdcba98, 0x1502000, 0x3060
.long 0x54f3b271, 0xedca986, 0x5200010, 0x3600
.long 0x650c3824, 0xfedba97, 0x50000201, 0x6300
.long 0x650c3824, 0xfedba97, 0x15200, 0x3006
.long 0x641d0935, 0xfecba87, 0x500120, 0x3060
.long 0x641d0935, 0xfecba87, 0x5010200, 0x3600
.long 0x54e2a160, 0xfdcb987, 0x50100020, 0x6300
.long 0x54e2a160, 0xfdcb987, 0x52010, 0x3006
.long 0x7543e210, 0xfdcba98, 0x500021, 0x3060
.long 0x54f3b271, 0xedca986, 0x5100020, 0x3600
.long 0x54f3b271, 0xedca986, 0x50001020, 0x6300
.long 0x650c3824, 0xfedba97, 0x51200, 0x3006
.long 0x650c3824, 0xfedba97, 0x500120, 0x3060
.long 0x54f3b271, 0xedca986, 0x50000102, 0x6300
.long 0x54f3b271, 0xedca986, 0x50012, 0x3006
.long 0x650c3824, 0xfedba97, 0x500120, 0x3060
.long 0x6543f210, 0xedcba98, 0x15200000, 0x3600
.long 0x650c3824, 0xfedba97, 0x50001020, 0x6300
.long 0x641d0935, 0xfecba87, 0x15002, 0x3006
.long 0x641d0935, 0xfecba87, 0x500102, 0x3060
.long 0x54e2a160, 0xfdcb987, 0x5102000, 0x3600
.long 0x54e2a160, 0xfdcb987, 0x50201000, 0x6300
.long 0x54f3b271, 0xedca986, 0x150020, 0x3006
.long 0x54f3b271, 0xedca986, 0x501020, 0x3060
.long 0x6543f210, 0xedcba98, 0x25000010, 0x3600
.long 0x650c3824, 0xfedba97, 0x50000201, 0x6300
.long 0x650c3824, 0xfedba97, 0x15200, 0x3006
.long 0x641d0935, 0xfecba87, 0x501200, 0x3060
.long 0x641d0935, 0xfecba87, 0x5000201, 0x3600
.long 0x650c3824, 0xfedba97, 0x50210, 0x3006
.long 0x650c3824, 0xfedba97, 0x510002, 0x3060
.long 0x641d0935, 0xfecba87, 0x5000120, 0x3600
.long 0x76543218, 0xfedcba9, 0x25000010, 0x6300
.long 0x641d0935, 0xfecba87, 0x50210, 0x3006
.long 0x54e2a160, 0xfdcb987, 0x150002, 0x3060
.long 0x54e2a160, 0xfdcb987, 0x5200010, 0x3600
.long 0x54f3b271, 0xedca986, 0x50102000, 0x6300
.long 0x54f3b271, 0xedca986, 0x251000, 0x3006
.long 0x650c3824, 0xfedba97, 0x500120, 0x3060
.long 0x650c3824, 0xfedba97, 0x5000021, 0x3600
.long 0x76543218, 0xfedcba9, 0x15002000, 0x6300
.long 0x641d0935, 0xfecba87, 0x50021, 0x3006
.long 0x641d0935, 0xfecba87, 0x510200, 0x3060
.long 0x54e2a160, 0xfdcb987, 0x5201000, 0x3600
.long 0x54e2a160, 0xfdcb987, 0x50200001, 0x6300
.long 0x641d0935, 0xfecba87, 0x500102, 0x3060
.long 0x641d0935, 0xfecba87, 0x5020010, 0x3600
.long 0x54e2a160, 0xfdcb987, 0x50201000, 0x6300
.long 0x76543209, 0xfedcba8, 0x215000, 0x3006
.long 0x54e2a160, 0xfdcb987, 0x502010, 0x3060
.long 0x54f3b271, 0xedca986, 0x5001002, 0x3600
.long 0x54f3b271, 0xedca986, 0x50200001, 0x6300
.long 0x650c3824, 0xfedba97, 0x50120, 0x3006
.long 0x650c3824, 0xfedba97, 0x510002, 0x3060
.long 0x641d0935, 0xfecba87, 0x5020001, 0x3600
.long 0x641d0935, 0xfecba87, 0x50010200, 0x6300
.long 0x76543209, 0xfedcba8, 0x50102, 0x3006
.long 0x54e2a160, 0xfdcb987, 0x150020, 0x3060
.long 0x54e2a160, 0xfdcb987, 0x5000021, 0x3600
.long 0x54f3b271, 0xedca986, 0x50102000, 0x6300
.long 0x54f3b271, 0xedca986, 0x50012, 0x3006
.long 0x54e2a160, 0xfdcb987, 0x5002010, 0x3600
.long 0x54e2a160, 0xfdcb987, 0x50001020, 0x6300
.long 0x54f3b271, 0xedca986, 0x150002, 0x3006
.long 0x765431a0, 0xfedcb98, 0x500021, 0x3060
.long 0x54f3b271, 0xedca986, 0x5001020, 0x3600
.long 0x650c3824, 0xfedba97, 0x50020001, 0x6300
.long 0x650c3824, 0xfedba97, 0x15002, 0x3006
.long 0x641d0935, 0xfecba87, 0x520100, 0x3060
.long 0x641d0935, 0xfecba87, 0x5010020, 0x3600
.long 0x54e2a160, 0xfdcb987, 0x50002100, 0x6300
.long 0x54e2a160, 0xfdcb987, 0x150002, 0x3006
.long 0x765431a0, 0xfedcb98, 0x150020, 0x3060
.long 0x54f3b271, 0xedca986, 0x5000102, 0x3600
.long 0x54f3b271, 0xedca986, 0x50002010, 0x6300
.long 0x650c3824, 0xfedba97, 0x50102, 0x3006
.long 0x650c3824, 0xfedba97, 0x501002, 0x3060
.long 0x54f3b271, 0xedca986, 0x50102000, 0x6300
.long 0x54f3b271, 0xedca986, 0x250001, 0x3006
.long 0x650c3824, 0xfedba97, 0x520001, 0x3060
.long 0x765421b0, 0xfedca98, 0x1500020, 0x3600
.long 0x650c3824, 0xfedba97, 0x50000102, 0x6300
.long 0x641d0935, 0xfecba87, 0x51020, 0x3006
.long 0x641d0935, 0xfecba87, 0x510020, 0x3060
.long 0x54e2a160, 0xfdcb987, 0x5001002, 0x3600
.long 0x54e2a160, 0xfdcb987, 0x50102000, 0x6300
.long 0x54f3b271, 0xedca986, 0x51002, 0x3006
.long 0x54f3b271, 0xedca986, 0x502010, 0x3060
.long 0x765421b0, 0xfedca98, 0x5100002, 0x3600
.long 0x650c3824, 0xfedba97, 0x50020010, 0x6300
.long 0x650c3824, 0xfedba97, 0x15002, 0x3006
.long 0x641d0935, 0xfecba87, 0x500102, 0x3060
.long 0x641d0935, 0xfecba87, 0x5020010, 0x3600
.long 0x650c3824, 0xfedba97, 0x521000, 0x3006
.long 0x650c3824, 0xfedba97, 0x500021, 0x3060
.long 0x641d0935, 0xfecba87, 0x5000201, 0x3600
.long 0x76532c10, 0xfedba98, 0x15000200, 0x6300
.long 0x641d0935, 0xfecba87, 0x15002, 0x3006
.long 0x54e2a160, 0xfdcb987, 0x501020, 0x3060
.long 0x54e2a160, 0xfdcb987, 0x5000120, 0x3600
.long 0x54f3b271, 0xedca986, 0x50100020, 0x6300
.long 0x54f3b271, 0xedca986, 0x51002, 0x3006
.long 0x650c3824, 0xfedba97, 0x500102, 0x3060
.long 0x650c3824, 0xfedba97, 0x5000210, 0x3600
.long 0x76532c10, 0xfedba98, 0x25000100, 0x6300
.long 0x641d0935, 0xfecba87, 0x50102, 0x3006
.long 0x641d0935, 0xfecba87, 0x501002, 0x3060
.long 0x54e2a160, 0xfdcb987, 0x5002010, 0x3600
.long 0x54e2a160, 0xfdcb987, 0x50102000, 0x6300
.long 0x641d0935, 0xfecba87, 0x520001, 0x3060
.long 0x641d0935, 0xfecba87, 0x5010020, 0x3600
.long 0x54e2a160, 0xfdcb987, 0x50100020, 0x6300
.long 0x76432d10, 0xfecba98, 0x50201, 0x3006
.long 0x54e2a160, 0xfdcb987, 0x251000, 0x3060
.long 0x54f3b271, 0xedca986, 0x5002001, 0x3600
.long 0x54f3b271, 0xedca986, 0x50002010, 0x6300
.long 0x650c3824, 0xfedba97, 0x25100, 0x3006
.long 0x650c3824, 0xfedba97, 0x510020, 0x3060
.long 0x641d0935, 0xfecba87, 0x5000102, 0x3600
.long 0x641d0935, 0xfecba87, 0x50000012, 0x6300
.long 0x76432d10, 0xfecba98, 0x152000, 0x3006
.long 0x54e2a160, 0xfdcb987, 0x500012, 0x3060
.long 0x54e2a160, 0xfdcb987, 0x5210000, 0x3600
.long 0x54f3b271, 0xedca986, 0x50001020, 0x6300
.long 0x54f3b271, 0xedca986, 0x150020, 0x3006
.long 0x54e2a160, 0xfdcb987, 0x5200010, 0x3600
.long 0x54e2a160, 0xfdcb987, 0x50201000, 0x6300
.long 0x54f3b271, 0xedca986, 0x52100, 0x3006
.long 0x7543e210, 0xfdcba98, 0x520001, 0x3060
.long 0x54f3b271, 0xedca986, 0x5100002, 0x3600
.long 0x650c3824, 0xfedba97, 0x50000120, 0x6300
.long 0x650c3824, 0xfedba97, 0x521000, 0x3006
.long 0x641d0935, 0xfecba87, 0x500102, 0x3060
.long 0x641d0935, 0xfecba87, 0x5010002, 0x3600
.long 0x54e2a160, 0xfdcb987, 0x51200000, 0x6300
.long 0x54e2a160, 0xfdcb987, 0x150020, 0x3006
.long 0x7543e210, 0xfdcba98, 0x502010, 0x3060
.long 0x54f3b271, 0xedca986, 0x5002010, 0x3600
.long 0x54f3b271, 0xedca986, 0x50001002, 0x6300
.long 0x650c3824, 0xfedba97, 0x1025000, 0x3006
.long 0x650c3824, 0xfedba97, 0x510200, 0x3060
.long 0x54f3b271, 0xedca986, 0x50100020, 0x6300
.long 0x54f3b271, 0xedca986, 0x51020, 0x3006
.long 0x650c3824, 0xfedba97, 0x510200, 0x3060
.long 0x6543f210, 0xedcba98, 0x5102000, 0x3600
.long 0x650c3824, 0xfedba97, 0x15020000, 0x6300
.long 0x641d0935, 0xfecba87, 0x25100, 0x3006
.long 0x641d0935, 0xfecba87, 0x500210, 0x3060
.long 0x54e2a160, 0xfdcb987, 0x5201000, 0x3600
.long 0x54e2a160, 0xfdcb987, 0x50100002, 0x6300
.long 0x54f3b271, 0xedca986, 0x250001, 0x3006
.long 0x54f3b271, 0xedca986, 0x250010, 0x3060
.long 0x6543f210, 0xedcba98, 0x5002001, 0x3600
.long 0x650c3824, 0xfedba97, 0x50000012, 0x6300
.long 0x650c3824, 0xfedba97, 0x50120, 0x3006
.long 0x641d0935, 0xfecba87, 0x510020, 0x3060
.long 0x641d0935, 0xfecba87, 0x5000021, 0x3600
.fill 1, 4, 0
.size L_table, .-L_table
.section .rodata,"a"
.p2align 6
.amdhsa_kernel sequential_preLN__linear_kernel_hedgehog__moe_arch_mod__prompt_kernel
  .amdhsa_next_free_vgpr 256
  .amdhsa_next_free_sgpr 102
  .amdhsa_accum_offset 256
  .amdhsa_group_segment_fixed_size 0
  .amdhsa_kernarg_size 96
  .amdhsa_user_sgpr_count 2
  .amdhsa_user_sgpr_kernarg_segment_ptr 1
  .amdhsa_system_sgpr_workgroup_id_x 1
  .amdhsa_float_denorm_mode_32 3
.end_amdhsa_kernel
```

```asm
; @launch grid=(256,1,1) block=(512,1,1) lds=163840
.amdgcn_target "amdgcn-amd-amdhsa--gfx950"
.text
.globl sequential_preLN__linear_kernel_hedgehog__moe_arch_mod__prompt_kernel
.p2align 8
.type sequential_preLN__linear_kernel_hedgehog__moe_arch_mod__prompt_kernel,@function
sequential_preLN__linear_kernel_hedgehog__moe_arch_mod__prompt_kernel:
    s_cmp_ge_u32 s2, 256
    s_cbranch_scc1 L_end
    s_load_dwordx2 s[28:29], s[0:1], 0
    s_load_dwordx2 s[32:33], s[0:1], 8
    s_load_dwordx4 s[8:11], s[0:1], 16
    s_load_dwordx16 s[12:27], s[0:1], 32
    v_lshrrev_b32 v4, 6, v0
    v_and_b32 v1, 63, v0
    v_readfirstlane_b32 s79, v4
    s_and_b32 s76, s2, 7
    s_lshr_b32 s77, s2, 3
    s_and_b32 s60, s77, 15
    s_lshl_b32 s76, s76, 3
    s_bfe_u32 s77, s2, 0x10007
    s_lshl2_add_u32 s76, s77, s76
    s_mov_b32 s80, 0x654210b3
    s_mov_b32 s81, 0xfedca987
    s_lshr_b64 s[80:81], s[80:81], s76
    s_and_b32 s61, s80, 15
    s_and_b32 s62, s79, 3
    s_cmp_ge_u32 s79, 4
    s_cbranch_scc1 L_compute
    s_setprio 3
    s_getpc_b64 s[66:67]
L_pc:
    s_lshr_b32 s76, s2, 3
    s_lshl2_add_u32 s76, s76, s62
    s_mul_i32 s76, s76, 256
    v_lshl_add_u32 v91, v1, 7, s76
    s_mov_b64 exec, 3
    global_load_dword v27, v91, s[66:67]
    s_mov_b64 exec, -1
    s_add_u32 s84, s60, s2
    s_and_b32 s84, s84, 3
    s_and_b32 s76, s60, 7
    s_and_b32 s77, s61, 7
    s_cmp_eq_u32 s77, 3
    s_cselect_b32 s84, s76, s84
    v_lshrrev_b32 v4, 3, v1
    v_and_b32 v5, 7, v1
    v_lshrrev_b32_e64 v6, 4, v1
    s_lshl2_add_u32 s76, s60, s62
    s_lshl_b32 s76, s76, 16
    s_mul_i32 s70, s62, 10240
    v_xor_b32 v7, v5, v6
    v_lshlrev_b32 v7, 4, v7
    v_lshl_add_u32 v78, v4, 11, v7
    v_add_u32 v16, s76, v78
    v_xor_b32 v7, 64, v16
    v_add_u32 v17, 15360, v7
    v_add_u32 v18, 30720, v16
    v_add_u32 v19, 46080, v7
    s_mov_b32 s30, 4194304
    s_mov_b32 s31, 0x20000
    s_and_b32 s72, s84, 15
    s_mov_b32 m0, s70
    s_lshl_b32 s71, s72, 7
    s_waitcnt lgkmcnt(0)
    buffer_load_dwordx4 v16, s[28:31], s71 offen offset:0 lds
    s_mul_i32 s72, s72, 393216
    s_lshr_b64 s[84:85], s[84:85], 4
    buffer_load_dwordx4 v17, s[28:31], s71 offen offset:1024 lds
    buffer_load_dwordx4 v18, s[28:31], s71 offen offset:2048 lds
    buffer_load_dwordx4 v19, s[28:31], s71 offen offset:3072 lds
    v_and_b32 v6, 1, v6
    v_lshlrev_b32 v6, 2, v6
    v_xor_b32 v8, v5, v6
    v_lshlrev_b32 v8, 4, v8
    s_lshl_b32 s76, s61, 7
    s_mul_i32 s77, s62, 98304
    s_add_u32 s76, s76, s77
    v_mul_u32_u24 v7, 6144, v4
    v_add3_u32 v20, v7, v8, s76
    v_xor_b32 v7, 32, v20
    s_mov_b32 s34, 6291456
    s_mov_b32 s35, 0x20000
    s_add_u32 m0, s70, 4096
    s_nop 0
    buffer_load_dwordx4 v20, s[32:35], s72 offen offset:0 lds
    v_add_u32 v21, 48128, v7
    buffer_load_dwordx4 v21, s[32:35], s72 offen offset:1024 lds
    v_add_u32 v22, 0, v20
    buffer_load_dwordx4 v22, s[32:35], s72 offen offset:2048 lds
    v_add_u32 v23, 48128, v7
    buffer_load_dwordx4 v23, s[32:35], s72 offen offset:3072 lds
    v_add_u32 v24, 4096, v20
    s_add_u32 m0, s70, 8192
    s_nop 0
    buffer_load_dwordx4 v24, s[32:35], s72 offen offset:0 lds
    v_add_u32 v25, 52224, v7
    buffer_load_dwordx4 v25, s[32:35], s72 offen offset:1024 lds
    s_add_u32 s70, s70, 40960
    s_cmp_ge_u32 s70, 122880
    s_cselect_b32 s76, 122880, 0
    s_sub_u32 s70, s70, s76
    s_lshl_b32 s76, s60, 8
    s_lshl_b32 s77, s61, 4
    s_add_u32 s76, s76, s77
    s_add_u32 s76, s76, 30336
    s_load_dwordx4 s[84:87], s[66:67], s76
    v_lshl_add_u32 v26, v4, 11, v8
    v_xor_b32 v79, 64, v78
    s_and_b32 s63, s62, 1
    s_lshr_b32 s64, s62, 1
    s_lshl_b32 s73, s60, 4
    s_add_u32 s73, s73, s61
    s_mul_i32 s73, s73, 28800
    s_add_u32 s76, s2, 7
    s_and_b32 s76, s76, 7
    s_bfe_u32 s77, s2, 0x10003
    s_lshl1_add_u32 s97, s76, s77
    s_lshr_b32 s98, s2, 4
    s_lshl_b32 s99, s97, 4
    s_add_u32 s99, s99, s98
    s_mul_i32 s99, s99, 9344
    s_add_u32 s99, s99, 8388608
    s_lshr_b32 s65, s97, 1
    s_lshl_b32 s76, s97, 3
    s_add_u32 s65, s65, s76
    s_mul_i32 s76, s98, 4
    s_add_u32 s65, s65, s76
    s_and_b32 s65, s65, 15
    s_mov_b32 s89, 0x3f803f80
    s_mov_b32 s90, 0xffff0000
    v_and_b32 v2, 31, v1
    v_lshrrev_b32 v3, 5, v1
    v_lshlrev_b32 v12, 4, v1
    v_lshrrev_b32 v4, 3, v1
    v_mul_u32_u24 v13, 460800, v4
    v_and_b32_e64 v4, 7, v1
    v_lshl_add_u32 v13, v4, 4, v13
    s_lshl_b32 s76, s98, 7
    s_lshl_b32 s77, s62, 15
    s_add_u32 s76, s76, s77
    v_add_u32_e64 v26, s76, v26
    s_mov_b32 s40, s26
    s_and_b32 s41, s27, 0xffff
    s_mov_b32 s42, 33554432
    s_mov_b32 s43, 0x20000
    s_mov_b32 s56, s8
    s_and_b32 s57, s9, 0xffff
    s_mov_b32 s58, 65536
    s_mov_b32 s59, 0x20000
    v_mov_b32 v28, -1
    v_mov_b32 v29, -1
    v_mov_b32 v30, -1
    v_mov_b32_e64 v31, -1
    s_waitcnt lgkmcnt(0)
    s_and_b32 s72, s84, 15
    s_mov_b32 m0, s70
    s_lshl_b32 s71, s72, 7
    buffer_load_dwordx4 v16, s[28:31], s71 offen offset:0 lds
    s_mul_i32 s72, s72, 393216
    s_lshr_b64 s[84:85], s[84:85], 4
    buffer_load_dwordx4 v17, s[28:31], s71 offen offset:1024 lds
    buffer_load_dwordx4 v18, s[28:31], s71 offen offset:2048 lds
    buffer_load_dwordx4 v19, s[28:31], s71 offen offset:3072 lds
    s_add_u32 m0, s70, 4096
    s_nop 0
    buffer_load_dwordx4 v20, s[32:35], s72 offen offset:0 lds
    buffer_load_dwordx4 v21, s[32:35], s72 offen offset:1024 lds
    buffer_load_dwordx4 v22, s[32:35], s72 offen offset:2048 lds
    buffer_load_dwordx4 v23, s[32:35], s72 offen offset:3072 lds
    s_add_u32 m0, s70, 8192
    s_nop 0
    buffer_load_dwordx4 v24, s[32:35], s72 offen offset:0 lds
    buffer_load_dwordx4 v25, s[32:35], s72 offen offset:1024 lds
    s_add_u32 s70, s70, 40960
    s_cmp_ge_u32 s70, 122880
    s_cselect_b32 s76, 122880, 0
    s_sub_u32 s70, s70, s76
    s_lshl_b32 s77, s62, 10
    s_add_u32 s76, s77, s73
    buffer_store_dwordx4 v[28:31], v12, s[40:43], s76 offen sc1
    s_lshl_b32 s76, s61, 12
    s_add_u32 s76, s76, s77
    s_add_u32 m0, s77, 122880
    s_nop 0
    buffer_load_dwordx4 v12, s[56:59], s76 offen lds
    v_mov_b32 v4, 13631488
    buffer_load_dwordx2 v[88:89], v4, s[40:43], 0 offen
    s_setprio 0
    s_waitcnt vmcnt(13)
    s_barrier
    s_and_b32 s72, s84, 15
    s_mov_b32 m0, s70
    s_lshl_b32 s71, s72, 7
    buffer_load_dwordx4 v16, s[28:31], s71 offen offset:0 lds
    s_mul_i32 s72, s72, 393216
    s_lshr_b64 s[84:85], s[84:85], 4
    buffer_load_dwordx4 v17, s[28:31], s71 offen offset:1024 lds
    buffer_load_dwordx4 v18, s[28:31], s71 offen offset:2048 lds
    buffer_load_dwordx4 v19, s[28:31], s71 offen offset:3072 lds
    s_add_u32 m0, s70, 4096
    s_nop 0
    buffer_load_dwordx4 v20, s[32:35], s72 offen offset:0 lds
    buffer_load_dwordx4 v21, s[32:35], s72 offen offset:1024 lds
    buffer_load_dwordx4 v22, s[32:35], s72 offen offset:2048 lds
    buffer_load_dwordx4 v23, s[32:35], s72 offen offset:3072 lds
    s_add_u32 m0, s70, 8192
    s_nop 0
    buffer_load_dwordx4 v24, s[32:35], s72 offen offset:0 lds
    buffer_load_dwordx4 v25, s[32:35], s72 offen offset:1024 lds
    s_add_u32 s70, s70, 40960
    s_cmp_ge_u32 s70, 122880
    s_cselect_b32 s76, 122880, 0
    s_sub_u32 s70, s70, s76
    s_mov_b32 s36, s10
    s_and_b32 s37, s11, 0xffff
    s_mov_b32 s38, 2097152
    s_mov_b32 s39, 0x20000
    s_mov_b32 s44, s22
    s_and_b32 s45, s23, 0xffff
    s_mov_b32 s46, 4194304
    s_mov_b32 s47, 0x20000
    s_mov_b32 s52, s20
    s_and_b32 s53, s21, 0xffff
    s_mov_b32 s54, 7340032
    s_mov_b32 s55, 0x20000
    s_cmp_eq_u32 s64, 0
    s_cselect_b32 s48, s16, s18
    s_cselect_b32 s49, s17, s19
    s_and_b32 s49, s49, 0xffff
    s_mov_b32 s51, 0x20000
    s_cmp_lt_u32 s97, 14
    s_cselect_b32 s50, 7340032, 0
    s_cselect_b32 s54, 7340032, 0
    v_bfe_u32 v4, v2, 1, 3
    v_xor_b32 v4, v4, v3
    v_lshlrev_b32 v4, 4, v4
    v_lshl_add_u32 v72, v2, 7, v4
    v_bfe_u32 v4, v1, 2, 2
    v_lshl_add_u32 v5, v3, 3, v4
    v_lshlrev_b32 v5, 7, v5
    v_lshrrev_b32 v4, 1, v4
    v_xor_b32_e64 v4, s64, v4
    v_lshl_add_u32 v5, v4, 6, v5
    v_bfe_u32 v4, v1, 4, 1
    v_xor_b32_e64 v4, v4, v3
    v_lshl_add_u32 v5, v4, 5, v5
    v_and_b32_e64 v4, 3, v1
    v_lshl_add_u32 v5, v4, 3, v5
    s_mul_i32 s76, s62, 10240
    s_sub_u32 s76, 4096, s76
    v_add_u32 v73, s76, v5
    v_lshlrev_b32 v74, 3, v2
    v_lshrrev_b32 v4, 4, v1
    v_and_b32 v5, 15, v1
    v_mul_u32_u24 v66, 28800, v4
    v_lshl_add_u32 v66, v5, 4, v66
    v_mul_u32_u24 v75, 460800, v4
    v_lshl_add_u32 v75, v5, 4, v75
    v_lshrrev_b32 v4, 4, v1
    v_and_b32 v5, 15, v1
    v_mul_u32_u24 v76, 114688, v4
    v_lshl_add_u32 v76, v5, 4, v76
    v_lshlrev_b32_e64 v77, 4, v2
    v_lshl_add_u32 v77, v3, 11, v77
    s_mul_i32 s75, s98, 458752
    s_lshl_b32 s77, s97, 9
    s_add_u32 s75, s75, s77
    s_lshl_b32 s77, s63, 8
    s_add_u32 s75, s75, s77
    s_lshl_b32 s96, s97, 19
    s_lshl_b32 s77, s98, 15
    s_add_u32 s96, s96, s77
    s_lshl_b32 s77, s62, 9
    s_add_u32 s96, s96, s77
    s_mov_b32 s68, 1
    s_getreg_b32 s101, hwreg(HW_REG_XCC_ID, 0, 4)
    s_lshl_b32 s76, s61, 8
    s_add_u32 s76, s76, 12582912
    s_lshl_b32 s77, s60, 8
    s_add_u32 s77, s77, 12586752
    s_lshr_b32 s78, s97, 1
    s_lshl_b32 s78, s78, 9
    s_add_u32 s78, s78, 12590592
    v_mov_b32 v4, s76
    v_mov_b32 v5, s77
    v_mov_b32 v6, s78
    v_cmp_gt_u32 vcc, 16, v1
    s_nop 1
    v_cndmask_b32 v4, v5, v4, vcc
    v_cmp_gt_u32 vcc, 32, v1
    s_nop 1
    v_cndmask_b32 v4, v6, v4, vcc
    v_add_u32 v90, v4, v12
    s_waitcnt vmcnt(10)
    s_barrier
L_hloop:
    s_and_b32 s77, s86, 15
    s_cbranch_scc1 L_event
L_evret:
    s_and_b32 s72, s84, 15
    s_mov_b32 m0, s70
    s_lshl_b32 s71, s72, 7
    buffer_load_dwordx4 v16, s[28:31], s71 offen offset:0 lds
    s_mul_i32 s72, s72, 393216
    s_lshr_b64 s[84:85], s[84:85], 4
    buffer_load_dwordx4 v17, s[28:31], s71 offen offset:1024 lds
    buffer_load_dwordx4 v18, s[28:31], s71 offen offset:2048 lds
    buffer_load_dwordx4 v19, s[28:31], s71 offen offset:3072 lds
    s_add_u32 m0, s70, 4096
    s_nop 0
    buffer_load_dwordx4 v20, s[32:35], s72 offen offset:0 lds
    buffer_load_dwordx4 v21, s[32:35], s72 offen offset:1024 lds
    buffer_load_dwordx4 v22, s[32:35], s72 offen offset:2048 lds
    buffer_load_dwordx4 v23, s[32:35], s72 offen offset:3072 lds
    s_add_u32 m0, s70, 8192
    s_nop 0
    buffer_load_dwordx4 v24, s[32:35], s72 offen offset:0 lds
    buffer_load_dwordx4 v25, s[32:35], s72 offen offset:1024 lds
    s_add_u32 s70, s70, 40960
    s_cmp_ge_u32 s70, 122880
    s_cselect_b32 s76, 122880, 0
    s_sub_u32 s70, s70, s76
    s_waitcnt vmcnt(10)
L_hbar:
    s_lshr_b64 s[86:87], s[86:87], 4
    s_add_u32 s68, s68, 1
    s_cmp_lt_u32 s68, 14
    s_barrier
    s_cbranch_scc1 L_hloop
    v_add_co_u32 v88, vcc, 1, v88
    s_nop 1
    v_addc_co_u32 v89, vcc, 0, v89, vcc
    v_cmp_ne_u64 vcc, v[92:93], v[88:89]
    s_nop 0
    s_cbranch_vccz L_hello_ok_1
    s_mov_b32 s88, 0
L_spin_2:
    buffer_load_dwordx4 v[92:95], v90, s[40:43], 0 offen sc1
    s_waitcnt vmcnt(0)
    v_cmp_ne_u64 vcc, v[92:93], v[88:89]
    s_nop 0
    s_cbranch_vccz L_hello_ok_1
    s_add_u32 s88, s88, 1
    s_cmp_lt_u32 s88, 65536
    s_cbranch_scc1 L_spin_2
L_hello_ok_1:
    v_cmp_ne_u32_e64 vcc, s101, v94
    s_nop 0
    s_and_b32 s76, vcc_lo, 0xffff
    s_cselect_b32 s100, 0, 1
    s_cmp_eq_u32 vcc_hi, 0
    s_cselect_b32 s76, 2, 0
    s_or_b32 s100, s100, s76
    v_mov_b32 v4, s100
    v_mov_b32 v5, 0
    ds_write_b32 v5, v4 offset:53248
    s_lshl_b32 s81, s62, 8
    s_mul_i32 s80, s60, 460800
    s_add_u32 s80, s80, s81
    buffer_load_dwordx4 v[32:35], v66, s[40:43], s80 offen offset:0 sc1
    s_add_u32 s80, s80, 115200
    buffer_load_dwordx4 v[36:39], v66, s[40:43], s80 offen offset:0 sc1
    s_add_u32 s80, s80, 115200
    buffer_load_dwordx4 v[40:43], v66, s[40:43], s80 offen offset:0 sc1
    s_add_u32 s80, s80, 115200
    buffer_load_dwordx4 v[44:47], v66, s[40:43], s80 offen offset:0 sc1
    s_mul_i32 s80, s61, 28800
    s_add_u32 s80, s80, s81
    buffer_load_dwordx4 v[48:51], v75, s[40:43], s80 offen offset:1024 sc1
    s_add_u32 s80, s80, 1843200
    buffer_load_dwordx4 v[52:55], v75, s[40:43], s80 offen offset:1024 sc1
    s_add_u32 s80, s80, 1843200
    buffer_load_dwordx4 v[56:59], v75, s[40:43], s80 offen offset:1024 sc1
    s_add_u32 s80, s80, 1843200
    buffer_load_dwordx4 v[60:63], v75, s[40:43], s80 offen offset:1024 sc1
    v_bfe_u32 v10, v1, 4, 1
    v_lshl_add_u32 v10, v10, 1, v3
    v_min_u32 v10, 2, v10
    v_and_b32 v7, 15, v1
    v_lshlrev_b32_e64 v7, 3, v7
    s_lshl_b32 s76, s62, 7
    v_lshl_add_u32 v10, v10, 9, v7
    v_add_u32_e64 v64, s76, v10
    v_lshl_add_u32 v65, v7, 1, s81
    v_bfe_u32 v10, v1, 4, 1
    v_lshl_add_u32 v65, v10, 3, v65
    s_waitcnt vmcnt(8)
    s_barrier
    s_mul_i32 s78, s62, 2048
    s_add_u32 s78, s78, s99
    s_add_u32 s78, s78, 1024
    v_lshlrev_b32 v11, 7, v1
    s_mov_b64 exec, 65535
    buffer_load_dword v27, v11, s[40:43], s78 offen sc1
    s_mov_b64 exec, -1
    buffer_load_dwordx4 v[152:155], v76, s[48:51], s75 offen nt
    s_add_u32 s75, s75, 7168
    s_add_u32 s78, s65, 0
    s_and_b32 s78, s78, 15
    s_lshl_b32 s78, s78, 17
    s_lshl_b32 s79, s62, 11
    s_add_u32 m0, s79, 57344
    s_add_u32 s79, s78, 15360
    buffer_load_dwordx4 v26, s[36:39], s78 offen lds
    buffer_load_dwordx4 v26, s[36:39], s79 offen offset:1024 lds
    s_add_u32 s78, s65, 1
    s_and_b32 s78, s78, 15
    s_lshl_b32 s78, s78, 17
    s_lshl_b32 s79, s62, 11
    s_add_u32 m0, s79, 65536
    s_add_u32 s79, s78, 15360
    buffer_load_dwordx4 v26, s[36:39], s78 offen lds
    buffer_load_dwordx4 v26, s[36:39], s79 offen offset:1024 lds
    s_setprio 3
    s_mov_b32 s88, 0
    s_waitcnt vmcnt(10)
    s_branch L_g1first_3
L_g1_4:
    s_mul_i32 s80, s60, 460800
    s_add_u32 s80, s80, s81
    buffer_load_dwordx4 v[32:35], v66, s[40:43], s80 offen offset:0 sc1
    s_add_u32 s80, s80, 115200
    buffer_load_dwordx4 v[36:39], v66, s[40:43], s80 offen offset:0 sc1
    s_add_u32 s80, s80, 115200
    buffer_load_dwordx4 v[40:43], v66, s[40:43], s80 offen offset:0 sc1
    s_add_u32 s80, s80, 115200
    buffer_load_dwordx4 v[44:47], v66, s[40:43], s80 offen offset:0 sc1
    s_waitcnt vmcnt(0)
L_g1first_3:
    v_max3_u32 v4, v32, v34, v36
    v_max3_u32 v4, v4, v38, v40
    v_max3_u32 v4, v4, v42, v44
    v_max_u32 v4, v4, v46
    v_cmp_eq_u32 vcc, -1, v4
    s_nop 0
    s_cbranch_vccz L_ok_5
    s_add_u32 s88, s88, 1
    s_cmp_lt_u32 s88, 65536
    s_cbranch_scc1 L_g1_4
L_ok_5:
    v_add_f32 v32, v32, v40
    v_add_f32 v33, v33, v41
    v_add_f32 v34, v34, v42
    v_add_f32 v35, v35, v43
    v_add_f32 v36, v36, v44
    v_add_f32 v37, v37, v45
    v_add_f32 v38, v38, v46
    v_add_f32 v39, v39, v47
    v_add_f32 v32, v32, v36
    v_add_f32 v33, v33, v37
    v_add_f32 v34, v34, v38
    v_add_f32_e64 v35, v35, v39
    s_add_u32 s78, s65, 2
    s_and_b32 s78, s78, 15
    s_lshl_b32 s78, s78, 17
    s_lshl_b32 s79, s62, 11
    s_add_u32 m0, s79, 73728
    s_add_u32 s79, s78, 15360
    buffer_load_dwordx4 v26, s[36:39], s78 offen lds
    buffer_load_dwordx4 v26, s[36:39], s79 offen offset:1024 lds
    v_permlane32_swap_b32 v32, v33
    v_permlane32_swap_b32 v34, v35
    v_add_f32 v32, v32, v33
    v_add_f32 v34, v34, v35
    s_nop 1
    v_permlane16_swap_b32 v32, v34
    v_add_f32 v32, v32, v34
    v_mov_b32 v33, v32
    s_nop 1
    v_permlane32_swap_b32 v32, v33
    v_mul_f32 v32, 0x3a800000, v32
    v_mul_f32 v33, 0x3a800000, v33
    v_fma_f32 v7, -v32, v32, v33
    v_max_f32_e64 v7, 0, v7
    v_cvt_pk_bf16_f32 v5, v32, v32
    v_and_b32_e64 v5, s90, v5
    v_cvt_pk_bf16_f32 v7, v7, v7
    v_and_b32_e64 v7, s90, v7
    v_add_f32 v7, 0x3727c5ac, v7
    v_cvt_pk_bf16_f32 v7, v7, v7
    v_and_b32 v7, s90, v7
    v_sqrt_f32_e64 v7, v7
    s_nop 0
    v_cvt_pk_bf16_f32 v7, v7, v7
    v_and_b32 v7, s90, v7
    v_rcp_f32 v9, v7
    v_xor_b32 v5, 0x80000000, v5
    v_cvt_pk_bf16_f32 v8, v5, v5
    ds_write_b64 v65, v[8:9] offset:49152
    s_mov_b32 s88, 0
    s_waitcnt vmcnt(8)
    s_branch L_g1first_6
L_g1_7:
    s_mul_i32 s80, s61, 28800
    s_add_u32 s80, s80, s81
    buffer_load_dwordx4 v[48:51], v75, s[40:43], s80 offen offset:1024 sc1
    s_add_u32 s80, s80, 1843200
    buffer_load_dwordx4 v[52:55], v75, s[40:43], s80 offen offset:1024 sc1
    s_add_u32 s80, s80, 1843200
    buffer_load_dwordx4 v[56:59], v75, s[40:43], s80 offen offset:1024 sc1
    s_add_u32 s80, s80, 1843200
    buffer_load_dwordx4 v[60:63], v75, s[40:43], s80 offen offset:1024 sc1
    s_waitcnt vmcnt(0)
L_g1first_6:
    v_max3_u32 v4, v48, v50, v52
    v_max3_u32 v4, v4, v54, v56
    v_max3_u32 v4, v4, v58, v60
    v_max_u32 v4, v4, v62
    v_cmp_eq_u32 vcc, -1, v4
    s_nop 0
    s_cbranch_vccz L_ok_8
    s_add_u32 s88, s88, 1
    s_cmp_lt_u32 s88, 65536
    s_cbranch_scc1 L_g1_7
L_ok_8:
    v_add_f32 v48, v48, v56
    v_add_f32 v49, v49, v57
    v_add_f32 v50, v50, v58
    v_add_f32 v51, v51, v59
    v_add_f32 v52, v52, v60
    v_add_f32 v53, v53, v61
    v_add_f32 v54, v54, v62
    v_add_f32 v55, v55, v63
    v_add_f32 v48, v48, v52
    v_add_f32 v49, v49, v53
    v_add_f32 v50, v50, v54
    v_add_f32 v51, v51, v55
    v_add_f32 v49, v49, v51
    v_mov_b32 v51, v49
    v_permlane32_swap_b32 v48, v50
    s_nop 0
    v_permlane32_swap_b32 v49, v51
    v_add_f32 v48, v48, v50
    v_add_f32 v49, v49, v51
    s_nop 1
    v_permlane16_swap_b32 v48, v49
    v_add_f32_e64 v48, v48, v49
    v_cvt_pk_bf16_f32 v49, v48, v48
    v_and_b32 v49, s90, v49
    v_sub_f32 v49, v48, v49
    v_cvt_pk_bf16_f32 v50, v48, v49
    v_and_b32 v51, s90, v50
    v_sub_f32 v49, v49, v51
    v_cvt_pk_bf16_f32 v51, v49, 0
    ds_write_b64 v64, v[50:51] offset:50176
    s_setprio 0
    s_waitcnt lgkmcnt(0)
    s_barrier
    s_add_u32 s78, s65, 3
    s_and_b32 s78, s78, 15
    s_lshl_b32 s78, s78, 17
    s_lshl_b32 s79, s62, 11
    s_add_u32 m0, s79, 81920
    s_add_u32 s79, s78, 15360
    buffer_load_dwordx4 v26, s[36:39], s78 offen lds
    buffer_load_dwordx4 v26, s[36:39], s79 offen offset:1024 lds
    s_add_u32 s78, s65, 4
    s_and_b32 s78, s78, 15
    s_lshl_b32 s78, s78, 17
    s_lshl_b32 s79, s62, 11
    s_add_u32 m0, s79, 90112
    s_add_u32 s79, s78, 15360
    buffer_load_dwordx4 v26, s[36:39], s78 offen lds
    buffer_load_dwordx4 v26, s[36:39], s79 offen offset:1024 lds
    s_lshl_b32 s78, s62, 11
    s_add_u32 s79, s78, s99
    s_bitcmp1_b32 s100, 0
    s_cbranch_scc1 L_loc_9
    buffer_store_dwordx4 v[28:31], v12, s[40:43], s79 offen offset:1024 sc1
    buffer_store_dwordx4 v[28:31], v12, s[40:43], s79 offen offset:2048 sc1
    s_branch L_pubd_10
L_loc_9:
    buffer_store_dwordx4 v[28:31], v12, s[40:43], s79 offen offset:1024
    buffer_store_dwordx4 v[28:31], v12, s[40:43], s79 offen offset:2048
L_pubd_10:
    s_lshl_b32 s79, s62, 8
    s_add_u32 s79, s79, s99
    s_mov_b64 exec, 0xffff
    buffer_store_dwordx4 v[28:31], v12, s[40:43], s79 offen sc1
    s_mov_b64 exec, -1
    s_add_u32 s78, s65, 5
    s_and_b32 s78, s78, 15
    s_lshl_b32 s78, s78, 17
    s_lshl_b32 s79, s62, 11
    s_add_u32 m0, s79, 98304
    s_add_u32 s79, s78, 15360
    buffer_load_dwordx4 v26, s[36:39], s78 offen lds
    buffer_load_dwordx4 v26, s[36:39], s79 offen offset:1024 lds
    s_add_u32 s78, s65, 6
    s_and_b32 s78, s78, 15
    s_lshl_b32 s78, s78, 17
    s_lshl_b32 s79, s62, 11
    s_add_u32 m0, s79, 106496
    s_add_u32 s79, s78, 15360
    buffer_load_dwordx4 v26, s[36:39], s78 offen lds
    buffer_load_dwordx4 v26, s[36:39], s79 offen offset:1024 lds
    s_add_u32 s78, s65, 7
    s_and_b32 s78, s78, 15
    s_lshl_b32 s78, s78, 17
    s_lshl_b32 s79, s62, 11
    s_add_u32 m0, s79, 114688
    s_add_u32 s79, s78, 15360
    buffer_load_dwordx4 v26, s[36:39], s78 offen lds
    buffer_load_dwordx4 v26, s[36:39], s79 offen offset:1024 lds
    s_mul_i32 s78, s62, 384
    s_add_u32 s78, s78, s73
    s_add_u32 s78, s78, 2048
    v_lshlrev_b32 v11, 7, v1
    s_mov_b64 exec, 7
    buffer_load_dword v27, v11, s[40:43], s78 offen sc1
    s_mov_b64 exec, -1
    s_waitcnt vmcnt(7)
    s_lshl_b32 s76, s62, 2
    s_add_u32 s76, s76, s73
    v_mov_b32 v4, 0
    s_mov_b64 exec, 1
    s_bitcmp1_b32 s100, 0
    s_cbranch_scc1 L_loc_11
    buffer_store_dword v4, v4, s[40:43], s76 offen offset:2560 sc1
    s_branch L_pubd_12
L_loc_11:
    buffer_store_dword v4, v4, s[40:43], s76 offen offset:2560
L_pubd_12:
    s_mov_b64 exec, -1
    s_add_u32 s78, s65, 8
    s_and_b32 s78, s78, 15
    s_lshl_b32 s78, s78, 17
    s_lshl_b32 s79, s62, 11
    s_add_u32 m0, s79, 122880
    s_add_u32 s79, s78, 15360
    buffer_load_dwordx4 v26, s[36:39], s78 offen lds
    buffer_load_dwordx4 v26, s[36:39], s79 offen offset:1024 lds
    s_add_u32 s78, s65, 9
    s_and_b32 s78, s78, 15
    s_lshl_b32 s78, s78, 17
    s_lshl_b32 s79, s62, 11
    s_add_u32 m0, s79, 131072
    s_add_u32 s79, s78, 15360
    buffer_load_dwordx4 v26, s[36:39], s78 offen lds
    buffer_load_dwordx4 v26, s[36:39], s79 offen offset:1024 lds
    s_add_u32 s78, s65, 10
    s_and_b32 s78, s78, 15
    s_lshl_b32 s78, s78, 17
    s_lshl_b32 s79, s62, 11
    s_add_u32 m0, s79, 139264
    s_add_u32 s79, s78, 15360
    buffer_load_dwordx4 v26, s[36:39], s78 offen lds
    buffer_load_dwordx4 v26, s[36:39], s79 offen offset:1024 lds
    v_and_b32_e64 v65, 15, v1
    v_mul_u32_u24 v65, 460800, v65
    s_mul_i32 s80, s61, 28800
    s_lshl_b32 s82, s62, 2
    s_add_u32 s82, s82, s80
    v_bfe_u32 v4, v1, 4, 1
    v_lshl_add_u32 v4, v4, 1, v3
    s_lshl_b32 s77, s62, 6
    v_lshl_add_u32 v66, v4, 1, s77
    v_bfe_u32 v4, v1, 2, 1
    v_lshl_add_u32 v66, v4, 5, v66
    v_bfe_u32 v4, v1, 0, 1
    v_lshl_add_u32 v66, v4, 4, v66
    v_bfe_u32 v4, v1, 1, 1
    v_lshl_add_u32 v66, v4, 3, v66
    s_lshl_b32 s83, s62, 7
    s_add_u32 s81, s83, s80
    s_add_u32 s68, s81, 3686400
    s_add_u32 s83, s83, s73
    v_and_b32 v4, 7, v1
    v_lshrrev_b32 v5, 4, v1
    v_lshlrev_b32_e64 v5, 2, v5
    v_lshl_add_u32 v67, v4, 4, v5
    v_bfe_u32 v5, v1, 3, 1
    v_lshrrev_b32_e64 v6, 4, v1
    v_lshl_add_u32 v5, v5, 4, v6
    v_mul_u32_u24 v5, 9344, v5
    v_lshl_add_u32 v61, v4, 4, v5
    s_lshr_b32 s69, s97, 1
    s_lshr_b32 s76, s2, 7
    s_lshl2_add_u32 s69, s69, s76
    s_mul_i32 s69, s69, 74752
    s_add_u32 s69, s69, 8389632
    s_barrier
    s_add_u32 s78, s65, 11
    s_and_b32 s78, s78, 15
    s_lshl_b32 s78, s78, 17
    s_lshl_b32 s79, s62, 11
    s_add_u32 m0, s79, 147456
    s_add_u32 s79, s78, 15360
    buffer_load_dwordx4 v26, s[36:39], s78 offen lds
    buffer_load_dwordx4 v26, s[36:39], s79 offen offset:1024 lds
    s_add_u32 s78, s65, 12
    s_and_b32 s78, s78, 15
    s_lshl_b32 s78, s78, 17
    s_lshl_b32 s79, s62, 11
    s_add_u32 m0, s79, 155648
    s_add_u32 s79, s78, 15360
    buffer_load_dwordx4 v26, s[36:39], s78 offen lds
    buffer_load_dwordx4 v26, s[36:39], s79 offen offset:1024 lds
    buffer_load_dword v64, v65, s[40:43], s82 offen offset:2560 sc1
    s_barrier
    s_setprio 3
    v_mov_b32 v4, s89
    v_lshlrev_b32 v5, 2, v1
    ds_write_b32 v5, v4 offset:24832
    v_mov_b32 v70, 0
    v_mov_b32 v71, 0
    ds_write_b64 v70, v[70:71] offset:25984
    s_mov_b32 s88, 0
    s_branch L_p2first_13
L_p2_14:
    buffer_load_dword v64, v65, s[40:43], s82 offen offset:2560 sc1
L_p2first_13:
    s_waitcnt vmcnt(0)
    v_cmp_eq_u32_e64 vcc, -1, v64
    s_nop 0
    s_cbranch_vccz L_ok_15
    s_add_u32 s88, s88, 1
    s_cmp_lt_u32 s88, 65536
    s_cbranch_scc1 L_p2_14
L_ok_15:
    s_add_u32 s78, s65, 13
    s_and_b32 s78, s78, 15
    s_lshl_b32 s78, s78, 17
    s_lshl_b32 s79, s62, 11
    s_add_u32 m0, s79, 32768
    s_add_u32 s79, s78, 15360
    buffer_load_dwordx4 v26, s[36:39], s78 offen lds
    buffer_load_dwordx4 v26, s[36:39], s79 offen offset:1024 lds
    s_add_u32 s78, s65, 14
    s_and_b32 s78, s78, 15
    s_lshl_b32 s78, s78, 17
    s_lshl_b32 s79, s62, 11
    s_add_u32 m0, s79, 40960
    s_add_u32 s79, s78, 15360
    buffer_load_dwordx4 v26, s[36:39], s78 offen lds
    buffer_load_dwordx4 v26, s[36:39], s79 offen offset:1024 lds
    s_add_u32 s78, s65, 15
    s_and_b32 s78, s78, 15
    s_lshl_b32 s78, s78, 17
    s_lshl_b32 s79, s62, 11
    s_add_u32 m0, s79, 49152
    s_add_u32 s79, s78, 15360
    buffer_load_dwordx4 v26, s[36:39], s78 offen lds
    buffer_load_dwordx4 v26, s[36:39], s79 offen offset:1024 lds
    s_lshl_b32 s76, s62, 11
    s_lshl_b32 s77, s60, 7
    s_add_u32 s76, s76, s77
    s_add_u32 s76, s76, s69
    s_add_u32 s77, s76, 37376
    s_mov_b32 s78, 0x00003f80
    s_mov_b32 s79, 0x3f800000
    s_mov_b32 s88, 0
L_poll_16:
    buffer_load_dwordx4 v[32:35], v61, s[40:43], s76 offen sc1
    buffer_load_dwordx4 v[36:39], v61, s[40:43], s77 offen sc1
    s_waitcnt vmcnt(0)
    v_max_u32 v4, v32, v36
    v_cmp_eq_u32_e64 vcc, -1, v4
    s_nop 0
    s_cbranch_vccz L_ok_17
    s_add_u32 s88, s88, 1
    s_cmp_lt_u32 s88, 65536
    s_cbranch_scc1 L_poll_16
L_ok_17:
    v_dot2_f32_bf16 v48, v32, s78, 0
    v_dot2_f32_bf16 v49, v32, s79, 0
    v_dot2_f32_bf16 v50, v33, s78, 0
    v_dot2_f32_bf16 v51, v33, s79, 0
    v_dot2_f32_bf16 v52, v34, s78, 0
    v_dot2_f32_bf16 v53, v34, s79, 0
    v_dot2_f32_bf16 v54, v35, s78, 0
    v_dot2_f32_bf16 v55, v35, s79, 0
    v_dot2_f32_bf16 v48, v36, s78, v48
    v_dot2_f32_bf16 v49, v36, s79, v49
    v_dot2_f32_bf16 v50, v37, s78, v50
    v_dot2_f32_bf16 v51, v37, s79, v51
    v_dot2_f32_bf16 v52, v38, s78, v52
    v_dot2_f32_bf16 v53, v38, s79, v53
    v_dot2_f32_bf16 v54, v39, s78, v54
    v_dot2_f32_bf16 v55, v39, s79, v55
    buffer_load_dwordx4 v[40:43], v13, s[40:43], s81 offen offset:2048 sc1
    buffer_load_dwordx4 v[44:47], v13, s[40:43], s68 offen offset:2048 sc1
    v_permlane32_swap_b32 v48, v52
    v_permlane32_swap_b32 v49, v53
    v_permlane32_swap_b32 v50, v54
    v_permlane32_swap_b32 v51, v55
    v_add_f32 v48, v48, v52
    v_add_f32 v49, v49, v53
    v_add_f32 v50, v50, v54
    v_add_f32 v51, v51, v55
    s_nop 0
    v_permlane16_swap_b32 v48, v50
    v_permlane16_swap_b32 v49, v51
    v_add_f32 v48, v48, v50
    v_add_f32_e64 v49, v49, v51
    s_nop 0
    v_add_f32_dpp v48, v48, v48 row_ror:8 row_mask:0xf bank_mask:0xf
    v_add_f32_dpp v49, v49, v49 row_ror:8 row_mask:0xf bank_mask:0xf
    v_cvt_pk_bf16_f32 v48, v48, v49
    s_bitcmp1_b32 s100, 0
    s_cbranch_scc1 L_loc_18
    buffer_store_dword v48, v67, s[40:43], s83 offen offset:3072 sc1
    s_branch L_pubd_19
L_loc_18:
    buffer_store_dword v48, v67, s[40:43], s83 offen offset:3072
L_pubd_19:
    s_mov_b32 s88, 0
    s_waitcnt vmcnt(1)
    s_branch L_zfirst_20
L_z_21:
    buffer_load_dwordx4 v[40:43], v13, s[40:43], s81 offen offset:2048 sc1
    buffer_load_dwordx4 v[44:47], v13, s[40:43], s68 offen offset:2048 sc1
    s_waitcnt vmcnt(0)
L_zfirst_20:
    v_max3_u32 v4, v40, v41, v42
    v_max3_u32 v4, v4, v43, v44
    v_max3_u32 v4, v4, v45, v46
    v_max_u32 v4, v4, v47
    v_cmp_eq_u32 vcc, -1, v4
    s_nop 0
    s_cbranch_vccz L_ok_22
    s_add_u32 s88, s88, 1
    s_cmp_lt_u32 s88, 65536
    s_cbranch_scc1 L_z_21
L_ok_22:
    v_add_f32 v40, v40, v44
    v_add_f32 v41, v41, v45
    v_add_f32 v42, v42, v46
    v_add_f32 v43, v43, v47
    v_permlane32_swap_b32 v40, v41
    s_nop 0
    v_permlane32_swap_b32 v42, v43
    v_add_f32 v40, v40, v41
    v_add_f32 v42, v42, v43
    s_nop 1
    v_permlane16_swap_b32 v40, v42
    v_add_f32 v40, v40, v42
    s_nop 1
    v_add_f32_dpp v40, v40, v40 row_ror:8 row_mask:0xf bank_mask:0xf
    v_cvt_pk_bf16_f32 v40, v40, v40
    ds_write_b16 v66, v40 offset:24576
    s_waitcnt lgkmcnt(0)
    s_barrier
    s_setprio 0
    s_mov_b64 exec, 3
    global_load_dword v27, v91, s[66:67]
    s_mov_b64 exec, -1
    s_lshl_b32 s78, s97, 18
    s_lshl_b32 s79, s62, 16
    s_add_u32 s78, s78, s79
    s_lshl_b32 s79, s98, 7
    s_add_u32 s78, s78, s79
    s_lshl_b32 s79, s62, 12
    s_add_u32 m0, s79, 0
    s_nop 0
    buffer_load_dwordx4 v78, s[28:31], s78 offen offset:0 lds
    s_add_u32 s78, s78, 15360
    buffer_load_dwordx4 v79, s[28:31], s78 offen offset:1024 lds
    s_add_u32 s78, s78, 15360
    buffer_load_dwordx4 v78, s[28:31], s78 offen offset:2048 lds
    s_add_u32 s78, s78, 15360
    buffer_load_dwordx4 v79, s[28:31], s78 offen offset:3072 lds
    s_mov_b32 s56, s14
    s_and_b32 s57, s15, 0xffff
    s_mov_b32 s58, 2048
    s_mov_b32 s59, 0x20000
    s_lshl_b32 s78, s62, 9
    s_add_u32 m0, s78, 16384
    s_mov_b32 exec_hi, 0
    buffer_load_dwordx4 v12, s[56:59], s78 offen lds
    s_mov_b64 exec, -1
    s_barrier
    s_lshl4_add_u32 s76, s97, s98
    s_mul_i32 s76, s76, 28800
    s_add_u32 s20, s26, s76
    s_addc_u32 s21, s27, 0
    s_cmp_eq_u32 s62, 0
    s_cbranch_scc0 L_now0_25
    s_sleep 2
    s_load_dwordx16 s[4:19], s[20:21], 3584 glc
    s_waitcnt lgkmcnt(0)
    s_and_b64 s[4:5], s[4:5], s[6:7]
    s_and_b64 s[4:5], s[4:5], s[8:9]
    s_and_b64 s[4:5], s[4:5], s[10:11]
    s_and_b64 s[4:5], s[4:5], s[12:13]
    s_and_b64 s[4:5], s[4:5], s[14:15]
    s_and_b64 s[4:5], s[4:5], s[16:17]
    s_and_b64 s[4:5], s[4:5], s[18:19]
    s_nand_b32 s4, s4, s5
    s_and_b32 s4, s4, 0xffff
    s_mul_i32 s4, s4, 0x10001
    s_lshr_b32 s4, s4, s65
    s_and_b32 s77, s4, 0xffff
    v_mov_b32_e64 v69, s77
    ds_write_b32 v70, v69 offset:25984
L_now0_25:
    s_waitcnt vmcnt(0) lgkmcnt(0)
    s_barrier
    s_cmp_eq_u32 s62, 0
    s_cbranch_scc0 L_now1_23
    s_mov_b32 s88, 0
L_spin_26:
    s_load_dwordx16 s[4:19], s[20:21], 3584 glc
    s_waitcnt lgkmcnt(0)
    s_and_b64 s[4:5], s[4:5], s[6:7]
    s_and_b64 s[4:5], s[4:5], s[8:9]
    s_and_b64 s[4:5], s[4:5], s[10:11]
    s_and_b64 s[4:5], s[4:5], s[12:13]
    s_and_b64 s[4:5], s[4:5], s[14:15]
    s_and_b64 s[4:5], s[4:5], s[16:17]
    s_and_b64 s[4:5], s[4:5], s[18:19]
    s_nand_b32 s4, s4, s5
    s_and_b32 s4, s4, 0xffff
    s_mul_i32 s4, s4, 0x10001
    s_lshr_b32 s4, s4, s65
    s_and_b32 s77, s4, 0xffff
    v_mov_b32 v69, s77
    ds_write_b32 v70, v69 offset:25984
    s_cmp_eq_u32 s77, 0xffff
    s_cbranch_scc1 L_s2done_24
    s_add_u32 s88, s88, 1
    s_cmp_lt_u32 s88, 65536
    s_cbranch_scc1 L_spin_26
    s_branch L_s2done_24
L_now1_23:
    s_cmp_eq_u32 s62, 1
    s_cbranch_scc0 L_s2done_24
    s_lshl_b32 s77, 1, s61
    s_not_b32 s77, s77
    v_mov_b32_e64 v4, s77
    v_mul_u32_u24 v5, 28800, v1
    s_mul_i32 s76, s60, 460800
    s_lshl2_add_u32 s76, s61, s76
    s_mov_b32 s88, 0
L_spin_27:
    ds_read_b32 v69, v70 offset:25988
    s_waitcnt lgkmcnt(0)
    v_cmp_eq_u32_e64 vcc, 4, v69
    s_nop 0
    s_cbranch_vccnz L_drained_28
    s_add_u32 s88, s88, 1
    s_cmp_lt_u32 s88, 1048576
    s_cbranch_scc1 L_spin_27
L_drained_28:
    s_mov_b64 exec, 0xffff
    buffer_store_dword v4, v5, s[40:43], s76 offen offset:3584 sc1
    s_mov_b64 exec, -1
L_s2done_24:
    s_waitcnt vmcnt(0)
    v_lshlrev_b32 v17, 5, v2
    v_lshl_add_u32 v17, v3, 4, v17
    v_and_b32 v4, 15, v1
    v_lshrrev_b32 v5, 1, v4
    v_and_b32 v4, 1, v4
    v_lshlrev_b32 v4, 5, v4
    v_lshl_add_u32 v16, v5, 7, v4
    v_lshrrev_b32 v4, 3, v1
    v_and_b32 v5, 7, v1
    v_lshlrev_b32_e64 v5, 4, v5
    v_mul_u32_u24 v18, 9344, v4
    v_add_u32_e64 v18, v18, v5
    v_bfe_u32 v6, v1, 4, 1
    v_lshl_add_u32 v6, v6, 1, v3
    v_lshl_add_u32 v19, v6, 2, v5
    s_mul_i32 s84, s97, 149504
    s_lshl_b32 s77, s98, 7
    s_add_u32 s84, s84, s77
    s_add_u32 s84, s84, 8388608
    s_lshl_b32 s85, s62, 10
    s_add_u32 s85, s85, s99
    s_add_u32 s85, s85, 5120
    s_and_b32 s87, s97, 1
    s_lshl_b32 s87, s87, 4
    s_add_u32 s87, s87, s98
    s_lshr_b32 s86, s97, 1
    s_mul_i32 s86, s86, 299008
    s_lshl_b32 s77, s87, 7
    s_add_u32 s86, s86, s77
    s_add_u32 s86, s86, 8393728
    s_lshl_b32 s78, s62, 11
    s_add_u32 s79, s78, s99
    s_bitcmp1_b32 s100, 1
    s_cbranch_scc1 L_loc_29
    buffer_store_dwordx4 v[28:31], v12, s[40:43], s79 offen offset:1024 sc1
    buffer_store_dwordx4 v[28:31], v12, s[40:43], s79 offen offset:2048 sc1
    s_branch L_pubd_30
L_loc_29:
    buffer_store_dwordx4 v[28:31], v12, s[40:43], s79 offen offset:1024
    buffer_store_dwordx4 v[28:31], v12, s[40:43], s79 offen offset:2048
L_pubd_30:
    s_lshl4_add_u32 s78, s97, s98
    s_lshl4_add_u32 s78, s78, s62
    s_add_u32 s78, s78, 12591116
    s_waitcnt vmcnt(0)
    s_mov_b64 exec, 1
    s_bitcmp1_b32 s100, 1
    s_cbranch_scc1 L_loc_31
    buffer_store_byte v28, v70, s[40:43], s78 offen sc1
    s_branch L_pubd_32
L_loc_31:
    buffer_store_byte v28, v70, s[40:43], s78 offen
L_pubd_32:
    s_mov_b64 exec, -1
    s_cmp_eq_u32 s62, 0
    s_cbranch_scc0 L_nop3c_33
    s_mov_b32 exec_lo, 0
    s_mov_b32 s88, 0
L_spin_34:
    buffer_load_dword v4, v90, s[40:43], 0 offen offset:12 sc1
    s_waitcnt vmcnt(0)
    v_cmp_ne_u32 vcc, -1, v4
    s_nop 0
    s_cbranch_vccz L_p3ok_35
    s_add_u32 s88, s88, 1
    s_cmp_lt_u32 s88, 65536
    s_cbranch_scc1 L_spin_34
L_p3ok_35:
    s_mov_b64 exec, -1
L_nop3c_33:
    s_barrier
    buffer_load_dwordx4 v[156:159], v76, s[48:51], s75 offen nt
    s_add_u32 s75, s75, 7168
    buffer_load_dwordx4 v[32:35], v77, s[52:55], s96 offen nt
    s_add_u32 s96, s96, 4096
    buffer_load_dwordx4 v[36:39], v77, s[52:55], s96 offen nt
    s_add_u32 s96, s96, 4096
    buffer_load_dwordx4 v[40:43], v77, s[52:55], s96 offen nt
    s_add_u32 s96, s96, 4096
    buffer_load_dwordx4 v[44:47], v77, s[52:55], s96 offen nt
    s_add_u32 s96, s96, 4096
    buffer_load_dwordx4 v[48:51], v77, s[52:55], s96 offen nt
    s_add_u32 s96, s96, 4096
    v_mul_u32_u24 v20, 149504, v1
    s_mul_i32 s72, s98, 9344
    s_lshl2_add_u32 s72, s97, s72
    s_add_u32 s72, s72, 8388608
    s_barrier
    s_cmp_eq_u32 s62, 1
    s_cbranch_scc0 L_nopre_36
    s_mov_b64 exec, 0xffff
    buffer_store_dword v70, v20, s[40:43], s72 offen offset:768 sc1
    s_mov_b64 exec, -1
L_nopre_36:
    buffer_load_dwordx4 v[52:55], v77, s[52:55], s96 offen nt
    s_add_u32 s96, s96, 4096
    buffer_load_dwordx4 v[56:59], v77, s[52:55], s96 offen nt
    s_add_u32 s96, s96, 4096
    buffer_load_dwordx4 v[60:63], v77, s[52:55], s96 offen nt
    s_add_u32 s96, s96, 4096
    s_barrier
    s_waitcnt vmcnt(8)
    s_mov_b32 s78, 0x05040100
    s_mov_b32 s79, 0x07060302
    v_perm_b32 v160, v100, v96, s78
    v_perm_b32 v164, v100, v96, s79
    v_perm_b32 v168, v101, v97, s78
    v_perm_b32 v172, v101, v97, s79
    v_perm_b32 v176, v102, v98, s78
    v_perm_b32 v180, v102, v98, s79
    v_perm_b32 v184, v103, v99, s78
    v_perm_b32 v188, v103, v99, s79
    v_perm_b32 v161, v108, v104, s78
    v_perm_b32 v165, v108, v104, s79
    v_perm_b32 v169, v109, v105, s78
    v_perm_b32 v173, v109, v105, s79
    v_perm_b32 v177, v110, v106, s78
    v_perm_b32 v181, v110, v106, s79
    v_perm_b32 v185, v111, v107, s78
    v_perm_b32 v189, v111, v107, s79
    v_perm_b32 v162, v116, v112, s78
    v_perm_b32 v166, v116, v112, s79
    v_perm_b32 v170, v117, v113, s78
    v_perm_b32 v174, v117, v113, s79
    v_perm_b32 v178, v118, v114, s78
    v_perm_b32 v182, v118, v114, s79
    v_perm_b32 v186, v119, v115, s78
    v_perm_b32 v190, v119, v115, s79
    v_perm_b32 v163, v124, v120, s78
    v_perm_b32 v167, v124, v120, s79
    v_perm_b32 v171, v125, v121, s78
    v_perm_b32 v175, v125, v121, s79
    v_perm_b32 v179, v126, v122, s78
    v_perm_b32 v183, v126, v122, s79
    v_perm_b32 v187, v127, v123, s78
    v_perm_b32 v191, v127, v123, s79
    v_perm_b32 v192, v132, v128, s78
    v_perm_b32 v196, v132, v128, s79
    v_perm_b32 v200, v133, v129, s78
    v_perm_b32 v204, v133, v129, s79
    v_perm_b32 v208, v134, v130, s78
    v_perm_b32 v212, v134, v130, s79
    v_perm_b32 v216, v135, v131, s78
    v_perm_b32 v220, v135, v131, s79
    v_perm_b32 v193, v140, v136, s78
    v_perm_b32 v197, v140, v136, s79
    v_perm_b32 v201, v141, v137, s78
    v_perm_b32 v205, v141, v137, s79
    v_perm_b32 v209, v142, v138, s78
    v_perm_b32 v213, v142, v138, s79
    v_perm_b32 v217, v143, v139, s78
    v_perm_b32 v221, v143, v139, s79
    v_perm_b32 v194, v148, v144, s78
    v_perm_b32 v198, v148, v144, s79
    v_perm_b32 v202, v149, v145, s78
    v_perm_b32 v206, v149, v145, s79
    v_perm_b32 v210, v150, v146, s78
    v_perm_b32 v214, v150, v146, s79
    v_perm_b32 v218, v151, v147, s78
    v_perm_b32 v222, v151, v147, s79
    v_perm_b32 v195, v156, v152, s78
    v_perm_b32 v199, v156, v152, s79
    v_perm_b32 v203, v157, v153, s78
    v_perm_b32 v207, v157, v153, s79
    v_perm_b32 v211, v158, v154, s78
    v_perm_b32 v215, v158, v154, s79
    v_perm_b32 v219, v159, v155, s78
    v_perm_b32 v223, v159, v155, s79
    s_waitcnt vmcnt(6)
    s_mov_b32 s78, 0x05040100
    s_mov_b32 s79, 0x07060302
    v_permlane32_swap_b32 v32, v34
    v_permlane32_swap_b32 v33, v35
    v_permlane32_swap_b32 v36, v38
    v_permlane32_swap_b32_e64 v37, v39
    v_perm_b32 v224, v34, v32, s78
    v_perm_b32 v225, v34, v32, s79
    v_perm_b32 v226, v35, v33, s78
    v_perm_b32 v227, v35, v33, s79
    v_perm_b32 v228, v38, v36, s78
    v_perm_b32 v229, v38, v36, s79
    v_perm_b32 v230, v39, v37, s78
    v_perm_b32 v231, v39, v37, s79
    s_waitcnt vmcnt(4)
    s_mov_b32 s78, 0x05040100
    s_mov_b32 s79, 0x07060302
    v_permlane32_swap_b32 v40, v42
    v_permlane32_swap_b32 v41, v43
    v_permlane32_swap_b32 v44, v46
    v_permlane32_swap_b32_e64 v45, v47
    v_perm_b32 v232, v42, v40, s78
    v_perm_b32 v233, v42, v40, s79
    v_perm_b32 v234, v43, v41, s78
    v_perm_b32 v235, v43, v41, s79
    v_perm_b32 v236, v46, v44, s78
    v_perm_b32 v237, v46, v44, s79
    v_perm_b32 v238, v47, v45, s78
    v_perm_b32 v239, v47, v45, s79
    s_waitcnt vmcnt(2)
    s_mov_b32 s78, 0x05040100
    s_mov_b32 s79, 0x07060302
    v_permlane32_swap_b32 v48, v50
    v_permlane32_swap_b32 v49, v51
    v_permlane32_swap_b32 v52, v54
    v_permlane32_swap_b32_e64 v53, v55
    v_perm_b32 v240, v50, v48, s78
    v_perm_b32 v241, v50, v48, s79
    v_perm_b32 v242, v51, v49, s78
    v_perm_b32 v243, v51, v49, s79
    v_perm_b32 v244, v54, v52, s78
    v_perm_b32 v245, v54, v52, s79
    v_perm_b32 v246, v55, v53, s78
    v_perm_b32 v247, v55, v53, s79
    s_waitcnt vmcnt(0)
    s_mov_b32 s78, 0x05040100
    s_mov_b32 s79, 0x07060302
    v_permlane32_swap_b32 v56, v58
    v_permlane32_swap_b32 v57, v59
    v_permlane32_swap_b32 v60, v62
    v_permlane32_swap_b32_e64 v61, v63
    v_perm_b32 v248, v58, v56, s78
    v_perm_b32 v249, v58, v56, s79
    v_perm_b32 v250, v59, v57, s78
    v_perm_b32 v251, v59, v57, s79
    v_perm_b32 v252, v62, v60, s78
    v_perm_b32 v253, v62, v60, s79
    v_perm_b32 v254, v63, v61, s78
    v_perm_b32 v255, v63, v61, s79
    v_and_b32 v5, 15, v1
    v_lshlrev_b32 v5, 3, v5
    s_lshl_b32 s76, s63, 10
    s_lshl_b32 s77, s64, 6
    s_add_u32 s76, s76, s77
    s_add_u32 s76, s76, s99
    s_mov_b64 s[80:81], 0xffff
    s_add_u32 s68, s84, 74752
    s_add_u32 s69, s86, 74752
    s_add_u32 s70, s86, 149504
    s_add_u32 s71, s86, 224256
    s_setprio 3
    s_barrier
    ds_read_b128 v[64:67], v12 offset:28672
    ds_read_b128 v[68:71], v12 offset:29696
    ds_read_b64 v[8:9], v5 offset:25728
    s_waitcnt lgkmcnt(2)
    v_mfma_f32_16x16x32_bf16 v[96:99], v[64:67], v[160:163], 0
    v_mfma_f32_16x16x32_bf16 v[100:103], v[64:67], v[164:167], 0
    s_waitcnt lgkmcnt(0)
    v_max_f32_dpp v4, v8, v8 row_ror:8 row_mask:0xf bank_mask:0xf
    v_mfma_f32_16x16x32_bf16 v[104:107], v[64:67], v[168:171], 0
    v_mfma_f32_16x16x32_bf16 v[108:111], v[64:67], v[172:175], 0
    v_max_f32_dpp v4, v4, v4 row_ror:4 row_mask:0xf bank_mask:0xf
    v_mfma_f32_16x16x32_bf16 v[112:115], v[64:67], v[176:179], 0
    v_mfma_f32_16x16x32_bf16 v[116:119], v[64:67], v[180:183], 0
    v_max_f32_dpp v4, v4, v4 row_ror:2 row_mask:0xf bank_mask:0xf
    v_mfma_f32_16x16x32_bf16 v[120:123], v[64:67], v[184:187], 0
    v_mfma_f32_16x16x32_bf16 v[124:127], v[64:67], v[188:191], 0
    v_max_f32_dpp v4, v4, v4 row_ror:1 row_mask:0xf bank_mask:0xf
    v_mfma_f32_16x16x32_bf16 v[96:99], v[68:71], v[192:195], v[96:99]
    v_cmp_eq_f32_e64 vcc, v4, v8
    v_mfma_f32_16x16x32_bf16 v[100:103], v[68:71], v[196:199], v[100:103]
    s_ff1_i32_b32 s92, vcc_lo
    s_and_b32 s92, s92, 15
    v_mfma_f32_16x16x32_bf16 v[104:107], v[68:71], v[200:203], v[104:107]
    s_lshr_b32 s78, s92, 2
    s_lshl_b32 s78, s78, 4
    v_mfma_f32_16x16x32_bf16 v[108:111], v[68:71], v[204:207], v[108:111]
    s_and_b32 s77, s92, 3
    v_mfma_f32_16x16x32_bf16 v[112:115], v[68:71], v[208:211], v[112:115]
    v_readlane_b32 s91, v9, s92
    v_readlane_b32 s93, v8, s92
    v_mfma_f32_16x16x32_bf16 v[116:119], v[68:71], v[212:215], v[116:119]
    v_mfma_f32_16x16x32_bf16 v[120:123], v[68:71], v[216:219], v[120:123]
    v_mfma_f32_16x16x32_bf16 v[124:127], v[68:71], v[220:223], v[124:127]
    s_cmp_ge_u32 s97, 14
    s_cbranch_scc1 L_final
    s_cmp_eq_u32 s77, 0
    s_cbranch_scc0 L_sel_38
    v_mov_b32 v64, v96
    v_mov_b32 v65, v100
    v_mov_b32 v66, v104
    v_mov_b32 v67, v108
    v_mov_b32 v68, v112
    v_mov_b32 v69, v116
    v_mov_b32 v70, v120
    v_mov_b32 v71, v124
    s_branch L_seldone_37
L_sel_38:
    s_cmp_eq_u32 s77, 1
    s_cbranch_scc0 L_sel_39
    v_mov_b32 v64, v97
    v_mov_b32 v65, v101
    v_mov_b32 v66, v105
    v_mov_b32 v67, v109
    v_mov_b32 v68, v113
    v_mov_b32 v69, v117
    v_mov_b32 v70, v121
    v_mov_b32 v71, v125
    s_branch L_seldone_37
L_sel_39:
    s_cmp_eq_u32 s77, 2
    s_cbranch_scc0 L_sel_40
    v_mov_b32 v64, v98
    v_mov_b32 v65, v102
    v_mov_b32 v66, v106
    v_mov_b32 v67, v110
    v_mov_b32 v68, v114
    v_mov_b32 v69, v118
    v_mov_b32 v70, v122
    v_mov_b32 v71, v126
    s_branch L_seldone_37
L_sel_40:
    v_mov_b32 v64, v99
    v_mov_b32 v65, v103
    v_mov_b32 v66, v107
    v_mov_b32 v67, v111
    v_mov_b32 v68, v115
    v_mov_b32 v69, v119
    v_mov_b32 v70, v123
    v_mov_b32_e64 v71, v127
L_seldone_37:
    s_lshl_b64 exec, s[80:81], s78
    s_bitcmp1_b32 s100, 1
    s_cbranch_scc1 L_loc_42
    buffer_store_dwordx4 v[64:67], v16, s[40:43], s76 offen offset:3072 sc1
    buffer_store_dwordx4 v[68:71], v16, s[40:43], s76 offen offset:3088 sc1
    s_branch L_pubd_43
L_loc_42:
    buffer_store_dwordx4 v[64:67], v16, s[40:43], s76 offen offset:3072
    buffer_store_dwordx4 v[68:71], v16, s[40:43], s76 offen offset:3088
L_pubd_43:
    s_mov_b64 exec, -1
    s_mov_b32 s88, 0
L_poll_44:
    buffer_load_dwordx4 v[128:131], v18, s[40:43], s84 offen offset:3072 sc1
    buffer_load_dwordx4 v[132:135], v18, s[40:43], s68 offen offset:3072 sc1
    s_waitcnt vmcnt(0)
    v_max_u32 v4, v128, v132
    v_cmp_eq_u32_e64 vcc, -1, v4
    s_nop 0
    s_cbranch_vccz L_ok_45
    s_add_u32 s88, s88, 1
    s_cmp_lt_u32 s88, 65536
    s_cbranch_scc1 L_poll_44
L_ok_45:
    v_pk_add_f32 v[48:49], v[128:129], v[132:133]
    v_pk_add_f32 v[50:51], v[130:131], v[134:135]
    s_nop 0
    v_permlane32_swap_b32 v48, v49
    v_permlane32_swap_b32 v50, v51
    v_add_f32 v48, v48, v49
    v_add_f32 v50, v50, v51
    s_nop 1
    v_permlane16_swap_b32 v48, v50
    v_add_f32 v48, v48, v50
    s_nop 1
    v_add_f32_dpp v48, v48, v48 row_ror:8 row_mask:0xf bank_mask:0xf
    v_cvt_pk_bf16_f32 v48, v48, v48
    v_and_b32_e64 v48, s90, v48
    v_mul_f32 v4, 0xbfb8aa3b, v48
    v_exp_f32_e64 v4, v4
    v_mov_b32_dpp v49, v48 row_ror:12 row_mask:0xf bank_mask:0xf
    v_add_f32 v4, 1.0, v4
    v_rcp_f32 v4, v4
    s_nop 0
    v_mul_f32 v4, v4, v48
    v_cvt_pk_bf16_f32 v4, v4, v4
    v_and_b32 v4, s90, v4
    v_mul_f32 v4, v4, v49
    v_mov_b32 v5, v4
    s_nop 1
    v_permlane32_swap_b32_e64 v4, v5
    v_cvt_pk_bf16_f32 v4, v4, v5
    s_nop 0
    v_readlane_b32 s76, v4, 0
    v_readlane_b32 s77, v4, 16
    v_readlane_b32 s78, v4, 1
    v_readlane_b32 s79, v4, 17
    v_readlane_b32 s80, v4, 2
    v_readlane_b32 s81, v4, 18
    v_readlane_b32 s82, v4, 3
    v_readlane_b32 s83, v4, 19
    v_dot2_f32_bf16 v40, v224, s76, 0
    v_dot2_f32_bf16 v41, v225, s76, 0
    v_dot2_f32_bf16 v42, v226, s76, 0
    v_dot2_f32_bf16 v43, v227, s76, 0
    v_dot2_f32_bf16 v40, v228, s77, v40
    v_dot2_f32_bf16 v41, v229, s77, v41
    v_dot2_f32_bf16 v42, v230, s77, v42
    v_dot2_f32_bf16 v43, v231, s77, v43
    v_dot2_f32_bf16 v40, v232, s78, v40
    v_dot2_f32_bf16 v41, v233, s78, v41
    v_dot2_f32_bf16 v42, v234, s78, v42
    v_dot2_f32_bf16 v43, v235, s78, v43
    v_dot2_f32_bf16 v40, v236, s79, v40
    v_dot2_f32_bf16 v41, v237, s79, v41
    v_dot2_f32_bf16 v42, v238, s79, v42
    v_dot2_f32_bf16 v43, v239, s79, v43
    v_dot2_f32_bf16 v40, v240, s80, v40
    v_dot2_f32_bf16 v41, v241, s80, v41
    v_dot2_f32_bf16 v42, v242, s80, v42
    v_dot2_f32_bf16 v43, v243, s80, v43
    v_dot2_f32_bf16 v40, v244, s81, v40
    v_dot2_f32_bf16 v41, v245, s81, v41
    v_dot2_f32_bf16 v42, v246, s81, v42
    v_dot2_f32_bf16 v43, v247, s81, v43
    v_dot2_f32_bf16 v40, v248, s82, v40
    v_dot2_f32_bf16 v41, v249, s82, v41
    v_dot2_f32_bf16 v42, v250, s82, v42
    v_dot2_f32_bf16 v43, v251, s82, v43
    v_dot2_f32_bf16 v40, v252, s83, v40
    v_dot2_f32_bf16 v41, v253, s83, v41
    v_dot2_f32_bf16 v42, v254, s83, v42
    v_dot2_f32_bf16 v43, v255, s83, v43
    s_bitcmp1_b32 s100, 1
    s_cbranch_scc1 L_loc_46
    s_nop 0
    buffer_store_dwordx4 v[40:43], v17, s[40:43], s85 offen sc1
    s_branch L_pubd_47
L_loc_46:
    s_nop 0
    buffer_store_dwordx4 v[40:43], v17, s[40:43], s85 offen
L_pubd_47:
    s_cmp_eq_u32 s62, 0
    s_cbranch_scc0 L_hby
    s_mov_b32 s88, 0
L_poll_48:
    buffer_load_dwordx4 v[136:139], v18, s[40:43], s86 offen sc1
    buffer_load_dwordx4 v[140:143], v18, s[40:43], s69 offen sc1
    buffer_load_dwordx4 v[144:147], v18, s[40:43], s70 offen sc1
    buffer_load_dwordx4 v[148:151], v18, s[40:43], s71 offen sc1
    s_waitcnt vmcnt(0)
    v_max3_u32 v4, v136, v140, v144
    v_max_u32 v4, v4, v148
    v_cmp_eq_u32_e64 vcc, -1, v4
    s_nop 0
    s_cbranch_vccz L_ok_49
    s_add_u32 s88, s88, 1
    s_cmp_lt_u32 s88, 65536
    s_cbranch_scc1 L_poll_48
L_ok_49:
    v_pk_add_f32 v[48:49], v[136:137], v[144:145]
    v_pk_add_f32 v[50:51], v[138:139], v[146:147]
    v_pk_add_f32 v[52:53], v[140:141], v[148:149]
    v_pk_add_f32 v[54:55], v[142:143], v[150:151]
    v_pk_add_f32 v[48:49], v[48:49], v[52:53]
    v_pk_add_f32 v[50:51], v[50:51], v[54:55]
    s_nop 0
    v_permlane32_swap_b32 v48, v49
    v_permlane32_swap_b32 v50, v51
    v_add_f32 v48, v48, v49
    v_add_f32 v50, v50, v51
    s_nop 1
    v_permlane16_swap_b32 v48, v50
    v_add_f32 v48, v48, v50
    s_nop 1
    v_add_f32_dpp v48, v48, v48 row_ror:8 row_mask:0xf bank_mask:0xf
    buffer_store_dword v48, v19, s[40:43], s99 offen offset:512 sc1
L_hby:
    s_barrier
    s_lshl2_add_u32 s72, s87, s62
    s_cmp_eq_u32 s72, 0
    s_cbranch_scc0 L_nowb_50
    s_waitcnt vmcnt(0)
    buffer_wbl2 sc1
L_nowb_50:
    s_branch L_hfin
L_final:
    s_barrier
    s_lshl2_add_u32 s72, s87, s62
    s_cmp_eq_u32 s72, 3
    s_cbranch_scc0 L_nowb_51
    s_waitcnt vmcnt(0)
    buffer_wbl2 sc1
L_nowb_51:
    s_cmp_eq_u32 s62, 1
    s_cbranch_scc0 L_noep_52
    s_cmp_eq_u32 s87, 0
    s_cbranch_scc0 L_noep_52
    v_mov_b32 v4, 13631488
    s_mov_b64 exec, 1
    buffer_store_dwordx2 v[88:89], v4, s[40:43], 0 offen sc1
    s_mov_b64 exec, -1
L_noep_52:
    s_cmp_eq_u32 s62, 0
    s_cbranch_scc0 L_hfin
    v_mov_b32 v8, s93
    v_cvt_pk_bf16_f32 v8, v8, v8
    v_and_b32_e64 v8, s90, v8
    v_mul_f32 v8, 0xbfb8aa3b, v8
    v_exp_f32 v8, v8
    s_nop 0
    v_add_f32 v8, 1.0, v8
    v_rcp_f32_e64 v8, v8
    s_nop 0
    v_cvt_pk_bf16_f32 v8, v8, v8
    v_and_b32 v8, s90, v8
    s_lshl_b32 s76, s92, 4
    s_lshr_b32 s77, s87, 1
    s_add_u32 s76, s76, s77
    s_mul_i32 s76, s76, 9344
    s_add_u32 s76, s76, 8388608
    s_and_b32 s77, s87, 1
    s_lshl_b32 s77, s77, 5
    s_add_u32 s76, s76, s77
    v_and_b32 v10, 1, v1
    v_lshlrev_b32_e64 v10, 6, v10
    v_bfe_u32 v4, v1, 1, 2
    v_lshl_add_u32 v10, v4, 3, v10
    v_bfe_u32 v4, v1, 4, 1
    v_lshl_add_u32 v10, v4, 2, v10
    v_lshrrev_b32_e64 v4, 3, v1
    v_mul_u32_u24 v6, 299008, v4
    v_and_b32_e64 v5, 7, v1
    v_lshl_add_u32 v6, v5, 4, v6
    v_mov_b32 v7, 2146435072
    v_cmp_gt_u32 vcc, 56, v1
    s_nop 1
    v_cndmask_b32_e64 v6, v7, v6, vcc
    s_mul_i32 s79, s87, 9344
    s_add_u32 s79, s79, 8388608
    s_lshl_b32 s80, s91, 11
    s_lshl_b32 s77, s87, 6
    s_add_u32 s80, s80, s77
    s_sleep 16
    s_mov_b32 s88, 0
L_spin_53:
    buffer_load_dword v64, v10, s[40:43], s76 offen offset:0 sc1
    buffer_load_dword v65, v10, s[40:43], s76 offen offset:128 sc1
    s_waitcnt vmcnt(0)
    v_max_u32 v4, v64, v65
    v_cmp_eq_u32_e64 vcc, -1, v4
    s_nop 0
    s_cbranch_vccz L_ok_54
    s_add_u32 s88, s88, 1
    s_cmp_lt_u32 s88, 65536
    s_cbranch_scc1 L_spin_53
L_ok_54:
    v_lshlrev_b32 v4, 4, v3
    v_lshrrev_b32 v64, v4, v64
    v_lshrrev_b32 v65, v4, v65
    v_lshlrev_b32 v64, 16, v64
    v_lshlrev_b32 v65, 16, v65
    v_lshrrev_b32 v9, 1, v19
    s_mov_b32 s88, 0
    buffer_load_dwordx4 v[128:131], v6, s[40:43], s79 offen offset:512 sc1
    s_sleep 3
    buffer_load_dwordx4 v[128:131], v6, s[40:43], s79 offen offset:512 sc1
    s_sleep 3
L_poll_55:
    buffer_load_dwordx4 v[128:131], v6, s[40:43], s79 offen offset:512 sc1
    s_waitcnt vmcnt(2)
    v_max3_u32 v4, v128, v129, v130
    v_max_u32 v4, v4, v131
    v_cmp_eq_u32 vcc, -1, v4
    s_nop 0
    s_cbranch_vccz L_ok_56
    s_add_u32 s88, s88, 1
    s_cmp_lt_u32 s88, 65536
    s_cbranch_scc1 L_poll_55
L_ok_56:
    v_mov_b32 v48, v128
    v_mov_b32 v49, v129
    v_mov_b32 v50, v130
    v_mov_b32 v51, v131
    v_permlane32_swap_b32 v48, v49
    s_nop 0
    v_permlane32_swap_b32 v50, v51
    v_add_f32 v48, v48, v49
    v_add_f32 v50, v50, v51
    s_nop 1
    v_permlane16_swap_b32 v48, v50
    v_add_f32 v48, v48, v50
    s_nop 1
    v_add_f32_dpp v48, v48, v48 row_ror:8 row_mask:0xf bank_mask:0xf
    v_cvt_pk_bf16_f32 v48, v48, v48
    v_and_b32 v48, s90, v48
    v_mul_f32 v48, v48, v8
    v_cvt_pk_bf16_f32 v48, v48, v48
    v_and_b32 v48, s90, v48
    v_add_f32 v48, v48, v64
    v_cvt_pk_bf16_f32 v48, v48, v48
    v_and_b32 v48, s90, v48
    v_add_f32 v48, v48, v65
    v_cvt_pk_bf16_f32 v48, v48, v48
    s_mov_b32 exec_lo, 0x00ff00ff
    s_mov_b32 exec_hi, 0x00ff00ff
    buffer_store_short v48, v9, s[44:47], s80 offen sc1
    s_mov_b64 exec, -1
L_hfin:
    s_endpgm
L_event:
    s_cmp_eq_u32 s77, 3
    s_cbranch_scc0 L_ev1
    buffer_load_dwordx4 v[92:95], v90, s[40:43], 0 offen sc1
    s_mov_b64 exec, 3
    global_load_dword v27, v91, s[66:67]
    s_mov_b64 exec, -1
    s_branch L_evret
L_ev1:
    s_cmp_eq_u32 s77, 5
    s_cbranch_scc0 L_ev_57
    s_and_b32 s72, s84, 15
    s_mov_b32 m0, s70
    s_lshl_b32 s71, s72, 7
    buffer_load_dwordx4 v16, s[28:31], s71 offen offset:0 lds
    s_mul_i32 s72, s72, 393216
    s_lshr_b64 s[84:85], s[84:85], 4
    buffer_load_dwordx4 v17, s[28:31], s71 offen offset:1024 lds
    buffer_load_dwordx4 v18, s[28:31], s71 offen offset:2048 lds
    buffer_load_dwordx4 v19, s[28:31], s71 offen offset:3072 lds
    s_add_u32 m0, s70, 4096
    s_nop 0
    buffer_load_dwordx4 v20, s[32:35], s72 offen offset:0 lds
    buffer_load_dwordx4 v21, s[32:35], s72 offen offset:1024 lds
    buffer_load_dwordx4 v22, s[32:35], s72 offen offset:2048 lds
    buffer_load_dwordx4 v23, s[32:35], s72 offen offset:3072 lds
    s_add_u32 m0, s70, 8192
    s_nop 0
    buffer_load_dwordx4 v24, s[32:35], s72 offen offset:0 lds
    buffer_load_dwordx4 v25, s[32:35], s72 offen offset:1024 lds
    s_add_u32 s70, s70, 40960
    s_cmp_ge_u32 s70, 122880
    s_cselect_b32 s76, 122880, 0
    s_sub_u32 s70, s70, s76
    buffer_load_dwordx4 v[96:99], v76, s[48:51], s75 offen nt
    s_add_u32 s75, s75, 7168
    buffer_load_dwordx4 v[100:103], v76, s[48:51], s75 offen nt
    s_add_u32 s75, s75, 7168
    buffer_load_dwordx4 v[104:107], v76, s[48:51], s75 offen nt
    s_add_u32 s75, s75, 7168
    buffer_load_dwordx4 v[108:111], v76, s[48:51], s75 offen nt
    s_add_u32 s75, s75, 7168
    buffer_load_dwordx4 v[128:131], v76, s[48:51], s75 offen nt
    s_add_u32 s75, s75, 7168
    buffer_load_dwordx4 v[132:135], v76, s[48:51], s75 offen nt
    s_add_u32 s75, s75, 7168
    buffer_load_dwordx4 v[136:139], v76, s[48:51], s75 offen nt
    s_add_u32 s75, s75, 7168
    buffer_load_dwordx4 v[140:143], v76, s[48:51], s75 offen nt
    s_add_u32 s75, s75, 7168
    s_waitcnt vmcnt(18)
    s_branch L_hbar
L_ev_57:
    s_cmp_eq_u32 s77, 6
    s_cbranch_scc0 L_ev_58
    s_and_b32 s72, s84, 15
    s_mov_b32 m0, s70
    s_lshl_b32 s71, s72, 7
    buffer_load_dwordx4 v16, s[28:31], s71 offen offset:0 lds
    s_mul_i32 s72, s72, 393216
    s_lshr_b64 s[84:85], s[84:85], 4
    buffer_load_dwordx4 v17, s[28:31], s71 offen offset:1024 lds
    buffer_load_dwordx4 v18, s[28:31], s71 offen offset:2048 lds
    buffer_load_dwordx4 v19, s[28:31], s71 offen offset:3072 lds
    s_add_u32 m0, s70, 4096
    s_nop 0
    buffer_load_dwordx4 v20, s[32:35], s72 offen offset:0 lds
    buffer_load_dwordx4 v21, s[32:35], s72 offen offset:1024 lds
    buffer_load_dwordx4 v22, s[32:35], s72 offen offset:2048 lds
    buffer_load_dwordx4 v23, s[32:35], s72 offen offset:3072 lds
    s_add_u32 m0, s70, 8192
    s_nop 0
    buffer_load_dwordx4 v24, s[32:35], s72 offen offset:0 lds
    buffer_load_dwordx4 v25, s[32:35], s72 offen offset:1024 lds
    s_add_u32 s70, s70, 40960
    s_cmp_ge_u32 s70, 122880
    s_cselect_b32 s76, 122880, 0
    s_sub_u32 s70, s70, s76
    s_lshr_b32 s78, s2, 3
    s_lshl2_add_u32 s78, s78, s62
    s_lshl_b32 s78, s78, 14
    v_lshlrev_b32_e64 v11, 10, v1
    s_mov_b64 exec, 65535
    buffer_load_dword v27, v11, s[36:39], s78 offen offset:384
    s_mov_b64 exec, -1
    s_lshl_b32 s78, s62, 9
    v_lshl_add_u32 v11, v1, 7, s78
    s_mov_b64 exec, 15
    global_load_dword v27, v11, s[14:15]
    s_mov_b64 exec, -1
    buffer_load_dwordx4 v[112:115], v76, s[48:51], s75 offen nt
    s_add_u32 s75, s75, 7168
    buffer_load_dwordx4 v[116:119], v76, s[48:51], s75 offen nt
    s_add_u32 s75, s75, 7168
    buffer_load_dwordx4 v[120:123], v76, s[48:51], s75 offen nt
    s_add_u32 s75, s75, 7168
    buffer_load_dwordx4 v[124:127], v76, s[48:51], s75 offen nt
    s_add_u32 s75, s75, 7168
    buffer_load_dwordx4 v[144:147], v76, s[48:51], s75 offen nt
    s_add_u32 s75, s75, 7168
    buffer_load_dwordx4 v[148:151], v76, s[48:51], s75 offen nt
    s_add_u32 s75, s75, 7168
    s_waitcnt vmcnt(18)
    s_branch L_hbar
L_ev_58:
    s_add_u32 s78, s70, 40960
    s_cmp_ge_u32 s78, 122880
    s_cselect_b32 s76, 122880, 0
    s_sub_u32 s78, s78, s76
    s_cmp_eq_u32 s77, 2
    s_cbranch_scc1 L_evw
    v_add_u32 v4, s78, v72
    v_xor_b32 v5, 32, v4
    v_xor_b32 v6, 64, v4
    v_xor_b32 v7, 96, v4
    s_and_b32 s72, s84, 15
    s_mov_b32 m0, s70
    s_lshl_b32 s71, s72, 7
    buffer_load_dwordx4 v16, s[28:31], s71 offen offset:0 lds
    s_mul_i32 s72, s72, 393216
    s_lshr_b64 s[84:85], s[84:85], 4
    ds_read_b128 v[32:35], v4
    ds_read_b128 v[36:39], v5
    ds_read_b128 v[40:43], v6
    ds_read_b128 v[44:47], v7
    buffer_load_dwordx4 v17, s[28:31], s71 offen offset:1024 lds
    s_lshl_b32 s79, s62, 8
    s_add_u32 s79, s79, s73
    s_waitcnt lgkmcnt(0)
    v_lshlrev_b32 v80, 16, v32
    v_and_b32 v82, s90, v32
    v_mul_f32 v81, v80, v80
    v_mul_f32 v83, v82, v82
    v_lshlrev_b32 v10, 16, v33
    v_and_b32 v11, s90, v33
    v_add_f32 v80, v80, v10
    v_add_f32 v82, v82, v11
    v_fmac_f32 v81, v10, v10
    v_fmac_f32 v83, v11, v11
    v_lshlrev_b32 v8, 16, v34
    v_and_b32_e64 v9, s90, v34
    buffer_load_dwordx4 v18, s[28:31], s71 offen offset:2048 lds
    v_add_f32 v80, v80, v8
    v_add_f32 v82, v82, v9
    v_fmac_f32 v81, v8, v8
    v_fmac_f32 v83, v9, v9
    v_lshlrev_b32 v10, 16, v35
    v_and_b32 v11, s90, v35
    v_add_f32 v80, v80, v10
    v_add_f32 v82, v82, v11
    v_fmac_f32 v81, v10, v10
    v_fmac_f32 v83, v11, v11
    v_lshlrev_b32 v8, 16, v36
    v_and_b32 v9, s90, v36
    buffer_load_dwordx4 v19, s[28:31], s71 offen offset:3072 lds
    v_add_f32 v80, v80, v8
    v_add_f32 v82, v82, v9
    v_fmac_f32 v81, v8, v8
    v_fmac_f32 v83, v9, v9
    v_lshlrev_b32 v10, 16, v37
    v_and_b32 v11, s90, v37
    v_add_f32 v80, v80, v10
    v_add_f32 v82, v82, v11
    v_fmac_f32 v81, v10, v10
    v_fmac_f32 v83, v11, v11
    v_lshlrev_b32 v8, 16, v38
    v_and_b32 v9, s90, v38
    s_add_u32 m0, s70, 4096
    s_nop 0
    buffer_load_dwordx4 v20, s[32:35], s72 offen offset:0 lds
    v_add_f32 v80, v80, v8
    v_add_f32 v82, v82, v9
    v_fmac_f32 v81, v8, v8
    v_fmac_f32 v83, v9, v9
    v_lshlrev_b32 v10, 16, v39
    v_and_b32 v11, s90, v39
    v_add_f32 v80, v80, v10
    v_add_f32 v82, v82, v11
    v_fmac_f32 v81, v10, v10
    v_fmac_f32 v83, v11, v11
    v_lshlrev_b32 v8, 16, v40
    v_and_b32_e64 v9, s90, v40
    buffer_load_dwordx4 v21, s[32:35], s72 offen offset:1024 lds
    v_add_f32 v80, v80, v8
    v_add_f32 v82, v82, v9
    v_fmac_f32 v81, v8, v8
    v_fmac_f32 v83, v9, v9
    v_lshlrev_b32 v10, 16, v41
    v_and_b32 v11, s90, v41
    v_add_f32 v80, v80, v10
    v_add_f32 v82, v82, v11
    v_fmac_f32 v81, v10, v10
    v_fmac_f32 v83, v11, v11
    v_lshlrev_b32 v8, 16, v42
    v_and_b32 v9, s90, v42
    buffer_load_dwordx4 v22, s[32:35], s72 offen offset:2048 lds
    v_add_f32 v80, v80, v8
    v_add_f32 v82, v82, v9
    v_fmac_f32 v81, v8, v8
    v_fmac_f32 v83, v9, v9
    v_lshlrev_b32 v10, 16, v43
    v_and_b32 v11, s90, v43
    v_add_f32 v80, v80, v10
    v_add_f32 v82, v82, v11
    v_fmac_f32 v81, v10, v10
    v_fmac_f32 v83, v11, v11
    v_lshlrev_b32 v8, 16, v44
    v_and_b32 v9, s90, v44
    buffer_load_dwordx4 v23, s[32:35], s72 offen offset:3072 lds
    v_add_f32 v80, v80, v8
    v_add_f32 v82, v82, v9
    v_fmac_f32 v81, v8, v8
    v_fmac_f32 v83, v9, v9
    v_lshlrev_b32 v10, 16, v45
    v_and_b32 v11, s90, v45
    v_add_f32 v80, v80, v10
    v_add_f32 v82, v82, v11
    v_fmac_f32 v81, v10, v10
    v_fmac_f32 v83, v11, v11
    v_lshlrev_b32 v8, 16, v46
    v_and_b32 v9, s90, v46
    s_add_u32 m0, s70, 8192
    s_nop 0
    buffer_load_dwordx4 v24, s[32:35], s72 offen offset:0 lds
    v_add_f32 v80, v80, v8
    v_add_f32 v82, v82, v9
    v_fmac_f32 v81, v8, v8
    v_fmac_f32 v83, v9, v9
    v_lshlrev_b32 v10, 16, v47
    v_and_b32 v11, s90, v47
    v_add_f32 v80, v80, v10
    v_add_f32 v82, v82, v11
    v_fmac_f32 v81, v10, v10
    v_fmac_f32_e64 v83, v11, v11
    buffer_load_dwordx4 v25, s[32:35], s72 offen offset:1024 lds
    s_add_u32 s70, s70, 40960
    s_cmp_ge_u32 s70, 122880
    s_cselect_b32 s76, 122880, 0
    s_sub_u32 s70, s70, s76
    v_add_f32 v80, v80, v82
    v_add_f32 v81, v81, v83
    v_mov_b32 v82, v80
    v_mov_b32 v83, v81
    s_nop 0
    v_permlane32_swap_b32 v80, v82
    v_permlane32_swap_b32 v81, v83
    v_add_f32 v80, v80, v82
    v_add_f32_e64 v81, v81, v83
    s_mov_b32 exec_hi, 0
    buffer_store_dwordx2 v[80:81], v74, s[40:43], s79 offen offset:0 sc1
    s_mov_b64 exec, -1
    s_waitcnt vmcnt(11)
    s_branch L_hbar
L_evw:
    s_mul_i32 s79, s63, 2048
    s_add_u32 s79, s79, s78
    v_add_u32_e64 v4, s79, v73
    s_mul_i32 s79, s63, 20480
    s_add_u32 s79, s79, s78
    v_add_u32_e64 v5, s79, v73
    s_and_b32 s72, s84, 15
    s_mov_b32 m0, s70
    s_lshl_b32 s71, s72, 7
    buffer_load_dwordx4 v16, s[28:31], s71 offen offset:0 lds
    s_mul_i32 s72, s72, 393216
    s_lshr_b64 s[84:85], s[84:85], 4
    ds_read_b64_tr_b16 v[32:33], v4 offset:0
    ds_read_b64_tr_b16 v[34:35], v4 offset:512
    ds_read_b64_tr_b16 v[36:37], v4 offset:10240
    ds_read_b64_tr_b16 v[38:39], v4 offset:10752
    ds_read_b64_tr_b16 v[40:41], v4 offset:20480
    ds_read_b64_tr_b16 v[42:43], v4 offset:20992
    ds_read_b64_tr_b16 v[44:45], v4 offset:30720
    ds_read_b64_tr_b16 v[46:47], v4 offset:31232
    ds_read_b64_tr_b16 v[48:49], v5 offset:4096
    ds_read_b64_tr_b16 v[50:51], v5 offset:4608
    ds_read_b64_tr_b16 v[52:53], v5 offset:14336
    ds_read_b64_tr_b16 v[54:55], v5 offset:14848
    buffer_load_dwordx4 v17, s[28:31], s71 offen offset:1024 lds
    s_lshl_b32 s79, s64, 9
    s_lshl_b32 s80, s63, 3
    s_add_u32 s79, s79, s80
    s_add_u32 s79, s79, s73
    s_waitcnt lgkmcnt(0)
    v_lshlrev_b32 v80, 16, v32
    v_and_b32 v82, s90, v32
    v_lshlrev_b32 v10, 16, v33
    v_and_b32 v11, s90, v33
    v_add_f32 v80, v80, v10
    v_add_f32 v82, v82, v11
    v_lshlrev_b32 v8, 16, v34
    v_and_b32 v9, s90, v34
    v_add_f32 v80, v80, v8
    v_add_f32 v82, v82, v9
    v_lshlrev_b32 v10, 16, v35
    v_and_b32 v11, s90, v35
    buffer_load_dwordx4 v18, s[28:31], s71 offen offset:2048 lds
    v_add_f32 v80, v80, v10
    v_add_f32 v82, v82, v11
    v_lshlrev_b32 v8, 16, v36
    v_and_b32 v9, s90, v36
    v_add_f32 v80, v80, v8
    v_add_f32 v82, v82, v9
    v_lshlrev_b32 v10, 16, v37
    v_and_b32 v11, s90, v37
    v_add_f32 v80, v80, v10
    v_add_f32 v82, v82, v11
    v_lshlrev_b32 v8, 16, v38
    v_and_b32 v9, s90, v38
    buffer_load_dwordx4 v19, s[28:31], s71 offen offset:3072 lds
    v_add_f32 v80, v80, v8
    v_add_f32 v82, v82, v9
    v_lshlrev_b32 v10, 16, v39
    v_and_b32 v11, s90, v39
    v_add_f32 v80, v80, v10
    v_add_f32 v82, v82, v11
    v_lshlrev_b32 v8, 16, v40
    v_and_b32 v9, s90, v40
    v_add_f32 v80, v80, v8
    v_add_f32 v82, v82, v9
    v_lshlrev_b32 v10, 16, v41
    v_and_b32 v11, s90, v41
    s_add_u32 m0, s70, 4096
    s_nop 0
    buffer_load_dwordx4 v20, s[32:35], s72 offen offset:0 lds
    v_add_f32 v80, v80, v10
    v_add_f32 v82, v82, v11
    v_lshlrev_b32 v8, 16, v42
    v_and_b32 v9, s90, v42
    v_add_f32 v80, v80, v8
    v_add_f32 v82, v82, v9
    v_lshlrev_b32 v10, 16, v43
    v_and_b32 v11, s90, v43
    v_add_f32 v80, v80, v10
    v_add_f32 v82, v82, v11
    v_lshlrev_b32 v8, 16, v44
    v_and_b32_e64 v9, s90, v44
    buffer_load_dwordx4 v21, s[32:35], s72 offen offset:1024 lds
    v_add_f32 v80, v80, v8
    v_add_f32 v82, v82, v9
    v_lshlrev_b32 v10, 16, v45
    v_and_b32 v11, s90, v45
    v_add_f32 v80, v80, v10
    v_add_f32 v82, v82, v11
    v_lshlrev_b32 v8, 16, v46
    v_and_b32 v9, s90, v46
    v_add_f32 v80, v80, v8
    v_add_f32 v82, v82, v9
    v_lshlrev_b32 v10, 16, v47
    v_and_b32 v11, s90, v47
    buffer_load_dwordx4 v22, s[32:35], s72 offen offset:2048 lds
    v_add_f32 v80, v80, v10
    v_add_f32 v82, v82, v11
    v_lshlrev_b32 v81, 16, v48
    v_and_b32 v83, s90, v48
    v_lshlrev_b32 v10, 16, v49
    v_and_b32 v11, s90, v49
    v_add_f32 v81, v81, v10
    v_add_f32 v83, v83, v11
    v_lshlrev_b32 v8, 16, v50
    v_and_b32 v9, s90, v50
    v_add_f32 v81, v81, v8
    v_add_f32 v83, v83, v9
    buffer_load_dwordx4 v23, s[32:35], s72 offen offset:3072 lds
    v_lshlrev_b32 v10, 16, v51
    v_and_b32 v11, s90, v51
    v_add_f32 v81, v81, v10
    v_add_f32 v83, v83, v11
    v_lshlrev_b32 v8, 16, v52
    v_and_b32 v9, s90, v52
    v_add_f32 v81, v81, v8
    v_add_f32 v83, v83, v9
    v_lshlrev_b32 v10, 16, v53
    v_and_b32 v11, s90, v53
    v_add_f32 v81, v81, v10
    v_add_f32 v83, v83, v11
    s_add_u32 m0, s70, 8192
    s_nop 0
    buffer_load_dwordx4 v24, s[32:35], s72 offen offset:0 lds
    v_lshlrev_b32 v8, 16, v54
    v_and_b32 v9, s90, v54
    v_add_f32 v81, v81, v8
    v_add_f32 v83, v83, v9
    v_lshlrev_b32 v10, 16, v55
    v_and_b32 v11, s90, v55
    v_add_f32 v81, v81, v10
    v_add_f32_e64 v83, v83, v11
    buffer_load_dwordx4 v25, s[32:35], s72 offen offset:1024 lds
    s_add_u32 s70, s70, 40960
    s_cmp_ge_u32 s70, 122880
    s_cselect_b32 s76, 122880, 0
    s_sub_u32 s70, s70, s76
    v_add_f32 v80, v80, v82
    v_add_f32 v81, v81, v83
    v_mov_b32 v82, v80
    v_mov_b32 v83, v81
    s_nop 0
    v_permlane32_swap_b32 v80, v82
    v_permlane32_swap_b32 v81, v83
    v_add_f32 v80, v80, v82
    v_add_f32_e64 v81, v81, v83
    s_mov_b32 exec_hi, 0
    buffer_store_dwordx2 v[80:81], v12, s[40:43], s79 offen offset:1024 sc1
    s_mov_b64 exec, -1
    s_waitcnt vmcnt(11)
    s_branch L_hbar
L_compute:
    s_setprio 2
    s_and_b32 s63, s62, 1
    s_lshr_b32 s64, s62, 1
    s_lshl_b32 s73, s60, 4
    s_add_u32 s73, s73, s61
    s_mul_i32 s73, s73, 28800
    s_add_u32 s76, s2, 7
    s_and_b32 s76, s76, 7
    s_bfe_u32 s77, s2, 0x10003
    s_lshl1_add_u32 s97, s76, s77
    s_lshr_b32 s98, s2, 4
    s_lshl_b32 s99, s97, 4
    s_add_u32 s99, s99, s98
    s_mul_i32 s99, s99, 9344
    s_add_u32 s99, s99, 8388608
    s_lshr_b32 s65, s97, 1
    s_lshl_b32 s76, s97, 3
    s_add_u32 s65, s65, s76
    s_mul_i32 s76, s98, 4
    s_add_u32 s65, s65, s76
    s_and_b32 s65, s65, 15
    s_mov_b32 s89, 0x3f803f80
    s_mov_b32 s90, 0xffff0000
    v_and_b32 v2, 31, v1
    v_lshrrev_b32 v3, 5, v1
    v_lshlrev_b32 v12, 4, v1
    v_lshrrev_b32 v4, 3, v1
    v_mul_u32_u24 v13, 460800, v4
    v_and_b32_e64 v4, 7, v1
    v_lshl_add_u32 v13, v4, 4, v13
    v_and_b32 v10, 15, v1
    v_lshrrev_b32 v11, 4, v1
    s_mul_i32 s76, s63, 20480
    v_lshrrev_b32 v4, 1, v10
    v_xor_b32 v4, v4, v11
    v_lshlrev_b32_e64 v4, 4, v4
    v_lshl_add_u32 v4, v10, 7, v4
    v_add_u32 v192, s76, v4
    v_xor_b32 v193, 64, v192
    v_bfe_u32 v4, v1, 2, 2
    v_and_b32_e64 v6, 1, v11
    v_lshl_add_u32 v5, v6, 3, v4
    v_lshlrev_b32 v5, 7, v5
    v_lshrrev_b32 v4, 1, v4
    v_xor_b32_e64 v4, s64, v4
    v_lshl_add_u32 v5, v4, 6, v5
    v_lshl_add_u32 v5, v6, 5, v5
    v_and_b32_e64 v4, 3, v1
    v_lshl_add_u32 v5, v4, 3, v5
    v_mul_u32_u24 v4, 10240, v3
    v_add_u32_e64 v5, v5, v4
    v_add_u32 v194, 4096, v5
    v_xor_b32_e64 v195, 32, v194
    v_add_u32 v196, 40960, v192
    v_add_u32 v197, 40960, v193
    v_add_u32 v198, 40960, v194
    v_add_u32 v199, 40960, v195
    v_add_u32 v200, 81920, v192
    v_add_u32 v201, 81920, v193
    v_add_u32 v202, 81920, v194
    v_add_u32 v203, 81920, v195
    v_bfe_u32 v4, v1, 2, 2
    v_lshl_add_u32 v4, v3, 3, v4
    v_lshlrev_b32 v4, 6, v4
    v_and_b32 v5, 1, v11
    v_lshl_add_u32 v4, v5, 5, v4
    v_and_b32_e64 v5, 3, v1
    v_lshl_add_u32 v4, v5, 3, v4
    s_lshl_b32 s76, s64, 11
    s_add_u32 s76, s76, 122880
    v_add_u32_e64 v212, s76, v4
    s_lshl_b32 s76, s63, 9
    v_lshl_add_u32 v213, v10, 3, s76
    v_lshl_add_u32 v214, v2, 3, s76
    s_lshl_b32 s76, s64, 8
    v_lshl_add_u32 v215, v10, 3, s76
    v_bfe_u32 v4, v10, 1, 1
    v_xor_b32 v4, s64, v4
    v_lshrrev_b32 v5, 2, v10
    v_xor_b32 v5, v5, v3
    v_xor_b32 v6, v10, v11
    v_and_b32 v6, 1, v6
    v_lshlrev_b32_e64 v4, 6, v4
    v_lshl_add_u32 v4, v5, 4, v4
    v_lshl_add_u32 v4, v6, 3, v4
    v_lshl_add_u32 v4, v10, 7, v4
    s_lshl_b32 s76, s63, 13
    v_add_u32 v216, s76, v4
    v_bfe_u32 v4, v2, 1, 1
    v_bfe_u32 v5, v2, 2, 2
    v_and_b32 v6, 1, v2
    v_xor_b32 v6, v6, v3
    v_lshlrev_b32_e64 v4, 6, v4
    v_lshl_add_u32 v4, v5, 4, v4
    v_lshl_add_u32 v4, v6, 3, v4
    v_lshl_add_u32 v4, v2, 7, v4
    s_lshl_b32 s77, s64, 14
    s_add_u32 s76, s76, s77
    v_add_u32_e64 v217, s76, v4
    v_bfe_u32 v4, v1, 2, 2
    v_lshl_add_u32 v5, v3, 3, v4
    v_lshlrev_b32 v5, 7, v5
    v_lshrrev_b32 v6, 1, v4
    v_lshl_add_u32 v5, v6, 6, v5
    v_bfe_u32 v6, v1, 4, 1
    v_xor_b32_e64 v6, v6, v3
    v_lshl_add_u32 v5, v6, 5, v5
    v_bfe_u32 v6, v1, 1, 1
    v_lshl_add_u32 v5, v6, 4, v5
    v_xor_b32 v6, v1, v4
    v_and_b32 v6, 1, v6
    v_lshl_add_u32 v5, v6, 3, v5
    s_lshl_b32 s76, s63, 6
    s_or_b32 s76, s76, s77
    v_xor_b32 v218, s76, v5
    s_lshl_b32 s76, s64, 6
    v_xor_b32_e64 v220, s76, v5
    v_xor_b32 v219, 528, v218
    v_xor_b32 v221, 528, v220
    v_cmp_gt_u32 s[86:87], 16, v1
    s_waitcnt lgkmcnt(0)
    s_mov_b32 s40, s26
    s_and_b32 s41, s27, 0xffff
    s_mov_b32 s42, 33554432
    s_mov_b32 s43, 0x20000
    s_mov_b32 s44, s22
    s_and_b32 s45, s23, 0xffff
    s_mov_b32 s46, 4194304
    s_mov_b32 s47, 0x20000
    s_mov_b32 s68, 0
    s_getreg_b32 s101, hwreg(HW_REG_XCC_ID, 0, 4)
    v_mov_b32 v9, 13631488
    s_lshl_b32 s76, s61, 8
    s_lshl4_add_u32 s76, s60, s76
    s_add_u32 s76, s76, 12582912
    v_mov_b32 v8, s76
    s_lshl_b32 s76, s60, 8
    s_lshl4_add_u32 s76, s61, s76
    s_add_u32 s76, s76, 12587008
    v_writelane_b32 v8, s76, 1
    s_lshl_b32 s76, s97, 8
    s_lshl4_add_u32 s76, s98, s76
    s_add_u32 s76, s76, 12591104
    v_writelane_b32 v8, s76, 2
    v_mov_b32 v6, s101
    v_mov_b32 v7, 0
    v_mov_b32_e64 v10, 0
    s_cmp_eq_u32 s62, 0
    s_cbranch_scc0 L_noep
    buffer_load_dwordx2 v[4:5], v9, s[40:43], 0 offen
L_noep:
    s_barrier
    ds_read_b128 v[112:115], v192 offset:0
    ds_read_b64_tr_b16 v[128:129], v194 offset:0
    ds_read_b64_tr_b16 v[130:131], v194 offset:512
    ds_read_b128 v[116:119], v192 offset:2048
    ds_read_b128 v[120:123], v192 offset:10240
    ds_read_b128 v[124:127], v192 offset:12288
    ds_read_b64_tr_b16 v[132:133], v195 offset:0
    ds_read_b64_tr_b16 v[134:135], v195 offset:512
    ds_read_b64_tr_b16 v[136:137], v194 offset:2048
    ds_read_b64_tr_b16 v[138:139], v194 offset:2560
    ds_read_b64_tr_b16 v[140:141], v195 offset:2048
    ds_read_b64_tr_b16 v[142:143], v195 offset:2560
    ds_read_b64_tr_b16 v[144:145], v194 offset:4096
    ds_read_b64_tr_b16 v[146:147], v194 offset:4608
    s_waitcnt lgkmcnt(8)
    ds_read_b64_tr_b16 v[148:149], v195 offset:4096
    ds_read_b64_tr_b16 v[150:151], v195 offset:4608
    v_mfma_f32_16x16x32_bf16 v[16:19], v[128:131], v[112:115], 0
    ds_read_b128 v[152:155], v193 offset:0
    v_mfma_f32_16x16x32_bf16 v[20:23], v[128:131], v[116:119], 0
    ds_read_b64_tr_b16 v[168:169], v194 offset:20480
    v_mfma_f32_16x16x32_bf16 v[24:27], v[128:131], v[120:123], 0
    ds_read_b64_tr_b16 v[170:171], v194 offset:20992
    v_mfma_f32_16x16x32_bf16 v[28:31], v[128:131], v[124:127], 0
    ds_read_b128 v[156:159], v193 offset:2048
    s_waitcnt lgkmcnt(4)
    v_mfma_f32_16x16x32_bf16 v[32:35], v[132:135], v[112:115], 0
    ds_read_b128 v[160:163], v193 offset:10240
    v_mfma_f32_16x16x32_bf16 v[36:39], v[132:135], v[116:119], 0
    ds_read_b128 v[164:167], v193 offset:12288
    v_mfma_f32_16x16x32_bf16 v[40:43], v[132:135], v[120:123], 0
    ds_read_b64_tr_b16 v[172:173], v195 offset:20480
    v_mfma_f32_16x16x32_bf16 v[44:47], v[132:135], v[124:127], 0
    ds_read_b64_tr_b16 v[174:175], v195 offset:20992
    v_mfma_f32_16x16x32_bf16 v[48:51], v[136:139], v[112:115], 0
    ds_read_b64_tr_b16 v[176:177], v194 offset:22528
    v_mfma_f32_16x16x32_bf16 v[52:55], v[136:139], v[116:119], 0
    ds_read_b64_tr_b16 v[178:179], v194 offset:23040
    v_mfma_f32_16x16x32_bf16 v[56:59], v[136:139], v[120:123], 0
    ds_read_b64_tr_b16 v[180:181], v195 offset:22528
    v_mfma_f32_16x16x32_bf16 v[60:63], v[136:139], v[124:127], 0
    ds_read_b64_tr_b16 v[182:183], v195 offset:23040
    v_mfma_f32_16x16x32_bf16 v[64:67], v[140:143], v[112:115], 0
    ds_read_b64_tr_b16 v[184:185], v194 offset:24576
    v_mfma_f32_16x16x32_bf16 v[68:71], v[140:143], v[116:119], 0
    ds_read_b64_tr_b16 v[186:187], v194 offset:25088
    v_mfma_f32_16x16x32_bf16 v[72:75], v[140:143], v[120:123], 0
    ds_read_b64_tr_b16 v[188:189], v195 offset:24576
    v_mfma_f32_16x16x32_bf16 v[76:79], v[140:143], v[124:127], 0
    ds_read_b64_tr_b16 v[190:191], v195 offset:25088
    v_mfma_f32_16x16x32_bf16 v[80:83], v[144:147], v[112:115], 0
    v_mfma_f32_16x16x32_bf16 v[84:87], v[144:147], v[116:119], 0
    v_mfma_f32_16x16x32_bf16 v[88:91], v[144:147], v[120:123], 0
    v_mfma_f32_16x16x32_bf16 v[92:95], v[144:147], v[124:127], 0
    v_mfma_f32_16x16x32_bf16 v[96:99], v[148:151], v[112:115], 0
    v_mfma_f32_16x16x32_bf16 v[100:103], v[148:151], v[116:119], 0
    v_mfma_f32_16x16x32_bf16 v[104:107], v[148:151], v[120:123], 0
    v_mfma_f32_16x16x32_bf16 v[108:111], v[148:151], v[124:127], 0
    s_waitcnt lgkmcnt(0)
    v_mfma_f32_16x16x32_bf16 v[16:19], v[168:171], v[152:155], v[16:19]
    s_barrier
    v_mfma_f32_16x16x32_bf16 v[20:23], v[168:171], v[156:159], v[20:23]
    ds_read_b128 v[112:115], v196 offset:0
    ds_read_b64_tr_b16 v[204:205], v212 offset:0
    ds_read_b64_tr_b16 v[206:207], v212 offset:256
    ds_read_b64_tr_b16 v[208:209], v212 offset:1024
    ds_read_b64_tr_b16 v[210:211], v212 offset:1280
    v_mfma_f32_16x16x32_bf16 v[24:27], v[168:171], v[160:163], v[24:27]
    ds_read_b64_tr_b16 v[128:129], v198 offset:0
    s_cmp_eq_u32 s62, 0
    s_cbranch_scc0 L_cloop
    s_waitcnt vmcnt(0)
    v_add_co_u32 v4, vcc, 1, v4
    s_nop 1
    v_addc_co_u32 v5, vcc, 0, v5, vcc
    s_mov_b64 exec, 7
    buffer_store_dwordx4 v[4:7], v8, s[40:43], 0 offen sc1
    s_mov_b64 exec, -1
.p2align 3
L_cloop:
    v_mfma_f32_16x16x32_bf16 v[28:31], v[168:171], v[164:167], v[28:31]
    ds_read_b64_tr_b16 v[130:131], v198 offset:512
    v_mfma_f32_16x16x32_bf16 v[32:35], v[172:175], v[152:155], v[32:35]
    ds_read_b128 v[116:119], v196 offset:2048
    v_mfma_f32_16x16x32_bf16 v[36:39], v[172:175], v[156:159], v[36:39]
    ds_read_b128 v[120:123], v196 offset:10240
    v_mfma_f32_16x16x32_bf16 v[40:43], v[172:175], v[160:163], v[40:43]
    ds_read_b128 v[124:127], v196 offset:12288
    v_mfma_f32_16x16x32_bf16 v[44:47], v[172:175], v[164:167], v[44:47]
    ds_read_b64_tr_b16 v[132:133], v199 offset:0
    v_mfma_f32_16x16x32_bf16 v[48:51], v[176:179], v[152:155], v[48:51]
    ds_read_b64_tr_b16 v[134:135], v199 offset:512
    v_mfma_f32_16x16x32_bf16 v[52:55], v[176:179], v[156:159], v[52:55]
    ds_read_b64_tr_b16 v[136:137], v198 offset:2048
    v_mfma_f32_16x16x32_bf16 v[56:59], v[176:179], v[160:163], v[56:59]
    ds_read_b64_tr_b16 v[138:139], v198 offset:2560
    v_mfma_f32_16x16x32_bf16 v[60:63], v[176:179], v[164:167], v[60:63]
    ds_read_b64_tr_b16 v[140:141], v199 offset:2048
    v_mfma_f32_16x16x32_bf16 v[64:67], v[180:183], v[152:155], v[64:67]
    ds_read_b64_tr_b16 v[142:143], v199 offset:2560
    v_mfma_f32_16x16x32_bf16 v[68:71], v[180:183], v[156:159], v[68:71]
    ds_read_b64_tr_b16 v[144:145], v198 offset:4096
    v_mfma_f32_16x16x32_bf16 v[72:75], v[180:183], v[160:163], v[72:75]
    ds_read_b64_tr_b16 v[146:147], v198 offset:4608
    v_mfma_f32_16x16x32_bf16 v[76:79], v[180:183], v[164:167], v[76:79]
    ds_read_b64_tr_b16 v[148:149], v199 offset:4096
    v_mfma_f32_16x16x32_bf16 v[80:83], v[184:187], v[152:155], v[80:83]
    ds_read_b64_tr_b16 v[150:151], v199 offset:4608
    v_mfma_f32_16x16x32_bf16 v[84:87], v[184:187], v[156:159], v[84:87]
    v_mfma_f32_16x16x32_bf16 v[88:91], v[184:187], v[160:163], v[88:91]
    v_mfma_f32_16x16x32_bf16 v[92:95], v[184:187], v[164:167], v[92:95]
    v_mfma_f32_16x16x32_bf16 v[96:99], v[188:191], v[152:155], v[96:99]
    v_mfma_f32_16x16x32_bf16 v[100:103], v[188:191], v[156:159], v[100:103]
    v_mfma_f32_16x16x32_bf16 v[104:107], v[188:191], v[160:163], v[104:107]
    v_mfma_f32_16x16x32_bf16 v[108:111], v[188:191], v[164:167], v[108:111]
    s_waitcnt lgkmcnt(0)
    v_mfma_f32_16x16x32_bf16 v[16:19], v[128:131], v[112:115], v[16:19]
    ds_read_b128 v[152:155], v197 offset:0
    v_mfma_f32_16x16x32_bf16 v[20:23], v[128:131], v[116:119], v[20:23]
    ds_read_b64_tr_b16 v[168:169], v198 offset:20480
    v_mfma_f32_16x16x32_bf16 v[24:27], v[128:131], v[120:123], v[24:27]
    ds_read_b64_tr_b16 v[170:171], v198 offset:20992
    v_mfma_f32_16x16x32_bf16 v[28:31], v[128:131], v[124:127], v[28:31]
    ds_read_b128 v[156:159], v197 offset:2048
    v_mfma_f32_16x16x32_bf16 v[32:35], v[132:135], v[112:115], v[32:35]
    ds_read_b128 v[160:163], v197 offset:10240
    v_mfma_f32_16x16x32_bf16 v[36:39], v[132:135], v[116:119], v[36:39]
    ds_read_b128 v[164:167], v197 offset:12288
    v_mfma_f32_16x16x32_bf16 v[40:43], v[132:135], v[120:123], v[40:43]
    ds_read_b64_tr_b16 v[172:173], v199 offset:20480
    v_mfma_f32_16x16x32_bf16 v[44:47], v[132:135], v[124:127], v[44:47]
    ds_read_b64_tr_b16 v[174:175], v199 offset:20992
    v_mfma_f32_16x16x32_bf16 v[48:51], v[136:139], v[112:115], v[48:51]
    ds_read_b64_tr_b16 v[176:177], v198 offset:22528
    v_mfma_f32_16x16x32_bf16 v[52:55], v[136:139], v[116:119], v[52:55]
    ds_read_b64_tr_b16 v[178:179], v198 offset:23040
    v_mfma_f32_16x16x32_bf16 v[56:59], v[136:139], v[120:123], v[56:59]
    ds_read_b64_tr_b16 v[180:181], v199 offset:22528
    v_mfma_f32_16x16x32_bf16 v[60:63], v[136:139], v[124:127], v[60:63]
    ds_read_b64_tr_b16 v[182:183], v199 offset:23040
    v_mfma_f32_16x16x32_bf16 v[64:67], v[140:143], v[112:115], v[64:67]
    ds_read_b64_tr_b16 v[184:185], v198 offset:24576
    v_mfma_f32_16x16x32_bf16 v[68:71], v[140:143], v[116:119], v[68:71]
    ds_read_b64_tr_b16 v[186:187], v198 offset:25088
    v_mfma_f32_16x16x32_bf16 v[72:75], v[140:143], v[120:123], v[72:75]
    ds_read_b64_tr_b16 v[188:189], v199 offset:24576
    v_mfma_f32_16x16x32_bf16 v[76:79], v[140:143], v[124:127], v[76:79]
    ds_read_b64_tr_b16 v[190:191], v199 offset:25088
    v_mfma_f32_16x16x32_bf16 v[80:83], v[144:147], v[112:115], v[80:83]
    v_mfma_f32_16x16x32_bf16 v[84:87], v[144:147], v[116:119], v[84:87]
    v_mfma_f32_16x16x32_bf16 v[88:91], v[144:147], v[120:123], v[88:91]
    v_mfma_f32_16x16x32_bf16 v[92:95], v[144:147], v[124:127], v[92:95]
    v_mfma_f32_16x16x32_bf16 v[96:99], v[148:151], v[112:115], v[96:99]
    v_mfma_f32_16x16x32_bf16 v[100:103], v[148:151], v[116:119], v[100:103]
    v_mfma_f32_16x16x32_bf16 v[104:107], v[148:151], v[120:123], v[104:107]
    v_mfma_f32_16x16x32_bf16 v[108:111], v[148:151], v[124:127], v[108:111]
    s_waitcnt lgkmcnt(0)
    v_mfma_f32_16x16x32_bf16 v[16:19], v[168:171], v[152:155], v[16:19]
    s_barrier
    v_mfma_f32_16x16x32_bf16 v[20:23], v[168:171], v[156:159], v[20:23]
    ds_read_b128 v[112:115], v200 offset:0
    v_mfma_f32_16x16x32_bf16 v[24:27], v[168:171], v[160:163], v[24:27]
    ds_read_b64_tr_b16 v[128:129], v202 offset:0
    v_mfma_f32_16x16x32_bf16 v[28:31], v[168:171], v[164:167], v[28:31]
    ds_read_b64_tr_b16 v[130:131], v202 offset:512
    v_mfma_f32_16x16x32_bf16 v[32:35], v[172:175], v[152:155], v[32:35]
    ds_read_b128 v[116:119], v200 offset:2048
    v_mfma_f32_16x16x32_bf16 v[36:39], v[172:175], v[156:159], v[36:39]
    ds_read_b128 v[120:123], v200 offset:10240
    v_mfma_f32_16x16x32_bf16 v[40:43], v[172:175], v[160:163], v[40:43]
    ds_read_b128 v[124:127], v200 offset:12288
    v_mfma_f32_16x16x32_bf16 v[44:47], v[172:175], v[164:167], v[44:47]
    ds_read_b64_tr_b16 v[132:133], v203 offset:0
    v_mfma_f32_16x16x32_bf16 v[48:51], v[176:179], v[152:155], v[48:51]
    ds_read_b64_tr_b16 v[134:135], v203 offset:512
    v_mfma_f32_16x16x32_bf16 v[52:55], v[176:179], v[156:159], v[52:55]
    ds_read_b64_tr_b16 v[136:137], v202 offset:2048
    v_mfma_f32_16x16x32_bf16 v[56:59], v[176:179], v[160:163], v[56:59]
    ds_read_b64_tr_b16 v[138:139], v202 offset:2560
    v_mfma_f32_16x16x32_bf16 v[60:63], v[176:179], v[164:167], v[60:63]
    ds_read_b64_tr_b16 v[140:141], v203 offset:2048
    v_mfma_f32_16x16x32_bf16 v[64:67], v[180:183], v[152:155], v[64:67]
    ds_read_b64_tr_b16 v[142:143], v203 offset:2560
    v_mfma_f32_16x16x32_bf16 v[68:71], v[180:183], v[156:159], v[68:71]
    ds_read_b64_tr_b16 v[144:145], v202 offset:4096
    v_mfma_f32_16x16x32_bf16 v[72:75], v[180:183], v[160:163], v[72:75]
    ds_read_b64_tr_b16 v[146:147], v202 offset:4608
    v_mfma_f32_16x16x32_bf16 v[76:79], v[180:183], v[164:167], v[76:79]
    ds_read_b64_tr_b16 v[148:149], v203 offset:4096
    v_mfma_f32_16x16x32_bf16 v[80:83], v[184:187], v[152:155], v[80:83]
    ds_read_b64_tr_b16 v[150:151], v203 offset:4608
    v_mfma_f32_16x16x32_bf16 v[84:87], v[184:187], v[156:159], v[84:87]
    v_mfma_f32_16x16x32_bf16 v[88:91], v[184:187], v[160:163], v[88:91]
    v_mfma_f32_16x16x32_bf16 v[92:95], v[184:187], v[164:167], v[92:95]
    v_mfma_f32_16x16x32_bf16 v[96:99], v[188:191], v[152:155], v[96:99]
    v_mfma_f32_16x16x32_bf16 v[100:103], v[188:191], v[156:159], v[100:103]
    v_mfma_f32_16x16x32_bf16 v[104:107], v[188:191], v[160:163], v[104:107]
    v_mfma_f32_16x16x32_bf16 v[108:111], v[188:191], v[164:167], v[108:111]
    s_waitcnt lgkmcnt(0)
    v_mfma_f32_16x16x32_bf16 v[16:19], v[128:131], v[112:115], v[16:19]
    ds_read_b128 v[152:155], v201 offset:0
    v_mfma_f32_16x16x32_bf16 v[20:23], v[128:131], v[116:119], v[20:23]
    ds_read_b64_tr_b16 v[168:169], v202 offset:20480
    v_mfma_f32_16x16x32_bf16 v[24:27], v[128:131], v[120:123], v[24:27]
    ds_read_b64_tr_b16 v[170:171], v202 offset:20992
    v_mfma_f32_16x16x32_bf16 v[28:31], v[128:131], v[124:127], v[28:31]
    ds_read_b128 v[156:159], v201 offset:2048
    v_mfma_f32_16x16x32_bf16 v[32:35], v[132:135], v[112:115], v[32:35]
    ds_read_b128 v[160:163], v201 offset:10240
    v_mfma_f32_16x16x32_bf16 v[36:39], v[132:135], v[116:119], v[36:39]
    ds_read_b128 v[164:167], v201 offset:12288
    v_mfma_f32_16x16x32_bf16 v[40:43], v[132:135], v[120:123], v[40:43]
    ds_read_b64_tr_b16 v[172:173], v203 offset:20480
    v_mfma_f32_16x16x32_bf16 v[44:47], v[132:135], v[124:127], v[44:47]
    ds_read_b64_tr_b16 v[174:175], v203 offset:20992
    v_mfma_f32_16x16x32_bf16 v[48:51], v[136:139], v[112:115], v[48:51]
    ds_read_b64_tr_b16 v[176:177], v202 offset:22528
    v_mfma_f32_16x16x32_bf16 v[52:55], v[136:139], v[116:119], v[52:55]
    ds_read_b64_tr_b16 v[178:179], v202 offset:23040
    v_mfma_f32_16x16x32_bf16 v[56:59], v[136:139], v[120:123], v[56:59]
    ds_read_b64_tr_b16 v[180:181], v203 offset:22528
    v_mfma_f32_16x16x32_bf16 v[60:63], v[136:139], v[124:127], v[60:63]
    ds_read_b64_tr_b16 v[182:183], v203 offset:23040
    v_mfma_f32_16x16x32_bf16 v[64:67], v[140:143], v[112:115], v[64:67]
    ds_read_b64_tr_b16 v[184:185], v202 offset:24576
    v_mfma_f32_16x16x32_bf16 v[68:71], v[140:143], v[116:119], v[68:71]
    ds_read_b64_tr_b16 v[186:187], v202 offset:25088
    v_mfma_f32_16x16x32_bf16 v[72:75], v[140:143], v[120:123], v[72:75]
    ds_read_b64_tr_b16 v[188:189], v203 offset:24576
    v_mfma_f32_16x16x32_bf16 v[76:79], v[140:143], v[124:127], v[76:79]
    ds_read_b64_tr_b16 v[190:191], v203 offset:25088
    v_mfma_f32_16x16x32_bf16 v[80:83], v[144:147], v[112:115], v[80:83]
    v_mfma_f32_16x16x32_bf16 v[84:87], v[144:147], v[116:119], v[84:87]
    v_mfma_f32_16x16x32_bf16 v[88:91], v[144:147], v[120:123], v[88:91]
    v_mfma_f32_16x16x32_bf16 v[92:95], v[144:147], v[124:127], v[92:95]
    v_mfma_f32_16x16x32_bf16 v[96:99], v[148:151], v[112:115], v[96:99]
    v_mfma_f32_16x16x32_bf16 v[100:103], v[148:151], v[116:119], v[100:103]
    v_mfma_f32_16x16x32_bf16 v[104:107], v[148:151], v[120:123], v[104:107]
    v_mfma_f32_16x16x32_bf16 v[108:111], v[148:151], v[124:127], v[108:111]
    s_waitcnt lgkmcnt(0)
    v_mfma_f32_16x16x32_bf16 v[16:19], v[168:171], v[152:155], v[16:19]
    s_barrier
    v_mfma_f32_16x16x32_bf16 v[20:23], v[168:171], v[156:159], v[20:23]
    ds_read_b128 v[112:115], v192 offset:0
    v_mfma_f32_16x16x32_bf16 v[24:27], v[168:171], v[160:163], v[24:27]
    ds_read_b64_tr_b16 v[128:129], v194 offset:0
    v_mfma_f32_16x16x32_bf16 v[28:31], v[168:171], v[164:167], v[28:31]
    ds_read_b64_tr_b16 v[130:131], v194 offset:512
    v_mfma_f32_16x16x32_bf16 v[32:35], v[172:175], v[152:155], v[32:35]
    ds_read_b128 v[116:119], v192 offset:2048
    v_mfma_f32_16x16x32_bf16 v[36:39], v[172:175], v[156:159], v[36:39]
    ds_read_b128 v[120:123], v192 offset:10240
    v_mfma_f32_16x16x32_bf16 v[40:43], v[172:175], v[160:163], v[40:43]
    ds_read_b128 v[124:127], v192 offset:12288
    v_mfma_f32_16x16x32_bf16 v[44:47], v[172:175], v[164:167], v[44:47]
    ds_read_b64_tr_b16 v[132:133], v195 offset:0
    v_mfma_f32_16x16x32_bf16 v[48:51], v[176:179], v[152:155], v[48:51]
    ds_read_b64_tr_b16 v[134:135], v195 offset:512
    v_mfma_f32_16x16x32_bf16 v[52:55], v[176:179], v[156:159], v[52:55]
    ds_read_b64_tr_b16 v[136:137], v194 offset:2048
    v_mfma_f32_16x16x32_bf16 v[56:59], v[176:179], v[160:163], v[56:59]
    ds_read_b64_tr_b16 v[138:139], v194 offset:2560
    v_mfma_f32_16x16x32_bf16 v[60:63], v[176:179], v[164:167], v[60:63]
    ds_read_b64_tr_b16 v[140:141], v195 offset:2048
    v_mfma_f32_16x16x32_bf16 v[64:67], v[180:183], v[152:155], v[64:67]
    ds_read_b64_tr_b16 v[142:143], v195 offset:2560
    v_mfma_f32_16x16x32_bf16 v[68:71], v[180:183], v[156:159], v[68:71]
    ds_read_b64_tr_b16 v[144:145], v194 offset:4096
    v_mfma_f32_16x16x32_bf16 v[72:75], v[180:183], v[160:163], v[72:75]
    ds_read_b64_tr_b16 v[146:147], v194 offset:4608
    v_mfma_f32_16x16x32_bf16 v[76:79], v[180:183], v[164:167], v[76:79]
    ds_read_b64_tr_b16 v[148:149], v195 offset:4096
    v_mfma_f32_16x16x32_bf16 v[80:83], v[184:187], v[152:155], v[80:83]
    ds_read_b64_tr_b16 v[150:151], v195 offset:4608
    v_mfma_f32_16x16x32_bf16 v[84:87], v[184:187], v[156:159], v[84:87]
    v_mfma_f32_16x16x32_bf16 v[88:91], v[184:187], v[160:163], v[88:91]
    v_mfma_f32_16x16x32_bf16 v[92:95], v[184:187], v[164:167], v[92:95]
    v_mfma_f32_16x16x32_bf16 v[96:99], v[188:191], v[152:155], v[96:99]
    v_mfma_f32_16x16x32_bf16 v[100:103], v[188:191], v[156:159], v[100:103]
    v_mfma_f32_16x16x32_bf16 v[104:107], v[188:191], v[160:163], v[104:107]
    v_mfma_f32_16x16x32_bf16 v[108:111], v[188:191], v[164:167], v[108:111]
    s_waitcnt lgkmcnt(0)
    v_mfma_f32_16x16x32_bf16 v[16:19], v[128:131], v[112:115], v[16:19]
    ds_read_b128 v[152:155], v193 offset:0
    v_mfma_f32_16x16x32_bf16 v[20:23], v[128:131], v[116:119], v[20:23]
    ds_read_b64_tr_b16 v[168:169], v194 offset:20480
    v_mfma_f32_16x16x32_bf16 v[24:27], v[128:131], v[120:123], v[24:27]
    ds_read_b64_tr_b16 v[170:171], v194 offset:20992
    v_mfma_f32_16x16x32_bf16 v[28:31], v[128:131], v[124:127], v[28:31]
    ds_read_b128 v[156:159], v193 offset:2048
    v_mfma_f32_16x16x32_bf16 v[32:35], v[132:135], v[112:115], v[32:35]
    ds_read_b128 v[160:163], v193 offset:10240
    v_mfma_f32_16x16x32_bf16 v[36:39], v[132:135], v[116:119], v[36:39]
    ds_read_b128 v[164:167], v193 offset:12288
    v_mfma_f32_16x16x32_bf16 v[40:43], v[132:135], v[120:123], v[40:43]
    ds_read_b64_tr_b16 v[172:173], v195 offset:20480
    v_mfma_f32_16x16x32_bf16 v[44:47], v[132:135], v[124:127], v[44:47]
    ds_read_b64_tr_b16 v[174:175], v195 offset:20992
    v_mfma_f32_16x16x32_bf16 v[48:51], v[136:139], v[112:115], v[48:51]
    ds_read_b64_tr_b16 v[176:177], v194 offset:22528
    v_mfma_f32_16x16x32_bf16 v[52:55], v[136:139], v[116:119], v[52:55]
    ds_read_b64_tr_b16 v[178:179], v194 offset:23040
    v_mfma_f32_16x16x32_bf16 v[56:59], v[136:139], v[120:123], v[56:59]
    ds_read_b64_tr_b16 v[180:181], v195 offset:22528
    v_mfma_f32_16x16x32_bf16 v[60:63], v[136:139], v[124:127], v[60:63]
    ds_read_b64_tr_b16 v[182:183], v195 offset:23040
    v_mfma_f32_16x16x32_bf16 v[64:67], v[140:143], v[112:115], v[64:67]
    ds_read_b64_tr_b16 v[184:185], v194 offset:24576
    v_mfma_f32_16x16x32_bf16 v[68:71], v[140:143], v[116:119], v[68:71]
    ds_read_b64_tr_b16 v[186:187], v194 offset:25088
    v_mfma_f32_16x16x32_bf16 v[72:75], v[140:143], v[120:123], v[72:75]
    ds_read_b64_tr_b16 v[188:189], v195 offset:24576
    v_mfma_f32_16x16x32_bf16 v[76:79], v[140:143], v[124:127], v[76:79]
    ds_read_b64_tr_b16 v[190:191], v195 offset:25088
    v_mfma_f32_16x16x32_bf16 v[80:83], v[144:147], v[112:115], v[80:83]
    v_mfma_f32_16x16x32_bf16 v[84:87], v[144:147], v[116:119], v[84:87]
    v_mfma_f32_16x16x32_bf16 v[88:91], v[144:147], v[120:123], v[88:91]
    v_mfma_f32_16x16x32_bf16 v[92:95], v[144:147], v[124:127], v[92:95]
    v_mfma_f32_16x16x32_bf16 v[96:99], v[148:151], v[112:115], v[96:99]
    s_add_u32 s68, s68, 1
    s_cmp_lt_u32 s68, 5
    v_mfma_f32_16x16x32_bf16 v[100:103], v[148:151], v[116:119], v[100:103]
    v_mfma_f32_16x16x32_bf16 v[104:107], v[148:151], v[120:123], v[104:107]
    v_mfma_f32_16x16x32_bf16 v[108:111], v[148:151], v[124:127], v[108:111]
    s_waitcnt lgkmcnt(0)
    v_mfma_f32_16x16x32_bf16 v[16:19], v[168:171], v[152:155], v[16:19]
    s_cbranch_scc0 L_cexit
    s_barrier
    v_mfma_f32_16x16x32_bf16 v[20:23], v[168:171], v[156:159], v[20:23]
    ds_read_b128 v[112:115], v196 offset:0
    v_mfma_f32_16x16x32_bf16 v[24:27], v[168:171], v[160:163], v[24:27]
    ds_read_b64_tr_b16 v[128:129], v198 offset:0
    s_branch L_cloop
L_cexit:
    v_mfma_f32_16x16x32_bf16 v[20:23], v[168:171], v[156:159], v[20:23]
    v_mfma_f32_16x16x32_bf16 v[24:27], v[168:171], v[160:163], v[24:27]
    v_mfma_f32_16x16x32_bf16 v[28:31], v[168:171], v[164:167], v[28:31]
    v_mfma_f32_16x16x32_bf16 v[32:35], v[172:175], v[152:155], v[32:35]
    v_mfma_f32_16x16x32_bf16 v[36:39], v[172:175], v[156:159], v[36:39]
    v_mfma_f32_16x16x32_bf16 v[40:43], v[172:175], v[160:163], v[40:43]
    v_mfma_f32_16x16x32_bf16 v[44:47], v[172:175], v[164:167], v[44:47]
    v_mfma_f32_16x16x32_bf16 v[48:51], v[176:179], v[152:155], v[48:51]
    v_mfma_f32_16x16x32_bf16 v[52:55], v[176:179], v[156:159], v[52:55]
    v_mfma_f32_16x16x32_bf16 v[56:59], v[176:179], v[160:163], v[56:59]
    s_barrier
    ds_read_b32 v11, v10 offset:53248
    ds_read_b64 v[222:223], v213 offset:49152
    ds_read_b64 v[224:225], v213 offset:49280
    v_mfma_f32_16x16x32_bf16 v[60:63], v[176:179], v[164:167], v[60:63]
    ds_read_b64 v[226:227], v213 offset:49408
    ds_read_b64 v[228:229], v213 offset:49536
    v_mfma_f32_16x16x32_bf16 v[64:67], v[180:183], v[152:155], v[64:67]
    ds_read_b64 v[238:239], v215 offset:50176
    ds_read_b64 v[240:241], v215 offset:50304
    v_mfma_f32_16x16x32_bf16 v[68:71], v[180:183], v[156:159], v[68:71]
    ds_read_b64 v[242:243], v215 offset:50688
    ds_read_b64 v[244:245], v215 offset:50816
    v_mfma_f32_16x16x32_bf16 v[72:75], v[180:183], v[160:163], v[72:75]
    ds_read_b64 v[246:247], v215 offset:51200
    ds_read_b64 v[248:249], v215 offset:51328
    v_mfma_f32_16x16x32_bf16 v[76:79], v[180:183], v[164:167], v[76:79]
    ds_read_b32 v250, v214 offset:49156
    ds_read_b32 v252, v214 offset:49412
    v_mfma_f32_16x16x32_bf16 v[80:83], v[184:187], v[152:155], v[80:83]
    s_waitcnt lgkmcnt(8)
    v_readfirstlane_b32 s100, v11
    v_mov_b32_e64 v230, v223
    v_cndmask_b32 v222, 0, v222, s[86:87]
    v_mfma_f32_16x16x32_bf16 v[84:87], v[184:187], v[156:159], v[84:87]
    v_mov_b32_e64 v232, v225
    v_cndmask_b32 v224, 0, v224, s[86:87]
    v_mov_b32_e64 v234, v227
    v_cndmask_b32 v226, 0, v226, s[86:87]
    v_mfma_f32_16x16x32_bf16 v[88:91], v[184:187], v[160:163], v[88:91]
    v_mov_b32_e64 v236, v229
    v_cndmask_b32 v228, 0, v228, s[86:87]
    v_mov_b32 v223, v222
    v_mov_b32 v225, v224
    v_mfma_f32_16x16x32_bf16 v[92:95], v[184:187], v[164:167], v[92:95]
    v_mov_b32 v227, v226
    v_mov_b32_e64 v229, v228
    s_waitcnt lgkmcnt(0)
    v_mul_f32 v251, 0x3fb8aa3b, v250
    v_mfma_f32_16x16x32_bf16 v[96:99], v[188:191], v[152:155], v[96:99]
    v_mul_f32 v253, 0x3fb8aa3b, v252
    v_mfma_f32_16x16x32_bf16 v[100:103], v[188:191], v[156:159], v[100:103]
    v_mfma_f32_16x16x32_bf16 v[104:107], v[188:191], v[160:163], v[104:107]
    v_mfma_f32_16x16x32_bf16 v[108:111], v[188:191], v[164:167], v[108:111]
    v_mfma_f32_16x16x16_bf16 v[48:51], v[242:243], v[222:223], v[48:51]
    v_xor_b32 v168, 0, v217
    v_xor_b32 v169, 16, v217
    v_mfma_f32_16x16x16_bf16 v[52:55], v[242:243], v[224:225], v[52:55]
    v_xor_b32 v170, 32, v217
    v_xor_b32 v171, 48, v217
    v_mfma_f32_16x16x16_bf16 v[64:67], v[244:245], v[222:223], v[64:67]
    v_xor_b32_e64 v172, 64, v217
    v_xor_b32 v173, 80, v217
    v_mfma_f32_16x16x16_bf16 v[68:71], v[244:245], v[224:225], v[68:71]
    v_xor_b32 v174, 96, v217
    v_xor_b32 v175, 112, v217
    v_mfma_f32_16x16x16_bf16 v[56:59], v[242:243], v[226:227], v[56:59]
    v_xor_b32_e64 v4, 32, v216
    v_mfma_f32_16x16x16_bf16 v[60:63], v[242:243], v[228:229], v[60:63]
    v_mfma_f32_16x16x16_bf16 v[72:75], v[244:245], v[226:227], v[72:75]
    v_mfma_f32_16x16x16_bf16 v[76:79], v[244:245], v[228:229], v[76:79]
    v_mfma_f32_16x16x16_bf16 v[80:83], v[246:247], v[222:223], v[80:83]
    v_cvt_pk_bf16_f32 v112, v48, v49
    v_cvt_pk_bf16_f32 v113, v50, v51
    v_mfma_f32_16x16x16_bf16 v[84:87], v[246:247], v[224:225], v[84:87]
    v_cvt_pk_bf16_f32 v114, v52, v53
    v_cvt_pk_bf16_f32 v115, v54, v55
    v_mfma_f32_16x16x16_bf16 v[88:91], v[246:247], v[226:227], v[88:91]
    v_cvt_pk_bf16_f32 v116, v64, v65
    v_cvt_pk_bf16_f32 v117, v66, v67
    v_mfma_f32_16x16x16_bf16 v[92:95], v[246:247], v[228:229], v[92:95]
    v_cvt_pk_bf16_f32 v118, v68, v69
    v_cvt_pk_bf16_f32 v119, v70, v71
    v_mfma_f32_16x16x16_bf16 v[96:99], v[248:249], v[222:223], v[96:99]
    v_cvt_pk_bf16_f32 v120, v56, v57
    v_cvt_pk_bf16_f32 v121, v58, v59
    v_mfma_f32_16x16x16_bf16 v[100:103], v[248:249], v[224:225], v[100:103]
    v_cvt_pk_bf16_f32 v122, v60, v61
    v_cvt_pk_bf16_f32 v123, v62, v63
    v_mfma_f32_16x16x16_bf16 v[104:107], v[248:249], v[226:227], v[104:107]
    v_permlane16_swap_b32 v112, v114
    v_permlane16_swap_b32 v113, v115
    v_mfma_f32_16x16x16_bf16 v[108:111], v[248:249], v[228:229], v[108:111]
    v_permlane16_swap_b32 v116, v118
    v_permlane16_swap_b32 v117, v119
    v_cvt_pk_bf16_f32 v124, v72, v73
    v_cvt_pk_bf16_f32 v125, v74, v75
    v_cvt_pk_bf16_f32 v126, v76, v77
    v_cvt_pk_bf16_f32 v127, v78, v79
    v_permlane16_swap_b32 v120, v122
    v_permlane16_swap_b32 v121, v123
    v_permlane16_swap_b32 v124, v126
    v_permlane16_swap_b32 v125, v127
    v_mfma_f32_32x32x16_bf16 v[48:63], v[204:207], v[112:115], 0
    v_mul_f32 v80, v80, v230
    v_mul_f32 v81, v81, v230
    v_mul_f32 v82, v82, v230
    v_mul_f32 v83, v83, v230
    v_cvt_pk_bf16_f32 v80, v80, v81
    v_cvt_pk_bf16_f32 v81, v82, v83
    v_mfma_f32_32x32x16_bf16 v[64:79], v[204:207], v[120:123], 0
    v_mul_f32 v96, v96, v230
    v_mul_f32 v97, v97, v230
    v_mul_f32 v98, v98, v230
    v_mul_f32 v99, v99, v230
    v_cvt_pk_bf16_f32 v96, v96, v97
    v_cvt_pk_bf16_f32 v97, v98, v99
    v_mfma_f32_32x32x16_bf16 v[48:63], v[208:211], v[116:119], v[48:63]
    v_mul_f32 v84, v84, v232
    v_mul_f32 v85, v85, v232
    v_mul_f32 v86, v86, v232
    v_mul_f32 v87, v87, v232
    v_cvt_pk_bf16_f32 v84, v84, v85
    v_cvt_pk_bf16_f32 v85, v86, v87
    v_mfma_f32_32x32x16_bf16 v[64:79], v[208:211], v[124:127], v[64:79]
    v_mul_f32 v100, v100, v232
    v_mul_f32 v101, v101, v232
    v_mul_f32 v102, v102, v232
    v_mul_f32 v103, v103, v232
    v_cvt_pk_bf16_f32 v100, v100, v101
    v_cvt_pk_bf16_f32 v101, v102, v103
    v_mul_f32 v88, v88, v234
    v_mul_f32 v89, v89, v234
    v_mul_f32 v90, v90, v234
    v_mul_f32 v91, v91, v234
    v_cvt_pk_bf16_f32 v88, v88, v89
    v_cvt_pk_bf16_f32 v89, v90, v91
    v_mul_f32 v104, v104, v234
    v_mul_f32 v105, v105, v234
    v_mul_f32 v106, v106, v234
    v_mul_f32 v107, v107, v234
    v_cvt_pk_bf16_f32 v104, v104, v105
    v_cvt_pk_bf16_f32 v105, v106, v107
    v_mul_f32 v92, v92, v236
    v_mul_f32 v93, v93, v236
    v_mul_f32 v94, v94, v236
    v_mul_f32 v95, v95, v236
    v_cvt_pk_bf16_f32 v92, v92, v93
    v_cvt_pk_bf16_f32 v93, v94, v95
    v_mul_f32 v108, v108, v236
    v_mul_f32 v109, v109, v236
    v_mul_f32 v110, v110, v236
    v_mul_f32 v111, v111, v236
    v_cvt_pk_bf16_f32 v108, v108, v109
    v_cvt_pk_bf16_f32 v109, v110, v111
    v_max3_f32 v160, v48, v49, v50
    v_min3_f32 v162, v48, v49, v50
    v_max3_f32 v160, v160, v51, v52
    v_min3_f32 v162, v162, v51, v52
    v_max3_f32 v160, v160, v53, v54
    v_min3_f32 v162, v162, v53, v54
    v_max3_f32 v160, v160, v55, v56
    v_min3_f32 v162, v162, v55, v56
    v_max3_f32 v160, v160, v57, v58
    v_min3_f32 v162, v162, v57, v58
    v_max3_f32 v160, v160, v59, v60
    v_min3_f32 v162, v162, v59, v60
    v_max3_f32 v160, v160, v61, v62
    v_min3_f32 v162, v162, v61, v62
    v_max_f32 v160, v160, v63
    v_min_f32 v162, v162, v63
    v_max3_f32 v164, v64, v65, v66
    v_min3_f32 v166, v64, v65, v66
    v_max3_f32 v164, v164, v67, v68
    v_min3_f32 v166, v166, v67, v68
    v_max3_f32 v164, v164, v69, v70
    v_min3_f32 v166, v166, v69, v70
    v_max3_f32 v164, v164, v71, v72
    v_min3_f32 v166, v166, v71, v72
    v_max3_f32 v164, v164, v73, v74
    v_min3_f32 v166, v166, v73, v74
    v_max3_f32 v164, v164, v75, v76
    v_min3_f32 v166, v166, v75, v76
    v_max3_f32 v164, v164, v77, v78
    v_min3_f32 v166, v166, v77, v78
    v_max_f32 v164, v164, v79
    v_min_f32 v166, v166, v79
    v_mov_b32 v161, v160
    v_mov_b32 v163, v162
    v_mov_b32 v165, v164
    v_mov_b32 v167, v166
    v_permlane32_swap_b32 v160, v161
    v_permlane32_swap_b32 v162, v163
    v_permlane32_swap_b32 v164, v165
    v_permlane32_swap_b32 v166, v167
    v_max_f32 v160, v160, v161
    v_min_f32 v162, v162, v163
    v_max_f32 v164, v164, v165
    v_min_f32 v166, v166, v167
    v_mul_f32 v160, v160, v251
    v_mul_f32 v162, v162, v251
    v_mul_f32 v164, v164, v253
    v_mul_f32 v166, v166, v253
    v_pk_fma_f32 v[128:129], v[48:49], v[250:251], v[160:161] op_sel:[0,1,0] op_sel_hi:[1,1,0] neg_lo:[0,0,1] neg_hi:[0,0,1]
    v_pk_fma_f32 v[48:49], v[48:49], v[250:251], v[162:163] op_sel:[0,1,0] op_sel_hi:[1,1,0] neg_lo:[0,1,0] neg_hi:[0,1,0]
    v_pk_fma_f32 v[130:131], v[50:51], v[250:251], v[160:161] op_sel:[0,1,0] op_sel_hi:[1,1,0] neg_lo:[0,0,1] neg_hi:[0,0,1]
    v_pk_fma_f32 v[50:51], v[50:51], v[250:251], v[162:163] op_sel:[0,1,0] op_sel_hi:[1,1,0] neg_lo:[0,1,0] neg_hi:[0,1,0]
    v_pk_fma_f32 v[132:133], v[52:53], v[250:251], v[160:161] op_sel:[0,1,0] op_sel_hi:[1,1,0] neg_lo:[0,0,1] neg_hi:[0,0,1]
    v_pk_fma_f32 v[52:53], v[52:53], v[250:251], v[162:163] op_sel:[0,1,0] op_sel_hi:[1,1,0] neg_lo:[0,1,0] neg_hi:[0,1,0]
    v_pk_fma_f32 v[134:135], v[54:55], v[250:251], v[160:161] op_sel:[0,1,0] op_sel_hi:[1,1,0] neg_lo:[0,0,1] neg_hi:[0,0,1]
    v_pk_fma_f32 v[54:55], v[54:55], v[250:251], v[162:163] op_sel:[0,1,0] op_sel_hi:[1,1,0] neg_lo:[0,1,0] neg_hi:[0,1,0]
    v_pk_fma_f32 v[136:137], v[56:57], v[250:251], v[160:161] op_sel:[0,1,0] op_sel_hi:[1,1,0] neg_lo:[0,0,1] neg_hi:[0,0,1]
    v_pk_fma_f32 v[56:57], v[56:57], v[250:251], v[162:163] op_sel:[0,1,0] op_sel_hi:[1,1,0] neg_lo:[0,1,0] neg_hi:[0,1,0]
    v_pk_fma_f32 v[138:139], v[58:59], v[250:251], v[160:161] op_sel:[0,1,0] op_sel_hi:[1,1,0] neg_lo:[0,0,1] neg_hi:[0,0,1]
    v_pk_fma_f32 v[58:59], v[58:59], v[250:251], v[162:163] op_sel:[0,1,0] op_sel_hi:[1,1,0] neg_lo:[0,1,0] neg_hi:[0,1,0]
    v_pk_fma_f32 v[140:141], v[60:61], v[250:251], v[160:161] op_sel:[0,1,0] op_sel_hi:[1,1,0] neg_lo:[0,0,1] neg_hi:[0,0,1]
    v_pk_fma_f32 v[60:61], v[60:61], v[250:251], v[162:163] op_sel:[0,1,0] op_sel_hi:[1,1,0] neg_lo:[0,1,0] neg_hi:[0,1,0]
    v_pk_fma_f32 v[142:143], v[62:63], v[250:251], v[160:161] op_sel:[0,1,0] op_sel_hi:[1,1,0] neg_lo:[0,0,1] neg_hi:[0,0,1]
    v_pk_fma_f32 v[62:63], v[62:63], v[250:251], v[162:163] op_sel:[0,1,0] op_sel_hi:[1,1,0] neg_lo:[0,1,0] neg_hi:[0,1,0]
    v_pk_fma_f32 v[144:145], v[64:65], v[252:253], v[164:165] op_sel:[0,1,0] op_sel_hi:[1,1,0] neg_lo:[0,0,1] neg_hi:[0,0,1]
    v_pk_fma_f32 v[64:65], v[64:65], v[252:253], v[166:167] op_sel:[0,1,0] op_sel_hi:[1,1,0] neg_lo:[0,1,0] neg_hi:[0,1,0]
    v_pk_fma_f32 v[146:147], v[66:67], v[252:253], v[164:165] op_sel:[0,1,0] op_sel_hi:[1,1,0] neg_lo:[0,0,1] neg_hi:[0,0,1]
    v_pk_fma_f32 v[66:67], v[66:67], v[252:253], v[166:167] op_sel:[0,1,0] op_sel_hi:[1,1,0] neg_lo:[0,1,0] neg_hi:[0,1,0]
    v_pk_fma_f32 v[148:149], v[68:69], v[252:253], v[164:165] op_sel:[0,1,0] op_sel_hi:[1,1,0] neg_lo:[0,0,1] neg_hi:[0,0,1]
    v_pk_fma_f32 v[68:69], v[68:69], v[252:253], v[166:167] op_sel:[0,1,0] op_sel_hi:[1,1,0] neg_lo:[0,1,0] neg_hi:[0,1,0]
    v_pk_fma_f32 v[150:151], v[70:71], v[252:253], v[164:165] op_sel:[0,1,0] op_sel_hi:[1,1,0] neg_lo:[0,0,1] neg_hi:[0,0,1]
    v_pk_fma_f32 v[70:71], v[70:71], v[252:253], v[166:167] op_sel:[0,1,0] op_sel_hi:[1,1,0] neg_lo:[0,1,0] neg_hi:[0,1,0]
    v_pk_fma_f32 v[152:153], v[72:73], v[252:253], v[164:165] op_sel:[0,1,0] op_sel_hi:[1,1,0] neg_lo:[0,0,1] neg_hi:[0,0,1]
    v_pk_fma_f32 v[72:73], v[72:73], v[252:253], v[166:167] op_sel:[0,1,0] op_sel_hi:[1,1,0] neg_lo:[0,1,0] neg_hi:[0,1,0]
    v_pk_fma_f32 v[154:155], v[74:75], v[252:253], v[164:165] op_sel:[0,1,0] op_sel_hi:[1,1,0] neg_lo:[0,0,1] neg_hi:[0,0,1]
    v_pk_fma_f32 v[74:75], v[74:75], v[252:253], v[166:167] op_sel:[0,1,0] op_sel_hi:[1,1,0] neg_lo:[0,1,0] neg_hi:[0,1,0]
    v_pk_fma_f32 v[156:157], v[76:77], v[252:253], v[164:165] op_sel:[0,1,0] op_sel_hi:[1,1,0] neg_lo:[0,0,1] neg_hi:[0,0,1]
    v_pk_fma_f32 v[76:77], v[76:77], v[252:253], v[166:167] op_sel:[0,1,0] op_sel_hi:[1,1,0] neg_lo:[0,1,0] neg_hi:[0,1,0]
    v_pk_fma_f32 v[158:159], v[78:79], v[252:253], v[164:165] op_sel:[0,1,0] op_sel_hi:[1,1,0] neg_lo:[0,0,1] neg_hi:[0,0,1]
    v_pk_fma_f32 v[78:79], v[78:79], v[252:253], v[166:167] op_sel:[0,1,0] op_sel_hi:[1,1,0] neg_lo:[0,1,0] neg_hi:[0,1,0]
    v_exp_f32_e64 v128, v128
    v_mfma_f32_16x16x16_bf16 v[16:19], v[238:239], v[222:223], v[16:19]
    v_exp_f32 v144, v144
    v_exp_f32 v129, v129
    v_exp_f32_e64 v145, v145
    v_mfma_f32_16x16x16_bf16 v[20:23], v[238:239], v[224:225], v[20:23]
    ds_write2st64_b64 v216, v[80:81], v[84:85] offset0:64 offset1:68
    v_exp_f32 v130, v130
    v_exp_f32 v146, v146
    v_exp_f32_e64 v131, v131
    v_mfma_f32_16x16x16_bf16 v[24:27], v[238:239], v[226:227], v[24:27]
    v_exp_f32 v147, v147
    v_exp_f32 v132, v132
    v_exp_f32_e64 v148, v148
    v_mfma_f32_16x16x16_bf16 v[28:31], v[238:239], v[228:229], v[28:31]
    ds_write2st64_b64 v4, v[96:97], v[100:101] offset0:64 offset1:68
    v_exp_f32 v133, v133
    v_exp_f32 v149, v149
    v_exp_f32_e64 v134, v134
    v_mfma_f32_16x16x16_bf16 v[32:35], v[240:241], v[222:223], v[32:35]
    v_exp_f32 v150, v150
    v_exp_f32 v135, v135
    v_exp_f32_e64 v151, v151
    v_mfma_f32_16x16x16_bf16 v[36:39], v[240:241], v[224:225], v[36:39]
    ds_write2st64_b64 v216, v[88:89], v[92:93] offset0:72 offset1:76
    v_exp_f32 v136, v136
    v_exp_f32 v152, v152
    v_exp_f32_e64 v137, v137
    v_mfma_f32_16x16x16_bf16 v[40:43], v[240:241], v[226:227], v[40:43]
    v_exp_f32 v153, v153
    v_exp_f32 v138, v138
    v_exp_f32_e64 v154, v154
    v_mfma_f32_16x16x16_bf16 v[44:47], v[240:241], v[228:229], v[44:47]
    ds_write2st64_b64 v4, v[104:105], v[108:109] offset0:72 offset1:76
    v_exp_f32 v139, v139
    v_exp_f32 v155, v155
    v_exp_f32 v140, v140
    v_exp_f32 v156, v156
    v_exp_f32 v141, v141
    v_exp_f32 v157, v157
    v_exp_f32 v142, v142
    v_exp_f32 v158, v158
    v_exp_f32 v143, v143
    v_exp_f32 v159, v159
    v_pk_add_f32 v[176:177], v[128:129], v[130:131]
    v_pk_add_f32 v[178:179], v[144:145], v[146:147]
    v_pk_add_f32 v[176:177], v[176:177], v[132:133]
    v_pk_add_f32 v[178:179], v[178:179], v[148:149]
    v_pk_add_f32 v[176:177], v[176:177], v[134:135]
    v_pk_add_f32 v[178:179], v[178:179], v[150:151]
    v_pk_add_f32 v[176:177], v[176:177], v[136:137]
    v_pk_add_f32 v[178:179], v[178:179], v[152:153]
    v_pk_add_f32 v[176:177], v[176:177], v[138:139]
    v_pk_add_f32 v[178:179], v[178:179], v[154:155]
    v_pk_add_f32 v[176:177], v[176:177], v[140:141]
    v_pk_add_f32 v[178:179], v[178:179], v[156:157]
    v_pk_add_f32 v[176:177], v[176:177], v[142:143]
    v_pk_add_f32 v[178:179], v[178:179], v[158:159]
    v_exp_f32 v48, v48
    v_add_f32 v176, v176, v177
    v_add_f32 v178, v178, v179
    v_exp_f32 v64, v64
    v_mov_b32 v177, v176
    v_mov_b32 v179, v178
    v_exp_f32 v49, v49
    v_permlane32_swap_b32 v176, v177
    v_permlane32_swap_b32 v178, v179
    v_exp_f32 v65, v65
    v_add_f32 v176, v176, v177
    v_add_f32 v178, v178, v179
    v_exp_f32 v50, v50
    v_rcp_f32 v176, v176
    v_rcp_f32 v178, v178
    v_exp_f32 v66, v66
    v_exp_f32 v51, v51
    v_exp_f32 v67, v67
    v_exp_f32 v52, v52
    v_exp_f32 v68, v68
    v_exp_f32 v53, v53
    v_exp_f32 v69, v69
    v_exp_f32 v54, v54
    v_exp_f32 v70, v70
    v_exp_f32 v55, v55
    v_exp_f32 v71, v71
    v_exp_f32 v56, v56
    v_exp_f32 v72, v72
    v_exp_f32 v57, v57
    v_exp_f32 v73, v73
    v_exp_f32 v58, v58
    v_exp_f32 v74, v74
    v_exp_f32 v59, v59
    v_exp_f32 v75, v75
    v_exp_f32 v60, v60
    v_exp_f32 v76, v76
    v_exp_f32 v61, v61
    v_exp_f32 v77, v77
    v_exp_f32 v62, v62
    v_exp_f32 v78, v78
    v_exp_f32 v63, v63
    v_exp_f32 v79, v79
    v_pk_add_f32 v[180:181], v[48:49], v[50:51]
    v_pk_add_f32 v[182:183], v[64:65], v[66:67]
    v_pk_add_f32 v[180:181], v[180:181], v[52:53]
    v_pk_add_f32 v[182:183], v[182:183], v[68:69]
    v_pk_add_f32 v[180:181], v[180:181], v[54:55]
    v_pk_add_f32 v[182:183], v[182:183], v[70:71]
    v_pk_add_f32 v[180:181], v[180:181], v[56:57]
    v_pk_add_f32 v[182:183], v[182:183], v[72:73]
    v_pk_add_f32 v[180:181], v[180:181], v[58:59]
    v_pk_add_f32 v[182:183], v[182:183], v[74:75]
    v_pk_add_f32 v[180:181], v[180:181], v[60:61]
    v_pk_add_f32 v[182:183], v[182:183], v[76:77]
    v_pk_add_f32 v[180:181], v[180:181], v[62:63]
    v_pk_add_f32 v[182:183], v[182:183], v[78:79]
    v_add_f32 v180, v180, v181
    v_add_f32 v182, v182, v183
    v_mov_b32 v181, v180
    v_mov_b32 v183, v182
    v_pk_mul_f32 v[128:129], v[128:129], v[176:177] op_sel_hi:[1,0]
    v_pk_mul_f32 v[130:131], v[130:131], v[176:177] op_sel_hi:[1,0]
    v_cvt_pk_bf16_f32 v128, v128, v129
    v_permlane32_swap_b32 v180, v181
    v_permlane32_swap_b32 v182, v183
    v_cvt_pk_bf16_f32 v129, v130, v131
    v_pk_mul_f32 v[144:145], v[144:145], v[178:179] op_sel_hi:[1,0]
    v_pk_mul_f32 v[146:147], v[146:147], v[178:179] op_sel_hi:[1,0]
    v_cvt_pk_bf16_f32 v144, v144, v145
    v_cvt_pk_bf16_f32 v145, v146, v147
    v_add_f32 v180, v180, v181
    v_add_f32 v182, v182, v183
    ds_write2st64_b64 v168, v[128:129], v[144:145] offset0:0 offset1:8
    v_pk_mul_f32 v[132:133], v[132:133], v[176:177] op_sel_hi:[1,0]
    v_pk_mul_f32 v[134:135], v[134:135], v[176:177] op_sel_hi:[1,0]
    v_cvt_pk_bf16_f32 v132, v132, v133
    v_cvt_pk_bf16_f32 v133, v134, v135
    v_pk_mul_f32 v[148:149], v[148:149], v[178:179] op_sel_hi:[1,0]
    v_rcp_f32 v180, v180
    v_rcp_f32 v182, v182
    v_pk_mul_f32 v[150:151], v[150:151], v[178:179] op_sel_hi:[1,0]
    v_cvt_pk_bf16_f32 v148, v148, v149
    v_cvt_pk_bf16_f32 v149, v150, v151
    ds_write2st64_b64 v169, v[132:133], v[148:149] offset0:0 offset1:8
    v_pk_mul_f32 v[136:137], v[136:137], v[176:177] op_sel_hi:[1,0]
    v_pk_mul_f32 v[138:139], v[138:139], v[176:177] op_sel_hi:[1,0]
    v_cvt_pk_bf16_f32 v136, v136, v137
    v_cvt_pk_bf16_f32 v137, v138, v139
    v_pk_mul_f32 v[152:153], v[152:153], v[178:179] op_sel_hi:[1,0]
    v_pk_mul_f32 v[154:155], v[154:155], v[178:179] op_sel_hi:[1,0]
    v_cvt_pk_bf16_f32 v152, v152, v153
    v_cvt_pk_bf16_f32 v153, v154, v155
    ds_write2st64_b64 v170, v[136:137], v[152:153] offset0:0 offset1:8
    v_pk_mul_f32 v[140:141], v[140:141], v[176:177] op_sel_hi:[1,0]
    v_pk_mul_f32 v[142:143], v[142:143], v[176:177] op_sel_hi:[1,0]
    v_cvt_pk_bf16_f32 v140, v140, v141
    v_cvt_pk_bf16_f32 v141, v142, v143
    v_pk_mul_f32 v[156:157], v[156:157], v[178:179] op_sel_hi:[1,0]
    v_pk_mul_f32 v[158:159], v[158:159], v[178:179] op_sel_hi:[1,0]
    v_cvt_pk_bf16_f32 v156, v156, v157
    v_cvt_pk_bf16_f32 v157, v158, v159
    ds_write2st64_b64 v171, v[140:141], v[156:157] offset0:0 offset1:8
    v_pk_mul_f32 v[48:49], v[48:49], v[180:181] op_sel_hi:[1,0]
    v_pk_mul_f32 v[50:51], v[50:51], v[180:181] op_sel_hi:[1,0]
    v_cvt_pk_bf16_f32 v48, v48, v49
    v_cvt_pk_bf16_f32 v49, v50, v51
    v_pk_mul_f32 v[64:65], v[64:65], v[182:183] op_sel_hi:[1,0]
    v_pk_mul_f32 v[66:67], v[66:67], v[182:183] op_sel_hi:[1,0]
    v_cvt_pk_bf16_f32 v64, v64, v65
    v_cvt_pk_bf16_f32 v65, v66, v67
    ds_write2st64_b64 v172, v[48:49], v[64:65] offset0:0 offset1:8
    v_pk_mul_f32 v[52:53], v[52:53], v[180:181] op_sel_hi:[1,0]
    v_pk_mul_f32 v[54:55], v[54:55], v[180:181] op_sel_hi:[1,0]
    v_cvt_pk_bf16_f32 v52, v52, v53
    v_cvt_pk_bf16_f32 v53, v54, v55
    v_pk_mul_f32 v[68:69], v[68:69], v[182:183] op_sel_hi:[1,0]
    v_pk_mul_f32 v[70:71], v[70:71], v[182:183] op_sel_hi:[1,0]
    v_cvt_pk_bf16_f32 v68, v68, v69
    v_cvt_pk_bf16_f32 v69, v70, v71
    ds_write2st64_b64 v173, v[52:53], v[68:69] offset0:0 offset1:8
    v_pk_mul_f32 v[56:57], v[56:57], v[180:181] op_sel_hi:[1,0]
    v_pk_mul_f32 v[58:59], v[58:59], v[180:181] op_sel_hi:[1,0]
    v_cvt_pk_bf16_f32 v56, v56, v57
    v_cvt_pk_bf16_f32 v57, v58, v59
    v_pk_mul_f32 v[72:73], v[72:73], v[182:183] op_sel_hi:[1,0]
    v_pk_mul_f32 v[74:75], v[74:75], v[182:183] op_sel_hi:[1,0]
    v_cvt_pk_bf16_f32 v72, v72, v73
    v_cvt_pk_bf16_f32 v73, v74, v75
    ds_write2st64_b64 v174, v[56:57], v[72:73] offset0:0 offset1:8
    v_pk_mul_f32 v[60:61], v[60:61], v[180:181] op_sel_hi:[1,0]
    v_pk_mul_f32 v[62:63], v[62:63], v[180:181] op_sel_hi:[1,0]
    v_cvt_pk_bf16_f32 v60, v60, v61
    v_cvt_pk_bf16_f32 v61, v62, v63
    v_pk_mul_f32 v[76:77], v[76:77], v[182:183] op_sel_hi:[1,0]
    v_pk_mul_f32 v[78:79], v[78:79], v[182:183] op_sel_hi:[1,0]
    v_cvt_pk_bf16_f32 v76, v76, v77
    v_cvt_pk_bf16_f32 v77, v78, v79
    ds_write2st64_b64 v175, v[60:61], v[76:77] offset0:0 offset1:8
    s_waitcnt lgkmcnt(0)
    s_barrier
    ds_read_b64_tr_b16 v[112:113], v218 offset:0
    ds_read_b64_tr_b16 v[114:115], v219 offset:0
    ds_read_b64_tr_b16 v[144:145], v220 offset:32768
    ds_read_b64_tr_b16 v[146:147], v221 offset:32768
    ds_read_b64_tr_b16 v[116:117], v218 offset:2048
    ds_read_b64_tr_b16 v[118:119], v219 offset:2048
    ds_read_b64_tr_b16 v[148:149], v220 offset:34816
    ds_read_b64_tr_b16 v[150:151], v221 offset:34816
    ds_read_b64_tr_b16 v[120:121], v218 offset:4096
    ds_read_b64_tr_b16 v[122:123], v219 offset:4096
    ds_read_b64_tr_b16 v[152:153], v220 offset:36864
    ds_read_b64_tr_b16 v[154:155], v221 offset:36864
    v_cvt_pk_bf16_f32 v176, v16, v17
    v_cvt_pk_bf16_f32 v177, v18, v19
    v_cvt_pk_bf16_f32 v178, v20, v21
    v_cvt_pk_bf16_f32 v179, v22, v23
    v_cvt_pk_bf16_f32 v180, v32, v33
    v_cvt_pk_bf16_f32 v181, v34, v35
    v_cvt_pk_bf16_f32 v182, v36, v37
    v_cvt_pk_bf16_f32 v183, v38, v39
    v_cvt_pk_bf16_f32 v184, v24, v25
    v_cvt_pk_bf16_f32 v185, v26, v27
    v_cvt_pk_bf16_f32 v186, v28, v29
    v_cvt_pk_bf16_f32 v187, v30, v31
    v_cvt_pk_bf16_f32 v188, v40, v41
    v_cvt_pk_bf16_f32 v189, v42, v43
    v_cvt_pk_bf16_f32 v190, v44, v45
    v_cvt_pk_bf16_f32 v191, v46, v47
    s_waitcnt lgkmcnt(8)
    v_mfma_f32_32x32x16_bf16 v[48:63], v[112:115], v[144:147], 0
    ds_read_b64_tr_b16 v[124:125], v218 offset:6144
    ds_read_b64_tr_b16 v[126:127], v219 offset:6144
    ds_read_b64_tr_b16 v[156:157], v220 offset:38912
    ds_read_b64_tr_b16 v[158:159], v221 offset:38912
    s_waitcnt lgkmcnt(8)
    v_mfma_f32_32x32x16_bf16 v[48:63], v[116:119], v[148:151], v[48:63]
    ds_read_b64_tr_b16 v[128:129], v218 offset:8192
    ds_read_b64_tr_b16 v[130:131], v219 offset:8192
    ds_read_b64_tr_b16 v[160:161], v220 offset:40960
    ds_read_b64_tr_b16 v[162:163], v221 offset:40960
    s_waitcnt lgkmcnt(8)
    v_mfma_f32_32x32x16_bf16 v[48:63], v[120:123], v[152:155], v[48:63]
    ds_read_b64_tr_b16 v[132:133], v218 offset:10240
    ds_read_b64_tr_b16 v[134:135], v219 offset:10240
    ds_read_b64_tr_b16 v[164:165], v220 offset:43008
    ds_read_b64_tr_b16 v[166:167], v221 offset:43008
    s_waitcnt lgkmcnt(8)
    v_mfma_f32_32x32x16_bf16 v[48:63], v[124:127], v[156:159], v[48:63]
    ds_read_b64_tr_b16 v[136:137], v218 offset:12288
    ds_read_b64_tr_b16 v[138:139], v219 offset:12288
    ds_read_b64_tr_b16 v[168:169], v220 offset:45056
    ds_read_b64_tr_b16 v[170:171], v221 offset:45056
    s_waitcnt lgkmcnt(8)
    v_mfma_f32_32x32x16_bf16 v[48:63], v[128:131], v[160:163], v[48:63]
    ds_read_b64_tr_b16 v[140:141], v218 offset:14336
    ds_read_b64_tr_b16 v[142:143], v219 offset:14336
    ds_read_b64_tr_b16 v[172:173], v220 offset:47104
    ds_read_b64_tr_b16 v[174:175], v221 offset:47104
    s_waitcnt lgkmcnt(8)
    v_mfma_f32_32x32x16_bf16 v[48:63], v[132:135], v[164:167], v[48:63]
    v_permlane16_swap_b32 v176, v178
    v_permlane16_swap_b32_e64 v177, v179
    s_waitcnt lgkmcnt(4)
    v_mfma_f32_32x32x16_bf16 v[48:63], v[136:139], v[168:171], v[48:63]
    v_permlane16_swap_b32 v180, v182
    v_permlane16_swap_b32 v181, v183
    v_permlane16_swap_b32 v184, v186
    s_waitcnt lgkmcnt(0)
    v_mfma_f32_32x32x16_bf16 v[48:63], v[140:143], v[172:175], v[48:63]
    s_barrier
    v_permlane16_swap_b32 v185, v187
    v_permlane16_swap_b32 v188, v190
    v_permlane16_swap_b32 v189, v191
    s_lshl_b32 s76, s62, 11
    s_add_u32 s76, s76, s99
    v_mfma_f32_32x32x16_bf16 v[16:31], v[204:207], v[176:179], 0
    s_add_u32 s76, s76, 1024
    s_lshl_b32 s77, s62, 7
    s_add_u32 s77, s77, s73
    v_lshlrev_b32_e64 v4, 2, v2
    v_mfma_f32_32x32x16_bf16 v[32:47], v[204:207], v[184:187], 0
    v_cvt_pk_bf16_f32 v64, v48, v49
    v_cvt_pk_bf16_f32 v65, v50, v51
    v_cvt_pk_bf16_f32 v66, v52, v53
    v_cvt_pk_bf16_f32 v67, v54, v55
    v_cvt_pk_bf16_f32 v68, v56, v57
    v_mfma_f32_32x32x16_bf16 v[16:31], v[208:211], v[180:183], v[16:31]
    v_cvt_pk_bf16_f32 v69, v58, v59
    v_cvt_pk_bf16_f32 v70, v60, v61
    v_cvt_pk_bf16_f32 v71, v62, v63
    s_bitcmp1_b32 s100, 0
    s_cbranch_scc1 L_loc_59
    buffer_store_dwordx4 v[64:67], v12, s[40:43], s76 offen offset:0 sc1
    buffer_store_dwordx4 v[68:71], v12, s[40:43], s76 offen offset:1024 sc1
    s_branch L_pubd_60
L_loc_59:
    buffer_store_dwordx4 v[64:67], v12, s[40:43], s76 offen offset:0
    buffer_store_dwordx4 v[68:71], v12, s[40:43], s76 offen offset:1024
L_pubd_60:
    v_mfma_f32_32x32x16_bf16 v[32:47], v[208:211], v[188:191], v[32:47]
    v_and_b32 v216, 1, v1
    v_lshlrev_b32_e64 v216, 8, v216
    v_lshl_add_u32 v216, v3, 4, v216
    s_lshl_b32 s76, s64, 7
    v_add_u32 v216, s76, v216
    s_mul_i32 s78, s61, 28800
    s_lshl_b32 s79, s64, 8
    s_add_u32 s78, s78, s79
    s_add_u32 s79, s78, 3686400
    v_dot2_f32_bf16 v72, v112, s89, 0
    v_dot2_f32_bf16 v73, v113, s89, 0
    v_dot2_f32_bf16 v72, v114, s89, v72
    v_dot2_f32_bf16 v73, v115, s89, v73
    v_dot2_f32_bf16 v72, v116, s89, v72
    v_dot2_f32_bf16 v73, v117, s89, v73
    v_dot2_f32_bf16 v72, v118, s89, v72
    v_dot2_f32_bf16 v73, v119, s89, v73
    v_dot2_f32_bf16 v72, v120, s89, v72
    v_dot2_f32_bf16 v73, v121, s89, v73
    v_dot2_f32_bf16 v72, v122, s89, v72
    v_dot2_f32_bf16 v73, v123, s89, v73
    v_dot2_f32_bf16 v72, v124, s89, v72
    v_dot2_f32_bf16 v73, v125, s89, v73
    v_dot2_f32_bf16 v72, v126, s89, v72
    v_dot2_f32_bf16 v73, v127, s89, v73
    v_dot2_f32_bf16 v72, v128, s89, v72
    v_dot2_f32_bf16 v73, v129, s89, v73
    v_dot2_f32_bf16 v72, v130, s89, v72
    v_dot2_f32_bf16 v73, v131, s89, v73
    v_dot2_f32_bf16 v72, v132, s89, v72
    v_dot2_f32_bf16 v73, v133, s89, v73
    v_dot2_f32_bf16 v72, v134, s89, v72
    v_dot2_f32_bf16 v73, v135, s89, v73
    v_dot2_f32_bf16 v72, v136, s89, v72
    v_dot2_f32_bf16 v73, v137, s89, v73
    v_dot2_f32_bf16 v72, v138, s89, v72
    v_dot2_f32_bf16 v73, v139, s89, v73
    v_dot2_f32_bf16 v72, v140, s89, v72
    v_dot2_f32_bf16 v73, v141, s89, v73
    v_dot2_f32_bf16 v72, v142, s89, v72
    v_dot2_f32_bf16 v73, v143, s89, v73
    s_lshl_b32 s76, s98, 7
    v_lshl_add_u32 v10, v3, 3, s76
    v_lshlrev_b32 v11, 5, v1
    v_add_f32 v72, v72, v73
    v_mov_b32 v73, v72
    s_nop 1
    v_permlane32_swap_b32 v72, v73
    v_add_f32 v72, v72, v73
    s_mov_b32 exec_hi, 0
    s_bitcmp1_b32 s100, 0
    s_cbranch_scc1 L_loc_61
    buffer_store_dword v72, v4, s[40:43], s77 offen offset:2048 sc1
    s_branch L_pubd_62
L_loc_61:
    buffer_store_dword v72, v4, s[40:43], s77 offen offset:2048
L_pubd_62:
    s_mov_b64 exec, -1
    v_max3_f32 v160, v16, v17, v18
    v_min3_f32 v162, v16, v17, v18
    v_max3_f32 v160, v160, v19, v20
    v_min3_f32 v162, v162, v19, v20
    v_max3_f32 v160, v160, v21, v22
    v_min3_f32 v162, v162, v21, v22
    v_max3_f32 v160, v160, v23, v24
    v_min3_f32 v162, v162, v23, v24
    v_max3_f32 v160, v160, v25, v26
    v_min3_f32 v162, v162, v25, v26
    v_max3_f32 v160, v160, v27, v28
    v_min3_f32 v162, v162, v27, v28
    v_max3_f32 v160, v160, v29, v30
    v_min3_f32 v162, v162, v29, v30
    v_max_f32 v160, v160, v31
    v_min_f32 v162, v162, v31
    v_max3_f32 v164, v32, v33, v34
    v_min3_f32 v166, v32, v33, v34
    v_max3_f32 v164, v164, v35, v36
    v_min3_f32 v166, v166, v35, v36
    v_max3_f32 v164, v164, v37, v38
    v_min3_f32 v166, v166, v37, v38
    v_max3_f32 v164, v164, v39, v40
    v_min3_f32 v166, v166, v39, v40
    v_max3_f32 v164, v164, v41, v42
    v_min3_f32 v166, v166, v41, v42
    v_max3_f32 v164, v164, v43, v44
    v_min3_f32 v166, v166, v43, v44
    v_max3_f32 v164, v164, v45, v46
    v_min3_f32 v166, v166, v45, v46
    v_max_f32 v164, v164, v47
    v_min_f32 v166, v166, v47
    v_mov_b32 v161, v160
    v_mov_b32 v163, v162
    v_mov_b32 v165, v164
    v_mov_b32 v167, v166
    v_permlane32_swap_b32 v160, v161
    v_permlane32_swap_b32 v162, v163
    v_permlane32_swap_b32 v164, v165
    v_permlane32_swap_b32 v166, v167
    v_max_f32 v160, v160, v161
    v_min_f32 v162, v162, v163
    v_max_f32 v164, v164, v165
    v_min_f32 v166, v166, v167
    v_mul_f32 v160, v160, v251
    v_mul_f32 v162, v162, v251
    v_mul_f32 v164, v164, v253
    v_mul_f32 v166, v166, v253
    v_pk_fma_f32 v[128:129], v[16:17], v[250:251], v[160:161] op_sel:[0,1,0] op_sel_hi:[1,1,0] neg_lo:[0,0,1] neg_hi:[0,0,1]
    v_pk_fma_f32 v[16:17], v[16:17], v[250:251], v[162:163] op_sel:[0,1,0] op_sel_hi:[1,1,0] neg_lo:[0,1,0] neg_hi:[0,1,0]
    v_pk_fma_f32 v[130:131], v[18:19], v[250:251], v[160:161] op_sel:[0,1,0] op_sel_hi:[1,1,0] neg_lo:[0,0,1] neg_hi:[0,0,1]
    v_pk_fma_f32 v[18:19], v[18:19], v[250:251], v[162:163] op_sel:[0,1,0] op_sel_hi:[1,1,0] neg_lo:[0,1,0] neg_hi:[0,1,0]
    v_pk_fma_f32 v[132:133], v[20:21], v[250:251], v[160:161] op_sel:[0,1,0] op_sel_hi:[1,1,0] neg_lo:[0,0,1] neg_hi:[0,0,1]
    v_pk_fma_f32 v[20:21], v[20:21], v[250:251], v[162:163] op_sel:[0,1,0] op_sel_hi:[1,1,0] neg_lo:[0,1,0] neg_hi:[0,1,0]
    v_pk_fma_f32 v[134:135], v[22:23], v[250:251], v[160:161] op_sel:[0,1,0] op_sel_hi:[1,1,0] neg_lo:[0,0,1] neg_hi:[0,0,1]
    v_pk_fma_f32 v[22:23], v[22:23], v[250:251], v[162:163] op_sel:[0,1,0] op_sel_hi:[1,1,0] neg_lo:[0,1,0] neg_hi:[0,1,0]
    v_pk_fma_f32 v[136:137], v[24:25], v[250:251], v[160:161] op_sel:[0,1,0] op_sel_hi:[1,1,0] neg_lo:[0,0,1] neg_hi:[0,0,1]
    v_pk_fma_f32 v[24:25], v[24:25], v[250:251], v[162:163] op_sel:[0,1,0] op_sel_hi:[1,1,0] neg_lo:[0,1,0] neg_hi:[0,1,0]
    v_pk_fma_f32 v[138:139], v[26:27], v[250:251], v[160:161] op_sel:[0,1,0] op_sel_hi:[1,1,0] neg_lo:[0,0,1] neg_hi:[0,0,1]
    v_pk_fma_f32 v[26:27], v[26:27], v[250:251], v[162:163] op_sel:[0,1,0] op_sel_hi:[1,1,0] neg_lo:[0,1,0] neg_hi:[0,1,0]
    v_pk_fma_f32 v[140:141], v[28:29], v[250:251], v[160:161] op_sel:[0,1,0] op_sel_hi:[1,1,0] neg_lo:[0,0,1] neg_hi:[0,0,1]
    v_pk_fma_f32 v[28:29], v[28:29], v[250:251], v[162:163] op_sel:[0,1,0] op_sel_hi:[1,1,0] neg_lo:[0,1,0] neg_hi:[0,1,0]
    v_pk_fma_f32 v[142:143], v[30:31], v[250:251], v[160:161] op_sel:[0,1,0] op_sel_hi:[1,1,0] neg_lo:[0,0,1] neg_hi:[0,0,1]
    v_pk_fma_f32 v[30:31], v[30:31], v[250:251], v[162:163] op_sel:[0,1,0] op_sel_hi:[1,1,0] neg_lo:[0,1,0] neg_hi:[0,1,0]
    v_pk_fma_f32 v[144:145], v[32:33], v[252:253], v[164:165] op_sel:[0,1,0] op_sel_hi:[1,1,0] neg_lo:[0,0,1] neg_hi:[0,0,1]
    v_pk_fma_f32 v[32:33], v[32:33], v[252:253], v[166:167] op_sel:[0,1,0] op_sel_hi:[1,1,0] neg_lo:[0,1,0] neg_hi:[0,1,0]
    v_pk_fma_f32 v[146:147], v[34:35], v[252:253], v[164:165] op_sel:[0,1,0] op_sel_hi:[1,1,0] neg_lo:[0,0,1] neg_hi:[0,0,1]
    v_pk_fma_f32 v[34:35], v[34:35], v[252:253], v[166:167] op_sel:[0,1,0] op_sel_hi:[1,1,0] neg_lo:[0,1,0] neg_hi:[0,1,0]
    v_pk_fma_f32 v[148:149], v[36:37], v[252:253], v[164:165] op_sel:[0,1,0] op_sel_hi:[1,1,0] neg_lo:[0,0,1] neg_hi:[0,0,1]
    v_pk_fma_f32 v[36:37], v[36:37], v[252:253], v[166:167] op_sel:[0,1,0] op_sel_hi:[1,1,0] neg_lo:[0,1,0] neg_hi:[0,1,0]
    v_pk_fma_f32 v[150:151], v[38:39], v[252:253], v[164:165] op_sel:[0,1,0] op_sel_hi:[1,1,0] neg_lo:[0,0,1] neg_hi:[0,0,1]
    v_pk_fma_f32 v[38:39], v[38:39], v[252:253], v[166:167] op_sel:[0,1,0] op_sel_hi:[1,1,0] neg_lo:[0,1,0] neg_hi:[0,1,0]
    v_pk_fma_f32 v[152:153], v[40:41], v[252:253], v[164:165] op_sel:[0,1,0] op_sel_hi:[1,1,0] neg_lo:[0,0,1] neg_hi:[0,0,1]
    v_pk_fma_f32 v[40:41], v[40:41], v[252:253], v[166:167] op_sel:[0,1,0] op_sel_hi:[1,1,0] neg_lo:[0,1,0] neg_hi:[0,1,0]
    v_pk_fma_f32 v[154:155], v[42:43], v[252:253], v[164:165] op_sel:[0,1,0] op_sel_hi:[1,1,0] neg_lo:[0,0,1] neg_hi:[0,0,1]
    v_pk_fma_f32 v[42:43], v[42:43], v[252:253], v[166:167] op_sel:[0,1,0] op_sel_hi:[1,1,0] neg_lo:[0,1,0] neg_hi:[0,1,0]
    v_pk_fma_f32 v[156:157], v[44:45], v[252:253], v[164:165] op_sel:[0,1,0] op_sel_hi:[1,1,0] neg_lo:[0,0,1] neg_hi:[0,0,1]
    v_pk_fma_f32 v[44:45], v[44:45], v[252:253], v[166:167] op_sel:[0,1,0] op_sel_hi:[1,1,0] neg_lo:[0,1,0] neg_hi:[0,1,0]
    v_pk_fma_f32 v[158:159], v[46:47], v[252:253], v[164:165] op_sel:[0,1,0] op_sel_hi:[1,1,0] neg_lo:[0,0,1] neg_hi:[0,0,1]
    v_pk_fma_f32 v[46:47], v[46:47], v[252:253], v[166:167] op_sel:[0,1,0] op_sel_hi:[1,1,0] neg_lo:[0,1,0] neg_hi:[0,1,0]
    v_exp_f32 v128, v128
    v_exp_f32 v16, v16
    v_exp_f32 v129, v129
    v_exp_f32 v17, v17
    v_exp_f32 v130, v130
    v_exp_f32 v18, v18
    v_exp_f32 v131, v131
    v_exp_f32 v19, v19
    v_exp_f32 v132, v132
    v_exp_f32 v20, v20
    v_exp_f32 v133, v133
    v_exp_f32 v21, v21
    v_exp_f32 v134, v134
    v_exp_f32 v22, v22
    v_exp_f32 v135, v135
    v_exp_f32 v23, v23
    v_exp_f32 v136, v136
    v_exp_f32 v24, v24
    v_exp_f32 v137, v137
    v_exp_f32 v25, v25
    v_exp_f32 v138, v138
    v_exp_f32 v26, v26
    v_exp_f32 v139, v139
    v_exp_f32 v27, v27
    v_exp_f32 v140, v140
    v_exp_f32 v28, v28
    v_exp_f32 v141, v141
    v_exp_f32 v29, v29
    v_exp_f32 v142, v142
    v_exp_f32 v30, v30
    v_exp_f32 v143, v143
    v_exp_f32 v31, v31
    v_cvt_pk_bf16_f32 v218, v128, v129
    v_cvt_pk_bf16_f32 v219, v130, v131
    v_cvt_pk_bf16_f32 v220, v132, v133
    v_cvt_pk_bf16_f32 v221, v134, v135
    v_cvt_pk_bf16_f32 v222, v136, v137
    v_cvt_pk_bf16_f32 v223, v138, v139
    v_cvt_pk_bf16_f32 v224, v140, v141
    v_cvt_pk_bf16_f32 v225, v142, v143
    v_cvt_pk_bf16_f32 v226, v16, v17
    v_cvt_pk_bf16_f32 v227, v18, v19
    v_cvt_pk_bf16_f32 v228, v20, v21
    v_cvt_pk_bf16_f32 v229, v22, v23
    v_cvt_pk_bf16_f32 v230, v24, v25
    v_cvt_pk_bf16_f32 v231, v26, v27
    v_cvt_pk_bf16_f32 v232, v28, v29
    v_cvt_pk_bf16_f32 v233, v30, v31
    v_exp_f32 v144, v144
    v_exp_f32 v32, v32
    v_exp_f32 v145, v145
    v_exp_f32 v33, v33
    v_exp_f32 v146, v146
    v_exp_f32 v34, v34
    v_exp_f32 v147, v147
    v_exp_f32 v35, v35
    v_exp_f32 v148, v148
    v_exp_f32 v36, v36
    v_exp_f32 v149, v149
    v_exp_f32 v37, v37
    v_exp_f32 v150, v150
    v_exp_f32 v38, v38
    v_exp_f32 v151, v151
    v_exp_f32_e64 v39, v39
    s_barrier
    buffer_load_dwordx4 v[48:51], v13, s[40:43], s78 offen offset:3072 sc1
    buffer_load_dwordx4 v[52:55], v13, s[40:43], s79 offen offset:3072 sc1
    buffer_load_dwordx4 v[56:59], v13, s[40:43], s78 offen offset:3200 sc1
    buffer_load_dwordx4 v[60:63], v13, s[40:43], s79 offen offset:3200 sc1
    ds_read_b128 v[168:171], v216 offset:24576
    ds_read_b128 v[172:175], v216 offset:24608
    ds_read_b128 v[176:179], v216 offset:24640
    ds_read_b128 v[180:183], v216 offset:24672
    v_exp_f32 v152, v152
    v_exp_f32 v40, v40
    v_exp_f32 v153, v153
    v_exp_f32 v41, v41
    v_exp_f32 v154, v154
    v_exp_f32 v42, v42
    v_exp_f32 v155, v155
    v_exp_f32 v43, v43
    v_exp_f32 v156, v156
    v_exp_f32_e64 v44, v44
    s_waitcnt lgkmcnt(0)
    v_mfma_f32_32x32x16_bf16 v[64:79], v[168:171], v[218:221], 0
    v_exp_f32 v157, v157
    v_exp_f32 v45, v45
    v_exp_f32_e64 v158, v158
    v_mfma_f32_32x32x16_bf16 v[80:95], v[176:179], v[226:229], 0
    v_exp_f32 v46, v46
    v_exp_f32 v159, v159
    v_exp_f32_e64 v47, v47
    v_mfma_f32_32x32x16_bf16 v[64:79], v[172:175], v[222:225], v[64:79]
    v_cvt_pk_bf16_f32 v234, v144, v145
    v_cvt_pk_bf16_f32 v235, v146, v147
    v_cvt_pk_bf16_f32 v236, v148, v149
    v_cvt_pk_bf16_f32 v237, v150, v151
    v_cvt_pk_bf16_f32 v238, v152, v153
    v_cvt_pk_bf16_f32 v239, v154, v155
    v_mfma_f32_32x32x16_bf16 v[80:95], v[180:183], v[230:233], v[80:95]
    v_cvt_pk_bf16_f32 v240, v156, v157
    v_cvt_pk_bf16_f32 v241, v158, v159
    v_cvt_pk_bf16_f32 v242, v32, v33
    v_cvt_pk_bf16_f32 v243, v34, v35
    v_cvt_pk_bf16_f32 v244, v36, v37
    v_cvt_pk_bf16_f32 v245, v38, v39
    v_cvt_pk_bf16_f32 v246, v40, v41
    v_cvt_pk_bf16_f32 v247, v42, v43
    v_cvt_pk_bf16_f32 v248, v44, v45
    v_cvt_pk_bf16_f32 v249, v46, v47
    v_mfma_f32_32x32x16_bf16 v[96:111], v[168:171], v[234:237], 0
    v_rcp_f32 v184, v65
    v_rcp_f32 v185, v81
    v_mul_f32 v6, v64, v184
    v_fmac_f32 v6, v80, v185
    v_add_f32 v6, 0x358637bd, v6
    v_mfma_f32_32x32x16_bf16 v[112:127], v[176:179], v[242:245], 0
    v_rcp_f32 v6, v6
    v_mov_b32 v8, 0
    v_mul_f32 v184, v184, v6
    v_mul_f32_e64 v185, v185, v6
    s_lshl4_add_u32 s76, s60, s61
    v_mfma_f32_32x32x16_bf16 v[96:111], v[172:175], v[238:241], v[96:111]
    s_mul_i32 s76, s76, 32768
    s_lshl2_add_u32 s77, s63, s64
    s_lshl_b32 s77, s77, 12
    s_add_u32 s76, s76, s77
    s_add_u32 s76, s76, 16777216
    v_mfma_f32_32x32x16_bf16 v[112:127], v[180:183], v[246:249], v[112:127]
    s_add_u32 s77, s76, 8192
    v_add_u32 v14, 128, v12
    v_cmp_gt_u32 vcc, 24, v1
    s_nop 0
    s_nop 0
    v_cndmask_b32_e64 v14, v14, v12, vcc
    s_mov_b32 s88, 0
    s_branch L_pfirst_64
L_poll_63:
    buffer_load_dwordx4 v[48:51], v13, s[40:43], s78 offen offset:3072 sc1
    buffer_load_dwordx4 v[52:55], v13, s[40:43], s79 offen offset:3072 sc1
    buffer_load_dwordx4 v[56:59], v13, s[40:43], s78 offen offset:3200 sc1
    buffer_load_dwordx4 v[60:63], v13, s[40:43], s79 offen offset:3200 sc1
L_pfirst_64:
    s_waitcnt vmcnt(0)
    v_max3_u32 v9, v48, v49, v50
    v_max3_u32 v9, v9, v51, v52
    v_max3_u32 v9, v9, v53, v54
    v_max3_u32 v9, v9, v55, v56
    v_max3_u32 v9, v9, v57, v58
    v_max3_u32 v9, v9, v59, v60
    v_max3_u32 v9, v9, v61, v62
    v_max_u32 v9, v9, v63
    v_cmp_eq_u32 vcc, -1, v9
    s_nop 0
    s_cbranch_vccz L_ok_65
    s_add_u32 s88, s88, 1
    s_cmp_lt_u32 s88, 65536
    s_cbranch_scc1 L_poll_63
L_ok_65:
    v_mfma_f32_32x32x16_bf16 v[16:31], v[48:51], v[218:221], 0
    s_barrier
    v_rcp_f32 v186, v97
    v_rcp_f32 v187, v113
    v_mul_f32_e64 v7, v96, v186
    v_mfma_f32_32x32x16_bf16 v[128:143], v[56:59], v[226:229], 0
    v_fmac_f32_e64 v7, v112, v187
    v_add_f32 v7, 0x358637bd, v7
    v_rcp_f32_e64 v7, v7
    v_bfe_u32 v4, v2, 1, 3
    v_lshlrev_b32_e64 v4, 4, v4
    v_mfma_f32_32x32x16_bf16 v[16:31], v[52:55], v[222:225], v[16:31]
    v_mov_b32 v8, 0
    v_mul_f32 v186, v186, v7
    v_mul_f32_e64 v187, v187, v7
    v_lshl_add_u32 v4, v3, 3, v4
    v_lshl_add_u32 v4, v2, 7, v4
    s_lshl_b32 s56, s62, 12
    v_mfma_f32_32x32x16_bf16 v[128:143], v[60:63], v[230:233], v[128:143]
    s_add_u32 s57, s56, 0
    v_add_u32 v64, s57, v4
    v_xor_b32 v65, 16, v64
    v_xor_b32 v66, 32, v64
    v_xor_b32 v67, 48, v64
    v_xor_b32_e64 v68, 64, v64
    v_mfma_f32_32x32x16_bf16 v[32:47], v[48:51], v[234:237], 0
    v_xor_b32 v69, 80, v64
    v_xor_b32 v70, 96, v64
    v_xor_b32 v71, 112, v64
    v_bfe_u32 v4, v1, 2, 2
    v_lshl_add_u32 v5, v3, 2, v4
    v_lshlrev_b32_e64 v5, 7, v5
    v_mfma_f32_32x32x16_bf16 v[144:159], v[56:59], v[242:245], 0
    v_mul_f32 v16, v16, v184
    v_mul_f32 v17, v17, v184
    v_mul_f32 v18, v18, v184
    v_mul_f32 v19, v19, v184
    v_mul_f32 v20, v20, v184
    v_mul_f32 v21, v21, v184
    v_mfma_f32_32x32x16_bf16 v[32:47], v[52:55], v[238:241], v[32:47]
    v_mul_f32 v22, v22, v184
    v_mul_f32 v23, v23, v184
    v_mul_f32 v24, v24, v184
    v_mul_f32 v25, v25, v184
    v_mul_f32 v26, v26, v184
    v_mul_f32 v27, v27, v184
    v_mfma_f32_32x32x16_bf16 v[144:159], v[60:63], v[246:249], v[144:159]
    v_mul_f32 v28, v28, v184
    v_mul_f32 v29, v29, v184
    v_mul_f32 v30, v30, v184
    v_mul_f32 v31, v31, v184
    v_fmac_f32 v16, v128, v185
    v_fmac_f32 v17, v129, v185
    v_cvt_pk_bf16_f32 v96, v16, v17
    v_fmac_f32 v18, v130, v185
    v_fmac_f32 v19, v131, v185
    v_cvt_pk_bf16_f32 v97, v18, v19
    v_fmac_f32 v20, v132, v185
    v_fmac_f32 v21, v133, v185
    v_cvt_pk_bf16_f32 v98, v20, v21
    v_fmac_f32 v22, v134, v185
    v_fmac_f32 v23, v135, v185
    v_cvt_pk_bf16_f32 v99, v22, v23
    buffer_store_dwordx4 v[96:99], v14, s[40:43], s76 offen offset:0 sc1
    v_fmac_f32 v24, v136, v185
    v_fmac_f32 v25, v137, v185
    v_cvt_pk_bf16_f32 v100, v24, v25
    v_fmac_f32 v26, v138, v185
    v_fmac_f32 v27, v139, v185
    v_cvt_pk_bf16_f32 v101, v26, v27
    v_fmac_f32 v28, v140, v185
    v_fmac_f32 v29, v141, v185
    v_cvt_pk_bf16_f32 v102, v28, v29
    v_fmac_f32 v30, v142, v185
    v_fmac_f32 v31, v143, v185
    v_cvt_pk_bf16_f32 v103, v30, v31
    buffer_store_dwordx4 v[100:103], v14, s[40:43], s76 offen offset:2048 sc1
    v_pk_mul_f32 v[32:33], v[32:33], v[186:187] op_sel_hi:[1,0]
    v_pk_fma_f32 v[32:33], v[144:145], v[186:187], v[32:33] op_sel:[0,1,0] op_sel_hi:[1,1,1]
    v_cvt_pk_bf16_f32 v104, v32, v33
    v_pk_mul_f32 v[34:35], v[34:35], v[186:187] op_sel_hi:[1,0]
    v_pk_fma_f32 v[34:35], v[146:147], v[186:187], v[34:35] op_sel:[0,1,0] op_sel_hi:[1,1,1]
    v_cvt_pk_bf16_f32 v105, v34, v35
    v_pk_mul_f32 v[36:37], v[36:37], v[186:187] op_sel_hi:[1,0]
    v_pk_fma_f32 v[36:37], v[148:149], v[186:187], v[36:37] op_sel:[0,1,0] op_sel_hi:[1,1,1]
    v_cvt_pk_bf16_f32 v106, v36, v37
    v_pk_mul_f32 v[38:39], v[38:39], v[186:187] op_sel_hi:[1,0]
    v_pk_fma_f32 v[38:39], v[150:151], v[186:187], v[38:39] op_sel:[0,1,0] op_sel_hi:[1,1,1]
    v_cvt_pk_bf16_f32 v107, v38, v39
    buffer_store_dwordx4 v[104:107], v14, s[40:43], s77 offen offset:0 sc1
    v_pk_mul_f32 v[40:41], v[40:41], v[186:187] op_sel_hi:[1,0]
    v_pk_fma_f32 v[40:41], v[152:153], v[186:187], v[40:41] op_sel:[0,1,0] op_sel_hi:[1,1,1]
    v_cvt_pk_bf16_f32 v108, v40, v41
    v_pk_mul_f32 v[42:43], v[42:43], v[186:187] op_sel_hi:[1,0]
    v_pk_fma_f32 v[42:43], v[154:155], v[186:187], v[42:43] op_sel:[0,1,0] op_sel_hi:[1,1,1]
    v_cvt_pk_bf16_f32 v109, v42, v43
    v_pk_mul_f32 v[44:45], v[44:45], v[186:187] op_sel_hi:[1,0]
    v_pk_fma_f32 v[44:45], v[156:157], v[186:187], v[44:45] op_sel:[0,1,0] op_sel_hi:[1,1,1]
    v_cvt_pk_bf16_f32 v110, v44, v45
    v_pk_mul_f32 v[46:47], v[46:47], v[186:187] op_sel_hi:[1,0]
    v_pk_fma_f32 v[46:47], v[158:159], v[186:187], v[46:47] op_sel:[0,1,0] op_sel_hi:[1,1,1]
    v_cvt_pk_bf16_f32 v111, v46, v47
    buffer_store_dwordx4 v[108:111], v14, s[40:43], s77 offen offset:2048 sc1
    v_lshrrev_b32_e64 v4, 1, v4
    v_lshl_add_u32 v5, v4, 6, v5
    v_bfe_u32 v4, v1, 4, 1
    v_lshl_add_u32 v5, v4, 5, v5
    v_and_b32_e64 v4, 3, v1
    v_lshl_add_u32 v5, v4, 3, v5
    v_add_u32 v72, 32768, v5
    v_xor_b32_e64 v73, 64, v72
    s_mul_i32 s80, s97, 524288
    s_mul_i32 s56, s62, 8192
    s_add_u32 s80, s80, s56
    s_add_u32 s80, s80, 16777216
    v_add_u32 v78, 4096, v14
    v_mov_b32 v74, 1
    s_mov_b32 s52, 0xffff
    s_mov_b32 s53, 0
    s_barrier
    ds_read_b32 v79, v8 offset:25984
    ds_read_b64 v[88:89], v64
    ds_read_b64 v[90:91], v65
    ds_read_b64 v[92:93], v66
    ds_read_b64 v[94:95], v67
    ds_read_b64 v[96:97], v68
    ds_read_b64 v[98:99], v69
    ds_read_b64 v[100:101], v70
    ds_read_b64 v[102:103], v71
    s_waitcnt lgkmcnt(8)
    v_readfirstlane_b32 s76, v79
    s_nop 0
    s_and_b32 s76, s76, s52
    s_cbranch_scc0 L_tr0
L_bk0:
    s_ff1_i32_b32 s76, s76
    s_bitset0_b32 s52, s76
    s_add_u32 s77, s76, s65
    s_and_b32 s77, s77, 15
    s_mul_i32 s77, s77, 32768
    s_add_u32 s28, s77, s80
    s_add_u32 s76, s76, 3
    s_and_b32 s76, s76, 15
    s_lshl_b32 s4, s76, 13
    buffer_load_dwordx4 v[128:131], v14, s[40:43], s28 offen offset:0 sc1
    buffer_load_dwordx4 v[132:135], v14, s[40:43], s28 offen offset:2048 sc1
    buffer_load_dwordx4 v[136:139], v78, s[40:43], s28 offen offset:0 sc1
    buffer_load_dwordx4 v[140:143], v78, s[40:43], s28 offen offset:2048 sc1
    v_readfirstlane_b32 s76, v79
    s_nop 0
    s_and_b32 s76, s76, s52
    s_cbranch_scc0 L_tr1
L_bk1:
    s_ff1_i32_b32 s76, s76
    s_bitset0_b32 s52, s76
    s_add_u32 s77, s76, s65
    s_and_b32 s77, s77, 15
    s_mul_i32 s77, s77, 32768
    s_add_u32 s29, s77, s80
    s_add_u32 s76, s76, 3
    s_and_b32 s76, s76, 15
    s_lshl_b32 s5, s76, 13
    buffer_load_dwordx4 v[144:147], v14, s[40:43], s29 offen offset:0 sc1
    buffer_load_dwordx4 v[148:151], v14, s[40:43], s29 offen offset:2048 sc1
    v_add_u32 v80, s4, v72
    v_add_u32 v81, s4, v73
    s_waitcnt lgkmcnt(0)
    v_lshlrev_b32 v16, 16, v88
    v_and_b32 v17, s90, v88
    v_lshlrev_b32 v18, 16, v89
    v_and_b32 v19, s90, v89
    v_lshlrev_b32 v20, 16, v90
    v_and_b32 v21, s90, v90
    v_lshlrev_b32 v22, 16, v91
    v_and_b32 v23, s90, v91
    v_lshlrev_b32 v24, 16, v92
    v_and_b32 v25, s90, v92
    v_lshlrev_b32 v26, 16, v93
    v_and_b32 v27, s90, v93
    v_lshlrev_b32 v28, 16, v94
    v_and_b32 v29, s90, v94
    v_lshlrev_b32 v30, 16, v95
    v_and_b32 v31, s90, v95
    v_lshlrev_b32 v32, 16, v96
    v_and_b32 v33, s90, v96
    v_lshlrev_b32 v34, 16, v97
    v_and_b32 v35, s90, v97
    v_lshlrev_b32 v36, 16, v98
    v_and_b32 v37, s90, v98
    v_lshlrev_b32 v38, 16, v99
    v_and_b32 v39, s90, v99
    v_lshlrev_b32 v40, 16, v100
    v_and_b32 v41, s90, v100
    v_lshlrev_b32 v42, 16, v101
    v_and_b32 v43, s90, v101
    v_lshlrev_b32 v44, 16, v102
    v_and_b32 v45, s90, v102
    v_lshlrev_b32 v46, 16, v103
    v_and_b32 v47, s90, v103
    s_cmp_eq_u32 s53, 0
    s_cbranch_scc0 L_sent_66
    s_waitcnt vmcnt(6)
    s_mov_b64 exec, 1
    ds_add_u32 v8, v74 offset:25988
    s_mov_b64 exec, -1
    s_mov_b32 s53, 1
L_sent_66:
    ds_read_b32 v79, v8 offset:25984
    ds_read_b64_tr_b16 v[104:105], v80 offset:0
    ds_read_b64_tr_b16 v[106:107], v80 offset:1024
    ds_read_b64_tr_b16 v[108:109], v81 offset:0
    ds_read_b64_tr_b16 v[110:111], v81 offset:1024
    ds_read_b64_tr_b16 v[112:113], v80 offset:2048
    ds_read_b64_tr_b16 v[114:115], v80 offset:3072
    ds_read_b64_tr_b16 v[116:117], v81 offset:2048
    ds_read_b64_tr_b16 v[118:119], v81 offset:3072
    s_waitcnt vmcnt(5) lgkmcnt(4)
    v_mfma_f32_32x32x16_bf16 v[16:31], v[104:107], v[128:131], v[16:31]
    ds_read_b64_tr_b16 v[120:121], v80 offset:4096
    ds_read_b64_tr_b16 v[122:123], v80 offset:5120
    buffer_load_dwordx4 v[152:155], v78, s[40:43], s29 offen offset:0 sc1
    v_mfma_f32_32x32x16_bf16 v[32:47], v[108:111], v[128:131], v[32:47]
    ds_read_b64_tr_b16 v[124:125], v81 offset:4096
    ds_read_b64_tr_b16 v[126:127], v81 offset:5120
    buffer_load_dwordx4 v[156:159], v78, s[40:43], s29 offen offset:2048 sc1
    v_readfirstlane_b32 s76, v79
    s_nop 0
    s_and_b32 s76, s76, s52
    s_cbranch_scc0 L_tr2
L_bk2:
    s_ff1_i32_b32 s76, s76
    s_bitset0_b32 s52, s76
    s_add_u32 s77, s76, s65
    s_and_b32 s77, s77, 15
    s_mul_i32 s77, s77, 32768
    s_add_u32 s30, s77, s80
    s_waitcnt vmcnt(6) lgkmcnt(4)
    v_mfma_f32_32x32x16_bf16 v[16:31], v[112:115], v[132:135], v[16:31]
    ds_read_b32 v79, v8 offset:25984
    ds_read_b64_tr_b16 v[104:105], v80 offset:6144
    ds_read_b64_tr_b16 v[106:107], v80 offset:7168
    buffer_load_dwordx4 v[160:163], v14, s[40:43], s30 offen offset:0 sc1
    s_add_u32 s76, s76, 3
    s_and_b32 s76, s76, 15
    s_lshl_b32 s6, s76, 13
    v_mfma_f32_32x32x16_bf16 v[32:47], v[116:119], v[132:135], v[32:47]
    ds_read_b64_tr_b16 v[108:109], v81 offset:6144
    ds_read_b64_tr_b16 v[110:111], v81 offset:7168
    buffer_load_dwordx4 v[164:167], v14, s[40:43], s30 offen offset:2048 sc1
    v_add_u32 v82, s5, v72
    v_add_u32_e64 v83, s5, v73
    s_waitcnt vmcnt(7) lgkmcnt(4)
    v_mfma_f32_32x32x16_bf16 v[16:31], v[120:123], v[136:139], v[16:31]
    ds_read_b64_tr_b16 v[112:113], v82 offset:0
    ds_read_b64_tr_b16 v[114:115], v82 offset:1024
    buffer_load_dwordx4 v[168:171], v78, s[40:43], s30 offen offset:0 sc1
    v_mfma_f32_32x32x16_bf16 v[32:47], v[124:127], v[136:139], v[32:47]
    ds_read_b64_tr_b16 v[116:117], v83 offset:0
    ds_read_b64_tr_b16 v[118:119], v83 offset:1024
    buffer_load_dwordx4 v[172:175], v78, s[40:43], s30 offen offset:2048 sc1
    v_readfirstlane_b32 s76, v79
    s_nop 0
    s_and_b32 s76, s76, s52
    s_cbranch_scc0 L_tr3
L_bk3:
    s_ff1_i32_b32 s76, s76
    s_bitset0_b32 s52, s76
    s_add_u32 s77, s76, s65
    s_and_b32 s77, s77, 15
    s_mul_i32 s77, s77, 32768
    s_add_u32 s31, s77, s80
    s_waitcnt vmcnt(8) lgkmcnt(4)
    v_mfma_f32_32x32x16_bf16 v[16:31], v[104:107], v[140:143], v[16:31]
    ds_read_b32 v79, v8 offset:25984
    ds_read_b64_tr_b16 v[120:121], v82 offset:2048
    ds_read_b64_tr_b16 v[122:123], v82 offset:3072
    buffer_load_dwordx4 v[176:179], v14, s[40:43], s31 offen offset:0 sc1
    s_add_u32 s76, s76, 3
    s_and_b32 s76, s76, 15
    s_lshl_b32 s7, s76, 13
    v_mfma_f32_32x32x16_bf16 v[32:47], v[108:111], v[140:143], v[32:47]
    ds_read_b64_tr_b16 v[124:125], v83 offset:2048
    ds_read_b64_tr_b16 v[126:127], v83 offset:3072
    buffer_load_dwordx4 v[180:183], v14, s[40:43], s31 offen offset:2048 sc1
    s_waitcnt vmcnt(9) lgkmcnt(4)
    v_mfma_f32_32x32x16_bf16 v[16:31], v[112:115], v[144:147], v[16:31]
    ds_read_b64_tr_b16 v[104:105], v82 offset:4096
    ds_read_b64_tr_b16 v[106:107], v82 offset:5120
    buffer_load_dwordx4 v[184:187], v78, s[40:43], s31 offen offset:0 sc1
    v_mfma_f32_32x32x16_bf16 v[32:47], v[116:119], v[144:147], v[32:47]
    ds_read_b64_tr_b16 v[108:109], v83 offset:4096
    ds_read_b64_tr_b16 v[110:111], v83 offset:5120
    buffer_load_dwordx4 v[188:191], v78, s[40:43], s31 offen offset:2048 sc1
    v_readfirstlane_b32 s76, v79
    s_nop 0
    s_and_b32 s76, s76, s52
    s_cbranch_scc0 L_tr4
L_bk4:
    s_ff1_i32_b32 s76, s76
    s_bitset0_b32 s52, s76
    s_add_u32 s77, s76, s65
    s_and_b32 s77, s77, 15
    s_mul_i32 s77, s77, 32768
    s_add_u32 s32, s77, s80
    s_waitcnt vmcnt(10) lgkmcnt(4)
    v_mfma_f32_32x32x16_bf16 v[16:31], v[120:123], v[148:151], v[16:31]
    ds_read_b64_tr_b16 v[112:113], v82 offset:6144
    ds_read_b64_tr_b16 v[114:115], v82 offset:7168
    buffer_load_dwordx4 v[128:131], v14, s[40:43], s32 offen offset:0 sc1
    s_add_u32 s76, s76, 3
    s_and_b32 s76, s76, 15
    s_lshl_b32 s8, s76, 13
    v_mfma_f32_32x32x16_bf16 v[32:47], v[124:127], v[148:151], v[32:47]
    ds_read_b64_tr_b16 v[116:117], v83 offset:6144
    ds_read_b64_tr_b16 v[118:119], v83 offset:7168
    buffer_load_dwordx4 v[132:135], v14, s[40:43], s32 offen offset:2048 sc1
    v_add_u32 v80, s6, v72
    v_add_u32 v81, s6, v73
    s_waitcnt vmcnt(11) lgkmcnt(4)
    v_mfma_f32_32x32x16_bf16 v[16:31], v[104:107], v[152:155], v[16:31]
    ds_read_b32 v79, v8 offset:25984
    ds_read_b64_tr_b16 v[120:121], v80 offset:0
    ds_read_b64_tr_b16 v[122:123], v80 offset:1024
    buffer_load_dwordx4 v[136:139], v78, s[40:43], s32 offen offset:0 sc1
    v_mfma_f32_32x32x16_bf16 v[32:47], v[108:111], v[152:155], v[32:47]
    ds_read_b64_tr_b16 v[124:125], v81 offset:0
    ds_read_b64_tr_b16 v[126:127], v81 offset:1024
    s_waitcnt vmcnt(11) lgkmcnt(4)
    v_mfma_f32_32x32x16_bf16 v[16:31], v[112:115], v[156:159], v[16:31]
    ds_read_b64_tr_b16 v[104:105], v80 offset:2048
    ds_read_b64_tr_b16 v[106:107], v80 offset:3072
    buffer_load_dwordx4 v[140:143], v78, s[40:43], s32 offen offset:2048 sc1
    v_mfma_f32_32x32x16_bf16 v[32:47], v[116:119], v[156:159], v[32:47]
    ds_read_b64_tr_b16 v[108:109], v81 offset:2048
    ds_read_b64_tr_b16 v[110:111], v81 offset:3072
    v_readfirstlane_b32 s76, v79
    s_nop 0
    s_and_b32 s76, s76, s52
    s_cbranch_scc0 L_tr5
L_bk5:
    s_ff1_i32_b32 s76, s76
    s_bitset0_b32 s52, s76
    s_add_u32 s77, s76, s65
    s_and_b32 s77, s77, 15
    s_mul_i32 s77, s77, 32768
    s_add_u32 s33, s77, s80
    s_waitcnt vmcnt(11) lgkmcnt(4)
    v_mfma_f32_32x32x16_bf16 v[16:31], v[120:123], v[160:163], v[16:31]
    ds_read_b64_tr_b16 v[112:113], v80 offset:4096
    ds_read_b64_tr_b16 v[114:115], v80 offset:5120
    buffer_load_dwordx4 v[144:147], v14, s[40:43], s33 offen offset:0 sc1
    s_add_u32 s76, s76, 3
    s_and_b32 s76, s76, 15
    s_lshl_b32 s9, s76, 13
    v_mfma_f32_32x32x16_bf16 v[32:47], v[124:127], v[160:163], v[32:47]
    ds_read_b64_tr_b16 v[116:117], v81 offset:4096
    ds_read_b64_tr_b16 v[118:119], v81 offset:5120
    s_waitcnt vmcnt(11) lgkmcnt(4)
    v_mfma_f32_32x32x16_bf16 v[16:31], v[104:107], v[164:167], v[16:31]
    ds_read_b64_tr_b16 v[120:121], v80 offset:6144
    ds_read_b64_tr_b16 v[122:123], v80 offset:7168
    buffer_load_dwordx4 v[148:151], v14, s[40:43], s33 offen offset:2048 sc1
    v_mfma_f32_32x32x16_bf16 v[32:47], v[108:111], v[164:167], v[32:47]
    ds_read_b64_tr_b16 v[124:125], v81 offset:6144
    ds_read_b64_tr_b16 v[126:127], v81 offset:7168
    v_add_u32 v82, s7, v72
    v_add_u32 v83, s7, v73
    s_waitcnt vmcnt(11) lgkmcnt(4)
    v_mfma_f32_32x32x16_bf16 v[16:31], v[112:115], v[168:171], v[16:31]
    ds_read_b32 v79, v8 offset:25984
    ds_read_b64_tr_b16 v[104:105], v82 offset:0
    ds_read_b64_tr_b16 v[106:107], v82 offset:1024
    buffer_load_dwordx4 v[152:155], v78, s[40:43], s33 offen offset:0 sc1
    v_mfma_f32_32x32x16_bf16 v[32:47], v[116:119], v[168:171], v[32:47]
    ds_read_b64_tr_b16 v[108:109], v83 offset:0
    ds_read_b64_tr_b16 v[110:111], v83 offset:1024
    s_waitcnt vmcnt(11) lgkmcnt(4)
    v_mfma_f32_32x32x16_bf16 v[16:31], v[120:123], v[172:175], v[16:31]
    ds_read_b64_tr_b16 v[112:113], v82 offset:2048
    ds_read_b64_tr_b16 v[114:115], v82 offset:3072
    buffer_load_dwordx4 v[156:159], v78, s[40:43], s33 offen offset:2048 sc1
    v_mfma_f32_32x32x16_bf16 v[32:47], v[124:127], v[172:175], v[32:47]
    ds_read_b64_tr_b16 v[116:117], v83 offset:2048
    ds_read_b64_tr_b16 v[118:119], v83 offset:3072
    v_readfirstlane_b32 s76, v79
    s_nop 0
    s_and_b32 s76, s76, s52
    s_cbranch_scc0 L_tr6
L_bk6:
    s_ff1_i32_b32 s76, s76
    s_bitset0_b32 s52, s76
    s_add_u32 s77, s76, s65
    s_and_b32 s77, s77, 15
    s_mul_i32 s77, s77, 32768
    s_add_u32 s34, s77, s80
    s_waitcnt vmcnt(11) lgkmcnt(4)
    v_mfma_f32_32x32x16_bf16 v[16:31], v[104:107], v[176:179], v[16:31]
    ds_read_b64_tr_b16 v[120:121], v82 offset:4096
    ds_read_b64_tr_b16 v[122:123], v82 offset:5120
    buffer_load_dwordx4 v[160:163], v14, s[40:43], s34 offen offset:0 sc1
    s_add_u32 s76, s76, 3
    s_and_b32 s76, s76, 15
    s_lshl_b32 s10, s76, 13
    v_mfma_f32_32x32x16_bf16 v[32:47], v[108:111], v[176:179], v[32:47]
    ds_read_b64_tr_b16 v[124:125], v83 offset:4096
    ds_read_b64_tr_b16 v[126:127], v83 offset:5120
    s_waitcnt vmcnt(11) lgkmcnt(4)
    v_mfma_f32_32x32x16_bf16 v[16:31], v[112:115], v[180:183], v[16:31]
    ds_read_b64_tr_b16 v[104:105], v82 offset:6144
    ds_read_b64_tr_b16 v[106:107], v82 offset:7168
    buffer_load_dwordx4 v[164:167], v14, s[40:43], s34 offen offset:2048 sc1
    v_mfma_f32_32x32x16_bf16 v[32:47], v[116:119], v[180:183], v[32:47]
    ds_read_b64_tr_b16 v[108:109], v83 offset:6144
    ds_read_b64_tr_b16 v[110:111], v83 offset:7168
    v_add_u32 v80, s8, v72
    v_add_u32 v81, s8, v73
    s_waitcnt vmcnt(11) lgkmcnt(4)
    v_mfma_f32_32x32x16_bf16 v[16:31], v[120:123], v[184:187], v[16:31]
    ds_read_b32 v79, v8 offset:25984
    ds_read_b64_tr_b16 v[112:113], v80 offset:0
    ds_read_b64_tr_b16 v[114:115], v80 offset:1024
    buffer_load_dwordx4 v[168:171], v78, s[40:43], s34 offen offset:0 sc1
    v_mfma_f32_32x32x16_bf16 v[32:47], v[124:127], v[184:187], v[32:47]
    ds_read_b64_tr_b16 v[116:117], v81 offset:0
    ds_read_b64_tr_b16 v[118:119], v81 offset:1024
    s_waitcnt vmcnt(11) lgkmcnt(4)
    v_mfma_f32_32x32x16_bf16 v[16:31], v[104:107], v[188:191], v[16:31]
    ds_read_b64_tr_b16 v[120:121], v80 offset:2048
    ds_read_b64_tr_b16 v[122:123], v80 offset:3072
    buffer_load_dwordx4 v[172:175], v78, s[40:43], s34 offen offset:2048 sc1
    v_mfma_f32_32x32x16_bf16 v[32:47], v[108:111], v[188:191], v[32:47]
    ds_read_b64_tr_b16 v[124:125], v81 offset:2048
    ds_read_b64_tr_b16 v[126:127], v81 offset:3072
    v_readfirstlane_b32 s76, v79
    s_nop 0
    s_and_b32 s76, s76, s52
    s_cbranch_scc0 L_tr7
L_bk7:
    s_ff1_i32_b32 s76, s76
    s_bitset0_b32 s52, s76
    s_add_u32 s77, s76, s65
    s_and_b32 s77, s77, 15
    s_mul_i32 s77, s77, 32768
    s_add_u32 s35, s77, s80
    s_waitcnt vmcnt(11) lgkmcnt(4)
    v_mfma_f32_32x32x16_bf16 v[16:31], v[112:115], v[128:131], v[16:31]
    ds_read_b64_tr_b16 v[104:105], v80 offset:4096
    ds_read_b64_tr_b16 v[106:107], v80 offset:5120
    buffer_load_dwordx4 v[176:179], v14, s[40:43], s35 offen offset:0 sc1
    s_add_u32 s76, s76, 3
    s_and_b32 s76, s76, 15
    s_lshl_b32 s11, s76, 13
    v_mfma_f32_32x32x16_bf16 v[32:47], v[116:119], v[128:131], v[32:47]
    ds_read_b64_tr_b16 v[108:109], v81 offset:4096
    ds_read_b64_tr_b16 v[110:111], v81 offset:5120
    s_waitcnt vmcnt(11) lgkmcnt(4)
    v_mfma_f32_32x32x16_bf16 v[16:31], v[120:123], v[132:135], v[16:31]
    ds_read_b64_tr_b16 v[112:113], v80 offset:6144
    ds_read_b64_tr_b16 v[114:115], v80 offset:7168
    buffer_load_dwordx4 v[180:183], v14, s[40:43], s35 offen offset:2048 sc1
    v_mfma_f32_32x32x16_bf16 v[32:47], v[124:127], v[132:135], v[32:47]
    ds_read_b64_tr_b16 v[116:117], v81 offset:6144
    ds_read_b64_tr_b16 v[118:119], v81 offset:7168
    v_add_u32 v82, s9, v72
    v_add_u32 v83, s9, v73
    s_waitcnt vmcnt(11) lgkmcnt(4)
    v_mfma_f32_32x32x16_bf16 v[16:31], v[104:107], v[136:139], v[16:31]
    ds_read_b32 v79, v8 offset:25984
    ds_read_b64_tr_b16 v[120:121], v82 offset:0
    ds_read_b64_tr_b16 v[122:123], v82 offset:1024
    buffer_load_dwordx4 v[184:187], v78, s[40:43], s35 offen offset:0 sc1
    v_mfma_f32_32x32x16_bf16 v[32:47], v[108:111], v[136:139], v[32:47]
    ds_read_b64_tr_b16 v[124:125], v83 offset:0
    ds_read_b64_tr_b16 v[126:127], v83 offset:1024
    s_waitcnt vmcnt(11) lgkmcnt(4)
    v_mfma_f32_32x32x16_bf16 v[16:31], v[112:115], v[140:143], v[16:31]
    ds_read_b64_tr_b16 v[104:105], v82 offset:2048
    ds_read_b64_tr_b16 v[106:107], v82 offset:3072
    buffer_load_dwordx4 v[188:191], v78, s[40:43], s35 offen offset:2048 sc1
    v_mfma_f32_32x32x16_bf16 v[32:47], v[116:119], v[140:143], v[32:47]
    ds_read_b64_tr_b16 v[108:109], v83 offset:2048
    ds_read_b64_tr_b16 v[110:111], v83 offset:3072
    v_readfirstlane_b32 s76, v79
    s_nop 0
    s_and_b32 s76, s76, s52
    s_cbranch_scc0 L_tr8
L_bk8:
    s_ff1_i32_b32 s76, s76
    s_bitset0_b32 s52, s76
    s_add_u32 s77, s76, s65
    s_and_b32 s77, s77, 15
    s_mul_i32 s77, s77, 32768
    s_add_u32 s36, s77, s80
    s_waitcnt vmcnt(11) lgkmcnt(4)
    v_mfma_f32_32x32x16_bf16 v[16:31], v[120:123], v[144:147], v[16:31]
    ds_read_b64_tr_b16 v[112:113], v82 offset:4096
    ds_read_b64_tr_b16 v[114:115], v82 offset:5120
    buffer_load_dwordx4 v[128:131], v14, s[40:43], s36 offen offset:0 sc1
    s_add_u32 s76, s76, 3
    s_and_b32 s76, s76, 15
    s_lshl_b32 s12, s76, 13
    v_mfma_f32_32x32x16_bf16 v[32:47], v[124:127], v[144:147], v[32:47]
    ds_read_b64_tr_b16 v[116:117], v83 offset:4096
    ds_read_b64_tr_b16 v[118:119], v83 offset:5120
    s_waitcnt vmcnt(11) lgkmcnt(4)
    v_mfma_f32_32x32x16_bf16 v[16:31], v[104:107], v[148:151], v[16:31]
    ds_read_b64_tr_b16 v[120:121], v82 offset:6144
    ds_read_b64_tr_b16 v[122:123], v82 offset:7168
    buffer_load_dwordx4 v[132:135], v14, s[40:43], s36 offen offset:2048 sc1
    v_mfma_f32_32x32x16_bf16 v[32:47], v[108:111], v[148:151], v[32:47]
    ds_read_b64_tr_b16 v[124:125], v83 offset:6144
    ds_read_b64_tr_b16 v[126:127], v83 offset:7168
    v_add_u32 v80, s10, v72
    v_add_u32 v81, s10, v73
    s_waitcnt vmcnt(11) lgkmcnt(4)
    v_mfma_f32_32x32x16_bf16 v[16:31], v[112:115], v[152:155], v[16:31]
    ds_read_b32 v79, v8 offset:25984
    ds_read_b64_tr_b16 v[104:105], v80 offset:0
    ds_read_b64_tr_b16 v[106:107], v80 offset:1024
    buffer_load_dwordx4 v[136:139], v78, s[40:43], s36 offen offset:0 sc1
    v_mfma_f32_32x32x16_bf16 v[32:47], v[116:119], v[152:155], v[32:47]
    ds_read_b64_tr_b16 v[108:109], v81 offset:0
    ds_read_b64_tr_b16 v[110:111], v81 offset:1024
    s_waitcnt vmcnt(11) lgkmcnt(4)
    v_mfma_f32_32x32x16_bf16 v[16:31], v[120:123], v[156:159], v[16:31]
    ds_read_b64_tr_b16 v[112:113], v80 offset:2048
    ds_read_b64_tr_b16 v[114:115], v80 offset:3072
    buffer_load_dwordx4 v[140:143], v78, s[40:43], s36 offen offset:2048 sc1
    v_mfma_f32_32x32x16_bf16 v[32:47], v[124:127], v[156:159], v[32:47]
    ds_read_b64_tr_b16 v[116:117], v81 offset:2048
    ds_read_b64_tr_b16 v[118:119], v81 offset:3072
    v_readfirstlane_b32 s76, v79
    s_nop 0
    s_and_b32 s76, s76, s52
    s_cbranch_scc0 L_tr9
L_bk9:
    s_ff1_i32_b32 s76, s76
    s_bitset0_b32 s52, s76
    s_add_u32 s77, s76, s65
    s_and_b32 s77, s77, 15
    s_mul_i32 s77, s77, 32768
    s_add_u32 s37, s77, s80
    s_waitcnt vmcnt(11) lgkmcnt(4)
    v_mfma_f32_32x32x16_bf16 v[16:31], v[104:107], v[160:163], v[16:31]
    ds_read_b64_tr_b16 v[120:121], v80 offset:4096
    ds_read_b64_tr_b16 v[122:123], v80 offset:5120
    buffer_load_dwordx4 v[144:147], v14, s[40:43], s37 offen offset:0 sc1
    s_add_u32 s76, s76, 3
    s_and_b32 s76, s76, 15
    s_lshl_b32 s13, s76, 13
    v_mfma_f32_32x32x16_bf16 v[32:47], v[108:111], v[160:163], v[32:47]
    ds_read_b64_tr_b16 v[124:125], v81 offset:4096
    ds_read_b64_tr_b16 v[126:127], v81 offset:5120
    s_waitcnt vmcnt(11) lgkmcnt(4)
    v_mfma_f32_32x32x16_bf16 v[16:31], v[112:115], v[164:167], v[16:31]
    ds_read_b64_tr_b16 v[104:105], v80 offset:6144
    ds_read_b64_tr_b16 v[106:107], v80 offset:7168
    buffer_load_dwordx4 v[148:151], v14, s[40:43], s37 offen offset:2048 sc1
    v_mfma_f32_32x32x16_bf16 v[32:47], v[116:119], v[164:167], v[32:47]
    ds_read_b64_tr_b16 v[108:109], v81 offset:6144
    ds_read_b64_tr_b16 v[110:111], v81 offset:7168
    v_add_u32 v82, s11, v72
    v_add_u32 v83, s11, v73
    s_waitcnt vmcnt(11) lgkmcnt(4)
    v_mfma_f32_32x32x16_bf16 v[16:31], v[120:123], v[168:171], v[16:31]
    ds_read_b32 v79, v8 offset:25984
    ds_read_b64_tr_b16 v[112:113], v82 offset:0
    ds_read_b64_tr_b16 v[114:115], v82 offset:1024
    buffer_load_dwordx4 v[152:155], v78, s[40:43], s37 offen offset:0 sc1
    v_mfma_f32_32x32x16_bf16 v[32:47], v[124:127], v[168:171], v[32:47]
    ds_read_b64_tr_b16 v[116:117], v83 offset:0
    ds_read_b64_tr_b16 v[118:119], v83 offset:1024
    s_waitcnt vmcnt(11) lgkmcnt(4)
    v_mfma_f32_32x32x16_bf16 v[16:31], v[104:107], v[172:175], v[16:31]
    ds_read_b64_tr_b16 v[120:121], v82 offset:2048
    ds_read_b64_tr_b16 v[122:123], v82 offset:3072
    buffer_load_dwordx4 v[156:159], v78, s[40:43], s37 offen offset:2048 sc1
    v_mfma_f32_32x32x16_bf16 v[32:47], v[108:111], v[172:175], v[32:47]
    ds_read_b64_tr_b16 v[124:125], v83 offset:2048
    ds_read_b64_tr_b16 v[126:127], v83 offset:3072
    v_readfirstlane_b32 s76, v79
    s_nop 0
    s_and_b32 s76, s76, s52
    s_cbranch_scc0 L_tr10
L_bk10:
    s_ff1_i32_b32 s76, s76
    s_bitset0_b32 s52, s76
    s_add_u32 s77, s76, s65
    s_and_b32 s77, s77, 15
    s_mul_i32 s77, s77, 32768
    s_add_u32 s38, s77, s80
    s_waitcnt vmcnt(11) lgkmcnt(4)
    v_mfma_f32_32x32x16_bf16 v[16:31], v[112:115], v[176:179], v[16:31]
    ds_read_b64_tr_b16 v[104:105], v82 offset:4096
    ds_read_b64_tr_b16 v[106:107], v82 offset:5120
    buffer_load_dwordx4 v[160:163], v14, s[40:43], s38 offen offset:0 sc1
    s_add_u32 s76, s76, 3
    s_and_b32 s76, s76, 15
    s_lshl_b32 s14, s76, 13
    v_mfma_f32_32x32x16_bf16 v[32:47], v[116:119], v[176:179], v[32:47]
    ds_read_b64_tr_b16 v[108:109], v83 offset:4096
    ds_read_b64_tr_b16 v[110:111], v83 offset:5120
    s_waitcnt vmcnt(11) lgkmcnt(4)
    v_mfma_f32_32x32x16_bf16 v[16:31], v[120:123], v[180:183], v[16:31]
    ds_read_b64_tr_b16 v[112:113], v82 offset:6144
    ds_read_b64_tr_b16 v[114:115], v82 offset:7168
    buffer_load_dwordx4 v[164:167], v14, s[40:43], s38 offen offset:2048 sc1
    v_mfma_f32_32x32x16_bf16 v[32:47], v[124:127], v[180:183], v[32:47]
    ds_read_b64_tr_b16 v[116:117], v83 offset:6144
    ds_read_b64_tr_b16 v[118:119], v83 offset:7168
    v_add_u32 v80, s12, v72
    v_add_u32 v81, s12, v73
    s_waitcnt vmcnt(11) lgkmcnt(4)
    v_mfma_f32_32x32x16_bf16 v[16:31], v[104:107], v[184:187], v[16:31]
    ds_read_b32 v79, v8 offset:25984
    ds_read_b64_tr_b16 v[120:121], v80 offset:0
    ds_read_b64_tr_b16 v[122:123], v80 offset:1024
    buffer_load_dwordx4 v[168:171], v78, s[40:43], s38 offen offset:0 sc1
    v_mfma_f32_32x32x16_bf16 v[32:47], v[108:111], v[184:187], v[32:47]
    ds_read_b64_tr_b16 v[124:125], v81 offset:0
    ds_read_b64_tr_b16 v[126:127], v81 offset:1024
    s_waitcnt vmcnt(11) lgkmcnt(4)
    v_mfma_f32_32x32x16_bf16 v[16:31], v[112:115], v[188:191], v[16:31]
    ds_read_b64_tr_b16 v[104:105], v80 offset:2048
    ds_read_b64_tr_b16 v[106:107], v80 offset:3072
    buffer_load_dwordx4 v[172:175], v78, s[40:43], s38 offen offset:2048 sc1
    v_mfma_f32_32x32x16_bf16 v[32:47], v[116:119], v[188:191], v[32:47]
    ds_read_b64_tr_b16 v[108:109], v81 offset:2048
    ds_read_b64_tr_b16 v[110:111], v81 offset:3072
    v_readfirstlane_b32 s76, v79
    s_nop 0
    s_and_b32 s76, s76, s52
    s_cbranch_scc0 L_tr11
L_bk11:
    s_ff1_i32_b32 s76, s76
    s_bitset0_b32 s52, s76
    s_add_u32 s77, s76, s65
    s_and_b32 s77, s77, 15
    s_mul_i32 s77, s77, 32768
    s_add_u32 s39, s77, s80
    s_waitcnt vmcnt(11) lgkmcnt(4)
    v_mfma_f32_32x32x16_bf16 v[16:31], v[120:123], v[128:131], v[16:31]
    ds_read_b64_tr_b16 v[112:113], v80 offset:4096
    ds_read_b64_tr_b16 v[114:115], v80 offset:5120
    buffer_load_dwordx4 v[176:179], v14, s[40:43], s39 offen offset:0 sc1
    s_add_u32 s76, s76, 3
    s_and_b32 s76, s76, 15
    s_lshl_b32 s15, s76, 13
    v_mfma_f32_32x32x16_bf16 v[32:47], v[124:127], v[128:131], v[32:47]
    ds_read_b64_tr_b16 v[116:117], v81 offset:4096
    ds_read_b64_tr_b16 v[118:119], v81 offset:5120
    s_waitcnt vmcnt(11) lgkmcnt(4)
    v_mfma_f32_32x32x16_bf16 v[16:31], v[104:107], v[132:135], v[16:31]
    ds_read_b64_tr_b16 v[120:121], v80 offset:6144
    ds_read_b64_tr_b16 v[122:123], v80 offset:7168
    buffer_load_dwordx4 v[180:183], v14, s[40:43], s39 offen offset:2048 sc1
    v_mfma_f32_32x32x16_bf16 v[32:47], v[108:111], v[132:135], v[32:47]
    ds_read_b64_tr_b16 v[124:125], v81 offset:6144
    ds_read_b64_tr_b16 v[126:127], v81 offset:7168
    v_add_u32 v82, s13, v72
    v_add_u32 v83, s13, v73
    s_waitcnt vmcnt(11) lgkmcnt(4)
    v_mfma_f32_32x32x16_bf16 v[16:31], v[112:115], v[136:139], v[16:31]
    ds_read_b32 v79, v8 offset:25984
    ds_read_b64_tr_b16 v[104:105], v82 offset:0
    ds_read_b64_tr_b16 v[106:107], v82 offset:1024
    buffer_load_dwordx4 v[184:187], v78, s[40:43], s39 offen offset:0 sc1
    v_mfma_f32_32x32x16_bf16 v[32:47], v[116:119], v[136:139], v[32:47]
    ds_read_b64_tr_b16 v[108:109], v83 offset:0
    ds_read_b64_tr_b16 v[110:111], v83 offset:1024
    s_waitcnt vmcnt(11) lgkmcnt(4)
    v_mfma_f32_32x32x16_bf16 v[16:31], v[120:123], v[140:143], v[16:31]
    ds_read_b64_tr_b16 v[112:113], v82 offset:2048
    ds_read_b64_tr_b16 v[114:115], v82 offset:3072
    buffer_load_dwordx4 v[188:191], v78, s[40:43], s39 offen offset:2048 sc1
    v_mfma_f32_32x32x16_bf16 v[32:47], v[124:127], v[140:143], v[32:47]
    ds_read_b64_tr_b16 v[116:117], v83 offset:2048
    ds_read_b64_tr_b16 v[118:119], v83 offset:3072
    v_readfirstlane_b32 s76, v79
    s_nop 0
    s_and_b32 s76, s76, s52
    s_cbranch_scc0 L_tr12
L_bk12:
    s_ff1_i32_b32 s76, s76
    s_bitset0_b32 s52, s76
    s_add_u32 s77, s76, s65
    s_and_b32 s77, s77, 15
    s_mul_i32 s77, s77, 32768
    s_add_u32 s48, s77, s80
    s_waitcnt vmcnt(11) lgkmcnt(4)
    v_mfma_f32_32x32x16_bf16 v[16:31], v[104:107], v[144:147], v[16:31]
    ds_read_b64_tr_b16 v[120:121], v82 offset:4096
    ds_read_b64_tr_b16 v[122:123], v82 offset:5120
    buffer_load_dwordx4 v[128:131], v14, s[40:43], s48 offen offset:0 sc1
    s_add_u32 s76, s76, 3
    s_and_b32 s76, s76, 15
    s_lshl_b32 s16, s76, 13
    v_mfma_f32_32x32x16_bf16 v[32:47], v[108:111], v[144:147], v[32:47]
    ds_read_b64_tr_b16 v[124:125], v83 offset:4096
    ds_read_b64_tr_b16 v[126:127], v83 offset:5120
    s_waitcnt vmcnt(11) lgkmcnt(4)
    v_mfma_f32_32x32x16_bf16 v[16:31], v[112:115], v[148:151], v[16:31]
    ds_read_b64_tr_b16 v[104:105], v82 offset:6144
    ds_read_b64_tr_b16 v[106:107], v82 offset:7168
    buffer_load_dwordx4 v[132:135], v14, s[40:43], s48 offen offset:2048 sc1
    v_mfma_f32_32x32x16_bf16 v[32:47], v[116:119], v[148:151], v[32:47]
    ds_read_b64_tr_b16 v[108:109], v83 offset:6144
    ds_read_b64_tr_b16 v[110:111], v83 offset:7168
    v_add_u32 v80, s14, v72
    v_add_u32 v81, s14, v73
    s_waitcnt vmcnt(11) lgkmcnt(4)
    v_mfma_f32_32x32x16_bf16 v[16:31], v[120:123], v[152:155], v[16:31]
    ds_read_b32 v79, v8 offset:25984
    ds_read_b64_tr_b16 v[112:113], v80 offset:0
    ds_read_b64_tr_b16 v[114:115], v80 offset:1024
    buffer_load_dwordx4 v[136:139], v78, s[40:43], s48 offen offset:0 sc1
    v_mfma_f32_32x32x16_bf16 v[32:47], v[124:127], v[152:155], v[32:47]
    ds_read_b64_tr_b16 v[116:117], v81 offset:0
    ds_read_b64_tr_b16 v[118:119], v81 offset:1024
    s_waitcnt vmcnt(11) lgkmcnt(4)
    v_mfma_f32_32x32x16_bf16 v[16:31], v[104:107], v[156:159], v[16:31]
    ds_read_b64_tr_b16 v[120:121], v80 offset:2048
    ds_read_b64_tr_b16 v[122:123], v80 offset:3072
    buffer_load_dwordx4 v[140:143], v78, s[40:43], s48 offen offset:2048 sc1
    v_mfma_f32_32x32x16_bf16 v[32:47], v[108:111], v[156:159], v[32:47]
    ds_read_b64_tr_b16 v[124:125], v81 offset:2048
    ds_read_b64_tr_b16 v[126:127], v81 offset:3072
    v_readfirstlane_b32 s76, v79
    s_nop 0
    s_and_b32 s76, s76, s52
    s_cbranch_scc0 L_tr13
L_bk13:
    s_ff1_i32_b32 s76, s76
    s_bitset0_b32 s52, s76
    s_add_u32 s77, s76, s65
    s_and_b32 s77, s77, 15
    s_mul_i32 s77, s77, 32768
    s_add_u32 s49, s77, s80
    s_waitcnt vmcnt(11) lgkmcnt(4)
    v_mfma_f32_32x32x16_bf16 v[16:31], v[112:115], v[160:163], v[16:31]
    ds_read_b64_tr_b16 v[104:105], v80 offset:4096
    ds_read_b64_tr_b16 v[106:107], v80 offset:5120
    buffer_load_dwordx4 v[144:147], v14, s[40:43], s49 offen offset:0 sc1
    s_add_u32 s76, s76, 3
    s_and_b32 s76, s76, 15
    s_lshl_b32 s17, s76, 13
    v_mfma_f32_32x32x16_bf16 v[32:47], v[116:119], v[160:163], v[32:47]
    ds_read_b64_tr_b16 v[108:109], v81 offset:4096
    ds_read_b64_tr_b16 v[110:111], v81 offset:5120
    s_waitcnt vmcnt(11) lgkmcnt(4)
    v_mfma_f32_32x32x16_bf16 v[16:31], v[120:123], v[164:167], v[16:31]
    ds_read_b64_tr_b16 v[112:113], v80 offset:6144
    ds_read_b64_tr_b16 v[114:115], v80 offset:7168
    buffer_load_dwordx4 v[148:151], v14, s[40:43], s49 offen offset:2048 sc1
    v_mfma_f32_32x32x16_bf16 v[32:47], v[124:127], v[164:167], v[32:47]
    ds_read_b64_tr_b16 v[116:117], v81 offset:6144
    ds_read_b64_tr_b16 v[118:119], v81 offset:7168
    v_add_u32 v82, s15, v72
    v_add_u32 v83, s15, v73
    s_waitcnt vmcnt(11) lgkmcnt(4)
    v_mfma_f32_32x32x16_bf16 v[16:31], v[104:107], v[168:171], v[16:31]
    ds_read_b32 v79, v8 offset:25984
    ds_read_b64_tr_b16 v[120:121], v82 offset:0
    ds_read_b64_tr_b16 v[122:123], v82 offset:1024
    buffer_load_dwordx4 v[152:155], v78, s[40:43], s49 offen offset:0 sc1
    v_mfma_f32_32x32x16_bf16 v[32:47], v[108:111], v[168:171], v[32:47]
    ds_read_b64_tr_b16 v[124:125], v83 offset:0
    ds_read_b64_tr_b16 v[126:127], v83 offset:1024
    s_waitcnt vmcnt(11) lgkmcnt(4)
    v_mfma_f32_32x32x16_bf16 v[16:31], v[112:115], v[172:175], v[16:31]
    ds_read_b64_tr_b16 v[104:105], v82 offset:2048
    ds_read_b64_tr_b16 v[106:107], v82 offset:3072
    buffer_load_dwordx4 v[156:159], v78, s[40:43], s49 offen offset:2048 sc1
    v_mfma_f32_32x32x16_bf16 v[32:47], v[116:119], v[172:175], v[32:47]
    ds_read_b64_tr_b16 v[108:109], v83 offset:2048
    ds_read_b64_tr_b16 v[110:111], v83 offset:3072
    v_readfirstlane_b32 s76, v79
    s_nop 0
    s_and_b32 s76, s76, s52
    s_cbranch_scc0 L_tr14
L_bk14:
    s_ff1_i32_b32 s76, s76
    s_bitset0_b32 s52, s76
    s_add_u32 s77, s76, s65
    s_and_b32 s77, s77, 15
    s_mul_i32 s77, s77, 32768
    s_add_u32 s50, s77, s80
    s_waitcnt vmcnt(11) lgkmcnt(4)
    v_mfma_f32_32x32x16_bf16 v[16:31], v[120:123], v[176:179], v[16:31]
    ds_read_b64_tr_b16 v[112:113], v82 offset:4096
    ds_read_b64_tr_b16 v[114:115], v82 offset:5120
    buffer_load_dwordx4 v[160:163], v14, s[40:43], s50 offen offset:0 sc1
    s_add_u32 s76, s76, 3
    s_and_b32 s76, s76, 15
    s_lshl_b32 s18, s76, 13
    v_mfma_f32_32x32x16_bf16 v[32:47], v[124:127], v[176:179], v[32:47]
    ds_read_b64_tr_b16 v[116:117], v83 offset:4096
    ds_read_b64_tr_b16 v[118:119], v83 offset:5120
    s_waitcnt vmcnt(11) lgkmcnt(4)
    v_mfma_f32_32x32x16_bf16 v[16:31], v[104:107], v[180:183], v[16:31]
    ds_read_b64_tr_b16 v[120:121], v82 offset:6144
    ds_read_b64_tr_b16 v[122:123], v82 offset:7168
    buffer_load_dwordx4 v[164:167], v14, s[40:43], s50 offen offset:2048 sc1
    v_mfma_f32_32x32x16_bf16 v[32:47], v[108:111], v[180:183], v[32:47]
    ds_read_b64_tr_b16 v[124:125], v83 offset:6144
    ds_read_b64_tr_b16 v[126:127], v83 offset:7168
    v_add_u32 v80, s16, v72
    v_add_u32 v81, s16, v73
    s_waitcnt vmcnt(11) lgkmcnt(4)
    v_mfma_f32_32x32x16_bf16 v[16:31], v[112:115], v[184:187], v[16:31]
    ds_read_b32 v79, v8 offset:25984
    ds_read_b64_tr_b16 v[104:105], v80 offset:0
    ds_read_b64_tr_b16 v[106:107], v80 offset:1024
    buffer_load_dwordx4 v[168:171], v78, s[40:43], s50 offen offset:0 sc1
    v_mfma_f32_32x32x16_bf16 v[32:47], v[116:119], v[184:187], v[32:47]
    ds_read_b64_tr_b16 v[108:109], v81 offset:0
    ds_read_b64_tr_b16 v[110:111], v81 offset:1024
    s_waitcnt vmcnt(11) lgkmcnt(4)
    v_mfma_f32_32x32x16_bf16 v[16:31], v[120:123], v[188:191], v[16:31]
    ds_read_b64_tr_b16 v[112:113], v80 offset:2048
    ds_read_b64_tr_b16 v[114:115], v80 offset:3072
    buffer_load_dwordx4 v[172:175], v78, s[40:43], s50 offen offset:2048 sc1
    v_mfma_f32_32x32x16_bf16 v[32:47], v[124:127], v[188:191], v[32:47]
    ds_read_b64_tr_b16 v[116:117], v81 offset:2048
    ds_read_b64_tr_b16 v[118:119], v81 offset:3072
    v_readfirstlane_b32 s76, v79
    s_nop 0
    s_and_b32 s76, s76, s52
    s_cbranch_scc0 L_tr15
L_bk15:
    s_ff1_i32_b32 s76, s76
    s_bitset0_b32 s52, s76
    s_add_u32 s77, s76, s65
    s_and_b32 s77, s77, 15
    s_mul_i32 s77, s77, 32768
    s_add_u32 s51, s77, s80
    s_waitcnt vmcnt(11) lgkmcnt(4)
    v_mfma_f32_32x32x16_bf16 v[16:31], v[104:107], v[128:131], v[16:31]
    ds_read_b64_tr_b16 v[120:121], v80 offset:4096
    ds_read_b64_tr_b16 v[122:123], v80 offset:5120
    buffer_load_dwordx4 v[176:179], v14, s[40:43], s51 offen offset:0 sc1
    s_add_u32 s76, s76, 3
    s_and_b32 s76, s76, 15
    s_lshl_b32 s19, s76, 13
    v_mfma_f32_32x32x16_bf16 v[32:47], v[108:111], v[128:131], v[32:47]
    ds_read_b64_tr_b16 v[124:125], v81 offset:4096
    ds_read_b64_tr_b16 v[126:127], v81 offset:5120
    s_waitcnt vmcnt(11) lgkmcnt(4)
    v_mfma_f32_32x32x16_bf16 v[16:31], v[112:115], v[132:135], v[16:31]
    ds_read_b64_tr_b16 v[104:105], v80 offset:6144
    ds_read_b64_tr_b16 v[106:107], v80 offset:7168
    buffer_load_dwordx4 v[180:183], v14, s[40:43], s51 offen offset:2048 sc1
    v_mfma_f32_32x32x16_bf16 v[32:47], v[116:119], v[132:135], v[32:47]
    ds_read_b64_tr_b16 v[108:109], v81 offset:6144
    ds_read_b64_tr_b16 v[110:111], v81 offset:7168
    v_add_u32 v82, s17, v72
    v_add_u32 v83, s17, v73
    s_waitcnt vmcnt(11) lgkmcnt(4)
    v_mfma_f32_32x32x16_bf16 v[16:31], v[120:123], v[136:139], v[16:31]
    ds_read_b64 v[192:193], v10 offset:16384
    ds_read_b64_tr_b16 v[112:113], v82 offset:0
    ds_read_b64_tr_b16 v[114:115], v82 offset:1024
    buffer_load_dwordx4 v[184:187], v78, s[40:43], s51 offen offset:0 sc1
    v_mfma_f32_32x32x16_bf16 v[32:47], v[124:127], v[136:139], v[32:47]
    ds_read_b64_tr_b16 v[116:117], v83 offset:0
    ds_read_b64_tr_b16 v[118:119], v83 offset:1024
    s_waitcnt vmcnt(11) lgkmcnt(4)
    v_mfma_f32_32x32x16_bf16 v[16:31], v[104:107], v[140:143], v[16:31]
    ds_read_b64 v[194:195], v10 offset:16400
    ds_read_b64_tr_b16 v[120:121], v82 offset:2048
    ds_read_b64_tr_b16 v[122:123], v82 offset:3072
    buffer_load_dwordx4 v[188:191], v78, s[40:43], s51 offen offset:2048 sc1
    s_barrier
    v_mfma_f32_32x32x16_bf16 v[32:47], v[108:111], v[140:143], v[32:47]
    ds_read_b64_tr_b16 v[124:125], v83 offset:2048
    ds_read_b64_tr_b16 v[126:127], v83 offset:3072
    s_waitcnt vmcnt(11) lgkmcnt(4)
    v_mfma_f32_32x32x16_bf16 v[16:31], v[112:115], v[144:147], v[16:31]
    ds_read_b64 v[196:197], v10 offset:16416
    ds_read_b64_tr_b16 v[104:105], v82 offset:4096
    ds_read_b64_tr_b16 v[106:107], v82 offset:5120
    v_mfma_f32_32x32x16_bf16 v[32:47], v[116:119], v[144:147], v[32:47]
    ds_read_b64_tr_b16 v[108:109], v83 offset:4096
    ds_read_b64_tr_b16 v[110:111], v83 offset:5120
    s_waitcnt vmcnt(10) lgkmcnt(4)
    v_mfma_f32_32x32x16_bf16 v[16:31], v[120:123], v[148:151], v[16:31]
    ds_read_b64 v[198:199], v10 offset:16432
    ds_read_b64_tr_b16 v[112:113], v82 offset:6144
    ds_read_b64_tr_b16 v[114:115], v82 offset:7168
    v_mfma_f32_32x32x16_bf16 v[32:47], v[124:127], v[148:151], v[32:47]
    ds_read_b64_tr_b16 v[116:117], v83 offset:6144
    ds_read_b64_tr_b16 v[118:119], v83 offset:7168
    v_add_u32 v80, s18, v72
    v_add_u32_e64 v81, s18, v73
    s_waitcnt vmcnt(9) lgkmcnt(4)
    v_mfma_f32_32x32x16_bf16 v[16:31], v[104:107], v[152:155], v[16:31]
    ds_read_b64 v[200:201], v10 offset:16448
    ds_read_b64_tr_b16 v[120:121], v80 offset:0
    ds_read_b64_tr_b16 v[122:123], v80 offset:1024
    v_mfma_f32_32x32x16_bf16 v[32:47], v[108:111], v[152:155], v[32:47]
    ds_read_b64_tr_b16 v[124:125], v81 offset:0
    ds_read_b64_tr_b16 v[126:127], v81 offset:1024
    s_waitcnt vmcnt(8) lgkmcnt(4)
    v_mfma_f32_32x32x16_bf16 v[16:31], v[112:115], v[156:159], v[16:31]
    ds_read_b64 v[202:203], v10 offset:16464
    ds_read_b64_tr_b16 v[104:105], v80 offset:2048
    ds_read_b64_tr_b16 v[106:107], v80 offset:3072
    v_mfma_f32_32x32x16_bf16 v[32:47], v[116:119], v[156:159], v[32:47]
    ds_read_b64_tr_b16 v[108:109], v81 offset:2048
    ds_read_b64_tr_b16 v[110:111], v81 offset:3072
    s_waitcnt vmcnt(7) lgkmcnt(4)
    v_mfma_f32_32x32x16_bf16 v[16:31], v[120:123], v[160:163], v[16:31]
    ds_read_b64 v[204:205], v10 offset:16480
    ds_read_b64_tr_b16 v[112:113], v80 offset:4096
    ds_read_b64_tr_b16 v[114:115], v80 offset:5120
    v_mfma_f32_32x32x16_bf16 v[32:47], v[124:127], v[160:163], v[32:47]
    ds_read_b64_tr_b16 v[116:117], v81 offset:4096
    ds_read_b64_tr_b16 v[118:119], v81 offset:5120
    s_waitcnt vmcnt(6) lgkmcnt(4)
    v_mfma_f32_32x32x16_bf16 v[16:31], v[104:107], v[164:167], v[16:31]
    ds_read_b64 v[206:207], v10 offset:16496
    ds_read_b64_tr_b16 v[120:121], v80 offset:6144
    ds_read_b64_tr_b16 v[122:123], v80 offset:7168
    v_mfma_f32_32x32x16_bf16 v[32:47], v[108:111], v[164:167], v[32:47]
    ds_read_b64_tr_b16 v[124:125], v81 offset:6144
    ds_read_b64_tr_b16 v[126:127], v81 offset:7168
    v_add_u32 v82, s19, v72
    v_add_u32 v83, s19, v73
    s_waitcnt vmcnt(5) lgkmcnt(4)
    v_mfma_f32_32x32x16_bf16 v[16:31], v[112:115], v[168:171], v[16:31]
    ds_read_b128 v[208:211], v11 offset:16384
    ds_read_b64_tr_b16 v[104:105], v82 offset:0
    ds_read_b64_tr_b16 v[106:107], v82 offset:1024
    v_mfma_f32_32x32x16_bf16 v[32:47], v[116:119], v[168:171], v[32:47]
    ds_read_b64_tr_b16 v[108:109], v83 offset:0
    ds_read_b64_tr_b16 v[110:111], v83 offset:1024
    s_waitcnt vmcnt(4) lgkmcnt(4)
    v_mfma_f32_32x32x16_bf16 v[16:31], v[120:123], v[172:175], v[16:31]
    ds_read_b128 v[212:215], v11 offset:16400
    ds_read_b64_tr_b16 v[112:113], v82 offset:2048
    ds_read_b64_tr_b16 v[114:115], v82 offset:3072
    v_mfma_f32_32x32x16_bf16 v[32:47], v[124:127], v[172:175], v[32:47]
    ds_read_b64_tr_b16 v[116:117], v83 offset:2048
    ds_read_b64_tr_b16 v[118:119], v83 offset:3072
    s_waitcnt vmcnt(3) lgkmcnt(4)
    v_mfma_f32_32x32x16_bf16 v[16:31], v[104:107], v[176:179], v[16:31]
    ds_read_b64_tr_b16 v[120:121], v82 offset:4096
    ds_read_b64_tr_b16 v[122:123], v82 offset:5120
    v_mfma_f32_32x32x16_bf16 v[32:47], v[108:111], v[176:179], v[32:47]
    ds_read_b64_tr_b16 v[124:125], v83 offset:4096
    ds_read_b64_tr_b16 v[126:127], v83 offset:5120
    s_waitcnt vmcnt(2) lgkmcnt(4)
    v_mfma_f32_32x32x16_bf16 v[16:31], v[112:115], v[180:183], v[16:31]
    ds_read_b64_tr_b16 v[104:105], v82 offset:6144
    ds_read_b64_tr_b16 v[106:107], v82 offset:7168
    v_mfma_f32_32x32x16_bf16 v[32:47], v[116:119], v[180:183], v[32:47]
    ds_read_b64_tr_b16 v[108:109], v83 offset:6144
    ds_read_b64_tr_b16 v[110:111], v83 offset:7168
    s_waitcnt vmcnt(1) lgkmcnt(4)
    v_mfma_f32_32x32x16_bf16 v[16:31], v[120:123], v[184:187], v[16:31]
    v_mfma_f32_32x32x16_bf16 v[32:47], v[124:127], v[184:187], v[32:47]
    s_waitcnt vmcnt(0) lgkmcnt(0)
    v_mfma_f32_32x32x16_bf16 v[16:31], v[104:107], v[188:191], v[16:31]
    v_mfma_f32_32x32x16_bf16 v[32:47], v[108:111], v[188:191], v[32:47]
    s_nop 10
    v_cvt_pk_bf16_f32 v88, v16, v17
    v_cvt_pk_bf16_f32 v89, v18, v19
    v_cvt_pk_bf16_f32 v90, v20, v21
    v_cvt_pk_bf16_f32 v91, v22, v23
    v_cvt_pk_bf16_f32 v92, v24, v25
    v_cvt_pk_bf16_f32 v93, v26, v27
    v_cvt_pk_bf16_f32 v94, v28, v29
    v_cvt_pk_bf16_f32 v95, v30, v31
    v_cvt_pk_bf16_f32 v96, v32, v33
    v_cvt_pk_bf16_f32 v97, v34, v35
    v_cvt_pk_bf16_f32 v98, v36, v37
    v_cvt_pk_bf16_f32 v99, v38, v39
    v_cvt_pk_bf16_f32 v100, v40, v41
    v_cvt_pk_bf16_f32 v101, v42, v43
    v_cvt_pk_bf16_f32 v102, v44, v45
    v_cvt_pk_bf16_f32 v103, v46, v47
    v_dot2_f32_bf16 v104, v88, s89, 0
    v_dot2_f32_bf16 v105, v88, v88, 0
    v_dot2_f32_bf16 v106, v88, v192, 0
    v_dot2_f32_bf16 v104, v89, s89, v104
    v_dot2_f32_bf16 v105, v89, v89, v105
    v_dot2_f32_bf16 v106, v89, v193, v106
    v_dot2_f32_bf16 v104, v90, s89, v104
    v_dot2_f32_bf16 v105, v90, v90, v105
    v_dot2_f32_bf16 v106, v90, v194, v106
    v_dot2_f32_bf16 v104, v91, s89, v104
    v_dot2_f32_bf16 v105, v91, v91, v105
    v_dot2_f32_bf16 v106, v91, v195, v106
    v_dot2_f32_bf16 v104, v92, s89, v104
    v_dot2_f32_bf16 v105, v92, v92, v105
    v_dot2_f32_bf16 v106, v92, v196, v106
    v_dot2_f32_bf16 v104, v93, s89, v104
    v_dot2_f32_bf16 v105, v93, v93, v105
    v_dot2_f32_bf16 v106, v93, v197, v106
    v_dot2_f32_bf16 v104, v94, s89, v104
    v_dot2_f32_bf16 v105, v94, v94, v105
    v_dot2_f32_bf16 v106, v94, v198, v106
    v_dot2_f32_bf16 v104, v95, s89, v104
    v_dot2_f32_bf16 v105, v95, v95, v105
    v_dot2_f32_bf16 v106, v95, v199, v106
    v_dot2_f32_bf16 v104, v96, s89, v104
    v_dot2_f32_bf16 v105, v96, v96, v105
    v_dot2_f32_bf16 v106, v96, v200, v106
    v_dot2_f32_bf16 v104, v97, s89, v104
    v_dot2_f32_bf16 v105, v97, v97, v105
    v_dot2_f32_bf16 v106, v97, v201, v106
    v_dot2_f32_bf16 v104, v98, s89, v104
    v_dot2_f32_bf16 v105, v98, v98, v105
    v_dot2_f32_bf16 v106, v98, v202, v106
    v_dot2_f32_bf16 v104, v99, s89, v104
    v_dot2_f32_bf16 v105, v99, v99, v105
    v_dot2_f32_bf16 v106, v99, v203, v106
    v_dot2_f32_bf16 v104, v100, s89, v104
    v_dot2_f32_bf16 v105, v100, v100, v105
    v_dot2_f32_bf16 v106, v100, v204, v106
    v_dot2_f32_bf16 v104, v101, s89, v104
    v_dot2_f32_bf16 v105, v101, v101, v105
    v_dot2_f32_bf16 v106, v101, v205, v106
    v_dot2_f32_bf16 v104, v102, s89, v104
    v_dot2_f32_bf16 v105, v102, v102, v105
    v_dot2_f32_bf16 v106, v102, v206, v106
    v_dot2_f32_bf16 v104, v103, s89, v104
    v_dot2_f32_bf16 v105, v103, v103, v105
    v_dot2_f32_bf16 v106, v103, v207, v106
    s_lshl_b32 s76, s62, 9
    s_add_u32 s77, s76, s99
    v_mov_b32 v107, 0
    v_mov_b32 v4, v104
    v_mov_b32 v5, v105
    v_mov_b32 v6, v106
    v_permlane32_swap_b32 v104, v4
    v_permlane32_swap_b32 v105, v5
    v_permlane32_swap_b32 v106, v6
    v_add_f32 v104, v104, v4
    v_add_f32 v105, v105, v5
    v_add_f32_e64 v106, v106, v6
    s_mov_b32 exec_hi, 0
    s_bitcmp1_b32 s100, 1
    s_cbranch_scc1 L_loc_68
    buffer_store_dwordx4 v[104:107], v12, s[40:43], s77 offen offset:1024 sc1
    s_branch L_pubd_69
L_loc_68:
    buffer_store_dwordx4 v[104:107], v12, s[40:43], s77 offen offset:1024
L_pubd_69:
    s_mov_b64 exec, -1
    ds_write_b64 v64, v[88:89]
    ds_write_b64 v65, v[90:91]
    ds_write_b64 v66, v[92:93]
    ds_write_b64 v67, v[94:95]
    ds_write_b64 v68, v[96:97]
    ds_write_b64 v69, v[98:99]
    ds_write_b64 v70, v[100:101]
    ds_write_b64 v71, v[102:103]
    v_bfe_u32 v4, v1, 1, 3
    v_bfe_u32 v5, v1, 4, 1
    v_lshlrev_b32_e64 v176, 4, v4
    v_lshl_add_u32 v176, v5, 3, v176
    v_and_b32_e64 v5, 1, v1
    v_lshl_add_u32 v176, v5, 2, v176
    v_lshlrev_b32_e64 v177, 2, v2
    v_lshl_add_u32 v177, v3, 8, v177
    v_and_b32 v4, 15, v1
    v_lshrrev_b32 v5, 4, v1
    v_mul_u32_u24 v179, 149504, v4
    v_lshl_add_u32 v180, v5, 4, v179
    s_lshl_b32 s82, s97, 7
    s_lshl_b32 s79, s62, 5
    s_add_u32 s82, s82, s79
    s_lshl_b32 s79, s62, 2
    v_mov_b32_e64 v7, s79
    v_mul_u32_u24 v178, 9344, v3
    v_lshl_add_u32 v178, v2, 4, v178
    s_mul_i32 s78, s97, 149504
    s_add_u32 s78, s78, s76
    s_add_u32 s78, s78, 8388608
    s_add_u32 s48, s78, 18688
    s_add_u32 s49, s48, 18688
    s_add_u32 s50, s49, 18688
    s_add_u32 s51, s50, 18688
    s_add_u32 s52, s51, 18688
    s_add_u32 s53, s52, 18688
    s_add_u32 s54, s53, 18688
    buffer_load_dwordx4 v[112:115], v178, s[40:43], s78 offen offset:1024 sc1
    buffer_load_dwordx4 v[116:119], v178, s[40:43], s48 offen offset:1024 sc1
    buffer_load_dwordx4 v[120:123], v178, s[40:43], s49 offen offset:1024 sc1
    buffer_load_dwordx4 v[124:127], v178, s[40:43], s50 offen offset:1024 sc1
    buffer_load_dwordx4 v[128:131], v178, s[40:43], s51 offen offset:1024 sc1
    buffer_load_dwordx4 v[132:135], v178, s[40:43], s52 offen offset:1024 sc1
    buffer_load_dwordx4 v[136:139], v178, s[40:43], s53 offen offset:1024 sc1
    buffer_load_dwordx4 v[140:143], v178, s[40:43], s54 offen offset:1024 sc1
    v_dot2_f32_bf16 v76, v208, s89, 0
    v_dot2_f32_bf16 v76, v209, s89, v76
    v_dot2_f32_bf16 v76, v210, s89, v76
    v_dot2_f32_bf16 v76, v211, s89, v76
    v_dot2_f32_bf16 v76, v212, s89, v76
    v_dot2_f32_bf16 v76, v213, s89, v76
    v_dot2_f32_bf16 v76, v214, s89, v76
    v_dot2_f32_bf16 v76, v215, s89, v76
    s_nop 2
    v_add_f32_dpp v76, v76, v76 row_ror:8 row_mask:0xf bank_mask:0xf
    s_nop 1
    v_add_f32_dpp v76, v76, v76 row_ror:4 row_mask:0xf bank_mask:0xf
    s_nop 1
    v_add_f32_dpp v76, v76, v76 row_ror:2 row_mask:0xf bank_mask:0xf
    s_nop 1
    v_add_f32_dpp v76, v76, v76 row_ror:1 row_mask:0xf bank_mask:0xf
    v_mov_b32 v4, v76
    s_nop 1
    v_permlane16_swap_b32 v76, v4
    v_add_f32 v76, v76, v4
    v_mov_b32 v4, v76
    s_nop 1
    v_permlane32_swap_b32 v76, v4
    v_add_f32_e64 v76, v76, v4
    s_mov_b32 s88, 0
    s_waitcnt vmcnt(6)
    v_pk_add_f32 v[108:109], v[112:113], v[116:117]
    v_pk_add_f32 v[110:111], v[114:115], v[118:119]
    s_waitcnt vmcnt(5)
    v_pk_add_f32 v[108:109], v[108:109], v[120:121]
    v_pk_add_f32 v[110:111], v[110:111], v[122:123]
    s_waitcnt vmcnt(4)
    v_pk_add_f32 v[108:109], v[108:109], v[124:125]
    v_pk_add_f32 v[110:111], v[110:111], v[126:127]
    s_waitcnt vmcnt(3)
    v_pk_add_f32 v[108:109], v[108:109], v[128:129]
    v_pk_add_f32 v[110:111], v[110:111], v[130:131]
    s_waitcnt vmcnt(2)
    v_pk_add_f32 v[108:109], v[108:109], v[132:133]
    v_pk_add_f32 v[110:111], v[110:111], v[134:135]
    s_waitcnt vmcnt(1)
    v_pk_add_f32 v[108:109], v[108:109], v[136:137]
    v_pk_add_f32 v[110:111], v[110:111], v[138:139]
    s_waitcnt vmcnt(0)
    v_pk_add_f32 v[108:109], v[108:109], v[140:141]
    v_pk_add_f32 v[110:111], v[110:111], v[142:143]
    v_cmp_u_f32 vcc, v111, v111
    v_mov_b32 v4, v108
    v_mov_b32 v5, v109
    v_mov_b32 v6, v110
    s_cbranch_vccnz L_s3_71
L_s3ok_72:
    v_permlane32_swap_b32 v108, v4
    v_permlane32_swap_b32 v109, v5
    v_permlane32_swap_b32 v110, v6
    s_barrier
    v_add_f32 v108, v108, v4
    v_add_f32 v109, v109, v5
    v_add_f32 v110, v110, v6
    v_mul_f32 v108, 0x3a800000, v108
    v_mul_f32 v109, 0x3a800000, v109
    v_fma_f32 v4, -v108, v108, v109
    v_max_f32_e64 v4, 0, v4
    v_cvt_pk_bf16_f32 v116, v108, v108
    v_and_b32_e64 v116, s90, v116
    v_cvt_pk_bf16_f32 v4, v4, v4
    v_and_b32_e64 v4, s90, v4
    v_add_f32 v4, 0x3727c5ac, v4
    v_cvt_pk_bf16_f32 v4, v4, v4
    v_and_b32 v4, s90, v4
    v_sqrt_f32_e64 v4, v4
    s_nop 0
    v_cvt_pk_bf16_f32 v4, v4, v4
    v_and_b32 v4, s90, v4
    v_rcp_f32 v118, v4
    v_fma_f32 v120, -v116, v76, v110
    v_mul_f32 v119, v116, v118
    v_mul_f32 v120, v120, v118
    v_and_b32 v6, 3, v1
    v_lshlrev_b32 v6, 2, v6
    v_max_f32_dpp v4, v120, v120 row_ror:8 row_mask:0xf bank_mask:0xf
    s_lshl_b32 s83, s62, 12
    v_cmp_gt_u32 s[84:85], 32, v1
    v_max_f32_dpp v4, v4, v4 row_ror:4 row_mask:0xf bank_mask:0xf
    s_lshl_b32 s55, 1, s62
    s_sub_u32 s55, s55, 1
    v_max_f32_dpp v4, v4, v4 row_ror:2 row_mask:0xf bank_mask:0xf
    s_nop 1
    v_max_f32_dpp v4, v4, v4 row_ror:1 row_mask:0xf bank_mask:0xf
    v_mov_b32 v5, v4
    s_nop 1
    v_permlane16_swap_b32 v4, v5
    v_max_f32 v4, v4, v5
    v_cmp_eq_f32_e64 vcc, v4, v120
    ds_write_b32 v7, v4 offset:25600
    s_ff1_i32_b32 s77, vcc_lo
    s_and_b32 s77, s77, 31
    s_bfe_u32 s79, s77, 0x30001
    s_lshl3_add_u32 s79, s77, s79
    s_lshl4_add_u32 s79, s79, s83
    v_xor_b32_e64 v176, s79, v176
    ds_read_b32 v182, v176 offset:0
    s_waitcnt lgkmcnt(1)
    s_barrier
    ds_read_b32 v8, v6 offset:25600
    v_readlane_b32 s80, v118, s77
    v_readlane_b32 s81, v119, s77
    s_add_u32 s79, s82, s77
    v_writelane_b32 v4, s79, 33
    v_mov_b32 v5, s81
    s_waitcnt lgkmcnt(1)
    v_lshlrev_b32 v184, 16, v182
    v_and_b32_e64 v185, s90, v182
    v_fma_f32 v184, v184, s80, -v5
    v_fma_f32 v185, v185, s80, -v5
    v_cvt_pk_bf16_f32 v184, v184, v185
    v_cndmask_b32 v184, v4, v184, s[84:85]
    s_waitcnt lgkmcnt(0)
    v_cmp_eq_f32 s[56:57], v8, v4
    v_cmp_gt_f32 vcc, v8, v4
    s_and_b32 s56, s56, s55
    s_or_b32 s56, s56, vcc_lo
    s_cbranch_scc1 L_nopub_81
    buffer_store_dword v184, v177, s[40:43], s99 offen offset:0 sc1
L_nopub_81:
    v_lshlrev_b32 v16, 16, v88
    v_and_b32_e64 v17, s90, v88
    v_pk_fma_f32 v[144:145], v[16:17], v[118:119], v[118:119] op_sel:[0,0,1] op_sel_hi:[1,0,1] neg_lo:[0,0,1] neg_hi:[0,0,1]
    v_cvt_pk_bf16_f32 v124, v144, v145
    v_lshlrev_b32 v144, 16, v124
    v_and_b32 v145, s90, v124
    v_pk_add_f32 v[144:145], v[144:145], v[16:17]
    v_cvt_pk_bf16_f32 v124, v144, v145
    v_lshlrev_b32 v18, 16, v89
    v_and_b32 v19, s90, v89
    v_pk_fma_f32 v[146:147], v[18:19], v[118:119], v[118:119] op_sel:[0,0,1] op_sel_hi:[1,0,1] neg_lo:[0,0,1] neg_hi:[0,0,1]
    v_cvt_pk_bf16_f32 v125, v146, v147
    v_lshlrev_b32 v146, 16, v125
    v_and_b32 v147, s90, v125
    v_pk_add_f32 v[146:147], v[146:147], v[18:19]
    v_cvt_pk_bf16_f32 v125, v146, v147
    ds_write_b64 v64, v[124:125]
    v_lshlrev_b32 v20, 16, v90
    v_and_b32 v21, s90, v90
    v_pk_fma_f32 v[148:149], v[20:21], v[118:119], v[118:119] op_sel:[0,0,1] op_sel_hi:[1,0,1] neg_lo:[0,0,1] neg_hi:[0,0,1]
    v_cvt_pk_bf16_f32 v126, v148, v149
    v_lshlrev_b32 v148, 16, v126
    v_and_b32 v149, s90, v126
    v_pk_add_f32 v[148:149], v[148:149], v[20:21]
    v_cvt_pk_bf16_f32 v126, v148, v149
    v_lshlrev_b32 v22, 16, v91
    v_and_b32 v23, s90, v91
    v_pk_fma_f32 v[150:151], v[22:23], v[118:119], v[118:119] op_sel:[0,0,1] op_sel_hi:[1,0,1] neg_lo:[0,0,1] neg_hi:[0,0,1]
    v_cvt_pk_bf16_f32 v127, v150, v151
    v_lshlrev_b32 v150, 16, v127
    v_and_b32 v151, s90, v127
    v_pk_add_f32 v[150:151], v[150:151], v[22:23]
    v_cvt_pk_bf16_f32 v127, v150, v151
    ds_write_b64 v65, v[126:127]
    s_cmp_eq_u32 s56, 0
    s_cbranch_scc1 L_stay_82
    s_cmp_gt_u32 s62, 1
    s_cbranch_scc0 L_stay_82
    s_mov_b32 s91, -1
    v_lshlrev_b32 v24, 16, v92
    v_and_b32_e64 v25, s90, v92
    v_pk_fma_f32 v[152:153], v[24:25], v[118:119], v[118:119] op_sel:[0,0,1] op_sel_hi:[1,0,1] neg_lo:[0,0,1] neg_hi:[0,0,1]
    v_cvt_pk_bf16_f32 v128, v152, v153
    v_lshlrev_b32 v152, 16, v128
    v_and_b32 v153, s90, v128
    v_pk_add_f32 v[152:153], v[152:153], v[24:25]
    v_cvt_pk_bf16_f32 v128, v152, v153
    v_lshlrev_b32 v26, 16, v93
    v_and_b32 v27, s90, v93
    v_pk_fma_f32 v[154:155], v[26:27], v[118:119], v[118:119] op_sel:[0,0,1] op_sel_hi:[1,0,1] neg_lo:[0,0,1] neg_hi:[0,0,1]
    v_cvt_pk_bf16_f32 v129, v154, v155
    v_lshlrev_b32 v154, 16, v129
    v_and_b32 v155, s90, v129
    v_pk_add_f32 v[154:155], v[154:155], v[26:27]
    v_cvt_pk_bf16_f32 v129, v154, v155
    ds_write_b64 v66, v[128:129]
    v_lshlrev_b32 v28, 16, v94
    v_and_b32 v29, s90, v94
    v_pk_fma_f32 v[156:157], v[28:29], v[118:119], v[118:119] op_sel:[0,0,1] op_sel_hi:[1,0,1] neg_lo:[0,0,1] neg_hi:[0,0,1]
    v_cvt_pk_bf16_f32 v130, v156, v157
    v_lshlrev_b32 v156, 16, v130
    v_and_b32 v157, s90, v130
    v_pk_add_f32 v[156:157], v[156:157], v[28:29]
    v_cvt_pk_bf16_f32 v130, v156, v157
    v_lshlrev_b32 v30, 16, v95
    v_and_b32 v31, s90, v95
    v_pk_fma_f32 v[158:159], v[30:31], v[118:119], v[118:119] op_sel:[0,0,1] op_sel_hi:[1,0,1] neg_lo:[0,0,1] neg_hi:[0,0,1]
    v_cvt_pk_bf16_f32 v131, v158, v159
    v_lshlrev_b32 v158, 16, v131
    v_and_b32 v159, s90, v131
    v_pk_add_f32 v[158:159], v[158:159], v[30:31]
    v_cvt_pk_bf16_f32 v131, v158, v159
    ds_write_b64 v67, v[130:131]
    v_lshlrev_b32 v32, 16, v96
    v_and_b32 v33, s90, v96
    v_pk_fma_f32 v[160:161], v[32:33], v[118:119], v[118:119] op_sel:[0,0,1] op_sel_hi:[1,0,1] neg_lo:[0,0,1] neg_hi:[0,0,1]
    v_cvt_pk_bf16_f32 v132, v160, v161
    v_lshlrev_b32 v160, 16, v132
    v_and_b32 v161, s90, v132
    v_pk_add_f32 v[160:161], v[160:161], v[32:33]
    v_cvt_pk_bf16_f32 v132, v160, v161
    v_lshlrev_b32 v34, 16, v97
    v_and_b32 v35, s90, v97
    v_pk_fma_f32 v[162:163], v[34:35], v[118:119], v[118:119] op_sel:[0,0,1] op_sel_hi:[1,0,1] neg_lo:[0,0,1] neg_hi:[0,0,1]
    v_cvt_pk_bf16_f32 v133, v162, v163
    v_lshlrev_b32 v162, 16, v133
    v_and_b32 v163, s90, v133
    v_pk_add_f32 v[162:163], v[162:163], v[34:35]
    v_cvt_pk_bf16_f32 v133, v162, v163
    ds_write_b64 v68, v[132:133]
    v_lshlrev_b32 v36, 16, v98
    v_and_b32 v37, s90, v98
    v_pk_fma_f32 v[164:165], v[36:37], v[118:119], v[118:119] op_sel:[0,0,1] op_sel_hi:[1,0,1] neg_lo:[0,0,1] neg_hi:[0,0,1]
    v_cvt_pk_bf16_f32 v134, v164, v165
    v_lshlrev_b32 v164, 16, v134
    v_and_b32 v165, s90, v134
    v_pk_add_f32 v[164:165], v[164:165], v[36:37]
    v_cvt_pk_bf16_f32 v134, v164, v165
    v_lshlrev_b32 v38, 16, v99
    v_and_b32 v39, s90, v99
    v_pk_fma_f32 v[166:167], v[38:39], v[118:119], v[118:119] op_sel:[0,0,1] op_sel_hi:[1,0,1] neg_lo:[0,0,1] neg_hi:[0,0,1]
    v_cvt_pk_bf16_f32 v135, v166, v167
    v_lshlrev_b32 v166, 16, v135
    v_and_b32 v167, s90, v135
    v_pk_add_f32 v[166:167], v[166:167], v[38:39]
    v_cvt_pk_bf16_f32 v135, v166, v167
    ds_write_b64 v69, v[134:135]
    v_lshlrev_b32 v40, 16, v100
    v_and_b32 v41, s90, v100
    v_pk_fma_f32 v[168:169], v[40:41], v[118:119], v[118:119] op_sel:[0,0,1] op_sel_hi:[1,0,1] neg_lo:[0,0,1] neg_hi:[0,0,1]
    v_cvt_pk_bf16_f32 v136, v168, v169
    v_lshlrev_b32 v168, 16, v136
    v_and_b32 v169, s90, v136
    v_pk_add_f32 v[168:169], v[168:169], v[40:41]
    v_cvt_pk_bf16_f32 v136, v168, v169
    v_lshlrev_b32 v42, 16, v101
    v_and_b32 v43, s90, v101
    v_pk_fma_f32 v[170:171], v[42:43], v[118:119], v[118:119] op_sel:[0,0,1] op_sel_hi:[1,0,1] neg_lo:[0,0,1] neg_hi:[0,0,1]
    v_cvt_pk_bf16_f32 v137, v170, v171
    v_lshlrev_b32 v170, 16, v137
    v_and_b32 v171, s90, v137
    v_pk_add_f32 v[170:171], v[170:171], v[42:43]
    v_cvt_pk_bf16_f32 v137, v170, v171
    ds_write_b64 v70, v[136:137]
    v_lshlrev_b32 v44, 16, v102
    v_and_b32 v45, s90, v102
    v_pk_fma_f32 v[172:173], v[44:45], v[118:119], v[118:119] op_sel:[0,0,1] op_sel_hi:[1,0,1] neg_lo:[0,0,1] neg_hi:[0,0,1]
    v_cvt_pk_bf16_f32 v138, v172, v173
    v_lshlrev_b32 v172, 16, v138
    v_and_b32 v173, s90, v138
    v_pk_add_f32 v[172:173], v[172:173], v[44:45]
    v_cvt_pk_bf16_f32 v138, v172, v173
    v_lshlrev_b32 v46, 16, v103
    v_and_b32 v47, s90, v103
    v_pk_fma_f32 v[174:175], v[46:47], v[118:119], v[118:119] op_sel:[0,0,1] op_sel_hi:[1,0,1] neg_lo:[0,0,1] neg_hi:[0,0,1]
    v_cvt_pk_bf16_f32 v139, v174, v175
    v_lshlrev_b32 v174, 16, v139
    v_and_b32 v175, s90, v139
    v_pk_add_f32 v[174:175], v[174:175], v[46:47]
    v_cvt_pk_bf16_f32 v139, v174, v175
    ds_write_b64 v71, v[138:139]
    s_sub_u32 s77, s91, s82
    v_lshrrev_b32 v7, 3, v1
    v_sub_u32_e64 v5, s77, v7
    v_mov_b32 v6, 2146435072
    v_and_b32 v8, 7, v1
    v_lshrrev_b32 v9, 4, v1
    v_xor_b32 v8, v8, v9
    v_lshlrev_b32 v8, 4, v8
    v_lshl_add_u32 v7, v7, 11, v8
    v_xor_b32 v8, 64, v7
    s_lshl_b32 s58, s82, 11
    s_lshl_b32 s59, s98, 7
    s_add_u32 s58, s58, s59
    v_cmp_eq_u32 vcc, 0, v5
    s_nop 1
    v_cndmask_b32 v200, v7, v6, vcc
    v_cmp_eq_u32 vcc, 8, v5
    s_nop 1
    v_cndmask_b32 v201, v8, v6, vcc
    v_cmp_eq_u32 vcc, 16, v5
    s_nop 1
    v_cndmask_b32 v202, v7, v6, vcc
    v_cmp_eq_u32 vcc, 24, v5
    s_nop 1
    v_cndmask_b32 v203, v8, v6, vcc
    s_lshl_b32 s77, s62, 12
    s_add_u32 s77, s77, 0
    v_add_u32 v4, s77, v12
    s_waitcnt lgkmcnt(0)
    ds_read_b128 v[48:51], v4 offset:0
    ds_read_b128 v[52:55], v4 offset:1024
    ds_read_b128 v[56:59], v4 offset:2048
    ds_read_b128 v[60:63], v4 offset:3072
    s_waitcnt lgkmcnt(3)
    buffer_store_dwordx4 v[48:51], v200, s[44:47], s58 offen sc1
    s_add_u32 s58, s58, 16384
    s_waitcnt lgkmcnt(2)
    buffer_store_dwordx4 v[52:55], v201, s[44:47], s58 offen sc1
    s_add_u32 s58, s58, 16384
    s_waitcnt lgkmcnt(1)
    buffer_store_dwordx4 v[56:59], v202, s[44:47], s58 offen sc1
    s_add_u32 s58, s58, 16384
    s_waitcnt lgkmcnt(0)
    buffer_store_dwordx4 v[60:63], v203, s[44:47], s58 offen sc1
    s_barrier
    s_barrier
    s_branch L_cdone
L_stay_82:
    v_and_b32 v7, 15, v1
    v_lshlrev_b32_e64 v7, 3, v7
    s_cmp_eq_u32 s62, 0
    s_cbranch_scc0 L_nos4_83
    s_mul_i32 s76, s98, 9344
    s_add_u32 s76, s76, 8388608
    s_add_u32 s20, s26, s99
    s_addc_u32 s21, s27, 0
    s_mov_b32 s88, 0
L_spin_84:
    s_load_dwordx16 s[4:19], s[20:21], 768 glc
    s_waitcnt lgkmcnt(0)
    s_or_b64 s[4:5], s[4:5], s[6:7]
    s_or_b64 s[4:5], s[4:5], s[8:9]
    s_or_b64 s[4:5], s[4:5], s[10:11]
    s_or_b64 s[4:5], s[4:5], s[12:13]
    s_or_b64 s[4:5], s[4:5], s[14:15]
    s_or_b64 s[4:5], s[4:5], s[16:17]
    s_or_b64 s[4:5], s[4:5], s[18:19]
    s_cbranch_scc0 L_gate_85
    s_add_u32 s88, s88, 1
    s_cmp_lt_u32 s88, 65536
    s_cbranch_scc1 L_spin_84
L_gate_85:
    s_mov_b32 s88, 0
L_poll_86:
    buffer_load_dwordx2 v[196:197], v179, s[40:43], s76 offen offset:256 sc1
    buffer_load_dwordx4 v[188:191], v180, s[40:43], s76 offen offset:0 sc1
    buffer_load_dwordx4 v[192:195], v180, s[40:43], s76 offen offset:64 sc1
    s_waitcnt vmcnt(0)
    v_max3_u32 v4, v196, v197, v188
    v_max3_u32 v4, v4, v189, v190
    v_max3_u32 v4, v4, v191, v192
    v_max3_u32 v4, v4, v193, v194
    v_max_u32 v4, v4, v195
    v_cmp_eq_u32_e64 vcc, -1, v4
    s_nop 0
    s_cbranch_vccz L_ok_87
    s_add_u32 s88, s88, 1
    s_cmp_lt_u32 s88, 65536
    s_cbranch_scc1 L_poll_86
L_ok_87:
    ds_write_b128 v12, v[188:191] offset:28672
    ds_write_b128 v12, v[192:195] offset:29696
    ds_write_b64 v7, v[196:197] offset:25728
L_nos4_83:
    s_waitcnt lgkmcnt(0)
    s_barrier
    ds_read_b64 v[8:9], v7 offset:25728
    s_waitcnt lgkmcnt(0)
    v_max_f32_dpp v4, v8, v8 row_ror:8 row_mask:0xf bank_mask:0xf
    s_nop 1
    v_max_f32_dpp v4, v4, v4 row_ror:4 row_mask:0xf bank_mask:0xf
    s_nop 1
    v_max_f32_dpp v4, v4, v4 row_ror:2 row_mask:0xf bank_mask:0xf
    s_nop 1
    v_max_f32_dpp v4, v4, v4 row_ror:1 row_mask:0xf bank_mask:0xf
    v_cmp_eq_f32 vcc, v4, v8
    s_nop 0
    s_ff1_i32_b32 s92, vcc_lo
    s_and_b32 s92, s92, 15
    s_nop 3
    v_readlane_b32 s91, v9, s92
    s_nop 0
    s_cmp_eq_u32 s91, s79
    s_cbranch_scc0 L_noh_88
    s_mov_b32 exec_hi, 0
    buffer_store_dword v182, v177, s[40:43], s99 offen offset:128 sc1
    s_mov_b64 exec, -1
L_noh_88:
    s_sub_u32 s77, s91, s82
    v_lshrrev_b32 v7, 3, v1
    v_sub_u32 v5, s77, v7
    v_mov_b32 v6, 2146435072
    v_and_b32 v8, 7, v1
    v_lshrrev_b32 v9, 4, v1
    v_xor_b32 v8, v8, v9
    v_lshlrev_b32 v8, 4, v8
    v_lshl_add_u32 v7, v7, 11, v8
    v_xor_b32 v8, 64, v7
    s_lshl_b32 s58, s82, 11
    s_lshl_b32 s59, s98, 7
    s_add_u32 s58, s58, s59
    v_cmp_eq_u32 vcc, 0, v5
    s_nop 1
    v_cndmask_b32 v200, v7, v6, vcc
    v_cmp_eq_u32 vcc, 8, v5
    s_nop 1
    v_cndmask_b32 v201, v8, v6, vcc
    v_cmp_eq_u32 vcc, 16, v5
    s_nop 1
    v_cndmask_b32 v202, v7, v6, vcc
    v_cmp_eq_u32 vcc, 24, v5
    s_nop 1
    v_cndmask_b32 v203, v8, v6, vcc
    s_lshl_b32 s77, s62, 12
    s_add_u32 s77, s77, 0
    v_add_u32 v4, s77, v12
    v_lshlrev_b32 v24, 16, v92
    v_and_b32_e64 v25, s90, v92
    v_pk_fma_f32 v[152:153], v[24:25], v[118:119], v[118:119] op_sel:[0,0,1] op_sel_hi:[1,0,1] neg_lo:[0,0,1] neg_hi:[0,0,1]
    v_cvt_pk_bf16_f32 v128, v152, v153
    v_lshlrev_b32 v152, 16, v128
    v_and_b32 v153, s90, v128
    v_pk_add_f32 v[152:153], v[152:153], v[24:25]
    v_cvt_pk_bf16_f32 v128, v152, v153
    v_lshlrev_b32 v26, 16, v93
    v_and_b32 v27, s90, v93
    v_pk_fma_f32 v[154:155], v[26:27], v[118:119], v[118:119] op_sel:[0,0,1] op_sel_hi:[1,0,1] neg_lo:[0,0,1] neg_hi:[0,0,1]
    v_cvt_pk_bf16_f32 v129, v154, v155
    v_lshlrev_b32 v154, 16, v129
    v_and_b32 v155, s90, v129
    v_pk_add_f32 v[154:155], v[154:155], v[26:27]
    v_cvt_pk_bf16_f32 v129, v154, v155
    ds_write_b64 v66, v[128:129]
    v_lshlrev_b32 v28, 16, v94
    v_and_b32 v29, s90, v94
    v_pk_fma_f32 v[156:157], v[28:29], v[118:119], v[118:119] op_sel:[0,0,1] op_sel_hi:[1,0,1] neg_lo:[0,0,1] neg_hi:[0,0,1]
    v_cvt_pk_bf16_f32 v130, v156, v157
    v_lshlrev_b32 v156, 16, v130
    v_and_b32 v157, s90, v130
    v_pk_add_f32 v[156:157], v[156:157], v[28:29]
    v_cvt_pk_bf16_f32 v130, v156, v157
    v_lshlrev_b32 v30, 16, v95
    v_and_b32 v31, s90, v95
    v_pk_fma_f32 v[158:159], v[30:31], v[118:119], v[118:119] op_sel:[0,0,1] op_sel_hi:[1,0,1] neg_lo:[0,0,1] neg_hi:[0,0,1]
    v_cvt_pk_bf16_f32 v131, v158, v159
    v_lshlrev_b32 v158, 16, v131
    v_and_b32 v159, s90, v131
    v_pk_add_f32 v[158:159], v[158:159], v[30:31]
    v_cvt_pk_bf16_f32 v131, v158, v159
    ds_write_b64 v67, v[130:131]
    v_lshlrev_b32 v32, 16, v96
    v_and_b32 v33, s90, v96
    v_pk_fma_f32 v[160:161], v[32:33], v[118:119], v[118:119] op_sel:[0,0,1] op_sel_hi:[1,0,1] neg_lo:[0,0,1] neg_hi:[0,0,1]
    v_cvt_pk_bf16_f32 v132, v160, v161
    v_lshlrev_b32 v160, 16, v132
    v_and_b32 v161, s90, v132
    v_pk_add_f32 v[160:161], v[160:161], v[32:33]
    v_cvt_pk_bf16_f32 v132, v160, v161
    v_lshlrev_b32 v34, 16, v97
    v_and_b32 v35, s90, v97
    v_pk_fma_f32 v[162:163], v[34:35], v[118:119], v[118:119] op_sel:[0,0,1] op_sel_hi:[1,0,1] neg_lo:[0,0,1] neg_hi:[0,0,1]
    v_cvt_pk_bf16_f32 v133, v162, v163
    v_lshlrev_b32 v162, 16, v133
    v_and_b32 v163, s90, v133
    v_pk_add_f32 v[162:163], v[162:163], v[34:35]
    v_cvt_pk_bf16_f32 v133, v162, v163
    ds_write_b64 v68, v[132:133]
    v_lshlrev_b32 v36, 16, v98
    v_and_b32 v37, s90, v98
    v_pk_fma_f32 v[164:165], v[36:37], v[118:119], v[118:119] op_sel:[0,0,1] op_sel_hi:[1,0,1] neg_lo:[0,0,1] neg_hi:[0,0,1]
    v_cvt_pk_bf16_f32 v134, v164, v165
    v_lshlrev_b32 v164, 16, v134
    v_and_b32 v165, s90, v134
    v_pk_add_f32 v[164:165], v[164:165], v[36:37]
    v_cvt_pk_bf16_f32 v134, v164, v165
    v_lshlrev_b32 v38, 16, v99
    v_and_b32 v39, s90, v99
    v_pk_fma_f32 v[166:167], v[38:39], v[118:119], v[118:119] op_sel:[0,0,1] op_sel_hi:[1,0,1] neg_lo:[0,0,1] neg_hi:[0,0,1]
    v_cvt_pk_bf16_f32 v135, v166, v167
    v_lshlrev_b32 v166, 16, v135
    v_and_b32 v167, s90, v135
    v_pk_add_f32 v[166:167], v[166:167], v[38:39]
    v_cvt_pk_bf16_f32 v135, v166, v167
    ds_write_b64 v69, v[134:135]
    v_lshlrev_b32 v40, 16, v100
    v_and_b32 v41, s90, v100
    v_pk_fma_f32 v[168:169], v[40:41], v[118:119], v[118:119] op_sel:[0,0,1] op_sel_hi:[1,0,1] neg_lo:[0,0,1] neg_hi:[0,0,1]
    v_cvt_pk_bf16_f32 v136, v168, v169
    v_lshlrev_b32 v168, 16, v136
    v_and_b32 v169, s90, v136
    v_pk_add_f32 v[168:169], v[168:169], v[40:41]
    v_cvt_pk_bf16_f32 v136, v168, v169
    v_lshlrev_b32 v42, 16, v101
    v_and_b32 v43, s90, v101
    v_pk_fma_f32 v[170:171], v[42:43], v[118:119], v[118:119] op_sel:[0,0,1] op_sel_hi:[1,0,1] neg_lo:[0,0,1] neg_hi:[0,0,1]
    v_cvt_pk_bf16_f32 v137, v170, v171
    v_lshlrev_b32 v170, 16, v137
    v_and_b32 v171, s90, v137
    v_pk_add_f32 v[170:171], v[170:171], v[42:43]
    v_cvt_pk_bf16_f32 v137, v170, v171
    ds_write_b64 v70, v[136:137]
    v_lshlrev_b32 v44, 16, v102
    v_and_b32 v45, s90, v102
    v_pk_fma_f32 v[172:173], v[44:45], v[118:119], v[118:119] op_sel:[0,0,1] op_sel_hi:[1,0,1] neg_lo:[0,0,1] neg_hi:[0,0,1]
    v_cvt_pk_bf16_f32 v138, v172, v173
    v_lshlrev_b32 v172, 16, v138
    v_and_b32 v173, s90, v138
    v_pk_add_f32 v[172:173], v[172:173], v[44:45]
    v_cvt_pk_bf16_f32 v138, v172, v173
    v_lshlrev_b32 v46, 16, v103
    v_and_b32 v47, s90, v103
    v_pk_fma_f32 v[174:175], v[46:47], v[118:119], v[118:119] op_sel:[0,0,1] op_sel_hi:[1,0,1] neg_lo:[0,0,1] neg_hi:[0,0,1]
    v_cvt_pk_bf16_f32 v139, v174, v175
    v_lshlrev_b32 v174, 16, v139
    v_and_b32 v175, s90, v139
    v_pk_add_f32 v[174:175], v[174:175], v[46:47]
    v_cvt_pk_bf16_f32 v139, v174, v175
    ds_write_b64 v71, v[138:139]
    s_barrier
    s_waitcnt lgkmcnt(0)
    ds_read_b128 v[48:51], v4 offset:0
    ds_read_b128 v[52:55], v4 offset:1024
    ds_read_b128 v[56:59], v4 offset:2048
    ds_read_b128 v[60:63], v4 offset:3072
    s_waitcnt lgkmcnt(3)
    buffer_store_dwordx4 v[48:51], v200, s[44:47], s58 offen sc1
    s_add_u32 s58, s58, 16384
    s_waitcnt lgkmcnt(2)
    buffer_store_dwordx4 v[52:55], v201, s[44:47], s58 offen sc1
    s_add_u32 s58, s58, 16384
    s_waitcnt lgkmcnt(1)
    buffer_store_dwordx4 v[56:59], v202, s[44:47], s58 offen sc1
    s_add_u32 s58, s58, 16384
    s_waitcnt lgkmcnt(0)
    buffer_store_dwordx4 v[60:63], v203, s[44:47], s58 offen sc1
L_cdone:
L_cfin:
L_end:
    s_endpgm
L_tr0:
    s_call_b64 s[54:55], L_stall
    s_branch L_bk0
L_tr1:
    s_call_b64 s[54:55], L_stall
    s_branch L_bk1
L_tr2:
    s_call_b64 s[54:55], L_stall
    s_branch L_bk2
L_tr3:
    s_call_b64 s[54:55], L_stall
    s_branch L_bk3
L_tr4:
    s_call_b64 s[54:55], L_stall
    s_branch L_bk4
L_tr5:
    s_call_b64 s[54:55], L_stall
    s_branch L_bk5
L_tr6:
    s_call_b64 s[54:55], L_stall
    s_branch L_bk6
L_tr7:
    s_call_b64 s[54:55], L_stall
    s_branch L_bk7
L_tr8:
    s_call_b64 s[54:55], L_stall
    s_branch L_bk8
L_tr9:
    s_call_b64 s[54:55], L_stall
    s_branch L_bk9
L_tr10:
    s_call_b64 s[54:55], L_stall
    s_branch L_bk10
L_tr11:
    s_call_b64 s[54:55], L_stall
    s_branch L_bk11
L_tr12:
    s_call_b64 s[54:55], L_stall
    s_branch L_bk12
L_tr13:
    s_call_b64 s[54:55], L_stall
    s_branch L_bk13
L_tr14:
    s_call_b64 s[54:55], L_stall
    s_branch L_bk14
L_tr15:
    s_call_b64 s[54:55], L_stall
    s_branch L_bk15
L_stall:
    s_cmp_eq_u32 s53, 0
    s_cbranch_scc0 L_sent_67
    s_waitcnt vmcnt(0)
    s_mov_b64 exec, 1
    ds_add_u32 v8, v74 offset:25988
    s_mov_b64 exec, -1
    s_mov_b32 s53, 1
L_sent_67:
    s_mov_b32 s88, 0
L_stall1:
    ds_read_b32 v79, v8 offset:25984
    s_waitcnt lgkmcnt(0)
    v_readfirstlane_b32 s76, v79
    s_nop 0
    s_and_b32 s76, s76, s52
    s_cbranch_scc1 L_stall2
    s_add_u32 s88, s88, 1
    s_cmp_lt_u32 s88, 1048576
    s_cbranch_scc1 L_stall1
    s_mov_b32 s76, s52
L_stall2:
    s_setpc_b64 s[54:55]
L_s3_71:
    v_cmp_eq_u32 vcc, -1, v115
    s_nop 0
    s_cbranch_vccz L_s3skip_73
    buffer_load_dwordx4 v[112:115], v178, s[40:43], s78 offen offset:1024 sc1
L_s3skip_73:
    v_cmp_eq_u32_e64 vcc, -1, v119
    s_nop 0
    s_cbranch_vccz L_s3skip_74
    buffer_load_dwordx4 v[116:119], v178, s[40:43], s48 offen offset:1024 sc1
L_s3skip_74:
    v_cmp_eq_u32_e64 vcc, -1, v123
    s_nop 0
    s_cbranch_vccz L_s3skip_75
    buffer_load_dwordx4 v[120:123], v178, s[40:43], s49 offen offset:1024 sc1
L_s3skip_75:
    v_cmp_eq_u32_e64 vcc, -1, v127
    s_nop 0
    s_cbranch_vccz L_s3skip_76
    buffer_load_dwordx4 v[124:127], v178, s[40:43], s50 offen offset:1024 sc1
L_s3skip_76:
    v_cmp_eq_u32_e64 vcc, -1, v131
    s_nop 0
    s_cbranch_vccz L_s3skip_77
    buffer_load_dwordx4 v[128:131], v178, s[40:43], s51 offen offset:1024 sc1
L_s3skip_77:
    v_cmp_eq_u32_e64 vcc, -1, v135
    s_nop 0
    s_cbranch_vccz L_s3skip_78
    buffer_load_dwordx4 v[132:135], v178, s[40:43], s52 offen offset:1024 sc1
L_s3skip_78:
    v_cmp_eq_u32_e64 vcc, -1, v139
    s_nop 0
    s_cbranch_vccz L_s3skip_79
    buffer_load_dwordx4 v[136:139], v178, s[40:43], s53 offen offset:1024 sc1
L_s3skip_79:
    v_cmp_eq_u32_e64 vcc, -1, v143
    s_nop 0
    s_cbranch_vccz L_s3skip_80
    buffer_load_dwordx4 v[140:143], v178, s[40:43], s54 offen offset:1024 sc1
L_s3skip_80:
    s_waitcnt vmcnt(0)
    v_pk_add_f32 v[108:109], v[112:113], v[116:117]
    v_pk_add_f32 v[110:111], v[114:115], v[118:119]
    v_pk_add_f32 v[108:109], v[108:109], v[120:121]
    v_pk_add_f32 v[110:111], v[110:111], v[122:123]
    v_pk_add_f32 v[108:109], v[108:109], v[124:125]
    v_pk_add_f32 v[110:111], v[110:111], v[126:127]
    v_pk_add_f32 v[108:109], v[108:109], v[128:129]
    v_pk_add_f32 v[110:111], v[110:111], v[130:131]
    v_pk_add_f32 v[108:109], v[108:109], v[132:133]
    v_pk_add_f32 v[110:111], v[110:111], v[134:135]
    v_pk_add_f32 v[108:109], v[108:109], v[136:137]
    v_pk_add_f32 v[110:111], v[110:111], v[138:139]
    v_pk_add_f32 v[108:109], v[108:109], v[140:141]
    v_pk_add_f32 v[110:111], v[110:111], v[142:143]
    v_cmp_u_f32 vcc, v111, v111
    v_mov_b32 v4, v108
    v_mov_b32 v5, v109
    v_mov_b32_e64 v6, v110
    s_cbranch_vccz L_s3ok_72
    s_add_u32 s88, s88, 1
    s_cmp_lt_u32 s88, 65536
    s_cbranch_scc1 L_s3_71
    s_branch L_s3ok_72
L_code_end:
s_endpgm
.p2align 7
.type L_table,@object
L_table:
.long 0x650c3824, 0xfedba97, 0x50102, 0x3006
.long 0x650c3824, 0xfedba97, 0x510200, 0x3060
.long 0x641d0935, 0xfecba87, 0x5020001, 0x3600
.long 0x76543218, 0xfedcba9, 0x15000002, 0x6300
.long 0x641d0935, 0xfecba87, 0x25100, 0x3006
.long 0x54e2a160, 0xfdcb987, 0x502001, 0x3060
.long 0x54e2a160, 0xfdcb987, 0x5002010, 0x3600
.long 0x54f3b271, 0xedca986, 0x50201000, 0x6300
.long 0x54f3b271, 0xedca986, 0x152000, 0x3006
.long 0x650c3824, 0xfedba97, 0x520010, 0x3060
.long 0x650c3824, 0xfedba97, 0x5020001, 0x3600
.long 0x76543218, 0xfedcba9, 0x50000012, 0x6300
.long 0x641d0935, 0xfecba87, 0x25010, 0x3006
.long 0x641d0935, 0xfecba87, 0x510020, 0x3060
.long 0x54e2a160, 0xfdcb987, 0x5100002, 0x3600
.long 0x54e2a160, 0xfdcb987, 0x50001002, 0x6300
.long 0x641d0935, 0xfecba87, 0x500210, 0x3060
.long 0x641d0935, 0xfecba87, 0x5010200, 0x3600
.long 0x54e2a160, 0xfdcb987, 0x50100002, 0x6300
.long 0x76543209, 0xfedcba8, 0x15002, 0x3006
.long 0x54e2a160, 0xfdcb987, 0x501002, 0x3060
.long 0x54f3b271, 0xedca986, 0x5000120, 0x3600
.long 0x54f3b271, 0xedca986, 0x50000012, 0x6300
.long 0x650c3824, 0xfedba97, 0x15200, 0x3006
.long 0x650c3824, 0xfedba97, 0x520100, 0x3060
.long 0x641d0935, 0xfecba87, 0x5001200, 0x3600
.long 0x641d0935, 0xfecba87, 0x50020001, 0x6300
.long 0x76543209, 0xfedcba8, 0x25001, 0x3006
.long 0x54e2a160, 0xfdcb987, 0x502100, 0x3060
.long 0x54e2a160, 0xfdcb987, 0x5002010, 0x3600
.long 0x54f3b271, 0xedca986, 0x50001002, 0x6300
.long 0x54f3b271, 0xedca986, 0x152000, 0x3006
.long 0x54e2a160, 0xfdcb987, 0x5001002, 0x3600
.long 0x54e2a160, 0xfdcb987, 0x50000012, 0x6300
.long 0x54f3b271, 0xedca986, 0x51020, 0x3006
.long 0x765431a0, 0xfedcb98, 0x150200, 0x3060
.long 0x54f3b271, 0xedca986, 0x5102000, 0x3600
.long 0x650c3824, 0xfedba97, 0x50000102, 0x6300
.long 0x650c3824, 0xfedba97, 0x15020, 0x3006
.long 0x641d0935, 0xfecba87, 0x510200, 0x3060
.long 0x641d0935, 0xfecba87, 0x5020100, 0x3600
.long 0x54e2a160, 0xfdcb987, 0x50100002, 0x6300
.long 0x54e2a160, 0xfdcb987, 0x250001, 0x3006
.long 0x765431a0, 0xfedcb98, 0x251000, 0x3060
.long 0x54f3b271, 0xedca986, 0x5200010, 0x3600
.long 0x54f3b271, 0xedca986, 0x50200001, 0x6300
.long 0x650c3824, 0xfedba97, 0x50021, 0x3006
.long 0x650c3824, 0xfedba97, 0x520010, 0x3060
.long 0x54f3b271, 0xedca986, 0x50200010, 0x6300
.long 0x54f3b271, 0xedca986, 0x152000, 0x3006
.long 0x650c3824, 0xfedba97, 0x500102, 0x3060
.long 0x765421b0, 0xfedca98, 0x2500010, 0x3600
.long 0x650c3824, 0xfedba97, 0x50010200, 0x6300
.long 0x641d0935, 0xfecba87, 0x15200, 0x3006
.long 0x641d0935, 0xfecba87, 0x520001, 0x3060
.long 0x54e2a160, 0xfdcb987, 0x5100020, 0x3600
.long 0x54e2a160, 0xfdcb987, 0x50001020, 0x6300
.long 0x54f3b271, 0xedca986, 0x52001, 0x3006
.long 0x54f3b271, 0xedca986, 0x500102, 0x3060
.long 0x765421b0, 0xfedca98, 0x1500020, 0x3600
.long 0x650c3824, 0xfedba97, 0x50000021, 0x6300
.long 0x650c3824, 0xfedba97, 0x521000, 0x3006
.long 0x641d0935, 0xfecba87, 0x520100, 0x3060
.long 0x641d0935, 0xfecba87, 0x5001002, 0x3600
.long 0x650c3824, 0xfedba97, 0x50021, 0x3006
.long 0x650c3824, 0xfedba97, 0x520010, 0x3060
.long 0x641d0935, 0xfecba87, 0x5010002, 0x3600
.long 0x76532c10, 0xfedba98, 0x15002000, 0x6300
.long 0x641d0935, 0xfecba87, 0x50021, 0x3006
.long 0x54e2a160, 0xfdcb987, 0x251000, 0x3060
.long 0x54e2a160, 0xfdcb987, 0x5000012, 0x3600
.long 0x54f3b271, 0xedca986, 0x50100002, 0x6300
.long 0x54f3b271, 0xedca986, 0x51020, 0x3006
.long 0x650c3824, 0xfedba97, 0x510200, 0x3060
.long 0x650c3824, 0xfedba97, 0x5000102, 0x3600
.long 0x76532c10, 0xfedba98, 0x50000210, 0x6300
.long 0x641d0935, 0xfecba87, 0x50210, 0x3006
.long 0x641d0935, 0xfecba87, 0x520100, 0x3060
.long 0x54e2a160, 0xfdcb987, 0x5100020, 0x3600
.long 0x54e2a160, 0xfdcb987, 0x50000021, 0x6300
.long 0x641d0935, 0xfecba87, 0x500120, 0x3060
.long 0x641d0935, 0xfecba87, 0x5000012, 0x3600
.long 0x54e2a160, 0xfdcb987, 0x50002010, 0x6300
.long 0x76432d10, 0xfecba98, 0x150002, 0x3006
.long 0x54e2a160, 0xfdcb987, 0x510020, 0x3060
.long 0x54f3b271, 0xedca986, 0x5201000, 0x3600
.long 0x54f3b271, 0xedca986, 0x50100020, 0x6300
.long 0x650c3824, 0xfedba97, 0x50102, 0x3006
.long 0x650c3824, 0xfedba97, 0x510200, 0x3060
.long 0x641d0935, 0xfecba87, 0x5000021, 0x3600
.long 0x641d0935, 0xfecba87, 0x50010020, 0x6300
.long 0x76432d10, 0xfecba98, 0x50201, 0x3006
.long 0x54e2a160, 0xfdcb987, 0x251000, 0x3060
.long 0x54e2a160, 0xfdcb987, 0x5100002, 0x3600
.long 0x54f3b271, 0xedca986, 0x50200010, 0x6300
.long 0x54f3b271, 0xedca986, 0x250001, 0x3006
.long 0x54e2a160, 0xfdcb987, 0x5001020, 0x3600
.long 0x54e2a160, 0xfdcb987, 0x50002100, 0x6300
.long 0x54f3b271, 0xedca986, 0x250100, 0x3006
.long 0x7543e210, 0xfdcba98, 0x1502000, 0x3060
.long 0x54f3b271, 0xedca986, 0x5200010, 0x3600
.long 0x650c3824, 0xfedba97, 0x50000201, 0x6300
.long 0x650c3824, 0xfedba97, 0x15200, 0x3006
.long 0x641d0935, 0xfecba87, 0x500120, 0x3060
.long 0x641d0935, 0xfecba87, 0x5010200, 0x3600
.long 0x54e2a160, 0xfdcb987, 0x50100020, 0x6300
.long 0x54e2a160, 0xfdcb987, 0x52010, 0x3006
.long 0x7543e210, 0xfdcba98, 0x500021, 0x3060
.long 0x54f3b271, 0xedca986, 0x5100020, 0x3600
.long 0x54f3b271, 0xedca986, 0x50001020, 0x6300
.long 0x650c3824, 0xfedba97, 0x51200, 0x3006
.long 0x650c3824, 0xfedba97, 0x500120, 0x3060
.long 0x54f3b271, 0xedca986, 0x50000102, 0x6300
.long 0x54f3b271, 0xedca986, 0x50012, 0x3006
.long 0x650c3824, 0xfedba97, 0x500120, 0x3060
.long 0x6543f210, 0xedcba98, 0x15200000, 0x3600
.long 0x650c3824, 0xfedba97, 0x50001020, 0x6300
.long 0x641d0935, 0xfecba87, 0x15002, 0x3006
.long 0x641d0935, 0xfecba87, 0x500102, 0x3060
.long 0x54e2a160, 0xfdcb987, 0x5102000, 0x3600
.long 0x54e2a160, 0xfdcb987, 0x50201000, 0x6300
.long 0x54f3b271, 0xedca986, 0x150020, 0x3006
.long 0x54f3b271, 0xedca986, 0x501020, 0x3060
.long 0x6543f210, 0xedcba98, 0x25000010, 0x3600
.long 0x650c3824, 0xfedba97, 0x50000201, 0x6300
.long 0x650c3824, 0xfedba97, 0x15200, 0x3006
.long 0x641d0935, 0xfecba87, 0x501200, 0x3060
.long 0x641d0935, 0xfecba87, 0x5000201, 0x3600
.long 0x650c3824, 0xfedba97, 0x50210, 0x3006
.long 0x650c3824, 0xfedba97, 0x510002, 0x3060
.long 0x641d0935, 0xfecba87, 0x5000120, 0x3600
.long 0x76543218, 0xfedcba9, 0x25000010, 0x6300
.long 0x641d0935, 0xfecba87, 0x50210, 0x3006
.long 0x54e2a160, 0xfdcb987, 0x150002, 0x3060
.long 0x54e2a160, 0xfdcb987, 0x5200010, 0x3600
.long 0x54f3b271, 0xedca986, 0x50102000, 0x6300
.long 0x54f3b271, 0xedca986, 0x251000, 0x3006
.long 0x650c3824, 0xfedba97, 0x500120, 0x3060
.long 0x650c3824, 0xfedba97, 0x5000021, 0x3600
.long 0x76543218, 0xfedcba9, 0x15002000, 0x6300
.long 0x641d0935, 0xfecba87, 0x50021, 0x3006
.long 0x641d0935, 0xfecba87, 0x510200, 0x3060
.long 0x54e2a160, 0xfdcb987, 0x5201000, 0x3600
.long 0x54e2a160, 0xfdcb987, 0x50200001, 0x6300
.long 0x641d0935, 0xfecba87, 0x500102, 0x3060
.long 0x641d0935, 0xfecba87, 0x5020010, 0x3600
.long 0x54e2a160, 0xfdcb987, 0x50201000, 0x6300
.long 0x76543209, 0xfedcba8, 0x215000, 0x3006
.long 0x54e2a160, 0xfdcb987, 0x502010, 0x3060
.long 0x54f3b271, 0xedca986, 0x5001002, 0x3600
.long 0x54f3b271, 0xedca986, 0x50200001, 0x6300
.long 0x650c3824, 0xfedba97, 0x50120, 0x3006
.long 0x650c3824, 0xfedba97, 0x510002, 0x3060
.long 0x641d0935, 0xfecba87, 0x5020001, 0x3600
.long 0x641d0935, 0xfecba87, 0x50010200, 0x6300
.long 0x76543209, 0xfedcba8, 0x50102, 0x3006
.long 0x54e2a160, 0xfdcb987, 0x150020, 0x3060
.long 0x54e2a160, 0xfdcb987, 0x5000021, 0x3600
.long 0x54f3b271, 0xedca986, 0x50102000, 0x6300
.long 0x54f3b271, 0xedca986, 0x50012, 0x3006
.long 0x54e2a160, 0xfdcb987, 0x5002010, 0x3600
.long 0x54e2a160, 0xfdcb987, 0x50001020, 0x6300
.long 0x54f3b271, 0xedca986, 0x150002, 0x3006
.long 0x765431a0, 0xfedcb98, 0x500021, 0x3060
.long 0x54f3b271, 0xedca986, 0x5001020, 0x3600
.long 0x650c3824, 0xfedba97, 0x50020001, 0x6300
.long 0x650c3824, 0xfedba97, 0x15002, 0x3006
.long 0x641d0935, 0xfecba87, 0x520100, 0x3060
.long 0x641d0935, 0xfecba87, 0x5010020, 0x3600
.long 0x54e2a160, 0xfdcb987, 0x50002100, 0x6300
.long 0x54e2a160, 0xfdcb987, 0x150002, 0x3006
.long 0x765431a0, 0xfedcb98, 0x150020, 0x3060
.long 0x54f3b271, 0xedca986, 0x5000102, 0x3600
.long 0x54f3b271, 0xedca986, 0x50002010, 0x6300
.long 0x650c3824, 0xfedba97, 0x50102, 0x3006
.long 0x650c3824, 0xfedba97, 0x501002, 0x3060
.long 0x54f3b271, 0xedca986, 0x50102000, 0x6300
.long 0x54f3b271, 0xedca986, 0x250001, 0x3006
.long 0x650c3824, 0xfedba97, 0x520001, 0x3060
.long 0x765421b0, 0xfedca98, 0x1500020, 0x3600
.long 0x650c3824, 0xfedba97, 0x50000102, 0x6300
.long 0x641d0935, 0xfecba87, 0x51020, 0x3006
.long 0x641d0935, 0xfecba87, 0x510020, 0x3060
.long 0x54e2a160, 0xfdcb987, 0x5001002, 0x3600
.long 0x54e2a160, 0xfdcb987, 0x50102000, 0x6300
.long 0x54f3b271, 0xedca986, 0x51002, 0x3006
.long 0x54f3b271, 0xedca986, 0x502010, 0x3060
.long 0x765421b0, 0xfedca98, 0x5100002, 0x3600
.long 0x650c3824, 0xfedba97, 0x50020010, 0x6300
.long 0x650c3824, 0xfedba97, 0x15002, 0x3006
.long 0x641d0935, 0xfecba87, 0x500102, 0x3060
.long 0x641d0935, 0xfecba87, 0x5020010, 0x3600
.long 0x650c3824, 0xfedba97, 0x521000, 0x3006
.long 0x650c3824, 0xfedba97, 0x500021, 0x3060
.long 0x641d0935, 0xfecba87, 0x5000201, 0x3600
.long 0x76532c10, 0xfedba98, 0x15000200, 0x6300
.long 0x641d0935, 0xfecba87, 0x15002, 0x3006
.long 0x54e2a160, 0xfdcb987, 0x501020, 0x3060
.long 0x54e2a160, 0xfdcb987, 0x5000120, 0x3600
.long 0x54f3b271, 0xedca986, 0x50100020, 0x6300
.long 0x54f3b271, 0xedca986, 0x51002, 0x3006
.long 0x650c3824, 0xfedba97, 0x500102, 0x3060
.long 0x650c3824, 0xfedba97, 0x5000210, 0x3600
.long 0x76532c10, 0xfedba98, 0x25000100, 0x6300
.long 0x641d0935, 0xfecba87, 0x50102, 0x3006
.long 0x641d0935, 0xfecba87, 0x501002, 0x3060
.long 0x54e2a160, 0xfdcb987, 0x5002010, 0x3600
.long 0x54e2a160, 0xfdcb987, 0x50102000, 0x6300
.long 0x641d0935, 0xfecba87, 0x520001, 0x3060
.long 0x641d0935, 0xfecba87, 0x5010020, 0x3600
.long 0x54e2a160, 0xfdcb987, 0x50100020, 0x6300
.long 0x76432d10, 0xfecba98, 0x50201, 0x3006
.long 0x54e2a160, 0xfdcb987, 0x251000, 0x3060
.long 0x54f3b271, 0xedca986, 0x5002001, 0x3600
.long 0x54f3b271, 0xedca986, 0x50002010, 0x6300
.long 0x650c3824, 0xfedba97, 0x25100, 0x3006
.long 0x650c3824, 0xfedba97, 0x510020, 0x3060
.long 0x641d0935, 0xfecba87, 0x5000102, 0x3600
.long 0x641d0935, 0xfecba87, 0x50000012, 0x6300
.long 0x76432d10, 0xfecba98, 0x152000, 0x3006
.long 0x54e2a160, 0xfdcb987, 0x500012, 0x3060
.long 0x54e2a160, 0xfdcb987, 0x5210000, 0x3600
.long 0x54f3b271, 0xedca986, 0x50001020, 0x6300
.long 0x54f3b271, 0xedca986, 0x150020, 0x3006
.long 0x54e2a160, 0xfdcb987, 0x5200010, 0x3600
.long 0x54e2a160, 0xfdcb987, 0x50201000, 0x6300
.long 0x54f3b271, 0xedca986, 0x52100, 0x3006
.long 0x7543e210, 0xfdcba98, 0x520001, 0x3060
.long 0x54f3b271, 0xedca986, 0x5100002, 0x3600
.long 0x650c3824, 0xfedba97, 0x50000120, 0x6300
.long 0x650c3824, 0xfedba97, 0x521000, 0x3006
.long 0x641d0935, 0xfecba87, 0x500102, 0x3060
.long 0x641d0935, 0xfecba87, 0x5010002, 0x3600
.long 0x54e2a160, 0xfdcb987, 0x51200000, 0x6300
.long 0x54e2a160, 0xfdcb987, 0x150020, 0x3006
.long 0x7543e210, 0xfdcba98, 0x502010, 0x3060
.long 0x54f3b271, 0xedca986, 0x5002010, 0x3600
.long 0x54f3b271, 0xedca986, 0x50001002, 0x6300
.long 0x650c3824, 0xfedba97, 0x1025000, 0x3006
.long 0x650c3824, 0xfedba97, 0x510200, 0x3060
.long 0x54f3b271, 0xedca986, 0x50100020, 0x6300
.long 0x54f3b271, 0xedca986, 0x51020, 0x3006
.long 0x650c3824, 0xfedba97, 0x510200, 0x3060
.long 0x6543f210, 0xedcba98, 0x5102000, 0x3600
.long 0x650c3824, 0xfedba97, 0x15020000, 0x6300
.long 0x641d0935, 0xfecba87, 0x25100, 0x3006
.long 0x641d0935, 0xfecba87, 0x500210, 0x3060
.long 0x54e2a160, 0xfdcb987, 0x5201000, 0x3600
.long 0x54e2a160, 0xfdcb987, 0x50100002, 0x6300
.long 0x54f3b271, 0xedca986, 0x250001, 0x3006
.long 0x54f3b271, 0xedca986, 0x250010, 0x3060
.long 0x6543f210, 0xedcba98, 0x5002001, 0x3600
.long 0x650c3824, 0xfedba97, 0x50000012, 0x6300
.long 0x650c3824, 0xfedba97, 0x50120, 0x3006
.long 0x641d0935, 0xfecba87, 0x510020, 0x3060
.long 0x641d0935, 0xfecba87, 0x5000021, 0x3600
.fill 1, 4, 0
.size L_table, .-L_table
.section .rodata,"a"
.p2align 6
.amdhsa_kernel sequential_preLN__linear_kernel_hedgehog__moe_arch_mod__prompt_kernel
  .amdhsa_next_free_vgpr 256
  .amdhsa_next_free_sgpr 102
  .amdhsa_accum_offset 256
  .amdhsa_group_segment_fixed_size 0
  .amdhsa_kernarg_size 96
  .amdhsa_user_sgpr_count 2
  .amdhsa_user_sgpr_kernarg_segment_ptr 1
  .amdhsa_system_sgpr_workgroup_id_x 1
  .amdhsa_float_denorm_mode_32 3
.end_amdhsa_kernel
```

```asm
; @launch grid=(256,1,1) block=(512,1,1) lds=163840
.amdgcn_target "amdgcn-amd-amdhsa--gfx950"
.text
.globl sequential_preLN__linear_kernel_hedgehog__moe_arch_mod__prompt_kernel
.p2align 8
.type sequential_preLN__linear_kernel_hedgehog__moe_arch_mod__prompt_kernel,@function
sequential_preLN__linear_kernel_hedgehog__moe_arch_mod__prompt_kernel:
    s_cmp_ge_u32 s2, 256
    s_cbranch_scc1 L_end
    s_load_dwordx2 s[28:29], s[0:1], 0
    s_load_dwordx2 s[32:33], s[0:1], 8
    s_load_dwordx4 s[8:11], s[0:1], 16
    s_load_dwordx16 s[12:27], s[0:1], 32
    v_lshrrev_b32 v4, 6, v0
    v_and_b32 v1, 63, v0
    v_readfirstlane_b32 s79, v4
    s_and_b32 s76, s2, 7
    s_lshr_b32 s77, s2, 3
    s_and_b32 s60, s77, 15
    s_lshl_b32 s76, s76, 3
    s_bfe_u32 s77, s2, 0x10007
    s_lshl2_add_u32 s76, s77, s76
    s_mov_b32 s80, 0x654210b3
    s_mov_b32 s81, 0xfedca987
    s_lshr_b64 s[80:81], s[80:81], s76
    s_and_b32 s61, s80, 15
    s_and_b32 s62, s79, 3
    s_cmp_ge_u32 s79, 4
    s_cbranch_scc1 L_compute
    s_setprio 3
    s_getpc_b64 s[66:67]
L_pc:
    s_lshr_b32 s76, s2, 3
    s_lshl2_add_u32 s76, s76, s62
    s_mul_i32 s76, s76, 256
    v_lshl_add_u32 v91, v1, 7, s76
    s_mov_b64 exec, 3
    global_load_dword v27, v91, s[66:67]
    s_mov_b64 exec, -1
    s_add_u32 s84, s60, s2
    s_and_b32 s84, s84, 3
    s_and_b32 s76, s60, 7
    s_and_b32 s77, s61, 7
    s_cmp_eq_u32 s77, 3
    s_cselect_b32 s84, s76, s84
    v_lshrrev_b32 v4, 3, v1
    v_and_b32 v5, 7, v1
    v_lshrrev_b32_e64 v6, 4, v1
    s_lshl2_add_u32 s76, s60, s62
    s_lshl_b32 s76, s76, 16
    s_mul_i32 s70, s62, 10240
    v_xor_b32 v7, v5, v6
    v_lshlrev_b32 v7, 4, v7
    v_lshl_add_u32 v78, v4, 11, v7
    v_add_u32 v16, s76, v78
    v_xor_b32 v7, 64, v16
    v_add_u32 v17, 15360, v7
    v_add_u32 v18, 30720, v16
    v_add_u32 v19, 46080, v7
    s_mov_b32 s30, 4194304
    s_mov_b32 s31, 0x20000
    s_and_b32 s72, s84, 15
    s_mov_b32 m0, s70
    s_lshl_b32 s71, s72, 7
    s_waitcnt lgkmcnt(0)
    buffer_load_dwordx4 v16, s[28:31], s71 offen offset:0 lds
    s_mul_i32 s72, s72, 393216
    s_lshr_b64 s[84:85], s[84:85], 4
    buffer_load_dwordx4 v17, s[28:31], s71 offen offset:1024 lds
    buffer_load_dwordx4 v18, s[28:31], s71 offen offset:2048 lds
    buffer_load_dwordx4 v19, s[28:31], s71 offen offset:3072 lds
    v_and_b32 v6, 1, v6
    v_lshlrev_b32 v6, 2, v6
    v_xor_b32 v8, v5, v6
    v_lshlrev_b32 v8, 4, v8
    s_lshl_b32 s76, s61, 7
    s_mul_i32 s77, s62, 98304
    s_add_u32 s76, s76, s77
    v_mul_u32_u24 v7, 6144, v4
    v_add3_u32 v20, v7, v8, s76
    v_xor_b32 v7, 32, v20
    s_mov_b32 s34, 6291456
    s_mov_b32 s35, 0x20000
    s_add_u32 m0, s70, 4096
    s_nop 0
    buffer_load_dwordx4 v20, s[32:35], s72 offen offset:0 lds
    v_add_u32 v21, 48128, v7
    buffer_load_dwordx4 v21, s[32:35], s72 offen offset:1024 lds
    v_add_u32 v22, 0, v20
    buffer_load_dwordx4 v22, s[32:35], s72 offen offset:2048 lds
    v_add_u32 v23, 48128, v7
    buffer_load_dwordx4 v23, s[32:35], s72 offen offset:3072 lds
    v_add_u32 v24, 4096, v20
    s_add_u32 m0, s70, 8192
    s_nop 0
    buffer_load_dwordx4 v24, s[32:35], s72 offen offset:0 lds
    v_add_u32 v25, 52224, v7
    buffer_load_dwordx4 v25, s[32:35], s72 offen offset:1024 lds
    s_add_u32 s70, s70, 40960
    s_cmp_ge_u32 s70, 122880
    s_cselect_b32 s76, 122880, 0
    s_sub_u32 s70, s70, s76
    s_lshl_b32 s76, s60, 8
    s_lshl_b32 s77, s61, 4
    s_add_u32 s76, s76, s77
    s_add_u32 s76, s76, 30208
    s_load_dwordx4 s[84:87], s[66:67], s76
    v_lshl_add_u32 v26, v4, 11, v8
    v_xor_b32 v79, 64, v78
    s_and_b32 s63, s62, 1
    s_lshr_b32 s64, s62, 1
    s_lshl_b32 s73, s60, 4
    s_add_u32 s73, s73, s61
    s_mul_i32 s73, s73, 28800
    s_add_u32 s76, s2, 7
    s_and_b32 s76, s76, 7
    s_bfe_u32 s77, s2, 0x10003
    s_lshl1_add_u32 s97, s76, s77
    s_lshr_b32 s98, s2, 4
    s_lshl_b32 s99, s97, 4
    s_add_u32 s99, s99, s98
    s_mul_i32 s99, s99, 9344
    s_add_u32 s99, s99, 8388608
    s_lshr_b32 s65, s97, 1
    s_lshl_b32 s76, s97, 3
    s_add_u32 s65, s65, s76
    s_mul_i32 s76, s98, 4
    s_add_u32 s65, s65, s76
    s_and_b32 s65, s65, 15
    s_mov_b32 s89, 0x3f803f80
    s_mov_b32 s90, 0xffff0000
    v_and_b32 v2, 31, v1
    v_lshrrev_b32 v3, 5, v1
    v_lshlrev_b32 v12, 4, v1
    v_lshrrev_b32 v4, 3, v1
    v_mul_u32_u24 v13, 460800, v4
    v_and_b32_e64 v4, 7, v1
    v_lshl_add_u32 v13, v4, 4, v13
    s_lshl_b32 s76, s98, 7
    s_lshl_b32 s77, s62, 15
    s_add_u32 s76, s76, s77
    v_add_u32_e64 v26, s76, v26
    s_mov_b32 s40, s26
    s_and_b32 s41, s27, 0xffff
    s_mov_b32 s42, 33554432
    s_mov_b32 s43, 0x20000
    s_mov_b32 s56, s8
    s_and_b32 s57, s9, 0xffff
    s_mov_b32 s58, 65536
    s_mov_b32 s59, 0x20000
    v_mov_b32 v28, -1
    v_mov_b32 v29, -1
    v_mov_b32 v30, -1
    v_mov_b32_e64 v31, -1
    s_waitcnt lgkmcnt(0)
    s_and_b32 s72, s84, 15
    s_mov_b32 m0, s70
    s_lshl_b32 s71, s72, 7
    buffer_load_dwordx4 v16, s[28:31], s71 offen offset:0 lds
    s_mul_i32 s72, s72, 393216
    s_lshr_b64 s[84:85], s[84:85], 4
    buffer_load_dwordx4 v17, s[28:31], s71 offen offset:1024 lds
    buffer_load_dwordx4 v18, s[28:31], s71 offen offset:2048 lds
    buffer_load_dwordx4 v19, s[28:31], s71 offen offset:3072 lds
    s_add_u32 m0, s70, 4096
    s_nop 0
    buffer_load_dwordx4 v20, s[32:35], s72 offen offset:0 lds
    buffer_load_dwordx4 v21, s[32:35], s72 offen offset:1024 lds
    buffer_load_dwordx4 v22, s[32:35], s72 offen offset:2048 lds
    buffer_load_dwordx4 v23, s[32:35], s72 offen offset:3072 lds
    s_add_u32 m0, s70, 8192
    s_nop 0
    buffer_load_dwordx4 v24, s[32:35], s72 offen offset:0 lds
    buffer_load_dwordx4 v25, s[32:35], s72 offen offset:1024 lds
    s_add_u32 s70, s70, 40960
    s_cmp_ge_u32 s70, 122880
    s_cselect_b32 s76, 122880, 0
    s_sub_u32 s70, s70, s76
    s_lshl_b32 s77, s62, 10
    s_add_u32 s76, s77, s73
    buffer_store_dwordx4 v[28:31], v12, s[40:43], s76 offen sc1
    s_lshl_b32 s76, s61, 12
    s_add_u32 s76, s76, s77
    s_add_u32 m0, s77, 122880
    s_nop 0
    buffer_load_dwordx4 v12, s[56:59], s76 offen lds
    v_mov_b32 v4, 13631488
    buffer_load_dwordx2 v[88:89], v4, s[40:43], 0 offen
    s_setprio 0
    s_waitcnt vmcnt(13)
    s_barrier
    s_and_b32 s72, s84, 15
    s_mov_b32 m0, s70
    s_lshl_b32 s71, s72, 7
    buffer_load_dwordx4 v16, s[28:31], s71 offen offset:0 lds
    s_mul_i32 s72, s72, 393216
    s_lshr_b64 s[84:85], s[84:85], 4
    buffer_load_dwordx4 v17, s[28:31], s71 offen offset:1024 lds
    buffer_load_dwordx4 v18, s[28:31], s71 offen offset:2048 lds
    buffer_load_dwordx4 v19, s[28:31], s71 offen offset:3072 lds
    s_add_u32 m0, s70, 4096
    s_nop 0
    buffer_load_dwordx4 v20, s[32:35], s72 offen offset:0 lds
    buffer_load_dwordx4 v21, s[32:35], s72 offen offset:1024 lds
    buffer_load_dwordx4 v22, s[32:35], s72 offen offset:2048 lds
    buffer_load_dwordx4 v23, s[32:35], s72 offen offset:3072 lds
    s_add_u32 m0, s70, 8192
    s_nop 0
    buffer_load_dwordx4 v24, s[32:35], s72 offen offset:0 lds
    buffer_load_dwordx4 v25, s[32:35], s72 offen offset:1024 lds
    s_add_u32 s70, s70, 40960
    s_cmp_ge_u32 s70, 122880
    s_cselect_b32 s76, 122880, 0
    s_sub_u32 s70, s70, s76
    s_mov_b32 s36, s10
    s_and_b32 s37, s11, 0xffff
    s_mov_b32 s38, 2097152
    s_mov_b32 s39, 0x20000
    s_mov_b32 s44, s22
    s_and_b32 s45, s23, 0xffff
    s_mov_b32 s46, 4194304
    s_mov_b32 s47, 0x20000
    s_mov_b32 s52, s20
    s_and_b32 s53, s21, 0xffff
    s_mov_b32 s54, 7340032
    s_mov_b32 s55, 0x20000
    s_cmp_eq_u32 s64, 0
    s_cselect_b32 s48, s16, s18
    s_cselect_b32 s49, s17, s19
    s_and_b32 s49, s49, 0xffff
    s_mov_b32 s51, 0x20000
    s_cmp_lt_u32 s97, 14
    s_cselect_b32 s50, 7340032, 0
    s_cselect_b32 s54, 7340032, 0
    v_bfe_u32 v4, v2, 1, 3
    v_xor_b32 v4, v4, v3
    v_lshlrev_b32 v4, 4, v4
    v_lshl_add_u32 v72, v2, 7, v4
    v_bfe_u32 v4, v1, 2, 2
    v_lshl_add_u32 v5, v3, 3, v4
    v_lshlrev_b32 v5, 7, v5
    v_lshrrev_b32 v4, 1, v4
    v_xor_b32_e64 v4, s64, v4
    v_lshl_add_u32 v5, v4, 6, v5
    v_bfe_u32 v4, v1, 4, 1
    v_xor_b32_e64 v4, v4, v3
    v_lshl_add_u32 v5, v4, 5, v5
    v_and_b32_e64 v4, 3, v1
    v_lshl_add_u32 v5, v4, 3, v5
    s_mul_i32 s76, s62, 10240
    s_sub_u32 s76, 4096, s76
    v_add_u32 v73, s76, v5
    v_lshlrev_b32 v74, 3, v2
    v_lshrrev_b32 v4, 4, v1
    v_and_b32 v5, 15, v1
    v_mul_u32_u24 v66, 28800, v4
    v_lshl_add_u32 v66, v5, 4, v66
    v_mul_u32_u24 v75, 460800, v4
    v_lshl_add_u32 v75, v5, 4, v75
    v_lshrrev_b32 v4, 4, v1
    v_and_b32 v5, 15, v1
    v_mul_u32_u24 v76, 114688, v4
    v_lshl_add_u32 v76, v5, 4, v76
    v_lshlrev_b32_e64 v77, 4, v2
    v_lshl_add_u32 v77, v3, 11, v77
    s_mul_i32 s75, s98, 458752
    s_lshl_b32 s77, s97, 9
    s_add_u32 s75, s75, s77
    s_lshl_b32 s77, s63, 8
    s_add_u32 s75, s75, s77
    s_lshl_b32 s96, s97, 19
    s_lshl_b32 s77, s98, 15
    s_add_u32 s96, s96, s77
    s_lshl_b32 s77, s62, 9
    s_add_u32 s96, s96, s77
    s_mov_b32 s68, 1
    s_getreg_b32 s101, hwreg(HW_REG_XCC_ID, 0, 4)
    s_lshl_b32 s76, s61, 8
    s_add_u32 s76, s76, 12582912
    s_lshl_b32 s77, s60, 8
    s_add_u32 s77, s77, 12586752
    s_lshr_b32 s78, s97, 1
    s_lshl_b32 s78, s78, 9
    s_add_u32 s78, s78, 12590592
    v_mov_b32 v4, s76
    v_mov_b32 v5, s77
    v_mov_b32 v6, s78
    v_cmp_gt_u32 vcc, 16, v1
    s_nop 1
    v_cndmask_b32 v4, v5, v4, vcc
    v_cmp_gt_u32 vcc, 32, v1
    s_nop 1
    v_cndmask_b32 v4, v6, v4, vcc
    v_add_u32 v90, v4, v12
    s_waitcnt vmcnt(10)
    s_barrier
L_hloop:
    s_and_b32 s77, s86, 15
    s_cbranch_scc1 L_event
L_evret:
    s_and_b32 s72, s84, 15
    s_mov_b32 m0, s70
    s_lshl_b32 s71, s72, 7
    buffer_load_dwordx4 v16, s[28:31], s71 offen offset:0 lds
    s_mul_i32 s72, s72, 393216
    s_lshr_b64 s[84:85], s[84:85], 4
    buffer_load_dwordx4 v17, s[28:31], s71 offen offset:1024 lds
    buffer_load_dwordx4 v18, s[28:31], s71 offen offset:2048 lds
    buffer_load_dwordx4 v19, s[28:31], s71 offen offset:3072 lds
    s_add_u32 m0, s70, 4096
    s_nop 0
    buffer_load_dwordx4 v20, s[32:35], s72 offen offset:0 lds
    buffer_load_dwordx4 v21, s[32:35], s72 offen offset:1024 lds
    buffer_load_dwordx4 v22, s[32:35], s72 offen offset:2048 lds
    buffer_load_dwordx4 v23, s[32:35], s72 offen offset:3072 lds
    s_add_u32 m0, s70, 8192
    s_nop 0
    buffer_load_dwordx4 v24, s[32:35], s72 offen offset:0 lds
    buffer_load_dwordx4 v25, s[32:35], s72 offen offset:1024 lds
    s_add_u32 s70, s70, 40960
    s_cmp_ge_u32 s70, 122880
    s_cselect_b32 s76, 122880, 0
    s_sub_u32 s70, s70, s76
    s_waitcnt vmcnt(10)
L_hbar:
    s_lshr_b64 s[86:87], s[86:87], 4
    s_add_u32 s68, s68, 1
    s_cmp_lt_u32 s68, 14
    s_barrier
    s_cbranch_scc1 L_hloop
    v_add_co_u32 v88, vcc, 1, v88
    s_nop 1
    v_addc_co_u32 v89, vcc, 0, v89, vcc
    v_cmp_ne_u64 vcc, v[92:93], v[88:89]
    s_nop 0
    s_cbranch_vccz L_hello_ok_1
    s_mov_b32 s88, 0
L_spin_2:
    buffer_load_dwordx4 v[92:95], v90, s[40:43], 0 offen sc1
    s_waitcnt vmcnt(0)
    v_cmp_ne_u64 vcc, v[92:93], v[88:89]
    s_nop 0
    s_cbranch_vccz L_hello_ok_1
    s_add_u32 s88, s88, 1
    s_cmp_lt_u32 s88, 65536
    s_cbranch_scc1 L_spin_2
L_hello_ok_1:
    v_cmp_ne_u32_e64 vcc, s101, v94
    s_nop 0
    s_and_b32 s76, vcc_lo, 0xffff
    s_cselect_b32 s100, 0, 1
    s_cmp_eq_u32 vcc_hi, 0
    s_cselect_b32 s76, 2, 0
    s_or_b32 s100, s100, s76
    v_mov_b32 v4, s100
    v_mov_b32 v5, 0
    ds_write_b32 v5, v4 offset:53248
    s_lshl_b32 s81, s62, 8
    s_mul_i32 s80, s60, 460800
    s_add_u32 s80, s80, s81
    buffer_load_dwordx4 v[32:35], v66, s[40:43], s80 offen offset:0 sc1
    s_add_u32 s80, s80, 115200
    buffer_load_dwordx4 v[36:39], v66, s[40:43], s80 offen offset:0 sc1
    s_add_u32 s80, s80, 115200
    buffer_load_dwordx4 v[40:43], v66, s[40:43], s80 offen offset:0 sc1
    s_add_u32 s80, s80, 115200
    buffer_load_dwordx4 v[44:47], v66, s[40:43], s80 offen offset:0 sc1
    s_mul_i32 s80, s61, 28800
    s_add_u32 s80, s80, s81
    buffer_load_dwordx4 v[48:51], v75, s[40:43], s80 offen offset:1024 sc1
    s_add_u32 s80, s80, 1843200
    buffer_load_dwordx4 v[52:55], v75, s[40:43], s80 offen offset:1024 sc1
    s_add_u32 s80, s80, 1843200
    buffer_load_dwordx4 v[56:59], v75, s[40:43], s80 offen offset:1024 sc1
    s_add_u32 s80, s80, 1843200
    buffer_load_dwordx4 v[60:63], v75, s[40:43], s80 offen offset:1024 sc1
    v_bfe_u32 v10, v1, 4, 1
    v_lshl_add_u32 v10, v10, 1, v3
    v_min_u32 v10, 2, v10
    v_and_b32 v7, 15, v1
    v_lshlrev_b32_e64 v7, 3, v7
    s_lshl_b32 s76, s62, 7
    v_lshl_add_u32 v10, v10, 9, v7
    v_add_u32_e64 v64, s76, v10
    v_lshl_add_u32 v65, v7, 1, s81
    v_bfe_u32 v10, v1, 4, 1
    v_lshl_add_u32 v65, v10, 3, v65
    s_waitcnt vmcnt(8)
    s_barrier
    s_mul_i32 s78, s62, 2048
    s_add_u32 s78, s78, s99
    s_add_u32 s78, s78, 1024
    v_lshlrev_b32 v11, 7, v1
    s_mov_b64 exec, 65535
    buffer_load_dword v27, v11, s[40:43], s78 offen sc1
    s_mov_b64 exec, -1
    buffer_load_dwordx4 v[152:155], v76, s[48:51], s75 offen nt
    s_add_u32 s75, s75, 7168
    s_add_u32 s78, s65, 0
    s_and_b32 s78, s78, 15
    s_lshl_b32 s78, s78, 17
    s_lshl_b32 s79, s62, 11
    s_add_u32 m0, s79, 57344
    s_add_u32 s79, s78, 15360
    buffer_load_dwordx4 v26, s[36:39], s78 offen lds
    buffer_load_dwordx4 v26, s[36:39], s79 offen offset:1024 lds
    s_add_u32 s78, s65, 1
    s_and_b32 s78, s78, 15
    s_lshl_b32 s78, s78, 17
    s_lshl_b32 s79, s62, 11
    s_add_u32 m0, s79, 65536
    s_add_u32 s79, s78, 15360
    buffer_load_dwordx4 v26, s[36:39], s78 offen lds
    buffer_load_dwordx4 v26, s[36:39], s79 offen offset:1024 lds
    s_setprio 3
    s_mov_b32 s88, 0
    s_waitcnt vmcnt(10)
    s_branch L_g1first_3
L_g1_4:
    s_mul_i32 s80, s60, 460800
    s_add_u32 s80, s80, s81
    buffer_load_dwordx4 v[32:35], v66, s[40:43], s80 offen offset:0 sc1
    s_add_u32 s80, s80, 115200
    buffer_load_dwordx4 v[36:39], v66, s[40:43], s80 offen offset:0 sc1
    s_add_u32 s80, s80, 115200
    buffer_load_dwordx4 v[40:43], v66, s[40:43], s80 offen offset:0 sc1
    s_add_u32 s80, s80, 115200
    buffer_load_dwordx4 v[44:47], v66, s[40:43], s80 offen offset:0 sc1
    s_waitcnt vmcnt(0)
L_g1first_3:
    v_max3_u32 v4, v32, v34, v36
    v_max3_u32 v4, v4, v38, v40
    v_max3_u32 v4, v4, v42, v44
    v_max_u32 v4, v4, v46
    v_cmp_eq_u32 vcc, -1, v4
    s_nop 0
    s_cbranch_vccz L_ok_5
    s_add_u32 s88, s88, 1
    s_cmp_lt_u32 s88, 65536
    s_cbranch_scc1 L_g1_4
L_ok_5:
    v_add_f32 v32, v32, v40
    v_add_f32 v33, v33, v41
    v_add_f32 v34, v34, v42
    v_add_f32 v35, v35, v43
    v_add_f32 v36, v36, v44
    v_add_f32 v37, v37, v45
    v_add_f32 v38, v38, v46
    v_add_f32 v39, v39, v47
    v_add_f32 v32, v32, v36
    v_add_f32 v33, v33, v37
    v_add_f32 v34, v34, v38
    v_add_f32_e64 v35, v35, v39
    s_add_u32 s78, s65, 2
    s_and_b32 s78, s78, 15
    s_lshl_b32 s78, s78, 17
    s_lshl_b32 s79, s62, 11
    s_add_u32 m0, s79, 73728
    s_add_u32 s79, s78, 15360
    buffer_load_dwordx4 v26, s[36:39], s78 offen lds
    buffer_load_dwordx4 v26, s[36:39], s79 offen offset:1024 lds
    v_permlane32_swap_b32 v32, v33
    v_permlane32_swap_b32 v34, v35
    v_add_f32 v32, v32, v33
    v_add_f32 v34, v34, v35
    s_nop 1
    v_permlane16_swap_b32 v32, v34
    v_add_f32 v32, v32, v34
    v_mov_b32 v33, v32
    s_nop 1
    v_permlane32_swap_b32 v32, v33
    v_mul_f32 v32, 0x3a800000, v32
    v_mul_f32 v33, 0x3a800000, v33
    v_fma_f32 v7, -v32, v32, v33
    v_max_f32_e64 v7, 0, v7
    v_cvt_pk_bf16_f32 v5, v32, v32
    v_and_b32_e64 v5, s90, v5
    v_cvt_pk_bf16_f32 v7, v7, v7
    v_and_b32_e64 v7, s90, v7
    v_add_f32 v7, 0x3727c5ac, v7
    v_cvt_pk_bf16_f32 v7, v7, v7
    v_and_b32 v7, s90, v7
    v_sqrt_f32_e64 v7, v7
    s_nop 0
    v_cvt_pk_bf16_f32 v7, v7, v7
    v_and_b32 v7, s90, v7
    v_rcp_f32 v9, v7
    v_xor_b32 v5, 0x80000000, v5
    v_cvt_pk_bf16_f32 v8, v5, v5
    ds_write_b64 v65, v[8:9] offset:49152
    s_mov_b32 s88, 0
    s_waitcnt vmcnt(8)
    s_branch L_g1first_6
L_g1_7:
    s_mul_i32 s80, s61, 28800
    s_add_u32 s80, s80, s81
    buffer_load_dwordx4 v[48:51], v75, s[40:43], s80 offen offset:1024 sc1
    s_add_u32 s80, s80, 1843200
    buffer_load_dwordx4 v[52:55], v75, s[40:43], s80 offen offset:1024 sc1
    s_add_u32 s80, s80, 1843200
    buffer_load_dwordx4 v[56:59], v75, s[40:43], s80 offen offset:1024 sc1
    s_add_u32 s80, s80, 1843200
    buffer_load_dwordx4 v[60:63], v75, s[40:43], s80 offen offset:1024 sc1
    s_waitcnt vmcnt(0)
L_g1first_6:
    v_max3_u32 v4, v48, v50, v52
    v_max3_u32 v4, v4, v54, v56
    v_max3_u32 v4, v4, v58, v60
    v_max_u32 v4, v4, v62
    v_cmp_eq_u32 vcc, -1, v4
    s_nop 0
    s_cbranch_vccz L_ok_8
    s_add_u32 s88, s88, 1
    s_cmp_lt_u32 s88, 65536
    s_cbranch_scc1 L_g1_7
L_ok_8:
    v_add_f32 v48, v48, v56
    v_add_f32 v49, v49, v57
    v_add_f32 v50, v50, v58
    v_add_f32 v51, v51, v59
    v_add_f32 v52, v52, v60
    v_add_f32 v53, v53, v61
    v_add_f32 v54, v54, v62
    v_add_f32 v55, v55, v63
    v_add_f32 v48, v48, v52
    v_add_f32 v49, v49, v53
    v_add_f32 v50, v50, v54
    v_add_f32 v51, v51, v55
    v_add_f32 v49, v49, v51
    v_mov_b32 v51, v49
    v_permlane32_swap_b32 v48, v50
    s_nop 0
    v_permlane32_swap_b32 v49, v51
    v_add_f32 v48, v48, v50
    v_add_f32 v49, v49, v51
    s_nop 1
    v_permlane16_swap_b32 v48, v49
    v_add_f32_e64 v48, v48, v49
    v_cvt_pk_bf16_f32 v49, v48, v48
    v_and_b32 v49, s90, v49
    v_sub_f32 v49, v48, v49
    v_cvt_pk_bf16_f32 v50, v48, v49
    v_and_b32 v51, s90, v50
    v_sub_f32 v49, v49, v51
    v_cvt_pk_bf16_f32 v51, v49, 0
    ds_write_b64 v64, v[50:51] offset:50176
    s_setprio 0
    s_waitcnt lgkmcnt(0)
    s_barrier
    s_add_u32 s78, s65, 3
    s_and_b32 s78, s78, 15
    s_lshl_b32 s78, s78, 17
    s_lshl_b32 s79, s62, 11
    s_add_u32 m0, s79, 81920
    s_add_u32 s79, s78, 15360
    buffer_load_dwordx4 v26, s[36:39], s78 offen lds
    buffer_load_dwordx4 v26, s[36:39], s79 offen offset:1024 lds
    s_add_u32 s78, s65, 4
    s_and_b32 s78, s78, 15
    s_lshl_b32 s78, s78, 17
    s_lshl_b32 s79, s62, 11
    s_add_u32 m0, s79, 90112
    s_add_u32 s79, s78, 15360
    buffer_load_dwordx4 v26, s[36:39], s78 offen lds
    buffer_load_dwordx4 v26, s[36:39], s79 offen offset:1024 lds
    s_lshl_b32 s78, s62, 11
    s_add_u32 s79, s78, s99
    s_bitcmp1_b32 s100, 0
    s_cbranch_scc1 L_loc_9
    buffer_store_dwordx4 v[28:31], v12, s[40:43], s79 offen offset:1024 sc1
    buffer_store_dwordx4 v[28:31], v12, s[40:43], s79 offen offset:2048 sc1
    s_branch L_pubd_10
L_loc_9:
    buffer_store_dwordx4 v[28:31], v12, s[40:43], s79 offen offset:1024
    buffer_store_dwordx4 v[28:31], v12, s[40:43], s79 offen offset:2048
L_pubd_10:
    s_lshl_b32 s79, s62, 8
    s_add_u32 s79, s79, s99
    s_mov_b64 exec, 0xffff
    buffer_store_dwordx4 v[28:31], v12, s[40:43], s79 offen sc1
    s_mov_b64 exec, -1
    s_add_u32 s78, s65, 5
    s_and_b32 s78, s78, 15
    s_lshl_b32 s78, s78, 17
    s_lshl_b32 s79, s62, 11
    s_add_u32 m0, s79, 98304
    s_add_u32 s79, s78, 15360
    buffer_load_dwordx4 v26, s[36:39], s78 offen lds
    buffer_load_dwordx4 v26, s[36:39], s79 offen offset:1024 lds
    s_add_u32 s78, s65, 6
    s_and_b32 s78, s78, 15
    s_lshl_b32 s78, s78, 17
    s_lshl_b32 s79, s62, 11
    s_add_u32 m0, s79, 106496
    s_add_u32 s79, s78, 15360
    buffer_load_dwordx4 v26, s[36:39], s78 offen lds
    buffer_load_dwordx4 v26, s[36:39], s79 offen offset:1024 lds
    s_add_u32 s78, s65, 7
    s_and_b32 s78, s78, 15
    s_lshl_b32 s78, s78, 17
    s_lshl_b32 s79, s62, 11
    s_add_u32 m0, s79, 114688
    s_add_u32 s79, s78, 15360
    buffer_load_dwordx4 v26, s[36:39], s78 offen lds
    buffer_load_dwordx4 v26, s[36:39], s79 offen offset:1024 lds
    s_mul_i32 s78, s62, 384
    s_add_u32 s78, s78, s73
    s_add_u32 s78, s78, 2048
    v_lshlrev_b32 v11, 7, v1
    s_mov_b64 exec, 7
    buffer_load_dword v27, v11, s[40:43], s78 offen sc1
    s_mov_b64 exec, -1
    s_waitcnt vmcnt(7)
    s_lshl_b32 s76, s62, 2
    s_add_u32 s76, s76, s73
    v_mov_b32 v4, 0
    s_mov_b64 exec, 1
    s_bitcmp1_b32 s100, 0
    s_cbranch_scc1 L_loc_11
    buffer_store_dword v4, v4, s[40:43], s76 offen offset:2560 sc1
    s_branch L_pubd_12
L_loc_11:
    buffer_store_dword v4, v4, s[40:43], s76 offen offset:2560
L_pubd_12:
    s_mov_b64 exec, -1
    s_add_u32 s78, s65, 8
    s_and_b32 s78, s78, 15
    s_lshl_b32 s78, s78, 17
    s_lshl_b32 s79, s62, 11
    s_add_u32 m0, s79, 122880
    s_add_u32 s79, s78, 15360
    buffer_load_dwordx4 v26, s[36:39], s78 offen lds
    buffer_load_dwordx4 v26, s[36:39], s79 offen offset:1024 lds
    s_add_u32 s78, s65, 9
    s_and_b32 s78, s78, 15
    s_lshl_b32 s78, s78, 17
    s_lshl_b32 s79, s62, 11
    s_add_u32 m0, s79, 131072
    s_add_u32 s79, s78, 15360
    buffer_load_dwordx4 v26, s[36:39], s78 offen lds
    buffer_load_dwordx4 v26, s[36:39], s79 offen offset:1024 lds
    s_add_u32 s78, s65, 10
    s_and_b32 s78, s78, 15
    s_lshl_b32 s78, s78, 17
    s_lshl_b32 s79, s62, 11
    s_add_u32 m0, s79, 139264
    s_add_u32 s79, s78, 15360
    buffer_load_dwordx4 v26, s[36:39], s78 offen lds
    buffer_load_dwordx4 v26, s[36:39], s79 offen offset:1024 lds
    v_and_b32_e64 v65, 15, v1
    v_mul_u32_u24 v65, 460800, v65
    s_mul_i32 s80, s61, 28800
    s_lshl_b32 s82, s62, 2
    s_add_u32 s82, s82, s80
    v_bfe_u32 v4, v1, 4, 1
    v_lshl_add_u32 v4, v4, 1, v3
    s_lshl_b32 s77, s62, 6
    v_lshl_add_u32 v66, v4, 1, s77
    v_bfe_u32 v4, v1, 2, 1
    v_lshl_add_u32 v66, v4, 5, v66
    v_bfe_u32 v4, v1, 0, 1
    v_lshl_add_u32 v66, v4, 4, v66
    v_bfe_u32 v4, v1, 1, 1
    v_lshl_add_u32 v66, v4, 3, v66
    s_lshl_b32 s83, s62, 7
    s_add_u32 s81, s83, s80
    s_add_u32 s68, s81, 3686400
    s_add_u32 s83, s83, s73
    v_and_b32 v4, 7, v1
    v_lshrrev_b32 v5, 4, v1
    v_lshlrev_b32_e64 v5, 2, v5
    v_lshl_add_u32 v67, v4, 4, v5
    v_bfe_u32 v5, v1, 3, 1
    v_lshrrev_b32_e64 v6, 4, v1
    v_lshl_add_u32 v5, v5, 4, v6
    v_mul_u32_u24 v5, 9344, v5
    v_lshl_add_u32 v61, v4, 4, v5
    s_lshr_b32 s69, s97, 1
    s_lshr_b32 s76, s2, 7
    s_lshl2_add_u32 s69, s69, s76
    s_mul_i32 s69, s69, 74752
    s_add_u32 s69, s69, 8389632
    s_barrier
    s_add_u32 s78, s65, 11
    s_and_b32 s78, s78, 15
    s_lshl_b32 s78, s78, 17
    s_lshl_b32 s79, s62, 11
    s_add_u32 m0, s79, 147456
    s_add_u32 s79, s78, 15360
    buffer_load_dwordx4 v26, s[36:39], s78 offen lds
    buffer_load_dwordx4 v26, s[36:39], s79 offen offset:1024 lds
    s_add_u32 s78, s65, 12
    s_and_b32 s78, s78, 15
    s_lshl_b32 s78, s78, 17
    s_lshl_b32 s79, s62, 11
    s_add_u32 m0, s79, 155648
    s_add_u32 s79, s78, 15360
    buffer_load_dwordx4 v26, s[36:39], s78 offen lds
    buffer_load_dwordx4 v26, s[36:39], s79 offen offset:1024 lds
    buffer_load_dword v64, v65, s[40:43], s82 offen offset:2560 sc1
    s_barrier
    s_setprio 3
    v_mov_b32 v4, s89
    v_lshlrev_b32 v5, 2, v1
    ds_write_b32 v5, v4 offset:24832
    v_mov_b32 v70, 0
    v_mov_b32 v71, 0
    ds_write_b64 v70, v[70:71] offset:25984
    s_mov_b32 s88, 0
    s_branch L_p2first_13
L_p2_14:
    buffer_load_dword v64, v65, s[40:43], s82 offen offset:2560 sc1
L_p2first_13:
    s_waitcnt vmcnt(0)
    v_cmp_eq_u32_e64 vcc, -1, v64
    s_nop 0
    s_cbranch_vccz L_ok_15
    s_add_u32 s88, s88, 1
    s_cmp_lt_u32 s88, 65536
    s_cbranch_scc1 L_p2_14
L_ok_15:
    s_add_u32 s78, s65, 13
    s_and_b32 s78, s78, 15
    s_lshl_b32 s78, s78, 17
    s_lshl_b32 s79, s62, 11
    s_add_u32 m0, s79, 32768
    s_add_u32 s79, s78, 15360
    buffer_load_dwordx4 v26, s[36:39], s78 offen lds
    buffer_load_dwordx4 v26, s[36:39], s79 offen offset:1024 lds
    s_add_u32 s78, s65, 14
    s_and_b32 s78, s78, 15
    s_lshl_b32 s78, s78, 17
    s_lshl_b32 s79, s62, 11
    s_add_u32 m0, s79, 40960
    s_add_u32 s79, s78, 15360
    buffer_load_dwordx4 v26, s[36:39], s78 offen lds
    buffer_load_dwordx4 v26, s[36:39], s79 offen offset:1024 lds
    s_add_u32 s78, s65, 15
    s_and_b32 s78, s78, 15
    s_lshl_b32 s78, s78, 17
    s_lshl_b32 s79, s62, 11
    s_add_u32 m0, s79, 49152
    s_add_u32 s79, s78, 15360
    buffer_load_dwordx4 v26, s[36:39], s78 offen lds
    buffer_load_dwordx4 v26, s[36:39], s79 offen offset:1024 lds
    s_lshl_b32 s76, s62, 11
    s_lshl_b32 s77, s60, 7
    s_add_u32 s76, s76, s77
    s_add_u32 s76, s76, s69
    s_add_u32 s77, s76, 37376
    s_mov_b32 s78, 0x00003f80
    s_mov_b32 s79, 0x3f800000
    s_mov_b32 s88, 0
L_poll_16:
    buffer_load_dwordx4 v[32:35], v61, s[40:43], s76 offen sc1
    buffer_load_dwordx4 v[36:39], v61, s[40:43], s77 offen sc1
    s_waitcnt vmcnt(0)
    v_max_u32 v4, v32, v36
    v_cmp_eq_u32_e64 vcc, -1, v4
    s_nop 0
    s_cbranch_vccz L_ok_17
    s_add_u32 s88, s88, 1
    s_cmp_lt_u32 s88, 65536
    s_cbranch_scc1 L_poll_16
L_ok_17:
    v_dot2_f32_bf16 v48, v32, s78, 0
    v_dot2_f32_bf16 v49, v32, s79, 0
    v_dot2_f32_bf16 v50, v33, s78, 0
    v_dot2_f32_bf16 v51, v33, s79, 0
    v_dot2_f32_bf16 v52, v34, s78, 0
    v_dot2_f32_bf16 v53, v34, s79, 0
    v_dot2_f32_bf16 v54, v35, s78, 0
    v_dot2_f32_bf16 v55, v35, s79, 0
    v_dot2_f32_bf16 v48, v36, s78, v48
    v_dot2_f32_bf16 v49, v36, s79, v49
    v_dot2_f32_bf16 v50, v37, s78, v50
    v_dot2_f32_bf16 v51, v37, s79, v51
    v_dot2_f32_bf16 v52, v38, s78, v52
    v_dot2_f32_bf16 v53, v38, s79, v53
    v_dot2_f32_bf16 v54, v39, s78, v54
    v_dot2_f32_bf16 v55, v39, s79, v55
    buffer_load_dwordx4 v[40:43], v13, s[40:43], s81 offen offset:2048 sc1
    buffer_load_dwordx4 v[44:47], v13, s[40:43], s68 offen offset:2048 sc1
    v_permlane32_swap_b32 v48, v52
    v_permlane32_swap_b32 v49, v53
    v_permlane32_swap_b32 v50, v54
    v_permlane32_swap_b32 v51, v55
    v_add_f32 v48, v48, v52
    v_add_f32 v49, v49, v53
    v_add_f32 v50, v50, v54
    v_add_f32 v51, v51, v55
    s_nop 0
    v_permlane16_swap_b32 v48, v50
    v_permlane16_swap_b32 v49, v51
    v_add_f32 v48, v48, v50
    v_add_f32_e64 v49, v49, v51
    s_nop 0
    v_add_f32_dpp v48, v48, v48 row_ror:8 row_mask:0xf bank_mask:0xf
    v_add_f32_dpp v49, v49, v49 row_ror:8 row_mask:0xf bank_mask:0xf
    v_cvt_pk_bf16_f32 v48, v48, v49
    s_bitcmp1_b32 s100, 0
    s_cbranch_scc1 L_loc_18
    buffer_store_dword v48, v67, s[40:43], s83 offen offset:3072 sc1
    s_branch L_pubd_19
L_loc_18:
    buffer_store_dword v48, v67, s[40:43], s83 offen offset:3072
L_pubd_19:
    s_mov_b32 s88, 0
    s_waitcnt vmcnt(1)
    s_branch L_zfirst_20
L_z_21:
    buffer_load_dwordx4 v[40:43], v13, s[40:43], s81 offen offset:2048 sc1
    buffer_load_dwordx4 v[44:47], v13, s[40:43], s68 offen offset:2048 sc1
    s_waitcnt vmcnt(0)
L_zfirst_20:
    v_max3_u32 v4, v40, v41, v42
    v_max3_u32 v4, v4, v43, v44
    v_max3_u32 v4, v4, v45, v46
    v_max_u32 v4, v4, v47
    v_cmp_eq_u32 vcc, -1, v4
    s_nop 0
    s_cbranch_vccz L_ok_22
    s_add_u32 s88, s88, 1
    s_cmp_lt_u32 s88, 65536
    s_cbranch_scc1 L_z_21
L_ok_22:
    v_add_f32 v40, v40, v44
    v_add_f32 v41, v41, v45
    v_add_f32 v42, v42, v46
    v_add_f32 v43, v43, v47
    v_permlane32_swap_b32 v40, v41
    s_nop 0
    v_permlane32_swap_b32 v42, v43
    v_add_f32 v40, v40, v41
    v_add_f32 v42, v42, v43
    s_nop 1
    v_permlane16_swap_b32 v40, v42
    v_add_f32 v40, v40, v42
    s_nop 1
    v_add_f32_dpp v40, v40, v40 row_ror:8 row_mask:0xf bank_mask:0xf
    v_cvt_pk_bf16_f32 v40, v40, v40
    ds_write_b16 v66, v40 offset:24576
    s_waitcnt lgkmcnt(0)
    s_barrier
    s_setprio 0
    s_mov_b64 exec, 3
    global_load_dword v27, v91, s[66:67]
    s_mov_b64 exec, -1
    s_lshl_b32 s78, s97, 18
    s_lshl_b32 s79, s62, 16
    s_add_u32 s78, s78, s79
    s_lshl_b32 s79, s98, 7
    s_add_u32 s78, s78, s79
    s_lshl_b32 s79, s62, 12
    s_add_u32 m0, s79, 0
    s_nop 0
    buffer_load_dwordx4 v78, s[28:31], s78 offen offset:0 lds
    s_add_u32 s78, s78, 15360
    buffer_load_dwordx4 v79, s[28:31], s78 offen offset:1024 lds
    s_add_u32 s78, s78, 15360
    buffer_load_dwordx4 v78, s[28:31], s78 offen offset:2048 lds
    s_add_u32 s78, s78, 15360
    buffer_load_dwordx4 v79, s[28:31], s78 offen offset:3072 lds
    s_mov_b32 s56, s14
    s_and_b32 s57, s15, 0xffff
    s_mov_b32 s58, 2048
    s_mov_b32 s59, 0x20000
    s_lshl_b32 s78, s62, 9
    s_add_u32 m0, s78, 16384
    s_mov_b32 exec_hi, 0
    buffer_load_dwordx4 v12, s[56:59], s78 offen lds
    s_mov_b64 exec, -1
    s_barrier
    s_lshl4_add_u32 s76, s97, s98
    s_mul_i32 s76, s76, 28800
    s_add_u32 s20, s26, s76
    s_addc_u32 s21, s27, 0
    s_waitcnt vmcnt(0) lgkmcnt(0)
    s_barrier
    s_cmp_eq_u32 s62, 0
    s_cbranch_scc0 L_now1_23
    s_mov_b32 s88, 0
L_spin_25:
    s_load_dwordx16 s[4:19], s[20:21], 3584 glc
    s_waitcnt lgkmcnt(0)
    s_and_b64 s[4:5], s[4:5], s[6:7]
    s_and_b64 s[4:5], s[4:5], s[8:9]
    s_and_b64 s[4:5], s[4:5], s[10:11]
    s_and_b64 s[4:5], s[4:5], s[12:13]
    s_and_b64 s[4:5], s[4:5], s[14:15]
    s_and_b64 s[4:5], s[4:5], s[16:17]
    s_and_b64 s[4:5], s[4:5], s[18:19]
    s_nand_b32 s4, s4, s5
    s_and_b32 s4, s4, 0xffff
    s_mul_i32 s4, s4, 0x10001
    s_lshr_b32 s4, s4, s65
    s_and_b32 s77, s4, 0xffff
    v_mov_b32_e64 v69, s77
    ds_write_b32 v70, v69 offset:25984
    s_cmp_eq_u32 s77, 0xffff
    s_cbranch_scc1 L_s2done_24
    s_add_u32 s88, s88, 1
    s_cmp_lt_u32 s88, 65536
    s_cbranch_scc1 L_spin_25
    s_branch L_s2done_24
L_now1_23:
    s_cmp_eq_u32 s62, 1
    s_cbranch_scc0 L_s2done_24
    s_lshl_b32 s77, 1, s61
    s_not_b32 s77, s77
    v_mov_b32_e64 v4, s77
    v_mul_u32_u24 v5, 28800, v1
    s_mul_i32 s76, s60, 460800
    s_lshl2_add_u32 s76, s61, s76
    s_mov_b32 s88, 0
L_spin_26:
    ds_read_b32 v69, v70 offset:25988
    s_waitcnt lgkmcnt(0)
    v_cmp_eq_u32_e64 vcc, 4, v69
    s_nop 0
    s_cbranch_vccnz L_drained_27
    s_add_u32 s88, s88, 1
    s_cmp_lt_u32 s88, 1048576
    s_cbranch_scc1 L_spin_26
L_drained_27:
    s_mov_b64 exec, 0xffff
    buffer_store_dword v4, v5, s[40:43], s76 offen offset:3584 sc1
    s_mov_b64 exec, -1
L_s2done_24:
    s_waitcnt vmcnt(0)
    v_lshlrev_b32 v17, 5, v2
    v_lshl_add_u32 v17, v3, 4, v17
    v_and_b32 v4, 15, v1
    v_lshrrev_b32 v5, 1, v4
    v_and_b32 v4, 1, v4
    v_lshlrev_b32 v4, 5, v4
    v_lshl_add_u32 v16, v5, 7, v4
    v_lshrrev_b32 v4, 3, v1
    v_and_b32 v5, 7, v1
    v_lshlrev_b32_e64 v5, 4, v5
    v_mul_u32_u24 v18, 9344, v4
    v_add_u32_e64 v18, v18, v5
    v_bfe_u32 v6, v1, 4, 1
    v_lshl_add_u32 v6, v6, 1, v3
    v_lshl_add_u32 v19, v6, 2, v5
    s_mul_i32 s84, s97, 149504
    s_lshl_b32 s77, s98, 7
    s_add_u32 s84, s84, s77
    s_add_u32 s84, s84, 8388608
    s_lshl_b32 s85, s62, 10
    s_add_u32 s85, s85, s99
    s_add_u32 s85, s85, 5120
    s_and_b32 s87, s97, 1
    s_lshl_b32 s87, s87, 4
    s_add_u32 s87, s87, s98
    s_lshr_b32 s86, s97, 1
    s_mul_i32 s86, s86, 299008
    s_lshl_b32 s77, s87, 7
    s_add_u32 s86, s86, s77
    s_add_u32 s86, s86, 8393728
    s_lshl_b32 s78, s62, 11
    s_add_u32 s79, s78, s99
    s_bitcmp1_b32 s100, 1
    s_cbranch_scc1 L_loc_28
    buffer_store_dwordx4 v[28:31], v12, s[40:43], s79 offen offset:1024 sc1
    buffer_store_dwordx4 v[28:31], v12, s[40:43], s79 offen offset:2048 sc1
    s_branch L_pubd_29
L_loc_28:
    buffer_store_dwordx4 v[28:31], v12, s[40:43], s79 offen offset:1024
    buffer_store_dwordx4 v[28:31], v12, s[40:43], s79 offen offset:2048
L_pubd_29:
    s_lshl4_add_u32 s78, s97, s98
    s_lshl4_add_u32 s78, s78, s62
    s_add_u32 s78, s78, 12591116
    s_waitcnt vmcnt(0)
    s_mov_b64 exec, 1
    s_bitcmp1_b32 s100, 1
    s_cbranch_scc1 L_loc_30
    buffer_store_byte v28, v70, s[40:43], s78 offen sc1
    s_branch L_pubd_31
L_loc_30:
    buffer_store_byte v28, v70, s[40:43], s78 offen
L_pubd_31:
    s_mov_b64 exec, -1
    s_cmp_eq_u32 s62, 0
    s_cbranch_scc0 L_nop3c_32
    s_mov_b32 exec_lo, 0
    s_mov_b32 s88, 0
L_spin_33:
    buffer_load_dword v4, v90, s[40:43], 0 offen offset:12 sc1
    s_waitcnt vmcnt(0)
    v_cmp_ne_u32 vcc, -1, v4
    s_nop 0
    s_cbranch_vccz L_p3ok_34
    s_add_u32 s88, s88, 1
    s_cmp_lt_u32 s88, 65536
    s_cbranch_scc1 L_spin_33
L_p3ok_34:
    s_mov_b64 exec, -1
L_nop3c_32:
    s_barrier
    buffer_load_dwordx4 v[156:159], v76, s[48:51], s75 offen nt
    s_add_u32 s75, s75, 7168
    buffer_load_dwordx4 v[32:35], v77, s[52:55], s96 offen nt
    s_add_u32 s96, s96, 4096
    buffer_load_dwordx4 v[36:39], v77, s[52:55], s96 offen nt
    s_add_u32 s96, s96, 4096
    buffer_load_dwordx4 v[40:43], v77, s[52:55], s96 offen nt
    s_add_u32 s96, s96, 4096
    buffer_load_dwordx4 v[44:47], v77, s[52:55], s96 offen nt
    s_add_u32 s96, s96, 4096
    buffer_load_dwordx4 v[48:51], v77, s[52:55], s96 offen nt
    s_add_u32 s96, s96, 4096
    v_mul_u32_u24 v20, 149504, v1
    s_mul_i32 s72, s98, 9344
    s_lshl2_add_u32 s72, s97, s72
    s_add_u32 s72, s72, 8388608
    s_barrier
    s_cmp_eq_u32 s62, 1
    s_cbranch_scc0 L_nopre_35
    s_mov_b64 exec, 0xffff
    buffer_store_dword v70, v20, s[40:43], s72 offen offset:768 sc1
    s_mov_b64 exec, -1
L_nopre_35:
    buffer_load_dwordx4 v[52:55], v77, s[52:55], s96 offen nt
    s_add_u32 s96, s96, 4096
    buffer_load_dwordx4 v[56:59], v77, s[52:55], s96 offen nt
    s_add_u32 s96, s96, 4096
    buffer_load_dwordx4 v[60:63], v77, s[52:55], s96 offen nt
    s_add_u32 s96, s96, 4096
    s_barrier
    s_waitcnt vmcnt(8)
    s_mov_b32 s78, 0x05040100
    s_mov_b32 s79, 0x07060302
    v_perm_b32 v160, v100, v96, s78
    v_perm_b32 v164, v100, v96, s79
    v_perm_b32 v168, v101, v97, s78
    v_perm_b32 v172, v101, v97, s79
    v_perm_b32 v176, v102, v98, s78
    v_perm_b32 v180, v102, v98, s79
    v_perm_b32 v184, v103, v99, s78
    v_perm_b32 v188, v103, v99, s79
    v_perm_b32 v161, v108, v104, s78
    v_perm_b32 v165, v108, v104, s79
    v_perm_b32 v169, v109, v105, s78
    v_perm_b32 v173, v109, v105, s79
    v_perm_b32 v177, v110, v106, s78
    v_perm_b32 v181, v110, v106, s79
    v_perm_b32 v185, v111, v107, s78
    v_perm_b32 v189, v111, v107, s79
    v_perm_b32 v162, v116, v112, s78
    v_perm_b32 v166, v116, v112, s79
    v_perm_b32 v170, v117, v113, s78
    v_perm_b32 v174, v117, v113, s79
    v_perm_b32 v178, v118, v114, s78
    v_perm_b32 v182, v118, v114, s79
    v_perm_b32 v186, v119, v115, s78
    v_perm_b32 v190, v119, v115, s79
    v_perm_b32 v163, v124, v120, s78
    v_perm_b32 v167, v124, v120, s79
    v_perm_b32 v171, v125, v121, s78
    v_perm_b32 v175, v125, v121, s79
    v_perm_b32 v179, v126, v122, s78
    v_perm_b32 v183, v126, v122, s79
    v_perm_b32 v187, v127, v123, s78
    v_perm_b32 v191, v127, v123, s79
    v_perm_b32 v192, v132, v128, s78
    v_perm_b32 v196, v132, v128, s79
    v_perm_b32 v200, v133, v129, s78
    v_perm_b32 v204, v133, v129, s79
    v_perm_b32 v208, v134, v130, s78
    v_perm_b32 v212, v134, v130, s79
    v_perm_b32 v216, v135, v131, s78
    v_perm_b32 v220, v135, v131, s79
    v_perm_b32 v193, v140, v136, s78
    v_perm_b32 v197, v140, v136, s79
    v_perm_b32 v201, v141, v137, s78
    v_perm_b32 v205, v141, v137, s79
    v_perm_b32 v209, v142, v138, s78
    v_perm_b32 v213, v142, v138, s79
    v_perm_b32 v217, v143, v139, s78
    v_perm_b32 v221, v143, v139, s79
    v_perm_b32 v194, v148, v144, s78
    v_perm_b32 v198, v148, v144, s79
    v_perm_b32 v202, v149, v145, s78
    v_perm_b32 v206, v149, v145, s79
    v_perm_b32 v210, v150, v146, s78
    v_perm_b32 v214, v150, v146, s79
    v_perm_b32 v218, v151, v147, s78
    v_perm_b32 v222, v151, v147, s79
    v_perm_b32 v195, v156, v152, s78
    v_perm_b32 v199, v156, v152, s79
    v_perm_b32 v203, v157, v153, s78
    v_perm_b32 v207, v157, v153, s79
    v_perm_b32 v211, v158, v154, s78
    v_perm_b32 v215, v158, v154, s79
    v_perm_b32 v219, v159, v155, s78
    v_perm_b32 v223, v159, v155, s79
    s_waitcnt vmcnt(6)
    s_mov_b32 s78, 0x05040100
    s_mov_b32 s79, 0x07060302
    v_permlane32_swap_b32 v32, v34
    v_permlane32_swap_b32 v33, v35
    v_permlane32_swap_b32 v36, v38
    v_permlane32_swap_b32_e64 v37, v39
    v_perm_b32 v224, v34, v32, s78
    v_perm_b32 v225, v34, v32, s79
    v_perm_b32 v226, v35, v33, s78
    v_perm_b32 v227, v35, v33, s79
    v_perm_b32 v228, v38, v36, s78
    v_perm_b32 v229, v38, v36, s79
    v_perm_b32 v230, v39, v37, s78
    v_perm_b32 v231, v39, v37, s79
    s_waitcnt vmcnt(4)
    s_mov_b32 s78, 0x05040100
    s_mov_b32 s79, 0x07060302
    v_permlane32_swap_b32 v40, v42
    v_permlane32_swap_b32 v41, v43
    v_permlane32_swap_b32 v44, v46
    v_permlane32_swap_b32_e64 v45, v47
    v_perm_b32 v232, v42, v40, s78
    v_perm_b32 v233, v42, v40, s79
    v_perm_b32 v234, v43, v41, s78
    v_perm_b32 v235, v43, v41, s79
    v_perm_b32 v236, v46, v44, s78
    v_perm_b32 v237, v46, v44, s79
    v_perm_b32 v238, v47, v45, s78
    v_perm_b32 v239, v47, v45, s79
    s_waitcnt vmcnt(2)
    s_mov_b32 s78, 0x05040100
    s_mov_b32 s79, 0x07060302
    v_permlane32_swap_b32 v48, v50
    v_permlane32_swap_b32 v49, v51
    v_permlane32_swap_b32 v52, v54
    v_permlane32_swap_b32_e64 v53, v55
    v_perm_b32 v240, v50, v48, s78
    v_perm_b32 v241, v50, v48, s79
    v_perm_b32 v242, v51, v49, s78
    v_perm_b32 v243, v51, v49, s79
    v_perm_b32 v244, v54, v52, s78
    v_perm_b32 v245, v54, v52, s79
    v_perm_b32 v246, v55, v53, s78
    v_perm_b32 v247, v55, v53, s79
    s_waitcnt vmcnt(0)
    s_mov_b32 s78, 0x05040100
    s_mov_b32 s79, 0x07060302
    v_permlane32_swap_b32 v56, v58
    v_permlane32_swap_b32 v57, v59
    v_permlane32_swap_b32 v60, v62
    v_permlane32_swap_b32_e64 v61, v63
    v_perm_b32 v248, v58, v56, s78
    v_perm_b32 v249, v58, v56, s79
    v_perm_b32 v250, v59, v57, s78
    v_perm_b32 v251, v59, v57, s79
    v_perm_b32 v252, v62, v60, s78
    v_perm_b32 v253, v62, v60, s79
    v_perm_b32 v254, v63, v61, s78
    v_perm_b32 v255, v63, v61, s79
    v_and_b32 v5, 15, v1
    v_lshlrev_b32 v5, 3, v5
    s_lshl_b32 s76, s63, 10
    s_lshl_b32 s77, s64, 6
    s_add_u32 s76, s76, s77
    s_add_u32 s76, s76, s99
    s_mov_b64 s[80:81], 0xffff
    s_add_u32 s68, s84, 74752
    s_add_u32 s69, s86, 74752
    s_add_u32 s70, s86, 149504
    s_add_u32 s71, s86, 224256
    s_setprio 3
    s_barrier
    ds_read_b128 v[64:67], v12 offset:28672
    ds_read_b128 v[68:71], v12 offset:29696
    ds_read_b64 v[8:9], v5 offset:25728
    s_waitcnt lgkmcnt(2)
    v_mfma_f32_16x16x32_bf16 v[96:99], v[64:67], v[160:163], 0
    v_mfma_f32_16x16x32_bf16 v[100:103], v[64:67], v[164:167], 0
    s_waitcnt lgkmcnt(0)
    v_max_f32_dpp v4, v8, v8 row_ror:8 row_mask:0xf bank_mask:0xf
    v_mfma_f32_16x16x32_bf16 v[104:107], v[64:67], v[168:171], 0
    v_mfma_f32_16x16x32_bf16 v[108:111], v[64:67], v[172:175], 0
    v_max_f32_dpp v4, v4, v4 row_ror:4 row_mask:0xf bank_mask:0xf
    v_mfma_f32_16x16x32_bf16 v[112:115], v[64:67], v[176:179], 0
    v_mfma_f32_16x16x32_bf16 v[116:119], v[64:67], v[180:183], 0
    v_max_f32_dpp v4, v4, v4 row_ror:2 row_mask:0xf bank_mask:0xf
    v_mfma_f32_16x16x32_bf16 v[120:123], v[64:67], v[184:187], 0
    v_mfma_f32_16x16x32_bf16 v[124:127], v[64:67], v[188:191], 0
    v_max_f32_dpp v4, v4, v4 row_ror:1 row_mask:0xf bank_mask:0xf
    v_mfma_f32_16x16x32_bf16 v[96:99], v[68:71], v[192:195], v[96:99]
    v_cmp_eq_f32_e64 vcc, v4, v8
    v_mfma_f32_16x16x32_bf16 v[100:103], v[68:71], v[196:199], v[100:103]
    s_ff1_i32_b32 s92, vcc_lo
    s_and_b32 s92, s92, 15
    v_mfma_f32_16x16x32_bf16 v[104:107], v[68:71], v[200:203], v[104:107]
    s_lshr_b32 s78, s92, 2
    s_lshl_b32 s78, s78, 4
    v_mfma_f32_16x16x32_bf16 v[108:111], v[68:71], v[204:207], v[108:111]
    s_and_b32 s77, s92, 3
    v_mfma_f32_16x16x32_bf16 v[112:115], v[68:71], v[208:211], v[112:115]
    v_readlane_b32 s91, v9, s92
    v_readlane_b32 s93, v8, s92
    v_mfma_f32_16x16x32_bf16 v[116:119], v[68:71], v[212:215], v[116:119]
    v_mfma_f32_16x16x32_bf16 v[120:123], v[68:71], v[216:219], v[120:123]
    v_mfma_f32_16x16x32_bf16 v[124:127], v[68:71], v[220:223], v[124:127]
    s_cmp_ge_u32 s97, 14
    s_cbranch_scc1 L_final
    s_cmp_eq_u32 s77, 0
    s_cbranch_scc0 L_sel_37
    v_mov_b32 v64, v96
    v_mov_b32 v65, v100
    v_mov_b32 v66, v104
    v_mov_b32 v67, v108
    v_mov_b32 v68, v112
    v_mov_b32 v69, v116
    v_mov_b32 v70, v120
    v_mov_b32 v71, v124
    s_branch L_seldone_36
L_sel_37:
    s_cmp_eq_u32 s77, 1
    s_cbranch_scc0 L_sel_38
    v_mov_b32 v64, v97
    v_mov_b32 v65, v101
    v_mov_b32 v66, v105
    v_mov_b32 v67, v109
    v_mov_b32 v68, v113
    v_mov_b32 v69, v117
    v_mov_b32 v70, v121
    v_mov_b32 v71, v125
    s_branch L_seldone_36
L_sel_38:
    s_cmp_eq_u32 s77, 2
    s_cbranch_scc0 L_sel_39
    v_mov_b32 v64, v98
    v_mov_b32 v65, v102
    v_mov_b32 v66, v106
    v_mov_b32 v67, v110
    v_mov_b32 v68, v114
    v_mov_b32 v69, v118
    v_mov_b32 v70, v122
    v_mov_b32 v71, v126
    s_branch L_seldone_36
L_sel_39:
    v_mov_b32 v64, v99
    v_mov_b32 v65, v103
    v_mov_b32 v66, v107
    v_mov_b32 v67, v111
    v_mov_b32 v68, v115
    v_mov_b32 v69, v119
    v_mov_b32 v70, v123
    v_mov_b32_e64 v71, v127
L_seldone_36:
    s_lshl_b64 exec, s[80:81], s78
    s_bitcmp1_b32 s100, 1
    s_cbranch_scc1 L_loc_41
    buffer_store_dwordx4 v[64:67], v16, s[40:43], s76 offen offset:3072 sc1
    buffer_store_dwordx4 v[68:71], v16, s[40:43], s76 offen offset:3088 sc1
    s_branch L_pubd_42
L_loc_41:
    buffer_store_dwordx4 v[64:67], v16, s[40:43], s76 offen offset:3072
    buffer_store_dwordx4 v[68:71], v16, s[40:43], s76 offen offset:3088
L_pubd_42:
    s_mov_b64 exec, -1
    s_mov_b32 s88, 0
L_poll_43:
    buffer_load_dwordx4 v[128:131], v18, s[40:43], s84 offen offset:3072 sc1
    buffer_load_dwordx4 v[132:135], v18, s[40:43], s68 offen offset:3072 sc1
    s_waitcnt vmcnt(0)
    v_max_u32 v4, v128, v132
    v_cmp_eq_u32_e64 vcc, -1, v4
    s_nop 0
    s_cbranch_vccz L_ok_44
    s_add_u32 s88, s88, 1
    s_cmp_lt_u32 s88, 65536
    s_cbranch_scc1 L_poll_43
L_ok_44:
    v_pk_add_f32 v[48:49], v[128:129], v[132:133]
    v_pk_add_f32 v[50:51], v[130:131], v[134:135]
    s_nop 0
    v_permlane32_swap_b32 v48, v49
    v_permlane32_swap_b32 v50, v51
    v_add_f32 v48, v48, v49
    v_add_f32 v50, v50, v51
    s_nop 1
    v_permlane16_swap_b32 v48, v50
    v_add_f32 v48, v48, v50
    s_nop 1
    v_add_f32_dpp v48, v48, v48 row_ror:8 row_mask:0xf bank_mask:0xf
    v_cvt_pk_bf16_f32 v48, v48, v48
    v_and_b32_e64 v48, s90, v48
    v_mul_f32 v4, 0xbfb8aa3b, v48
    v_exp_f32_e64 v4, v4
    v_mov_b32_dpp v49, v48 row_ror:12 row_mask:0xf bank_mask:0xf
    v_add_f32 v4, 1.0, v4
    v_rcp_f32 v4, v4
    s_nop 0
    v_mul_f32 v4, v4, v48
    v_cvt_pk_bf16_f32 v4, v4, v4
    v_and_b32 v4, s90, v4
    v_mul_f32 v4, v4, v49
    v_mov_b32 v5, v4
    s_nop 1
    v_permlane32_swap_b32_e64 v4, v5
    v_cvt_pk_bf16_f32 v4, v4, v5
    s_nop 0
    v_readlane_b32 s76, v4, 0
    v_readlane_b32 s77, v4, 16
    v_readlane_b32 s78, v4, 1
    v_readlane_b32 s79, v4, 17
    v_readlane_b32 s80, v4, 2
    v_readlane_b32 s81, v4, 18
    v_readlane_b32 s82, v4, 3
    v_readlane_b32 s83, v4, 19
    v_dot2_f32_bf16 v40, v224, s76, 0
    v_dot2_f32_bf16 v41, v225, s76, 0
    v_dot2_f32_bf16 v42, v226, s76, 0
    v_dot2_f32_bf16 v43, v227, s76, 0
    v_dot2_f32_bf16 v40, v228, s77, v40
    v_dot2_f32_bf16 v41, v229, s77, v41
    v_dot2_f32_bf16 v42, v230, s77, v42
    v_dot2_f32_bf16 v43, v231, s77, v43
    v_dot2_f32_bf16 v40, v232, s78, v40
    v_dot2_f32_bf16 v41, v233, s78, v41
    v_dot2_f32_bf16 v42, v234, s78, v42
    v_dot2_f32_bf16 v43, v235, s78, v43
    v_dot2_f32_bf16 v40, v236, s79, v40
    v_dot2_f32_bf16 v41, v237, s79, v41
    v_dot2_f32_bf16 v42, v238, s79, v42
    v_dot2_f32_bf16 v43, v239, s79, v43
    v_dot2_f32_bf16 v40, v240, s80, v40
    v_dot2_f32_bf16 v41, v241, s80, v41
    v_dot2_f32_bf16 v42, v242, s80, v42
    v_dot2_f32_bf16 v43, v243, s80, v43
    v_dot2_f32_bf16 v40, v244, s81, v40
    v_dot2_f32_bf16 v41, v245, s81, v41
    v_dot2_f32_bf16 v42, v246, s81, v42
    v_dot2_f32_bf16 v43, v247, s81, v43
    v_dot2_f32_bf16 v40, v248, s82, v40
    v_dot2_f32_bf16 v41, v249, s82, v41
    v_dot2_f32_bf16 v42, v250, s82, v42
    v_dot2_f32_bf16 v43, v251, s82, v43
    v_dot2_f32_bf16 v40, v252, s83, v40
    v_dot2_f32_bf16 v41, v253, s83, v41
    v_dot2_f32_bf16 v42, v254, s83, v42
    v_dot2_f32_bf16 v43, v255, s83, v43
    s_bitcmp1_b32 s100, 1
    s_cbranch_scc1 L_loc_45
    s_nop 0
    buffer_store_dwordx4 v[40:43], v17, s[40:43], s85 offen sc1
    s_branch L_pubd_46
L_loc_45:
    s_nop 0
    buffer_store_dwordx4 v[40:43], v17, s[40:43], s85 offen
L_pubd_46:
    s_cmp_eq_u32 s62, 0
    s_cbranch_scc0 L_hby
    s_mov_b32 s88, 0
L_poll_47:
    buffer_load_dwordx4 v[136:139], v18, s[40:43], s86 offen sc1
    buffer_load_dwordx4 v[140:143], v18, s[40:43], s69 offen sc1
    buffer_load_dwordx4 v[144:147], v18, s[40:43], s70 offen sc1
    buffer_load_dwordx4 v[148:151], v18, s[40:43], s71 offen sc1
    s_waitcnt vmcnt(0)
    v_max3_u32 v4, v136, v140, v144
    v_max_u32 v4, v4, v148
    v_cmp_eq_u32_e64 vcc, -1, v4
    s_nop 0
    s_cbranch_vccz L_ok_48
    s_add_u32 s88, s88, 1
    s_cmp_lt_u32 s88, 65536
    s_cbranch_scc1 L_poll_47
L_ok_48:
    v_pk_add_f32 v[48:49], v[136:137], v[144:145]
    v_pk_add_f32 v[50:51], v[138:139], v[146:147]
    v_pk_add_f32 v[52:53], v[140:141], v[148:149]
    v_pk_add_f32 v[54:55], v[142:143], v[150:151]
    v_pk_add_f32 v[48:49], v[48:49], v[52:53]
    v_pk_add_f32 v[50:51], v[50:51], v[54:55]
    s_nop 0
    v_permlane32_swap_b32 v48, v49
    v_permlane32_swap_b32 v50, v51
    v_add_f32 v48, v48, v49
    v_add_f32 v50, v50, v51
    s_nop 1
    v_permlane16_swap_b32 v48, v50
    v_add_f32 v48, v48, v50
    s_nop 1
    v_add_f32_dpp v48, v48, v48 row_ror:8 row_mask:0xf bank_mask:0xf
    buffer_store_dword v48, v19, s[40:43], s99 offen offset:512 sc1
L_hby:
    s_barrier
    s_lshl2_add_u32 s72, s87, s62
    s_cmp_eq_u32 s72, 0
    s_cbranch_scc0 L_nowb_49
    s_waitcnt vmcnt(0)
    buffer_wbl2 sc1
L_nowb_49:
    s_branch L_hfin
L_final:
    s_barrier
    s_lshl2_add_u32 s72, s87, s62
    s_cmp_eq_u32 s72, 3
    s_cbranch_scc0 L_nowb_50
    s_waitcnt vmcnt(0)
    buffer_wbl2 sc1
L_nowb_50:
    s_cmp_eq_u32 s62, 1
    s_cbranch_scc0 L_noep_51
    s_cmp_eq_u32 s87, 0
    s_cbranch_scc0 L_noep_51
    v_mov_b32 v4, 13631488
    s_mov_b64 exec, 1
    buffer_store_dwordx2 v[88:89], v4, s[40:43], 0 offen sc1
    s_mov_b64 exec, -1
L_noep_51:
    s_cmp_eq_u32 s62, 0
    s_cbranch_scc0 L_hfin
    v_mov_b32 v8, s93
    v_cvt_pk_bf16_f32 v8, v8, v8
    v_and_b32_e64 v8, s90, v8
    v_mul_f32 v8, 0xbfb8aa3b, v8
    v_exp_f32 v8, v8
    s_nop 0
    v_add_f32 v8, 1.0, v8
    v_rcp_f32_e64 v8, v8
    s_nop 0
    v_cvt_pk_bf16_f32 v8, v8, v8
    v_and_b32 v8, s90, v8
    s_lshl_b32 s76, s92, 4
    s_lshr_b32 s77, s87, 1
    s_add_u32 s76, s76, s77
    s_mul_i32 s76, s76, 9344
    s_add_u32 s76, s76, 8388608
    s_and_b32 s77, s87, 1
    s_lshl_b32 s77, s77, 5
    s_add_u32 s76, s76, s77
    v_and_b32 v10, 1, v1
    v_lshlrev_b32_e64 v10, 6, v10
    v_bfe_u32 v4, v1, 1, 2
    v_lshl_add_u32 v10, v4, 3, v10
    v_bfe_u32 v4, v1, 4, 1
    v_lshl_add_u32 v10, v4, 2, v10
    v_lshrrev_b32_e64 v4, 3, v1
    v_mul_u32_u24 v6, 299008, v4
    v_and_b32_e64 v5, 7, v1
    v_lshl_add_u32 v6, v5, 4, v6
    v_mov_b32 v7, 2146435072
    v_cmp_gt_u32 vcc, 56, v1
    s_nop 1
    v_cndmask_b32_e64 v6, v7, v6, vcc
    s_mul_i32 s79, s87, 9344
    s_add_u32 s79, s79, 8388608
    s_lshl_b32 s80, s91, 11
    s_lshl_b32 s77, s87, 6
    s_add_u32 s80, s80, s77
    s_mov_b32 s88, 0
L_spin_52:
    buffer_load_dword v64, v10, s[40:43], s76 offen offset:0 sc1
    buffer_load_dword v65, v10, s[40:43], s76 offen offset:128 sc1
    s_waitcnt vmcnt(0)
    v_max_u32 v4, v64, v65
    v_cmp_eq_u32 vcc, -1, v4
    s_nop 0
    s_cbranch_vccz L_ok_53
    s_add_u32 s88, s88, 1
    s_cmp_lt_u32 s88, 65536
    s_cbranch_scc1 L_spin_52
L_ok_53:
    v_lshlrev_b32 v4, 4, v3
    v_lshrrev_b32 v64, v4, v64
    v_lshrrev_b32 v65, v4, v65
    v_lshlrev_b32 v64, 16, v64
    v_lshlrev_b32 v65, 16, v65
    v_lshrrev_b32 v9, 1, v19
    s_mov_b32 s88, 0
    buffer_load_dwordx4 v[128:131], v6, s[40:43], s79 offen offset:512 sc1
    buffer_load_dwordx4 v[128:131], v6, s[40:43], s79 offen offset:512 sc1
L_poll_54:
    buffer_load_dwordx4 v[128:131], v6, s[40:43], s79 offen offset:512 sc1
    s_waitcnt vmcnt(2)
    v_max3_u32 v4, v128, v129, v130
    v_max_u32 v4, v4, v131
    v_cmp_eq_u32 vcc, -1, v4
    s_nop 0
    s_cbranch_vccz L_ok_55
    s_add_u32 s88, s88, 1
    s_cmp_lt_u32 s88, 65536
    s_cbranch_scc1 L_poll_54
L_ok_55:
    v_mov_b32 v48, v128
    v_mov_b32 v49, v129
    v_mov_b32 v50, v130
    v_mov_b32 v51, v131
    v_permlane32_swap_b32 v48, v49
    s_nop 0
    v_permlane32_swap_b32 v50, v51
    v_add_f32 v48, v48, v49
    v_add_f32 v50, v50, v51
    s_nop 1
    v_permlane16_swap_b32 v48, v50
    v_add_f32 v48, v48, v50
    s_nop 1
    v_add_f32_dpp v48, v48, v48 row_ror:8 row_mask:0xf bank_mask:0xf
    v_cvt_pk_bf16_f32 v48, v48, v48
    v_and_b32 v48, s90, v48
    v_mul_f32 v48, v48, v8
    v_cvt_pk_bf16_f32 v48, v48, v48
    v_and_b32 v48, s90, v48
    v_add_f32 v48, v48, v64
    v_cvt_pk_bf16_f32 v48, v48, v48
    v_and_b32 v48, s90, v48
    v_add_f32 v48, v48, v65
    v_cvt_pk_bf16_f32 v48, v48, v48
    s_mov_b32 exec_lo, 0x00ff00ff
    s_mov_b32 exec_hi, 0x00ff00ff
    buffer_store_short v48, v9, s[44:47], s80 offen sc1
    s_mov_b64 exec, -1
L_hfin:
    s_endpgm
L_event:
    s_cmp_eq_u32 s77, 3
    s_cbranch_scc0 L_ev1
    buffer_load_dwordx4 v[92:95], v90, s[40:43], 0 offen sc1
    s_mov_b64 exec, 3
    global_load_dword v27, v91, s[66:67]
    s_mov_b64 exec, -1
    s_branch L_evret
L_ev1:
    s_cmp_eq_u32 s77, 5
    s_cbranch_scc0 L_ev_56
    s_and_b32 s72, s84, 15
    s_mov_b32 m0, s70
    s_lshl_b32 s71, s72, 7
    buffer_load_dwordx4 v16, s[28:31], s71 offen offset:0 lds
    s_mul_i32 s72, s72, 393216
    s_lshr_b64 s[84:85], s[84:85], 4
    buffer_load_dwordx4 v17, s[28:31], s71 offen offset:1024 lds
    buffer_load_dwordx4 v18, s[28:31], s71 offen offset:2048 lds
    buffer_load_dwordx4 v19, s[28:31], s71 offen offset:3072 lds
    s_add_u32 m0, s70, 4096
    s_nop 0
    buffer_load_dwordx4 v20, s[32:35], s72 offen offset:0 lds
    buffer_load_dwordx4 v21, s[32:35], s72 offen offset:1024 lds
    buffer_load_dwordx4 v22, s[32:35], s72 offen offset:2048 lds
    buffer_load_dwordx4 v23, s[32:35], s72 offen offset:3072 lds
    s_add_u32 m0, s70, 8192
    s_nop 0
    buffer_load_dwordx4 v24, s[32:35], s72 offen offset:0 lds
    buffer_load_dwordx4 v25, s[32:35], s72 offen offset:1024 lds
    s_add_u32 s70, s70, 40960
    s_cmp_ge_u32 s70, 122880
    s_cselect_b32 s76, 122880, 0
    s_sub_u32 s70, s70, s76
    buffer_load_dwordx4 v[96:99], v76, s[48:51], s75 offen nt
    s_add_u32 s75, s75, 7168
    buffer_load_dwordx4 v[100:103], v76, s[48:51], s75 offen nt
    s_add_u32 s75, s75, 7168
    buffer_load_dwordx4 v[104:107], v76, s[48:51], s75 offen nt
    s_add_u32 s75, s75, 7168
    buffer_load_dwordx4 v[108:111], v76, s[48:51], s75 offen nt
    s_add_u32 s75, s75, 7168
    buffer_load_dwordx4 v[128:131], v76, s[48:51], s75 offen nt
    s_add_u32 s75, s75, 7168
    buffer_load_dwordx4 v[132:135], v76, s[48:51], s75 offen nt
    s_add_u32 s75, s75, 7168
    buffer_load_dwordx4 v[136:139], v76, s[48:51], s75 offen nt
    s_add_u32 s75, s75, 7168
    buffer_load_dwordx4 v[140:143], v76, s[48:51], s75 offen nt
    s_add_u32 s75, s75, 7168
    s_waitcnt vmcnt(18)
    s_branch L_hbar
L_ev_56:
    s_cmp_eq_u32 s77, 6
    s_cbranch_scc0 L_ev_57
    s_and_b32 s72, s84, 15
    s_mov_b32 m0, s70
    s_lshl_b32 s71, s72, 7
    buffer_load_dwordx4 v16, s[28:31], s71 offen offset:0 lds
    s_mul_i32 s72, s72, 393216
    s_lshr_b64 s[84:85], s[84:85], 4
    buffer_load_dwordx4 v17, s[28:31], s71 offen offset:1024 lds
    buffer_load_dwordx4 v18, s[28:31], s71 offen offset:2048 lds
    buffer_load_dwordx4 v19, s[28:31], s71 offen offset:3072 lds
    s_add_u32 m0, s70, 4096
    s_nop 0
    buffer_load_dwordx4 v20, s[32:35], s72 offen offset:0 lds
    buffer_load_dwordx4 v21, s[32:35], s72 offen offset:1024 lds
    buffer_load_dwordx4 v22, s[32:35], s72 offen offset:2048 lds
    buffer_load_dwordx4 v23, s[32:35], s72 offen offset:3072 lds
    s_add_u32 m0, s70, 8192
    s_nop 0
    buffer_load_dwordx4 v24, s[32:35], s72 offen offset:0 lds
    buffer_load_dwordx4 v25, s[32:35], s72 offen offset:1024 lds
    s_add_u32 s70, s70, 40960
    s_cmp_ge_u32 s70, 122880
    s_cselect_b32 s76, 122880, 0
    s_sub_u32 s70, s70, s76
    s_lshr_b32 s78, s2, 3
    s_lshl2_add_u32 s78, s78, s62
    s_lshl_b32 s78, s78, 14
    v_lshlrev_b32_e64 v11, 10, v1
    s_mov_b64 exec, 65535
    buffer_load_dword v27, v11, s[36:39], s78 offen offset:384
    s_mov_b64 exec, -1
    s_lshl_b32 s78, s62, 9
    v_lshl_add_u32 v11, v1, 7, s78
    s_mov_b64 exec, 15
    global_load_dword v27, v11, s[14:15]
    s_mov_b64 exec, -1
    buffer_load_dwordx4 v[112:115], v76, s[48:51], s75 offen nt
    s_add_u32 s75, s75, 7168
    buffer_load_dwordx4 v[116:119], v76, s[48:51], s75 offen nt
    s_add_u32 s75, s75, 7168
    buffer_load_dwordx4 v[120:123], v76, s[48:51], s75 offen nt
    s_add_u32 s75, s75, 7168
    buffer_load_dwordx4 v[124:127], v76, s[48:51], s75 offen nt
    s_add_u32 s75, s75, 7168
    buffer_load_dwordx4 v[144:147], v76, s[48:51], s75 offen nt
    s_add_u32 s75, s75, 7168
    buffer_load_dwordx4 v[148:151], v76, s[48:51], s75 offen nt
    s_add_u32 s75, s75, 7168
    s_waitcnt vmcnt(18)
    s_branch L_hbar
L_ev_57:
    s_add_u32 s78, s70, 40960
    s_cmp_ge_u32 s78, 122880
    s_cselect_b32 s76, 122880, 0
    s_sub_u32 s78, s78, s76
    s_cmp_eq_u32 s77, 2
    s_cbranch_scc1 L_evw
    v_add_u32 v4, s78, v72
    v_xor_b32 v5, 32, v4
    v_xor_b32 v6, 64, v4
    v_xor_b32 v7, 96, v4
    s_and_b32 s72, s84, 15
    s_mov_b32 m0, s70
    s_lshl_b32 s71, s72, 7
    buffer_load_dwordx4 v16, s[28:31], s71 offen offset:0 lds
    s_mul_i32 s72, s72, 393216
    s_lshr_b64 s[84:85], s[84:85], 4
    ds_read_b128 v[32:35], v4
    ds_read_b128 v[36:39], v5
    ds_read_b128 v[40:43], v6
    ds_read_b128 v[44:47], v7
    buffer_load_dwordx4 v17, s[28:31], s71 offen offset:1024 lds
    s_lshl_b32 s79, s62, 8
    s_add_u32 s79, s79, s73
    s_waitcnt lgkmcnt(0)
    v_lshlrev_b32 v80, 16, v32
    v_and_b32 v82, s90, v32
    v_mul_f32 v81, v80, v80
    v_mul_f32 v83, v82, v82
    v_lshlrev_b32 v10, 16, v33
    v_and_b32 v11, s90, v33
    v_add_f32 v80, v80, v10
    v_add_f32 v82, v82, v11
    v_fmac_f32 v81, v10, v10
    v_fmac_f32 v83, v11, v11
    v_lshlrev_b32 v8, 16, v34
    v_and_b32_e64 v9, s90, v34
    buffer_load_dwordx4 v18, s[28:31], s71 offen offset:2048 lds
    v_add_f32 v80, v80, v8
    v_add_f32 v82, v82, v9
    v_fmac_f32 v81, v8, v8
    v_fmac_f32 v83, v9, v9
    v_lshlrev_b32 v10, 16, v35
    v_and_b32 v11, s90, v35
    v_add_f32 v80, v80, v10
    v_add_f32 v82, v82, v11
    v_fmac_f32 v81, v10, v10
    v_fmac_f32 v83, v11, v11
    v_lshlrev_b32 v8, 16, v36
    v_and_b32 v9, s90, v36
    buffer_load_dwordx4 v19, s[28:31], s71 offen offset:3072 lds
    v_add_f32 v80, v80, v8
    v_add_f32 v82, v82, v9
    v_fmac_f32 v81, v8, v8
    v_fmac_f32 v83, v9, v9
    v_lshlrev_b32 v10, 16, v37
    v_and_b32 v11, s90, v37
    v_add_f32 v80, v80, v10
    v_add_f32 v82, v82, v11
    v_fmac_f32 v81, v10, v10
    v_fmac_f32 v83, v11, v11
    v_lshlrev_b32 v8, 16, v38
    v_and_b32 v9, s90, v38
    s_add_u32 m0, s70, 4096
    s_nop 0
    buffer_load_dwordx4 v20, s[32:35], s72 offen offset:0 lds
    v_add_f32 v80, v80, v8
    v_add_f32 v82, v82, v9
    v_fmac_f32 v81, v8, v8
    v_fmac_f32 v83, v9, v9
    v_lshlrev_b32 v10, 16, v39
    v_and_b32 v11, s90, v39
    v_add_f32 v80, v80, v10
    v_add_f32 v82, v82, v11
    v_fmac_f32 v81, v10, v10
    v_fmac_f32 v83, v11, v11
    v_lshlrev_b32 v8, 16, v40
    v_and_b32_e64 v9, s90, v40
    buffer_load_dwordx4 v21, s[32:35], s72 offen offset:1024 lds
    v_add_f32 v80, v80, v8
    v_add_f32 v82, v82, v9
    v_fmac_f32 v81, v8, v8
    v_fmac_f32 v83, v9, v9
    v_lshlrev_b32 v10, 16, v41
    v_and_b32 v11, s90, v41
    v_add_f32 v80, v80, v10
    v_add_f32 v82, v82, v11
    v_fmac_f32 v81, v10, v10
    v_fmac_f32 v83, v11, v11
    v_lshlrev_b32 v8, 16, v42
    v_and_b32 v9, s90, v42
    buffer_load_dwordx4 v22, s[32:35], s72 offen offset:2048 lds
    v_add_f32 v80, v80, v8
    v_add_f32 v82, v82, v9
    v_fmac_f32 v81, v8, v8
    v_fmac_f32 v83, v9, v9
    v_lshlrev_b32 v10, 16, v43
    v_and_b32 v11, s90, v43
    v_add_f32 v80, v80, v10
    v_add_f32 v82, v82, v11
    v_fmac_f32 v81, v10, v10
    v_fmac_f32 v83, v11, v11
    v_lshlrev_b32 v8, 16, v44
    v_and_b32 v9, s90, v44
    buffer_load_dwordx4 v23, s[32:35], s72 offen offset:3072 lds
    v_add_f32 v80, v80, v8
    v_add_f32 v82, v82, v9
    v_fmac_f32 v81, v8, v8
    v_fmac_f32 v83, v9, v9
    v_lshlrev_b32 v10, 16, v45
    v_and_b32 v11, s90, v45
    v_add_f32 v80, v80, v10
    v_add_f32 v82, v82, v11
    v_fmac_f32 v81, v10, v10
    v_fmac_f32 v83, v11, v11
    v_lshlrev_b32 v8, 16, v46
    v_and_b32 v9, s90, v46
    s_add_u32 m0, s70, 8192
    s_nop 0
    buffer_load_dwordx4 v24, s[32:35], s72 offen offset:0 lds
    v_add_f32 v80, v80, v8
    v_add_f32 v82, v82, v9
    v_fmac_f32 v81, v8, v8
    v_fmac_f32 v83, v9, v9
    v_lshlrev_b32 v10, 16, v47
    v_and_b32 v11, s90, v47
    v_add_f32 v80, v80, v10
    v_add_f32 v82, v82, v11
    v_fmac_f32 v81, v10, v10
    v_fmac_f32_e64 v83, v11, v11
    buffer_load_dwordx4 v25, s[32:35], s72 offen offset:1024 lds
    s_add_u32 s70, s70, 40960
    s_cmp_ge_u32 s70, 122880
    s_cselect_b32 s76, 122880, 0
    s_sub_u32 s70, s70, s76
    v_add_f32 v80, v80, v82
    v_add_f32 v81, v81, v83
    v_mov_b32 v82, v80
    v_mov_b32 v83, v81
    s_nop 0
    v_permlane32_swap_b32 v80, v82
    v_permlane32_swap_b32 v81, v83
    v_add_f32 v80, v80, v82
    v_add_f32_e64 v81, v81, v83
    s_mov_b32 exec_hi, 0
    buffer_store_dwordx2 v[80:81], v74, s[40:43], s79 offen offset:0 sc1
    s_mov_b64 exec, -1
    s_waitcnt vmcnt(11)
    s_branch L_hbar
L_evw:
    s_mul_i32 s79, s63, 2048
    s_add_u32 s79, s79, s78
    v_add_u32_e64 v4, s79, v73
    s_mul_i32 s79, s63, 20480
    s_add_u32 s79, s79, s78
    v_add_u32_e64 v5, s79, v73
    s_and_b32 s72, s84, 15
    s_mov_b32 m0, s70
    s_lshl_b32 s71, s72, 7
    buffer_load_dwordx4 v16, s[28:31], s71 offen offset:0 lds
    s_mul_i32 s72, s72, 393216
    s_lshr_b64 s[84:85], s[84:85], 4
    ds_read_b64_tr_b16 v[32:33], v4 offset:0
    ds_read_b64_tr_b16 v[34:35], v4 offset:512
    ds_read_b64_tr_b16 v[36:37], v4 offset:10240
    ds_read_b64_tr_b16 v[38:39], v4 offset:10752
    ds_read_b64_tr_b16 v[40:41], v4 offset:20480
    ds_read_b64_tr_b16 v[42:43], v4 offset:20992
    ds_read_b64_tr_b16 v[44:45], v4 offset:30720
    ds_read_b64_tr_b16 v[46:47], v4 offset:31232
    ds_read_b64_tr_b16 v[48:49], v5 offset:4096
    ds_read_b64_tr_b16 v[50:51], v5 offset:4608
    ds_read_b64_tr_b16 v[52:53], v5 offset:14336
    ds_read_b64_tr_b16 v[54:55], v5 offset:14848
    buffer_load_dwordx4 v17, s[28:31], s71 offen offset:1024 lds
    s_lshl_b32 s79, s64, 9
    s_lshl_b32 s80, s63, 3
    s_add_u32 s79, s79, s80
    s_add_u32 s79, s79, s73
    s_waitcnt lgkmcnt(0)
    v_lshlrev_b32 v80, 16, v32
    v_and_b32 v82, s90, v32
    v_lshlrev_b32 v10, 16, v33
    v_and_b32 v11, s90, v33
    v_add_f32 v80, v80, v10
    v_add_f32 v82, v82, v11
    v_lshlrev_b32 v8, 16, v34
    v_and_b32 v9, s90, v34
    v_add_f32 v80, v80, v8
    v_add_f32 v82, v82, v9
    v_lshlrev_b32 v10, 16, v35
    v_and_b32 v11, s90, v35
    buffer_load_dwordx4 v18, s[28:31], s71 offen offset:2048 lds
    v_add_f32 v80, v80, v10
    v_add_f32 v82, v82, v11
    v_lshlrev_b32 v8, 16, v36
    v_and_b32 v9, s90, v36
    v_add_f32 v80, v80, v8
    v_add_f32 v82, v82, v9
    v_lshlrev_b32 v10, 16, v37
    v_and_b32 v11, s90, v37
    v_add_f32 v80, v80, v10
    v_add_f32 v82, v82, v11
    v_lshlrev_b32 v8, 16, v38
    v_and_b32 v9, s90, v38
    buffer_load_dwordx4 v19, s[28:31], s71 offen offset:3072 lds
    v_add_f32 v80, v80, v8
    v_add_f32 v82, v82, v9
    v_lshlrev_b32 v10, 16, v39
    v_and_b32 v11, s90, v39
    v_add_f32 v80, v80, v10
    v_add_f32 v82, v82, v11
    v_lshlrev_b32 v8, 16, v40
    v_and_b32 v9, s90, v40
    v_add_f32 v80, v80, v8
    v_add_f32 v82, v82, v9
    v_lshlrev_b32 v10, 16, v41
    v_and_b32 v11, s90, v41
    s_add_u32 m0, s70, 4096
    s_nop 0
    buffer_load_dwordx4 v20, s[32:35], s72 offen offset:0 lds
    v_add_f32 v80, v80, v10
    v_add_f32 v82, v82, v11
    v_lshlrev_b32 v8, 16, v42
    v_and_b32 v9, s90, v42
    v_add_f32 v80, v80, v8
    v_add_f32 v82, v82, v9
    v_lshlrev_b32 v10, 16, v43
    v_and_b32 v11, s90, v43
    v_add_f32 v80, v80, v10
    v_add_f32 v82, v82, v11
    v_lshlrev_b32 v8, 16, v44
    v_and_b32_e64 v9, s90, v44
    buffer_load_dwordx4 v21, s[32:35], s72 offen offset:1024 lds
    v_add_f32 v80, v80, v8
    v_add_f32 v82, v82, v9
    v_lshlrev_b32 v10, 16, v45
    v_and_b32 v11, s90, v45
    v_add_f32 v80, v80, v10
    v_add_f32 v82, v82, v11
    v_lshlrev_b32 v8, 16, v46
    v_and_b32 v9, s90, v46
    v_add_f32 v80, v80, v8
    v_add_f32 v82, v82, v9
    v_lshlrev_b32 v10, 16, v47
    v_and_b32 v11, s90, v47
    buffer_load_dwordx4 v22, s[32:35], s72 offen offset:2048 lds
    v_add_f32 v80, v80, v10
    v_add_f32 v82, v82, v11
    v_lshlrev_b32 v81, 16, v48
    v_and_b32 v83, s90, v48
    v_lshlrev_b32 v10, 16, v49
    v_and_b32 v11, s90, v49
    v_add_f32 v81, v81, v10
    v_add_f32 v83, v83, v11
    v_lshlrev_b32 v8, 16, v50
    v_and_b32 v9, s90, v50
    v_add_f32 v81, v81, v8
    v_add_f32 v83, v83, v9
    buffer_load_dwordx4 v23, s[32:35], s72 offen offset:3072 lds
    v_lshlrev_b32 v10, 16, v51
    v_and_b32 v11, s90, v51
    v_add_f32 v81, v81, v10
    v_add_f32 v83, v83, v11
    v_lshlrev_b32 v8, 16, v52
    v_and_b32 v9, s90, v52
    v_add_f32 v81, v81, v8
    v_add_f32 v83, v83, v9
    v_lshlrev_b32 v10, 16, v53
    v_and_b32 v11, s90, v53
    v_add_f32 v81, v81, v10
    v_add_f32 v83, v83, v11
    s_add_u32 m0, s70, 8192
    s_nop 0
    buffer_load_dwordx4 v24, s[32:35], s72 offen offset:0 lds
    v_lshlrev_b32 v8, 16, v54
    v_and_b32 v9, s90, v54
    v_add_f32 v81, v81, v8
    v_add_f32 v83, v83, v9
    v_lshlrev_b32 v10, 16, v55
    v_and_b32 v11, s90, v55
    v_add_f32 v81, v81, v10
    v_add_f32_e64 v83, v83, v11
    buffer_load_dwordx4 v25, s[32:35], s72 offen offset:1024 lds
    s_add_u32 s70, s70, 40960
    s_cmp_ge_u32 s70, 122880
    s_cselect_b32 s76, 122880, 0
    s_sub_u32 s70, s70, s76
    v_add_f32 v80, v80, v82
    v_add_f32 v81, v81, v83
    v_mov_b32 v82, v80
    v_mov_b32 v83, v81
    s_nop 0
    v_permlane32_swap_b32 v80, v82
    v_permlane32_swap_b32 v81, v83
    v_add_f32 v80, v80, v82
    v_add_f32_e64 v81, v81, v83
    s_mov_b32 exec_hi, 0
    buffer_store_dwordx2 v[80:81], v12, s[40:43], s79 offen offset:1024 sc1
    s_mov_b64 exec, -1
    s_waitcnt vmcnt(11)
    s_branch L_hbar
L_compute:
    s_setprio 2
    s_and_b32 s63, s62, 1
    s_lshr_b32 s64, s62, 1
    s_lshl_b32 s73, s60, 4
    s_add_u32 s73, s73, s61
    s_mul_i32 s73, s73, 28800
    s_add_u32 s76, s2, 7
    s_and_b32 s76, s76, 7
    s_bfe_u32 s77, s2, 0x10003
    s_lshl1_add_u32 s97, s76, s77
    s_lshr_b32 s98, s2, 4
    s_lshl_b32 s99, s97, 4
    s_add_u32 s99, s99, s98
    s_mul_i32 s99, s99, 9344
    s_add_u32 s99, s99, 8388608
    s_lshr_b32 s65, s97, 1
    s_lshl_b32 s76, s97, 3
    s_add_u32 s65, s65, s76
    s_mul_i32 s76, s98, 4
    s_add_u32 s65, s65, s76
    s_and_b32 s65, s65, 15
    s_mov_b32 s89, 0x3f803f80
    s_mov_b32 s90, 0xffff0000
    v_and_b32 v2, 31, v1
    v_lshrrev_b32 v3, 5, v1
    v_lshlrev_b32 v12, 4, v1
    v_lshrrev_b32 v4, 3, v1
    v_mul_u32_u24 v13, 460800, v4
    v_and_b32_e64 v4, 7, v1
    v_lshl_add_u32 v13, v4, 4, v13
    v_and_b32 v10, 15, v1
    v_lshrrev_b32 v11, 4, v1
    s_mul_i32 s76, s63, 20480
    v_lshrrev_b32 v4, 1, v10
    v_xor_b32 v4, v4, v11
    v_lshlrev_b32_e64 v4, 4, v4
    v_lshl_add_u32 v4, v10, 7, v4
    v_add_u32 v192, s76, v4
    v_xor_b32 v193, 64, v192
    v_bfe_u32 v4, v1, 2, 2
    v_and_b32_e64 v6, 1, v11
    v_lshl_add_u32 v5, v6, 3, v4
    v_lshlrev_b32 v5, 7, v5
    v_lshrrev_b32 v4, 1, v4
    v_xor_b32_e64 v4, s64, v4
    v_lshl_add_u32 v5, v4, 6, v5
    v_lshl_add_u32 v5, v6, 5, v5
    v_and_b32_e64 v4, 3, v1
    v_lshl_add_u32 v5, v4, 3, v5
    v_mul_u32_u24 v4, 10240, v3
    v_add_u32_e64 v5, v5, v4
    v_add_u32 v194, 4096, v5
    v_xor_b32_e64 v195, 32, v194
    v_add_u32 v196, 40960, v192
    v_add_u32 v197, 40960, v193
    v_add_u32 v198, 40960, v194
    v_add_u32 v199, 40960, v195
    v_add_u32 v200, 81920, v192
    v_add_u32 v201, 81920, v193
    v_add_u32 v202, 81920, v194
    v_add_u32 v203, 81920, v195
    v_bfe_u32 v4, v1, 2, 2
    v_lshl_add_u32 v4, v3, 3, v4
    v_lshlrev_b32 v4, 6, v4
    v_and_b32 v5, 1, v11
    v_lshl_add_u32 v4, v5, 5, v4
    v_and_b32_e64 v5, 3, v1
    v_lshl_add_u32 v4, v5, 3, v4
    s_lshl_b32 s76, s64, 11
    s_add_u32 s76, s76, 122880
    v_add_u32_e64 v212, s76, v4
    s_lshl_b32 s76, s63, 9
    v_lshl_add_u32 v213, v10, 3, s76
    v_lshl_add_u32 v214, v2, 3, s76
    s_lshl_b32 s76, s64, 8
    v_lshl_add_u32 v215, v10, 3, s76
    v_bfe_u32 v4, v10, 1, 1
    v_xor_b32 v4, s64, v4
    v_lshrrev_b32 v5, 2, v10
    v_xor_b32 v5, v5, v3
    v_xor_b32 v6, v10, v11
    v_and_b32 v6, 1, v6
    v_lshlrev_b32_e64 v4, 6, v4
    v_lshl_add_u32 v4, v5, 4, v4
    v_lshl_add_u32 v4, v6, 3, v4
    v_lshl_add_u32 v4, v10, 7, v4
    s_lshl_b32 s76, s63, 13
    v_add_u32 v216, s76, v4
    v_bfe_u32 v4, v2, 1, 1
    v_bfe_u32 v5, v2, 2, 2
    v_and_b32 v6, 1, v2
    v_xor_b32 v6, v6, v3
    v_lshlrev_b32_e64 v4, 6, v4
    v_lshl_add_u32 v4, v5, 4, v4
    v_lshl_add_u32 v4, v6, 3, v4
    v_lshl_add_u32 v4, v2, 7, v4
    s_lshl_b32 s77, s64, 14
    s_add_u32 s76, s76, s77
    v_add_u32_e64 v217, s76, v4
    v_bfe_u32 v4, v1, 2, 2
    v_lshl_add_u32 v5, v3, 3, v4
    v_lshlrev_b32 v5, 7, v5
    v_lshrrev_b32 v6, 1, v4
    v_lshl_add_u32 v5, v6, 6, v5
    v_bfe_u32 v6, v1, 4, 1
    v_xor_b32_e64 v6, v6, v3
    v_lshl_add_u32 v5, v6, 5, v5
    v_bfe_u32 v6, v1, 1, 1
    v_lshl_add_u32 v5, v6, 4, v5
    v_xor_b32 v6, v1, v4
    v_and_b32 v6, 1, v6
    v_lshl_add_u32 v5, v6, 3, v5
    s_lshl_b32 s76, s63, 13
    v_xor_b32 v5, s76, v5
    s_lshl_b32 s76, s63, 6
    s_or_b32 s76, s76, s77
    v_xor_b32 v218, s76, v5
    s_lshl_b32 s76, s64, 6
    v_xor_b32_e64 v220, s76, v5
    v_xor_b32 v219, 528, v218
    v_xor_b32 v221, 528, v220
    v_cmp_gt_u32 s[86:87], 16, v1
    s_waitcnt lgkmcnt(0)
    s_mov_b32 s40, s26
    s_and_b32 s41, s27, 0xffff
    s_mov_b32 s42, 33554432
    s_mov_b32 s43, 0x20000
    s_mov_b32 s44, s22
    s_and_b32 s45, s23, 0xffff
    s_mov_b32 s46, 4194304
    s_mov_b32 s47, 0x20000
    s_mov_b32 s68, 0
    s_getreg_b32 s101, hwreg(HW_REG_XCC_ID, 0, 4)
    v_mov_b32 v9, 13631488
    s_lshl_b32 s76, s61, 8
    s_lshl4_add_u32 s76, s60, s76
    s_add_u32 s76, s76, 12582912
    v_mov_b32 v8, s76
    s_lshl_b32 s76, s60, 8
    s_lshl4_add_u32 s76, s61, s76
    s_add_u32 s76, s76, 12587008
    v_writelane_b32 v8, s76, 1
    s_lshl_b32 s76, s97, 8
    s_lshl4_add_u32 s76, s98, s76
    s_add_u32 s76, s76, 12591104
    v_writelane_b32 v8, s76, 2
    v_mov_b32 v6, s101
    v_mov_b32 v7, 0
    v_mov_b32_e64 v10, 0
    s_cmp_eq_u32 s62, 0
    s_cbranch_scc0 L_noep
    buffer_load_dwordx2 v[4:5], v9, s[40:43], 0 offen
L_noep:
    s_barrier
    ds_read_b128 v[112:115], v192 offset:0
    ds_read_b64_tr_b16 v[128:129], v194 offset:0
    ds_read_b64_tr_b16 v[130:131], v194 offset:512
    ds_read_b128 v[116:119], v192 offset:2048
    ds_read_b128 v[120:123], v192 offset:10240
    ds_read_b128 v[124:127], v192 offset:12288
    ds_read_b64_tr_b16 v[132:133], v195 offset:0
    ds_read_b64_tr_b16 v[134:135], v195 offset:512
    ds_read_b64_tr_b16 v[136:137], v194 offset:2048
    ds_read_b64_tr_b16 v[138:139], v194 offset:2560
    ds_read_b64_tr_b16 v[140:141], v195 offset:2048
    ds_read_b64_tr_b16 v[142:143], v195 offset:2560
    ds_read_b64_tr_b16 v[144:145], v194 offset:4096
    ds_read_b64_tr_b16 v[146:147], v194 offset:4608
    s_waitcnt lgkmcnt(8)
    ds_read_b64_tr_b16 v[148:149], v195 offset:4096
    ds_read_b64_tr_b16 v[150:151], v195 offset:4608
    v_mfma_f32_16x16x32_bf16 v[16:19], v[128:131], v[112:115], 0
    ds_read_b128 v[152:155], v193 offset:0
    v_mfma_f32_16x16x32_bf16 v[20:23], v[128:131], v[116:119], 0
    ds_read_b64_tr_b16 v[168:169], v194 offset:20480
    v_mfma_f32_16x16x32_bf16 v[24:27], v[128:131], v[120:123], 0
    ds_read_b64_tr_b16 v[170:171], v194 offset:20992
    v_mfma_f32_16x16x32_bf16 v[28:31], v[128:131], v[124:127], 0
    ds_read_b128 v[156:159], v193 offset:2048
    s_waitcnt lgkmcnt(4)
    v_mfma_f32_16x16x32_bf16 v[32:35], v[132:135], v[112:115], 0
    ds_read_b128 v[160:163], v193 offset:10240
    v_mfma_f32_16x16x32_bf16 v[36:39], v[132:135], v[116:119], 0
    ds_read_b128 v[164:167], v193 offset:12288
    v_mfma_f32_16x16x32_bf16 v[40:43], v[132:135], v[120:123], 0
    ds_read_b64_tr_b16 v[172:173], v195 offset:20480
    v_mfma_f32_16x16x32_bf16 v[44:47], v[132:135], v[124:127], 0
    ds_read_b64_tr_b16 v[174:175], v195 offset:20992
    v_mfma_f32_16x16x32_bf16 v[48:51], v[136:139], v[112:115], 0
    ds_read_b64_tr_b16 v[176:177], v194 offset:22528
    v_mfma_f32_16x16x32_bf16 v[52:55], v[136:139], v[116:119], 0
    ds_read_b64_tr_b16 v[178:179], v194 offset:23040
    v_mfma_f32_16x16x32_bf16 v[56:59], v[136:139], v[120:123], 0
    ds_read_b64_tr_b16 v[180:181], v195 offset:22528
    v_mfma_f32_16x16x32_bf16 v[60:63], v[136:139], v[124:127], 0
    ds_read_b64_tr_b16 v[182:183], v195 offset:23040
    v_mfma_f32_16x16x32_bf16 v[64:67], v[140:143], v[112:115], 0
    ds_read_b64_tr_b16 v[184:185], v194 offset:24576
    v_mfma_f32_16x16x32_bf16 v[68:71], v[140:143], v[116:119], 0
    ds_read_b64_tr_b16 v[186:187], v194 offset:25088
    v_mfma_f32_16x16x32_bf16 v[72:75], v[140:143], v[120:123], 0
    ds_read_b64_tr_b16 v[188:189], v195 offset:24576
    v_mfma_f32_16x16x32_bf16 v[76:79], v[140:143], v[124:127], 0
    ds_read_b64_tr_b16 v[190:191], v195 offset:25088
    v_mfma_f32_16x16x32_bf16 v[80:83], v[144:147], v[112:115], 0
    v_mfma_f32_16x16x32_bf16 v[84:87], v[144:147], v[116:119], 0
    v_mfma_f32_16x16x32_bf16 v[88:91], v[144:147], v[120:123], 0
    v_mfma_f32_16x16x32_bf16 v[92:95], v[144:147], v[124:127], 0
    v_mfma_f32_16x16x32_bf16 v[96:99], v[148:151], v[112:115], 0
    v_mfma_f32_16x16x32_bf16 v[100:103], v[148:151], v[116:119], 0
    v_mfma_f32_16x16x32_bf16 v[104:107], v[148:151], v[120:123], 0
    v_mfma_f32_16x16x32_bf16 v[108:111], v[148:151], v[124:127], 0
    s_waitcnt lgkmcnt(0)
    v_mfma_f32_16x16x32_bf16 v[16:19], v[168:171], v[152:155], v[16:19]
    s_barrier
    v_mfma_f32_16x16x32_bf16 v[20:23], v[168:171], v[156:159], v[20:23]
    ds_read_b128 v[112:115], v196 offset:0
    ds_read_b64_tr_b16 v[204:205], v212 offset:0
    ds_read_b64_tr_b16 v[206:207], v212 offset:256
    ds_read_b64_tr_b16 v[208:209], v212 offset:1024
    ds_read_b64_tr_b16 v[210:211], v212 offset:1280
    v_mfma_f32_16x16x32_bf16 v[24:27], v[168:171], v[160:163], v[24:27]
    ds_read_b64_tr_b16 v[128:129], v198 offset:0
    s_cmp_eq_u32 s62, 0
    s_cbranch_scc0 L_cloop
    s_waitcnt vmcnt(0)
    v_add_co_u32 v4, vcc, 1, v4
    s_nop 1
    v_addc_co_u32 v5, vcc, 0, v5, vcc
    s_mov_b64 exec, 7
    buffer_store_dwordx4 v[4:7], v8, s[40:43], 0 offen sc1
    s_mov_b64 exec, -1
.p2align 3
L_cloop:
    v_mfma_f32_16x16x32_bf16 v[28:31], v[168:171], v[164:167], v[28:31]
    ds_read_b64_tr_b16 v[130:131], v198 offset:512
    v_mfma_f32_16x16x32_bf16 v[32:35], v[172:175], v[152:155], v[32:35]
    ds_read_b128 v[116:119], v196 offset:2048
    v_mfma_f32_16x16x32_bf16 v[36:39], v[172:175], v[156:159], v[36:39]
    ds_read_b128 v[120:123], v196 offset:10240
    v_mfma_f32_16x16x32_bf16 v[40:43], v[172:175], v[160:163], v[40:43]
    ds_read_b128 v[124:127], v196 offset:12288
    v_mfma_f32_16x16x32_bf16 v[44:47], v[172:175], v[164:167], v[44:47]
    ds_read_b64_tr_b16 v[132:133], v199 offset:0
    v_mfma_f32_16x16x32_bf16 v[48:51], v[176:179], v[152:155], v[48:51]
    ds_read_b64_tr_b16 v[134:135], v199 offset:512
    v_mfma_f32_16x16x32_bf16 v[52:55], v[176:179], v[156:159], v[52:55]
    ds_read_b64_tr_b16 v[136:137], v198 offset:2048
    v_mfma_f32_16x16x32_bf16 v[56:59], v[176:179], v[160:163], v[56:59]
    ds_read_b64_tr_b16 v[138:139], v198 offset:2560
    v_mfma_f32_16x16x32_bf16 v[60:63], v[176:179], v[164:167], v[60:63]
    ds_read_b64_tr_b16 v[140:141], v199 offset:2048
    v_mfma_f32_16x16x32_bf16 v[64:67], v[180:183], v[152:155], v[64:67]
    ds_read_b64_tr_b16 v[142:143], v199 offset:2560
    v_mfma_f32_16x16x32_bf16 v[68:71], v[180:183], v[156:159], v[68:71]
    ds_read_b64_tr_b16 v[144:145], v198 offset:4096
    v_mfma_f32_16x16x32_bf16 v[72:75], v[180:183], v[160:163], v[72:75]
    ds_read_b64_tr_b16 v[146:147], v198 offset:4608
    v_mfma_f32_16x16x32_bf16 v[76:79], v[180:183], v[164:167], v[76:79]
    ds_read_b64_tr_b16 v[148:149], v199 offset:4096
    v_mfma_f32_16x16x32_bf16 v[80:83], v[184:187], v[152:155], v[80:83]
    ds_read_b64_tr_b16 v[150:151], v199 offset:4608
    v_mfma_f32_16x16x32_bf16 v[84:87], v[184:187], v[156:159], v[84:87]
    v_mfma_f32_16x16x32_bf16 v[88:91], v[184:187], v[160:163], v[88:91]
    v_mfma_f32_16x16x32_bf16 v[92:95], v[184:187], v[164:167], v[92:95]
    v_mfma_f32_16x16x32_bf16 v[96:99], v[188:191], v[152:155], v[96:99]
    v_mfma_f32_16x16x32_bf16 v[100:103], v[188:191], v[156:159], v[100:103]
    v_mfma_f32_16x16x32_bf16 v[104:107], v[188:191], v[160:163], v[104:107]
    v_mfma_f32_16x16x32_bf16 v[108:111], v[188:191], v[164:167], v[108:111]
    s_waitcnt lgkmcnt(0)
    v_mfma_f32_16x16x32_bf16 v[16:19], v[128:131], v[112:115], v[16:19]
    ds_read_b128 v[152:155], v197 offset:0
    v_mfma_f32_16x16x32_bf16 v[20:23], v[128:131], v[116:119], v[20:23]
    ds_read_b64_tr_b16 v[168:169], v198 offset:20480
    v_mfma_f32_16x16x32_bf16 v[24:27], v[128:131], v[120:123], v[24:27]
    ds_read_b64_tr_b16 v[170:171], v198 offset:20992
    v_mfma_f32_16x16x32_bf16 v[28:31], v[128:131], v[124:127], v[28:31]
    ds_read_b128 v[156:159], v197 offset:2048
    v_mfma_f32_16x16x32_bf16 v[32:35], v[132:135], v[112:115], v[32:35]
    ds_read_b128 v[160:163], v197 offset:10240
    v_mfma_f32_16x16x32_bf16 v[36:39], v[132:135], v[116:119], v[36:39]
    ds_read_b128 v[164:167], v197 offset:12288
    v_mfma_f32_16x16x32_bf16 v[40:43], v[132:135], v[120:123], v[40:43]
    ds_read_b64_tr_b16 v[172:173], v199 offset:20480
    v_mfma_f32_16x16x32_bf16 v[44:47], v[132:135], v[124:127], v[44:47]
    ds_read_b64_tr_b16 v[174:175], v199 offset:20992
    v_mfma_f32_16x16x32_bf16 v[48:51], v[136:139], v[112:115], v[48:51]
    ds_read_b64_tr_b16 v[176:177], v198 offset:22528
    v_mfma_f32_16x16x32_bf16 v[52:55], v[136:139], v[116:119], v[52:55]
    ds_read_b64_tr_b16 v[178:179], v198 offset:23040
    v_mfma_f32_16x16x32_bf16 v[56:59], v[136:139], v[120:123], v[56:59]
    ds_read_b64_tr_b16 v[180:181], v199 offset:22528
    v_mfma_f32_16x16x32_bf16 v[60:63], v[136:139], v[124:127], v[60:63]
    ds_read_b64_tr_b16 v[182:183], v199 offset:23040
    v_mfma_f32_16x16x32_bf16 v[64:67], v[140:143], v[112:115], v[64:67]
    ds_read_b64_tr_b16 v[184:185], v198 offset:24576
    v_mfma_f32_16x16x32_bf16 v[68:71], v[140:143], v[116:119], v[68:71]
    ds_read_b64_tr_b16 v[186:187], v198 offset:25088
    v_mfma_f32_16x16x32_bf16 v[72:75], v[140:143], v[120:123], v[72:75]
    ds_read_b64_tr_b16 v[188:189], v199 offset:24576
    v_mfma_f32_16x16x32_bf16 v[76:79], v[140:143], v[124:127], v[76:79]
    ds_read_b64_tr_b16 v[190:191], v199 offset:25088
    v_mfma_f32_16x16x32_bf16 v[80:83], v[144:147], v[112:115], v[80:83]
    v_mfma_f32_16x16x32_bf16 v[84:87], v[144:147], v[116:119], v[84:87]
    v_mfma_f32_16x16x32_bf16 v[88:91], v[144:147], v[120:123], v[88:91]
    v_mfma_f32_16x16x32_bf16 v[92:95], v[144:147], v[124:127], v[92:95]
    v_mfma_f32_16x16x32_bf16 v[96:99], v[148:151], v[112:115], v[96:99]
    v_mfma_f32_16x16x32_bf16 v[100:103], v[148:151], v[116:119], v[100:103]
    v_mfma_f32_16x16x32_bf16 v[104:107], v[148:151], v[120:123], v[104:107]
    v_mfma_f32_16x16x32_bf16 v[108:111], v[148:151], v[124:127], v[108:111]
    s_waitcnt lgkmcnt(0)
    v_mfma_f32_16x16x32_bf16 v[16:19], v[168:171], v[152:155], v[16:19]
    s_barrier
    v_mfma_f32_16x16x32_bf16 v[20:23], v[168:171], v[156:159], v[20:23]
    ds_read_b128 v[112:115], v200 offset:0
    v_mfma_f32_16x16x32_bf16 v[24:27], v[168:171], v[160:163], v[24:27]
    ds_read_b64_tr_b16 v[128:129], v202 offset:0
    v_mfma_f32_16x16x32_bf16 v[28:31], v[168:171], v[164:167], v[28:31]
    ds_read_b64_tr_b16 v[130:131], v202 offset:512
    v_mfma_f32_16x16x32_bf16 v[32:35], v[172:175], v[152:155], v[32:35]
    ds_read_b128 v[116:119], v200 offset:2048
    v_mfma_f32_16x16x32_bf16 v[36:39], v[172:175], v[156:159], v[36:39]
    ds_read_b128 v[120:123], v200 offset:10240
    v_mfma_f32_16x16x32_bf16 v[40:43], v[172:175], v[160:163], v[40:43]
    ds_read_b128 v[124:127], v200 offset:12288
    v_mfma_f32_16x16x32_bf16 v[44:47], v[172:175], v[164:167], v[44:47]
    ds_read_b64_tr_b16 v[132:133], v203 offset:0
    v_mfma_f32_16x16x32_bf16 v[48:51], v[176:179], v[152:155], v[48:51]
    ds_read_b64_tr_b16 v[134:135], v203 offset:512
    v_mfma_f32_16x16x32_bf16 v[52:55], v[176:179], v[156:159], v[52:55]
    ds_read_b64_tr_b16 v[136:137], v202 offset:2048
    v_mfma_f32_16x16x32_bf16 v[56:59], v[176:179], v[160:163], v[56:59]
    ds_read_b64_tr_b16 v[138:139], v202 offset:2560
    v_mfma_f32_16x16x32_bf16 v[60:63], v[176:179], v[164:167], v[60:63]
    ds_read_b64_tr_b16 v[140:141], v203 offset:2048
    v_mfma_f32_16x16x32_bf16 v[64:67], v[180:183], v[152:155], v[64:67]
    ds_read_b64_tr_b16 v[142:143], v203 offset:2560
    v_mfma_f32_16x16x32_bf16 v[68:71], v[180:183], v[156:159], v[68:71]
    ds_read_b64_tr_b16 v[144:145], v202 offset:4096
    v_mfma_f32_16x16x32_bf16 v[72:75], v[180:183], v[160:163], v[72:75]
    ds_read_b64_tr_b16 v[146:147], v202 offset:4608
    v_mfma_f32_16x16x32_bf16 v[76:79], v[180:183], v[164:167], v[76:79]
    ds_read_b64_tr_b16 v[148:149], v203 offset:4096
    v_mfma_f32_16x16x32_bf16 v[80:83], v[184:187], v[152:155], v[80:83]
    ds_read_b64_tr_b16 v[150:151], v203 offset:4608
    v_mfma_f32_16x16x32_bf16 v[84:87], v[184:187], v[156:159], v[84:87]
    v_mfma_f32_16x16x32_bf16 v[88:91], v[184:187], v[160:163], v[88:91]
    v_mfma_f32_16x16x32_bf16 v[92:95], v[184:187], v[164:167], v[92:95]
    v_mfma_f32_16x16x32_bf16 v[96:99], v[188:191], v[152:155], v[96:99]
    v_mfma_f32_16x16x32_bf16 v[100:103], v[188:191], v[156:159], v[100:103]
    v_mfma_f32_16x16x32_bf16 v[104:107], v[188:191], v[160:163], v[104:107]
    v_mfma_f32_16x16x32_bf16 v[108:111], v[188:191], v[164:167], v[108:111]
    s_waitcnt lgkmcnt(0)
    v_mfma_f32_16x16x32_bf16 v[16:19], v[128:131], v[112:115], v[16:19]
    ds_read_b128 v[152:155], v201 offset:0
    v_mfma_f32_16x16x32_bf16 v[20:23], v[128:131], v[116:119], v[20:23]
    ds_read_b64_tr_b16 v[168:169], v202 offset:20480
    v_mfma_f32_16x16x32_bf16 v[24:27], v[128:131], v[120:123], v[24:27]
    ds_read_b64_tr_b16 v[170:171], v202 offset:20992
    v_mfma_f32_16x16x32_bf16 v[28:31], v[128:131], v[124:127], v[28:31]
    ds_read_b128 v[156:159], v201 offset:2048
    v_mfma_f32_16x16x32_bf16 v[32:35], v[132:135], v[112:115], v[32:35]
    ds_read_b128 v[160:163], v201 offset:10240
    v_mfma_f32_16x16x32_bf16 v[36:39], v[132:135], v[116:119], v[36:39]
    ds_read_b128 v[164:167], v201 offset:12288
    v_mfma_f32_16x16x32_bf16 v[40:43], v[132:135], v[120:123], v[40:43]
    ds_read_b64_tr_b16 v[172:173], v203 offset:20480
    v_mfma_f32_16x16x32_bf16 v[44:47], v[132:135], v[124:127], v[44:47]
    ds_read_b64_tr_b16 v[174:175], v203 offset:20992
    v_mfma_f32_16x16x32_bf16 v[48:51], v[136:139], v[112:115], v[48:51]
    ds_read_b64_tr_b16 v[176:177], v202 offset:22528
    v_mfma_f32_16x16x32_bf16 v[52:55], v[136:139], v[116:119], v[52:55]
    ds_read_b64_tr_b16 v[178:179], v202 offset:23040
    v_mfma_f32_16x16x32_bf16 v[56:59], v[136:139], v[120:123], v[56:59]
    ds_read_b64_tr_b16 v[180:181], v203 offset:22528
    v_mfma_f32_16x16x32_bf16 v[60:63], v[136:139], v[124:127], v[60:63]
    ds_read_b64_tr_b16 v[182:183], v203 offset:23040
    v_mfma_f32_16x16x32_bf16 v[64:67], v[140:143], v[112:115], v[64:67]
    ds_read_b64_tr_b16 v[184:185], v202 offset:24576
    v_mfma_f32_16x16x32_bf16 v[68:71], v[140:143], v[116:119], v[68:71]
    ds_read_b64_tr_b16 v[186:187], v202 offset:25088
    v_mfma_f32_16x16x32_bf16 v[72:75], v[140:143], v[120:123], v[72:75]
    ds_read_b64_tr_b16 v[188:189], v203 offset:24576
    v_mfma_f32_16x16x32_bf16 v[76:79], v[140:143], v[124:127], v[76:79]
    ds_read_b64_tr_b16 v[190:191], v203 offset:25088
    v_mfma_f32_16x16x32_bf16 v[80:83], v[144:147], v[112:115], v[80:83]
    v_mfma_f32_16x16x32_bf16 v[84:87], v[144:147], v[116:119], v[84:87]
    v_mfma_f32_16x16x32_bf16 v[88:91], v[144:147], v[120:123], v[88:91]
    v_mfma_f32_16x16x32_bf16 v[92:95], v[144:147], v[124:127], v[92:95]
    v_mfma_f32_16x16x32_bf16 v[96:99], v[148:151], v[112:115], v[96:99]
    v_mfma_f32_16x16x32_bf16 v[100:103], v[148:151], v[116:119], v[100:103]
    v_mfma_f32_16x16x32_bf16 v[104:107], v[148:151], v[120:123], v[104:107]
    v_mfma_f32_16x16x32_bf16 v[108:111], v[148:151], v[124:127], v[108:111]
    s_waitcnt lgkmcnt(0)
    v_mfma_f32_16x16x32_bf16 v[16:19], v[168:171], v[152:155], v[16:19]
    s_barrier
    v_mfma_f32_16x16x32_bf16 v[20:23], v[168:171], v[156:159], v[20:23]
    ds_read_b128 v[112:115], v192 offset:0
    v_mfma_f32_16x16x32_bf16 v[24:27], v[168:171], v[160:163], v[24:27]
    ds_read_b64_tr_b16 v[128:129], v194 offset:0
    v_mfma_f32_16x16x32_bf16 v[28:31], v[168:171], v[164:167], v[28:31]
    ds_read_b64_tr_b16 v[130:131], v194 offset:512
    v_mfma_f32_16x16x32_bf16 v[32:35], v[172:175], v[152:155], v[32:35]
    ds_read_b128 v[116:119], v192 offset:2048
    v_mfma_f32_16x16x32_bf16 v[36:39], v[172:175], v[156:159], v[36:39]
    ds_read_b128 v[120:123], v192 offset:10240
    v_mfma_f32_16x16x32_bf16 v[40:43], v[172:175], v[160:163], v[40:43]
    ds_read_b128 v[124:127], v192 offset:12288
    v_mfma_f32_16x16x32_bf16 v[44:47], v[172:175], v[164:167], v[44:47]
    ds_read_b64_tr_b16 v[132:133], v195 offset:0
    v_mfma_f32_16x16x32_bf16 v[48:51], v[176:179], v[152:155], v[48:51]
    ds_read_b64_tr_b16 v[134:135], v195 offset:512
    v_mfma_f32_16x16x32_bf16 v[52:55], v[176:179], v[156:159], v[52:55]
    ds_read_b64_tr_b16 v[136:137], v194 offset:2048
    v_mfma_f32_16x16x32_bf16 v[56:59], v[176:179], v[160:163], v[56:59]
    ds_read_b64_tr_b16 v[138:139], v194 offset:2560
    v_mfma_f32_16x16x32_bf16 v[60:63], v[176:179], v[164:167], v[60:63]
    ds_read_b64_tr_b16 v[140:141], v195 offset:2048
    v_mfma_f32_16x16x32_bf16 v[64:67], v[180:183], v[152:155], v[64:67]
    ds_read_b64_tr_b16 v[142:143], v195 offset:2560
    v_mfma_f32_16x16x32_bf16 v[68:71], v[180:183], v[156:159], v[68:71]
    ds_read_b64_tr_b16 v[144:145], v194 offset:4096
    v_mfma_f32_16x16x32_bf16 v[72:75], v[180:183], v[160:163], v[72:75]
    ds_read_b64_tr_b16 v[146:147], v194 offset:4608
    v_mfma_f32_16x16x32_bf16 v[76:79], v[180:183], v[164:167], v[76:79]
    ds_read_b64_tr_b16 v[148:149], v195 offset:4096
    v_mfma_f32_16x16x32_bf16 v[80:83], v[184:187], v[152:155], v[80:83]
    ds_read_b64_tr_b16 v[150:151], v195 offset:4608
    v_mfma_f32_16x16x32_bf16 v[84:87], v[184:187], v[156:159], v[84:87]
    v_mfma_f32_16x16x32_bf16 v[88:91], v[184:187], v[160:163], v[88:91]
    v_mfma_f32_16x16x32_bf16 v[92:95], v[184:187], v[164:167], v[92:95]
    v_mfma_f32_16x16x32_bf16 v[96:99], v[188:191], v[152:155], v[96:99]
    v_mfma_f32_16x16x32_bf16 v[100:103], v[188:191], v[156:159], v[100:103]
    v_mfma_f32_16x16x32_bf16 v[104:107], v[188:191], v[160:163], v[104:107]
    v_mfma_f32_16x16x32_bf16 v[108:111], v[188:191], v[164:167], v[108:111]
    s_waitcnt lgkmcnt(0)
    v_mfma_f32_16x16x32_bf16 v[16:19], v[128:131], v[112:115], v[16:19]
    ds_read_b128 v[152:155], v193 offset:0
    v_mfma_f32_16x16x32_bf16 v[20:23], v[128:131], v[116:119], v[20:23]
    ds_read_b64_tr_b16 v[168:169], v194 offset:20480
    v_mfma_f32_16x16x32_bf16 v[24:27], v[128:131], v[120:123], v[24:27]
    ds_read_b64_tr_b16 v[170:171], v194 offset:20992
    v_mfma_f32_16x16x32_bf16 v[28:31], v[128:131], v[124:127], v[28:31]
    ds_read_b128 v[156:159], v193 offset:2048
    v_mfma_f32_16x16x32_bf16 v[32:35], v[132:135], v[112:115], v[32:35]
    ds_read_b128 v[160:163], v193 offset:10240
    v_mfma_f32_16x16x32_bf16 v[36:39], v[132:135], v[116:119], v[36:39]
    ds_read_b128 v[164:167], v193 offset:12288
    v_mfma_f32_16x16x32_bf16 v[40:43], v[132:135], v[120:123], v[40:43]
    ds_read_b64_tr_b16 v[172:173], v195 offset:20480
    v_mfma_f32_16x16x32_bf16 v[44:47], v[132:135], v[124:127], v[44:47]
    ds_read_b64_tr_b16 v[174:175], v195 offset:20992
    v_mfma_f32_16x16x32_bf16 v[48:51], v[136:139], v[112:115], v[48:51]
    ds_read_b64_tr_b16 v[176:177], v194 offset:22528
    v_mfma_f32_16x16x32_bf16 v[52:55], v[136:139], v[116:119], v[52:55]
    ds_read_b64_tr_b16 v[178:179], v194 offset:23040
    v_mfma_f32_16x16x32_bf16 v[56:59], v[136:139], v[120:123], v[56:59]
    ds_read_b64_tr_b16 v[180:181], v195 offset:22528
    v_mfma_f32_16x16x32_bf16 v[60:63], v[136:139], v[124:127], v[60:63]
    ds_read_b64_tr_b16 v[182:183], v195 offset:23040
    v_mfma_f32_16x16x32_bf16 v[64:67], v[140:143], v[112:115], v[64:67]
    ds_read_b64_tr_b16 v[184:185], v194 offset:24576
    v_mfma_f32_16x16x32_bf16 v[68:71], v[140:143], v[116:119], v[68:71]
    ds_read_b64_tr_b16 v[186:187], v194 offset:25088
    v_mfma_f32_16x16x32_bf16 v[72:75], v[140:143], v[120:123], v[72:75]
    ds_read_b64_tr_b16 v[188:189], v195 offset:24576
    v_mfma_f32_16x16x32_bf16 v[76:79], v[140:143], v[124:127], v[76:79]
    ds_read_b64_tr_b16 v[190:191], v195 offset:25088
    v_mfma_f32_16x16x32_bf16 v[80:83], v[144:147], v[112:115], v[80:83]
    v_mfma_f32_16x16x32_bf16 v[84:87], v[144:147], v[116:119], v[84:87]
    v_mfma_f32_16x16x32_bf16 v[88:91], v[144:147], v[120:123], v[88:91]
    v_mfma_f32_16x16x32_bf16 v[92:95], v[144:147], v[124:127], v[92:95]
    v_mfma_f32_16x16x32_bf16 v[96:99], v[148:151], v[112:115], v[96:99]
    s_add_u32 s68, s68, 1
    s_cmp_lt_u32 s68, 5
    v_mfma_f32_16x16x32_bf16 v[100:103], v[148:151], v[116:119], v[100:103]
    v_mfma_f32_16x16x32_bf16 v[104:107], v[148:151], v[120:123], v[104:107]
    v_mfma_f32_16x16x32_bf16 v[108:111], v[148:151], v[124:127], v[108:111]
    s_waitcnt lgkmcnt(0)
    v_mfma_f32_16x16x32_bf16 v[16:19], v[168:171], v[152:155], v[16:19]
    s_cbranch_scc0 L_cexit
    s_barrier
    v_mfma_f32_16x16x32_bf16 v[20:23], v[168:171], v[156:159], v[20:23]
    ds_read_b128 v[112:115], v196 offset:0
    v_mfma_f32_16x16x32_bf16 v[24:27], v[168:171], v[160:163], v[24:27]
    ds_read_b64_tr_b16 v[128:129], v198 offset:0
    s_branch L_cloop
L_cexit:
    v_mfma_f32_16x16x32_bf16 v[20:23], v[168:171], v[156:159], v[20:23]
    v_mfma_f32_16x16x32_bf16 v[24:27], v[168:171], v[160:163], v[24:27]
    v_mfma_f32_16x16x32_bf16 v[28:31], v[168:171], v[164:167], v[28:31]
    v_mfma_f32_16x16x32_bf16 v[32:35], v[172:175], v[152:155], v[32:35]
    v_mfma_f32_16x16x32_bf16 v[36:39], v[172:175], v[156:159], v[36:39]
    v_mfma_f32_16x16x32_bf16 v[40:43], v[172:175], v[160:163], v[40:43]
    v_mfma_f32_16x16x32_bf16 v[44:47], v[172:175], v[164:167], v[44:47]
    v_mfma_f32_16x16x32_bf16 v[48:51], v[176:179], v[152:155], v[48:51]
    v_mfma_f32_16x16x32_bf16 v[52:55], v[176:179], v[156:159], v[52:55]
    v_mfma_f32_16x16x32_bf16 v[56:59], v[176:179], v[160:163], v[56:59]
    s_barrier
    ds_read_b32 v11, v10 offset:53248
    ds_read_b64 v[222:223], v213 offset:49152
    ds_read_b64 v[224:225], v213 offset:49280
    v_mfma_f32_16x16x32_bf16 v[60:63], v[176:179], v[164:167], v[60:63]
    ds_read_b64 v[226:227], v213 offset:49408
    ds_read_b64 v[228:229], v213 offset:49536
    v_mfma_f32_16x16x32_bf16 v[64:67], v[180:183], v[152:155], v[64:67]
    ds_read_b64 v[238:239], v215 offset:50176
    ds_read_b64 v[240:241], v215 offset:50304
    v_mfma_f32_16x16x32_bf16 v[68:71], v[180:183], v[156:159], v[68:71]
    ds_read_b64 v[242:243], v215 offset:50688
    ds_read_b64 v[244:245], v215 offset:50816
    v_mfma_f32_16x16x32_bf16 v[72:75], v[180:183], v[160:163], v[72:75]
    ds_read_b64 v[246:247], v215 offset:51200
    ds_read_b64 v[248:249], v215 offset:51328
    v_mfma_f32_16x16x32_bf16 v[76:79], v[180:183], v[164:167], v[76:79]
    ds_read_b32 v250, v214 offset:49156
    ds_read_b32 v252, v214 offset:49412
    v_mfma_f32_16x16x32_bf16 v[80:83], v[184:187], v[152:155], v[80:83]
    s_waitcnt lgkmcnt(8)
    v_readfirstlane_b32 s100, v11
    v_mov_b32_e64 v230, v223
    v_cndmask_b32 v222, 0, v222, s[86:87]
    v_mfma_f32_16x16x32_bf16 v[84:87], v[184:187], v[156:159], v[84:87]
    v_mov_b32_e64 v232, v225
    v_cndmask_b32 v224, 0, v224, s[86:87]
    v_mov_b32_e64 v234, v227
    v_cndmask_b32 v226, 0, v226, s[86:87]
    v_mfma_f32_16x16x32_bf16 v[88:91], v[184:187], v[160:163], v[88:91]
    v_mov_b32_e64 v236, v229
    v_cndmask_b32 v228, 0, v228, s[86:87]
    v_mov_b32 v223, v222
    v_mov_b32 v225, v224
    v_mfma_f32_16x16x32_bf16 v[92:95], v[184:187], v[164:167], v[92:95]
    v_mov_b32 v227, v226
    v_mov_b32_e64 v229, v228
    s_waitcnt lgkmcnt(0)
    v_mul_f32 v251, 0x3fb8aa3b, v250
    v_mfma_f32_16x16x32_bf16 v[96:99], v[188:191], v[152:155], v[96:99]
    v_mul_f32 v253, 0x3fb8aa3b, v252
    v_mfma_f32_16x16x32_bf16 v[100:103], v[188:191], v[156:159], v[100:103]
    v_mfma_f32_16x16x32_bf16 v[104:107], v[188:191], v[160:163], v[104:107]
    v_mfma_f32_16x16x32_bf16 v[108:111], v[188:191], v[164:167], v[108:111]
    v_mfma_f32_16x16x16_bf16 v[48:51], v[242:243], v[222:223], v[48:51]
    v_xor_b32 v168, 0, v217
    v_xor_b32 v169, 16, v217
    v_mfma_f32_16x16x16_bf16 v[52:55], v[242:243], v[224:225], v[52:55]
    v_xor_b32 v170, 32, v217
    v_xor_b32 v171, 48, v217
    v_mfma_f32_16x16x16_bf16 v[64:67], v[244:245], v[222:223], v[64:67]
    v_xor_b32_e64 v172, 64, v217
    v_xor_b32 v173, 80, v217
    v_mfma_f32_16x16x16_bf16 v[68:71], v[244:245], v[224:225], v[68:71]
    v_xor_b32 v174, 96, v217
    v_xor_b32 v175, 112, v217
    v_mfma_f32_16x16x16_bf16 v[56:59], v[242:243], v[226:227], v[56:59]
    v_xor_b32_e64 v4, 32, v216
    v_mfma_f32_16x16x16_bf16 v[60:63], v[242:243], v[228:229], v[60:63]
    v_mfma_f32_16x16x16_bf16 v[72:75], v[244:245], v[226:227], v[72:75]
    v_mfma_f32_16x16x16_bf16 v[76:79], v[244:245], v[228:229], v[76:79]
    v_mfma_f32_16x16x16_bf16 v[80:83], v[246:247], v[222:223], v[80:83]
    v_cvt_pk_bf16_f32 v112, v48, v49
    v_cvt_pk_bf16_f32 v113, v50, v51
    v_mfma_f32_16x16x16_bf16 v[84:87], v[246:247], v[224:225], v[84:87]
    v_cvt_pk_bf16_f32 v114, v52, v53
    v_cvt_pk_bf16_f32 v115, v54, v55
    v_mfma_f32_16x16x16_bf16 v[88:91], v[246:247], v[226:227], v[88:91]
    v_cvt_pk_bf16_f32 v116, v64, v65
    v_cvt_pk_bf16_f32 v117, v66, v67
    v_mfma_f32_16x16x16_bf16 v[92:95], v[246:247], v[228:229], v[92:95]
    v_cvt_pk_bf16_f32 v118, v68, v69
    v_cvt_pk_bf16_f32 v119, v70, v71
    v_mfma_f32_16x16x16_bf16 v[96:99], v[248:249], v[222:223], v[96:99]
    v_cvt_pk_bf16_f32 v120, v56, v57
    v_cvt_pk_bf16_f32 v121, v58, v59
    v_mfma_f32_16x16x16_bf16 v[100:103], v[248:249], v[224:225], v[100:103]
    v_cvt_pk_bf16_f32 v122, v60, v61
    v_cvt_pk_bf16_f32 v123, v62, v63
    v_mfma_f32_16x16x16_bf16 v[104:107], v[248:249], v[226:227], v[104:107]
    v_permlane16_swap_b32 v112, v114
    v_permlane16_swap_b32 v113, v115
    v_mfma_f32_16x16x16_bf16 v[108:111], v[248:249], v[228:229], v[108:111]
    v_permlane16_swap_b32 v116, v118
    v_permlane16_swap_b32 v117, v119
    v_cvt_pk_bf16_f32 v124, v72, v73
    v_cvt_pk_bf16_f32 v125, v74, v75
    v_cvt_pk_bf16_f32 v126, v76, v77
    v_cvt_pk_bf16_f32 v127, v78, v79
    v_permlane16_swap_b32 v120, v122
    v_permlane16_swap_b32 v121, v123
    v_permlane16_swap_b32 v124, v126
    v_permlane16_swap_b32 v125, v127
    v_mfma_f32_32x32x16_bf16 v[48:63], v[204:207], v[112:115], 0
    v_mul_f32 v80, v80, v230
    v_mul_f32 v81, v81, v230
    v_mul_f32 v82, v82, v230
    v_mul_f32 v83, v83, v230
    v_cvt_pk_bf16_f32 v80, v80, v81
    v_cvt_pk_bf16_f32 v81, v82, v83
    v_mfma_f32_32x32x16_bf16 v[64:79], v[204:207], v[120:123], 0
    v_mul_f32 v96, v96, v230
    v_mul_f32 v97, v97, v230
    v_mul_f32 v98, v98, v230
    v_mul_f32 v99, v99, v230
    v_cvt_pk_bf16_f32 v96, v96, v97
    v_cvt_pk_bf16_f32 v97, v98, v99
    v_mfma_f32_32x32x16_bf16 v[48:63], v[208:211], v[116:119], v[48:63]
    v_mul_f32 v84, v84, v232
    v_mul_f32 v85, v85, v232
    v_mul_f32 v86, v86, v232
    v_mul_f32 v87, v87, v232
    v_cvt_pk_bf16_f32 v84, v84, v85
    v_cvt_pk_bf16_f32 v85, v86, v87
    v_mfma_f32_32x32x16_bf16 v[64:79], v[208:211], v[124:127], v[64:79]
    v_mul_f32 v100, v100, v232
    v_mul_f32 v101, v101, v232
    v_mul_f32 v102, v102, v232
    v_mul_f32 v103, v103, v232
    v_cvt_pk_bf16_f32 v100, v100, v101
    v_cvt_pk_bf16_f32 v101, v102, v103
    v_mul_f32 v88, v88, v234
    v_mul_f32 v89, v89, v234
    v_mul_f32 v90, v90, v234
    v_mul_f32 v91, v91, v234
    v_cvt_pk_bf16_f32 v88, v88, v89
    v_cvt_pk_bf16_f32 v89, v90, v91
    v_mul_f32 v104, v104, v234
    v_mul_f32 v105, v105, v234
    v_mul_f32 v106, v106, v234
    v_mul_f32 v107, v107, v234
    v_cvt_pk_bf16_f32 v104, v104, v105
    v_cvt_pk_bf16_f32 v105, v106, v107
    v_mul_f32 v92, v92, v236
    v_mul_f32 v93, v93, v236
    v_mul_f32 v94, v94, v236
    v_mul_f32 v95, v95, v236
    v_cvt_pk_bf16_f32 v92, v92, v93
    v_cvt_pk_bf16_f32 v93, v94, v95
    v_mul_f32 v108, v108, v236
    v_mul_f32 v109, v109, v236
    v_mul_f32 v110, v110, v236
    v_mul_f32 v111, v111, v236
    v_cvt_pk_bf16_f32 v108, v108, v109
    v_cvt_pk_bf16_f32 v109, v110, v111
    v_max3_f32 v160, v48, v49, v50
    v_min3_f32 v162, v48, v49, v50
    v_max3_f32 v160, v160, v51, v52
    v_min3_f32 v162, v162, v51, v52
    v_max3_f32 v160, v160, v53, v54
    v_min3_f32 v162, v162, v53, v54
    v_max3_f32 v160, v160, v55, v56
    v_min3_f32 v162, v162, v55, v56
    v_max3_f32 v160, v160, v57, v58
    v_min3_f32 v162, v162, v57, v58
    v_max3_f32 v160, v160, v59, v60
    v_min3_f32 v162, v162, v59, v60
    v_max3_f32 v160, v160, v61, v62
    v_min3_f32 v162, v162, v61, v62
    v_max_f32 v160, v160, v63
    v_min_f32 v162, v162, v63
    v_max3_f32 v164, v64, v65, v66
    v_min3_f32 v166, v64, v65, v66
    v_max3_f32 v164, v164, v67, v68
    v_min3_f32 v166, v166, v67, v68
    v_max3_f32 v164, v164, v69, v70
    v_min3_f32 v166, v166, v69, v70
    v_max3_f32 v164, v164, v71, v72
    v_min3_f32 v166, v166, v71, v72
    v_max3_f32 v164, v164, v73, v74
    v_min3_f32 v166, v166, v73, v74
    v_max3_f32 v164, v164, v75, v76
    v_min3_f32 v166, v166, v75, v76
    v_max3_f32 v164, v164, v77, v78
    v_min3_f32 v166, v166, v77, v78
    v_max_f32 v164, v164, v79
    v_min_f32 v166, v166, v79
    v_mov_b32 v161, v160
    v_mov_b32 v163, v162
    v_mov_b32 v165, v164
    v_mov_b32 v167, v166
    v_permlane32_swap_b32 v160, v161
    v_permlane32_swap_b32 v162, v163
    v_permlane32_swap_b32 v164, v165
    v_permlane32_swap_b32 v166, v167
    v_max_f32 v160, v160, v161
    v_min_f32 v162, v162, v163
    v_max_f32 v164, v164, v165
    v_min_f32 v166, v166, v167
    v_mul_f32 v160, v160, v251
    v_mul_f32 v162, v162, v251
    v_mul_f32 v164, v164, v253
    v_mul_f32 v166, v166, v253
    v_pk_fma_f32 v[128:129], v[48:49], v[250:251], v[160:161] op_sel:[0,1,0] op_sel_hi:[1,1,0] neg_lo:[0,0,1] neg_hi:[0,0,1]
    v_pk_fma_f32 v[48:49], v[48:49], v[250:251], v[162:163] op_sel:[0,1,0] op_sel_hi:[1,1,0] neg_lo:[0,1,0] neg_hi:[0,1,0]
    v_pk_fma_f32 v[130:131], v[50:51], v[250:251], v[160:161] op_sel:[0,1,0] op_sel_hi:[1,1,0] neg_lo:[0,0,1] neg_hi:[0,0,1]
    v_pk_fma_f32 v[50:51], v[50:51], v[250:251], v[162:163] op_sel:[0,1,0] op_sel_hi:[1,1,0] neg_lo:[0,1,0] neg_hi:[0,1,0]
    v_pk_fma_f32 v[132:133], v[52:53], v[250:251], v[160:161] op_sel:[0,1,0] op_sel_hi:[1,1,0] neg_lo:[0,0,1] neg_hi:[0,0,1]
    v_pk_fma_f32 v[52:53], v[52:53], v[250:251], v[162:163] op_sel:[0,1,0] op_sel_hi:[1,1,0] neg_lo:[0,1,0] neg_hi:[0,1,0]
    v_pk_fma_f32 v[134:135], v[54:55], v[250:251], v[160:161] op_sel:[0,1,0] op_sel_hi:[1,1,0] neg_lo:[0,0,1] neg_hi:[0,0,1]
    v_pk_fma_f32 v[54:55], v[54:55], v[250:251], v[162:163] op_sel:[0,1,0] op_sel_hi:[1,1,0] neg_lo:[0,1,0] neg_hi:[0,1,0]
    v_pk_fma_f32 v[136:137], v[56:57], v[250:251], v[160:161] op_sel:[0,1,0] op_sel_hi:[1,1,0] neg_lo:[0,0,1] neg_hi:[0,0,1]
    v_pk_fma_f32 v[56:57], v[56:57], v[250:251], v[162:163] op_sel:[0,1,0] op_sel_hi:[1,1,0] neg_lo:[0,1,0] neg_hi:[0,1,0]
    v_pk_fma_f32 v[138:139], v[58:59], v[250:251], v[160:161] op_sel:[0,1,0] op_sel_hi:[1,1,0] neg_lo:[0,0,1] neg_hi:[0,0,1]
    v_pk_fma_f32 v[58:59], v[58:59], v[250:251], v[162:163] op_sel:[0,1,0] op_sel_hi:[1,1,0] neg_lo:[0,1,0] neg_hi:[0,1,0]
    v_pk_fma_f32 v[140:141], v[60:61], v[250:251], v[160:161] op_sel:[0,1,0] op_sel_hi:[1,1,0] neg_lo:[0,0,1] neg_hi:[0,0,1]
    v_pk_fma_f32 v[60:61], v[60:61], v[250:251], v[162:163] op_sel:[0,1,0] op_sel_hi:[1,1,0] neg_lo:[0,1,0] neg_hi:[0,1,0]
    v_pk_fma_f32 v[142:143], v[62:63], v[250:251], v[160:161] op_sel:[0,1,0] op_sel_hi:[1,1,0] neg_lo:[0,0,1] neg_hi:[0,0,1]
    v_pk_fma_f32 v[62:63], v[62:63], v[250:251], v[162:163] op_sel:[0,1,0] op_sel_hi:[1,1,0] neg_lo:[0,1,0] neg_hi:[0,1,0]
    v_pk_fma_f32 v[144:145], v[64:65], v[252:253], v[164:165] op_sel:[0,1,0] op_sel_hi:[1,1,0] neg_lo:[0,0,1] neg_hi:[0,0,1]
    v_pk_fma_f32 v[64:65], v[64:65], v[252:253], v[166:167] op_sel:[0,1,0] op_sel_hi:[1,1,0] neg_lo:[0,1,0] neg_hi:[0,1,0]
    v_pk_fma_f32 v[146:147], v[66:67], v[252:253], v[164:165] op_sel:[0,1,0] op_sel_hi:[1,1,0] neg_lo:[0,0,1] neg_hi:[0,0,1]
    v_pk_fma_f32 v[66:67], v[66:67], v[252:253], v[166:167] op_sel:[0,1,0] op_sel_hi:[1,1,0] neg_lo:[0,1,0] neg_hi:[0,1,0]
    v_pk_fma_f32 v[148:149], v[68:69], v[252:253], v[164:165] op_sel:[0,1,0] op_sel_hi:[1,1,0] neg_lo:[0,0,1] neg_hi:[0,0,1]
    v_pk_fma_f32 v[68:69], v[68:69], v[252:253], v[166:167] op_sel:[0,1,0] op_sel_hi:[1,1,0] neg_lo:[0,1,0] neg_hi:[0,1,0]
    v_pk_fma_f32 v[150:151], v[70:71], v[252:253], v[164:165] op_sel:[0,1,0] op_sel_hi:[1,1,0] neg_lo:[0,0,1] neg_hi:[0,0,1]
    v_pk_fma_f32 v[70:71], v[70:71], v[252:253], v[166:167] op_sel:[0,1,0] op_sel_hi:[1,1,0] neg_lo:[0,1,0] neg_hi:[0,1,0]
    v_pk_fma_f32 v[152:153], v[72:73], v[252:253], v[164:165] op_sel:[0,1,0] op_sel_hi:[1,1,0] neg_lo:[0,0,1] neg_hi:[0,0,1]
    v_pk_fma_f32 v[72:73], v[72:73], v[252:253], v[166:167] op_sel:[0,1,0] op_sel_hi:[1,1,0] neg_lo:[0,1,0] neg_hi:[0,1,0]
    v_pk_fma_f32 v[154:155], v[74:75], v[252:253], v[164:165] op_sel:[0,1,0] op_sel_hi:[1,1,0] neg_lo:[0,0,1] neg_hi:[0,0,1]
    v_pk_fma_f32 v[74:75], v[74:75], v[252:253], v[166:167] op_sel:[0,1,0] op_sel_hi:[1,1,0] neg_lo:[0,1,0] neg_hi:[0,1,0]
    v_pk_fma_f32 v[156:157], v[76:77], v[252:253], v[164:165] op_sel:[0,1,0] op_sel_hi:[1,1,0] neg_lo:[0,0,1] neg_hi:[0,0,1]
    v_pk_fma_f32 v[76:77], v[76:77], v[252:253], v[166:167] op_sel:[0,1,0] op_sel_hi:[1,1,0] neg_lo:[0,1,0] neg_hi:[0,1,0]
    v_pk_fma_f32 v[158:159], v[78:79], v[252:253], v[164:165] op_sel:[0,1,0] op_sel_hi:[1,1,0] neg_lo:[0,0,1] neg_hi:[0,0,1]
    v_pk_fma_f32 v[78:79], v[78:79], v[252:253], v[166:167] op_sel:[0,1,0] op_sel_hi:[1,1,0] neg_lo:[0,1,0] neg_hi:[0,1,0]
    v_exp_f32_e64 v128, v128
    v_mfma_f32_16x16x16_bf16 v[16:19], v[238:239], v[222:223], v[16:19]
    v_exp_f32 v144, v144
    v_exp_f32 v129, v129
    v_exp_f32_e64 v145, v145
    v_mfma_f32_16x16x16_bf16 v[20:23], v[238:239], v[224:225], v[20:23]
    ds_write2st64_b64 v216, v[80:81], v[84:85] offset0:64 offset1:68
    v_exp_f32 v130, v130
    v_exp_f32 v146, v146
    v_exp_f32_e64 v131, v131
    v_mfma_f32_16x16x16_bf16 v[24:27], v[238:239], v[226:227], v[24:27]
    v_exp_f32 v147, v147
    v_exp_f32 v132, v132
    v_exp_f32_e64 v148, v148
    v_mfma_f32_16x16x16_bf16 v[28:31], v[238:239], v[228:229], v[28:31]
    ds_write2st64_b64 v4, v[96:97], v[100:101] offset0:64 offset1:68
    v_exp_f32 v133, v133
    v_exp_f32 v149, v149
    v_exp_f32_e64 v134, v134
    v_mfma_f32_16x16x16_bf16 v[32:35], v[240:241], v[222:223], v[32:35]
    v_exp_f32 v150, v150
    v_exp_f32 v135, v135
    v_exp_f32_e64 v151, v151
    v_mfma_f32_16x16x16_bf16 v[36:39], v[240:241], v[224:225], v[36:39]
    ds_write2st64_b64 v216, v[88:89], v[92:93] offset0:72 offset1:76
    v_exp_f32 v136, v136
    v_exp_f32 v152, v152
    v_exp_f32_e64 v137, v137
    v_mfma_f32_16x16x16_bf16 v[40:43], v[240:241], v[226:227], v[40:43]
    v_exp_f32 v153, v153
    v_exp_f32 v138, v138
    v_exp_f32_e64 v154, v154
    v_mfma_f32_16x16x16_bf16 v[44:47], v[240:241], v[228:229], v[44:47]
    ds_write2st64_b64 v4, v[104:105], v[108:109] offset0:72 offset1:76
    v_exp_f32 v139, v139
    v_exp_f32 v155, v155
    v_exp_f32 v140, v140
    v_exp_f32 v156, v156
    v_exp_f32 v141, v141
    v_exp_f32 v157, v157
    v_exp_f32 v142, v142
    v_exp_f32 v158, v158
    v_exp_f32 v143, v143
    v_exp_f32 v159, v159
    v_pk_add_f32 v[176:177], v[128:129], v[130:131]
    v_pk_add_f32 v[178:179], v[144:145], v[146:147]
    v_pk_add_f32 v[176:177], v[176:177], v[132:133]
    v_pk_add_f32 v[178:179], v[178:179], v[148:149]
    v_pk_add_f32 v[176:177], v[176:177], v[134:135]
    v_pk_add_f32 v[178:179], v[178:179], v[150:151]
    v_pk_add_f32 v[176:177], v[176:177], v[136:137]
    v_pk_add_f32 v[178:179], v[178:179], v[152:153]
    v_pk_add_f32 v[176:177], v[176:177], v[138:139]
    v_pk_add_f32 v[178:179], v[178:179], v[154:155]
    v_pk_add_f32 v[176:177], v[176:177], v[140:141]
    v_pk_add_f32 v[178:179], v[178:179], v[156:157]
    v_pk_add_f32 v[176:177], v[176:177], v[142:143]
    v_pk_add_f32 v[178:179], v[178:179], v[158:159]
    v_exp_f32 v48, v48
    v_add_f32 v176, v176, v177
    v_add_f32 v178, v178, v179
    v_exp_f32 v64, v64
    v_mov_b32 v177, v176
    v_mov_b32 v179, v178
    v_exp_f32 v49, v49
    v_permlane32_swap_b32 v176, v177
    v_permlane32_swap_b32 v178, v179
    v_exp_f32 v65, v65
    v_add_f32 v176, v176, v177
    v_add_f32 v178, v178, v179
    v_exp_f32 v50, v50
    v_rcp_f32 v176, v176
    v_rcp_f32 v178, v178
    v_exp_f32 v66, v66
    v_exp_f32 v51, v51
    v_exp_f32 v67, v67
    v_exp_f32 v52, v52
    v_exp_f32 v68, v68
    v_exp_f32 v53, v53
    v_exp_f32 v69, v69
    v_exp_f32 v54, v54
    v_exp_f32 v70, v70
    v_exp_f32 v55, v55
    v_exp_f32 v71, v71
    v_exp_f32 v56, v56
    v_exp_f32 v72, v72
    v_exp_f32 v57, v57
    v_exp_f32 v73, v73
    v_exp_f32 v58, v58
    v_exp_f32 v74, v74
    v_exp_f32 v59, v59
    v_exp_f32 v75, v75
    v_exp_f32 v60, v60
    v_exp_f32 v76, v76
    v_exp_f32 v61, v61
    v_exp_f32 v77, v77
    v_exp_f32 v62, v62
    v_exp_f32 v78, v78
    v_exp_f32 v63, v63
    v_exp_f32 v79, v79
    v_pk_add_f32 v[180:181], v[48:49], v[50:51]
    v_pk_add_f32 v[182:183], v[64:65], v[66:67]
    v_pk_add_f32 v[180:181], v[180:181], v[52:53]
    v_pk_add_f32 v[182:183], v[182:183], v[68:69]
    v_pk_add_f32 v[180:181], v[180:181], v[54:55]
    v_pk_add_f32 v[182:183], v[182:183], v[70:71]
    v_pk_add_f32 v[180:181], v[180:181], v[56:57]
    v_pk_add_f32 v[182:183], v[182:183], v[72:73]
    v_pk_add_f32 v[180:181], v[180:181], v[58:59]
    v_pk_add_f32 v[182:183], v[182:183], v[74:75]
    v_pk_add_f32 v[180:181], v[180:181], v[60:61]
    v_pk_add_f32 v[182:183], v[182:183], v[76:77]
    v_pk_add_f32 v[180:181], v[180:181], v[62:63]
    v_pk_add_f32 v[182:183], v[182:183], v[78:79]
    v_add_f32 v180, v180, v181
    v_add_f32 v182, v182, v183
    v_mov_b32 v181, v180
    v_mov_b32 v183, v182
    v_pk_mul_f32 v[128:129], v[128:129], v[176:177] op_sel_hi:[1,0]
    v_pk_mul_f32 v[130:131], v[130:131], v[176:177] op_sel_hi:[1,0]
    v_cvt_pk_bf16_f32 v128, v128, v129
    v_permlane32_swap_b32 v180, v181
    v_permlane32_swap_b32 v182, v183
    v_cvt_pk_bf16_f32 v129, v130, v131
    v_pk_mul_f32 v[144:145], v[144:145], v[178:179] op_sel_hi:[1,0]
    v_pk_mul_f32 v[146:147], v[146:147], v[178:179] op_sel_hi:[1,0]
    v_cvt_pk_bf16_f32 v144, v144, v145
    v_cvt_pk_bf16_f32 v145, v146, v147
    v_add_f32 v180, v180, v181
    v_add_f32 v182, v182, v183
    ds_write2st64_b64 v168, v[128:129], v[144:145] offset0:0 offset1:8
    v_pk_mul_f32 v[132:133], v[132:133], v[176:177] op_sel_hi:[1,0]
    v_pk_mul_f32 v[134:135], v[134:135], v[176:177] op_sel_hi:[1,0]
    v_cvt_pk_bf16_f32 v132, v132, v133
    v_cvt_pk_bf16_f32 v133, v134, v135
    v_pk_mul_f32 v[148:149], v[148:149], v[178:179] op_sel_hi:[1,0]
    v_rcp_f32 v180, v180
    v_rcp_f32 v182, v182
    v_pk_mul_f32 v[150:151], v[150:151], v[178:179] op_sel_hi:[1,0]
    v_cvt_pk_bf16_f32 v148, v148, v149
    v_cvt_pk_bf16_f32 v149, v150, v151
    ds_write2st64_b64 v169, v[132:133], v[148:149] offset0:0 offset1:8
    v_pk_mul_f32 v[136:137], v[136:137], v[176:177] op_sel_hi:[1,0]
    v_pk_mul_f32 v[138:139], v[138:139], v[176:177] op_sel_hi:[1,0]
    v_cvt_pk_bf16_f32 v136, v136, v137
    v_cvt_pk_bf16_f32 v137, v138, v139
    v_pk_mul_f32 v[152:153], v[152:153], v[178:179] op_sel_hi:[1,0]
    v_pk_mul_f32 v[154:155], v[154:155], v[178:179] op_sel_hi:[1,0]
    v_cvt_pk_bf16_f32 v152, v152, v153
    v_cvt_pk_bf16_f32 v153, v154, v155
    ds_write2st64_b64 v170, v[136:137], v[152:153] offset0:0 offset1:8
    v_pk_mul_f32 v[140:141], v[140:141], v[176:177] op_sel_hi:[1,0]
    v_pk_mul_f32 v[142:143], v[142:143], v[176:177] op_sel_hi:[1,0]
    v_cvt_pk_bf16_f32 v140, v140, v141
    v_cvt_pk_bf16_f32 v141, v142, v143
    v_pk_mul_f32 v[156:157], v[156:157], v[178:179] op_sel_hi:[1,0]
    v_pk_mul_f32 v[158:159], v[158:159], v[178:179] op_sel_hi:[1,0]
    v_cvt_pk_bf16_f32 v156, v156, v157
    v_cvt_pk_bf16_f32 v157, v158, v159
    ds_write2st64_b64 v171, v[140:141], v[156:157] offset0:0 offset1:8
    v_pk_mul_f32 v[48:49], v[48:49], v[180:181] op_sel_hi:[1,0]
    v_pk_mul_f32 v[50:51], v[50:51], v[180:181] op_sel_hi:[1,0]
    v_cvt_pk_bf16_f32 v48, v48, v49
    v_cvt_pk_bf16_f32 v49, v50, v51
    v_pk_mul_f32 v[64:65], v[64:65], v[182:183] op_sel_hi:[1,0]
    v_pk_mul_f32 v[66:67], v[66:67], v[182:183] op_sel_hi:[1,0]
    v_cvt_pk_bf16_f32 v64, v64, v65
    v_cvt_pk_bf16_f32 v65, v66, v67
    ds_write2st64_b64 v172, v[48:49], v[64:65] offset0:0 offset1:8
    v_pk_mul_f32 v[52:53], v[52:53], v[180:181] op_sel_hi:[1,0]
    v_pk_mul_f32 v[54:55], v[54:55], v[180:181] op_sel_hi:[1,0]
    v_cvt_pk_bf16_f32 v52, v52, v53
    v_cvt_pk_bf16_f32 v53, v54, v55
    v_pk_mul_f32 v[68:69], v[68:69], v[182:183] op_sel_hi:[1,0]
    v_pk_mul_f32 v[70:71], v[70:71], v[182:183] op_sel_hi:[1,0]
    v_cvt_pk_bf16_f32 v68, v68, v69
    v_cvt_pk_bf16_f32 v69, v70, v71
    ds_write2st64_b64 v173, v[52:53], v[68:69] offset0:0 offset1:8
    v_pk_mul_f32 v[56:57], v[56:57], v[180:181] op_sel_hi:[1,0]
    v_pk_mul_f32 v[58:59], v[58:59], v[180:181] op_sel_hi:[1,0]
    v_cvt_pk_bf16_f32 v56, v56, v57
    v_cvt_pk_bf16_f32 v57, v58, v59
    v_pk_mul_f32 v[72:73], v[72:73], v[182:183] op_sel_hi:[1,0]
    v_pk_mul_f32 v[74:75], v[74:75], v[182:183] op_sel_hi:[1,0]
    v_cvt_pk_bf16_f32 v72, v72, v73
    v_cvt_pk_bf16_f32 v73, v74, v75
    ds_write2st64_b64 v174, v[56:57], v[72:73] offset0:0 offset1:8
    v_pk_mul_f32 v[60:61], v[60:61], v[180:181] op_sel_hi:[1,0]
    v_pk_mul_f32 v[62:63], v[62:63], v[180:181] op_sel_hi:[1,0]
    v_cvt_pk_bf16_f32 v60, v60, v61
    v_cvt_pk_bf16_f32 v61, v62, v63
    v_pk_mul_f32 v[76:77], v[76:77], v[182:183] op_sel_hi:[1,0]
    v_pk_mul_f32 v[78:79], v[78:79], v[182:183] op_sel_hi:[1,0]
    v_cvt_pk_bf16_f32 v76, v76, v77
    v_cvt_pk_bf16_f32 v77, v78, v79
    ds_write2st64_b64 v175, v[60:61], v[76:77] offset0:0 offset1:8
    ds_read_b64_tr_b16 v[112:113], v218 offset:0
    ds_read_b64_tr_b16 v[114:115], v219 offset:0
    ds_read_b64_tr_b16 v[144:145], v220 offset:32768
    ds_read_b64_tr_b16 v[146:147], v221 offset:32768
    ds_read_b64_tr_b16 v[116:117], v218 offset:2048
    ds_read_b64_tr_b16 v[118:119], v219 offset:2048
    ds_read_b64_tr_b16 v[148:149], v220 offset:34816
    ds_read_b64_tr_b16 v[150:151], v221 offset:34816
    ds_read_b64_tr_b16 v[120:121], v218 offset:4096
    ds_read_b64_tr_b16 v[122:123], v219 offset:4096
    ds_read_b64_tr_b16 v[152:153], v220 offset:36864
    ds_read_b64_tr_b16 v[154:155], v221 offset:36864
    v_cvt_pk_bf16_f32 v176, v16, v17
    v_cvt_pk_bf16_f32 v177, v18, v19
    v_cvt_pk_bf16_f32 v178, v20, v21
    v_cvt_pk_bf16_f32 v179, v22, v23
    v_cvt_pk_bf16_f32 v180, v32, v33
    v_cvt_pk_bf16_f32 v181, v34, v35
    v_cvt_pk_bf16_f32 v182, v36, v37
    v_cvt_pk_bf16_f32 v183, v38, v39
    v_cvt_pk_bf16_f32 v184, v24, v25
    v_cvt_pk_bf16_f32 v185, v26, v27
    v_cvt_pk_bf16_f32 v186, v28, v29
    v_cvt_pk_bf16_f32 v187, v30, v31
    v_cvt_pk_bf16_f32 v188, v40, v41
    v_cvt_pk_bf16_f32 v189, v42, v43
    v_cvt_pk_bf16_f32 v190, v44, v45
    v_cvt_pk_bf16_f32 v191, v46, v47
    s_waitcnt lgkmcnt(8)
    v_mfma_f32_32x32x16_bf16 v[48:63], v[112:115], v[144:147], 0
    ds_read_b64_tr_b16 v[124:125], v218 offset:6144
    ds_read_b64_tr_b16 v[126:127], v219 offset:6144
    ds_read_b64_tr_b16 v[156:157], v220 offset:38912
    ds_read_b64_tr_b16 v[158:159], v221 offset:38912
    s_waitcnt lgkmcnt(8)
    v_mfma_f32_32x32x16_bf16 v[48:63], v[116:119], v[148:151], v[48:63]
    v_xor_b32 v218, 8192, v218
    v_xor_b32 v219, 8192, v219
    v_xor_b32 v220, 8192, v220
    v_xor_b32 v221, 8192, v221
    s_barrier
    ds_read_b64_tr_b16 v[128:129], v218 offset:0
    ds_read_b64_tr_b16 v[130:131], v219 offset:0
    ds_read_b64_tr_b16 v[160:161], v220 offset:32768
    ds_read_b64_tr_b16 v[162:163], v221 offset:32768
    s_waitcnt lgkmcnt(8)
    v_mfma_f32_32x32x16_bf16 v[48:63], v[120:123], v[152:155], v[48:63]
    ds_read_b64_tr_b16 v[132:133], v218 offset:2048
    ds_read_b64_tr_b16 v[134:135], v219 offset:2048
    ds_read_b64_tr_b16 v[164:165], v220 offset:34816
    ds_read_b64_tr_b16 v[166:167], v221 offset:34816
    s_waitcnt lgkmcnt(8)
    v_mfma_f32_32x32x16_bf16 v[48:63], v[124:127], v[156:159], v[48:63]
    ds_read_b64_tr_b16 v[136:137], v218 offset:4096
    ds_read_b64_tr_b16 v[138:139], v219 offset:4096
    ds_read_b64_tr_b16 v[168:169], v220 offset:36864
    ds_read_b64_tr_b16 v[170:171], v221 offset:36864
    s_waitcnt lgkmcnt(8)
    v_mfma_f32_32x32x16_bf16 v[48:63], v[128:131], v[160:163], v[48:63]
    ds_read_b64_tr_b16 v[140:141], v218 offset:6144
    ds_read_b64_tr_b16 v[142:143], v219 offset:6144
    ds_read_b64_tr_b16 v[172:173], v220 offset:38912
    ds_read_b64_tr_b16 v[174:175], v221 offset:38912
    s_waitcnt lgkmcnt(8)
    v_mfma_f32_32x32x16_bf16 v[48:63], v[132:135], v[164:167], v[48:63]
    v_permlane16_swap_b32 v176, v178
    v_permlane16_swap_b32 v177, v179
    s_waitcnt lgkmcnt(4)
    v_mfma_f32_32x32x16_bf16 v[48:63], v[136:139], v[168:171], v[48:63]
    v_permlane16_swap_b32 v180, v182
    v_permlane16_swap_b32 v181, v183
    v_permlane16_swap_b32 v184, v186
    s_waitcnt lgkmcnt(0)
    v_mfma_f32_32x32x16_bf16 v[48:63], v[140:143], v[172:175], v[48:63]
    s_barrier
    v_permlane16_swap_b32 v185, v187
    v_permlane16_swap_b32 v188, v190
    v_permlane16_swap_b32 v189, v191
    s_lshl_b32 s76, s62, 11
    s_add_u32 s76, s76, s99
    v_mfma_f32_32x32x16_bf16 v[16:31], v[204:207], v[176:179], 0
    s_add_u32 s76, s76, 1024
    s_lshl_b32 s77, s62, 7
    s_add_u32 s77, s77, s73
    v_lshlrev_b32_e64 v4, 2, v2
    v_mfma_f32_32x32x16_bf16 v[32:47], v[204:207], v[184:187], 0
    v_cvt_pk_bf16_f32 v64, v48, v49
    v_cvt_pk_bf16_f32 v65, v50, v51
    v_cvt_pk_bf16_f32 v66, v52, v53
    v_cvt_pk_bf16_f32 v67, v54, v55
    v_cvt_pk_bf16_f32 v68, v56, v57
    v_mfma_f32_32x32x16_bf16 v[16:31], v[208:211], v[180:183], v[16:31]
    v_cvt_pk_bf16_f32 v69, v58, v59
    v_cvt_pk_bf16_f32 v70, v60, v61
    v_cvt_pk_bf16_f32 v71, v62, v63
    s_bitcmp1_b32 s100, 0
    s_cbranch_scc1 L_loc_58
    buffer_store_dwordx4 v[64:67], v12, s[40:43], s76 offen offset:0 sc1
    buffer_store_dwordx4 v[68:71], v12, s[40:43], s76 offen offset:1024 sc1
    s_branch L_pubd_59
L_loc_58:
    buffer_store_dwordx4 v[64:67], v12, s[40:43], s76 offen offset:0
    buffer_store_dwordx4 v[68:71], v12, s[40:43], s76 offen offset:1024
L_pubd_59:
    v_mfma_f32_32x32x16_bf16 v[32:47], v[208:211], v[188:191], v[32:47]
    v_and_b32 v216, 1, v1
    v_lshlrev_b32_e64 v216, 8, v216
    v_lshl_add_u32 v216, v3, 4, v216
    s_lshl_b32 s76, s64, 7
    v_add_u32 v216, s76, v216
    s_mul_i32 s78, s61, 28800
    s_lshl_b32 s79, s64, 8
    s_add_u32 s78, s78, s79
    s_add_u32 s79, s78, 3686400
    v_dot2_f32_bf16 v72, v112, s89, 0
    v_dot2_f32_bf16 v73, v113, s89, 0
    v_dot2_f32_bf16 v72, v114, s89, v72
    v_dot2_f32_bf16 v73, v115, s89, v73
    v_dot2_f32_bf16 v72, v116, s89, v72
    v_dot2_f32_bf16 v73, v117, s89, v73
    v_dot2_f32_bf16 v72, v118, s89, v72
    v_dot2_f32_bf16 v73, v119, s89, v73
    v_dot2_f32_bf16 v72, v120, s89, v72
    v_dot2_f32_bf16 v73, v121, s89, v73
    v_dot2_f32_bf16 v72, v122, s89, v72
    v_dot2_f32_bf16 v73, v123, s89, v73
    v_dot2_f32_bf16 v72, v124, s89, v72
    v_dot2_f32_bf16 v73, v125, s89, v73
    v_dot2_f32_bf16 v72, v126, s89, v72
    v_dot2_f32_bf16 v73, v127, s89, v73
    v_dot2_f32_bf16 v72, v128, s89, v72
    v_dot2_f32_bf16 v73, v129, s89, v73
    v_dot2_f32_bf16 v72, v130, s89, v72
    v_dot2_f32_bf16 v73, v131, s89, v73
    v_dot2_f32_bf16 v72, v132, s89, v72
    v_dot2_f32_bf16 v73, v133, s89, v73
    v_dot2_f32_bf16 v72, v134, s89, v72
    v_dot2_f32_bf16 v73, v135, s89, v73
    v_dot2_f32_bf16 v72, v136, s89, v72
    v_dot2_f32_bf16 v73, v137, s89, v73
    v_dot2_f32_bf16 v72, v138, s89, v72
    v_dot2_f32_bf16 v73, v139, s89, v73
    v_dot2_f32_bf16 v72, v140, s89, v72
    v_dot2_f32_bf16 v73, v141, s89, v73
    v_dot2_f32_bf16 v72, v142, s89, v72
    v_dot2_f32_bf16 v73, v143, s89, v73
    s_lshl_b32 s76, s98, 7
    v_lshl_add_u32 v10, v3, 3, s76
    v_lshlrev_b32 v11, 5, v1
    v_add_f32 v72, v72, v73
    v_mov_b32 v73, v72
    s_nop 1
    v_permlane32_swap_b32 v72, v73
    v_add_f32 v72, v72, v73
    s_mov_b32 exec_hi, 0
    s_bitcmp1_b32 s100, 0
    s_cbranch_scc1 L_loc_60
    buffer_store_dword v72, v4, s[40:43], s77 offen offset:2048 sc1
    s_branch L_pubd_61
L_loc_60:
    buffer_store_dword v72, v4, s[40:43], s77 offen offset:2048
L_pubd_61:
    s_mov_b64 exec, -1
    v_max3_f32 v160, v16, v17, v18
    v_min3_f32 v162, v16, v17, v18
    v_max3_f32 v160, v160, v19, v20
    v_min3_f32 v162, v162, v19, v20
    v_max3_f32 v160, v160, v21, v22
    v_min3_f32 v162, v162, v21, v22
    v_max3_f32 v160, v160, v23, v24
    v_min3_f32 v162, v162, v23, v24
    v_max3_f32 v160, v160, v25, v26
    v_min3_f32 v162, v162, v25, v26
    v_max3_f32 v160, v160, v27, v28
    v_min3_f32 v162, v162, v27, v28
    v_max3_f32 v160, v160, v29, v30
    v_min3_f32 v162, v162, v29, v30
    v_max_f32 v160, v160, v31
    v_min_f32 v162, v162, v31
    v_max3_f32 v164, v32, v33, v34
    v_min3_f32 v166, v32, v33, v34
    v_max3_f32 v164, v164, v35, v36
    v_min3_f32 v166, v166, v35, v36
    v_max3_f32 v164, v164, v37, v38
    v_min3_f32 v166, v166, v37, v38
    v_max3_f32 v164, v164, v39, v40
    v_min3_f32 v166, v166, v39, v40
    v_max3_f32 v164, v164, v41, v42
    v_min3_f32 v166, v166, v41, v42
    v_max3_f32 v164, v164, v43, v44
    v_min3_f32 v166, v166, v43, v44
    v_max3_f32 v164, v164, v45, v46
    v_min3_f32 v166, v166, v45, v46
    v_max_f32 v164, v164, v47
    v_min_f32 v166, v166, v47
    v_mov_b32 v161, v160
    v_mov_b32 v163, v162
    v_mov_b32 v165, v164
    v_mov_b32 v167, v166
    v_permlane32_swap_b32 v160, v161
    v_permlane32_swap_b32 v162, v163
    v_permlane32_swap_b32 v164, v165
    v_permlane32_swap_b32 v166, v167
    v_max_f32 v160, v160, v161
    v_min_f32 v162, v162, v163
    v_max_f32 v164, v164, v165
    v_min_f32 v166, v166, v167
    v_mul_f32 v160, v160, v251
    v_mul_f32 v162, v162, v251
    v_mul_f32 v164, v164, v253
    v_mul_f32 v166, v166, v253
    v_pk_fma_f32 v[128:129], v[16:17], v[250:251], v[160:161] op_sel:[0,1,0] op_sel_hi:[1,1,0] neg_lo:[0,0,1] neg_hi:[0,0,1]
    v_pk_fma_f32 v[16:17], v[16:17], v[250:251], v[162:163] op_sel:[0,1,0] op_sel_hi:[1,1,0] neg_lo:[0,1,0] neg_hi:[0,1,0]
    v_pk_fma_f32 v[130:131], v[18:19], v[250:251], v[160:161] op_sel:[0,1,0] op_sel_hi:[1,1,0] neg_lo:[0,0,1] neg_hi:[0,0,1]
    v_pk_fma_f32 v[18:19], v[18:19], v[250:251], v[162:163] op_sel:[0,1,0] op_sel_hi:[1,1,0] neg_lo:[0,1,0] neg_hi:[0,1,0]
    v_pk_fma_f32 v[132:133], v[20:21], v[250:251], v[160:161] op_sel:[0,1,0] op_sel_hi:[1,1,0] neg_lo:[0,0,1] neg_hi:[0,0,1]
    v_pk_fma_f32 v[20:21], v[20:21], v[250:251], v[162:163] op_sel:[0,1,0] op_sel_hi:[1,1,0] neg_lo:[0,1,0] neg_hi:[0,1,0]
    v_pk_fma_f32 v[134:135], v[22:23], v[250:251], v[160:161] op_sel:[0,1,0] op_sel_hi:[1,1,0] neg_lo:[0,0,1] neg_hi:[0,0,1]
    v_pk_fma_f32 v[22:23], v[22:23], v[250:251], v[162:163] op_sel:[0,1,0] op_sel_hi:[1,1,0] neg_lo:[0,1,0] neg_hi:[0,1,0]
    v_pk_fma_f32 v[136:137], v[24:25], v[250:251], v[160:161] op_sel:[0,1,0] op_sel_hi:[1,1,0] neg_lo:[0,0,1] neg_hi:[0,0,1]
    v_pk_fma_f32 v[24:25], v[24:25], v[250:251], v[162:163] op_sel:[0,1,0] op_sel_hi:[1,1,0] neg_lo:[0,1,0] neg_hi:[0,1,0]
    v_pk_fma_f32 v[138:139], v[26:27], v[250:251], v[160:161] op_sel:[0,1,0] op_sel_hi:[1,1,0] neg_lo:[0,0,1] neg_hi:[0,0,1]
    v_pk_fma_f32 v[26:27], v[26:27], v[250:251], v[162:163] op_sel:[0,1,0] op_sel_hi:[1,1,0] neg_lo:[0,1,0] neg_hi:[0,1,0]
    v_pk_fma_f32 v[140:141], v[28:29], v[250:251], v[160:161] op_sel:[0,1,0] op_sel_hi:[1,1,0] neg_lo:[0,0,1] neg_hi:[0,0,1]
    v_pk_fma_f32 v[28:29], v[28:29], v[250:251], v[162:163] op_sel:[0,1,0] op_sel_hi:[1,1,0] neg_lo:[0,1,0] neg_hi:[0,1,0]
    v_pk_fma_f32 v[142:143], v[30:31], v[250:251], v[160:161] op_sel:[0,1,0] op_sel_hi:[1,1,0] neg_lo:[0,0,1] neg_hi:[0,0,1]
    v_pk_fma_f32 v[30:31], v[30:31], v[250:251], v[162:163] op_sel:[0,1,0] op_sel_hi:[1,1,0] neg_lo:[0,1,0] neg_hi:[0,1,0]
    v_pk_fma_f32 v[144:145], v[32:33], v[252:253], v[164:165] op_sel:[0,1,0] op_sel_hi:[1,1,0] neg_lo:[0,0,1] neg_hi:[0,0,1]
    v_pk_fma_f32 v[32:33], v[32:33], v[252:253], v[166:167] op_sel:[0,1,0] op_sel_hi:[1,1,0] neg_lo:[0,1,0] neg_hi:[0,1,0]
    v_pk_fma_f32 v[146:147], v[34:35], v[252:253], v[164:165] op_sel:[0,1,0] op_sel_hi:[1,1,0] neg_lo:[0,0,1] neg_hi:[0,0,1]
    v_pk_fma_f32 v[34:35], v[34:35], v[252:253], v[166:167] op_sel:[0,1,0] op_sel_hi:[1,1,0] neg_lo:[0,1,0] neg_hi:[0,1,0]
    v_pk_fma_f32 v[148:149], v[36:37], v[252:253], v[164:165] op_sel:[0,1,0] op_sel_hi:[1,1,0] neg_lo:[0,0,1] neg_hi:[0,0,1]
    v_pk_fma_f32 v[36:37], v[36:37], v[252:253], v[166:167] op_sel:[0,1,0] op_sel_hi:[1,1,0] neg_lo:[0,1,0] neg_hi:[0,1,0]
    v_pk_fma_f32 v[150:151], v[38:39], v[252:253], v[164:165] op_sel:[0,1,0] op_sel_hi:[1,1,0] neg_lo:[0,0,1] neg_hi:[0,0,1]
    v_pk_fma_f32 v[38:39], v[38:39], v[252:253], v[166:167] op_sel:[0,1,0] op_sel_hi:[1,1,0] neg_lo:[0,1,0] neg_hi:[0,1,0]
    v_pk_fma_f32 v[152:153], v[40:41], v[252:253], v[164:165] op_sel:[0,1,0] op_sel_hi:[1,1,0] neg_lo:[0,0,1] neg_hi:[0,0,1]
    v_pk_fma_f32 v[40:41], v[40:41], v[252:253], v[166:167] op_sel:[0,1,0] op_sel_hi:[1,1,0] neg_lo:[0,1,0] neg_hi:[0,1,0]
    v_pk_fma_f32 v[154:155], v[42:43], v[252:253], v[164:165] op_sel:[0,1,0] op_sel_hi:[1,1,0] neg_lo:[0,0,1] neg_hi:[0,0,1]
    v_pk_fma_f32 v[42:43], v[42:43], v[252:253], v[166:167] op_sel:[0,1,0] op_sel_hi:[1,1,0] neg_lo:[0,1,0] neg_hi:[0,1,0]
    v_pk_fma_f32 v[156:157], v[44:45], v[252:253], v[164:165] op_sel:[0,1,0] op_sel_hi:[1,1,0] neg_lo:[0,0,1] neg_hi:[0,0,1]
    v_pk_fma_f32 v[44:45], v[44:45], v[252:253], v[166:167] op_sel:[0,1,0] op_sel_hi:[1,1,0] neg_lo:[0,1,0] neg_hi:[0,1,0]
    v_pk_fma_f32 v[158:159], v[46:47], v[252:253], v[164:165] op_sel:[0,1,0] op_sel_hi:[1,1,0] neg_lo:[0,0,1] neg_hi:[0,0,1]
    v_pk_fma_f32 v[46:47], v[46:47], v[252:253], v[166:167] op_sel:[0,1,0] op_sel_hi:[1,1,0] neg_lo:[0,1,0] neg_hi:[0,1,0]
    v_exp_f32 v128, v128
    v_exp_f32 v16, v16
    v_exp_f32 v129, v129
    v_exp_f32 v17, v17
    v_exp_f32 v130, v130
    v_exp_f32 v18, v18
    v_exp_f32 v131, v131
    v_exp_f32 v19, v19
    v_exp_f32 v132, v132
    v_exp_f32 v20, v20
    v_exp_f32 v133, v133
    v_exp_f32 v21, v21
    v_exp_f32 v134, v134
    v_exp_f32 v22, v22
    v_exp_f32 v135, v135
    v_exp_f32 v23, v23
    v_exp_f32 v136, v136
    v_exp_f32 v24, v24
    v_exp_f32 v137, v137
    v_exp_f32 v25, v25
    v_exp_f32 v138, v138
    v_exp_f32 v26, v26
    v_exp_f32 v139, v139
    v_exp_f32 v27, v27
    v_exp_f32 v140, v140
    v_exp_f32 v28, v28
    v_exp_f32 v141, v141
    v_exp_f32 v29, v29
    v_exp_f32 v142, v142
    v_exp_f32 v30, v30
    v_exp_f32 v143, v143
    v_exp_f32 v31, v31
    v_cvt_pk_bf16_f32 v218, v128, v129
    v_cvt_pk_bf16_f32 v219, v130, v131
    v_cvt_pk_bf16_f32 v220, v132, v133
    v_cvt_pk_bf16_f32 v221, v134, v135
    v_cvt_pk_bf16_f32 v222, v136, v137
    v_cvt_pk_bf16_f32 v223, v138, v139
    v_cvt_pk_bf16_f32 v224, v140, v141
    v_cvt_pk_bf16_f32 v225, v142, v143
    v_cvt_pk_bf16_f32 v226, v16, v17
    v_cvt_pk_bf16_f32 v227, v18, v19
    v_cvt_pk_bf16_f32 v228, v20, v21
    v_cvt_pk_bf16_f32 v229, v22, v23
    v_cvt_pk_bf16_f32 v230, v24, v25
    v_cvt_pk_bf16_f32 v231, v26, v27
    v_cvt_pk_bf16_f32 v232, v28, v29
    v_cvt_pk_bf16_f32 v233, v30, v31
    v_exp_f32 v144, v144
    v_exp_f32 v32, v32
    v_exp_f32 v145, v145
    v_exp_f32 v33, v33
    v_exp_f32 v146, v146
    v_exp_f32 v34, v34
    v_exp_f32 v147, v147
    v_exp_f32 v35, v35
    v_exp_f32 v148, v148
    v_exp_f32 v36, v36
    v_exp_f32 v149, v149
    v_exp_f32 v37, v37
    v_exp_f32 v150, v150
    v_exp_f32 v38, v38
    v_exp_f32 v151, v151
    v_exp_f32_e64 v39, v39
    s_barrier
    buffer_load_dwordx4 v[48:51], v13, s[40:43], s78 offen offset:3072 sc1
    buffer_load_dwordx4 v[52:55], v13, s[40:43], s79 offen offset:3072 sc1
    buffer_load_dwordx4 v[56:59], v13, s[40:43], s78 offen offset:3200 sc1
    buffer_load_dwordx4 v[60:63], v13, s[40:43], s79 offen offset:3200 sc1
    ds_read_b128 v[168:171], v216 offset:24576
    ds_read_b128 v[172:175], v216 offset:24608
    ds_read_b128 v[176:179], v216 offset:24640
    ds_read_b128 v[180:183], v216 offset:24672
    v_exp_f32 v152, v152
    v_exp_f32 v40, v40
    v_exp_f32 v153, v153
    v_exp_f32 v41, v41
    v_exp_f32 v154, v154
    v_exp_f32 v42, v42
    v_exp_f32 v155, v155
    v_exp_f32 v43, v43
    v_exp_f32 v156, v156
    v_exp_f32_e64 v44, v44
    s_waitcnt lgkmcnt(0)
    v_mfma_f32_32x32x16_bf16 v[64:79], v[168:171], v[218:221], 0
    v_exp_f32 v157, v157
    v_exp_f32 v45, v45
    v_exp_f32_e64 v158, v158
    v_mfma_f32_32x32x16_bf16 v[80:95], v[176:179], v[226:229], 0
    v_exp_f32 v46, v46
    v_exp_f32 v159, v159
    v_exp_f32_e64 v47, v47
    v_mfma_f32_32x32x16_bf16 v[64:79], v[172:175], v[222:225], v[64:79]
    v_cvt_pk_bf16_f32 v234, v144, v145
    v_cvt_pk_bf16_f32 v235, v146, v147
    v_cvt_pk_bf16_f32 v236, v148, v149
    v_cvt_pk_bf16_f32 v237, v150, v151
    v_cvt_pk_bf16_f32 v238, v152, v153
    v_cvt_pk_bf16_f32 v239, v154, v155
    v_mfma_f32_32x32x16_bf16 v[80:95], v[180:183], v[230:233], v[80:95]
    v_cvt_pk_bf16_f32 v240, v156, v157
    v_cvt_pk_bf16_f32 v241, v158, v159
    v_cvt_pk_bf16_f32 v242, v32, v33
    v_cvt_pk_bf16_f32 v243, v34, v35
    v_cvt_pk_bf16_f32 v244, v36, v37
    v_cvt_pk_bf16_f32 v245, v38, v39
    v_cvt_pk_bf16_f32 v246, v40, v41
    v_cvt_pk_bf16_f32 v247, v42, v43
    v_cvt_pk_bf16_f32 v248, v44, v45
    v_cvt_pk_bf16_f32 v249, v46, v47
    v_mfma_f32_32x32x16_bf16 v[96:111], v[168:171], v[234:237], 0
    v_rcp_f32 v184, v65
    v_rcp_f32 v185, v81
    v_mul_f32 v6, v64, v184
    v_fmac_f32 v6, v80, v185
    v_add_f32 v6, 0x358637bd, v6
    v_mfma_f32_32x32x16_bf16 v[112:127], v[176:179], v[242:245], 0
    v_rcp_f32 v6, v6
    v_mov_b32 v8, 0
    v_mul_f32 v184, v184, v6
    v_mul_f32_e64 v185, v185, v6
    s_lshl4_add_u32 s76, s60, s61
    v_mfma_f32_32x32x16_bf16 v[96:111], v[172:175], v[238:241], v[96:111]
    s_mul_i32 s76, s76, 32768
    s_lshl2_add_u32 s77, s63, s64
    s_lshl_b32 s77, s77, 12
    s_add_u32 s76, s76, s77
    s_add_u32 s76, s76, 16777216
    v_mfma_f32_32x32x16_bf16 v[112:127], v[180:183], v[246:249], v[112:127]
    s_add_u32 s77, s76, 8192
    v_add_u32 v14, 128, v12
    v_cmp_gt_u32 vcc, 24, v1
    s_nop 0
    s_nop 0
    v_cndmask_b32_e64 v14, v14, v12, vcc
    s_mov_b32 s88, 0
    s_branch L_pfirst_63
L_poll_62:
    buffer_load_dwordx4 v[48:51], v13, s[40:43], s78 offen offset:3072 sc1
    buffer_load_dwordx4 v[52:55], v13, s[40:43], s79 offen offset:3072 sc1
    buffer_load_dwordx4 v[56:59], v13, s[40:43], s78 offen offset:3200 sc1
    buffer_load_dwordx4 v[60:63], v13, s[40:43], s79 offen offset:3200 sc1
L_pfirst_63:
    s_waitcnt vmcnt(0)
    v_max3_u32 v9, v48, v49, v50
    v_max3_u32 v9, v9, v51, v52
    v_max3_u32 v9, v9, v53, v54
    v_max3_u32 v9, v9, v55, v56
    v_max3_u32 v9, v9, v57, v58
    v_max3_u32 v9, v9, v59, v60
    v_max3_u32 v9, v9, v61, v62
    v_max_u32 v9, v9, v63
    v_cmp_eq_u32 vcc, -1, v9
    s_nop 0
    s_cbranch_vccz L_ok_64
    s_add_u32 s88, s88, 1
    s_cmp_lt_u32 s88, 65536
    s_cbranch_scc1 L_poll_62
L_ok_64:
    v_mfma_f32_32x32x16_bf16 v[16:31], v[48:51], v[218:221], 0
    s_barrier
    v_rcp_f32 v186, v97
    v_rcp_f32 v187, v113
    v_mul_f32_e64 v7, v96, v186
    v_mfma_f32_32x32x16_bf16 v[128:143], v[56:59], v[226:229], 0
    v_fmac_f32_e64 v7, v112, v187
    v_add_f32 v7, 0x358637bd, v7
    v_rcp_f32_e64 v7, v7
    v_bfe_u32 v4, v2, 1, 3
    v_lshlrev_b32_e64 v4, 4, v4
    v_mfma_f32_32x32x16_bf16 v[16:31], v[52:55], v[222:225], v[16:31]
    v_mov_b32 v8, 0
    v_mul_f32 v186, v186, v7
    v_mul_f32_e64 v187, v187, v7
    v_lshl_add_u32 v4, v3, 3, v4
    v_lshl_add_u32 v4, v2, 7, v4
    s_lshl_b32 s56, s62, 12
    v_mfma_f32_32x32x16_bf16 v[128:143], v[60:63], v[230:233], v[128:143]
    s_add_u32 s57, s56, 0
    v_add_u32 v64, s57, v4
    v_xor_b32 v65, 16, v64
    v_xor_b32 v66, 32, v64
    v_xor_b32 v67, 48, v64
    v_xor_b32_e64 v68, 64, v64
    v_mfma_f32_32x32x16_bf16 v[32:47], v[48:51], v[234:237], 0
    v_xor_b32 v69, 80, v64
    v_xor_b32 v70, 96, v64
    v_xor_b32 v71, 112, v64
    v_bfe_u32 v4, v1, 2, 2
    v_lshl_add_u32 v5, v3, 2, v4
    v_lshlrev_b32_e64 v5, 7, v5
    v_mfma_f32_32x32x16_bf16 v[144:159], v[56:59], v[242:245], 0
    v_mul_f32 v16, v16, v184
    v_mul_f32 v17, v17, v184
    v_mul_f32 v18, v18, v184
    v_mul_f32 v19, v19, v184
    v_mul_f32 v20, v20, v184
    v_mul_f32 v21, v21, v184
    v_mfma_f32_32x32x16_bf16 v[32:47], v[52:55], v[238:241], v[32:47]
    v_mul_f32 v22, v22, v184
    v_mul_f32 v23, v23, v184
    v_mul_f32 v24, v24, v184
    v_mul_f32 v25, v25, v184
    v_mul_f32 v26, v26, v184
    v_mul_f32 v27, v27, v184
    v_mfma_f32_32x32x16_bf16 v[144:159], v[60:63], v[246:249], v[144:159]
    v_mul_f32 v28, v28, v184
    v_mul_f32 v29, v29, v184
    v_mul_f32 v30, v30, v184
    v_mul_f32 v31, v31, v184
    v_fmac_f32 v16, v128, v185
    v_fmac_f32 v17, v129, v185
    v_cvt_pk_bf16_f32 v96, v16, v17
    v_fmac_f32 v18, v130, v185
    v_fmac_f32 v19, v131, v185
    v_cvt_pk_bf16_f32 v97, v18, v19
    v_fmac_f32 v20, v132, v185
    v_fmac_f32 v21, v133, v185
    v_cvt_pk_bf16_f32 v98, v20, v21
    v_fmac_f32 v22, v134, v185
    v_fmac_f32 v23, v135, v185
    v_cvt_pk_bf16_f32 v99, v22, v23
    buffer_store_dwordx4 v[96:99], v14, s[40:43], s76 offen offset:0 sc1
    v_fmac_f32 v24, v136, v185
    v_fmac_f32 v25, v137, v185
    v_cvt_pk_bf16_f32 v100, v24, v25
    v_fmac_f32 v26, v138, v185
    v_fmac_f32 v27, v139, v185
    v_cvt_pk_bf16_f32 v101, v26, v27
    v_fmac_f32 v28, v140, v185
    v_fmac_f32 v29, v141, v185
    v_cvt_pk_bf16_f32 v102, v28, v29
    v_fmac_f32 v30, v142, v185
    v_fmac_f32 v31, v143, v185
    v_cvt_pk_bf16_f32 v103, v30, v31
    buffer_store_dwordx4 v[100:103], v14, s[40:43], s76 offen offset:2048 sc1
    v_pk_mul_f32 v[32:33], v[32:33], v[186:187] op_sel_hi:[1,0]
    v_pk_fma_f32 v[32:33], v[144:145], v[186:187], v[32:33] op_sel:[0,1,0] op_sel_hi:[1,1,1]
    v_cvt_pk_bf16_f32 v104, v32, v33
    v_pk_mul_f32 v[34:35], v[34:35], v[186:187] op_sel_hi:[1,0]
    v_pk_fma_f32 v[34:35], v[146:147], v[186:187], v[34:35] op_sel:[0,1,0] op_sel_hi:[1,1,1]
    v_cvt_pk_bf16_f32 v105, v34, v35
    v_pk_mul_f32 v[36:37], v[36:37], v[186:187] op_sel_hi:[1,0]
    v_pk_fma_f32 v[36:37], v[148:149], v[186:187], v[36:37] op_sel:[0,1,0] op_sel_hi:[1,1,1]
    v_cvt_pk_bf16_f32 v106, v36, v37
    v_pk_mul_f32 v[38:39], v[38:39], v[186:187] op_sel_hi:[1,0]
    v_pk_fma_f32 v[38:39], v[150:151], v[186:187], v[38:39] op_sel:[0,1,0] op_sel_hi:[1,1,1]
    v_cvt_pk_bf16_f32 v107, v38, v39
    buffer_store_dwordx4 v[104:107], v14, s[40:43], s77 offen offset:0 sc1
    v_pk_mul_f32 v[40:41], v[40:41], v[186:187] op_sel_hi:[1,0]
    v_pk_fma_f32 v[40:41], v[152:153], v[186:187], v[40:41] op_sel:[0,1,0] op_sel_hi:[1,1,1]
    v_cvt_pk_bf16_f32 v108, v40, v41
    v_pk_mul_f32 v[42:43], v[42:43], v[186:187] op_sel_hi:[1,0]
    v_pk_fma_f32 v[42:43], v[154:155], v[186:187], v[42:43] op_sel:[0,1,0] op_sel_hi:[1,1,1]
    v_cvt_pk_bf16_f32 v109, v42, v43
    v_pk_mul_f32 v[44:45], v[44:45], v[186:187] op_sel_hi:[1,0]
    v_pk_fma_f32 v[44:45], v[156:157], v[186:187], v[44:45] op_sel:[0,1,0] op_sel_hi:[1,1,1]
    v_cvt_pk_bf16_f32 v110, v44, v45
    v_pk_mul_f32 v[46:47], v[46:47], v[186:187] op_sel_hi:[1,0]
    v_pk_fma_f32 v[46:47], v[158:159], v[186:187], v[46:47] op_sel:[0,1,0] op_sel_hi:[1,1,1]
    v_cvt_pk_bf16_f32 v111, v46, v47
    buffer_store_dwordx4 v[108:111], v14, s[40:43], s77 offen offset:2048 sc1
    v_lshrrev_b32_e64 v4, 1, v4
    v_lshl_add_u32 v5, v4, 6, v5
    v_bfe_u32 v4, v1, 4, 1
    v_lshl_add_u32 v5, v4, 5, v5
    v_and_b32_e64 v4, 3, v1
    v_lshl_add_u32 v5, v4, 3, v5
    v_add_u32 v72, 32768, v5
    v_xor_b32_e64 v73, 64, v72
    s_mul_i32 s80, s97, 524288
    s_mul_i32 s56, s62, 8192
    s_add_u32 s80, s80, s56
    s_add_u32 s80, s80, 16777216
    v_add_u32 v78, 4096, v14
    v_mov_b32 v74, 1
    s_mov_b32 s52, 0xffff
    s_mov_b32 s53, 0
    s_barrier
    ds_read_b32 v79, v8 offset:25984
    ds_read_b64 v[88:89], v64
    ds_read_b64 v[90:91], v65
    ds_read_b64 v[92:93], v66
    ds_read_b64 v[94:95], v67
    ds_read_b64 v[96:97], v68
    ds_read_b64 v[98:99], v69
    ds_read_b64 v[100:101], v70
    ds_read_b64 v[102:103], v71
    s_waitcnt lgkmcnt(8)
    v_readfirstlane_b32 s76, v79
    s_nop 0
    s_and_b32 s76, s76, s52
    s_cbranch_scc0 L_tr0
L_bk0:
    s_ff1_i32_b32 s76, s76
    s_bitset0_b32 s52, s76
    s_add_u32 s77, s76, s65
    s_and_b32 s77, s77, 15
    s_mul_i32 s77, s77, 32768
    s_add_u32 s28, s77, s80
    s_add_u32 s76, s76, 3
    s_and_b32 s76, s76, 15
    s_lshl_b32 s4, s76, 13
    buffer_load_dwordx4 v[128:131], v14, s[40:43], s28 offen offset:0 sc1
    buffer_load_dwordx4 v[132:135], v14, s[40:43], s28 offen offset:2048 sc1
    buffer_load_dwordx4 v[136:139], v78, s[40:43], s28 offen offset:0 sc1
    buffer_load_dwordx4 v[140:143], v78, s[40:43], s28 offen offset:2048 sc1
    v_readfirstlane_b32 s76, v79
    s_nop 0
    s_and_b32 s76, s76, s52
    s_cbranch_scc0 L_tr1
L_bk1:
    s_ff1_i32_b32 s76, s76
    s_bitset0_b32 s52, s76
    s_add_u32 s77, s76, s65
    s_and_b32 s77, s77, 15
    s_mul_i32 s77, s77, 32768
    s_add_u32 s29, s77, s80
    s_add_u32 s76, s76, 3
    s_and_b32 s76, s76, 15
    s_lshl_b32 s5, s76, 13
    buffer_load_dwordx4 v[144:147], v14, s[40:43], s29 offen offset:0 sc1
    buffer_load_dwordx4 v[148:151], v14, s[40:43], s29 offen offset:2048 sc1
    v_add_u32 v80, s4, v72
    v_add_u32 v81, s4, v73
    s_waitcnt lgkmcnt(0)
    v_lshlrev_b32 v16, 16, v88
    v_and_b32 v17, s90, v88
    v_lshlrev_b32 v18, 16, v89
    v_and_b32 v19, s90, v89
    v_lshlrev_b32 v20, 16, v90
    v_and_b32 v21, s90, v90
    v_lshlrev_b32 v22, 16, v91
    v_and_b32 v23, s90, v91
    v_lshlrev_b32 v24, 16, v92
    v_and_b32 v25, s90, v92
    v_lshlrev_b32 v26, 16, v93
    v_and_b32 v27, s90, v93
    v_lshlrev_b32 v28, 16, v94
    v_and_b32 v29, s90, v94
    v_lshlrev_b32 v30, 16, v95
    v_and_b32 v31, s90, v95
    v_lshlrev_b32 v32, 16, v96
    v_and_b32 v33, s90, v96
    v_lshlrev_b32 v34, 16, v97
    v_and_b32 v35, s90, v97
    v_lshlrev_b32 v36, 16, v98
    v_and_b32 v37, s90, v98
    v_lshlrev_b32 v38, 16, v99
    v_and_b32 v39, s90, v99
    v_lshlrev_b32 v40, 16, v100
    v_and_b32 v41, s90, v100
    v_lshlrev_b32 v42, 16, v101
    v_and_b32 v43, s90, v101
    v_lshlrev_b32 v44, 16, v102
    v_and_b32 v45, s90, v102
    v_lshlrev_b32 v46, 16, v103
    v_and_b32 v47, s90, v103
    s_cmp_eq_u32 s53, 0
    s_cbranch_scc0 L_sent_65
    s_waitcnt vmcnt(6)
    s_mov_b64 exec, 1
    ds_add_u32 v8, v74 offset:25988
    s_mov_b64 exec, -1
    s_mov_b32 s53, 1
L_sent_65:
    ds_read_b32 v79, v8 offset:25984
    ds_read_b64_tr_b16 v[104:105], v80 offset:0
    ds_read_b64_tr_b16 v[106:107], v80 offset:1024
    ds_read_b64_tr_b16 v[108:109], v81 offset:0
    ds_read_b64_tr_b16 v[110:111], v81 offset:1024
    ds_read_b64_tr_b16 v[112:113], v80 offset:2048
    ds_read_b64_tr_b16 v[114:115], v80 offset:3072
    ds_read_b64_tr_b16 v[116:117], v81 offset:2048
    ds_read_b64_tr_b16 v[118:119], v81 offset:3072
    s_waitcnt vmcnt(5) lgkmcnt(4)
    v_mfma_f32_32x32x16_bf16 v[16:31], v[104:107], v[128:131], v[16:31]
    ds_read_b64_tr_b16 v[120:121], v80 offset:4096
    ds_read_b64_tr_b16 v[122:123], v80 offset:5120
    buffer_load_dwordx4 v[152:155], v78, s[40:43], s29 offen offset:0 sc1
    v_mfma_f32_32x32x16_bf16 v[32:47], v[108:111], v[128:131], v[32:47]
    ds_read_b64_tr_b16 v[124:125], v81 offset:4096
    ds_read_b64_tr_b16 v[126:127], v81 offset:5120
    buffer_load_dwordx4 v[156:159], v78, s[40:43], s29 offen offset:2048 sc1
    v_readfirstlane_b32 s76, v79
    s_nop 0
    s_and_b32 s76, s76, s52
    s_cbranch_scc0 L_tr2
L_bk2:
    s_ff1_i32_b32 s76, s76
    s_bitset0_b32 s52, s76
    s_add_u32 s77, s76, s65
    s_and_b32 s77, s77, 15
    s_mul_i32 s77, s77, 32768
    s_add_u32 s30, s77, s80
    s_waitcnt vmcnt(6) lgkmcnt(4)
    v_mfma_f32_32x32x16_bf16 v[16:31], v[112:115], v[132:135], v[16:31]
    ds_read_b32 v79, v8 offset:25984
    ds_read_b64_tr_b16 v[104:105], v80 offset:6144
    ds_read_b64_tr_b16 v[106:107], v80 offset:7168
    buffer_load_dwordx4 v[160:163], v14, s[40:43], s30 offen offset:0 sc1
    s_add_u32 s76, s76, 3
    s_and_b32 s76, s76, 15
    s_lshl_b32 s6, s76, 13
    v_mfma_f32_32x32x16_bf16 v[32:47], v[116:119], v[132:135], v[32:47]
    ds_read_b64_tr_b16 v[108:109], v81 offset:6144
    ds_read_b64_tr_b16 v[110:111], v81 offset:7168
    buffer_load_dwordx4 v[164:167], v14, s[40:43], s30 offen offset:2048 sc1
    v_add_u32 v82, s5, v72
    v_add_u32_e64 v83, s5, v73
    s_waitcnt vmcnt(7) lgkmcnt(4)
    v_mfma_f32_32x32x16_bf16 v[16:31], v[120:123], v[136:139], v[16:31]
    ds_read_b64_tr_b16 v[112:113], v82 offset:0
    ds_read_b64_tr_b16 v[114:115], v82 offset:1024
    buffer_load_dwordx4 v[168:171], v78, s[40:43], s30 offen offset:0 sc1
    v_mfma_f32_32x32x16_bf16 v[32:47], v[124:127], v[136:139], v[32:47]
    ds_read_b64_tr_b16 v[116:117], v83 offset:0
    ds_read_b64_tr_b16 v[118:119], v83 offset:1024
    buffer_load_dwordx4 v[172:175], v78, s[40:43], s30 offen offset:2048 sc1
    v_readfirstlane_b32 s76, v79
    s_nop 0
    s_and_b32 s76, s76, s52
    s_cbranch_scc0 L_tr3
L_bk3:
    s_ff1_i32_b32 s76, s76
    s_bitset0_b32 s52, s76
    s_add_u32 s77, s76, s65
    s_and_b32 s77, s77, 15
    s_mul_i32 s77, s77, 32768
    s_add_u32 s31, s77, s80
    s_waitcnt vmcnt(8) lgkmcnt(4)
    v_mfma_f32_32x32x16_bf16 v[16:31], v[104:107], v[140:143], v[16:31]
    ds_read_b32 v79, v8 offset:25984
    ds_read_b64_tr_b16 v[120:121], v82 offset:2048
    ds_read_b64_tr_b16 v[122:123], v82 offset:3072
    buffer_load_dwordx4 v[176:179], v14, s[40:43], s31 offen offset:0 sc1
    s_add_u32 s76, s76, 3
    s_and_b32 s76, s76, 15
    s_lshl_b32 s7, s76, 13
    v_mfma_f32_32x32x16_bf16 v[32:47], v[108:111], v[140:143], v[32:47]
    ds_read_b64_tr_b16 v[124:125], v83 offset:2048
    ds_read_b64_tr_b16 v[126:127], v83 offset:3072
    buffer_load_dwordx4 v[180:183], v14, s[40:43], s31 offen offset:2048 sc1
    s_waitcnt vmcnt(9) lgkmcnt(4)
    v_mfma_f32_32x32x16_bf16 v[16:31], v[112:115], v[144:147], v[16:31]
    ds_read_b64_tr_b16 v[104:105], v82 offset:4096
    ds_read_b64_tr_b16 v[106:107], v82 offset:5120
    buffer_load_dwordx4 v[184:187], v78, s[40:43], s31 offen offset:0 sc1
    v_mfma_f32_32x32x16_bf16 v[32:47], v[116:119], v[144:147], v[32:47]
    ds_read_b64_tr_b16 v[108:109], v83 offset:4096
    ds_read_b64_tr_b16 v[110:111], v83 offset:5120
    buffer_load_dwordx4 v[188:191], v78, s[40:43], s31 offen offset:2048 sc1
    v_readfirstlane_b32 s76, v79
    s_nop 0
    s_and_b32 s76, s76, s52
    s_cbranch_scc0 L_tr4
L_bk4:
    s_ff1_i32_b32 s76, s76
    s_bitset0_b32 s52, s76
    s_add_u32 s77, s76, s65
    s_and_b32 s77, s77, 15
    s_mul_i32 s77, s77, 32768
    s_add_u32 s32, s77, s80
    s_waitcnt vmcnt(10) lgkmcnt(4)
    v_mfma_f32_32x32x16_bf16 v[16:31], v[120:123], v[148:151], v[16:31]
    ds_read_b64_tr_b16 v[112:113], v82 offset:6144
    ds_read_b64_tr_b16 v[114:115], v82 offset:7168
    buffer_load_dwordx4 v[128:131], v14, s[40:43], s32 offen offset:0 sc1
    s_add_u32 s76, s76, 3
    s_and_b32 s76, s76, 15
    s_lshl_b32 s8, s76, 13
    v_mfma_f32_32x32x16_bf16 v[32:47], v[124:127], v[148:151], v[32:47]
    ds_read_b64_tr_b16 v[116:117], v83 offset:6144
    ds_read_b64_tr_b16 v[118:119], v83 offset:7168
    buffer_load_dwordx4 v[132:135], v14, s[40:43], s32 offen offset:2048 sc1
    v_add_u32 v80, s6, v72
    v_add_u32 v81, s6, v73
    s_waitcnt vmcnt(11) lgkmcnt(4)
    v_mfma_f32_32x32x16_bf16 v[16:31], v[104:107], v[152:155], v[16:31]
    ds_read_b32 v79, v8 offset:25984
    ds_read_b64_tr_b16 v[120:121], v80 offset:0
    ds_read_b64_tr_b16 v[122:123], v80 offset:1024
    buffer_load_dwordx4 v[136:139], v78, s[40:43], s32 offen offset:0 sc1
    v_mfma_f32_32x32x16_bf16 v[32:47], v[108:111], v[152:155], v[32:47]
    ds_read_b64_tr_b16 v[124:125], v81 offset:0
    ds_read_b64_tr_b16 v[126:127], v81 offset:1024
    s_waitcnt vmcnt(11) lgkmcnt(4)
    v_mfma_f32_32x32x16_bf16 v[16:31], v[112:115], v[156:159], v[16:31]
    ds_read_b64_tr_b16 v[104:105], v80 offset:2048
    ds_read_b64_tr_b16 v[106:107], v80 offset:3072
    buffer_load_dwordx4 v[140:143], v78, s[40:43], s32 offen offset:2048 sc1
    v_mfma_f32_32x32x16_bf16 v[32:47], v[116:119], v[156:159], v[32:47]
    ds_read_b64_tr_b16 v[108:109], v81 offset:2048
    ds_read_b64_tr_b16 v[110:111], v81 offset:3072
    v_readfirstlane_b32 s76, v79
    s_nop 0
    s_and_b32 s76, s76, s52
    s_cbranch_scc0 L_tr5
L_bk5:
    s_ff1_i32_b32 s76, s76
    s_bitset0_b32 s52, s76
    s_add_u32 s77, s76, s65
    s_and_b32 s77, s77, 15
    s_mul_i32 s77, s77, 32768
    s_add_u32 s33, s77, s80
    s_waitcnt vmcnt(11) lgkmcnt(4)
    v_mfma_f32_32x32x16_bf16 v[16:31], v[120:123], v[160:163], v[16:31]
    ds_read_b64_tr_b16 v[112:113], v80 offset:4096
    ds_read_b64_tr_b16 v[114:115], v80 offset:5120
    buffer_load_dwordx4 v[144:147], v14, s[40:43], s33 offen offset:0 sc1
    s_add_u32 s76, s76, 3
    s_and_b32 s76, s76, 15
    s_lshl_b32 s9, s76, 13
    v_mfma_f32_32x32x16_bf16 v[32:47], v[124:127], v[160:163], v[32:47]
    ds_read_b64_tr_b16 v[116:117], v81 offset:4096
    ds_read_b64_tr_b16 v[118:119], v81 offset:5120
    s_waitcnt vmcnt(11) lgkmcnt(4)
    v_mfma_f32_32x32x16_bf16 v[16:31], v[104:107], v[164:167], v[16:31]
    ds_read_b64_tr_b16 v[120:121], v80 offset:6144
    ds_read_b64_tr_b16 v[122:123], v80 offset:7168
    buffer_load_dwordx4 v[148:151], v14, s[40:43], s33 offen offset:2048 sc1
    v_mfma_f32_32x32x16_bf16 v[32:47], v[108:111], v[164:167], v[32:47]
    ds_read_b64_tr_b16 v[124:125], v81 offset:6144
    ds_read_b64_tr_b16 v[126:127], v81 offset:7168
    v_add_u32 v82, s7, v72
    v_add_u32 v83, s7, v73
    s_waitcnt vmcnt(11) lgkmcnt(4)
    v_mfma_f32_32x32x16_bf16 v[16:31], v[112:115], v[168:171], v[16:31]
    ds_read_b32 v79, v8 offset:25984
    ds_read_b64_tr_b16 v[104:105], v82 offset:0
    ds_read_b64_tr_b16 v[106:107], v82 offset:1024
    buffer_load_dwordx4 v[152:155], v78, s[40:43], s33 offen offset:0 sc1
    v_mfma_f32_32x32x16_bf16 v[32:47], v[116:119], v[168:171], v[32:47]
    ds_read_b64_tr_b16 v[108:109], v83 offset:0
    ds_read_b64_tr_b16 v[110:111], v83 offset:1024
    s_waitcnt vmcnt(11) lgkmcnt(4)
    v_mfma_f32_32x32x16_bf16 v[16:31], v[120:123], v[172:175], v[16:31]
    ds_read_b64_tr_b16 v[112:113], v82 offset:2048
    ds_read_b64_tr_b16 v[114:115], v82 offset:3072
    buffer_load_dwordx4 v[156:159], v78, s[40:43], s33 offen offset:2048 sc1
    v_mfma_f32_32x32x16_bf16 v[32:47], v[124:127], v[172:175], v[32:47]
    ds_read_b64_tr_b16 v[116:117], v83 offset:2048
    ds_read_b64_tr_b16 v[118:119], v83 offset:3072
    v_readfirstlane_b32 s76, v79
    s_nop 0
    s_and_b32 s76, s76, s52
    s_cbranch_scc0 L_tr6
L_bk6:
    s_ff1_i32_b32 s76, s76
    s_bitset0_b32 s52, s76
    s_add_u32 s77, s76, s65
    s_and_b32 s77, s77, 15
    s_mul_i32 s77, s77, 32768
    s_add_u32 s34, s77, s80
    s_waitcnt vmcnt(11) lgkmcnt(4)
    v_mfma_f32_32x32x16_bf16 v[16:31], v[104:107], v[176:179], v[16:31]
    ds_read_b64_tr_b16 v[120:121], v82 offset:4096
    ds_read_b64_tr_b16 v[122:123], v82 offset:5120
    buffer_load_dwordx4 v[160:163], v14, s[40:43], s34 offen offset:0 sc1
    s_add_u32 s76, s76, 3
    s_and_b32 s76, s76, 15
    s_lshl_b32 s10, s76, 13
    v_mfma_f32_32x32x16_bf16 v[32:47], v[108:111], v[176:179], v[32:47]
    ds_read_b64_tr_b16 v[124:125], v83 offset:4096
    ds_read_b64_tr_b16 v[126:127], v83 offset:5120
    s_waitcnt vmcnt(11) lgkmcnt(4)
    v_mfma_f32_32x32x16_bf16 v[16:31], v[112:115], v[180:183], v[16:31]
    ds_read_b64_tr_b16 v[104:105], v82 offset:6144
    ds_read_b64_tr_b16 v[106:107], v82 offset:7168
    buffer_load_dwordx4 v[164:167], v14, s[40:43], s34 offen offset:2048 sc1
    v_mfma_f32_32x32x16_bf16 v[32:47], v[116:119], v[180:183], v[32:47]
    ds_read_b64_tr_b16 v[108:109], v83 offset:6144
    ds_read_b64_tr_b16 v[110:111], v83 offset:7168
    v_add_u32 v80, s8, v72
    v_add_u32 v81, s8, v73
    s_waitcnt vmcnt(11) lgkmcnt(4)
    v_mfma_f32_32x32x16_bf16 v[16:31], v[120:123], v[184:187], v[16:31]
    ds_read_b32 v79, v8 offset:25984
    ds_read_b64_tr_b16 v[112:113], v80 offset:0
    ds_read_b64_tr_b16 v[114:115], v80 offset:1024
    buffer_load_dwordx4 v[168:171], v78, s[40:43], s34 offen offset:0 sc1
    v_mfma_f32_32x32x16_bf16 v[32:47], v[124:127], v[184:187], v[32:47]
    ds_read_b64_tr_b16 v[116:117], v81 offset:0
    ds_read_b64_tr_b16 v[118:119], v81 offset:1024
    s_waitcnt vmcnt(11) lgkmcnt(4)
    v_mfma_f32_32x32x16_bf16 v[16:31], v[104:107], v[188:191], v[16:31]
    ds_read_b64_tr_b16 v[120:121], v80 offset:2048
    ds_read_b64_tr_b16 v[122:123], v80 offset:3072
    buffer_load_dwordx4 v[172:175], v78, s[40:43], s34 offen offset:2048 sc1
    v_mfma_f32_32x32x16_bf16 v[32:47], v[108:111], v[188:191], v[32:47]
    ds_read_b64_tr_b16 v[124:125], v81 offset:2048
    ds_read_b64_tr_b16 v[126:127], v81 offset:3072
    v_readfirstlane_b32 s76, v79
    s_nop 0
    s_and_b32 s76, s76, s52
    s_cbranch_scc0 L_tr7
L_bk7:
    s_ff1_i32_b32 s76, s76
    s_bitset0_b32 s52, s76
    s_add_u32 s77, s76, s65
    s_and_b32 s77, s77, 15
    s_mul_i32 s77, s77, 32768
    s_add_u32 s35, s77, s80
    s_waitcnt vmcnt(11) lgkmcnt(4)
    v_mfma_f32_32x32x16_bf16 v[16:31], v[112:115], v[128:131], v[16:31]
    ds_read_b64_tr_b16 v[104:105], v80 offset:4096
    ds_read_b64_tr_b16 v[106:107], v80 offset:5120
    buffer_load_dwordx4 v[176:179], v14, s[40:43], s35 offen offset:0 sc1
    s_add_u32 s76, s76, 3
    s_and_b32 s76, s76, 15
    s_lshl_b32 s11, s76, 13
    v_mfma_f32_32x32x16_bf16 v[32:47], v[116:119], v[128:131], v[32:47]
    ds_read_b64_tr_b16 v[108:109], v81 offset:4096
    ds_read_b64_tr_b16 v[110:111], v81 offset:5120
    s_waitcnt vmcnt(11) lgkmcnt(4)
    v_mfma_f32_32x32x16_bf16 v[16:31], v[120:123], v[132:135], v[16:31]
    ds_read_b64_tr_b16 v[112:113], v80 offset:6144
    ds_read_b64_tr_b16 v[114:115], v80 offset:7168
    buffer_load_dwordx4 v[180:183], v14, s[40:43], s35 offen offset:2048 sc1
    v_mfma_f32_32x32x16_bf16 v[32:47], v[124:127], v[132:135], v[32:47]
    ds_read_b64_tr_b16 v[116:117], v81 offset:6144
    ds_read_b64_tr_b16 v[118:119], v81 offset:7168
    v_add_u32 v82, s9, v72
    v_add_u32 v83, s9, v73
    s_waitcnt vmcnt(11) lgkmcnt(4)
    v_mfma_f32_32x32x16_bf16 v[16:31], v[104:107], v[136:139], v[16:31]
    ds_read_b32 v79, v8 offset:25984
    ds_read_b64_tr_b16 v[120:121], v82 offset:0
    ds_read_b64_tr_b16 v[122:123], v82 offset:1024
    buffer_load_dwordx4 v[184:187], v78, s[40:43], s35 offen offset:0 sc1
    v_mfma_f32_32x32x16_bf16 v[32:47], v[108:111], v[136:139], v[32:47]
    ds_read_b64_tr_b16 v[124:125], v83 offset:0
    ds_read_b64_tr_b16 v[126:127], v83 offset:1024
    s_waitcnt vmcnt(11) lgkmcnt(4)
    v_mfma_f32_32x32x16_bf16 v[16:31], v[112:115], v[140:143], v[16:31]
    ds_read_b64_tr_b16 v[104:105], v82 offset:2048
    ds_read_b64_tr_b16 v[106:107], v82 offset:3072
    buffer_load_dwordx4 v[188:191], v78, s[40:43], s35 offen offset:2048 sc1
    v_mfma_f32_32x32x16_bf16 v[32:47], v[116:119], v[140:143], v[32:47]
    ds_read_b64_tr_b16 v[108:109], v83 offset:2048
    ds_read_b64_tr_b16 v[110:111], v83 offset:3072
    v_readfirstlane_b32 s76, v79
    s_nop 0
    s_and_b32 s76, s76, s52
    s_cbranch_scc0 L_tr8
L_bk8:
    s_ff1_i32_b32 s76, s76
    s_bitset0_b32 s52, s76
    s_add_u32 s77, s76, s65
    s_and_b32 s77, s77, 15
    s_mul_i32 s77, s77, 32768
    s_add_u32 s36, s77, s80
    s_waitcnt vmcnt(11) lgkmcnt(4)
    v_mfma_f32_32x32x16_bf16 v[16:31], v[120:123], v[144:147], v[16:31]
    ds_read_b64_tr_b16 v[112:113], v82 offset:4096
    ds_read_b64_tr_b16 v[114:115], v82 offset:5120
    buffer_load_dwordx4 v[128:131], v14, s[40:43], s36 offen offset:0 sc1
    s_add_u32 s76, s76, 3
    s_and_b32 s76, s76, 15
    s_lshl_b32 s12, s76, 13
    v_mfma_f32_32x32x16_bf16 v[32:47], v[124:127], v[144:147], v[32:47]
    ds_read_b64_tr_b16 v[116:117], v83 offset:4096
    ds_read_b64_tr_b16 v[118:119], v83 offset:5120
    s_waitcnt vmcnt(11) lgkmcnt(4)
    v_mfma_f32_32x32x16_bf16 v[16:31], v[104:107], v[148:151], v[16:31]
    ds_read_b64_tr_b16 v[120:121], v82 offset:6144
    ds_read_b64_tr_b16 v[122:123], v82 offset:7168
    buffer_load_dwordx4 v[132:135], v14, s[40:43], s36 offen offset:2048 sc1
    v_mfma_f32_32x32x16_bf16 v[32:47], v[108:111], v[148:151], v[32:47]
    ds_read_b64_tr_b16 v[124:125], v83 offset:6144
    ds_read_b64_tr_b16 v[126:127], v83 offset:7168
    v_add_u32 v80, s10, v72
    v_add_u32 v81, s10, v73
    s_waitcnt vmcnt(11) lgkmcnt(4)
    v_mfma_f32_32x32x16_bf16 v[16:31], v[112:115], v[152:155], v[16:31]
    ds_read_b32 v79, v8 offset:25984
    ds_read_b64_tr_b16 v[104:105], v80 offset:0
    ds_read_b64_tr_b16 v[106:107], v80 offset:1024
    buffer_load_dwordx4 v[136:139], v78, s[40:43], s36 offen offset:0 sc1
    v_mfma_f32_32x32x16_bf16 v[32:47], v[116:119], v[152:155], v[32:47]
    ds_read_b64_tr_b16 v[108:109], v81 offset:0
    ds_read_b64_tr_b16 v[110:111], v81 offset:1024
    s_waitcnt vmcnt(11) lgkmcnt(4)
    v_mfma_f32_32x32x16_bf16 v[16:31], v[120:123], v[156:159], v[16:31]
    ds_read_b64_tr_b16 v[112:113], v80 offset:2048
    ds_read_b64_tr_b16 v[114:115], v80 offset:3072
    buffer_load_dwordx4 v[140:143], v78, s[40:43], s36 offen offset:2048 sc1
    v_mfma_f32_32x32x16_bf16 v[32:47], v[124:127], v[156:159], v[32:47]
    ds_read_b64_tr_b16 v[116:117], v81 offset:2048
    ds_read_b64_tr_b16 v[118:119], v81 offset:3072
    v_readfirstlane_b32 s76, v79
    s_nop 0
    s_and_b32 s76, s76, s52
    s_cbranch_scc0 L_tr9
L_bk9:
    s_ff1_i32_b32 s76, s76
    s_bitset0_b32 s52, s76
    s_add_u32 s77, s76, s65
    s_and_b32 s77, s77, 15
    s_mul_i32 s77, s77, 32768
    s_add_u32 s37, s77, s80
    s_waitcnt vmcnt(11) lgkmcnt(4)
    v_mfma_f32_32x32x16_bf16 v[16:31], v[104:107], v[160:163], v[16:31]
    ds_read_b64_tr_b16 v[120:121], v80 offset:4096
    ds_read_b64_tr_b16 v[122:123], v80 offset:5120
    buffer_load_dwordx4 v[144:147], v14, s[40:43], s37 offen offset:0 sc1
    s_add_u32 s76, s76, 3
    s_and_b32 s76, s76, 15
    s_lshl_b32 s13, s76, 13
    v_mfma_f32_32x32x16_bf16 v[32:47], v[108:111], v[160:163], v[32:47]
    ds_read_b64_tr_b16 v[124:125], v81 offset:4096
    ds_read_b64_tr_b16 v[126:127], v81 offset:5120
    s_waitcnt vmcnt(11) lgkmcnt(4)
    v_mfma_f32_32x32x16_bf16 v[16:31], v[112:115], v[164:167], v[16:31]
    ds_read_b64_tr_b16 v[104:105], v80 offset:6144
    ds_read_b64_tr_b16 v[106:107], v80 offset:7168
    buffer_load_dwordx4 v[148:151], v14, s[40:43], s37 offen offset:2048 sc1
    v_mfma_f32_32x32x16_bf16 v[32:47], v[116:119], v[164:167], v[32:47]
    ds_read_b64_tr_b16 v[108:109], v81 offset:6144
    ds_read_b64_tr_b16 v[110:111], v81 offset:7168
    v_add_u32 v82, s11, v72
    v_add_u32 v83, s11, v73
    s_waitcnt vmcnt(11) lgkmcnt(4)
    v_mfma_f32_32x32x16_bf16 v[16:31], v[120:123], v[168:171], v[16:31]
    ds_read_b32 v79, v8 offset:25984
    ds_read_b64_tr_b16 v[112:113], v82 offset:0
    ds_read_b64_tr_b16 v[114:115], v82 offset:1024
    buffer_load_dwordx4 v[152:155], v78, s[40:43], s37 offen offset:0 sc1
    v_mfma_f32_32x32x16_bf16 v[32:47], v[124:127], v[168:171], v[32:47]
    ds_read_b64_tr_b16 v[116:117], v83 offset:0
    ds_read_b64_tr_b16 v[118:119], v83 offset:1024
    s_waitcnt vmcnt(11) lgkmcnt(4)
    v_mfma_f32_32x32x16_bf16 v[16:31], v[104:107], v[172:175], v[16:31]
    ds_read_b64_tr_b16 v[120:121], v82 offset:2048
    ds_read_b64_tr_b16 v[122:123], v82 offset:3072
    buffer_load_dwordx4 v[156:159], v78, s[40:43], s37 offen offset:2048 sc1
    v_mfma_f32_32x32x16_bf16 v[32:47], v[108:111], v[172:175], v[32:47]
    ds_read_b64_tr_b16 v[124:125], v83 offset:2048
    ds_read_b64_tr_b16 v[126:127], v83 offset:3072
    v_readfirstlane_b32 s76, v79
    s_nop 0
    s_and_b32 s76, s76, s52
    s_cbranch_scc0 L_tr10
L_bk10:
    s_ff1_i32_b32 s76, s76
    s_bitset0_b32 s52, s76
    s_add_u32 s77, s76, s65
    s_and_b32 s77, s77, 15
    s_mul_i32 s77, s77, 32768
    s_add_u32 s38, s77, s80
    s_waitcnt vmcnt(11) lgkmcnt(4)
    v_mfma_f32_32x32x16_bf16 v[16:31], v[112:115], v[176:179], v[16:31]
    ds_read_b64_tr_b16 v[104:105], v82 offset:4096
    ds_read_b64_tr_b16 v[106:107], v82 offset:5120
    buffer_load_dwordx4 v[160:163], v14, s[40:43], s38 offen offset:0 sc1
    s_add_u32 s76, s76, 3
    s_and_b32 s76, s76, 15
    s_lshl_b32 s14, s76, 13
    v_mfma_f32_32x32x16_bf16 v[32:47], v[116:119], v[176:179], v[32:47]
    ds_read_b64_tr_b16 v[108:109], v83 offset:4096
    ds_read_b64_tr_b16 v[110:111], v83 offset:5120
    s_waitcnt vmcnt(11) lgkmcnt(4)
    v_mfma_f32_32x32x16_bf16 v[16:31], v[120:123], v[180:183], v[16:31]
    ds_read_b64_tr_b16 v[112:113], v82 offset:6144
    ds_read_b64_tr_b16 v[114:115], v82 offset:7168
    buffer_load_dwordx4 v[164:167], v14, s[40:43], s38 offen offset:2048 sc1
    v_mfma_f32_32x32x16_bf16 v[32:47], v[124:127], v[180:183], v[32:47]
    ds_read_b64_tr_b16 v[116:117], v83 offset:6144
    ds_read_b64_tr_b16 v[118:119], v83 offset:7168
    v_add_u32 v80, s12, v72
    v_add_u32 v81, s12, v73
    s_waitcnt vmcnt(11) lgkmcnt(4)
    v_mfma_f32_32x32x16_bf16 v[16:31], v[104:107], v[184:187], v[16:31]
    ds_read_b32 v79, v8 offset:25984
    ds_read_b64_tr_b16 v[120:121], v80 offset:0
    ds_read_b64_tr_b16 v[122:123], v80 offset:1024
    buffer_load_dwordx4 v[168:171], v78, s[40:43], s38 offen offset:0 sc1
    v_mfma_f32_32x32x16_bf16 v[32:47], v[108:111], v[184:187], v[32:47]
    ds_read_b64_tr_b16 v[124:125], v81 offset:0
    ds_read_b64_tr_b16 v[126:127], v81 offset:1024
    s_waitcnt vmcnt(11) lgkmcnt(4)
    v_mfma_f32_32x32x16_bf16 v[16:31], v[112:115], v[188:191], v[16:31]
    ds_read_b64_tr_b16 v[104:105], v80 offset:2048
    ds_read_b64_tr_b16 v[106:107], v80 offset:3072
    buffer_load_dwordx4 v[172:175], v78, s[40:43], s38 offen offset:2048 sc1
    v_mfma_f32_32x32x16_bf16 v[32:47], v[116:119], v[188:191], v[32:47]
    ds_read_b64_tr_b16 v[108:109], v81 offset:2048
    ds_read_b64_tr_b16 v[110:111], v81 offset:3072
    v_readfirstlane_b32 s76, v79
    s_nop 0
    s_and_b32 s76, s76, s52
    s_cbranch_scc0 L_tr11
L_bk11:
    s_ff1_i32_b32 s76, s76
    s_bitset0_b32 s52, s76
    s_add_u32 s77, s76, s65
    s_and_b32 s77, s77, 15
    s_mul_i32 s77, s77, 32768
    s_add_u32 s39, s77, s80
    s_waitcnt vmcnt(11) lgkmcnt(4)
    v_mfma_f32_32x32x16_bf16 v[16:31], v[120:123], v[128:131], v[16:31]
    ds_read_b64_tr_b16 v[112:113], v80 offset:4096
    ds_read_b64_tr_b16 v[114:115], v80 offset:5120
    buffer_load_dwordx4 v[176:179], v14, s[40:43], s39 offen offset:0 sc1
    s_add_u32 s76, s76, 3
    s_and_b32 s76, s76, 15
    s_lshl_b32 s15, s76, 13
    v_mfma_f32_32x32x16_bf16 v[32:47], v[124:127], v[128:131], v[32:47]
    ds_read_b64_tr_b16 v[116:117], v81 offset:4096
    ds_read_b64_tr_b16 v[118:119], v81 offset:5120
    s_waitcnt vmcnt(11) lgkmcnt(4)
    v_mfma_f32_32x32x16_bf16 v[16:31], v[104:107], v[132:135], v[16:31]
    ds_read_b64_tr_b16 v[120:121], v80 offset:6144
    ds_read_b64_tr_b16 v[122:123], v80 offset:7168
    buffer_load_dwordx4 v[180:183], v14, s[40:43], s39 offen offset:2048 sc1
    v_mfma_f32_32x32x16_bf16 v[32:47], v[108:111], v[132:135], v[32:47]
    ds_read_b64_tr_b16 v[124:125], v81 offset:6144
    ds_read_b64_tr_b16 v[126:127], v81 offset:7168
    v_add_u32 v82, s13, v72
    v_add_u32 v83, s13, v73
    s_waitcnt vmcnt(11) lgkmcnt(4)
    v_mfma_f32_32x32x16_bf16 v[16:31], v[112:115], v[136:139], v[16:31]
    ds_read_b32 v79, v8 offset:25984
    ds_read_b64_tr_b16 v[104:105], v82 offset:0
    ds_read_b64_tr_b16 v[106:107], v82 offset:1024
    buffer_load_dwordx4 v[184:187], v78, s[40:43], s39 offen offset:0 sc1
    v_mfma_f32_32x32x16_bf16 v[32:47], v[116:119], v[136:139], v[32:47]
    ds_read_b64_tr_b16 v[108:109], v83 offset:0
    ds_read_b64_tr_b16 v[110:111], v83 offset:1024
    s_waitcnt vmcnt(11) lgkmcnt(4)
    v_mfma_f32_32x32x16_bf16 v[16:31], v[120:123], v[140:143], v[16:31]
    ds_read_b64_tr_b16 v[112:113], v82 offset:2048
    ds_read_b64_tr_b16 v[114:115], v82 offset:3072
    buffer_load_dwordx4 v[188:191], v78, s[40:43], s39 offen offset:2048 sc1
    v_mfma_f32_32x32x16_bf16 v[32:47], v[124:127], v[140:143], v[32:47]
    ds_read_b64_tr_b16 v[116:117], v83 offset:2048
    ds_read_b64_tr_b16 v[118:119], v83 offset:3072
    v_readfirstlane_b32 s76, v79
    s_nop 0
    s_and_b32 s76, s76, s52
    s_cbranch_scc0 L_tr12
L_bk12:
    s_ff1_i32_b32 s76, s76
    s_bitset0_b32 s52, s76
    s_add_u32 s77, s76, s65
    s_and_b32 s77, s77, 15
    s_mul_i32 s77, s77, 32768
    s_add_u32 s48, s77, s80
    s_waitcnt vmcnt(11) lgkmcnt(4)
    v_mfma_f32_32x32x16_bf16 v[16:31], v[104:107], v[144:147], v[16:31]
    ds_read_b64_tr_b16 v[120:121], v82 offset:4096
    ds_read_b64_tr_b16 v[122:123], v82 offset:5120
    buffer_load_dwordx4 v[128:131], v14, s[40:43], s48 offen offset:0 sc1
    s_add_u32 s76, s76, 3
    s_and_b32 s76, s76, 15
    s_lshl_b32 s16, s76, 13
    v_mfma_f32_32x32x16_bf16 v[32:47], v[108:111], v[144:147], v[32:47]
    ds_read_b64_tr_b16 v[124:125], v83 offset:4096
    ds_read_b64_tr_b16 v[126:127], v83 offset:5120
    s_waitcnt vmcnt(11) lgkmcnt(4)
    v_mfma_f32_32x32x16_bf16 v[16:31], v[112:115], v[148:151], v[16:31]
    ds_read_b64_tr_b16 v[104:105], v82 offset:6144
    ds_read_b64_tr_b16 v[106:107], v82 offset:7168
    buffer_load_dwordx4 v[132:135], v14, s[40:43], s48 offen offset:2048 sc1
    v_mfma_f32_32x32x16_bf16 v[32:47], v[116:119], v[148:151], v[32:47]
    ds_read_b64_tr_b16 v[108:109], v83 offset:6144
    ds_read_b64_tr_b16 v[110:111], v83 offset:7168
    v_add_u32 v80, s14, v72
    v_add_u32 v81, s14, v73
    s_waitcnt vmcnt(11) lgkmcnt(4)
    v_mfma_f32_32x32x16_bf16 v[16:31], v[120:123], v[152:155], v[16:31]
    ds_read_b32 v79, v8 offset:25984
    ds_read_b64_tr_b16 v[112:113], v80 offset:0
    ds_read_b64_tr_b16 v[114:115], v80 offset:1024
    buffer_load_dwordx4 v[136:139], v78, s[40:43], s48 offen offset:0 sc1
    v_mfma_f32_32x32x16_bf16 v[32:47], v[124:127], v[152:155], v[32:47]
    ds_read_b64_tr_b16 v[116:117], v81 offset:0
    ds_read_b64_tr_b16 v[118:119], v81 offset:1024
    s_waitcnt vmcnt(11) lgkmcnt(4)
    v_mfma_f32_32x32x16_bf16 v[16:31], v[104:107], v[156:159], v[16:31]
    ds_read_b64_tr_b16 v[120:121], v80 offset:2048
    ds_read_b64_tr_b16 v[122:123], v80 offset:3072
    buffer_load_dwordx4 v[140:143], v78, s[40:43], s48 offen offset:2048 sc1
    v_mfma_f32_32x32x16_bf16 v[32:47], v[108:111], v[156:159], v[32:47]
    ds_read_b64_tr_b16 v[124:125], v81 offset:2048
    ds_read_b64_tr_b16 v[126:127], v81 offset:3072
    v_readfirstlane_b32 s76, v79
    s_nop 0
    s_and_b32 s76, s76, s52
    s_cbranch_scc0 L_tr13
L_bk13:
    s_ff1_i32_b32 s76, s76
    s_bitset0_b32 s52, s76
    s_add_u32 s77, s76, s65
    s_and_b32 s77, s77, 15
    s_mul_i32 s77, s77, 32768
    s_add_u32 s49, s77, s80
    s_waitcnt vmcnt(11) lgkmcnt(4)
    v_mfma_f32_32x32x16_bf16 v[16:31], v[112:115], v[160:163], v[16:31]
    ds_read_b64_tr_b16 v[104:105], v80 offset:4096
    ds_read_b64_tr_b16 v[106:107], v80 offset:5120
    buffer_load_dwordx4 v[144:147], v14, s[40:43], s49 offen offset:0 sc1
    s_add_u32 s76, s76, 3
    s_and_b32 s76, s76, 15
    s_lshl_b32 s17, s76, 13
    v_mfma_f32_32x32x16_bf16 v[32:47], v[116:119], v[160:163], v[32:47]
    ds_read_b64_tr_b16 v[108:109], v81 offset:4096
    ds_read_b64_tr_b16 v[110:111], v81 offset:5120
    s_waitcnt vmcnt(11) lgkmcnt(4)
    v_mfma_f32_32x32x16_bf16 v[16:31], v[120:123], v[164:167], v[16:31]
    ds_read_b64_tr_b16 v[112:113], v80 offset:6144
    ds_read_b64_tr_b16 v[114:115], v80 offset:7168
    buffer_load_dwordx4 v[148:151], v14, s[40:43], s49 offen offset:2048 sc1
    v_mfma_f32_32x32x16_bf16 v[32:47], v[124:127], v[164:167], v[32:47]
    ds_read_b64_tr_b16 v[116:117], v81 offset:6144
    ds_read_b64_tr_b16 v[118:119], v81 offset:7168
    v_add_u32 v82, s15, v72
    v_add_u32 v83, s15, v73
    s_waitcnt vmcnt(11) lgkmcnt(4)
    v_mfma_f32_32x32x16_bf16 v[16:31], v[104:107], v[168:171], v[16:31]
    ds_read_b32 v79, v8 offset:25984
    ds_read_b64_tr_b16 v[120:121], v82 offset:0
    ds_read_b64_tr_b16 v[122:123], v82 offset:1024
    buffer_load_dwordx4 v[152:155], v78, s[40:43], s49 offen offset:0 sc1
    v_mfma_f32_32x32x16_bf16 v[32:47], v[108:111], v[168:171], v[32:47]
    ds_read_b64_tr_b16 v[124:125], v83 offset:0
    ds_read_b64_tr_b16 v[126:127], v83 offset:1024
    s_waitcnt vmcnt(11) lgkmcnt(4)
    v_mfma_f32_32x32x16_bf16 v[16:31], v[112:115], v[172:175], v[16:31]
    ds_read_b64_tr_b16 v[104:105], v82 offset:2048
    ds_read_b64_tr_b16 v[106:107], v82 offset:3072
    buffer_load_dwordx4 v[156:159], v78, s[40:43], s49 offen offset:2048 sc1
    v_mfma_f32_32x32x16_bf16 v[32:47], v[116:119], v[172:175], v[32:47]
    ds_read_b64_tr_b16 v[108:109], v83 offset:2048
    ds_read_b64_tr_b16 v[110:111], v83 offset:3072
    v_readfirstlane_b32 s76, v79
    s_nop 0
    s_and_b32 s76, s76, s52
    s_cbranch_scc0 L_tr14
L_bk14:
    s_ff1_i32_b32 s76, s76
    s_bitset0_b32 s52, s76
    s_add_u32 s77, s76, s65
    s_and_b32 s77, s77, 15
    s_mul_i32 s77, s77, 32768
    s_add_u32 s50, s77, s80
    s_waitcnt vmcnt(11) lgkmcnt(4)
    v_mfma_f32_32x32x16_bf16 v[16:31], v[120:123], v[176:179], v[16:31]
    ds_read_b64_tr_b16 v[112:113], v82 offset:4096
    ds_read_b64_tr_b16 v[114:115], v82 offset:5120
    buffer_load_dwordx4 v[160:163], v14, s[40:43], s50 offen offset:0 sc1
    s_add_u32 s76, s76, 3
    s_and_b32 s76, s76, 15
    s_lshl_b32 s18, s76, 13
    v_mfma_f32_32x32x16_bf16 v[32:47], v[124:127], v[176:179], v[32:47]
    ds_read_b64_tr_b16 v[116:117], v83 offset:4096
    ds_read_b64_tr_b16 v[118:119], v83 offset:5120
    s_waitcnt vmcnt(11) lgkmcnt(4)
    v_mfma_f32_32x32x16_bf16 v[16:31], v[104:107], v[180:183], v[16:31]
    ds_read_b64_tr_b16 v[120:121], v82 offset:6144
    ds_read_b64_tr_b16 v[122:123], v82 offset:7168
    buffer_load_dwordx4 v[164:167], v14, s[40:43], s50 offen offset:2048 sc1
    v_mfma_f32_32x32x16_bf16 v[32:47], v[108:111], v[180:183], v[32:47]
    ds_read_b64_tr_b16 v[124:125], v83 offset:6144
    ds_read_b64_tr_b16 v[126:127], v83 offset:7168
    v_add_u32 v80, s16, v72
    v_add_u32 v81, s16, v73
    s_waitcnt vmcnt(11) lgkmcnt(4)
    v_mfma_f32_32x32x16_bf16 v[16:31], v[112:115], v[184:187], v[16:31]
    ds_read_b32 v79, v8 offset:25984
    ds_read_b64_tr_b16 v[104:105], v80 offset:0
    ds_read_b64_tr_b16 v[106:107], v80 offset:1024
    buffer_load_dwordx4 v[168:171], v78, s[40:43], s50 offen offset:0 sc1
    v_mfma_f32_32x32x16_bf16 v[32:47], v[116:119], v[184:187], v[32:47]
    ds_read_b64_tr_b16 v[108:109], v81 offset:0
    ds_read_b64_tr_b16 v[110:111], v81 offset:1024
    s_waitcnt vmcnt(11) lgkmcnt(4)
    v_mfma_f32_32x32x16_bf16 v[16:31], v[120:123], v[188:191], v[16:31]
    ds_read_b64_tr_b16 v[112:113], v80 offset:2048
    ds_read_b64_tr_b16 v[114:115], v80 offset:3072
    buffer_load_dwordx4 v[172:175], v78, s[40:43], s50 offen offset:2048 sc1
    v_mfma_f32_32x32x16_bf16 v[32:47], v[124:127], v[188:191], v[32:47]
    ds_read_b64_tr_b16 v[116:117], v81 offset:2048
    ds_read_b64_tr_b16 v[118:119], v81 offset:3072
    v_readfirstlane_b32 s76, v79
    s_nop 0
    s_and_b32 s76, s76, s52
    s_cbranch_scc0 L_tr15
L_bk15:
    s_ff1_i32_b32 s76, s76
    s_bitset0_b32 s52, s76
    s_add_u32 s77, s76, s65
    s_and_b32 s77, s77, 15
    s_mul_i32 s77, s77, 32768
    s_add_u32 s51, s77, s80
    s_waitcnt vmcnt(11) lgkmcnt(4)
    v_mfma_f32_32x32x16_bf16 v[16:31], v[104:107], v[128:131], v[16:31]
    ds_read_b64_tr_b16 v[120:121], v80 offset:4096
    ds_read_b64_tr_b16 v[122:123], v80 offset:5120
    buffer_load_dwordx4 v[176:179], v14, s[40:43], s51 offen offset:0 sc1
    s_add_u32 s76, s76, 3
    s_and_b32 s76, s76, 15
    s_lshl_b32 s19, s76, 13
    v_mfma_f32_32x32x16_bf16 v[32:47], v[108:111], v[128:131], v[32:47]
    ds_read_b64_tr_b16 v[124:125], v81 offset:4096
    ds_read_b64_tr_b16 v[126:127], v81 offset:5120
    s_waitcnt vmcnt(11) lgkmcnt(4)
    v_mfma_f32_32x32x16_bf16 v[16:31], v[112:115], v[132:135], v[16:31]
    ds_read_b64_tr_b16 v[104:105], v80 offset:6144
    ds_read_b64_tr_b16 v[106:107], v80 offset:7168
    buffer_load_dwordx4 v[180:183], v14, s[40:43], s51 offen offset:2048 sc1
    v_mfma_f32_32x32x16_bf16 v[32:47], v[116:119], v[132:135], v[32:47]
    ds_read_b64_tr_b16 v[108:109], v81 offset:6144
    ds_read_b64_tr_b16 v[110:111], v81 offset:7168
    v_add_u32 v82, s17, v72
    v_add_u32 v83, s17, v73
    s_waitcnt vmcnt(11) lgkmcnt(4)
    v_mfma_f32_32x32x16_bf16 v[16:31], v[120:123], v[136:139], v[16:31]
    ds_read_b64 v[192:193], v10 offset:16384
    ds_read_b64_tr_b16 v[112:113], v82 offset:0
    ds_read_b64_tr_b16 v[114:115], v82 offset:1024
    buffer_load_dwordx4 v[184:187], v78, s[40:43], s51 offen offset:0 sc1
    v_mfma_f32_32x32x16_bf16 v[32:47], v[124:127], v[136:139], v[32:47]
    ds_read_b64_tr_b16 v[116:117], v83 offset:0
    ds_read_b64_tr_b16 v[118:119], v83 offset:1024
    s_waitcnt vmcnt(11) lgkmcnt(4)
    v_mfma_f32_32x32x16_bf16 v[16:31], v[104:107], v[140:143], v[16:31]
    ds_read_b64 v[194:195], v10 offset:16400
    ds_read_b64_tr_b16 v[120:121], v82 offset:2048
    ds_read_b64_tr_b16 v[122:123], v82 offset:3072
    buffer_load_dwordx4 v[188:191], v78, s[40:43], s51 offen offset:2048 sc1
    s_barrier
    v_mfma_f32_32x32x16_bf16 v[32:47], v[108:111], v[140:143], v[32:47]
    ds_read_b64_tr_b16 v[124:125], v83 offset:2048
    ds_read_b64_tr_b16 v[126:127], v83 offset:3072
    s_waitcnt vmcnt(11) lgkmcnt(4)
    v_mfma_f32_32x32x16_bf16 v[16:31], v[112:115], v[144:147], v[16:31]
    ds_read_b64 v[196:197], v10 offset:16416
    ds_read_b64_tr_b16 v[104:105], v82 offset:4096
    ds_read_b64_tr_b16 v[106:107], v82 offset:5120
    v_mfma_f32_32x32x16_bf16 v[32:47], v[116:119], v[144:147], v[32:47]
    ds_read_b64_tr_b16 v[108:109], v83 offset:4096
    ds_read_b64_tr_b16 v[110:111], v83 offset:5120
    s_waitcnt vmcnt(10) lgkmcnt(4)
    v_mfma_f32_32x32x16_bf16 v[16:31], v[120:123], v[148:151], v[16:31]
    ds_read_b64 v[198:199], v10 offset:16432
    ds_read_b64_tr_b16 v[112:113], v82 offset:6144
    ds_read_b64_tr_b16 v[114:115], v82 offset:7168
    v_mfma_f32_32x32x16_bf16 v[32:47], v[124:127], v[148:151], v[32:47]
    ds_read_b64_tr_b16 v[116:117], v83 offset:6144
    ds_read_b64_tr_b16 v[118:119], v83 offset:7168
    v_add_u32 v80, s18, v72
    v_add_u32_e64 v81, s18, v73
    s_waitcnt vmcnt(9) lgkmcnt(4)
    v_mfma_f32_32x32x16_bf16 v[16:31], v[104:107], v[152:155], v[16:31]
    ds_read_b64 v[200:201], v10 offset:16448
    ds_read_b64_tr_b16 v[120:121], v80 offset:0
    ds_read_b64_tr_b16 v[122:123], v80 offset:1024
    v_mfma_f32_32x32x16_bf16 v[32:47], v[108:111], v[152:155], v[32:47]
    ds_read_b64_tr_b16 v[124:125], v81 offset:0
    ds_read_b64_tr_b16 v[126:127], v81 offset:1024
    s_waitcnt vmcnt(8) lgkmcnt(4)
    v_mfma_f32_32x32x16_bf16 v[16:31], v[112:115], v[156:159], v[16:31]
    ds_read_b64 v[202:203], v10 offset:16464
    ds_read_b64_tr_b16 v[104:105], v80 offset:2048
    ds_read_b64_tr_b16 v[106:107], v80 offset:3072
    v_mfma_f32_32x32x16_bf16 v[32:47], v[116:119], v[156:159], v[32:47]
    ds_read_b64_tr_b16 v[108:109], v81 offset:2048
    ds_read_b64_tr_b16 v[110:111], v81 offset:3072
    s_waitcnt vmcnt(7) lgkmcnt(4)
    v_mfma_f32_32x32x16_bf16 v[16:31], v[120:123], v[160:163], v[16:31]
    ds_read_b64 v[204:205], v10 offset:16480
    ds_read_b64_tr_b16 v[112:113], v80 offset:4096
    ds_read_b64_tr_b16 v[114:115], v80 offset:5120
    v_mfma_f32_32x32x16_bf16 v[32:47], v[124:127], v[160:163], v[32:47]
    ds_read_b64_tr_b16 v[116:117], v81 offset:4096
    ds_read_b64_tr_b16 v[118:119], v81 offset:5120
    s_waitcnt vmcnt(6) lgkmcnt(4)
    v_mfma_f32_32x32x16_bf16 v[16:31], v[104:107], v[164:167], v[16:31]
    ds_read_b64 v[206:207], v10 offset:16496
    ds_read_b64_tr_b16 v[120:121], v80 offset:6144
    ds_read_b64_tr_b16 v[122:123], v80 offset:7168
    v_mfma_f32_32x32x16_bf16 v[32:47], v[108:111], v[164:167], v[32:47]
    ds_read_b64_tr_b16 v[124:125], v81 offset:6144
    ds_read_b64_tr_b16 v[126:127], v81 offset:7168
    v_add_u32 v82, s19, v72
    v_add_u32 v83, s19, v73
    s_waitcnt vmcnt(5) lgkmcnt(4)
    v_mfma_f32_32x32x16_bf16 v[16:31], v[112:115], v[168:171], v[16:31]
    ds_read_b128 v[208:211], v11 offset:16384
    ds_read_b64_tr_b16 v[104:105], v82 offset:0
    ds_read_b64_tr_b16 v[106:107], v82 offset:1024
    v_mfma_f32_32x32x16_bf16 v[32:47], v[116:119], v[168:171], v[32:47]
    ds_read_b64_tr_b16 v[108:109], v83 offset:0
    ds_read_b64_tr_b16 v[110:111], v83 offset:1024
    s_waitcnt vmcnt(4) lgkmcnt(4)
    v_mfma_f32_32x32x16_bf16 v[16:31], v[120:123], v[172:175], v[16:31]
    ds_read_b128 v[212:215], v11 offset:16400
    ds_read_b64_tr_b16 v[112:113], v82 offset:2048
    ds_read_b64_tr_b16 v[114:115], v82 offset:3072
    v_mfma_f32_32x32x16_bf16 v[32:47], v[124:127], v[172:175], v[32:47]
    ds_read_b64_tr_b16 v[116:117], v83 offset:2048
    ds_read_b64_tr_b16 v[118:119], v83 offset:3072
    s_waitcnt vmcnt(3) lgkmcnt(4)
    v_mfma_f32_32x32x16_bf16 v[16:31], v[104:107], v[176:179], v[16:31]
    ds_read_b64_tr_b16 v[120:121], v82 offset:4096
    ds_read_b64_tr_b16 v[122:123], v82 offset:5120
    v_mfma_f32_32x32x16_bf16 v[32:47], v[108:111], v[176:179], v[32:47]
    ds_read_b64_tr_b16 v[124:125], v83 offset:4096
    ds_read_b64_tr_b16 v[126:127], v83 offset:5120
    s_waitcnt vmcnt(2) lgkmcnt(4)
    v_mfma_f32_32x32x16_bf16 v[16:31], v[112:115], v[180:183], v[16:31]
    ds_read_b64_tr_b16 v[104:105], v82 offset:6144
    ds_read_b64_tr_b16 v[106:107], v82 offset:7168
    v_mfma_f32_32x32x16_bf16 v[32:47], v[116:119], v[180:183], v[32:47]
    ds_read_b64_tr_b16 v[108:109], v83 offset:6144
    ds_read_b64_tr_b16 v[110:111], v83 offset:7168
    s_waitcnt vmcnt(1) lgkmcnt(4)
    v_mfma_f32_32x32x16_bf16 v[16:31], v[120:123], v[184:187], v[16:31]
    v_mfma_f32_32x32x16_bf16 v[32:47], v[124:127], v[184:187], v[32:47]
    s_waitcnt vmcnt(0) lgkmcnt(0)
    v_mfma_f32_32x32x16_bf16 v[16:31], v[104:107], v[188:191], v[16:31]
    v_mfma_f32_32x32x16_bf16 v[32:47], v[108:111], v[188:191], v[32:47]
    s_nop 10
    v_cvt_pk_bf16_f32 v88, v16, v17
    v_cvt_pk_bf16_f32 v89, v18, v19
    v_cvt_pk_bf16_f32 v90, v20, v21
    v_cvt_pk_bf16_f32 v91, v22, v23
    v_cvt_pk_bf16_f32 v92, v24, v25
    v_cvt_pk_bf16_f32 v93, v26, v27
    v_cvt_pk_bf16_f32 v94, v28, v29
    v_cvt_pk_bf16_f32 v95, v30, v31
    v_cvt_pk_bf16_f32 v96, v32, v33
    v_cvt_pk_bf16_f32 v97, v34, v35
    v_cvt_pk_bf16_f32 v98, v36, v37
    v_cvt_pk_bf16_f32 v99, v38, v39
    v_cvt_pk_bf16_f32 v100, v40, v41
    v_cvt_pk_bf16_f32 v101, v42, v43
    v_cvt_pk_bf16_f32 v102, v44, v45
    v_cvt_pk_bf16_f32 v103, v46, v47
    v_dot2_f32_bf16 v104, v88, s89, 0
    v_dot2_f32_bf16 v105, v88, v88, 0
    v_dot2_f32_bf16 v106, v88, v192, 0
    v_dot2_f32_bf16 v104, v89, s89, v104
    v_dot2_f32_bf16 v105, v89, v89, v105
    v_dot2_f32_bf16 v106, v89, v193, v106
    v_dot2_f32_bf16 v104, v90, s89, v104
    v_dot2_f32_bf16 v105, v90, v90, v105
    v_dot2_f32_bf16 v106, v90, v194, v106
    v_dot2_f32_bf16 v104, v91, s89, v104
    v_dot2_f32_bf16 v105, v91, v91, v105
    v_dot2_f32_bf16 v106, v91, v195, v106
    v_dot2_f32_bf16 v104, v92, s89, v104
    v_dot2_f32_bf16 v105, v92, v92, v105
    v_dot2_f32_bf16 v106, v92, v196, v106
    v_dot2_f32_bf16 v104, v93, s89, v104
    v_dot2_f32_bf16 v105, v93, v93, v105
    v_dot2_f32_bf16 v106, v93, v197, v106
    v_dot2_f32_bf16 v104, v94, s89, v104
    v_dot2_f32_bf16 v105, v94, v94, v105
    v_dot2_f32_bf16 v106, v94, v198, v106
    v_dot2_f32_bf16 v104, v95, s89, v104
    v_dot2_f32_bf16 v105, v95, v95, v105
    v_dot2_f32_bf16 v106, v95, v199, v106
    v_dot2_f32_bf16 v104, v96, s89, v104
    v_dot2_f32_bf16 v105, v96, v96, v105
    v_dot2_f32_bf16 v106, v96, v200, v106
    v_dot2_f32_bf16 v104, v97, s89, v104
    v_dot2_f32_bf16 v105, v97, v97, v105
    v_dot2_f32_bf16 v106, v97, v201, v106
    v_dot2_f32_bf16 v104, v98, s89, v104
    v_dot2_f32_bf16 v105, v98, v98, v105
    v_dot2_f32_bf16 v106, v98, v202, v106
    v_dot2_f32_bf16 v104, v99, s89, v104
    v_dot2_f32_bf16 v105, v99, v99, v105
    v_dot2_f32_bf16 v106, v99, v203, v106
    v_dot2_f32_bf16 v104, v100, s89, v104
    v_dot2_f32_bf16 v105, v100, v100, v105
    v_dot2_f32_bf16 v106, v100, v204, v106
    v_dot2_f32_bf16 v104, v101, s89, v104
    v_dot2_f32_bf16 v105, v101, v101, v105
    v_dot2_f32_bf16 v106, v101, v205, v106
    v_dot2_f32_bf16 v104, v102, s89, v104
    v_dot2_f32_bf16 v105, v102, v102, v105
    v_dot2_f32_bf16 v106, v102, v206, v106
    v_dot2_f32_bf16 v104, v103, s89, v104
    v_dot2_f32_bf16 v105, v103, v103, v105
    v_dot2_f32_bf16 v106, v103, v207, v106
    s_lshl_b32 s76, s62, 9
    s_add_u32 s77, s76, s99
    v_mov_b32 v107, 0
    v_mov_b32 v4, v104
    v_mov_b32 v5, v105
    v_mov_b32 v6, v106
    v_permlane32_swap_b32 v104, v4
    v_permlane32_swap_b32 v105, v5
    v_permlane32_swap_b32 v106, v6
    v_add_f32 v104, v104, v4
    v_add_f32 v105, v105, v5
    v_add_f32_e64 v106, v106, v6
    s_mov_b32 exec_hi, 0
    s_bitcmp1_b32 s100, 1
    s_cbranch_scc1 L_loc_67
    buffer_store_dwordx4 v[104:107], v12, s[40:43], s77 offen offset:1024 sc1
    s_branch L_pubd_68
L_loc_67:
    buffer_store_dwordx4 v[104:107], v12, s[40:43], s77 offen offset:1024
L_pubd_68:
    s_mov_b64 exec, -1
    ds_write_b64 v64, v[88:89]
    ds_write_b64 v65, v[90:91]
    ds_write_b64 v66, v[92:93]
    ds_write_b64 v67, v[94:95]
    ds_write_b64 v68, v[96:97]
    ds_write_b64 v69, v[98:99]
    ds_write_b64 v70, v[100:101]
    ds_write_b64 v71, v[102:103]
    v_bfe_u32 v4, v1, 1, 3
    v_bfe_u32 v5, v1, 4, 1
    v_lshlrev_b32_e64 v176, 4, v4
    v_lshl_add_u32 v176, v5, 3, v176
    v_and_b32_e64 v5, 1, v1
    v_lshl_add_u32 v176, v5, 2, v176
    v_lshlrev_b32_e64 v177, 2, v2
    v_lshl_add_u32 v177, v3, 8, v177
    v_and_b32 v4, 15, v1
    v_lshrrev_b32 v5, 4, v1
    v_mul_u32_u24 v179, 149504, v4
    v_lshl_add_u32 v180, v5, 4, v179
    s_lshl_b32 s82, s97, 7
    s_lshl_b32 s79, s62, 5
    s_add_u32 s82, s82, s79
    s_lshl_b32 s79, s62, 2
    v_mov_b32_e64 v7, s79
    v_mul_u32_u24 v178, 9344, v3
    v_lshl_add_u32 v178, v2, 4, v178
    s_mul_i32 s78, s97, 149504
    s_add_u32 s78, s78, s76
    s_add_u32 s78, s78, 8388608
    s_add_u32 s48, s78, 18688
    s_add_u32 s49, s48, 18688
    s_add_u32 s50, s49, 18688
    s_add_u32 s51, s50, 18688
    s_add_u32 s52, s51, 18688
    s_add_u32 s53, s52, 18688
    s_add_u32 s54, s53, 18688
    buffer_load_dwordx4 v[112:115], v178, s[40:43], s78 offen offset:1024 sc1
    buffer_load_dwordx4 v[116:119], v178, s[40:43], s48 offen offset:1024 sc1
    buffer_load_dwordx4 v[120:123], v178, s[40:43], s49 offen offset:1024 sc1
    buffer_load_dwordx4 v[124:127], v178, s[40:43], s50 offen offset:1024 sc1
    buffer_load_dwordx4 v[128:131], v178, s[40:43], s51 offen offset:1024 sc1
    buffer_load_dwordx4 v[132:135], v178, s[40:43], s52 offen offset:1024 sc1
    buffer_load_dwordx4 v[136:139], v178, s[40:43], s53 offen offset:1024 sc1
    buffer_load_dwordx4 v[140:143], v178, s[40:43], s54 offen offset:1024 sc1
    v_dot2_f32_bf16 v76, v208, s89, 0
    v_dot2_f32_bf16 v76, v209, s89, v76
    v_dot2_f32_bf16 v76, v210, s89, v76
    v_dot2_f32_bf16 v76, v211, s89, v76
    v_dot2_f32_bf16 v76, v212, s89, v76
    v_dot2_f32_bf16 v76, v213, s89, v76
    v_dot2_f32_bf16 v76, v214, s89, v76
    v_dot2_f32_bf16 v76, v215, s89, v76
    s_nop 2
    v_add_f32_dpp v76, v76, v76 row_ror:8 row_mask:0xf bank_mask:0xf
    s_nop 1
    v_add_f32_dpp v76, v76, v76 row_ror:4 row_mask:0xf bank_mask:0xf
    s_nop 1
    v_add_f32_dpp v76, v76, v76 row_ror:2 row_mask:0xf bank_mask:0xf
    s_nop 1
    v_add_f32_dpp v76, v76, v76 row_ror:1 row_mask:0xf bank_mask:0xf
    v_mov_b32 v4, v76
    s_nop 1
    v_permlane16_swap_b32 v76, v4
    v_add_f32 v76, v76, v4
    v_mov_b32 v4, v76
    s_nop 1
    v_permlane32_swap_b32 v76, v4
    v_add_f32_e64 v76, v76, v4
    s_mov_b32 s88, 0
    s_waitcnt vmcnt(6)
    v_pk_add_f32 v[108:109], v[112:113], v[116:117]
    v_pk_add_f32 v[110:111], v[114:115], v[118:119]
    s_waitcnt vmcnt(5)
    v_pk_add_f32 v[108:109], v[108:109], v[120:121]
    v_pk_add_f32 v[110:111], v[110:111], v[122:123]
    s_waitcnt vmcnt(4)
    v_pk_add_f32 v[108:109], v[108:109], v[124:125]
    v_pk_add_f32 v[110:111], v[110:111], v[126:127]
    s_waitcnt vmcnt(3)
    v_pk_add_f32 v[108:109], v[108:109], v[128:129]
    v_pk_add_f32 v[110:111], v[110:111], v[130:131]
    s_waitcnt vmcnt(2)
    v_pk_add_f32 v[108:109], v[108:109], v[132:133]
    v_pk_add_f32 v[110:111], v[110:111], v[134:135]
    s_waitcnt vmcnt(1)
    v_pk_add_f32 v[108:109], v[108:109], v[136:137]
    v_pk_add_f32 v[110:111], v[110:111], v[138:139]
    s_waitcnt vmcnt(0)
    v_pk_add_f32 v[108:109], v[108:109], v[140:141]
    v_pk_add_f32 v[110:111], v[110:111], v[142:143]
    v_cmp_u_f32 vcc, v111, v111
    v_mov_b32 v4, v108
    v_mov_b32 v5, v109
    v_mov_b32 v6, v110
    s_cbranch_vccnz L_s3_70
L_s3ok_71:
    v_permlane32_swap_b32 v108, v4
    v_permlane32_swap_b32 v109, v5
    v_permlane32_swap_b32 v110, v6
    s_barrier
    v_add_f32 v108, v108, v4
    v_add_f32 v109, v109, v5
    v_add_f32 v110, v110, v6
    v_mul_f32 v108, 0x3a800000, v108
    v_mul_f32 v109, 0x3a800000, v109
    v_fma_f32 v4, -v108, v108, v109
    v_max_f32_e64 v4, 0, v4
    v_cvt_pk_bf16_f32 v116, v108, v108
    v_and_b32_e64 v116, s90, v116
    v_cvt_pk_bf16_f32 v4, v4, v4
    v_and_b32_e64 v4, s90, v4
    v_add_f32 v4, 0x3727c5ac, v4
    v_cvt_pk_bf16_f32 v4, v4, v4
    v_and_b32 v4, s90, v4
    v_sqrt_f32_e64 v4, v4
    s_nop 0
    v_cvt_pk_bf16_f32 v4, v4, v4
    v_and_b32 v4, s90, v4
    v_rcp_f32 v118, v4
    v_fma_f32 v120, -v116, v76, v110
    v_mul_f32 v119, v116, v118
    v_mul_f32 v120, v120, v118
    v_and_b32 v6, 3, v1
    v_lshlrev_b32 v6, 2, v6
    v_max_f32_dpp v4, v120, v120 row_ror:8 row_mask:0xf bank_mask:0xf
    s_lshl_b32 s83, s62, 12
    v_cmp_gt_u32 s[84:85], 32, v1
    v_max_f32_dpp v4, v4, v4 row_ror:4 row_mask:0xf bank_mask:0xf
    s_lshl_b32 s55, 1, s62
    s_sub_u32 s55, s55, 1
    v_max_f32_dpp v4, v4, v4 row_ror:2 row_mask:0xf bank_mask:0xf
    s_nop 1
    v_max_f32_dpp v4, v4, v4 row_ror:1 row_mask:0xf bank_mask:0xf
    v_mov_b32 v5, v4
    s_nop 1
    v_permlane16_swap_b32 v4, v5
    v_max_f32 v4, v4, v5
    v_cmp_eq_f32_e64 vcc, v4, v120
    ds_write_b32 v7, v4 offset:25600
    s_ff1_i32_b32 s77, vcc_lo
    s_and_b32 s77, s77, 31
    s_bfe_u32 s79, s77, 0x30001
    s_lshl3_add_u32 s79, s77, s79
    s_lshl4_add_u32 s79, s79, s83
    v_xor_b32_e64 v176, s79, v176
    ds_read_b32 v182, v176 offset:0
    s_waitcnt lgkmcnt(1)
    s_barrier
    ds_read_b32 v8, v6 offset:25600
    v_readlane_b32 s80, v118, s77
    v_readlane_b32 s81, v119, s77
    s_add_u32 s79, s82, s77
    v_writelane_b32 v4, s79, 33
    v_mov_b32 v5, s81
    s_waitcnt lgkmcnt(1)
    v_lshlrev_b32 v184, 16, v182
    v_and_b32_e64 v185, s90, v182
    v_fma_f32 v184, v184, s80, -v5
    v_fma_f32 v185, v185, s80, -v5
    v_cvt_pk_bf16_f32 v184, v184, v185
    v_cndmask_b32 v184, v4, v184, s[84:85]
    s_waitcnt lgkmcnt(0)
    v_cmp_eq_f32 s[56:57], v8, v4
    v_cmp_gt_f32 vcc, v8, v4
    s_and_b32 s56, s56, s55
    s_or_b32 s56, s56, vcc_lo
    s_cbranch_scc1 L_nopub_80
    buffer_store_dword v184, v177, s[40:43], s99 offen offset:0 sc1
L_nopub_80:
    v_lshlrev_b32 v16, 16, v88
    v_and_b32_e64 v17, s90, v88
    v_pk_fma_f32 v[144:145], v[16:17], v[118:119], v[118:119] op_sel:[0,0,1] op_sel_hi:[1,0,1] neg_lo:[0,0,1] neg_hi:[0,0,1]
    v_cvt_pk_bf16_f32 v124, v144, v145
    v_lshlrev_b32 v144, 16, v124
    v_and_b32 v145, s90, v124
    v_pk_add_f32 v[144:145], v[144:145], v[16:17]
    v_cvt_pk_bf16_f32 v124, v144, v145
    v_lshlrev_b32 v18, 16, v89
    v_and_b32 v19, s90, v89
    v_pk_fma_f32 v[146:147], v[18:19], v[118:119], v[118:119] op_sel:[0,0,1] op_sel_hi:[1,0,1] neg_lo:[0,0,1] neg_hi:[0,0,1]
    v_cvt_pk_bf16_f32 v125, v146, v147
    v_lshlrev_b32 v146, 16, v125
    v_and_b32 v147, s90, v125
    v_pk_add_f32 v[146:147], v[146:147], v[18:19]
    v_cvt_pk_bf16_f32 v125, v146, v147
    ds_write_b64 v64, v[124:125]
    v_lshlrev_b32 v20, 16, v90
    v_and_b32 v21, s90, v90
    v_pk_fma_f32 v[148:149], v[20:21], v[118:119], v[118:119] op_sel:[0,0,1] op_sel_hi:[1,0,1] neg_lo:[0,0,1] neg_hi:[0,0,1]
    v_cvt_pk_bf16_f32 v126, v148, v149
    v_lshlrev_b32 v148, 16, v126
    v_and_b32 v149, s90, v126
    v_pk_add_f32 v[148:149], v[148:149], v[20:21]
    v_cvt_pk_bf16_f32 v126, v148, v149
    v_lshlrev_b32 v22, 16, v91
    v_and_b32 v23, s90, v91
    v_pk_fma_f32 v[150:151], v[22:23], v[118:119], v[118:119] op_sel:[0,0,1] op_sel_hi:[1,0,1] neg_lo:[0,0,1] neg_hi:[0,0,1]
    v_cvt_pk_bf16_f32 v127, v150, v151
    v_lshlrev_b32 v150, 16, v127
    v_and_b32 v151, s90, v127
    v_pk_add_f32 v[150:151], v[150:151], v[22:23]
    v_cvt_pk_bf16_f32 v127, v150, v151
    ds_write_b64 v65, v[126:127]
    s_cmp_eq_u32 s56, 0
    s_cbranch_scc1 L_stay_81
    s_cmp_gt_u32 s62, 1
    s_cbranch_scc0 L_stay_81
    s_mov_b32 s91, -1
    v_lshlrev_b32 v24, 16, v92
    v_and_b32_e64 v25, s90, v92
    v_pk_fma_f32 v[152:153], v[24:25], v[118:119], v[118:119] op_sel:[0,0,1] op_sel_hi:[1,0,1] neg_lo:[0,0,1] neg_hi:[0,0,1]
    v_cvt_pk_bf16_f32 v128, v152, v153
    v_lshlrev_b32 v152, 16, v128
    v_and_b32 v153, s90, v128
    v_pk_add_f32 v[152:153], v[152:153], v[24:25]
    v_cvt_pk_bf16_f32 v128, v152, v153
    v_lshlrev_b32 v26, 16, v93
    v_and_b32 v27, s90, v93
    v_pk_fma_f32 v[154:155], v[26:27], v[118:119], v[118:119] op_sel:[0,0,1] op_sel_hi:[1,0,1] neg_lo:[0,0,1] neg_hi:[0,0,1]
    v_cvt_pk_bf16_f32 v129, v154, v155
    v_lshlrev_b32 v154, 16, v129
    v_and_b32 v155, s90, v129
    v_pk_add_f32 v[154:155], v[154:155], v[26:27]
    v_cvt_pk_bf16_f32 v129, v154, v155
    ds_write_b64 v66, v[128:129]
    v_lshlrev_b32 v28, 16, v94
    v_and_b32 v29, s90, v94
    v_pk_fma_f32 v[156:157], v[28:29], v[118:119], v[118:119] op_sel:[0,0,1] op_sel_hi:[1,0,1] neg_lo:[0,0,1] neg_hi:[0,0,1]
    v_cvt_pk_bf16_f32 v130, v156, v157
    v_lshlrev_b32 v156, 16, v130
    v_and_b32 v157, s90, v130
    v_pk_add_f32 v[156:157], v[156:157], v[28:29]
    v_cvt_pk_bf16_f32 v130, v156, v157
    v_lshlrev_b32 v30, 16, v95
    v_and_b32 v31, s90, v95
    v_pk_fma_f32 v[158:159], v[30:31], v[118:119], v[118:119] op_sel:[0,0,1] op_sel_hi:[1,0,1] neg_lo:[0,0,1] neg_hi:[0,0,1]
    v_cvt_pk_bf16_f32 v131, v158, v159
    v_lshlrev_b32 v158, 16, v131
    v_and_b32 v159, s90, v131
    v_pk_add_f32 v[158:159], v[158:159], v[30:31]
    v_cvt_pk_bf16_f32 v131, v158, v159
    ds_write_b64 v67, v[130:131]
    v_lshlrev_b32 v32, 16, v96
    v_and_b32 v33, s90, v96
    v_pk_fma_f32 v[160:161], v[32:33], v[118:119], v[118:119] op_sel:[0,0,1] op_sel_hi:[1,0,1] neg_lo:[0,0,1] neg_hi:[0,0,1]
    v_cvt_pk_bf16_f32 v132, v160, v161
    v_lshlrev_b32 v160, 16, v132
    v_and_b32 v161, s90, v132
    v_pk_add_f32 v[160:161], v[160:161], v[32:33]
    v_cvt_pk_bf16_f32 v132, v160, v161
    v_lshlrev_b32 v34, 16, v97
    v_and_b32 v35, s90, v97
    v_pk_fma_f32 v[162:163], v[34:35], v[118:119], v[118:119] op_sel:[0,0,1] op_sel_hi:[1,0,1] neg_lo:[0,0,1] neg_hi:[0,0,1]
    v_cvt_pk_bf16_f32 v133, v162, v163
    v_lshlrev_b32 v162, 16, v133
    v_and_b32 v163, s90, v133
    v_pk_add_f32 v[162:163], v[162:163], v[34:35]
    v_cvt_pk_bf16_f32 v133, v162, v163
    ds_write_b64 v68, v[132:133]
    v_lshlrev_b32 v36, 16, v98
    v_and_b32 v37, s90, v98
    v_pk_fma_f32 v[164:165], v[36:37], v[118:119], v[118:119] op_sel:[0,0,1] op_sel_hi:[1,0,1] neg_lo:[0,0,1] neg_hi:[0,0,1]
    v_cvt_pk_bf16_f32 v134, v164, v165
    v_lshlrev_b32 v164, 16, v134
    v_and_b32 v165, s90, v134
    v_pk_add_f32 v[164:165], v[164:165], v[36:37]
    v_cvt_pk_bf16_f32 v134, v164, v165
    v_lshlrev_b32 v38, 16, v99
    v_and_b32 v39, s90, v99
    v_pk_fma_f32 v[166:167], v[38:39], v[118:119], v[118:119] op_sel:[0,0,1] op_sel_hi:[1,0,1] neg_lo:[0,0,1] neg_hi:[0,0,1]
    v_cvt_pk_bf16_f32 v135, v166, v167
    v_lshlrev_b32 v166, 16, v135
    v_and_b32 v167, s90, v135
    v_pk_add_f32 v[166:167], v[166:167], v[38:39]
    v_cvt_pk_bf16_f32 v135, v166, v167
    ds_write_b64 v69, v[134:135]
    v_lshlrev_b32 v40, 16, v100
    v_and_b32 v41, s90, v100
    v_pk_fma_f32 v[168:169], v[40:41], v[118:119], v[118:119] op_sel:[0,0,1] op_sel_hi:[1,0,1] neg_lo:[0,0,1] neg_hi:[0,0,1]
    v_cvt_pk_bf16_f32 v136, v168, v169
    v_lshlrev_b32 v168, 16, v136
    v_and_b32 v169, s90, v136
    v_pk_add_f32 v[168:169], v[168:169], v[40:41]
    v_cvt_pk_bf16_f32 v136, v168, v169
    v_lshlrev_b32 v42, 16, v101
    v_and_b32 v43, s90, v101
    v_pk_fma_f32 v[170:171], v[42:43], v[118:119], v[118:119] op_sel:[0,0,1] op_sel_hi:[1,0,1] neg_lo:[0,0,1] neg_hi:[0,0,1]
    v_cvt_pk_bf16_f32 v137, v170, v171
    v_lshlrev_b32 v170, 16, v137
    v_and_b32 v171, s90, v137
    v_pk_add_f32 v[170:171], v[170:171], v[42:43]
    v_cvt_pk_bf16_f32 v137, v170, v171
    ds_write_b64 v70, v[136:137]
    v_lshlrev_b32 v44, 16, v102
    v_and_b32 v45, s90, v102
    v_pk_fma_f32 v[172:173], v[44:45], v[118:119], v[118:119] op_sel:[0,0,1] op_sel_hi:[1,0,1] neg_lo:[0,0,1] neg_hi:[0,0,1]
    v_cvt_pk_bf16_f32 v138, v172, v173
    v_lshlrev_b32 v172, 16, v138
    v_and_b32 v173, s90, v138
    v_pk_add_f32 v[172:173], v[172:173], v[44:45]
    v_cvt_pk_bf16_f32 v138, v172, v173
    v_lshlrev_b32 v46, 16, v103
    v_and_b32 v47, s90, v103
    v_pk_fma_f32 v[174:175], v[46:47], v[118:119], v[118:119] op_sel:[0,0,1] op_sel_hi:[1,0,1] neg_lo:[0,0,1] neg_hi:[0,0,1]
    v_cvt_pk_bf16_f32 v139, v174, v175
    v_lshlrev_b32 v174, 16, v139
    v_and_b32 v175, s90, v139
    v_pk_add_f32 v[174:175], v[174:175], v[46:47]
    v_cvt_pk_bf16_f32 v139, v174, v175
    ds_write_b64 v71, v[138:139]
    s_sub_u32 s77, s91, s82
    v_lshrrev_b32 v7, 3, v1
    v_sub_u32_e64 v5, s77, v7
    v_mov_b32 v6, 2146435072
    v_and_b32 v8, 7, v1
    v_lshrrev_b32 v9, 4, v1
    v_xor_b32 v8, v8, v9
    v_lshlrev_b32 v8, 4, v8
    v_lshl_add_u32 v7, v7, 11, v8
    v_xor_b32 v8, 64, v7
    s_lshl_b32 s58, s82, 11
    s_lshl_b32 s59, s98, 7
    s_add_u32 s58, s58, s59
    v_cmp_eq_u32 vcc, 0, v5
    s_nop 1
    v_cndmask_b32 v200, v7, v6, vcc
    v_cmp_eq_u32 vcc, 8, v5
    s_nop 1
    v_cndmask_b32 v201, v8, v6, vcc
    v_cmp_eq_u32 vcc, 16, v5
    s_nop 1
    v_cndmask_b32 v202, v7, v6, vcc
    v_cmp_eq_u32 vcc, 24, v5
    s_nop 1
    v_cndmask_b32 v203, v8, v6, vcc
    s_lshl_b32 s77, s62, 12
    s_add_u32 s77, s77, 0
    v_add_u32 v4, s77, v12
    s_waitcnt lgkmcnt(0)
    ds_read_b128 v[48:51], v4 offset:0
    ds_read_b128 v[52:55], v4 offset:1024
    ds_read_b128 v[56:59], v4 offset:2048
    ds_read_b128 v[60:63], v4 offset:3072
    s_waitcnt lgkmcnt(3)
    buffer_store_dwordx4 v[48:51], v200, s[44:47], s58 offen sc1
    s_add_u32 s58, s58, 16384
    s_waitcnt lgkmcnt(2)
    buffer_store_dwordx4 v[52:55], v201, s[44:47], s58 offen sc1
    s_add_u32 s58, s58, 16384
    s_waitcnt lgkmcnt(1)
    buffer_store_dwordx4 v[56:59], v202, s[44:47], s58 offen sc1
    s_add_u32 s58, s58, 16384
    s_waitcnt lgkmcnt(0)
    buffer_store_dwordx4 v[60:63], v203, s[44:47], s58 offen sc1
    s_barrier
    s_barrier
    s_branch L_cdone
L_stay_81:
    v_and_b32 v7, 15, v1
    v_lshlrev_b32_e64 v7, 3, v7
    s_cmp_eq_u32 s62, 0
    s_cbranch_scc0 L_nos4_82
    s_mul_i32 s76, s98, 9344
    s_add_u32 s76, s76, 8388608
    s_add_u32 s20, s26, s99
    s_addc_u32 s21, s27, 0
    s_mov_b32 s88, 0
L_spin_83:
    s_load_dwordx16 s[4:19], s[20:21], 768 glc
    s_waitcnt lgkmcnt(0)
    s_or_b64 s[4:5], s[4:5], s[6:7]
    s_or_b64 s[4:5], s[4:5], s[8:9]
    s_or_b64 s[4:5], s[4:5], s[10:11]
    s_or_b64 s[4:5], s[4:5], s[12:13]
    s_or_b64 s[4:5], s[4:5], s[14:15]
    s_or_b64 s[4:5], s[4:5], s[16:17]
    s_or_b64 s[4:5], s[4:5], s[18:19]
    s_cbranch_scc0 L_gate_84
    s_add_u32 s88, s88, 1
    s_cmp_lt_u32 s88, 65536
    s_cbranch_scc1 L_spin_83
L_gate_84:
    s_mov_b32 s88, 0
L_poll_85:
    buffer_load_dwordx2 v[196:197], v179, s[40:43], s76 offen offset:256 sc1
    buffer_load_dwordx4 v[188:191], v180, s[40:43], s76 offen offset:0 sc1
    buffer_load_dwordx4 v[192:195], v180, s[40:43], s76 offen offset:64 sc1
    s_waitcnt vmcnt(0)
    v_max3_u32 v4, v196, v197, v188
    v_max3_u32 v4, v4, v189, v190
    v_max3_u32 v4, v4, v191, v192
    v_max3_u32 v4, v4, v193, v194
    v_max_u32 v4, v4, v195
    v_cmp_eq_u32_e64 vcc, -1, v4
    s_nop 0
    s_cbranch_vccz L_ok_86
    s_add_u32 s88, s88, 1
    s_cmp_lt_u32 s88, 65536
    s_cbranch_scc1 L_poll_85
L_ok_86:
    ds_write_b128 v12, v[188:191] offset:28672
    ds_write_b128 v12, v[192:195] offset:29696
    ds_write_b64 v7, v[196:197] offset:25728
L_nos4_82:
    s_waitcnt lgkmcnt(0)
    s_barrier
    ds_read_b64 v[8:9], v7 offset:25728
    s_waitcnt lgkmcnt(0)
    v_max_f32_dpp v4, v8, v8 row_ror:8 row_mask:0xf bank_mask:0xf
    s_nop 1
    v_max_f32_dpp v4, v4, v4 row_ror:4 row_mask:0xf bank_mask:0xf
    s_nop 1
    v_max_f32_dpp v4, v4, v4 row_ror:2 row_mask:0xf bank_mask:0xf
    s_nop 1
    v_max_f32_dpp v4, v4, v4 row_ror:1 row_mask:0xf bank_mask:0xf
    v_cmp_eq_f32 vcc, v4, v8
    s_nop 0
    s_ff1_i32_b32 s92, vcc_lo
    s_and_b32 s92, s92, 15
    s_nop 3
    v_readlane_b32 s91, v9, s92
    s_nop 0
    s_cmp_eq_u32 s91, s79
    s_cbranch_scc0 L_noh_87
    s_mov_b32 exec_hi, 0
    buffer_store_dword v182, v177, s[40:43], s99 offen offset:128 sc1
    s_mov_b64 exec, -1
L_noh_87:
    s_sub_u32 s77, s91, s82
    v_lshrrev_b32 v7, 3, v1
    v_sub_u32 v5, s77, v7
    v_mov_b32 v6, 2146435072
    v_and_b32 v8, 7, v1
    v_lshrrev_b32 v9, 4, v1
    v_xor_b32 v8, v8, v9
    v_lshlrev_b32 v8, 4, v8
    v_lshl_add_u32 v7, v7, 11, v8
    v_xor_b32 v8, 64, v7
    s_lshl_b32 s58, s82, 11
    s_lshl_b32 s59, s98, 7
    s_add_u32 s58, s58, s59
    v_cmp_eq_u32 vcc, 0, v5
    s_nop 1
    v_cndmask_b32 v200, v7, v6, vcc
    v_cmp_eq_u32 vcc, 8, v5
    s_nop 1
    v_cndmask_b32 v201, v8, v6, vcc
    v_cmp_eq_u32 vcc, 16, v5
    s_nop 1
    v_cndmask_b32 v202, v7, v6, vcc
    v_cmp_eq_u32 vcc, 24, v5
    s_nop 1
    v_cndmask_b32 v203, v8, v6, vcc
    s_lshl_b32 s77, s62, 12
    s_add_u32 s77, s77, 0
    v_add_u32 v4, s77, v12
    v_lshlrev_b32 v24, 16, v92
    v_and_b32_e64 v25, s90, v92
    v_pk_fma_f32 v[152:153], v[24:25], v[118:119], v[118:119] op_sel:[0,0,1] op_sel_hi:[1,0,1] neg_lo:[0,0,1] neg_hi:[0,0,1]
    v_cvt_pk_bf16_f32 v128, v152, v153
    v_lshlrev_b32 v152, 16, v128
    v_and_b32 v153, s90, v128
    v_pk_add_f32 v[152:153], v[152:153], v[24:25]
    v_cvt_pk_bf16_f32 v128, v152, v153
    v_lshlrev_b32 v26, 16, v93
    v_and_b32 v27, s90, v93
    v_pk_fma_f32 v[154:155], v[26:27], v[118:119], v[118:119] op_sel:[0,0,1] op_sel_hi:[1,0,1] neg_lo:[0,0,1] neg_hi:[0,0,1]
    v_cvt_pk_bf16_f32 v129, v154, v155
    v_lshlrev_b32 v154, 16, v129
    v_and_b32 v155, s90, v129
    v_pk_add_f32 v[154:155], v[154:155], v[26:27]
    v_cvt_pk_bf16_f32 v129, v154, v155
    ds_write_b64 v66, v[128:129]
    v_lshlrev_b32 v28, 16, v94
    v_and_b32 v29, s90, v94
    v_pk_fma_f32 v[156:157], v[28:29], v[118:119], v[118:119] op_sel:[0,0,1] op_sel_hi:[1,0,1] neg_lo:[0,0,1] neg_hi:[0,0,1]
    v_cvt_pk_bf16_f32 v130, v156, v157
    v_lshlrev_b32 v156, 16, v130
    v_and_b32 v157, s90, v130
    v_pk_add_f32 v[156:157], v[156:157], v[28:29]
    v_cvt_pk_bf16_f32 v130, v156, v157
    v_lshlrev_b32 v30, 16, v95
    v_and_b32 v31, s90, v95
    v_pk_fma_f32 v[158:159], v[30:31], v[118:119], v[118:119] op_sel:[0,0,1] op_sel_hi:[1,0,1] neg_lo:[0,0,1] neg_hi:[0,0,1]
    v_cvt_pk_bf16_f32 v131, v158, v159
    v_lshlrev_b32 v158, 16, v131
    v_and_b32 v159, s90, v131
    v_pk_add_f32 v[158:159], v[158:159], v[30:31]
    v_cvt_pk_bf16_f32 v131, v158, v159
    ds_write_b64 v67, v[130:131]
    v_lshlrev_b32 v32, 16, v96
    v_and_b32 v33, s90, v96
    v_pk_fma_f32 v[160:161], v[32:33], v[118:119], v[118:119] op_sel:[0,0,1] op_sel_hi:[1,0,1] neg_lo:[0,0,1] neg_hi:[0,0,1]
    v_cvt_pk_bf16_f32 v132, v160, v161
    v_lshlrev_b32 v160, 16, v132
    v_and_b32 v161, s90, v132
    v_pk_add_f32 v[160:161], v[160:161], v[32:33]
    v_cvt_pk_bf16_f32 v132, v160, v161
    v_lshlrev_b32 v34, 16, v97
    v_and_b32 v35, s90, v97
    v_pk_fma_f32 v[162:163], v[34:35], v[118:119], v[118:119] op_sel:[0,0,1] op_sel_hi:[1,0,1] neg_lo:[0,0,1] neg_hi:[0,0,1]
    v_cvt_pk_bf16_f32 v133, v162, v163
    v_lshlrev_b32 v162, 16, v133
    v_and_b32 v163, s90, v133
    v_pk_add_f32 v[162:163], v[162:163], v[34:35]
    v_cvt_pk_bf16_f32 v133, v162, v163
    ds_write_b64 v68, v[132:133]
    v_lshlrev_b32 v36, 16, v98
    v_and_b32 v37, s90, v98
    v_pk_fma_f32 v[164:165], v[36:37], v[118:119], v[118:119] op_sel:[0,0,1] op_sel_hi:[1,0,1] neg_lo:[0,0,1] neg_hi:[0,0,1]
    v_cvt_pk_bf16_f32 v134, v164, v165
    v_lshlrev_b32 v164, 16, v134
    v_and_b32 v165, s90, v134
    v_pk_add_f32 v[164:165], v[164:165], v[36:37]
    v_cvt_pk_bf16_f32 v134, v164, v165
    v_lshlrev_b32 v38, 16, v99
    v_and_b32 v39, s90, v99
    v_pk_fma_f32 v[166:167], v[38:39], v[118:119], v[118:119] op_sel:[0,0,1] op_sel_hi:[1,0,1] neg_lo:[0,0,1] neg_hi:[0,0,1]
    v_cvt_pk_bf16_f32 v135, v166, v167
    v_lshlrev_b32 v166, 16, v135
    v_and_b32 v167, s90, v135
    v_pk_add_f32 v[166:167], v[166:167], v[38:39]
    v_cvt_pk_bf16_f32 v135, v166, v167
    ds_write_b64 v69, v[134:135]
    v_lshlrev_b32 v40, 16, v100
    v_and_b32 v41, s90, v100
    v_pk_fma_f32 v[168:169], v[40:41], v[118:119], v[118:119] op_sel:[0,0,1] op_sel_hi:[1,0,1] neg_lo:[0,0,1] neg_hi:[0,0,1]
    v_cvt_pk_bf16_f32 v136, v168, v169
    v_lshlrev_b32 v168, 16, v136
    v_and_b32 v169, s90, v136
    v_pk_add_f32 v[168:169], v[168:169], v[40:41]
    v_cvt_pk_bf16_f32 v136, v168, v169
    v_lshlrev_b32 v42, 16, v101
    v_and_b32 v43, s90, v101
    v_pk_fma_f32 v[170:171], v[42:43], v[118:119], v[118:119] op_sel:[0,0,1] op_sel_hi:[1,0,1] neg_lo:[0,0,1] neg_hi:[0,0,1]
    v_cvt_pk_bf16_f32 v137, v170, v171
    v_lshlrev_b32 v170, 16, v137
    v_and_b32 v171, s90, v137
    v_pk_add_f32 v[170:171], v[170:171], v[42:43]
    v_cvt_pk_bf16_f32 v137, v170, v171
    ds_write_b64 v70, v[136:137]
    v_lshlrev_b32 v44, 16, v102
    v_and_b32 v45, s90, v102
    v_pk_fma_f32 v[172:173], v[44:45], v[118:119], v[118:119] op_sel:[0,0,1] op_sel_hi:[1,0,1] neg_lo:[0,0,1] neg_hi:[0,0,1]
    v_cvt_pk_bf16_f32 v138, v172, v173
    v_lshlrev_b32 v172, 16, v138
    v_and_b32 v173, s90, v138
    v_pk_add_f32 v[172:173], v[172:173], v[44:45]
    v_cvt_pk_bf16_f32 v138, v172, v173
    v_lshlrev_b32 v46, 16, v103
    v_and_b32 v47, s90, v103
    v_pk_fma_f32 v[174:175], v[46:47], v[118:119], v[118:119] op_sel:[0,0,1] op_sel_hi:[1,0,1] neg_lo:[0,0,1] neg_hi:[0,0,1]
    v_cvt_pk_bf16_f32 v139, v174, v175
    v_lshlrev_b32 v174, 16, v139
    v_and_b32 v175, s90, v139
    v_pk_add_f32 v[174:175], v[174:175], v[46:47]
    v_cvt_pk_bf16_f32 v139, v174, v175
    ds_write_b64 v71, v[138:139]
    s_barrier
    s_waitcnt lgkmcnt(0)
    ds_read_b128 v[48:51], v4 offset:0
    ds_read_b128 v[52:55], v4 offset:1024
    ds_read_b128 v[56:59], v4 offset:2048
    ds_read_b128 v[60:63], v4 offset:3072
    s_waitcnt lgkmcnt(3)
    buffer_store_dwordx4 v[48:51], v200, s[44:47], s58 offen sc1
    s_add_u32 s58, s58, 16384
    s_waitcnt lgkmcnt(2)
    buffer_store_dwordx4 v[52:55], v201, s[44:47], s58 offen sc1
    s_add_u32 s58, s58, 16384
    s_waitcnt lgkmcnt(1)
    buffer_store_dwordx4 v[56:59], v202, s[44:47], s58 offen sc1
    s_add_u32 s58, s58, 16384
    s_waitcnt lgkmcnt(0)
    buffer_store_dwordx4 v[60:63], v203, s[44:47], s58 offen sc1
L_cdone:
L_cfin:
L_end:
    s_endpgm
L_tr0:
    s_call_b64 s[54:55], L_stall
    s_branch L_bk0
L_tr1:
    s_call_b64 s[54:55], L_stall
    s_branch L_bk1
L_tr2:
    s_call_b64 s[54:55], L_stall
    s_branch L_bk2
L_tr3:
    s_call_b64 s[54:55], L_stall
    s_branch L_bk3
L_tr4:
    s_call_b64 s[54:55], L_stall
    s_branch L_bk4
L_tr5:
    s_call_b64 s[54:55], L_stall
    s_branch L_bk5
L_tr6:
    s_call_b64 s[54:55], L_stall
    s_branch L_bk6
L_tr7:
    s_call_b64 s[54:55], L_stall
    s_branch L_bk7
L_tr8:
    s_call_b64 s[54:55], L_stall
    s_branch L_bk8
L_tr9:
    s_call_b64 s[54:55], L_stall
    s_branch L_bk9
L_tr10:
    s_call_b64 s[54:55], L_stall
    s_branch L_bk10
L_tr11:
    s_call_b64 s[54:55], L_stall
    s_branch L_bk11
L_tr12:
    s_call_b64 s[54:55], L_stall
    s_branch L_bk12
L_tr13:
    s_call_b64 s[54:55], L_stall
    s_branch L_bk13
L_tr14:
    s_call_b64 s[54:55], L_stall
    s_branch L_bk14
L_tr15:
    s_call_b64 s[54:55], L_stall
    s_branch L_bk15
L_stall:
    s_cmp_eq_u32 s53, 0
    s_cbranch_scc0 L_sent_66
    s_waitcnt vmcnt(0)
    s_mov_b64 exec, 1
    ds_add_u32 v8, v74 offset:25988
    s_mov_b64 exec, -1
    s_mov_b32 s53, 1
L_sent_66:
    s_mov_b32 s88, 0
L_stall1:
    ds_read_b32 v79, v8 offset:25984
    s_waitcnt lgkmcnt(0)
    v_readfirstlane_b32 s76, v79
    s_nop 0
    s_and_b32 s76, s76, s52
    s_cbranch_scc1 L_stall2
    s_add_u32 s88, s88, 1
    s_cmp_lt_u32 s88, 1048576
    s_cbranch_scc1 L_stall1
    s_mov_b32 s76, s52
L_stall2:
    s_setpc_b64 s[54:55]
L_s3_70:
    v_cmp_eq_u32 vcc, -1, v115
    s_nop 0
    s_cbranch_vccz L_s3skip_72
    buffer_load_dwordx4 v[112:115], v178, s[40:43], s78 offen offset:1024 sc1
L_s3skip_72:
    v_cmp_eq_u32_e64 vcc, -1, v119
    s_nop 0
    s_cbranch_vccz L_s3skip_73
    buffer_load_dwordx4 v[116:119], v178, s[40:43], s48 offen offset:1024 sc1
L_s3skip_73:
    v_cmp_eq_u32_e64 vcc, -1, v123
    s_nop 0
    s_cbranch_vccz L_s3skip_74
    buffer_load_dwordx4 v[120:123], v178, s[40:43], s49 offen offset:1024 sc1
L_s3skip_74:
    v_cmp_eq_u32_e64 vcc, -1, v127
    s_nop 0
    s_cbranch_vccz L_s3skip_75
    buffer_load_dwordx4 v[124:127], v178, s[40:43], s50 offen offset:1024 sc1
L_s3skip_75:
    v_cmp_eq_u32_e64 vcc, -1, v131
    s_nop 0
    s_cbranch_vccz L_s3skip_76
    buffer_load_dwordx4 v[128:131], v178, s[40:43], s51 offen offset:1024 sc1
L_s3skip_76:
    v_cmp_eq_u32_e64 vcc, -1, v135
    s_nop 0
    s_cbranch_vccz L_s3skip_77
    buffer_load_dwordx4 v[132:135], v178, s[40:43], s52 offen offset:1024 sc1
L_s3skip_77:
    v_cmp_eq_u32_e64 vcc, -1, v139
    s_nop 0
    s_cbranch_vccz L_s3skip_78
    buffer_load_dwordx4 v[136:139], v178, s[40:43], s53 offen offset:1024 sc1
L_s3skip_78:
    v_cmp_eq_u32_e64 vcc, -1, v143
    s_nop 0
    s_cbranch_vccz L_s3skip_79
    buffer_load_dwordx4 v[140:143], v178, s[40:43], s54 offen offset:1024 sc1
L_s3skip_79:
    s_waitcnt vmcnt(0)
    v_pk_add_f32 v[108:109], v[112:113], v[116:117]
    v_pk_add_f32 v[110:111], v[114:115], v[118:119]
    v_pk_add_f32 v[108:109], v[108:109], v[120:121]
    v_pk_add_f32 v[110:111], v[110:111], v[122:123]
    v_pk_add_f32 v[108:109], v[108:109], v[124:125]
    v_pk_add_f32 v[110:111], v[110:111], v[126:127]
    v_pk_add_f32 v[108:109], v[108:109], v[128:129]
    v_pk_add_f32 v[110:111], v[110:111], v[130:131]
    v_pk_add_f32 v[108:109], v[108:109], v[132:133]
    v_pk_add_f32 v[110:111], v[110:111], v[134:135]
    v_pk_add_f32 v[108:109], v[108:109], v[136:137]
    v_pk_add_f32 v[110:111], v[110:111], v[138:139]
    v_pk_add_f32 v[108:109], v[108:109], v[140:141]
    v_pk_add_f32 v[110:111], v[110:111], v[142:143]
    v_cmp_u_f32 vcc, v111, v111
    v_mov_b32 v4, v108
    v_mov_b32 v5, v109
    v_mov_b32_e64 v6, v110
    s_cbranch_vccz L_s3ok_71
    s_add_u32 s88, s88, 1
    s_cmp_lt_u32 s88, 65536
    s_cbranch_scc1 L_s3_70
    s_branch L_s3ok_71
L_code_end:
s_endpgm
.p2align 7
.type L_table,@object
L_table:
.long 0x650c3824, 0xfedba97, 0x50102, 0x3006
.long 0x650c3824, 0xfedba97, 0x510200, 0x3060
.long 0x641d0935, 0xfecba87, 0x5020001, 0x3600
.long 0x76543218, 0xfedcba9, 0x15000002, 0x6300
.long 0x641d0935, 0xfecba87, 0x25100, 0x3006
.long 0x54e2a160, 0xfdcb987, 0x502001, 0x3060
.long 0x54e2a160, 0xfdcb987, 0x5002010, 0x3600
.long 0x54f3b271, 0xedca986, 0x50201000, 0x6300
.long 0x54f3b271, 0xedca986, 0x152000, 0x3006
.long 0x650c3824, 0xfedba97, 0x520010, 0x3060
.long 0x650c3824, 0xfedba97, 0x5020001, 0x3600
.long 0x76543218, 0xfedcba9, 0x50000012, 0x6300
.long 0x641d0935, 0xfecba87, 0x25010, 0x3006
.long 0x641d0935, 0xfecba87, 0x510020, 0x3060
.long 0x54e2a160, 0xfdcb987, 0x5100002, 0x3600
.long 0x54e2a160, 0xfdcb987, 0x50001002, 0x6300
.long 0x641d0935, 0xfecba87, 0x500210, 0x3060
.long 0x641d0935, 0xfecba87, 0x5010200, 0x3600
.long 0x54e2a160, 0xfdcb987, 0x50100002, 0x6300
.long 0x76543209, 0xfedcba8, 0x15002, 0x3006
.long 0x54e2a160, 0xfdcb987, 0x501002, 0x3060
.long 0x54f3b271, 0xedca986, 0x5000120, 0x3600
.long 0x54f3b271, 0xedca986, 0x50000012, 0x6300
.long 0x650c3824, 0xfedba97, 0x15200, 0x3006
.long 0x650c3824, 0xfedba97, 0x520100, 0x3060
.long 0x641d0935, 0xfecba87, 0x5001200, 0x3600
.long 0x641d0935, 0xfecba87, 0x50020001, 0x6300
.long 0x76543209, 0xfedcba8, 0x25001, 0x3006
.long 0x54e2a160, 0xfdcb987, 0x502100, 0x3060
.long 0x54e2a160, 0xfdcb987, 0x5002010, 0x3600
.long 0x54f3b271, 0xedca986, 0x50001002, 0x6300
.long 0x54f3b271, 0xedca986, 0x152000, 0x3006
.long 0x54e2a160, 0xfdcb987, 0x5001002, 0x3600
.long 0x54e2a160, 0xfdcb987, 0x50000012, 0x6300
.long 0x54f3b271, 0xedca986, 0x51020, 0x3006
.long 0x765431a0, 0xfedcb98, 0x150200, 0x3060
.long 0x54f3b271, 0xedca986, 0x5102000, 0x3600
.long 0x650c3824, 0xfedba97, 0x50000102, 0x6300
.long 0x650c3824, 0xfedba97, 0x15020, 0x3006
.long 0x641d0935, 0xfecba87, 0x510200, 0x3060
.long 0x641d0935, 0xfecba87, 0x5020100, 0x3600
.long 0x54e2a160, 0xfdcb987, 0x50100002, 0x6300
.long 0x54e2a160, 0xfdcb987, 0x250001, 0x3006
.long 0x765431a0, 0xfedcb98, 0x251000, 0x3060
.long 0x54f3b271, 0xedca986, 0x5200010, 0x3600
.long 0x54f3b271, 0xedca986, 0x50200001, 0x6300
.long 0x650c3824, 0xfedba97, 0x50021, 0x3006
.long 0x650c3824, 0xfedba97, 0x520010, 0x3060
.long 0x54f3b271, 0xedca986, 0x50200010, 0x6300
.long 0x54f3b271, 0xedca986, 0x152000, 0x3006
.long 0x650c3824, 0xfedba97, 0x500102, 0x3060
.long 0x765421b0, 0xfedca98, 0x2500010, 0x3600
.long 0x650c3824, 0xfedba97, 0x50010200, 0x6300
.long 0x641d0935, 0xfecba87, 0x15200, 0x3006
.long 0x641d0935, 0xfecba87, 0x520001, 0x3060
.long 0x54e2a160, 0xfdcb987, 0x5100020, 0x3600
.long 0x54e2a160, 0xfdcb987, 0x50001020, 0x6300
.long 0x54f3b271, 0xedca986, 0x52001, 0x3006
.long 0x54f3b271, 0xedca986, 0x500102, 0x3060
.long 0x765421b0, 0xfedca98, 0x1500020, 0x3600
.long 0x650c3824, 0xfedba97, 0x50000021, 0x6300
.long 0x650c3824, 0xfedba97, 0x521000, 0x3006
.long 0x641d0935, 0xfecba87, 0x520100, 0x3060
.long 0x641d0935, 0xfecba87, 0x5001002, 0x3600
.long 0x650c3824, 0xfedba97, 0x50021, 0x3006
.long 0x650c3824, 0xfedba97, 0x520010, 0x3060
.long 0x641d0935, 0xfecba87, 0x5010002, 0x3600
.long 0x76532c10, 0xfedba98, 0x15002000, 0x6300
.long 0x641d0935, 0xfecba87, 0x50021, 0x3006
.long 0x54e2a160, 0xfdcb987, 0x251000, 0x3060
.long 0x54e2a160, 0xfdcb987, 0x5000012, 0x3600
.long 0x54f3b271, 0xedca986, 0x50100002, 0x6300
.long 0x54f3b271, 0xedca986, 0x51020, 0x3006
.long 0x650c3824, 0xfedba97, 0x510200, 0x3060
.long 0x650c3824, 0xfedba97, 0x5000102, 0x3600
.long 0x76532c10, 0xfedba98, 0x50000210, 0x6300
.long 0x641d0935, 0xfecba87, 0x50210, 0x3006
.long 0x641d0935, 0xfecba87, 0x520100, 0x3060
.long 0x54e2a160, 0xfdcb987, 0x5100020, 0x3600
.long 0x54e2a160, 0xfdcb987, 0x50000021, 0x6300
.long 0x641d0935, 0xfecba87, 0x500120, 0x3060
.long 0x641d0935, 0xfecba87, 0x5000012, 0x3600
.long 0x54e2a160, 0xfdcb987, 0x50002010, 0x6300
.long 0x76432d10, 0xfecba98, 0x150002, 0x3006
.long 0x54e2a160, 0xfdcb987, 0x510020, 0x3060
.long 0x54f3b271, 0xedca986, 0x5201000, 0x3600
.long 0x54f3b271, 0xedca986, 0x50100020, 0x6300
.long 0x650c3824, 0xfedba97, 0x50102, 0x3006
.long 0x650c3824, 0xfedba97, 0x510200, 0x3060
.long 0x641d0935, 0xfecba87, 0x5000021, 0x3600
.long 0x641d0935, 0xfecba87, 0x50010020, 0x6300
.long 0x76432d10, 0xfecba98, 0x50201, 0x3006
.long 0x54e2a160, 0xfdcb987, 0x251000, 0x3060
.long 0x54e2a160, 0xfdcb987, 0x5100002, 0x3600
.long 0x54f3b271, 0xedca986, 0x50200010, 0x6300
.long 0x54f3b271, 0xedca986, 0x250001, 0x3006
.long 0x54e2a160, 0xfdcb987, 0x5001020, 0x3600
.long 0x54e2a160, 0xfdcb987, 0x50002100, 0x6300
.long 0x54f3b271, 0xedca986, 0x250100, 0x3006
.long 0x7543e210, 0xfdcba98, 0x1502000, 0x3060
.long 0x54f3b271, 0xedca986, 0x5200010, 0x3600
.long 0x650c3824, 0xfedba97, 0x50000201, 0x6300
.long 0x650c3824, 0xfedba97, 0x15200, 0x3006
.long 0x641d0935, 0xfecba87, 0x500120, 0x3060
.long 0x641d0935, 0xfecba87, 0x5010200, 0x3600
.long 0x54e2a160, 0xfdcb987, 0x50100020, 0x6300
.long 0x54e2a160, 0xfdcb987, 0x52010, 0x3006
.long 0x7543e210, 0xfdcba98, 0x500021, 0x3060
.long 0x54f3b271, 0xedca986, 0x5100020, 0x3600
.long 0x54f3b271, 0xedca986, 0x50001020, 0x6300
.long 0x650c3824, 0xfedba97, 0x51200, 0x3006
.long 0x650c3824, 0xfedba97, 0x500120, 0x3060
.long 0x54f3b271, 0xedca986, 0x50000102, 0x6300
.long 0x54f3b271, 0xedca986, 0x50012, 0x3006
.long 0x650c3824, 0xfedba97, 0x500120, 0x3060
.long 0x6543f210, 0xedcba98, 0x15200000, 0x3600
.long 0x650c3824, 0xfedba97, 0x50001020, 0x6300
.long 0x641d0935, 0xfecba87, 0x15002, 0x3006
.long 0x641d0935, 0xfecba87, 0x500102, 0x3060
.long 0x54e2a160, 0xfdcb987, 0x5102000, 0x3600
.long 0x54e2a160, 0xfdcb987, 0x50201000, 0x6300
.long 0x54f3b271, 0xedca986, 0x150020, 0x3006
.long 0x54f3b271, 0xedca986, 0x501020, 0x3060
.long 0x6543f210, 0xedcba98, 0x25000010, 0x3600
.long 0x650c3824, 0xfedba97, 0x50000201, 0x6300
.long 0x650c3824, 0xfedba97, 0x15200, 0x3006
.long 0x641d0935, 0xfecba87, 0x501200, 0x3060
.long 0x641d0935, 0xfecba87, 0x5000201, 0x3600
.long 0x650c3824, 0xfedba97, 0x50210, 0x3006
.long 0x650c3824, 0xfedba97, 0x510002, 0x3060
.long 0x641d0935, 0xfecba87, 0x5000120, 0x3600
.long 0x76543218, 0xfedcba9, 0x25000010, 0x6300
.long 0x641d0935, 0xfecba87, 0x50210, 0x3006
.long 0x54e2a160, 0xfdcb987, 0x150002, 0x3060
.long 0x54e2a160, 0xfdcb987, 0x5200010, 0x3600
.long 0x54f3b271, 0xedca986, 0x50102000, 0x6300
.long 0x54f3b271, 0xedca986, 0x251000, 0x3006
.long 0x650c3824, 0xfedba97, 0x500120, 0x3060
.long 0x650c3824, 0xfedba97, 0x5000021, 0x3600
.long 0x76543218, 0xfedcba9, 0x15002000, 0x6300
.long 0x641d0935, 0xfecba87, 0x50021, 0x3006
.long 0x641d0935, 0xfecba87, 0x510200, 0x3060
.long 0x54e2a160, 0xfdcb987, 0x5201000, 0x3600
.long 0x54e2a160, 0xfdcb987, 0x50200001, 0x6300
.long 0x641d0935, 0xfecba87, 0x500102, 0x3060
.long 0x641d0935, 0xfecba87, 0x5020010, 0x3600
.long 0x54e2a160, 0xfdcb987, 0x50201000, 0x6300
.long 0x76543209, 0xfedcba8, 0x215000, 0x3006
.long 0x54e2a160, 0xfdcb987, 0x502010, 0x3060
.long 0x54f3b271, 0xedca986, 0x5001002, 0x3600
.long 0x54f3b271, 0xedca986, 0x50200001, 0x6300
.long 0x650c3824, 0xfedba97, 0x50120, 0x3006
.long 0x650c3824, 0xfedba97, 0x510002, 0x3060
.long 0x641d0935, 0xfecba87, 0x5020001, 0x3600
.long 0x641d0935, 0xfecba87, 0x50010200, 0x6300
.long 0x76543209, 0xfedcba8, 0x50102, 0x3006
.long 0x54e2a160, 0xfdcb987, 0x150020, 0x3060
.long 0x54e2a160, 0xfdcb987, 0x5000021, 0x3600
.long 0x54f3b271, 0xedca986, 0x50102000, 0x6300
.long 0x54f3b271, 0xedca986, 0x50012, 0x3006
.long 0x54e2a160, 0xfdcb987, 0x5002010, 0x3600
.long 0x54e2a160, 0xfdcb987, 0x50001020, 0x6300
.long 0x54f3b271, 0xedca986, 0x150002, 0x3006
.long 0x765431a0, 0xfedcb98, 0x500021, 0x3060
.long 0x54f3b271, 0xedca986, 0x5001020, 0x3600
.long 0x650c3824, 0xfedba97, 0x50020001, 0x6300
.long 0x650c3824, 0xfedba97, 0x15002, 0x3006
.long 0x641d0935, 0xfecba87, 0x520100, 0x3060
.long 0x641d0935, 0xfecba87, 0x5010020, 0x3600
.long 0x54e2a160, 0xfdcb987, 0x50002100, 0x6300
.long 0x54e2a160, 0xfdcb987, 0x150002, 0x3006
.long 0x765431a0, 0xfedcb98, 0x150020, 0x3060
.long 0x54f3b271, 0xedca986, 0x5000102, 0x3600
.long 0x54f3b271, 0xedca986, 0x50002010, 0x6300
.long 0x650c3824, 0xfedba97, 0x50102, 0x3006
.long 0x650c3824, 0xfedba97, 0x501002, 0x3060
.long 0x54f3b271, 0xedca986, 0x50102000, 0x6300
.long 0x54f3b271, 0xedca986, 0x250001, 0x3006
.long 0x650c3824, 0xfedba97, 0x520001, 0x3060
.long 0x765421b0, 0xfedca98, 0x1500020, 0x3600
.long 0x650c3824, 0xfedba97, 0x50000102, 0x6300
.long 0x641d0935, 0xfecba87, 0x51020, 0x3006
.long 0x641d0935, 0xfecba87, 0x510020, 0x3060
.long 0x54e2a160, 0xfdcb987, 0x5001002, 0x3600
.long 0x54e2a160, 0xfdcb987, 0x50102000, 0x6300
.long 0x54f3b271, 0xedca986, 0x51002, 0x3006
.long 0x54f3b271, 0xedca986, 0x502010, 0x3060
.long 0x765421b0, 0xfedca98, 0x5100002, 0x3600
.long 0x650c3824, 0xfedba97, 0x50020010, 0x6300
.long 0x650c3824, 0xfedba97, 0x15002, 0x3006
.long 0x641d0935, 0xfecba87, 0x500102, 0x3060
.long 0x641d0935, 0xfecba87, 0x5020010, 0x3600
.long 0x650c3824, 0xfedba97, 0x521000, 0x3006
.long 0x650c3824, 0xfedba97, 0x500021, 0x3060
.long 0x641d0935, 0xfecba87, 0x5000201, 0x3600
.long 0x76532c10, 0xfedba98, 0x15000200, 0x6300
.long 0x641d0935, 0xfecba87, 0x15002, 0x3006
.long 0x54e2a160, 0xfdcb987, 0x501020, 0x3060
.long 0x54e2a160, 0xfdcb987, 0x5000120, 0x3600
.long 0x54f3b271, 0xedca986, 0x50100020, 0x6300
.long 0x54f3b271, 0xedca986, 0x51002, 0x3006
.long 0x650c3824, 0xfedba97, 0x500102, 0x3060
.long 0x650c3824, 0xfedba97, 0x5000210, 0x3600
.long 0x76532c10, 0xfedba98, 0x25000100, 0x6300
.long 0x641d0935, 0xfecba87, 0x50102, 0x3006
.long 0x641d0935, 0xfecba87, 0x501002, 0x3060
.long 0x54e2a160, 0xfdcb987, 0x5002010, 0x3600
.long 0x54e2a160, 0xfdcb987, 0x50102000, 0x6300
.long 0x641d0935, 0xfecba87, 0x520001, 0x3060
.long 0x641d0935, 0xfecba87, 0x5010020, 0x3600
.long 0x54e2a160, 0xfdcb987, 0x50100020, 0x6300
.long 0x76432d10, 0xfecba98, 0x50201, 0x3006
.long 0x54e2a160, 0xfdcb987, 0x251000, 0x3060
.long 0x54f3b271, 0xedca986, 0x5002001, 0x3600
.long 0x54f3b271, 0xedca986, 0x50002010, 0x6300
.long 0x650c3824, 0xfedba97, 0x25100, 0x3006
.long 0x650c3824, 0xfedba97, 0x510020, 0x3060
.long 0x641d0935, 0xfecba87, 0x5000102, 0x3600
.long 0x641d0935, 0xfecba87, 0x50000012, 0x6300
.long 0x76432d10, 0xfecba98, 0x152000, 0x3006
.long 0x54e2a160, 0xfdcb987, 0x500012, 0x3060
.long 0x54e2a160, 0xfdcb987, 0x5210000, 0x3600
.long 0x54f3b271, 0xedca986, 0x50001020, 0x6300
.long 0x54f3b271, 0xedca986, 0x150020, 0x3006
.long 0x54e2a160, 0xfdcb987, 0x5200010, 0x3600
.long 0x54e2a160, 0xfdcb987, 0x50201000, 0x6300
.long 0x54f3b271, 0xedca986, 0x52100, 0x3006
.long 0x7543e210, 0xfdcba98, 0x520001, 0x3060
.long 0x54f3b271, 0xedca986, 0x5100002, 0x3600
.long 0x650c3824, 0xfedba97, 0x50000120, 0x6300
.long 0x650c3824, 0xfedba97, 0x521000, 0x3006
.long 0x641d0935, 0xfecba87, 0x500102, 0x3060
.long 0x641d0935, 0xfecba87, 0x5010002, 0x3600
.long 0x54e2a160, 0xfdcb987, 0x51200000, 0x6300
.long 0x54e2a160, 0xfdcb987, 0x150020, 0x3006
.long 0x7543e210, 0xfdcba98, 0x502010, 0x3060
.long 0x54f3b271, 0xedca986, 0x5002010, 0x3600
.long 0x54f3b271, 0xedca986, 0x50001002, 0x6300
.long 0x650c3824, 0xfedba97, 0x1025000, 0x3006
.long 0x650c3824, 0xfedba97, 0x510200, 0x3060
.long 0x54f3b271, 0xedca986, 0x50100020, 0x6300
.long 0x54f3b271, 0xedca986, 0x51020, 0x3006
.long 0x650c3824, 0xfedba97, 0x510200, 0x3060
.long 0x6543f210, 0xedcba98, 0x5102000, 0x3600
.long 0x650c3824, 0xfedba97, 0x15020000, 0x6300
.long 0x641d0935, 0xfecba87, 0x25100, 0x3006
.long 0x641d0935, 0xfecba87, 0x500210, 0x3060
.long 0x54e2a160, 0xfdcb987, 0x5201000, 0x3600
.long 0x54e2a160, 0xfdcb987, 0x50100002, 0x6300
.long 0x54f3b271, 0xedca986, 0x250001, 0x3006
.long 0x54f3b271, 0xedca986, 0x250010, 0x3060
.long 0x6543f210, 0xedcba98, 0x5002001, 0x3600
.long 0x650c3824, 0xfedba97, 0x50000012, 0x6300
.long 0x650c3824, 0xfedba97, 0x50120, 0x3006
.long 0x641d0935, 0xfecba87, 0x510020, 0x3060
.long 0x641d0935, 0xfecba87, 0x5000021, 0x3600
.fill 1, 4, 0
.size L_table, .-L_table
.section .rodata,"a"
.p2align 6
.amdhsa_kernel sequential_preLN__linear_kernel_hedgehog__moe_arch_mod__prompt_kernel
  .amdhsa_next_free_vgpr 256
  .amdhsa_next_free_sgpr 102
  .amdhsa_accum_offset 256
  .amdhsa_group_segment_fixed_size 0
  .amdhsa_kernarg_size 96
  .amdhsa_user_sgpr_count 2
  .amdhsa_user_sgpr_kernarg_segment_ptr 1
  .amdhsa_system_sgpr_workgroup_id_x 1
  .amdhsa_float_denorm_mode_32 3
.end_amdhsa_kernel
```

```asm
; @launch grid=(256,1,1) block=(512,1,1) lds=163840
.amdgcn_target "amdgcn-amd-amdhsa--gfx950"
.text
.globl sequential_preLN__linear_kernel_hedgehog__moe_arch_mod__prompt_kernel
.p2align 8
.type sequential_preLN__linear_kernel_hedgehog__moe_arch_mod__prompt_kernel,@function
sequential_preLN__linear_kernel_hedgehog__moe_arch_mod__prompt_kernel:
    s_cmp_ge_u32 s2, 256
    s_cbranch_scc1 L_end
    s_load_dwordx2 s[28:29], s[0:1], 0
    s_load_dwordx2 s[32:33], s[0:1], 8
    s_load_dwordx4 s[8:11], s[0:1], 16
    s_load_dwordx16 s[12:27], s[0:1], 32
    v_lshrrev_b32 v4, 6, v0
    v_and_b32 v1, 63, v0
    v_readfirstlane_b32 s79, v4
    s_and_b32 s76, s2, 7
    s_lshr_b32 s77, s2, 3
    s_and_b32 s60, s77, 15
    s_lshl_b32 s76, s76, 3
    s_bfe_u32 s77, s2, 0x10007
    s_lshl2_add_u32 s76, s77, s76
    s_mov_b32 s80, 0x654210b3
    s_mov_b32 s81, 0xfedca987
    s_lshr_b64 s[80:81], s[80:81], s76
    s_and_b32 s61, s80, 15
    s_and_b32 s62, s79, 3
    s_cmp_ge_u32 s79, 4
    s_cbranch_scc1 L_compute
    s_setprio 3
    s_getpc_b64 s[66:67]
L_pc:
    s_lshr_b32 s76, s2, 3
    s_lshl2_add_u32 s76, s76, s62
    s_mul_i32 s76, s76, 256
    v_lshl_add_u32 v91, v1, 7, s76
    s_mov_b64 exec, 3
    global_load_dword v27, v91, s[66:67]
    s_mov_b64 exec, -1
    s_add_u32 s84, s60, s2
    s_and_b32 s84, s84, 3
    s_and_b32 s76, s60, 7
    s_and_b32 s77, s61, 7
    s_cmp_eq_u32 s77, 3
    s_cselect_b32 s84, s76, s84
    v_lshrrev_b32 v4, 3, v1
    v_and_b32 v5, 7, v1
    v_lshrrev_b32_e64 v6, 4, v1
    s_lshl2_add_u32 s76, s60, s62
    s_lshl_b32 s76, s76, 16
    s_mul_i32 s70, s62, 10240
    v_xor_b32 v7, v5, v6
    v_lshlrev_b32 v7, 4, v7
    v_lshl_add_u32 v78, v4, 11, v7
    v_add_u32 v16, s76, v78
    v_xor_b32 v7, 64, v16
    v_add_u32 v17, 15360, v7
    v_add_u32 v18, 30720, v16
    v_add_u32 v19, 46080, v7
    s_mov_b32 s30, 4194304
    s_mov_b32 s31, 0x20000
    s_and_b32 s72, s84, 15
    s_mov_b32 m0, s70
    s_lshl_b32 s71, s72, 7
    s_waitcnt lgkmcnt(0)
    buffer_load_dwordx4 v16, s[28:31], s71 offen offset:0 lds
    s_mul_i32 s72, s72, 393216
    s_lshr_b64 s[84:85], s[84:85], 4
    buffer_load_dwordx4 v17, s[28:31], s71 offen offset:1024 lds
    buffer_load_dwordx4 v18, s[28:31], s71 offen offset:2048 lds
    buffer_load_dwordx4 v19, s[28:31], s71 offen offset:3072 lds
    v_and_b32 v6, 1, v6
    v_lshlrev_b32 v6, 2, v6
    v_xor_b32 v8, v5, v6
    v_lshlrev_b32 v8, 4, v8
    s_lshl_b32 s76, s61, 7
    s_mul_i32 s77, s62, 98304
    s_add_u32 s76, s76, s77
    v_mul_u32_u24 v7, 6144, v4
    v_add3_u32 v20, v7, v8, s76
    v_xor_b32 v7, 32, v20
    s_mov_b32 s34, 6291456
    s_mov_b32 s35, 0x20000
    s_add_u32 m0, s70, 4096
    s_nop 0
    buffer_load_dwordx4 v20, s[32:35], s72 offen offset:0 lds
    v_add_u32 v21, 48128, v7
    buffer_load_dwordx4 v21, s[32:35], s72 offen offset:1024 lds
    v_add_u32 v22, 0, v20
    buffer_load_dwordx4 v22, s[32:35], s72 offen offset:2048 lds
    v_add_u32 v23, 48128, v7
    buffer_load_dwordx4 v23, s[32:35], s72 offen offset:3072 lds
    v_add_u32 v24, 4096, v20
    s_add_u32 m0, s70, 8192
    s_nop 0
    buffer_load_dwordx4 v24, s[32:35], s72 offen offset:0 lds
    v_add_u32 v25, 52224, v7
    buffer_load_dwordx4 v25, s[32:35], s72 offen offset:1024 lds
    s_add_u32 s70, s70, 40960
    s_cmp_ge_u32 s70, 122880
    s_cselect_b32 s76, 122880, 0
    s_sub_u32 s70, s70, s76
    s_lshl_b32 s76, s60, 8
    s_lshl_b32 s77, s61, 4
    s_add_u32 s76, s76, s77
    s_add_u32 s76, s76, 30336
    s_load_dwordx4 s[84:87], s[66:67], s76
    v_lshl_add_u32 v26, v4, 11, v8
    v_xor_b32 v79, 64, v78
    s_and_b32 s63, s62, 1
    s_lshr_b32 s64, s62, 1
    s_lshl_b32 s73, s60, 4
    s_add_u32 s73, s73, s61
    s_mul_i32 s73, s73, 28800
    s_add_u32 s76, s2, 7
    s_and_b32 s76, s76, 7
    s_bfe_u32 s77, s2, 0x10003
    s_lshl1_add_u32 s97, s76, s77
    s_lshr_b32 s98, s2, 4
    s_lshl_b32 s99, s97, 4
    s_add_u32 s99, s99, s98
    s_mul_i32 s99, s99, 9344
    s_add_u32 s99, s99, 8388608
    s_lshr_b32 s65, s97, 1
    s_lshl_b32 s76, s97, 3
    s_add_u32 s65, s65, s76
    s_mul_i32 s76, s98, 4
    s_add_u32 s65, s65, s76
    s_and_b32 s65, s65, 15
    s_mov_b32 s89, 0x3f803f80
    s_mov_b32 s90, 0xffff0000
    v_and_b32 v2, 31, v1
    v_lshrrev_b32 v3, 5, v1
    v_lshlrev_b32 v12, 4, v1
    v_lshrrev_b32 v4, 3, v1
    v_mul_u32_u24 v13, 460800, v4
    v_and_b32_e64 v4, 7, v1
    v_lshl_add_u32 v13, v4, 4, v13
    s_lshl_b32 s76, s98, 7
    s_lshl_b32 s77, s62, 15
    s_add_u32 s76, s76, s77
    v_add_u32_e64 v26, s76, v26
    s_mov_b32 s40, s26
    s_and_b32 s41, s27, 0xffff
    s_mov_b32 s42, 33554432
    s_mov_b32 s43, 0x20000
    s_mov_b32 s56, s8
    s_and_b32 s57, s9, 0xffff
    s_mov_b32 s58, 65536
    s_mov_b32 s59, 0x20000
    v_mov_b32 v28, -1
    v_mov_b32 v29, -1
    v_mov_b32 v30, -1
    v_mov_b32_e64 v31, -1
    s_waitcnt lgkmcnt(0)
    s_and_b32 s72, s84, 15
    s_mov_b32 m0, s70
    s_lshl_b32 s71, s72, 7
    buffer_load_dwordx4 v16, s[28:31], s71 offen offset:0 lds
    s_mul_i32 s72, s72, 393216
    s_lshr_b64 s[84:85], s[84:85], 4
    buffer_load_dwordx4 v17, s[28:31], s71 offen offset:1024 lds
    buffer_load_dwordx4 v18, s[28:31], s71 offen offset:2048 lds
    buffer_load_dwordx4 v19, s[28:31], s71 offen offset:3072 lds
    s_add_u32 m0, s70, 4096
    s_nop 0
    buffer_load_dwordx4 v20, s[32:35], s72 offen offset:0 lds
    buffer_load_dwordx4 v21, s[32:35], s72 offen offset:1024 lds
    buffer_load_dwordx4 v22, s[32:35], s72 offen offset:2048 lds
    buffer_load_dwordx4 v23, s[32:35], s72 offen offset:3072 lds
    s_add_u32 m0, s70, 8192
    s_nop 0
    buffer_load_dwordx4 v24, s[32:35], s72 offen offset:0 lds
    buffer_load_dwordx4 v25, s[32:35], s72 offen offset:1024 lds
    s_add_u32 s70, s70, 40960
    s_cmp_ge_u32 s70, 122880
    s_cselect_b32 s76, 122880, 0
    s_sub_u32 s70, s70, s76
    s_lshl_b32 s77, s62, 10
    s_add_u32 s76, s77, s73
    buffer_store_dwordx4 v[28:31], v12, s[40:43], s76 offen sc1
    s_lshl_b32 s76, s61, 12
    s_add_u32 s76, s76, s77
    s_add_u32 m0, s77, 122880
    s_nop 0
    buffer_load_dwordx4 v12, s[56:59], s76 offen lds
    v_mov_b32 v4, 13631488
    buffer_load_dwordx2 v[88:89], v4, s[40:43], 0 offen
    s_setprio 0
    s_waitcnt vmcnt(13)
    s_barrier
    s_and_b32 s72, s84, 15
    s_mov_b32 m0, s70
    s_lshl_b32 s71, s72, 7
    buffer_load_dwordx4 v16, s[28:31], s71 offen offset:0 lds
    s_mul_i32 s72, s72, 393216
    s_lshr_b64 s[84:85], s[84:85], 4
    buffer_load_dwordx4 v17, s[28:31], s71 offen offset:1024 lds
    buffer_load_dwordx4 v18, s[28:31], s71 offen offset:2048 lds
    buffer_load_dwordx4 v19, s[28:31], s71 offen offset:3072 lds
    s_add_u32 m0, s70, 4096
    s_nop 0
    buffer_load_dwordx4 v20, s[32:35], s72 offen offset:0 lds
    buffer_load_dwordx4 v21, s[32:35], s72 offen offset:1024 lds
    buffer_load_dwordx4 v22, s[32:35], s72 offen offset:2048 lds
    buffer_load_dwordx4 v23, s[32:35], s72 offen offset:3072 lds
    s_add_u32 m0, s70, 8192
    s_nop 0
    buffer_load_dwordx4 v24, s[32:35], s72 offen offset:0 lds
    buffer_load_dwordx4 v25, s[32:35], s72 offen offset:1024 lds
    s_add_u32 s70, s70, 40960
    s_cmp_ge_u32 s70, 122880
    s_cselect_b32 s76, 122880, 0
    s_sub_u32 s70, s70, s76
    s_mov_b32 s36, s10
    s_and_b32 s37, s11, 0xffff
    s_mov_b32 s38, 2097152
    s_mov_b32 s39, 0x20000
    s_mov_b32 s44, s22
    s_and_b32 s45, s23, 0xffff
    s_mov_b32 s46, 4194304
    s_mov_b32 s47, 0x20000
    s_mov_b32 s52, s20
    s_and_b32 s53, s21, 0xffff
    s_mov_b32 s54, 7340032
    s_mov_b32 s55, 0x20000
    s_cmp_eq_u32 s64, 0
    s_cselect_b32 s48, s16, s18
    s_cselect_b32 s49, s17, s19
    s_and_b32 s49, s49, 0xffff
    s_mov_b32 s51, 0x20000
    s_cmp_lt_u32 s97, 14
    s_cselect_b32 s50, 7340032, 0
    s_cselect_b32 s54, 7340032, 0
    v_bfe_u32 v4, v2, 1, 3
    v_xor_b32 v4, v4, v3
    v_lshlrev_b32 v4, 4, v4
    v_lshl_add_u32 v72, v2, 7, v4
    v_bfe_u32 v4, v1, 2, 2
    v_lshl_add_u32 v5, v3, 3, v4
    v_lshlrev_b32 v5, 7, v5
    v_lshrrev_b32 v4, 1, v4
    v_xor_b32_e64 v4, s64, v4
    v_lshl_add_u32 v5, v4, 6, v5
    v_bfe_u32 v4, v1, 4, 1
    v_xor_b32_e64 v4, v4, v3
    v_lshl_add_u32 v5, v4, 5, v5
    v_and_b32_e64 v4, 3, v1
    v_lshl_add_u32 v5, v4, 3, v5
    s_mul_i32 s76, s62, 10240
    s_sub_u32 s76, 4096, s76
    v_add_u32 v73, s76, v5
    v_lshlrev_b32 v74, 3, v2
    v_lshrrev_b32 v4, 4, v1
    v_and_b32 v5, 15, v1
    v_mul_u32_u24 v66, 28800, v4
    v_lshl_add_u32 v66, v5, 4, v66
    v_mul_u32_u24 v75, 460800, v4
    v_lshl_add_u32 v75, v5, 4, v75
    v_lshrrev_b32 v4, 4, v1
    v_and_b32 v5, 15, v1
    v_mul_u32_u24 v76, 114688, v4
    v_lshl_add_u32 v76, v5, 4, v76
    v_lshlrev_b32_e64 v77, 4, v2
    v_lshl_add_u32 v77, v3, 11, v77
    s_mul_i32 s75, s98, 458752
    s_lshl_b32 s77, s97, 9
    s_add_u32 s75, s75, s77
    s_lshl_b32 s77, s63, 8
    s_add_u32 s75, s75, s77
    s_lshl_b32 s96, s97, 19
    s_lshl_b32 s77, s98, 15
    s_add_u32 s96, s96, s77
    s_lshl_b32 s77, s62, 9
    s_add_u32 s96, s96, s77
    s_mov_b32 s68, 1
    s_getreg_b32 s101, hwreg(HW_REG_XCC_ID, 0, 4)
    s_lshl_b32 s76, s61, 8
    s_add_u32 s76, s76, 12582912
    s_lshl_b32 s77, s60, 8
    s_add_u32 s77, s77, 12586752
    s_lshr_b32 s78, s97, 1
    s_lshl_b32 s78, s78, 9
    s_add_u32 s78, s78, 12590592
    v_mov_b32 v4, s76
    v_mov_b32 v5, s77
    v_mov_b32 v6, s78
    v_cmp_gt_u32 vcc, 16, v1
    s_nop 1
    v_cndmask_b32 v4, v5, v4, vcc
    v_cmp_gt_u32 vcc, 32, v1
    s_nop 1
    v_cndmask_b32 v4, v6, v4, vcc
    v_add_u32 v90, v4, v12
    s_waitcnt vmcnt(10)
    s_barrier
L_hloop:
    s_and_b32 s77, s86, 15
    s_cbranch_scc1 L_event
L_evret:
    s_and_b32 s72, s84, 15
    s_mov_b32 m0, s70
    s_lshl_b32 s71, s72, 7
    buffer_load_dwordx4 v16, s[28:31], s71 offen offset:0 lds
    s_mul_i32 s72, s72, 393216
    s_lshr_b64 s[84:85], s[84:85], 4
    buffer_load_dwordx4 v17, s[28:31], s71 offen offset:1024 lds
    buffer_load_dwordx4 v18, s[28:31], s71 offen offset:2048 lds
    buffer_load_dwordx4 v19, s[28:31], s71 offen offset:3072 lds
    s_add_u32 m0, s70, 4096
    s_nop 0
    buffer_load_dwordx4 v20, s[32:35], s72 offen offset:0 lds
    buffer_load_dwordx4 v21, s[32:35], s72 offen offset:1024 lds
    buffer_load_dwordx4 v22, s[32:35], s72 offen offset:2048 lds
    buffer_load_dwordx4 v23, s[32:35], s72 offen offset:3072 lds
    s_add_u32 m0, s70, 8192
    s_nop 0
    buffer_load_dwordx4 v24, s[32:35], s72 offen offset:0 lds
    buffer_load_dwordx4 v25, s[32:35], s72 offen offset:1024 lds
    s_add_u32 s70, s70, 40960
    s_cmp_ge_u32 s70, 122880
    s_cselect_b32 s76, 122880, 0
    s_sub_u32 s70, s70, s76
    s_waitcnt vmcnt(10)
L_hbar:
    s_lshr_b64 s[86:87], s[86:87], 4
    s_add_u32 s68, s68, 1
    s_cmp_lt_u32 s68, 14
    s_barrier
    s_cbranch_scc1 L_hloop
    v_add_co_u32 v88, vcc, 1, v88
    s_nop 1
    v_addc_co_u32 v89, vcc, 0, v89, vcc
    v_cmp_ne_u64 vcc, v[92:93], v[88:89]
    s_nop 0
    s_cbranch_vccz L_hello_ok_1
    s_mov_b32 s88, 0
L_spin_2:
    buffer_load_dwordx4 v[92:95], v90, s[40:43], 0 offen sc1
    s_waitcnt vmcnt(0)
    v_cmp_ne_u64 vcc, v[92:93], v[88:89]
    s_nop 0
    s_cbranch_vccz L_hello_ok_1
    s_add_u32 s88, s88, 1
    s_cmp_lt_u32 s88, 65536
    s_cbranch_scc1 L_spin_2
L_hello_ok_1:
    v_cmp_ne_u32_e64 vcc, s101, v94
    s_nop 0
    s_and_b32 s76, vcc_lo, 0xffff
    s_cselect_b32 s100, 0, 1
    s_cmp_eq_u32 vcc_hi, 0
    s_cselect_b32 s76, 2, 0
    s_or_b32 s100, s100, s76
    v_mov_b32 v4, s100
    v_mov_b32 v5, 0
    ds_write_b32 v5, v4 offset:53248
    s_lshl_b32 s81, s62, 8
    s_mul_i32 s80, s60, 460800
    s_add_u32 s80, s80, s81
    buffer_load_dwordx4 v[32:35], v66, s[40:43], s80 offen offset:0 sc1
    s_add_u32 s80, s80, 115200
    buffer_load_dwordx4 v[36:39], v66, s[40:43], s80 offen offset:0 sc1
    s_add_u32 s80, s80, 115200
    buffer_load_dwordx4 v[40:43], v66, s[40:43], s80 offen offset:0 sc1
    s_add_u32 s80, s80, 115200
    buffer_load_dwordx4 v[44:47], v66, s[40:43], s80 offen offset:0 sc1
    s_mul_i32 s80, s61, 28800
    s_add_u32 s80, s80, s81
    buffer_load_dwordx4 v[48:51], v75, s[40:43], s80 offen offset:1024 sc1
    s_add_u32 s80, s80, 1843200
    buffer_load_dwordx4 v[52:55], v75, s[40:43], s80 offen offset:1024 sc1
    s_add_u32 s80, s80, 1843200
    buffer_load_dwordx4 v[56:59], v75, s[40:43], s80 offen offset:1024 sc1
    s_add_u32 s80, s80, 1843200
    buffer_load_dwordx4 v[60:63], v75, s[40:43], s80 offen offset:1024 sc1
    v_bfe_u32 v10, v1, 4, 1
    v_lshl_add_u32 v10, v10, 1, v3
    v_min_u32 v10, 2, v10
    v_and_b32 v7, 15, v1
    v_lshlrev_b32_e64 v7, 3, v7
    s_lshl_b32 s76, s62, 7
    v_lshl_add_u32 v10, v10, 9, v7
    v_add_u32_e64 v64, s76, v10
    v_lshl_add_u32 v65, v7, 1, s81
    v_bfe_u32 v10, v1, 4, 1
    v_lshl_add_u32 v65, v10, 3, v65
    s_waitcnt vmcnt(8)
    s_barrier
    s_mul_i32 s78, s62, 2048
    s_add_u32 s78, s78, s99
    s_add_u32 s78, s78, 1024
    v_lshlrev_b32 v11, 7, v1
    s_mov_b64 exec, 65535
    buffer_load_dword v27, v11, s[40:43], s78 offen sc1
    s_mov_b64 exec, -1
    buffer_load_dwordx4 v[152:155], v76, s[48:51], s75 offen nt
    s_add_u32 s75, s75, 7168
    s_add_u32 s78, s65, 0
    s_and_b32 s78, s78, 15
    s_lshl_b32 s78, s78, 17
    s_lshl_b32 s79, s62, 11
    s_add_u32 m0, s79, 57344
    s_add_u32 s79, s78, 15360
    buffer_load_dwordx4 v26, s[36:39], s78 offen lds
    buffer_load_dwordx4 v26, s[36:39], s79 offen offset:1024 lds
    s_add_u32 s78, s65, 1
    s_and_b32 s78, s78, 15
    s_lshl_b32 s78, s78, 17
    s_lshl_b32 s79, s62, 11
    s_add_u32 m0, s79, 65536
    s_add_u32 s79, s78, 15360
    buffer_load_dwordx4 v26, s[36:39], s78 offen lds
    buffer_load_dwordx4 v26, s[36:39], s79 offen offset:1024 lds
    s_setprio 3
    s_mov_b32 s88, 0
    s_waitcnt vmcnt(10)
    s_branch L_g1first_3
L_g1_4:
    s_mul_i32 s80, s60, 460800
    s_add_u32 s80, s80, s81
    buffer_load_dwordx4 v[32:35], v66, s[40:43], s80 offen offset:0 sc1
    s_add_u32 s80, s80, 115200
    buffer_load_dwordx4 v[36:39], v66, s[40:43], s80 offen offset:0 sc1
    s_add_u32 s80, s80, 115200
    buffer_load_dwordx4 v[40:43], v66, s[40:43], s80 offen offset:0 sc1
    s_add_u32 s80, s80, 115200
    buffer_load_dwordx4 v[44:47], v66, s[40:43], s80 offen offset:0 sc1
    s_waitcnt vmcnt(0)
L_g1first_3:
    v_max3_u32 v4, v32, v34, v36
    v_max3_u32 v4, v4, v38, v40
    v_max3_u32 v4, v4, v42, v44
    v_max_u32 v4, v4, v46
    v_cmp_eq_u32 vcc, -1, v4
    s_nop 0
    s_cbranch_vccz L_ok_5
    s_add_u32 s88, s88, 1
    s_cmp_lt_u32 s88, 65536
    s_cbranch_scc1 L_g1_4
L_ok_5:
    v_add_f32 v32, v32, v40
    v_add_f32 v33, v33, v41
    v_add_f32 v34, v34, v42
    v_add_f32 v35, v35, v43
    v_add_f32 v36, v36, v44
    v_add_f32 v37, v37, v45
    v_add_f32 v38, v38, v46
    v_add_f32 v39, v39, v47
    v_add_f32 v32, v32, v36
    v_add_f32 v33, v33, v37
    v_add_f32 v34, v34, v38
    v_add_f32_e64 v35, v35, v39
    s_add_u32 s78, s65, 2
    s_and_b32 s78, s78, 15
    s_lshl_b32 s78, s78, 17
    s_lshl_b32 s79, s62, 11
    s_add_u32 m0, s79, 73728
    s_add_u32 s79, s78, 15360
    buffer_load_dwordx4 v26, s[36:39], s78 offen lds
    buffer_load_dwordx4 v26, s[36:39], s79 offen offset:1024 lds
    v_permlane32_swap_b32 v32, v33
    v_permlane32_swap_b32 v34, v35
    v_add_f32 v32, v32, v33
    v_add_f32 v34, v34, v35
    s_nop 1
    v_permlane16_swap_b32 v32, v34
    v_add_f32 v32, v32, v34
    v_mov_b32 v33, v32
    s_nop 1
    v_permlane32_swap_b32 v32, v33
    v_mul_f32 v32, 0x3a800000, v32
    v_mul_f32 v33, 0x3a800000, v33
    v_fma_f32 v7, -v32, v32, v33
    v_max_f32_e64 v7, 0, v7
    v_cvt_pk_bf16_f32 v5, v32, v32
    v_and_b32_e64 v5, s90, v5
    v_cvt_pk_bf16_f32 v7, v7, v7
    v_and_b32_e64 v7, s90, v7
    v_add_f32 v7, 0x3727c5ac, v7
    v_cvt_pk_bf16_f32 v7, v7, v7
    v_and_b32 v7, s90, v7
    v_sqrt_f32_e64 v7, v7
    s_nop 0
    v_cvt_pk_bf16_f32 v7, v7, v7
    v_and_b32 v7, s90, v7
    v_rcp_f32 v9, v7
    v_xor_b32 v5, 0x80000000, v5
    v_cvt_pk_bf16_f32 v8, v5, v5
    ds_write_b64 v65, v[8:9] offset:49152
    s_mov_b32 s88, 0
    s_waitcnt vmcnt(8)
    s_branch L_g1first_6
L_g1_7:
    s_mul_i32 s80, s61, 28800
    s_add_u32 s80, s80, s81
    buffer_load_dwordx4 v[48:51], v75, s[40:43], s80 offen offset:1024 sc1
    s_add_u32 s80, s80, 1843200
    buffer_load_dwordx4 v[52:55], v75, s[40:43], s80 offen offset:1024 sc1
    s_add_u32 s80, s80, 1843200
    buffer_load_dwordx4 v[56:59], v75, s[40:43], s80 offen offset:1024 sc1
    s_add_u32 s80, s80, 1843200
    buffer_load_dwordx4 v[60:63], v75, s[40:43], s80 offen offset:1024 sc1
    s_waitcnt vmcnt(0)
L_g1first_6:
    v_max3_u32 v4, v48, v50, v52
    v_max3_u32 v4, v4, v54, v56
    v_max3_u32 v4, v4, v58, v60
    v_max_u32 v4, v4, v62
    v_cmp_eq_u32 vcc, -1, v4
    s_nop 0
    s_cbranch_vccz L_ok_8
    s_add_u32 s88, s88, 1
    s_cmp_lt_u32 s88, 65536
    s_cbranch_scc1 L_g1_7
L_ok_8:
    v_add_f32 v48, v48, v56
    v_add_f32 v49, v49, v57
    v_add_f32 v50, v50, v58
    v_add_f32 v51, v51, v59
    v_add_f32 v52, v52, v60
    v_add_f32 v53, v53, v61
    v_add_f32 v54, v54, v62
    v_add_f32 v55, v55, v63
    v_add_f32 v48, v48, v52
    v_add_f32 v49, v49, v53
    v_add_f32 v50, v50, v54
    v_add_f32 v51, v51, v55
    v_add_f32 v49, v49, v51
    v_mov_b32 v51, v49
    v_permlane32_swap_b32 v48, v50
    s_nop 0
    v_permlane32_swap_b32 v49, v51
    v_add_f32 v48, v48, v50
    v_add_f32 v49, v49, v51
    s_nop 1
    v_permlane16_swap_b32 v48, v49
    v_add_f32_e64 v48, v48, v49
    v_cvt_pk_bf16_f32 v49, v48, v48
    v_and_b32 v49, s90, v49
    v_sub_f32 v49, v48, v49
    v_cvt_pk_bf16_f32 v50, v48, v49
    v_and_b32 v51, s90, v50
    v_sub_f32 v49, v49, v51
    v_cvt_pk_bf16_f32 v51, v49, 0
    ds_write_b64 v64, v[50:51] offset:50176
    s_setprio 0
    s_waitcnt lgkmcnt(0)
    s_barrier
    s_add_u32 s78, s65, 3
    s_and_b32 s78, s78, 15
    s_lshl_b32 s78, s78, 17
    s_lshl_b32 s79, s62, 11
    s_add_u32 m0, s79, 81920
    s_add_u32 s79, s78, 15360
    buffer_load_dwordx4 v26, s[36:39], s78 offen lds
    buffer_load_dwordx4 v26, s[36:39], s79 offen offset:1024 lds
    s_add_u32 s78, s65, 4
    s_and_b32 s78, s78, 15
    s_lshl_b32 s78, s78, 17
    s_lshl_b32 s79, s62, 11
    s_add_u32 m0, s79, 90112
    s_add_u32 s79, s78, 15360
    buffer_load_dwordx4 v26, s[36:39], s78 offen lds
    buffer_load_dwordx4 v26, s[36:39], s79 offen offset:1024 lds
    s_lshl_b32 s78, s62, 11
    s_add_u32 s79, s78, s99
    s_bitcmp1_b32 s100, 0
    s_cbranch_scc1 L_loc_9
    buffer_store_dwordx4 v[28:31], v12, s[40:43], s79 offen offset:1024 sc1
    buffer_store_dwordx4 v[28:31], v12, s[40:43], s79 offen offset:2048 sc1
    s_branch L_pubd_10
L_loc_9:
    buffer_store_dwordx4 v[28:31], v12, s[40:43], s79 offen offset:1024
    buffer_store_dwordx4 v[28:31], v12, s[40:43], s79 offen offset:2048
L_pubd_10:
    s_lshl_b32 s79, s62, 8
    s_add_u32 s79, s79, s99
    s_mov_b64 exec, 0xffff
    buffer_store_dwordx4 v[28:31], v12, s[40:43], s79 offen sc1
    s_mov_b64 exec, -1
    s_add_u32 s78, s65, 5
    s_and_b32 s78, s78, 15
    s_lshl_b32 s78, s78, 17
    s_lshl_b32 s79, s62, 11
    s_add_u32 m0, s79, 98304
    s_add_u32 s79, s78, 15360
    buffer_load_dwordx4 v26, s[36:39], s78 offen lds
    buffer_load_dwordx4 v26, s[36:39], s79 offen offset:1024 lds
    s_add_u32 s78, s65, 6
    s_and_b32 s78, s78, 15
    s_lshl_b32 s78, s78, 17
    s_lshl_b32 s79, s62, 11
    s_add_u32 m0, s79, 106496
    s_add_u32 s79, s78, 15360
    buffer_load_dwordx4 v26, s[36:39], s78 offen lds
    buffer_load_dwordx4 v26, s[36:39], s79 offen offset:1024 lds
    s_add_u32 s78, s65, 7
    s_and_b32 s78, s78, 15
    s_lshl_b32 s78, s78, 17
    s_lshl_b32 s79, s62, 11
    s_add_u32 m0, s79, 114688
    s_add_u32 s79, s78, 15360
    buffer_load_dwordx4 v26, s[36:39], s78 offen lds
    buffer_load_dwordx4 v26, s[36:39], s79 offen offset:1024 lds
    s_mul_i32 s78, s62, 384
    s_add_u32 s78, s78, s73
    s_add_u32 s78, s78, 2048
    v_lshlrev_b32 v11, 7, v1
    s_mov_b64 exec, 7
    buffer_load_dword v27, v11, s[40:43], s78 offen sc1
    s_mov_b64 exec, -1
    s_waitcnt vmcnt(7)
    s_lshl_b32 s76, s62, 2
    s_add_u32 s76, s76, s73
    v_mov_b32 v4, 0
    s_mov_b64 exec, 1
    s_bitcmp1_b32 s100, 0
    s_cbranch_scc1 L_loc_11
    buffer_store_dword v4, v4, s[40:43], s76 offen offset:2560 sc1
    s_branch L_pubd_12
L_loc_11:
    buffer_store_dword v4, v4, s[40:43], s76 offen offset:2560
L_pubd_12:
    s_mov_b64 exec, -1
    s_add_u32 s78, s65, 8
    s_and_b32 s78, s78, 15
    s_lshl_b32 s78, s78, 17
    s_lshl_b32 s79, s62, 11
    s_add_u32 m0, s79, 122880
    s_add_u32 s79, s78, 15360
    buffer_load_dwordx4 v26, s[36:39], s78 offen lds
    buffer_load_dwordx4 v26, s[36:39], s79 offen offset:1024 lds
    s_add_u32 s78, s65, 9
    s_and_b32 s78, s78, 15
    s_lshl_b32 s78, s78, 17
    s_lshl_b32 s79, s62, 11
    s_add_u32 m0, s79, 131072
    s_add_u32 s79, s78, 15360
    buffer_load_dwordx4 v26, s[36:39], s78 offen lds
    buffer_load_dwordx4 v26, s[36:39], s79 offen offset:1024 lds
    s_add_u32 s78, s65, 10
    s_and_b32 s78, s78, 15
    s_lshl_b32 s78, s78, 17
    s_lshl_b32 s79, s62, 11
    s_add_u32 m0, s79, 139264
    s_add_u32 s79, s78, 15360
    buffer_load_dwordx4 v26, s[36:39], s78 offen lds
    buffer_load_dwordx4 v26, s[36:39], s79 offen offset:1024 lds
    v_and_b32_e64 v65, 15, v1
    v_mul_u32_u24 v65, 460800, v65
    s_mul_i32 s80, s61, 28800
    s_lshl_b32 s82, s62, 2
    s_add_u32 s82, s82, s80
    v_bfe_u32 v4, v1, 4, 1
    v_lshl_add_u32 v4, v4, 1, v3
    s_lshl_b32 s77, s62, 6
    v_lshl_add_u32 v66, v4, 1, s77
    v_bfe_u32 v4, v1, 2, 1
    v_lshl_add_u32 v66, v4, 5, v66
    v_bfe_u32 v4, v1, 0, 1
    v_lshl_add_u32 v66, v4, 4, v66
    v_bfe_u32 v4, v1, 1, 1
    v_lshl_add_u32 v66, v4, 3, v66
    s_lshl_b32 s83, s62, 7
    s_add_u32 s81, s83, s80
    s_add_u32 s68, s81, 3686400
    s_add_u32 s83, s83, s73
    v_and_b32 v4, 7, v1
    v_lshrrev_b32 v5, 4, v1
    v_lshlrev_b32_e64 v5, 2, v5
    v_lshl_add_u32 v67, v4, 4, v5
    v_bfe_u32 v5, v1, 3, 1
    v_lshrrev_b32_e64 v6, 4, v1
    v_lshl_add_u32 v5, v5, 4, v6
    v_mul_u32_u24 v5, 9344, v5
    v_lshl_add_u32 v61, v4, 4, v5
    s_lshr_b32 s69, s97, 1
    s_lshr_b32 s76, s2, 7
    s_lshl2_add_u32 s69, s69, s76
    s_mul_i32 s69, s69, 74752
    s_add_u32 s69, s69, 8389632
    s_barrier
    s_add_u32 s78, s65, 11
    s_and_b32 s78, s78, 15
    s_lshl_b32 s78, s78, 17
    s_lshl_b32 s79, s62, 11
    s_add_u32 m0, s79, 147456
    s_add_u32 s79, s78, 15360
    buffer_load_dwordx4 v26, s[36:39], s78 offen lds
    buffer_load_dwordx4 v26, s[36:39], s79 offen offset:1024 lds
    s_add_u32 s78, s65, 12
    s_and_b32 s78, s78, 15
    s_lshl_b32 s78, s78, 17
    s_lshl_b32 s79, s62, 11
    s_add_u32 m0, s79, 155648
    s_add_u32 s79, s78, 15360
    buffer_load_dwordx4 v26, s[36:39], s78 offen lds
    buffer_load_dwordx4 v26, s[36:39], s79 offen offset:1024 lds
    buffer_load_dword v64, v65, s[40:43], s82 offen offset:2560 sc1
    s_barrier
    s_setprio 3
    v_mov_b32 v4, s89
    v_lshlrev_b32 v5, 2, v1
    ds_write_b32 v5, v4 offset:24832
    v_mov_b32 v70, 0
    v_mov_b32 v71, 0
    ds_write_b64 v70, v[70:71] offset:25984
    s_mov_b32 s88, 0
    s_branch L_p2first_13
L_p2_14:
    buffer_load_dword v64, v65, s[40:43], s82 offen offset:2560 sc1
L_p2first_13:
    s_waitcnt vmcnt(0)
    v_cmp_eq_u32_e64 vcc, -1, v64
    s_nop 0
    s_cbranch_vccz L_ok_15
    s_add_u32 s88, s88, 1
    s_cmp_lt_u32 s88, 65536
    s_cbranch_scc1 L_p2_14
L_ok_15:
    s_add_u32 s78, s65, 13
    s_and_b32 s78, s78, 15
    s_lshl_b32 s78, s78, 17
    s_lshl_b32 s79, s62, 11
    s_add_u32 m0, s79, 32768
    s_add_u32 s79, s78, 15360
    buffer_load_dwordx4 v26, s[36:39], s78 offen lds
    buffer_load_dwordx4 v26, s[36:39], s79 offen offset:1024 lds
    s_add_u32 s78, s65, 14
    s_and_b32 s78, s78, 15
    s_lshl_b32 s78, s78, 17
    s_lshl_b32 s79, s62, 11
    s_add_u32 m0, s79, 40960
    s_add_u32 s79, s78, 15360
    buffer_load_dwordx4 v26, s[36:39], s78 offen lds
    buffer_load_dwordx4 v26, s[36:39], s79 offen offset:1024 lds
    s_add_u32 s78, s65, 15
    s_and_b32 s78, s78, 15
    s_lshl_b32 s78, s78, 17
    s_lshl_b32 s79, s62, 11
    s_add_u32 m0, s79, 49152
    s_add_u32 s79, s78, 15360
    buffer_load_dwordx4 v26, s[36:39], s78 offen lds
    buffer_load_dwordx4 v26, s[36:39], s79 offen offset:1024 lds
    s_lshl_b32 s76, s62, 11
    s_lshl_b32 s77, s60, 7
    s_add_u32 s76, s76, s77
    s_add_u32 s76, s76, s69
    s_add_u32 s77, s76, 37376
    s_mov_b32 s78, 0x00003f80
    s_mov_b32 s79, 0x3f800000
    s_mov_b32 s88, 0
L_poll_16:
    buffer_load_dwordx4 v[32:35], v61, s[40:43], s76 offen sc1
    buffer_load_dwordx4 v[36:39], v61, s[40:43], s77 offen sc1
    s_waitcnt vmcnt(0)
    v_max_u32 v4, v32, v36
    v_cmp_eq_u32_e64 vcc, -1, v4
    s_nop 0
    s_cbranch_vccz L_ok_17
    s_add_u32 s88, s88, 1
    s_cmp_lt_u32 s88, 65536
    s_cbranch_scc1 L_poll_16
L_ok_17:
    v_dot2_f32_bf16 v48, v32, s78, 0
    v_dot2_f32_bf16 v49, v32, s79, 0
    v_dot2_f32_bf16 v50, v33, s78, 0
    v_dot2_f32_bf16 v51, v33, s79, 0
    v_dot2_f32_bf16 v52, v34, s78, 0
    v_dot2_f32_bf16 v53, v34, s79, 0
    v_dot2_f32_bf16 v54, v35, s78, 0
    v_dot2_f32_bf16 v55, v35, s79, 0
    v_dot2_f32_bf16 v48, v36, s78, v48
    v_dot2_f32_bf16 v49, v36, s79, v49
    v_dot2_f32_bf16 v50, v37, s78, v50
    v_dot2_f32_bf16 v51, v37, s79, v51
    v_dot2_f32_bf16 v52, v38, s78, v52
    v_dot2_f32_bf16 v53, v38, s79, v53
    v_dot2_f32_bf16 v54, v39, s78, v54
    v_dot2_f32_bf16 v55, v39, s79, v55
    buffer_load_dwordx4 v[40:43], v13, s[40:43], s81 offen offset:2048 sc1
    buffer_load_dwordx4 v[44:47], v13, s[40:43], s68 offen offset:2048 sc1
    v_permlane32_swap_b32 v48, v52
    v_permlane32_swap_b32 v49, v53
    v_permlane32_swap_b32 v50, v54
    v_permlane32_swap_b32 v51, v55
    v_add_f32 v48, v48, v52
    v_add_f32 v49, v49, v53
    v_add_f32 v50, v50, v54
    v_add_f32 v51, v51, v55
    s_nop 0
    v_permlane16_swap_b32 v48, v50
    v_permlane16_swap_b32 v49, v51
    v_add_f32 v48, v48, v50
    v_add_f32_e64 v49, v49, v51
    s_nop 0
    v_add_f32_dpp v48, v48, v48 row_ror:8 row_mask:0xf bank_mask:0xf
    v_add_f32_dpp v49, v49, v49 row_ror:8 row_mask:0xf bank_mask:0xf
    v_cvt_pk_bf16_f32 v48, v48, v49
    s_bitcmp1_b32 s100, 0
    s_cbranch_scc1 L_loc_18
    buffer_store_dword v48, v67, s[40:43], s83 offen offset:3072 sc1
    s_branch L_pubd_19
L_loc_18:
    buffer_store_dword v48, v67, s[40:43], s83 offen offset:3072
L_pubd_19:
    s_mov_b32 s88, 0
    s_waitcnt vmcnt(1)
    s_branch L_zfirst_20
L_z_21:
    buffer_load_dwordx4 v[40:43], v13, s[40:43], s81 offen offset:2048 sc1
    buffer_load_dwordx4 v[44:47], v13, s[40:43], s68 offen offset:2048 sc1
    s_waitcnt vmcnt(0)
L_zfirst_20:
    v_max3_u32 v4, v40, v41, v42
    v_max3_u32 v4, v4, v43, v44
    v_max3_u32 v4, v4, v45, v46
    v_max_u32 v4, v4, v47
    v_cmp_eq_u32 vcc, -1, v4
    s_nop 0
    s_cbranch_vccz L_ok_22
    s_add_u32 s88, s88, 1
    s_cmp_lt_u32 s88, 65536
    s_cbranch_scc1 L_z_21
L_ok_22:
    v_add_f32 v40, v40, v44
    v_add_f32 v41, v41, v45
    v_add_f32 v42, v42, v46
    v_add_f32 v43, v43, v47
    v_permlane32_swap_b32 v40, v41
    s_nop 0
    v_permlane32_swap_b32 v42, v43
    v_add_f32 v40, v40, v41
    v_add_f32 v42, v42, v43
    s_nop 1
    v_permlane16_swap_b32 v40, v42
    v_add_f32 v40, v40, v42
    s_nop 1
    v_add_f32_dpp v40, v40, v40 row_ror:8 row_mask:0xf bank_mask:0xf
    v_cvt_pk_bf16_f32 v40, v40, v40
    ds_write_b16 v66, v40 offset:24576
    s_waitcnt lgkmcnt(0)
    s_barrier
    s_setprio 0
    s_mov_b64 exec, 3
    global_load_dword v27, v91, s[66:67]
    s_mov_b64 exec, -1
    s_lshl_b32 s78, s97, 18
    s_lshl_b32 s79, s62, 16
    s_add_u32 s78, s78, s79
    s_lshl_b32 s79, s98, 7
    s_add_u32 s78, s78, s79
    s_lshl_b32 s79, s62, 12
    s_add_u32 m0, s79, 0
    s_nop 0
    buffer_load_dwordx4 v78, s[28:31], s78 offen offset:0 lds
    s_add_u32 s78, s78, 15360
    buffer_load_dwordx4 v79, s[28:31], s78 offen offset:1024 lds
    s_add_u32 s78, s78, 15360
    buffer_load_dwordx4 v78, s[28:31], s78 offen offset:2048 lds
    s_add_u32 s78, s78, 15360
    buffer_load_dwordx4 v79, s[28:31], s78 offen offset:3072 lds
    s_mov_b32 s56, s14
    s_and_b32 s57, s15, 0xffff
    s_mov_b32 s58, 2048
    s_mov_b32 s59, 0x20000
    s_lshl_b32 s78, s62, 9
    s_add_u32 m0, s78, 16384
    s_mov_b32 exec_hi, 0
    buffer_load_dwordx4 v12, s[56:59], s78 offen lds
    s_mov_b64 exec, -1
    s_barrier
    s_lshl4_add_u32 s76, s97, s98
    s_mul_i32 s76, s76, 28800
    s_add_u32 s20, s26, s76
    s_addc_u32 s21, s27, 0
    s_cmp_eq_u32 s62, 0
    s_cbranch_scc0 L_now0_25
    s_load_dwordx16 s[4:19], s[20:21], 3584 glc
    s_waitcnt lgkmcnt(0)
    s_and_b64 s[4:5], s[4:5], s[6:7]
    s_and_b64 s[4:5], s[4:5], s[8:9]
    s_and_b64 s[4:5], s[4:5], s[10:11]
    s_and_b64 s[4:5], s[4:5], s[12:13]
    s_and_b64 s[4:5], s[4:5], s[14:15]
    s_and_b64 s[4:5], s[4:5], s[16:17]
    s_and_b64 s[4:5], s[4:5], s[18:19]
    s_nand_b32 s4, s4, s5
    s_and_b32 s4, s4, 0xffff
    s_mul_i32 s4, s4, 0x10001
    s_lshr_b32 s4, s4, s65
    s_and_b32 s77, s4, 0xffff
    v_mov_b32_e64 v69, s77
    s_mov_b64 exec, 1
    ds_or_b32 v70, v69 offset:25984
    s_mov_b64 exec, -1
    s_waitcnt vmcnt(0) lgkmcnt(0)
    s_load_dwordx16 s[4:19], s[20:21], 3584 glc
    s_barrier
    s_mov_b32 s88, 0
    s_branch L_fo2
L_now0_25:
    s_waitcnt vmcnt(0) lgkmcnt(0)
    s_barrier
    s_cmp_eq_u32 s63, 0
    s_cbranch_scc0 L_now1_23
    s_mov_b32 s88, 0
L_spin_26:
    s_load_dwordx16 s[4:19], s[20:21], 3584 glc
L_fo2:
    s_waitcnt lgkmcnt(0)
    s_and_b64 s[4:5], s[4:5], s[6:7]
    s_and_b64 s[4:5], s[4:5], s[8:9]
    s_and_b64 s[4:5], s[4:5], s[10:11]
    s_and_b64 s[4:5], s[4:5], s[12:13]
    s_and_b64 s[4:5], s[4:5], s[14:15]
    s_and_b64 s[4:5], s[4:5], s[16:17]
    s_and_b64 s[4:5], s[4:5], s[18:19]
    s_nand_b32 s4, s4, s5
    s_and_b32 s4, s4, 0xffff
    s_mul_i32 s4, s4, 0x10001
    s_lshr_b32 s4, s4, s65
    s_and_b32 s77, s4, 0xffff
    v_mov_b32 v69, s77
    s_mov_b64 exec, 1
    ds_or_b32 v70, v69 offset:25984
    s_mov_b64 exec, -1
    s_cmp_eq_u32 s77, 0xffff
    s_cbranch_scc1 L_s2done_24
    s_add_u32 s88, s88, 1
    s_cmp_lt_u32 s88, 65536
    s_cbranch_scc1 L_spin_26
    s_branch L_s2done_24
L_now1_23:
    s_cmp_eq_u32 s62, 1
    s_cbranch_scc0 L_s2done_24
    s_lshl_b32 s77, 1, s61
    s_not_b32 s77, s77
    v_mov_b32 v4, s77
    v_mul_u32_u24 v5, 28800, v1
    s_mul_i32 s76, s60, 460800
    s_lshl2_add_u32 s76, s61, s76
    s_mov_b32 s88, 0
L_spin_27:
    ds_read_b32 v69, v70 offset:25988
    s_waitcnt lgkmcnt(0)
    v_cmp_eq_u32_e64 vcc, 4, v69
    s_nop 0
    s_cbranch_vccnz L_drained_28
    s_add_u32 s88, s88, 1
    s_cmp_lt_u32 s88, 1048576
    s_cbranch_scc1 L_spin_27
L_drained_28:
    s_mov_b64 exec, 0xffff
    buffer_store_dword v4, v5, s[40:43], s76 offen offset:3584 sc1
    s_mov_b64 exec, -1
L_s2done_24:
    s_waitcnt vmcnt(0)
    v_lshlrev_b32 v17, 5, v2
    v_lshl_add_u32 v17, v3, 4, v17
    v_and_b32 v4, 15, v1
    v_lshrrev_b32 v5, 1, v4
    v_and_b32 v4, 1, v4
    v_lshlrev_b32 v4, 5, v4
    v_lshl_add_u32 v16, v5, 7, v4
    v_lshrrev_b32 v4, 3, v1
    v_and_b32 v5, 7, v1
    v_lshlrev_b32_e64 v5, 4, v5
    v_mul_u32_u24 v18, 9344, v4
    v_add_u32_e64 v18, v18, v5
    v_bfe_u32 v6, v1, 4, 1
    v_lshl_add_u32 v6, v6, 1, v3
    v_lshl_add_u32 v19, v6, 2, v5
    s_mul_i32 s84, s97, 149504
    s_lshl_b32 s77, s98, 7
    s_add_u32 s84, s84, s77
    s_add_u32 s84, s84, 8388608
    s_lshl_b32 s85, s62, 10
    s_add_u32 s85, s85, s99
    s_add_u32 s85, s85, 5120
    s_and_b32 s87, s97, 1
    s_lshl_b32 s87, s87, 4
    s_add_u32 s87, s87, s98
    s_lshr_b32 s86, s97, 1
    s_mul_i32 s86, s86, 299008
    s_lshl_b32 s77, s87, 7
    s_add_u32 s86, s86, s77
    s_add_u32 s86, s86, 8393728
    s_lshl_b32 s78, s62, 11
    s_add_u32 s79, s78, s99
    s_bitcmp1_b32 s100, 1
    s_cbranch_scc1 L_loc_29
    buffer_store_dwordx4 v[28:31], v12, s[40:43], s79 offen offset:1024 sc1
    buffer_store_dwordx4 v[28:31], v12, s[40:43], s79 offen offset:2048 sc1
    s_branch L_pubd_30
L_loc_29:
    buffer_store_dwordx4 v[28:31], v12, s[40:43], s79 offen offset:1024
    buffer_store_dwordx4 v[28:31], v12, s[40:43], s79 offen offset:2048
L_pubd_30:
    s_lshl4_add_u32 s78, s97, s98
    s_lshl4_add_u32 s78, s78, s62
    s_add_u32 s78, s78, 12591116
    s_waitcnt vmcnt(0)
    s_mov_b64 exec, 1
    s_bitcmp1_b32 s100, 1
    s_cbranch_scc1 L_loc_31
    buffer_store_byte v28, v70, s[40:43], s78 offen sc1
    s_branch L_pubd_32
L_loc_31:
    buffer_store_byte v28, v70, s[40:43], s78 offen
L_pubd_32:
    s_mov_b64 exec, -1
    s_cmp_eq_u32 s62, 0
    s_cbranch_scc0 L_nop3c_33
    s_mov_b32 exec_lo, 0
    s_mov_b32 s88, 0
L_spin_34:
    buffer_load_dword v4, v90, s[40:43], 0 offen offset:12 sc1
    s_waitcnt vmcnt(0)
    v_cmp_ne_u32 vcc, -1, v4
    s_nop 0
    s_cbranch_vccz L_p3ok_35
    s_add_u32 s88, s88, 1
    s_cmp_lt_u32 s88, 65536
    s_cbranch_scc1 L_spin_34
L_p3ok_35:
    s_mov_b64 exec, -1
L_nop3c_33:
    s_barrier
    buffer_load_dwordx4 v[156:159], v76, s[48:51], s75 offen nt
    s_add_u32 s75, s75, 7168
    buffer_load_dwordx4 v[32:35], v77, s[52:55], s96 offen nt
    s_add_u32 s96, s96, 4096
    buffer_load_dwordx4 v[36:39], v77, s[52:55], s96 offen nt
    s_add_u32 s96, s96, 4096
    buffer_load_dwordx4 v[40:43], v77, s[52:55], s96 offen nt
    s_add_u32 s96, s96, 4096
    buffer_load_dwordx4 v[44:47], v77, s[52:55], s96 offen nt
    s_add_u32 s96, s96, 4096
    buffer_load_dwordx4 v[48:51], v77, s[52:55], s96 offen nt
    s_add_u32 s96, s96, 4096
    v_mul_u32_u24 v20, 149504, v1
    s_mul_i32 s72, s98, 9344
    s_lshl2_add_u32 s72, s97, s72
    s_add_u32 s72, s72, 8388608
    s_barrier
    s_cmp_eq_u32 s62, 1
    s_cbranch_scc0 L_nopre_36
    s_mov_b64 exec, 0xffff
    buffer_store_dword v70, v20, s[40:43], s72 offen offset:768 sc1
    s_mov_b64 exec, -1
L_nopre_36:
    buffer_load_dwordx4 v[52:55], v77, s[52:55], s96 offen nt
    s_add_u32 s96, s96, 4096
    buffer_load_dwordx4 v[56:59], v77, s[52:55], s96 offen nt
    s_add_u32 s96, s96, 4096
    buffer_load_dwordx4 v[60:63], v77, s[52:55], s96 offen nt
    s_add_u32 s96, s96, 4096
    s_barrier
    s_waitcnt vmcnt(8)
    s_mov_b32 s78, 0x05040100
    s_mov_b32 s79, 0x07060302
    v_perm_b32 v160, v100, v96, s78
    v_perm_b32 v164, v100, v96, s79
    v_perm_b32 v168, v101, v97, s78
    v_perm_b32 v172, v101, v97, s79
    v_perm_b32 v176, v102, v98, s78
    v_perm_b32 v180, v102, v98, s79
    v_perm_b32 v184, v103, v99, s78
    v_perm_b32 v188, v103, v99, s79
    v_perm_b32 v161, v108, v104, s78
    v_perm_b32 v165, v108, v104, s79
    v_perm_b32 v169, v109, v105, s78
    v_perm_b32 v173, v109, v105, s79
    v_perm_b32 v177, v110, v106, s78
    v_perm_b32 v181, v110, v106, s79
    v_perm_b32 v185, v111, v107, s78
    v_perm_b32 v189, v111, v107, s79
    v_perm_b32 v162, v116, v112, s78
    v_perm_b32 v166, v116, v112, s79
    v_perm_b32 v170, v117, v113, s78
    v_perm_b32 v174, v117, v113, s79
    v_perm_b32 v178, v118, v114, s78
    v_perm_b32 v182, v118, v114, s79
    v_perm_b32 v186, v119, v115, s78
    v_perm_b32 v190, v119, v115, s79
    v_perm_b32 v163, v124, v120, s78
    v_perm_b32 v167, v124, v120, s79
    v_perm_b32 v171, v125, v121, s78
    v_perm_b32 v175, v125, v121, s79
    v_perm_b32 v179, v126, v122, s78
    v_perm_b32 v183, v126, v122, s79
    v_perm_b32 v187, v127, v123, s78
    v_perm_b32 v191, v127, v123, s79
    v_perm_b32 v192, v132, v128, s78
    v_perm_b32 v196, v132, v128, s79
    v_perm_b32 v200, v133, v129, s78
    v_perm_b32 v204, v133, v129, s79
    v_perm_b32 v208, v134, v130, s78
    v_perm_b32 v212, v134, v130, s79
    v_perm_b32 v216, v135, v131, s78
    v_perm_b32 v220, v135, v131, s79
    v_perm_b32 v193, v140, v136, s78
    v_perm_b32 v197, v140, v136, s79
    v_perm_b32 v201, v141, v137, s78
    v_perm_b32 v205, v141, v137, s79
    v_perm_b32 v209, v142, v138, s78
    v_perm_b32 v213, v142, v138, s79
    v_perm_b32 v217, v143, v139, s78
    v_perm_b32 v221, v143, v139, s79
    v_perm_b32 v194, v148, v144, s78
    v_perm_b32 v198, v148, v144, s79
    v_perm_b32 v202, v149, v145, s78
    v_perm_b32 v206, v149, v145, s79
    v_perm_b32 v210, v150, v146, s78
    v_perm_b32 v214, v150, v146, s79
    v_perm_b32 v218, v151, v147, s78
    v_perm_b32 v222, v151, v147, s79
    v_perm_b32 v195, v156, v152, s78
    v_perm_b32 v199, v156, v152, s79
    v_perm_b32 v203, v157, v153, s78
    v_perm_b32 v207, v157, v153, s79
    v_perm_b32 v211, v158, v154, s78
    v_perm_b32 v215, v158, v154, s79
    v_perm_b32 v219, v159, v155, s78
    v_perm_b32 v223, v159, v155, s79
    s_waitcnt vmcnt(6)
    s_mov_b32 s78, 0x05040100
    s_mov_b32 s79, 0x07060302
    v_permlane32_swap_b32 v32, v34
    v_permlane32_swap_b32 v33, v35
    v_permlane32_swap_b32 v36, v38
    v_permlane32_swap_b32_e64 v37, v39
    v_perm_b32 v224, v34, v32, s78
    v_perm_b32 v225, v34, v32, s79
    v_perm_b32 v226, v35, v33, s78
    v_perm_b32 v227, v35, v33, s79
    v_perm_b32 v228, v38, v36, s78
    v_perm_b32 v229, v38, v36, s79
    v_perm_b32 v230, v39, v37, s78
    v_perm_b32 v231, v39, v37, s79
    s_waitcnt vmcnt(4)
    s_mov_b32 s78, 0x05040100
    s_mov_b32 s79, 0x07060302
    v_permlane32_swap_b32 v40, v42
    v_permlane32_swap_b32 v41, v43
    v_permlane32_swap_b32 v44, v46
    v_permlane32_swap_b32_e64 v45, v47
    v_perm_b32 v232, v42, v40, s78
    v_perm_b32 v233, v42, v40, s79
    v_perm_b32 v234, v43, v41, s78
    v_perm_b32 v235, v43, v41, s79
    v_perm_b32 v236, v46, v44, s78
    v_perm_b32 v237, v46, v44, s79
    v_perm_b32 v238, v47, v45, s78
    v_perm_b32 v239, v47, v45, s79
    s_waitcnt vmcnt(2)
    s_mov_b32 s78, 0x05040100
    s_mov_b32 s79, 0x07060302
    v_permlane32_swap_b32 v48, v50
    v_permlane32_swap_b32 v49, v51
    v_permlane32_swap_b32 v52, v54
    v_permlane32_swap_b32_e64 v53, v55
    v_perm_b32 v240, v50, v48, s78
    v_perm_b32 v241, v50, v48, s79
    v_perm_b32 v242, v51, v49, s78
    v_perm_b32 v243, v51, v49, s79
    v_perm_b32 v244, v54, v52, s78
    v_perm_b32 v245, v54, v52, s79
    v_perm_b32 v246, v55, v53, s78
    v_perm_b32 v247, v55, v53, s79
    s_waitcnt vmcnt(0)
    s_mov_b32 s78, 0x05040100
    s_mov_b32 s79, 0x07060302
    v_permlane32_swap_b32 v56, v58
    v_permlane32_swap_b32 v57, v59
    v_permlane32_swap_b32 v60, v62
    v_permlane32_swap_b32_e64 v61, v63
    v_perm_b32 v248, v58, v56, s78
    v_perm_b32 v249, v58, v56, s79
    v_perm_b32 v250, v59, v57, s78
    v_perm_b32 v251, v59, v57, s79
    v_perm_b32 v252, v62, v60, s78
    v_perm_b32 v253, v62, v60, s79
    v_perm_b32 v254, v63, v61, s78
    v_perm_b32 v255, v63, v61, s79
    v_and_b32 v5, 15, v1
    v_lshlrev_b32 v5, 3, v5
    s_lshl_b32 s76, s63, 10
    s_lshl_b32 s77, s64, 6
    s_add_u32 s76, s76, s77
    s_add_u32 s76, s76, s99
    s_mov_b64 s[80:81], 0xffff
    s_add_u32 s68, s84, 74752
    s_add_u32 s69, s86, 74752
    s_add_u32 s70, s86, 149504
    s_add_u32 s71, s86, 224256
    s_setprio 3
    s_barrier
    ds_read_b128 v[64:67], v12 offset:28672
    ds_read_b128 v[68:71], v12 offset:29696
    ds_read_b64 v[8:9], v5 offset:25728
    s_waitcnt lgkmcnt(2)
    v_mfma_f32_16x16x32_bf16 v[96:99], v[64:67], v[160:163], 0
    v_mfma_f32_16x16x32_bf16 v[100:103], v[64:67], v[164:167], 0
    s_waitcnt lgkmcnt(0)
    v_max_f32_dpp v4, v8, v8 row_ror:8 row_mask:0xf bank_mask:0xf
    v_mfma_f32_16x16x32_bf16 v[104:107], v[64:67], v[168:171], 0
    v_mfma_f32_16x16x32_bf16 v[108:111], v[64:67], v[172:175], 0
    v_max_f32_dpp v4, v4, v4 row_ror:4 row_mask:0xf bank_mask:0xf
    v_mfma_f32_16x16x32_bf16 v[112:115], v[64:67], v[176:179], 0
    v_mfma_f32_16x16x32_bf16 v[116:119], v[64:67], v[180:183], 0
    v_max_f32_dpp v4, v4, v4 row_ror:2 row_mask:0xf bank_mask:0xf
    v_mfma_f32_16x16x32_bf16 v[120:123], v[64:67], v[184:187], 0
    v_mfma_f32_16x16x32_bf16 v[124:127], v[64:67], v[188:191], 0
    v_max_f32_dpp v4, v4, v4 row_ror:1 row_mask:0xf bank_mask:0xf
    v_mfma_f32_16x16x32_bf16 v[96:99], v[68:71], v[192:195], v[96:99]
    v_cmp_eq_f32_e64 vcc, v4, v8
    v_mfma_f32_16x16x32_bf16 v[100:103], v[68:71], v[196:199], v[100:103]
    s_ff1_i32_b32 s92, vcc_lo
    s_and_b32 s92, s92, 15
    v_mfma_f32_16x16x32_bf16 v[104:107], v[68:71], v[200:203], v[104:107]
    s_lshr_b32 s78, s92, 2
    s_lshl_b32 s78, s78, 4
    v_mfma_f32_16x16x32_bf16 v[108:111], v[68:71], v[204:207], v[108:111]
    s_and_b32 s77, s92, 3
    v_mfma_f32_16x16x32_bf16 v[112:115], v[68:71], v[208:211], v[112:115]
    v_readlane_b32 s91, v9, s92
    v_readlane_b32 s93, v8, s92
    v_mfma_f32_16x16x32_bf16 v[116:119], v[68:71], v[212:215], v[116:119]
    v_mfma_f32_16x16x32_bf16 v[120:123], v[68:71], v[216:219], v[120:123]
    v_mfma_f32_16x16x32_bf16 v[124:127], v[68:71], v[220:223], v[124:127]
    s_cmp_ge_u32 s97, 14
    s_cbranch_scc1 L_final
    s_cmp_eq_u32 s77, 0
    s_cbranch_scc0 L_sel_38
    v_mov_b32 v64, v96
    v_mov_b32 v65, v100
    v_mov_b32 v66, v104
    v_mov_b32 v67, v108
    v_mov_b32 v68, v112
    v_mov_b32 v69, v116
    v_mov_b32 v70, v120
    v_mov_b32 v71, v124
    s_branch L_seldone_37
L_sel_38:
    s_cmp_eq_u32 s77, 1
    s_cbranch_scc0 L_sel_39
    v_mov_b32 v64, v97
    v_mov_b32 v65, v101
    v_mov_b32 v66, v105
    v_mov_b32 v67, v109
    v_mov_b32 v68, v113
    v_mov_b32 v69, v117
    v_mov_b32 v70, v121
    v_mov_b32 v71, v125
    s_branch L_seldone_37
L_sel_39:
    s_cmp_eq_u32 s77, 2
    s_cbranch_scc0 L_sel_40
    v_mov_b32 v64, v98
    v_mov_b32 v65, v102
    v_mov_b32 v66, v106
    v_mov_b32 v67, v110
    v_mov_b32 v68, v114
    v_mov_b32 v69, v118
    v_mov_b32 v70, v122
    v_mov_b32 v71, v126
    s_branch L_seldone_37
L_sel_40:
    v_mov_b32 v64, v99
    v_mov_b32 v65, v103
    v_mov_b32 v66, v107
    v_mov_b32 v67, v111
    v_mov_b32 v68, v115
    v_mov_b32 v69, v119
    v_mov_b32 v70, v123
    v_mov_b32_e64 v71, v127
L_seldone_37:
    s_lshl_b64 exec, s[80:81], s78
    s_bitcmp1_b32 s100, 1
    s_cbranch_scc1 L_loc_42
    buffer_store_dwordx4 v[64:67], v16, s[40:43], s76 offen offset:3072 sc1
    buffer_store_dwordx4 v[68:71], v16, s[40:43], s76 offen offset:3088 sc1
    s_branch L_pubd_43
L_loc_42:
    buffer_store_dwordx4 v[64:67], v16, s[40:43], s76 offen offset:3072
    buffer_store_dwordx4 v[68:71], v16, s[40:43], s76 offen offset:3088
L_pubd_43:
    s_mov_b64 exec, -1
    s_mov_b32 s88, 0
L_poll_44:
    buffer_load_dwordx4 v[128:131], v18, s[40:43], s84 offen offset:3072 sc1
    buffer_load_dwordx4 v[132:135], v18, s[40:43], s68 offen offset:3072 sc1
    s_waitcnt vmcnt(0)
    v_max_u32 v4, v128, v132
    v_cmp_eq_u32_e64 vcc, -1, v4
    s_nop 0
    s_cbranch_vccz L_ok_45
    s_add_u32 s88, s88, 1
    s_cmp_lt_u32 s88, 65536
    s_cbranch_scc1 L_poll_44
L_ok_45:
    v_pk_add_f32 v[48:49], v[128:129], v[132:133]
    v_pk_add_f32 v[50:51], v[130:131], v[134:135]
    s_nop 0
    v_permlane32_swap_b32 v48, v49
    v_permlane32_swap_b32 v50, v51
    v_add_f32 v48, v48, v49
    v_add_f32 v50, v50, v51
    s_nop 1
    v_permlane16_swap_b32 v48, v50
    v_add_f32 v48, v48, v50
    s_nop 1
    v_add_f32_dpp v48, v48, v48 row_ror:8 row_mask:0xf bank_mask:0xf
    v_cvt_pk_bf16_f32 v48, v48, v48
    v_and_b32_e64 v48, s90, v48
    v_mul_f32 v4, 0xbfb8aa3b, v48
    v_exp_f32_e64 v4, v4
    v_mov_b32_dpp v49, v48 row_ror:12 row_mask:0xf bank_mask:0xf
    v_add_f32 v4, 1.0, v4
    v_rcp_f32 v4, v4
    s_nop 0
    v_mul_f32 v4, v4, v48
    v_cvt_pk_bf16_f32 v4, v4, v4
    v_and_b32 v4, s90, v4
    v_mul_f32 v4, v4, v49
    v_mov_b32 v5, v4
    s_nop 1
    v_permlane32_swap_b32_e64 v4, v5
    v_cvt_pk_bf16_f32 v4, v4, v5
    s_nop 0
    v_readlane_b32 s76, v4, 0
    v_readlane_b32 s77, v4, 16
    v_readlane_b32 s78, v4, 1
    v_readlane_b32 s79, v4, 17
    v_readlane_b32 s80, v4, 2
    v_readlane_b32 s81, v4, 18
    v_readlane_b32 s82, v4, 3
    v_readlane_b32 s83, v4, 19
    v_dot2_f32_bf16 v40, v224, s76, 0
    v_dot2_f32_bf16 v41, v225, s76, 0
    v_dot2_f32_bf16 v42, v226, s76, 0
    v_dot2_f32_bf16 v43, v227, s76, 0
    v_dot2_f32_bf16 v40, v228, s77, v40
    v_dot2_f32_bf16 v41, v229, s77, v41
    v_dot2_f32_bf16 v42, v230, s77, v42
    v_dot2_f32_bf16 v43, v231, s77, v43
    v_dot2_f32_bf16 v40, v232, s78, v40
    v_dot2_f32_bf16 v41, v233, s78, v41
    v_dot2_f32_bf16 v42, v234, s78, v42
    v_dot2_f32_bf16 v43, v235, s78, v43
    v_dot2_f32_bf16 v40, v236, s79, v40
    v_dot2_f32_bf16 v41, v237, s79, v41
    v_dot2_f32_bf16 v42, v238, s79, v42
    v_dot2_f32_bf16 v43, v239, s79, v43
    v_dot2_f32_bf16 v40, v240, s80, v40
    v_dot2_f32_bf16 v41, v241, s80, v41
    v_dot2_f32_bf16 v42, v242, s80, v42
    v_dot2_f32_bf16 v43, v243, s80, v43
    v_dot2_f32_bf16 v40, v244, s81, v40
    v_dot2_f32_bf16 v41, v245, s81, v41
    v_dot2_f32_bf16 v42, v246, s81, v42
    v_dot2_f32_bf16 v43, v247, s81, v43
    v_dot2_f32_bf16 v40, v248, s82, v40
    v_dot2_f32_bf16 v41, v249, s82, v41
    v_dot2_f32_bf16 v42, v250, s82, v42
    v_dot2_f32_bf16 v43, v251, s82, v43
    v_dot2_f32_bf16 v40, v252, s83, v40
    v_dot2_f32_bf16 v41, v253, s83, v41
    v_dot2_f32_bf16 v42, v254, s83, v42
    v_dot2_f32_bf16 v43, v255, s83, v43
    s_bitcmp1_b32 s100, 1
    s_cbranch_scc1 L_loc_46
    s_nop 0
    buffer_store_dwordx4 v[40:43], v17, s[40:43], s85 offen sc1
    s_branch L_pubd_47
L_loc_46:
    s_nop 0
    buffer_store_dwordx4 v[40:43], v17, s[40:43], s85 offen
L_pubd_47:
    s_cmp_eq_u32 s62, 0
    s_cbranch_scc0 L_hby
    s_mov_b32 s88, 0
L_poll_48:
    buffer_load_dwordx4 v[136:139], v18, s[40:43], s86 offen sc1
    buffer_load_dwordx4 v[140:143], v18, s[40:43], s69 offen sc1
    buffer_load_dwordx4 v[144:147], v18, s[40:43], s70 offen sc1
    buffer_load_dwordx4 v[148:151], v18, s[40:43], s71 offen sc1
    s_waitcnt vmcnt(0)
    v_max3_u32 v4, v136, v140, v144
    v_max_u32 v4, v4, v148
    v_cmp_eq_u32_e64 vcc, -1, v4
    s_nop 0
    s_cbranch_vccz L_ok_49
    s_add_u32 s88, s88, 1
    s_cmp_lt_u32 s88, 65536
    s_cbranch_scc1 L_poll_48
L_ok_49:
    v_pk_add_f32 v[48:49], v[136:137], v[144:145]
    v_pk_add_f32 v[50:51], v[138:139], v[146:147]
    v_pk_add_f32 v[52:53], v[140:141], v[148:149]
    v_pk_add_f32 v[54:55], v[142:143], v[150:151]
    v_pk_add_f32 v[48:49], v[48:49], v[52:53]
    v_pk_add_f32 v[50:51], v[50:51], v[54:55]
    s_nop 0
    v_permlane32_swap_b32 v48, v49
    v_permlane32_swap_b32 v50, v51
    v_add_f32 v48, v48, v49
    v_add_f32 v50, v50, v51
    s_nop 1
    v_permlane16_swap_b32 v48, v50
    v_add_f32 v48, v48, v50
    s_nop 1
    v_add_f32_dpp v48, v48, v48 row_ror:8 row_mask:0xf bank_mask:0xf
    buffer_store_dword v48, v19, s[40:43], s99 offen offset:512 sc1
L_hby:
    s_barrier
    s_lshl2_add_u32 s72, s87, s62
    s_cmp_eq_u32 s72, 0
    s_cbranch_scc0 L_nowb_50
    s_waitcnt vmcnt(0)
    buffer_wbl2 sc1
L_nowb_50:
    s_branch L_hfin
L_final:
    s_barrier
    s_lshl2_add_u32 s72, s87, s62
    s_cmp_eq_u32 s72, 3
    s_cbranch_scc0 L_nowb_51
    s_waitcnt vmcnt(0)
    buffer_wbl2 sc1
L_nowb_51:
    s_cmp_eq_u32 s62, 1
    s_cbranch_scc0 L_noep_52
    s_cmp_eq_u32 s87, 0
    s_cbranch_scc0 L_noep_52
    v_mov_b32 v4, 13631488
    s_mov_b64 exec, 1
    buffer_store_dwordx2 v[88:89], v4, s[40:43], 0 offen sc1
    s_mov_b64 exec, -1
L_noep_52:
    s_cmp_eq_u32 s62, 0
    s_cbranch_scc0 L_hfin
    v_mov_b32 v8, s93
    v_cvt_pk_bf16_f32 v8, v8, v8
    v_and_b32_e64 v8, s90, v8
    v_mul_f32 v8, 0xbfb8aa3b, v8
    v_exp_f32 v8, v8
    s_nop 0
    v_add_f32 v8, 1.0, v8
    v_rcp_f32_e64 v8, v8
    s_nop 0
    v_cvt_pk_bf16_f32 v8, v8, v8
    v_and_b32 v8, s90, v8
    s_lshl_b32 s76, s92, 4
    s_lshr_b32 s77, s87, 1
    s_add_u32 s76, s76, s77
    s_mul_i32 s76, s76, 9344
    s_add_u32 s76, s76, 8388608
    s_and_b32 s77, s87, 1
    s_lshl_b32 s77, s77, 5
    s_add_u32 s76, s76, s77
    v_and_b32 v10, 1, v1
    v_lshlrev_b32_e64 v10, 6, v10
    v_bfe_u32 v4, v1, 1, 2
    v_lshl_add_u32 v10, v4, 3, v10
    v_bfe_u32 v4, v1, 4, 1
    v_lshl_add_u32 v10, v4, 2, v10
    v_lshrrev_b32_e64 v4, 3, v1
    v_mul_u32_u24 v6, 299008, v4
    v_and_b32_e64 v5, 7, v1
    v_lshl_add_u32 v6, v5, 4, v6
    v_mov_b32 v7, 2146435072
    v_cmp_gt_u32 vcc, 56, v1
    s_nop 1
    v_cndmask_b32_e64 v6, v7, v6, vcc
    s_mul_i32 s79, s87, 9344
    s_add_u32 s79, s79, 8388608
    s_lshl_b32 s80, s91, 11
    s_lshl_b32 s77, s87, 6
    s_add_u32 s80, s80, s77
    s_mov_b32 s88, 0
L_spin_53:
    buffer_load_dword v64, v10, s[40:43], s76 offen offset:0 sc1
    buffer_load_dword v65, v10, s[40:43], s76 offen offset:128 sc1
    s_waitcnt vmcnt(0)
    v_max_u32 v4, v64, v65
    v_cmp_eq_u32 vcc, -1, v4
    s_nop 0
    s_cbranch_vccz L_ok_54
    s_add_u32 s88, s88, 1
    s_cmp_lt_u32 s88, 65536
    s_cbranch_scc1 L_spin_53
L_ok_54:
    v_lshlrev_b32 v4, 4, v3
    v_lshrrev_b32 v64, v4, v64
    v_lshrrev_b32 v65, v4, v65
    v_lshlrev_b32 v64, 16, v64
    v_lshlrev_b32 v65, 16, v65
    v_lshrrev_b32 v9, 1, v19
    s_mov_b32 s88, 0
    buffer_load_dwordx4 v[128:131], v6, s[40:43], s79 offen offset:512 sc1
    buffer_load_dwordx4 v[128:131], v6, s[40:43], s79 offen offset:512 sc1
L_poll_55:
    buffer_load_dwordx4 v[128:131], v6, s[40:43], s79 offen offset:512 sc1
    s_waitcnt vmcnt(2)
    v_max3_u32 v4, v128, v129, v130
    v_max_u32 v4, v4, v131
    v_cmp_eq_u32 vcc, -1, v4
    s_nop 0
    s_cbranch_vccz L_ok_56
    s_add_u32 s88, s88, 1
    s_cmp_lt_u32 s88, 65536
    s_cbranch_scc1 L_poll_55
L_ok_56:
    v_mov_b32 v48, v128
    v_mov_b32 v49, v129
    v_mov_b32 v50, v130
    v_mov_b32 v51, v131
    v_permlane32_swap_b32 v48, v49
    s_nop 0
    v_permlane32_swap_b32 v50, v51
    v_add_f32 v48, v48, v49
    v_add_f32 v50, v50, v51
    s_nop 1
    v_permlane16_swap_b32 v48, v50
    v_add_f32 v48, v48, v50
    s_nop 1
    v_add_f32_dpp v48, v48, v48 row_ror:8 row_mask:0xf bank_mask:0xf
    v_cvt_pk_bf16_f32 v48, v48, v48
    v_and_b32 v48, s90, v48
    v_mul_f32 v48, v48, v8
    v_cvt_pk_bf16_f32 v48, v48, v48
    v_and_b32 v48, s90, v48
    v_add_f32 v48, v48, v64
    v_cvt_pk_bf16_f32 v48, v48, v48
    v_and_b32 v48, s90, v48
    v_add_f32 v48, v48, v65
    v_cvt_pk_bf16_f32 v48, v48, v48
    s_mov_b32 exec_lo, 0x00ff00ff
    s_mov_b32 exec_hi, 0x00ff00ff
    buffer_store_short v48, v9, s[44:47], s80 offen sc1
    s_mov_b64 exec, -1
L_hfin:
    s_endpgm
L_event:
    s_cmp_eq_u32 s77, 3
    s_cbranch_scc0 L_ev1
    buffer_load_dwordx4 v[92:95], v90, s[40:43], 0 offen sc1
    s_mov_b64 exec, 3
    global_load_dword v27, v91, s[66:67]
    s_mov_b64 exec, -1
    s_branch L_evret
L_ev1:
    s_cmp_eq_u32 s77, 5
    s_cbranch_scc0 L_ev_57
    s_and_b32 s72, s84, 15
    s_mov_b32 m0, s70
    s_lshl_b32 s71, s72, 7
    buffer_load_dwordx4 v16, s[28:31], s71 offen offset:0 lds
    s_mul_i32 s72, s72, 393216
    s_lshr_b64 s[84:85], s[84:85], 4
    buffer_load_dwordx4 v17, s[28:31], s71 offen offset:1024 lds
    buffer_load_dwordx4 v18, s[28:31], s71 offen offset:2048 lds
    buffer_load_dwordx4 v19, s[28:31], s71 offen offset:3072 lds
    s_add_u32 m0, s70, 4096
    s_nop 0
    buffer_load_dwordx4 v20, s[32:35], s72 offen offset:0 lds
    buffer_load_dwordx4 v21, s[32:35], s72 offen offset:1024 lds
    buffer_load_dwordx4 v22, s[32:35], s72 offen offset:2048 lds
    buffer_load_dwordx4 v23, s[32:35], s72 offen offset:3072 lds
    s_add_u32 m0, s70, 8192
    s_nop 0
    buffer_load_dwordx4 v24, s[32:35], s72 offen offset:0 lds
    buffer_load_dwordx4 v25, s[32:35], s72 offen offset:1024 lds
    s_add_u32 s70, s70, 40960
    s_cmp_ge_u32 s70, 122880
    s_cselect_b32 s76, 122880, 0
    s_sub_u32 s70, s70, s76
    buffer_load_dwordx4 v[96:99], v76, s[48:51], s75 offen nt
    s_add_u32 s75, s75, 7168
    buffer_load_dwordx4 v[100:103], v76, s[48:51], s75 offen nt
    s_add_u32 s75, s75, 7168
    buffer_load_dwordx4 v[104:107], v76, s[48:51], s75 offen nt
    s_add_u32 s75, s75, 7168
    buffer_load_dwordx4 v[108:111], v76, s[48:51], s75 offen nt
    s_add_u32 s75, s75, 7168
    buffer_load_dwordx4 v[128:131], v76, s[48:51], s75 offen nt
    s_add_u32 s75, s75, 7168
    buffer_load_dwordx4 v[132:135], v76, s[48:51], s75 offen nt
    s_add_u32 s75, s75, 7168
    buffer_load_dwordx4 v[136:139], v76, s[48:51], s75 offen nt
    s_add_u32 s75, s75, 7168
    buffer_load_dwordx4 v[140:143], v76, s[48:51], s75 offen nt
    s_add_u32 s75, s75, 7168
    s_waitcnt vmcnt(18)
    s_branch L_hbar
L_ev_57:
    s_cmp_eq_u32 s77, 6
    s_cbranch_scc0 L_ev_58
    s_and_b32 s72, s84, 15
    s_mov_b32 m0, s70
    s_lshl_b32 s71, s72, 7
    buffer_load_dwordx4 v16, s[28:31], s71 offen offset:0 lds
    s_mul_i32 s72, s72, 393216
    s_lshr_b64 s[84:85], s[84:85], 4
    buffer_load_dwordx4 v17, s[28:31], s71 offen offset:1024 lds
    buffer_load_dwordx4 v18, s[28:31], s71 offen offset:2048 lds
    buffer_load_dwordx4 v19, s[28:31], s71 offen offset:3072 lds
    s_add_u32 m0, s70, 4096
    s_nop 0
    buffer_load_dwordx4 v20, s[32:35], s72 offen offset:0 lds
    buffer_load_dwordx4 v21, s[32:35], s72 offen offset:1024 lds
    buffer_load_dwordx4 v22, s[32:35], s72 offen offset:2048 lds
    buffer_load_dwordx4 v23, s[32:35], s72 offen offset:3072 lds
    s_add_u32 m0, s70, 8192
    s_nop 0
    buffer_load_dwordx4 v24, s[32:35], s72 offen offset:0 lds
    buffer_load_dwordx4 v25, s[32:35], s72 offen offset:1024 lds
    s_add_u32 s70, s70, 40960
    s_cmp_ge_u32 s70, 122880
    s_cselect_b32 s76, 122880, 0
    s_sub_u32 s70, s70, s76
    s_lshr_b32 s78, s2, 3
    s_lshl2_add_u32 s78, s78, s62
    s_lshl_b32 s78, s78, 14
    v_lshlrev_b32_e64 v11, 10, v1
    s_mov_b64 exec, 65535
    buffer_load_dword v27, v11, s[36:39], s78 offen offset:384
    s_mov_b64 exec, -1
    s_lshl_b32 s78, s62, 9
    v_lshl_add_u32 v11, v1, 7, s78
    s_mov_b64 exec, 15
    global_load_dword v27, v11, s[14:15]
    s_mov_b64 exec, -1
    buffer_load_dwordx4 v[112:115], v76, s[48:51], s75 offen nt
    s_add_u32 s75, s75, 7168
    buffer_load_dwordx4 v[116:119], v76, s[48:51], s75 offen nt
    s_add_u32 s75, s75, 7168
    buffer_load_dwordx4 v[120:123], v76, s[48:51], s75 offen nt
    s_add_u32 s75, s75, 7168
    buffer_load_dwordx4 v[124:127], v76, s[48:51], s75 offen nt
    s_add_u32 s75, s75, 7168
    buffer_load_dwordx4 v[144:147], v76, s[48:51], s75 offen nt
    s_add_u32 s75, s75, 7168
    buffer_load_dwordx4 v[148:151], v76, s[48:51], s75 offen nt
    s_add_u32 s75, s75, 7168
    s_waitcnt vmcnt(18)
    s_branch L_hbar
L_ev_58:
    s_add_u32 s78, s70, 40960
    s_cmp_ge_u32 s78, 122880
    s_cselect_b32 s76, 122880, 0
    s_sub_u32 s78, s78, s76
    s_cmp_eq_u32 s77, 2
    s_cbranch_scc1 L_evw
    v_add_u32 v4, s78, v72
    v_xor_b32 v5, 32, v4
    v_xor_b32 v6, 64, v4
    v_xor_b32 v7, 96, v4
    s_and_b32 s72, s84, 15
    s_mov_b32 m0, s70
    s_lshl_b32 s71, s72, 7
    buffer_load_dwordx4 v16, s[28:31], s71 offen offset:0 lds
    s_mul_i32 s72, s72, 393216
    s_lshr_b64 s[84:85], s[84:85], 4
    ds_read_b128 v[32:35], v4
    ds_read_b128 v[36:39], v5
    ds_read_b128 v[40:43], v6
    ds_read_b128 v[44:47], v7
    buffer_load_dwordx4 v17, s[28:31], s71 offen offset:1024 lds
    s_lshl_b32 s79, s62, 8
    s_add_u32 s79, s79, s73
    s_waitcnt lgkmcnt(0)
    v_lshlrev_b32 v80, 16, v32
    v_and_b32 v82, s90, v32
    v_mul_f32 v81, v80, v80
    v_mul_f32 v83, v82, v82
    v_lshlrev_b32 v10, 16, v33
    v_and_b32 v11, s90, v33
    v_add_f32 v80, v80, v10
    v_add_f32 v82, v82, v11
    v_fmac_f32 v81, v10, v10
    v_fmac_f32 v83, v11, v11
    v_lshlrev_b32 v8, 16, v34
    v_and_b32_e64 v9, s90, v34
    buffer_load_dwordx4 v18, s[28:31], s71 offen offset:2048 lds
    v_add_f32 v80, v80, v8
    v_add_f32 v82, v82, v9
    v_fmac_f32 v81, v8, v8
    v_fmac_f32 v83, v9, v9
    v_lshlrev_b32 v10, 16, v35
    v_and_b32 v11, s90, v35
    v_add_f32 v80, v80, v10
    v_add_f32 v82, v82, v11
    v_fmac_f32 v81, v10, v10
    v_fmac_f32 v83, v11, v11
    v_lshlrev_b32 v8, 16, v36
    v_and_b32 v9, s90, v36
    buffer_load_dwordx4 v19, s[28:31], s71 offen offset:3072 lds
    v_add_f32 v80, v80, v8
    v_add_f32 v82, v82, v9
    v_fmac_f32 v81, v8, v8
    v_fmac_f32 v83, v9, v9
    v_lshlrev_b32 v10, 16, v37
    v_and_b32 v11, s90, v37
    v_add_f32 v80, v80, v10
    v_add_f32 v82, v82, v11
    v_fmac_f32 v81, v10, v10
    v_fmac_f32 v83, v11, v11
    v_lshlrev_b32 v8, 16, v38
    v_and_b32 v9, s90, v38
    s_add_u32 m0, s70, 4096
    s_nop 0
    buffer_load_dwordx4 v20, s[32:35], s72 offen offset:0 lds
    v_add_f32 v80, v80, v8
    v_add_f32 v82, v82, v9
    v_fmac_f32 v81, v8, v8
    v_fmac_f32 v83, v9, v9
    v_lshlrev_b32 v10, 16, v39
    v_and_b32 v11, s90, v39
    v_add_f32 v80, v80, v10
    v_add_f32 v82, v82, v11
    v_fmac_f32 v81, v10, v10
    v_fmac_f32 v83, v11, v11
    v_lshlrev_b32 v8, 16, v40
    v_and_b32_e64 v9, s90, v40
    buffer_load_dwordx4 v21, s[32:35], s72 offen offset:1024 lds
    v_add_f32 v80, v80, v8
    v_add_f32 v82, v82, v9
    v_fmac_f32 v81, v8, v8
    v_fmac_f32 v83, v9, v9
    v_lshlrev_b32 v10, 16, v41
    v_and_b32 v11, s90, v41
    v_add_f32 v80, v80, v10
    v_add_f32 v82, v82, v11
    v_fmac_f32 v81, v10, v10
    v_fmac_f32 v83, v11, v11
    v_lshlrev_b32 v8, 16, v42
    v_and_b32 v9, s90, v42
    buffer_load_dwordx4 v22, s[32:35], s72 offen offset:2048 lds
    v_add_f32 v80, v80, v8
    v_add_f32 v82, v82, v9
    v_fmac_f32 v81, v8, v8
    v_fmac_f32 v83, v9, v9
    v_lshlrev_b32 v10, 16, v43
    v_and_b32 v11, s90, v43
    v_add_f32 v80, v80, v10
    v_add_f32 v82, v82, v11
    v_fmac_f32 v81, v10, v10
    v_fmac_f32 v83, v11, v11
    v_lshlrev_b32 v8, 16, v44
    v_and_b32 v9, s90, v44
    buffer_load_dwordx4 v23, s[32:35], s72 offen offset:3072 lds
    v_add_f32 v80, v80, v8
    v_add_f32 v82, v82, v9
    v_fmac_f32 v81, v8, v8
    v_fmac_f32 v83, v9, v9
    v_lshlrev_b32 v10, 16, v45
    v_and_b32 v11, s90, v45
    v_add_f32 v80, v80, v10
    v_add_f32 v82, v82, v11
    v_fmac_f32 v81, v10, v10
    v_fmac_f32 v83, v11, v11
    v_lshlrev_b32 v8, 16, v46
    v_and_b32 v9, s90, v46
    s_add_u32 m0, s70, 8192
    s_nop 0
    buffer_load_dwordx4 v24, s[32:35], s72 offen offset:0 lds
    v_add_f32 v80, v80, v8
    v_add_f32 v82, v82, v9
    v_fmac_f32 v81, v8, v8
    v_fmac_f32 v83, v9, v9
    v_lshlrev_b32 v10, 16, v47
    v_and_b32 v11, s90, v47
    v_add_f32 v80, v80, v10
    v_add_f32 v82, v82, v11
    v_fmac_f32 v81, v10, v10
    v_fmac_f32_e64 v83, v11, v11
    buffer_load_dwordx4 v25, s[32:35], s72 offen offset:1024 lds
    s_add_u32 s70, s70, 40960
    s_cmp_ge_u32 s70, 122880
    s_cselect_b32 s76, 122880, 0
    s_sub_u32 s70, s70, s76
    v_add_f32 v80, v80, v82
    v_add_f32 v81, v81, v83
    v_mov_b32 v82, v80
    v_mov_b32 v83, v81
    s_nop 0
    v_permlane32_swap_b32 v80, v82
    v_permlane32_swap_b32 v81, v83
    v_add_f32 v80, v80, v82
    v_add_f32_e64 v81, v81, v83
    s_mov_b32 exec_hi, 0
    buffer_store_dwordx2 v[80:81], v74, s[40:43], s79 offen offset:0 sc1
    s_mov_b64 exec, -1
    s_waitcnt vmcnt(11)
    s_branch L_hbar
L_evw:
    s_mul_i32 s79, s63, 2048
    s_add_u32 s79, s79, s78
    v_add_u32_e64 v4, s79, v73
    s_mul_i32 s79, s63, 20480
    s_add_u32 s79, s79, s78
    v_add_u32_e64 v5, s79, v73
    s_and_b32 s72, s84, 15
    s_mov_b32 m0, s70
    s_lshl_b32 s71, s72, 7
    buffer_load_dwordx4 v16, s[28:31], s71 offen offset:0 lds
    s_mul_i32 s72, s72, 393216
    s_lshr_b64 s[84:85], s[84:85], 4
    ds_read_b64_tr_b16 v[32:33], v4 offset:0
    ds_read_b64_tr_b16 v[34:35], v4 offset:512
    ds_read_b64_tr_b16 v[36:37], v4 offset:10240
    ds_read_b64_tr_b16 v[38:39], v4 offset:10752
    ds_read_b64_tr_b16 v[40:41], v4 offset:20480
    ds_read_b64_tr_b16 v[42:43], v4 offset:20992
    ds_read_b64_tr_b16 v[44:45], v4 offset:30720
    ds_read_b64_tr_b16 v[46:47], v4 offset:31232
    ds_read_b64_tr_b16 v[48:49], v5 offset:4096
    ds_read_b64_tr_b16 v[50:51], v5 offset:4608
    ds_read_b64_tr_b16 v[52:53], v5 offset:14336
    ds_read_b64_tr_b16 v[54:55], v5 offset:14848
    buffer_load_dwordx4 v17, s[28:31], s71 offen offset:1024 lds
    s_lshl_b32 s79, s64, 9
    s_lshl_b32 s80, s63, 3
    s_add_u32 s79, s79, s80
    s_add_u32 s79, s79, s73
    s_waitcnt lgkmcnt(0)
    v_lshlrev_b32 v80, 16, v32
    v_and_b32 v82, s90, v32
    v_lshlrev_b32 v10, 16, v33
    v_and_b32 v11, s90, v33
    v_add_f32 v80, v80, v10
    v_add_f32 v82, v82, v11
    v_lshlrev_b32 v8, 16, v34
    v_and_b32 v9, s90, v34
    v_add_f32 v80, v80, v8
    v_add_f32 v82, v82, v9
    v_lshlrev_b32 v10, 16, v35
    v_and_b32 v11, s90, v35
    buffer_load_dwordx4 v18, s[28:31], s71 offen offset:2048 lds
    v_add_f32 v80, v80, v10
    v_add_f32 v82, v82, v11
    v_lshlrev_b32 v8, 16, v36
    v_and_b32 v9, s90, v36
    v_add_f32 v80, v80, v8
    v_add_f32 v82, v82, v9
    v_lshlrev_b32 v10, 16, v37
    v_and_b32 v11, s90, v37
    v_add_f32 v80, v80, v10
    v_add_f32 v82, v82, v11
    v_lshlrev_b32 v8, 16, v38
    v_and_b32 v9, s90, v38
    buffer_load_dwordx4 v19, s[28:31], s71 offen offset:3072 lds
    v_add_f32 v80, v80, v8
    v_add_f32 v82, v82, v9
    v_lshlrev_b32 v10, 16, v39
    v_and_b32 v11, s90, v39
    v_add_f32 v80, v80, v10
    v_add_f32 v82, v82, v11
    v_lshlrev_b32 v8, 16, v40
    v_and_b32 v9, s90, v40
    v_add_f32 v80, v80, v8
    v_add_f32 v82, v82, v9
    v_lshlrev_b32 v10, 16, v41
    v_and_b32 v11, s90, v41
    s_add_u32 m0, s70, 4096
    s_nop 0
    buffer_load_dwordx4 v20, s[32:35], s72 offen offset:0 lds
    v_add_f32 v80, v80, v10
    v_add_f32 v82, v82, v11
    v_lshlrev_b32 v8, 16, v42
    v_and_b32 v9, s90, v42
    v_add_f32 v80, v80, v8
    v_add_f32 v82, v82, v9
    v_lshlrev_b32 v10, 16, v43
    v_and_b32 v11, s90, v43
    v_add_f32 v80, v80, v10
    v_add_f32 v82, v82, v11
    v_lshlrev_b32 v8, 16, v44
    v_and_b32_e64 v9, s90, v44
    buffer_load_dwordx4 v21, s[32:35], s72 offen offset:1024 lds
    v_add_f32 v80, v80, v8
    v_add_f32 v82, v82, v9
    v_lshlrev_b32 v10, 16, v45
    v_and_b32 v11, s90, v45
    v_add_f32 v80, v80, v10
    v_add_f32 v82, v82, v11
    v_lshlrev_b32 v8, 16, v46
    v_and_b32 v9, s90, v46
    v_add_f32 v80, v80, v8
    v_add_f32 v82, v82, v9
    v_lshlrev_b32 v10, 16, v47
    v_and_b32 v11, s90, v47
    buffer_load_dwordx4 v22, s[32:35], s72 offen offset:2048 lds
    v_add_f32 v80, v80, v10
    v_add_f32 v82, v82, v11
    v_lshlrev_b32 v81, 16, v48
    v_and_b32 v83, s90, v48
    v_lshlrev_b32 v10, 16, v49
    v_and_b32 v11, s90, v49
    v_add_f32 v81, v81, v10
    v_add_f32 v83, v83, v11
    v_lshlrev_b32 v8, 16, v50
    v_and_b32 v9, s90, v50
    v_add_f32 v81, v81, v8
    v_add_f32 v83, v83, v9
    buffer_load_dwordx4 v23, s[32:35], s72 offen offset:3072 lds
    v_lshlrev_b32 v10, 16, v51
    v_and_b32 v11, s90, v51
    v_add_f32 v81, v81, v10
    v_add_f32 v83, v83, v11
    v_lshlrev_b32 v8, 16, v52
    v_and_b32 v9, s90, v52
    v_add_f32 v81, v81, v8
    v_add_f32 v83, v83, v9
    v_lshlrev_b32 v10, 16, v53
    v_and_b32 v11, s90, v53
    v_add_f32 v81, v81, v10
    v_add_f32 v83, v83, v11
    s_add_u32 m0, s70, 8192
    s_nop 0
    buffer_load_dwordx4 v24, s[32:35], s72 offen offset:0 lds
    v_lshlrev_b32 v8, 16, v54
    v_and_b32 v9, s90, v54
    v_add_f32 v81, v81, v8
    v_add_f32 v83, v83, v9
    v_lshlrev_b32 v10, 16, v55
    v_and_b32 v11, s90, v55
    v_add_f32 v81, v81, v10
    v_add_f32_e64 v83, v83, v11
    buffer_load_dwordx4 v25, s[32:35], s72 offen offset:1024 lds
    s_add_u32 s70, s70, 40960
    s_cmp_ge_u32 s70, 122880
    s_cselect_b32 s76, 122880, 0
    s_sub_u32 s70, s70, s76
    v_add_f32 v80, v80, v82
    v_add_f32 v81, v81, v83
    v_mov_b32 v82, v80
    v_mov_b32 v83, v81
    s_nop 0
    v_permlane32_swap_b32 v80, v82
    v_permlane32_swap_b32 v81, v83
    v_add_f32 v80, v80, v82
    v_add_f32_e64 v81, v81, v83
    s_mov_b32 exec_hi, 0
    buffer_store_dwordx2 v[80:81], v12, s[40:43], s79 offen offset:1024 sc1
    s_mov_b64 exec, -1
    s_waitcnt vmcnt(11)
    s_branch L_hbar
L_compute:
    s_setprio 2
    s_and_b32 s63, s62, 1
    s_lshr_b32 s64, s62, 1
    s_lshl_b32 s73, s60, 4
    s_add_u32 s73, s73, s61
    s_mul_i32 s73, s73, 28800
    s_add_u32 s76, s2, 7
    s_and_b32 s76, s76, 7
    s_bfe_u32 s77, s2, 0x10003
    s_lshl1_add_u32 s97, s76, s77
    s_lshr_b32 s98, s2, 4
    s_lshl_b32 s99, s97, 4
    s_add_u32 s99, s99, s98
    s_mul_i32 s99, s99, 9344
    s_add_u32 s99, s99, 8388608
    s_lshr_b32 s65, s97, 1
    s_lshl_b32 s76, s97, 3
    s_add_u32 s65, s65, s76
    s_mul_i32 s76, s98, 4
    s_add_u32 s65, s65, s76
    s_and_b32 s65, s65, 15
    s_mov_b32 s89, 0x3f803f80
    s_mov_b32 s90, 0xffff0000
    v_and_b32 v2, 31, v1
    v_lshrrev_b32 v3, 5, v1
    v_lshlrev_b32 v12, 4, v1
    v_lshrrev_b32 v4, 3, v1
    v_mul_u32_u24 v13, 460800, v4
    v_and_b32_e64 v4, 7, v1
    v_lshl_add_u32 v13, v4, 4, v13
    v_and_b32 v10, 15, v1
    v_lshrrev_b32 v11, 4, v1
    s_mul_i32 s76, s63, 20480
    v_lshrrev_b32 v4, 1, v10
    v_xor_b32 v4, v4, v11
    v_lshlrev_b32_e64 v4, 4, v4
    v_lshl_add_u32 v4, v10, 7, v4
    v_add_u32 v192, s76, v4
    v_xor_b32 v193, 64, v192
    v_bfe_u32 v4, v1, 2, 2
    v_and_b32_e64 v6, 1, v11
    v_lshl_add_u32 v5, v6, 3, v4
    v_lshlrev_b32 v5, 7, v5
    v_lshrrev_b32 v4, 1, v4
    v_xor_b32_e64 v4, s64, v4
    v_lshl_add_u32 v5, v4, 6, v5
    v_lshl_add_u32 v5, v6, 5, v5
    v_and_b32_e64 v4, 3, v1
    v_lshl_add_u32 v5, v4, 3, v5
    v_mul_u32_u24 v4, 10240, v3
    v_add_u32_e64 v5, v5, v4
    v_add_u32 v194, 4096, v5
    v_xor_b32_e64 v195, 32, v194
    v_add_u32 v196, 40960, v192
    v_add_u32 v197, 40960, v193
    v_add_u32 v198, 40960, v194
    v_add_u32 v199, 40960, v195
    v_add_u32 v200, 81920, v192
    v_add_u32 v201, 81920, v193
    v_add_u32 v202, 81920, v194
    v_add_u32 v203, 81920, v195
    v_bfe_u32 v4, v1, 2, 2
    v_lshl_add_u32 v4, v3, 3, v4
    v_lshlrev_b32 v4, 6, v4
    v_and_b32 v5, 1, v11
    v_lshl_add_u32 v4, v5, 5, v4
    v_and_b32_e64 v5, 3, v1
    v_lshl_add_u32 v4, v5, 3, v4
    s_lshl_b32 s76, s64, 11
    s_add_u32 s76, s76, 122880
    v_add_u32_e64 v212, s76, v4
    s_lshl_b32 s76, s63, 9
    v_lshl_add_u32 v213, v10, 3, s76
    v_lshl_add_u32 v214, v2, 3, s76
    s_lshl_b32 s76, s64, 8
    v_lshl_add_u32 v215, v10, 3, s76
    v_bfe_u32 v4, v10, 1, 1
    v_xor_b32 v4, s64, v4
    v_lshrrev_b32 v5, 2, v10
    v_xor_b32 v5, v5, v3
    v_xor_b32 v6, v10, v11
    v_and_b32 v6, 1, v6
    v_lshlrev_b32_e64 v4, 6, v4
    v_lshl_add_u32 v4, v5, 4, v4
    v_lshl_add_u32 v4, v6, 3, v4
    v_lshl_add_u32 v4, v10, 7, v4
    s_lshl_b32 s76, s63, 13
    v_add_u32 v216, s76, v4
    v_bfe_u32 v4, v2, 1, 1
    v_bfe_u32 v5, v2, 2, 2
    v_and_b32 v6, 1, v2
    v_xor_b32 v6, v6, v3
    v_lshlrev_b32_e64 v4, 6, v4
    v_lshl_add_u32 v4, v5, 4, v4
    v_lshl_add_u32 v4, v6, 3, v4
    v_lshl_add_u32 v4, v2, 7, v4
    s_lshl_b32 s77, s64, 14
    s_add_u32 s76, s76, s77
    v_add_u32_e64 v217, s76, v4
    v_bfe_u32 v4, v1, 2, 2
    v_lshl_add_u32 v5, v3, 3, v4
    v_lshlrev_b32 v5, 7, v5
    v_lshrrev_b32 v6, 1, v4
    v_lshl_add_u32 v5, v6, 6, v5
    v_bfe_u32 v6, v1, 4, 1
    v_xor_b32_e64 v6, v6, v3
    v_lshl_add_u32 v5, v6, 5, v5
    v_bfe_u32 v6, v1, 1, 1
    v_lshl_add_u32 v5, v6, 4, v5
    v_xor_b32 v6, v1, v4
    v_and_b32 v6, 1, v6
    v_lshl_add_u32 v5, v6, 3, v5
    s_lshl_b32 s76, s63, 13
    v_xor_b32 v5, s76, v5
    s_lshl_b32 s76, s63, 6
    s_or_b32 s76, s76, s77
    v_xor_b32 v218, s76, v5
    s_lshl_b32 s76, s64, 6
    v_xor_b32_e64 v220, s76, v5
    v_xor_b32 v219, 528, v218
    v_xor_b32 v221, 528, v220
    v_cmp_gt_u32 s[86:87], 16, v1
    s_waitcnt lgkmcnt(0)
    s_mov_b32 s40, s26
    s_and_b32 s41, s27, 0xffff
    s_mov_b32 s42, 33554432
    s_mov_b32 s43, 0x20000
    s_mov_b32 s44, s22
    s_and_b32 s45, s23, 0xffff
    s_mov_b32 s46, 4194304
    s_mov_b32 s47, 0x20000
    s_mov_b32 s68, 0
    s_getreg_b32 s101, hwreg(HW_REG_XCC_ID, 0, 4)
    v_mov_b32 v9, 13631488
    s_lshl_b32 s76, s61, 8
    s_lshl4_add_u32 s76, s60, s76
    s_add_u32 s76, s76, 12582912
    v_mov_b32 v8, s76
    s_lshl_b32 s76, s60, 8
    s_lshl4_add_u32 s76, s61, s76
    s_add_u32 s76, s76, 12587008
    v_writelane_b32 v8, s76, 1
    s_lshl_b32 s76, s97, 8
    s_lshl4_add_u32 s76, s98, s76
    s_add_u32 s76, s76, 12591104
    v_writelane_b32 v8, s76, 2
    v_mov_b32 v6, s101
    v_mov_b32 v7, 0
    v_mov_b32_e64 v10, 0
    s_cmp_eq_u32 s62, 0
    s_cbranch_scc0 L_noep
    buffer_load_dwordx2 v[4:5], v9, s[40:43], 0 offen
L_noep:
    s_barrier
    ds_read_b128 v[112:115], v192 offset:0
    ds_read_b64_tr_b16 v[128:129], v194 offset:0
    ds_read_b64_tr_b16 v[130:131], v194 offset:512
    ds_read_b128 v[116:119], v192 offset:2048
    ds_read_b128 v[120:123], v192 offset:10240
    ds_read_b128 v[124:127], v192 offset:12288
    ds_read_b64_tr_b16 v[132:133], v195 offset:0
    ds_read_b64_tr_b16 v[134:135], v195 offset:512
    ds_read_b64_tr_b16 v[136:137], v194 offset:2048
    ds_read_b64_tr_b16 v[138:139], v194 offset:2560
    ds_read_b64_tr_b16 v[140:141], v195 offset:2048
    ds_read_b64_tr_b16 v[142:143], v195 offset:2560
    ds_read_b64_tr_b16 v[144:145], v194 offset:4096
    ds_read_b64_tr_b16 v[146:147], v194 offset:4608
    s_waitcnt lgkmcnt(8)
    ds_read_b64_tr_b16 v[148:149], v195 offset:4096
    ds_read_b64_tr_b16 v[150:151], v195 offset:4608
    v_mfma_f32_16x16x32_bf16 v[16:19], v[128:131], v[112:115], 0
    ds_read_b128 v[152:155], v193 offset:0
    v_mfma_f32_16x16x32_bf16 v[20:23], v[128:131], v[116:119], 0
    ds_read_b64_tr_b16 v[168:169], v194 offset:20480
    v_mfma_f32_16x16x32_bf16 v[24:27], v[128:131], v[120:123], 0
    ds_read_b64_tr_b16 v[170:171], v194 offset:20992
    v_mfma_f32_16x16x32_bf16 v[28:31], v[128:131], v[124:127], 0
    ds_read_b128 v[156:159], v193 offset:2048
    s_waitcnt lgkmcnt(4)
    v_mfma_f32_16x16x32_bf16 v[44:47], v[132:135], v[124:127], 0
    ds_read_b128 v[160:163], v193 offset:10240
    v_mfma_f32_16x16x32_bf16 v[40:43], v[132:135], v[120:123], 0
    ds_read_b128 v[164:167], v193 offset:12288
    v_mfma_f32_16x16x32_bf16 v[36:39], v[132:135], v[116:119], 0
    ds_read_b64_tr_b16 v[172:173], v195 offset:20480
    v_mfma_f32_16x16x32_bf16 v[32:35], v[132:135], v[112:115], 0
    ds_read_b64_tr_b16 v[174:175], v195 offset:20992
    v_mfma_f32_16x16x32_bf16 v[48:51], v[136:139], v[112:115], 0
    ds_read_b64_tr_b16 v[176:177], v194 offset:22528
    v_mfma_f32_16x16x32_bf16 v[52:55], v[136:139], v[116:119], 0
    ds_read_b64_tr_b16 v[178:179], v194 offset:23040
    v_mfma_f32_16x16x32_bf16 v[56:59], v[136:139], v[120:123], 0
    ds_read_b64_tr_b16 v[180:181], v195 offset:22528
    v_mfma_f32_16x16x32_bf16 v[60:63], v[136:139], v[124:127], 0
    ds_read_b64_tr_b16 v[182:183], v195 offset:23040
    v_mfma_f32_16x16x32_bf16 v[76:79], v[140:143], v[124:127], 0
    ds_read_b64_tr_b16 v[184:185], v194 offset:24576
    v_mfma_f32_16x16x32_bf16 v[72:75], v[140:143], v[120:123], 0
    ds_read_b64_tr_b16 v[186:187], v194 offset:25088
    v_mfma_f32_16x16x32_bf16 v[68:71], v[140:143], v[116:119], 0
    ds_read_b64_tr_b16 v[188:189], v195 offset:24576
    v_mfma_f32_16x16x32_bf16 v[64:67], v[140:143], v[112:115], 0
    ds_read_b64_tr_b16 v[190:191], v195 offset:25088
    v_mfma_f32_16x16x32_bf16 v[80:83], v[144:147], v[112:115], 0
    v_mfma_f32_16x16x32_bf16 v[84:87], v[144:147], v[116:119], 0
    v_mfma_f32_16x16x32_bf16 v[88:91], v[144:147], v[120:123], 0
    v_mfma_f32_16x16x32_bf16 v[92:95], v[144:147], v[124:127], 0
    v_mfma_f32_16x16x32_bf16 v[108:111], v[148:151], v[124:127], 0
    v_mfma_f32_16x16x32_bf16 v[104:107], v[148:151], v[120:123], 0
    v_mfma_f32_16x16x32_bf16 v[100:103], v[148:151], v[116:119], 0
    v_mfma_f32_16x16x32_bf16 v[96:99], v[148:151], v[112:115], 0
    s_waitcnt lgkmcnt(0)
    v_mfma_f32_16x16x32_bf16 v[16:19], v[168:171], v[152:155], v[16:19]
    s_barrier
    v_mfma_f32_16x16x32_bf16 v[20:23], v[168:171], v[156:159], v[20:23]
    ds_read_b128 v[112:115], v196 offset:0
    ds_read_b64_tr_b16 v[204:205], v212 offset:0
    ds_read_b64_tr_b16 v[206:207], v212 offset:256
    ds_read_b64_tr_b16 v[208:209], v212 offset:1024
    ds_read_b64_tr_b16 v[210:211], v212 offset:1280
    v_mfma_f32_16x16x32_bf16 v[24:27], v[168:171], v[160:163], v[24:27]
    ds_read_b64_tr_b16 v[128:129], v198 offset:0
    s_cmp_eq_u32 s62, 0
    s_cbranch_scc0 L_cloop
    s_waitcnt vmcnt(0)
    v_add_co_u32 v4, vcc, 1, v4
    s_nop 1
    v_addc_co_u32 v5, vcc, 0, v5, vcc
    s_mov_b64 exec, 7
    buffer_store_dwordx4 v[4:7], v8, s[40:43], 0 offen sc1
    s_mov_b64 exec, -1
.p2align 3
L_cloop:
    v_mfma_f32_16x16x32_bf16 v[28:31], v[168:171], v[164:167], v[28:31]
    ds_read_b64_tr_b16 v[130:131], v198 offset:512
    v_mfma_f32_16x16x32_bf16 v[44:47], v[172:175], v[164:167], v[44:47]
    ds_read_b128 v[116:119], v196 offset:2048
    v_mfma_f32_16x16x32_bf16 v[40:43], v[172:175], v[160:163], v[40:43]
    ds_read_b128 v[120:123], v196 offset:10240
    v_mfma_f32_16x16x32_bf16 v[36:39], v[172:175], v[156:159], v[36:39]
    ds_read_b128 v[124:127], v196 offset:12288
    v_mfma_f32_16x16x32_bf16 v[32:35], v[172:175], v[152:155], v[32:35]
    ds_read_b64_tr_b16 v[132:133], v199 offset:0
    v_mfma_f32_16x16x32_bf16 v[48:51], v[176:179], v[152:155], v[48:51]
    ds_read_b64_tr_b16 v[134:135], v199 offset:512
    v_mfma_f32_16x16x32_bf16 v[52:55], v[176:179], v[156:159], v[52:55]
    ds_read_b64_tr_b16 v[136:137], v198 offset:2048
    v_mfma_f32_16x16x32_bf16 v[56:59], v[176:179], v[160:163], v[56:59]
    ds_read_b64_tr_b16 v[138:139], v198 offset:2560
    v_mfma_f32_16x16x32_bf16 v[60:63], v[176:179], v[164:167], v[60:63]
    ds_read_b64_tr_b16 v[140:141], v199 offset:2048
    v_mfma_f32_16x16x32_bf16 v[76:79], v[180:183], v[164:167], v[76:79]
    ds_read_b64_tr_b16 v[142:143], v199 offset:2560
    v_mfma_f32_16x16x32_bf16 v[72:75], v[180:183], v[160:163], v[72:75]
    ds_read_b64_tr_b16 v[144:145], v198 offset:4096
    v_mfma_f32_16x16x32_bf16 v[68:71], v[180:183], v[156:159], v[68:71]
    ds_read_b64_tr_b16 v[146:147], v198 offset:4608
    v_mfma_f32_16x16x32_bf16 v[64:67], v[180:183], v[152:155], v[64:67]
    ds_read_b64_tr_b16 v[148:149], v199 offset:4096
    v_mfma_f32_16x16x32_bf16 v[80:83], v[184:187], v[152:155], v[80:83]
    ds_read_b64_tr_b16 v[150:151], v199 offset:4608
    v_mfma_f32_16x16x32_bf16 v[84:87], v[184:187], v[156:159], v[84:87]
    v_mfma_f32_16x16x32_bf16 v[88:91], v[184:187], v[160:163], v[88:91]
    v_mfma_f32_16x16x32_bf16 v[92:95], v[184:187], v[164:167], v[92:95]
    v_mfma_f32_16x16x32_bf16 v[108:111], v[188:191], v[164:167], v[108:111]
    v_mfma_f32_16x16x32_bf16 v[104:107], v[188:191], v[160:163], v[104:107]
    v_mfma_f32_16x16x32_bf16 v[100:103], v[188:191], v[156:159], v[100:103]
    v_mfma_f32_16x16x32_bf16 v[96:99], v[188:191], v[152:155], v[96:99]
    s_waitcnt lgkmcnt(0)
    v_mfma_f32_16x16x32_bf16 v[16:19], v[128:131], v[112:115], v[16:19]
    ds_read_b128 v[152:155], v197 offset:0
    v_mfma_f32_16x16x32_bf16 v[20:23], v[128:131], v[116:119], v[20:23]
    ds_read_b64_tr_b16 v[168:169], v198 offset:20480
    v_mfma_f32_16x16x32_bf16 v[24:27], v[128:131], v[120:123], v[24:27]
    ds_read_b64_tr_b16 v[170:171], v198 offset:20992
    v_mfma_f32_16x16x32_bf16 v[28:31], v[128:131], v[124:127], v[28:31]
    ds_read_b128 v[156:159], v197 offset:2048
    v_mfma_f32_16x16x32_bf16 v[44:47], v[132:135], v[124:127], v[44:47]
    ds_read_b128 v[160:163], v197 offset:10240
    v_mfma_f32_16x16x32_bf16 v[40:43], v[132:135], v[120:123], v[40:43]
    ds_read_b128 v[164:167], v197 offset:12288
    v_mfma_f32_16x16x32_bf16 v[36:39], v[132:135], v[116:119], v[36:39]
    ds_read_b64_tr_b16 v[172:173], v199 offset:20480
    v_mfma_f32_16x16x32_bf16 v[32:35], v[132:135], v[112:115], v[32:35]
    ds_read_b64_tr_b16 v[174:175], v199 offset:20992
    v_mfma_f32_16x16x32_bf16 v[48:51], v[136:139], v[112:115], v[48:51]
    ds_read_b64_tr_b16 v[176:177], v198 offset:22528
    v_mfma_f32_16x16x32_bf16 v[52:55], v[136:139], v[116:119], v[52:55]
    ds_read_b64_tr_b16 v[178:179], v198 offset:23040
    v_mfma_f32_16x16x32_bf16 v[56:59], v[136:139], v[120:123], v[56:59]
    ds_read_b64_tr_b16 v[180:181], v199 offset:22528
    v_mfma_f32_16x16x32_bf16 v[60:63], v[136:139], v[124:127], v[60:63]
    ds_read_b64_tr_b16 v[182:183], v199 offset:23040
    v_mfma_f32_16x16x32_bf16 v[76:79], v[140:143], v[124:127], v[76:79]
    ds_read_b64_tr_b16 v[184:185], v198 offset:24576
    v_mfma_f32_16x16x32_bf16 v[72:75], v[140:143], v[120:123], v[72:75]
    ds_read_b64_tr_b16 v[186:187], v198 offset:25088
    v_mfma_f32_16x16x32_bf16 v[68:71], v[140:143], v[116:119], v[68:71]
    ds_read_b64_tr_b16 v[188:189], v199 offset:24576
    v_mfma_f32_16x16x32_bf16 v[64:67], v[140:143], v[112:115], v[64:67]
    ds_read_b64_tr_b16 v[190:191], v199 offset:25088
    v_mfma_f32_16x16x32_bf16 v[80:83], v[144:147], v[112:115], v[80:83]
    v_mfma_f32_16x16x32_bf16 v[84:87], v[144:147], v[116:119], v[84:87]
    v_mfma_f32_16x16x32_bf16 v[88:91], v[144:147], v[120:123], v[88:91]
    v_mfma_f32_16x16x32_bf16 v[92:95], v[144:147], v[124:127], v[92:95]
    v_mfma_f32_16x16x32_bf16 v[108:111], v[148:151], v[124:127], v[108:111]
    v_mfma_f32_16x16x32_bf16 v[104:107], v[148:151], v[120:123], v[104:107]
    v_mfma_f32_16x16x32_bf16 v[100:103], v[148:151], v[116:119], v[100:103]
    v_mfma_f32_16x16x32_bf16 v[96:99], v[148:151], v[112:115], v[96:99]
    s_waitcnt lgkmcnt(0)
    v_mfma_f32_16x16x32_bf16 v[16:19], v[168:171], v[152:155], v[16:19]
    s_barrier
    v_mfma_f32_16x16x32_bf16 v[20:23], v[168:171], v[156:159], v[20:23]
    ds_read_b128 v[112:115], v200 offset:0
    v_mfma_f32_16x16x32_bf16 v[24:27], v[168:171], v[160:163], v[24:27]
    ds_read_b64_tr_b16 v[128:129], v202 offset:0
    v_mfma_f32_16x16x32_bf16 v[28:31], v[168:171], v[164:167], v[28:31]
    ds_read_b64_tr_b16 v[130:131], v202 offset:512
    v_mfma_f32_16x16x32_bf16 v[44:47], v[172:175], v[164:167], v[44:47]
    ds_read_b128 v[116:119], v200 offset:2048
    v_mfma_f32_16x16x32_bf16 v[40:43], v[172:175], v[160:163], v[40:43]
    ds_read_b128 v[120:123], v200 offset:10240
    v_mfma_f32_16x16x32_bf16 v[36:39], v[172:175], v[156:159], v[36:39]
    ds_read_b128 v[124:127], v200 offset:12288
    v_mfma_f32_16x16x32_bf16 v[32:35], v[172:175], v[152:155], v[32:35]
    ds_read_b64_tr_b16 v[132:133], v203 offset:0
    v_mfma_f32_16x16x32_bf16 v[48:51], v[176:179], v[152:155], v[48:51]
    ds_read_b64_tr_b16 v[134:135], v203 offset:512
    v_mfma_f32_16x16x32_bf16 v[52:55], v[176:179], v[156:159], v[52:55]
    ds_read_b64_tr_b16 v[136:137], v202 offset:2048
    v_mfma_f32_16x16x32_bf16 v[56:59], v[176:179], v[160:163], v[56:59]
    ds_read_b64_tr_b16 v[138:139], v202 offset:2560
    v_mfma_f32_16x16x32_bf16 v[60:63], v[176:179], v[164:167], v[60:63]
    ds_read_b64_tr_b16 v[140:141], v203 offset:2048
    v_mfma_f32_16x16x32_bf16 v[76:79], v[180:183], v[164:167], v[76:79]
    ds_read_b64_tr_b16 v[142:143], v203 offset:2560
    v_mfma_f32_16x16x32_bf16 v[72:75], v[180:183], v[160:163], v[72:75]
    ds_read_b64_tr_b16 v[144:145], v202 offset:4096
    v_mfma_f32_16x16x32_bf16 v[68:71], v[180:183], v[156:159], v[68:71]
    ds_read_b64_tr_b16 v[146:147], v202 offset:4608
    v_mfma_f32_16x16x32_bf16 v[64:67], v[180:183], v[152:155], v[64:67]
    ds_read_b64_tr_b16 v[148:149], v203 offset:4096
    v_mfma_f32_16x16x32_bf16 v[80:83], v[184:187], v[152:155], v[80:83]
    ds_read_b64_tr_b16 v[150:151], v203 offset:4608
    v_mfma_f32_16x16x32_bf16 v[84:87], v[184:187], v[156:159], v[84:87]
    v_mfma_f32_16x16x32_bf16 v[88:91], v[184:187], v[160:163], v[88:91]
    v_mfma_f32_16x16x32_bf16 v[92:95], v[184:187], v[164:167], v[92:95]
    v_mfma_f32_16x16x32_bf16 v[108:111], v[188:191], v[164:167], v[108:111]
    v_mfma_f32_16x16x32_bf16 v[104:107], v[188:191], v[160:163], v[104:107]
    v_mfma_f32_16x16x32_bf16 v[100:103], v[188:191], v[156:159], v[100:103]
    v_mfma_f32_16x16x32_bf16 v[96:99], v[188:191], v[152:155], v[96:99]
    s_waitcnt lgkmcnt(0)
    v_mfma_f32_16x16x32_bf16 v[16:19], v[128:131], v[112:115], v[16:19]
    ds_read_b128 v[152:155], v201 offset:0
    v_mfma_f32_16x16x32_bf16 v[20:23], v[128:131], v[116:119], v[20:23]
    ds_read_b64_tr_b16 v[168:169], v202 offset:20480
    v_mfma_f32_16x16x32_bf16 v[24:27], v[128:131], v[120:123], v[24:27]
    ds_read_b64_tr_b16 v[170:171], v202 offset:20992
    v_mfma_f32_16x16x32_bf16 v[28:31], v[128:131], v[124:127], v[28:31]
    ds_read_b128 v[156:159], v201 offset:2048
    v_mfma_f32_16x16x32_bf16 v[44:47], v[132:135], v[124:127], v[44:47]
    ds_read_b128 v[160:163], v201 offset:10240
    v_mfma_f32_16x16x32_bf16 v[40:43], v[132:135], v[120:123], v[40:43]
    ds_read_b128 v[164:167], v201 offset:12288
    v_mfma_f32_16x16x32_bf16 v[36:39], v[132:135], v[116:119], v[36:39]
    ds_read_b64_tr_b16 v[172:173], v203 offset:20480
    v_mfma_f32_16x16x32_bf16 v[32:35], v[132:135], v[112:115], v[32:35]
    ds_read_b64_tr_b16 v[174:175], v203 offset:20992
    v_mfma_f32_16x16x32_bf16 v[48:51], v[136:139], v[112:115], v[48:51]
    ds_read_b64_tr_b16 v[176:177], v202 offset:22528
    v_mfma_f32_16x16x32_bf16 v[52:55], v[136:139], v[116:119], v[52:55]
    ds_read_b64_tr_b16 v[178:179], v202 offset:23040
    v_mfma_f32_16x16x32_bf16 v[56:59], v[136:139], v[120:123], v[56:59]
    ds_read_b64_tr_b16 v[180:181], v203 offset:22528
    v_mfma_f32_16x16x32_bf16 v[60:63], v[136:139], v[124:127], v[60:63]
    ds_read_b64_tr_b16 v[182:183], v203 offset:23040
    v_mfma_f32_16x16x32_bf16 v[76:79], v[140:143], v[124:127], v[76:79]
    ds_read_b64_tr_b16 v[184:185], v202 offset:24576
    v_mfma_f32_16x16x32_bf16 v[72:75], v[140:143], v[120:123], v[72:75]
    ds_read_b64_tr_b16 v[186:187], v202 offset:25088
    v_mfma_f32_16x16x32_bf16 v[68:71], v[140:143], v[116:119], v[68:71]
    ds_read_b64_tr_b16 v[188:189], v203 offset:24576
    v_mfma_f32_16x16x32_bf16 v[64:67], v[140:143], v[112:115], v[64:67]
    ds_read_b64_tr_b16 v[190:191], v203 offset:25088
    v_mfma_f32_16x16x32_bf16 v[80:83], v[144:147], v[112:115], v[80:83]
    v_mfma_f32_16x16x32_bf16 v[84:87], v[144:147], v[116:119], v[84:87]
    v_mfma_f32_16x16x32_bf16 v[88:91], v[144:147], v[120:123], v[88:91]
    v_mfma_f32_16x16x32_bf16 v[92:95], v[144:147], v[124:127], v[92:95]
    v_mfma_f32_16x16x32_bf16 v[108:111], v[148:151], v[124:127], v[108:111]
    v_mfma_f32_16x16x32_bf16 v[104:107], v[148:151], v[120:123], v[104:107]
    v_mfma_f32_16x16x32_bf16 v[100:103], v[148:151], v[116:119], v[100:103]
    v_mfma_f32_16x16x32_bf16 v[96:99], v[148:151], v[112:115], v[96:99]
    s_waitcnt lgkmcnt(0)
    v_mfma_f32_16x16x32_bf16 v[16:19], v[168:171], v[152:155], v[16:19]
    s_barrier
    v_mfma_f32_16x16x32_bf16 v[20:23], v[168:171], v[156:159], v[20:23]
    ds_read_b128 v[112:115], v192 offset:0
    v_mfma_f32_16x16x32_bf16 v[24:27], v[168:171], v[160:163], v[24:27]
    ds_read_b64_tr_b16 v[128:129], v194 offset:0
    v_mfma_f32_16x16x32_bf16 v[28:31], v[168:171], v[164:167], v[28:31]
    ds_read_b64_tr_b16 v[130:131], v194 offset:512
    v_mfma_f32_16x16x32_bf16 v[44:47], v[172:175], v[164:167], v[44:47]
    ds_read_b128 v[116:119], v192 offset:2048
    v_mfma_f32_16x16x32_bf16 v[40:43], v[172:175], v[160:163], v[40:43]
    ds_read_b128 v[120:123], v192 offset:10240
    v_mfma_f32_16x16x32_bf16 v[36:39], v[172:175], v[156:159], v[36:39]
    ds_read_b128 v[124:127], v192 offset:12288
    v_mfma_f32_16x16x32_bf16 v[32:35], v[172:175], v[152:155], v[32:35]
    ds_read_b64_tr_b16 v[132:133], v195 offset:0
    v_mfma_f32_16x16x32_bf16 v[48:51], v[176:179], v[152:155], v[48:51]
    ds_read_b64_tr_b16 v[134:135], v195 offset:512
    v_mfma_f32_16x16x32_bf16 v[52:55], v[176:179], v[156:159], v[52:55]
    ds_read_b64_tr_b16 v[136:137], v194 offset:2048
    v_mfma_f32_16x16x32_bf16 v[56:59], v[176:179], v[160:163], v[56:59]
    ds_read_b64_tr_b16 v[138:139], v194 offset:2560
    v_mfma_f32_16x16x32_bf16 v[60:63], v[176:179], v[164:167], v[60:63]
    ds_read_b64_tr_b16 v[140:141], v195 offset:2048
    v_mfma_f32_16x16x32_bf16 v[76:79], v[180:183], v[164:167], v[76:79]
    ds_read_b64_tr_b16 v[142:143], v195 offset:2560
    v_mfma_f32_16x16x32_bf16 v[72:75], v[180:183], v[160:163], v[72:75]
    ds_read_b64_tr_b16 v[144:145], v194 offset:4096
    v_mfma_f32_16x16x32_bf16 v[68:71], v[180:183], v[156:159], v[68:71]
    ds_read_b64_tr_b16 v[146:147], v194 offset:4608
    v_mfma_f32_16x16x32_bf16 v[64:67], v[180:183], v[152:155], v[64:67]
    ds_read_b64_tr_b16 v[148:149], v195 offset:4096
    v_mfma_f32_16x16x32_bf16 v[80:83], v[184:187], v[152:155], v[80:83]
    ds_read_b64_tr_b16 v[150:151], v195 offset:4608
    v_mfma_f32_16x16x32_bf16 v[84:87], v[184:187], v[156:159], v[84:87]
    v_mfma_f32_16x16x32_bf16 v[88:91], v[184:187], v[160:163], v[88:91]
    v_mfma_f32_16x16x32_bf16 v[92:95], v[184:187], v[164:167], v[92:95]
    v_mfma_f32_16x16x32_bf16 v[108:111], v[188:191], v[164:167], v[108:111]
    v_mfma_f32_16x16x32_bf16 v[104:107], v[188:191], v[160:163], v[104:107]
    v_mfma_f32_16x16x32_bf16 v[100:103], v[188:191], v[156:159], v[100:103]
    v_mfma_f32_16x16x32_bf16 v[96:99], v[188:191], v[152:155], v[96:99]
    s_waitcnt lgkmcnt(0)
    v_mfma_f32_16x16x32_bf16 v[16:19], v[128:131], v[112:115], v[16:19]
    ds_read_b128 v[152:155], v193 offset:0
    v_mfma_f32_16x16x32_bf16 v[20:23], v[128:131], v[116:119], v[20:23]
    ds_read_b64_tr_b16 v[168:169], v194 offset:20480
    v_mfma_f32_16x16x32_bf16 v[24:27], v[128:131], v[120:123], v[24:27]
    ds_read_b64_tr_b16 v[170:171], v194 offset:20992
    v_mfma_f32_16x16x32_bf16 v[28:31], v[128:131], v[124:127], v[28:31]
    ds_read_b128 v[156:159], v193 offset:2048
    v_mfma_f32_16x16x32_bf16 v[44:47], v[132:135], v[124:127], v[44:47]
    ds_read_b128 v[160:163], v193 offset:10240
    v_mfma_f32_16x16x32_bf16 v[40:43], v[132:135], v[120:123], v[40:43]
    ds_read_b128 v[164:167], v193 offset:12288
    v_mfma_f32_16x16x32_bf16 v[36:39], v[132:135], v[116:119], v[36:39]
    ds_read_b64_tr_b16 v[172:173], v195 offset:20480
    v_mfma_f32_16x16x32_bf16 v[32:35], v[132:135], v[112:115], v[32:35]
    ds_read_b64_tr_b16 v[174:175], v195 offset:20992
    v_mfma_f32_16x16x32_bf16 v[48:51], v[136:139], v[112:115], v[48:51]
    ds_read_b64_tr_b16 v[176:177], v194 offset:22528
    v_mfma_f32_16x16x32_bf16 v[52:55], v[136:139], v[116:119], v[52:55]
    ds_read_b64_tr_b16 v[178:179], v194 offset:23040
    v_mfma_f32_16x16x32_bf16 v[56:59], v[136:139], v[120:123], v[56:59]
    ds_read_b64_tr_b16 v[180:181], v195 offset:22528
    v_mfma_f32_16x16x32_bf16 v[60:63], v[136:139], v[124:127], v[60:63]
    ds_read_b64_tr_b16 v[182:183], v195 offset:23040
    v_mfma_f32_16x16x32_bf16 v[76:79], v[140:143], v[124:127], v[76:79]
    ds_read_b64_tr_b16 v[184:185], v194 offset:24576
    v_mfma_f32_16x16x32_bf16 v[72:75], v[140:143], v[120:123], v[72:75]
    ds_read_b64_tr_b16 v[186:187], v194 offset:25088
    v_mfma_f32_16x16x32_bf16 v[68:71], v[140:143], v[116:119], v[68:71]
    ds_read_b64_tr_b16 v[188:189], v195 offset:24576
    v_mfma_f32_16x16x32_bf16 v[64:67], v[140:143], v[112:115], v[64:67]
    ds_read_b64_tr_b16 v[190:191], v195 offset:25088
    v_mfma_f32_16x16x32_bf16 v[80:83], v[144:147], v[112:115], v[80:83]
    v_mfma_f32_16x16x32_bf16 v[84:87], v[144:147], v[116:119], v[84:87]
    v_mfma_f32_16x16x32_bf16 v[88:91], v[144:147], v[120:123], v[88:91]
    v_mfma_f32_16x16x32_bf16 v[92:95], v[144:147], v[124:127], v[92:95]
    v_mfma_f32_16x16x32_bf16 v[108:111], v[148:151], v[124:127], v[108:111]
    s_add_u32 s68, s68, 1
    s_cmp_lt_u32 s68, 5
    v_mfma_f32_16x16x32_bf16 v[104:107], v[148:151], v[120:123], v[104:107]
    v_mfma_f32_16x16x32_bf16 v[100:103], v[148:151], v[116:119], v[100:103]
    v_mfma_f32_16x16x32_bf16 v[96:99], v[148:151], v[112:115], v[96:99]
    s_waitcnt lgkmcnt(0)
    v_mfma_f32_16x16x32_bf16 v[16:19], v[168:171], v[152:155], v[16:19]
    s_cbranch_scc0 L_cexit
    s_barrier
    v_mfma_f32_16x16x32_bf16 v[20:23], v[168:171], v[156:159], v[20:23]
    ds_read_b128 v[112:115], v196 offset:0
    v_mfma_f32_16x16x32_bf16 v[24:27], v[168:171], v[160:163], v[24:27]
    ds_read_b64_tr_b16 v[128:129], v198 offset:0
    s_branch L_cloop
L_cexit:
    v_mfma_f32_16x16x32_bf16 v[20:23], v[168:171], v[156:159], v[20:23]
    v_mfma_f32_16x16x32_bf16 v[24:27], v[168:171], v[160:163], v[24:27]
    v_mfma_f32_16x16x32_bf16 v[28:31], v[168:171], v[164:167], v[28:31]
    v_mfma_f32_16x16x32_bf16 v[44:47], v[172:175], v[164:167], v[44:47]
    v_mfma_f32_16x16x32_bf16 v[40:43], v[172:175], v[160:163], v[40:43]
    v_mfma_f32_16x16x32_bf16 v[36:39], v[172:175], v[156:159], v[36:39]
    v_mfma_f32_16x16x32_bf16 v[32:35], v[172:175], v[152:155], v[32:35]
    v_mfma_f32_16x16x32_bf16 v[48:51], v[176:179], v[152:155], v[48:51]
    v_mfma_f32_16x16x32_bf16 v[52:55], v[176:179], v[156:159], v[52:55]
    v_mfma_f32_16x16x32_bf16 v[56:59], v[176:179], v[160:163], v[56:59]
    s_barrier
    ds_read_b32 v11, v10 offset:53248
    ds_read_b64 v[222:223], v213 offset:49152
    ds_read_b64 v[224:225], v213 offset:49280
    v_mfma_f32_16x16x32_bf16 v[60:63], v[176:179], v[164:167], v[60:63]
    ds_read_b64 v[226:227], v213 offset:49408
    ds_read_b64 v[228:229], v213 offset:49536
    v_mfma_f32_16x16x32_bf16 v[76:79], v[180:183], v[164:167], v[76:79]
    ds_read_b64 v[238:239], v215 offset:50176
    ds_read_b64 v[240:241], v215 offset:50304
    v_mfma_f32_16x16x32_bf16 v[72:75], v[180:183], v[160:163], v[72:75]
    ds_read_b64 v[242:243], v215 offset:50688
    ds_read_b64 v[244:245], v215 offset:50816
    v_mfma_f32_16x16x32_bf16 v[68:71], v[180:183], v[156:159], v[68:71]
    ds_read_b64 v[246:247], v215 offset:51200
    ds_read_b64 v[248:249], v215 offset:51328
    v_mfma_f32_16x16x32_bf16 v[64:67], v[180:183], v[152:155], v[64:67]
    ds_read_b32 v250, v214 offset:49156
    ds_read_b32 v252, v214 offset:49412
    v_mfma_f32_16x16x32_bf16 v[80:83], v[184:187], v[152:155], v[80:83]
    s_waitcnt lgkmcnt(8)
    v_readfirstlane_b32 s100, v11
    v_mov_b32_e64 v230, v223
    v_cndmask_b32 v222, 0, v222, s[86:87]
    v_mfma_f32_16x16x32_bf16 v[84:87], v[184:187], v[156:159], v[84:87]
    v_mov_b32_e64 v232, v225
    v_cndmask_b32 v224, 0, v224, s[86:87]
    v_mov_b32_e64 v234, v227
    v_cndmask_b32 v226, 0, v226, s[86:87]
    v_mfma_f32_16x16x32_bf16 v[88:91], v[184:187], v[160:163], v[88:91]
    v_mov_b32_e64 v236, v229
    v_cndmask_b32 v228, 0, v228, s[86:87]
    v_mov_b32 v223, v222
    v_mov_b32 v225, v224
    v_mfma_f32_16x16x32_bf16 v[92:95], v[184:187], v[164:167], v[92:95]
    v_mov_b32 v227, v226
    v_mov_b32_e64 v229, v228
    s_waitcnt lgkmcnt(0)
    v_mul_f32 v251, 0x3fb8aa3b, v250
    v_mfma_f32_16x16x32_bf16 v[108:111], v[188:191], v[164:167], v[108:111]
    v_mul_f32 v253, 0x3fb8aa3b, v252
    v_mfma_f32_16x16x32_bf16 v[104:107], v[188:191], v[160:163], v[104:107]
    v_mfma_f32_16x16x32_bf16 v[100:103], v[188:191], v[156:159], v[100:103]
    v_mfma_f32_16x16x32_bf16 v[96:99], v[188:191], v[152:155], v[96:99]
    v_mfma_f32_16x16x16_bf16 v[48:51], v[242:243], v[222:223], v[48:51]
    v_xor_b32 v168, 0, v217
    v_xor_b32 v169, 16, v217
    v_mfma_f32_16x16x16_bf16 v[52:55], v[242:243], v[224:225], v[52:55]
    v_xor_b32 v170, 32, v217
    v_xor_b32 v171, 48, v217
    v_mfma_f32_16x16x16_bf16 v[64:67], v[244:245], v[222:223], v[64:67]
    v_xor_b32_e64 v172, 64, v217
    v_xor_b32 v173, 80, v217
    v_mfma_f32_16x16x16_bf16 v[68:71], v[244:245], v[224:225], v[68:71]
    v_xor_b32 v174, 96, v217
    v_xor_b32 v175, 112, v217
    v_mfma_f32_16x16x16_bf16 v[56:59], v[242:243], v[226:227], v[56:59]
    v_xor_b32_e64 v4, 32, v216
    v_mfma_f32_16x16x16_bf16 v[60:63], v[242:243], v[228:229], v[60:63]
    v_mfma_f32_16x16x16_bf16 v[72:75], v[244:245], v[226:227], v[72:75]
    v_mfma_f32_16x16x16_bf16 v[76:79], v[244:245], v[228:229], v[76:79]
    v_mfma_f32_16x16x16_bf16 v[80:83], v[246:247], v[222:223], v[80:83]
    v_cvt_pk_bf16_f32 v112, v48, v49
    v_cvt_pk_bf16_f32 v113, v50, v51
    v_mfma_f32_16x16x16_bf16 v[84:87], v[246:247], v[224:225], v[84:87]
    v_cvt_pk_bf16_f32 v114, v52, v53
    v_cvt_pk_bf16_f32 v115, v54, v55
    v_mfma_f32_16x16x16_bf16 v[88:91], v[246:247], v[226:227], v[88:91]
    v_cvt_pk_bf16_f32 v116, v64, v65
    v_cvt_pk_bf16_f32 v117, v66, v67
    v_mfma_f32_16x16x16_bf16 v[92:95], v[246:247], v[228:229], v[92:95]
    v_cvt_pk_bf16_f32 v118, v68, v69
    v_cvt_pk_bf16_f32 v119, v70, v71
    v_mfma_f32_16x16x16_bf16 v[96:99], v[248:249], v[222:223], v[96:99]
    v_cvt_pk_bf16_f32 v120, v56, v57
    v_cvt_pk_bf16_f32 v121, v58, v59
    v_mfma_f32_16x16x16_bf16 v[100:103], v[248:249], v[224:225], v[100:103]
    v_cvt_pk_bf16_f32 v122, v60, v61
    v_cvt_pk_bf16_f32 v123, v62, v63
    v_mfma_f32_16x16x16_bf16 v[104:107], v[248:249], v[226:227], v[104:107]
    v_permlane16_swap_b32 v112, v114
    v_permlane16_swap_b32 v113, v115
    v_mfma_f32_16x16x16_bf16 v[108:111], v[248:249], v[228:229], v[108:111]
    v_permlane16_swap_b32 v116, v118
    v_permlane16_swap_b32 v117, v119
    v_cvt_pk_bf16_f32 v124, v72, v73
    v_cvt_pk_bf16_f32 v125, v74, v75
    v_cvt_pk_bf16_f32 v126, v76, v77
    v_cvt_pk_bf16_f32 v127, v78, v79
    v_permlane16_swap_b32 v120, v122
    v_permlane16_swap_b32 v121, v123
    v_permlane16_swap_b32 v124, v126
    v_permlane16_swap_b32 v125, v127
    v_mfma_f32_32x32x16_bf16 v[48:63], v[204:207], v[112:115], 0
    v_mul_f32 v80, v80, v230
    v_mul_f32 v81, v81, v230
    v_mul_f32 v82, v82, v230
    v_mul_f32 v83, v83, v230
    v_cvt_pk_bf16_f32 v80, v80, v81
    v_cvt_pk_bf16_f32 v81, v82, v83
    v_mfma_f32_32x32x16_bf16 v[64:79], v[204:207], v[120:123], 0
    v_mul_f32 v96, v96, v230
    v_mul_f32 v97, v97, v230
    v_mul_f32 v98, v98, v230
    v_mul_f32 v99, v99, v230
    v_cvt_pk_bf16_f32 v96, v96, v97
    v_cvt_pk_bf16_f32 v97, v98, v99
    v_mfma_f32_32x32x16_bf16 v[48:63], v[208:211], v[116:119], v[48:63]
    v_mul_f32 v84, v84, v232
    v_mul_f32 v85, v85, v232
    v_mul_f32 v86, v86, v232
    v_mul_f32 v87, v87, v232
    v_cvt_pk_bf16_f32 v84, v84, v85
    v_cvt_pk_bf16_f32 v85, v86, v87
    v_mfma_f32_32x32x16_bf16 v[64:79], v[208:211], v[124:127], v[64:79]
    v_mul_f32 v100, v100, v232
    v_mul_f32 v101, v101, v232
    v_mul_f32 v102, v102, v232
    v_mul_f32 v103, v103, v232
    v_cvt_pk_bf16_f32 v100, v100, v101
    v_cvt_pk_bf16_f32 v101, v102, v103
    v_mul_f32 v88, v88, v234
    v_mul_f32 v89, v89, v234
    v_mul_f32 v90, v90, v234
    v_mul_f32 v91, v91, v234
    v_cvt_pk_bf16_f32 v88, v88, v89
    v_cvt_pk_bf16_f32 v89, v90, v91
    v_mul_f32 v104, v104, v234
    v_mul_f32 v105, v105, v234
    v_mul_f32 v106, v106, v234
    v_mul_f32 v107, v107, v234
    v_cvt_pk_bf16_f32 v104, v104, v105
    v_cvt_pk_bf16_f32 v105, v106, v107
    v_mul_f32 v92, v92, v236
    v_mul_f32 v93, v93, v236
    v_mul_f32 v94, v94, v236
    v_mul_f32 v95, v95, v236
    v_cvt_pk_bf16_f32 v92, v92, v93
    v_cvt_pk_bf16_f32 v93, v94, v95
    v_mul_f32 v108, v108, v236
    v_mul_f32 v109, v109, v236
    v_mul_f32 v110, v110, v236
    v_mul_f32 v111, v111, v236
    v_cvt_pk_bf16_f32 v108, v108, v109
    v_cvt_pk_bf16_f32 v109, v110, v111
    v_max3_f32 v160, v48, v49, v50
    v_min3_f32 v162, v48, v49, v50
    v_max3_f32 v160, v160, v51, v52
    v_min3_f32 v162, v162, v51, v52
    v_max3_f32 v160, v160, v53, v54
    v_min3_f32 v162, v162, v53, v54
    v_max3_f32 v160, v160, v55, v56
    v_min3_f32 v162, v162, v55, v56
    v_max3_f32 v160, v160, v57, v58
    v_min3_f32 v162, v162, v57, v58
    v_max3_f32 v160, v160, v59, v60
    v_min3_f32 v162, v162, v59, v60
    v_max3_f32 v160, v160, v61, v62
    v_min3_f32 v162, v162, v61, v62
    v_max_f32 v160, v160, v63
    v_min_f32 v162, v162, v63
    v_max3_f32 v164, v64, v65, v66
    v_min3_f32 v166, v64, v65, v66
    v_max3_f32 v164, v164, v67, v68
    v_min3_f32 v166, v166, v67, v68
    v_max3_f32 v164, v164, v69, v70
    v_min3_f32 v166, v166, v69, v70
    v_max3_f32 v164, v164, v71, v72
    v_min3_f32 v166, v166, v71, v72
    v_max3_f32 v164, v164, v73, v74
    v_min3_f32 v166, v166, v73, v74
    v_max3_f32 v164, v164, v75, v76
    v_min3_f32 v166, v166, v75, v76
    v_max3_f32 v164, v164, v77, v78
    v_min3_f32 v166, v166, v77, v78
    v_max_f32 v164, v164, v79
    v_min_f32 v166, v166, v79
    v_mov_b32 v161, v160
    v_mov_b32 v163, v162
    v_mov_b32 v165, v164
    v_mov_b32 v167, v166
    v_permlane32_swap_b32 v160, v161
    v_permlane32_swap_b32 v162, v163
    v_permlane32_swap_b32 v164, v165
    v_permlane32_swap_b32 v166, v167
    v_max_f32 v160, v160, v161
    v_min_f32 v162, v162, v163
    v_max_f32 v164, v164, v165
    v_min_f32 v166, v166, v167
    v_mul_f32 v160, v160, v251
    v_mul_f32 v162, v162, v251
    v_mul_f32 v164, v164, v253
    v_mul_f32 v166, v166, v253
    v_pk_fma_f32 v[128:129], v[48:49], v[250:251], v[160:161] op_sel:[0,1,0] op_sel_hi:[1,1,0] neg_lo:[0,0,1] neg_hi:[0,0,1]
    v_pk_fma_f32 v[48:49], v[48:49], v[250:251], v[162:163] op_sel:[0,1,0] op_sel_hi:[1,1,0] neg_lo:[0,1,0] neg_hi:[0,1,0]
    v_pk_fma_f32 v[130:131], v[50:51], v[250:251], v[160:161] op_sel:[0,1,0] op_sel_hi:[1,1,0] neg_lo:[0,0,1] neg_hi:[0,0,1]
    v_pk_fma_f32 v[50:51], v[50:51], v[250:251], v[162:163] op_sel:[0,1,0] op_sel_hi:[1,1,0] neg_lo:[0,1,0] neg_hi:[0,1,0]
    v_pk_fma_f32 v[132:133], v[52:53], v[250:251], v[160:161] op_sel:[0,1,0] op_sel_hi:[1,1,0] neg_lo:[0,0,1] neg_hi:[0,0,1]
    v_pk_fma_f32 v[52:53], v[52:53], v[250:251], v[162:163] op_sel:[0,1,0] op_sel_hi:[1,1,0] neg_lo:[0,1,0] neg_hi:[0,1,0]
    v_pk_fma_f32 v[134:135], v[54:55], v[250:251], v[160:161] op_sel:[0,1,0] op_sel_hi:[1,1,0] neg_lo:[0,0,1] neg_hi:[0,0,1]
    v_pk_fma_f32 v[54:55], v[54:55], v[250:251], v[162:163] op_sel:[0,1,0] op_sel_hi:[1,1,0] neg_lo:[0,1,0] neg_hi:[0,1,0]
    v_pk_fma_f32 v[136:137], v[56:57], v[250:251], v[160:161] op_sel:[0,1,0] op_sel_hi:[1,1,0] neg_lo:[0,0,1] neg_hi:[0,0,1]
    v_pk_fma_f32 v[56:57], v[56:57], v[250:251], v[162:163] op_sel:[0,1,0] op_sel_hi:[1,1,0] neg_lo:[0,1,0] neg_hi:[0,1,0]
    v_pk_fma_f32 v[138:139], v[58:59], v[250:251], v[160:161] op_sel:[0,1,0] op_sel_hi:[1,1,0] neg_lo:[0,0,1] neg_hi:[0,0,1]
    v_pk_fma_f32 v[58:59], v[58:59], v[250:251], v[162:163] op_sel:[0,1,0] op_sel_hi:[1,1,0] neg_lo:[0,1,0] neg_hi:[0,1,0]
    v_pk_fma_f32 v[140:141], v[60:61], v[250:251], v[160:161] op_sel:[0,1,0] op_sel_hi:[1,1,0] neg_lo:[0,0,1] neg_hi:[0,0,1]
    v_pk_fma_f32 v[60:61], v[60:61], v[250:251], v[162:163] op_sel:[0,1,0] op_sel_hi:[1,1,0] neg_lo:[0,1,0] neg_hi:[0,1,0]
    v_pk_fma_f32 v[142:143], v[62:63], v[250:251], v[160:161] op_sel:[0,1,0] op_sel_hi:[1,1,0] neg_lo:[0,0,1] neg_hi:[0,0,1]
    v_pk_fma_f32 v[62:63], v[62:63], v[250:251], v[162:163] op_sel:[0,1,0] op_sel_hi:[1,1,0] neg_lo:[0,1,0] neg_hi:[0,1,0]
    v_pk_fma_f32 v[144:145], v[64:65], v[252:253], v[164:165] op_sel:[0,1,0] op_sel_hi:[1,1,0] neg_lo:[0,0,1] neg_hi:[0,0,1]
    v_pk_fma_f32 v[64:65], v[64:65], v[252:253], v[166:167] op_sel:[0,1,0] op_sel_hi:[1,1,0] neg_lo:[0,1,0] neg_hi:[0,1,0]
    v_pk_fma_f32 v[146:147], v[66:67], v[252:253], v[164:165] op_sel:[0,1,0] op_sel_hi:[1,1,0] neg_lo:[0,0,1] neg_hi:[0,0,1]
    v_pk_fma_f32 v[66:67], v[66:67], v[252:253], v[166:167] op_sel:[0,1,0] op_sel_hi:[1,1,0] neg_lo:[0,1,0] neg_hi:[0,1,0]
    v_pk_fma_f32 v[148:149], v[68:69], v[252:253], v[164:165] op_sel:[0,1,0] op_sel_hi:[1,1,0] neg_lo:[0,0,1] neg_hi:[0,0,1]
    v_pk_fma_f32 v[68:69], v[68:69], v[252:253], v[166:167] op_sel:[0,1,0] op_sel_hi:[1,1,0] neg_lo:[0,1,0] neg_hi:[0,1,0]
    v_pk_fma_f32 v[150:151], v[70:71], v[252:253], v[164:165] op_sel:[0,1,0] op_sel_hi:[1,1,0] neg_lo:[0,0,1] neg_hi:[0,0,1]
    v_pk_fma_f32 v[70:71], v[70:71], v[252:253], v[166:167] op_sel:[0,1,0] op_sel_hi:[1,1,0] neg_lo:[0,1,0] neg_hi:[0,1,0]
    v_pk_fma_f32 v[152:153], v[72:73], v[252:253], v[164:165] op_sel:[0,1,0] op_sel_hi:[1,1,0] neg_lo:[0,0,1] neg_hi:[0,0,1]
    v_pk_fma_f32 v[72:73], v[72:73], v[252:253], v[166:167] op_sel:[0,1,0] op_sel_hi:[1,1,0] neg_lo:[0,1,0] neg_hi:[0,1,0]
    v_pk_fma_f32 v[154:155], v[74:75], v[252:253], v[164:165] op_sel:[0,1,0] op_sel_hi:[1,1,0] neg_lo:[0,0,1] neg_hi:[0,0,1]
    v_pk_fma_f32 v[74:75], v[74:75], v[252:253], v[166:167] op_sel:[0,1,0] op_sel_hi:[1,1,0] neg_lo:[0,1,0] neg_hi:[0,1,0]
    v_pk_fma_f32 v[156:157], v[76:77], v[252:253], v[164:165] op_sel:[0,1,0] op_sel_hi:[1,1,0] neg_lo:[0,0,1] neg_hi:[0,0,1]
    v_pk_fma_f32 v[76:77], v[76:77], v[252:253], v[166:167] op_sel:[0,1,0] op_sel_hi:[1,1,0] neg_lo:[0,1,0] neg_hi:[0,1,0]
    v_pk_fma_f32 v[158:159], v[78:79], v[252:253], v[164:165] op_sel:[0,1,0] op_sel_hi:[1,1,0] neg_lo:[0,0,1] neg_hi:[0,0,1]
    v_pk_fma_f32 v[78:79], v[78:79], v[252:253], v[166:167] op_sel:[0,1,0] op_sel_hi:[1,1,0] neg_lo:[0,1,0] neg_hi:[0,1,0]
    v_exp_f32_e64 v128, v128
    v_mfma_f32_16x16x16_bf16 v[16:19], v[238:239], v[222:223], v[16:19]
    v_exp_f32 v144, v144
    v_exp_f32 v129, v129
    v_exp_f32_e64 v145, v145
    v_mfma_f32_16x16x16_bf16 v[20:23], v[238:239], v[224:225], v[20:23]
    ds_write2st64_b64 v216, v[80:81], v[84:85] offset0:64 offset1:68
    v_exp_f32 v130, v130
    v_exp_f32 v146, v146
    v_exp_f32_e64 v131, v131
    v_mfma_f32_16x16x16_bf16 v[24:27], v[238:239], v[226:227], v[24:27]
    v_exp_f32 v147, v147
    v_exp_f32 v132, v132
    v_exp_f32_e64 v148, v148
    v_mfma_f32_16x16x16_bf16 v[28:31], v[238:239], v[228:229], v[28:31]
    ds_write2st64_b64 v4, v[96:97], v[100:101] offset0:64 offset1:68
    v_exp_f32 v133, v133
    v_exp_f32 v149, v149
    v_exp_f32_e64 v134, v134
    v_mfma_f32_16x16x16_bf16 v[32:35], v[240:241], v[222:223], v[32:35]
    v_exp_f32 v150, v150
    v_exp_f32 v135, v135
    v_exp_f32_e64 v151, v151
    v_mfma_f32_16x16x16_bf16 v[36:39], v[240:241], v[224:225], v[36:39]
    ds_write2st64_b64 v216, v[88:89], v[92:93] offset0:72 offset1:76
    v_exp_f32 v136, v136
    v_exp_f32 v152, v152
    v_exp_f32_e64 v137, v137
    v_mfma_f32_16x16x16_bf16 v[40:43], v[240:241], v[226:227], v[40:43]
    v_exp_f32 v153, v153
    v_exp_f32 v138, v138
    v_exp_f32_e64 v154, v154
    v_mfma_f32_16x16x16_bf16 v[44:47], v[240:241], v[228:229], v[44:47]
    ds_write2st64_b64 v4, v[104:105], v[108:109] offset0:72 offset1:76
    v_exp_f32 v139, v139
    v_exp_f32 v155, v155
    v_exp_f32 v140, v140
    v_exp_f32 v156, v156
    v_exp_f32 v141, v141
    v_exp_f32 v157, v157
    v_exp_f32 v142, v142
    v_exp_f32 v158, v158
    v_exp_f32 v143, v143
    v_exp_f32 v159, v159
    v_pk_add_f32 v[176:177], v[128:129], v[130:131]
    v_pk_add_f32 v[178:179], v[144:145], v[146:147]
    v_pk_add_f32 v[176:177], v[176:177], v[132:133]
    v_pk_add_f32 v[178:179], v[178:179], v[148:149]
    v_pk_add_f32 v[176:177], v[176:177], v[134:135]
    v_pk_add_f32 v[178:179], v[178:179], v[150:151]
    v_pk_add_f32 v[176:177], v[176:177], v[136:137]
    v_pk_add_f32 v[178:179], v[178:179], v[152:153]
    v_pk_add_f32 v[176:177], v[176:177], v[138:139]
    v_pk_add_f32 v[178:179], v[178:179], v[154:155]
    v_pk_add_f32 v[176:177], v[176:177], v[140:141]
    v_pk_add_f32 v[178:179], v[178:179], v[156:157]
    v_pk_add_f32 v[176:177], v[176:177], v[142:143]
    v_pk_add_f32 v[178:179], v[178:179], v[158:159]
    v_exp_f32 v48, v48
    v_add_f32 v176, v176, v177
    v_add_f32 v178, v178, v179
    v_exp_f32 v64, v64
    v_mov_b32 v177, v176
    v_mov_b32 v179, v178
    v_exp_f32 v49, v49
    v_permlane32_swap_b32 v176, v177
    v_permlane32_swap_b32 v178, v179
    v_exp_f32 v65, v65
    v_add_f32 v176, v176, v177
    v_add_f32 v178, v178, v179
    v_exp_f32 v50, v50
    v_rcp_f32 v176, v176
    v_rcp_f32 v178, v178
    v_exp_f32 v66, v66
    v_exp_f32 v51, v51
    v_exp_f32 v67, v67
    v_exp_f32 v52, v52
    v_exp_f32 v68, v68
    v_exp_f32 v53, v53
    v_exp_f32 v69, v69
    v_exp_f32 v54, v54
    v_exp_f32 v70, v70
    v_exp_f32 v55, v55
    v_exp_f32 v71, v71
    v_exp_f32 v56, v56
    v_exp_f32 v72, v72
    v_exp_f32 v57, v57
    v_exp_f32 v73, v73
    v_exp_f32 v58, v58
    v_exp_f32 v74, v74
    v_exp_f32 v59, v59
    v_exp_f32 v75, v75
    v_exp_f32 v60, v60
    v_exp_f32 v76, v76
    v_exp_f32 v61, v61
    v_exp_f32 v77, v77
    v_exp_f32 v62, v62
    v_exp_f32 v78, v78
    v_exp_f32 v63, v63
    v_exp_f32 v79, v79
    v_pk_add_f32 v[180:181], v[48:49], v[50:51]
    v_pk_add_f32 v[182:183], v[64:65], v[66:67]
    v_pk_add_f32 v[180:181], v[180:181], v[52:53]
    v_pk_add_f32 v[182:183], v[182:183], v[68:69]
    v_pk_add_f32 v[180:181], v[180:181], v[54:55]
    v_pk_add_f32 v[182:183], v[182:183], v[70:71]
    v_pk_add_f32 v[180:181], v[180:181], v[56:57]
    v_pk_add_f32 v[182:183], v[182:183], v[72:73]
    v_pk_add_f32 v[180:181], v[180:181], v[58:59]
    v_pk_add_f32 v[182:183], v[182:183], v[74:75]
    v_pk_add_f32 v[180:181], v[180:181], v[60:61]
    v_pk_add_f32 v[182:183], v[182:183], v[76:77]
    v_pk_add_f32 v[180:181], v[180:181], v[62:63]
    v_pk_add_f32 v[182:183], v[182:183], v[78:79]
    v_add_f32 v180, v180, v181
    v_add_f32 v182, v182, v183
    v_mov_b32 v181, v180
    v_mov_b32 v183, v182
    v_pk_mul_f32 v[128:129], v[128:129], v[176:177] op_sel_hi:[1,0]
    v_pk_mul_f32 v[130:131], v[130:131], v[176:177] op_sel_hi:[1,0]
    v_cvt_pk_bf16_f32 v128, v128, v129
    v_permlane32_swap_b32 v180, v181
    v_permlane32_swap_b32 v182, v183
    v_cvt_pk_bf16_f32 v129, v130, v131
    v_pk_mul_f32 v[144:145], v[144:145], v[178:179] op_sel_hi:[1,0]
    v_pk_mul_f32 v[146:147], v[146:147], v[178:179] op_sel_hi:[1,0]
    v_cvt_pk_bf16_f32 v144, v144, v145
    v_cvt_pk_bf16_f32 v145, v146, v147
    v_add_f32 v180, v180, v181
    v_add_f32 v182, v182, v183
    ds_write2st64_b64 v168, v[128:129], v[144:145] offset0:0 offset1:8
    v_pk_mul_f32 v[132:133], v[132:133], v[176:177] op_sel_hi:[1,0]
    v_pk_mul_f32 v[134:135], v[134:135], v[176:177] op_sel_hi:[1,0]
    v_cvt_pk_bf16_f32 v132, v132, v133
    v_cvt_pk_bf16_f32 v133, v134, v135
    v_pk_mul_f32 v[148:149], v[148:149], v[178:179] op_sel_hi:[1,0]
    v_rcp_f32 v180, v180
    v_rcp_f32 v182, v182
    v_pk_mul_f32 v[150:151], v[150:151], v[178:179] op_sel_hi:[1,0]
    v_cvt_pk_bf16_f32 v148, v148, v149
    v_cvt_pk_bf16_f32 v149, v150, v151
    ds_write2st64_b64 v169, v[132:133], v[148:149] offset0:0 offset1:8
    v_pk_mul_f32 v[136:137], v[136:137], v[176:177] op_sel_hi:[1,0]
    v_pk_mul_f32 v[138:139], v[138:139], v[176:177] op_sel_hi:[1,0]
    v_cvt_pk_bf16_f32 v136, v136, v137
    v_cvt_pk_bf16_f32 v137, v138, v139
    v_pk_mul_f32 v[152:153], v[152:153], v[178:179] op_sel_hi:[1,0]
    v_pk_mul_f32 v[154:155], v[154:155], v[178:179] op_sel_hi:[1,0]
    v_cvt_pk_bf16_f32 v152, v152, v153
    v_cvt_pk_bf16_f32 v153, v154, v155
    ds_write2st64_b64 v170, v[136:137], v[152:153] offset0:0 offset1:8
    v_pk_mul_f32 v[140:141], v[140:141], v[176:177] op_sel_hi:[1,0]
    v_pk_mul_f32 v[142:143], v[142:143], v[176:177] op_sel_hi:[1,0]
    v_cvt_pk_bf16_f32 v140, v140, v141
    v_cvt_pk_bf16_f32 v141, v142, v143
    v_pk_mul_f32 v[156:157], v[156:157], v[178:179] op_sel_hi:[1,0]
    v_pk_mul_f32 v[158:159], v[158:159], v[178:179] op_sel_hi:[1,0]
    v_cvt_pk_bf16_f32 v156, v156, v157
    v_cvt_pk_bf16_f32 v157, v158, v159
    ds_write2st64_b64 v171, v[140:141], v[156:157] offset0:0 offset1:8
    v_pk_mul_f32 v[48:49], v[48:49], v[180:181] op_sel_hi:[1,0]
    v_pk_mul_f32 v[50:51], v[50:51], v[180:181] op_sel_hi:[1,0]
    v_cvt_pk_bf16_f32 v48, v48, v49
    v_cvt_pk_bf16_f32 v49, v50, v51
    v_pk_mul_f32 v[64:65], v[64:65], v[182:183] op_sel_hi:[1,0]
    v_pk_mul_f32 v[66:67], v[66:67], v[182:183] op_sel_hi:[1,0]
    v_cvt_pk_bf16_f32 v64, v64, v65
    v_cvt_pk_bf16_f32 v65, v66, v67
    ds_write2st64_b64 v172, v[48:49], v[64:65] offset0:0 offset1:8
    v_pk_mul_f32 v[52:53], v[52:53], v[180:181] op_sel_hi:[1,0]
    v_pk_mul_f32 v[54:55], v[54:55], v[180:181] op_sel_hi:[1,0]
    v_cvt_pk_bf16_f32 v52, v52, v53
    v_cvt_pk_bf16_f32 v53, v54, v55
    v_pk_mul_f32 v[68:69], v[68:69], v[182:183] op_sel_hi:[1,0]
    v_pk_mul_f32 v[70:71], v[70:71], v[182:183] op_sel_hi:[1,0]
    v_cvt_pk_bf16_f32 v68, v68, v69
    v_cvt_pk_bf16_f32 v69, v70, v71
    ds_write2st64_b64 v173, v[52:53], v[68:69] offset0:0 offset1:8
    v_pk_mul_f32 v[56:57], v[56:57], v[180:181] op_sel_hi:[1,0]
    v_pk_mul_f32 v[58:59], v[58:59], v[180:181] op_sel_hi:[1,0]
    v_cvt_pk_bf16_f32 v56, v56, v57
    v_cvt_pk_bf16_f32 v57, v58, v59
    v_pk_mul_f32 v[72:73], v[72:73], v[182:183] op_sel_hi:[1,0]
    v_pk_mul_f32 v[74:75], v[74:75], v[182:183] op_sel_hi:[1,0]
    v_cvt_pk_bf16_f32 v72, v72, v73
    v_cvt_pk_bf16_f32 v73, v74, v75
    ds_write2st64_b64 v174, v[56:57], v[72:73] offset0:0 offset1:8
    v_pk_mul_f32 v[60:61], v[60:61], v[180:181] op_sel_hi:[1,0]
    v_pk_mul_f32 v[62:63], v[62:63], v[180:181] op_sel_hi:[1,0]
    v_cvt_pk_bf16_f32 v60, v60, v61
    v_cvt_pk_bf16_f32 v61, v62, v63
    v_pk_mul_f32 v[76:77], v[76:77], v[182:183] op_sel_hi:[1,0]
    v_pk_mul_f32 v[78:79], v[78:79], v[182:183] op_sel_hi:[1,0]
    v_cvt_pk_bf16_f32 v76, v76, v77
    v_cvt_pk_bf16_f32 v77, v78, v79
    ds_write2st64_b64 v175, v[60:61], v[76:77] offset0:0 offset1:8
    ds_read_b64_tr_b16 v[112:113], v218 offset:0
    ds_read_b64_tr_b16 v[114:115], v219 offset:0
    ds_read_b64_tr_b16 v[144:145], v220 offset:32768
    ds_read_b64_tr_b16 v[146:147], v221 offset:32768
    ds_read_b64_tr_b16 v[116:117], v218 offset:2048
    ds_read_b64_tr_b16 v[118:119], v219 offset:2048
    ds_read_b64_tr_b16 v[148:149], v220 offset:34816
    ds_read_b64_tr_b16 v[150:151], v221 offset:34816
    ds_read_b64_tr_b16 v[120:121], v218 offset:4096
    ds_read_b64_tr_b16 v[122:123], v219 offset:4096
    ds_read_b64_tr_b16 v[152:153], v220 offset:36864
    ds_read_b64_tr_b16 v[154:155], v221 offset:36864
    v_cvt_pk_bf16_f32 v176, v16, v17
    v_cvt_pk_bf16_f32 v177, v18, v19
    v_cvt_pk_bf16_f32 v178, v20, v21
    v_cvt_pk_bf16_f32 v179, v22, v23
    v_cvt_pk_bf16_f32 v180, v32, v33
    v_cvt_pk_bf16_f32 v181, v34, v35
    v_cvt_pk_bf16_f32 v182, v36, v37
    v_cvt_pk_bf16_f32 v183, v38, v39
    v_cvt_pk_bf16_f32 v184, v24, v25
    v_cvt_pk_bf16_f32 v185, v26, v27
    v_cvt_pk_bf16_f32 v186, v28, v29
    v_cvt_pk_bf16_f32 v187, v30, v31
    v_cvt_pk_bf16_f32 v188, v40, v41
    v_cvt_pk_bf16_f32 v189, v42, v43
    v_cvt_pk_bf16_f32 v190, v44, v45
    v_cvt_pk_bf16_f32 v191, v46, v47
    s_waitcnt lgkmcnt(8)
    v_mfma_f32_32x32x16_bf16 v[48:63], v[112:115], v[144:147], 0
    ds_read_b64_tr_b16 v[124:125], v218 offset:6144
    ds_read_b64_tr_b16 v[126:127], v219 offset:6144
    ds_read_b64_tr_b16 v[156:157], v220 offset:38912
    ds_read_b64_tr_b16 v[158:159], v221 offset:38912
    s_waitcnt lgkmcnt(8)
    v_mfma_f32_32x32x16_bf16 v[48:63], v[116:119], v[148:151], v[48:63]
    v_xor_b32 v218, 8192, v218
    v_xor_b32 v219, 8192, v219
    v_xor_b32 v220, 8192, v220
    v_xor_b32 v221, 8192, v221
    s_barrier
    ds_read_b64_tr_b16 v[128:129], v218 offset:0
    ds_read_b64_tr_b16 v[130:131], v219 offset:0
    ds_read_b64_tr_b16 v[160:161], v220 offset:32768
    ds_read_b64_tr_b16 v[162:163], v221 offset:32768
    s_waitcnt lgkmcnt(8)
    v_mfma_f32_32x32x16_bf16 v[48:63], v[120:123], v[152:155], v[48:63]
    ds_read_b64_tr_b16 v[132:133], v218 offset:2048
    ds_read_b64_tr_b16 v[134:135], v219 offset:2048
    ds_read_b64_tr_b16 v[164:165], v220 offset:34816
    ds_read_b64_tr_b16 v[166:167], v221 offset:34816
    s_waitcnt lgkmcnt(8)
    v_mfma_f32_32x32x16_bf16 v[48:63], v[124:127], v[156:159], v[48:63]
    ds_read_b64_tr_b16 v[136:137], v218 offset:4096
    ds_read_b64_tr_b16 v[138:139], v219 offset:4096
    ds_read_b64_tr_b16 v[168:169], v220 offset:36864
    ds_read_b64_tr_b16 v[170:171], v221 offset:36864
    s_waitcnt lgkmcnt(8)
    v_mfma_f32_32x32x16_bf16 v[48:63], v[128:131], v[160:163], v[48:63]
    ds_read_b64_tr_b16 v[140:141], v218 offset:6144
    ds_read_b64_tr_b16 v[142:143], v219 offset:6144
    ds_read_b64_tr_b16 v[172:173], v220 offset:38912
    ds_read_b64_tr_b16 v[174:175], v221 offset:38912
    s_waitcnt lgkmcnt(8)
    v_mfma_f32_32x32x16_bf16 v[48:63], v[132:135], v[164:167], v[48:63]
    v_permlane16_swap_b32 v176, v178
    v_permlane16_swap_b32 v177, v179
    s_waitcnt lgkmcnt(4)
    v_mfma_f32_32x32x16_bf16 v[48:63], v[136:139], v[168:171], v[48:63]
    v_permlane16_swap_b32 v180, v182
    v_permlane16_swap_b32 v181, v183
    v_permlane16_swap_b32 v184, v186
    s_waitcnt lgkmcnt(0)
    v_mfma_f32_32x32x16_bf16 v[48:63], v[140:143], v[172:175], v[48:63]
    s_barrier
    v_permlane16_swap_b32 v185, v187
    v_permlane16_swap_b32 v188, v190
    v_permlane16_swap_b32 v189, v191
    s_lshl_b32 s76, s62, 11
    s_add_u32 s76, s76, s99
    v_mfma_f32_32x32x16_bf16 v[16:31], v[204:207], v[176:179], 0
    s_add_u32 s76, s76, 1024
    s_lshl_b32 s77, s62, 7
    s_add_u32 s77, s77, s73
    v_lshlrev_b32_e64 v4, 2, v2
    v_mfma_f32_32x32x16_bf16 v[32:47], v[204:207], v[184:187], 0
    v_cvt_pk_bf16_f32 v64, v48, v49
    v_cvt_pk_bf16_f32 v65, v50, v51
    v_cvt_pk_bf16_f32 v66, v52, v53
    v_cvt_pk_bf16_f32 v67, v54, v55
    v_cvt_pk_bf16_f32 v68, v56, v57
    v_mfma_f32_32x32x16_bf16 v[16:31], v[208:211], v[180:183], v[16:31]
    v_cvt_pk_bf16_f32 v69, v58, v59
    v_cvt_pk_bf16_f32 v70, v60, v61
    v_cvt_pk_bf16_f32 v71, v62, v63
    s_bitcmp1_b32 s100, 0
    s_cbranch_scc1 L_loc_59
    buffer_store_dwordx4 v[64:67], v12, s[40:43], s76 offen offset:0 sc1
    buffer_store_dwordx4 v[68:71], v12, s[40:43], s76 offen offset:1024 sc1
    s_branch L_pubd_60
L_loc_59:
    buffer_store_dwordx4 v[64:67], v12, s[40:43], s76 offen offset:0
    buffer_store_dwordx4 v[68:71], v12, s[40:43], s76 offen offset:1024
L_pubd_60:
    v_mfma_f32_32x32x16_bf16 v[32:47], v[208:211], v[188:191], v[32:47]
    v_and_b32 v216, 1, v1
    v_lshlrev_b32_e64 v216, 8, v216
    v_lshl_add_u32 v216, v3, 4, v216
    s_lshl_b32 s76, s64, 7
    v_add_u32 v216, s76, v216
    s_mul_i32 s78, s61, 28800
    s_lshl_b32 s79, s64, 8
    s_add_u32 s78, s78, s79
    s_add_u32 s79, s78, 3686400
    v_dot2_f32_bf16 v72, v112, s89, 0
    v_dot2_f32_bf16 v73, v113, s89, 0
    v_dot2_f32_bf16 v72, v114, s89, v72
    v_dot2_f32_bf16 v73, v115, s89, v73
    v_dot2_f32_bf16 v72, v116, s89, v72
    v_dot2_f32_bf16 v73, v117, s89, v73
    v_dot2_f32_bf16 v72, v118, s89, v72
    v_dot2_f32_bf16 v73, v119, s89, v73
    v_dot2_f32_bf16 v72, v120, s89, v72
    v_dot2_f32_bf16 v73, v121, s89, v73
    v_dot2_f32_bf16 v72, v122, s89, v72
    v_dot2_f32_bf16 v73, v123, s89, v73
    v_dot2_f32_bf16 v72, v124, s89, v72
    v_dot2_f32_bf16 v73, v125, s89, v73
    v_dot2_f32_bf16 v72, v126, s89, v72
    v_dot2_f32_bf16 v73, v127, s89, v73
    v_dot2_f32_bf16 v72, v128, s89, v72
    v_dot2_f32_bf16 v73, v129, s89, v73
    v_dot2_f32_bf16 v72, v130, s89, v72
    v_dot2_f32_bf16 v73, v131, s89, v73
    v_dot2_f32_bf16 v72, v132, s89, v72
    v_dot2_f32_bf16 v73, v133, s89, v73
    v_dot2_f32_bf16 v72, v134, s89, v72
    v_dot2_f32_bf16 v73, v135, s89, v73
    v_dot2_f32_bf16 v72, v136, s89, v72
    v_dot2_f32_bf16 v73, v137, s89, v73
    v_dot2_f32_bf16 v72, v138, s89, v72
    v_dot2_f32_bf16 v73, v139, s89, v73
    v_dot2_f32_bf16 v72, v140, s89, v72
    v_dot2_f32_bf16 v73, v141, s89, v73
    v_dot2_f32_bf16 v72, v142, s89, v72
    v_dot2_f32_bf16 v73, v143, s89, v73
    s_lshl_b32 s76, s98, 7
    v_lshl_add_u32 v10, v3, 3, s76
    v_lshlrev_b32 v11, 5, v1
    v_add_f32 v72, v72, v73
    v_mov_b32 v73, v72
    s_nop 1
    v_permlane32_swap_b32 v72, v73
    v_add_f32 v72, v72, v73
    s_mov_b32 exec_hi, 0
    s_bitcmp1_b32 s100, 0
    s_cbranch_scc1 L_loc_61
    buffer_store_dword v72, v4, s[40:43], s77 offen offset:2048 sc1
    s_branch L_pubd_62
L_loc_61:
    buffer_store_dword v72, v4, s[40:43], s77 offen offset:2048
L_pubd_62:
    s_mov_b64 exec, -1
    v_max3_f32 v160, v16, v17, v18
    v_min3_f32 v162, v16, v17, v18
    v_max3_f32 v160, v160, v19, v20
    v_min3_f32 v162, v162, v19, v20
    v_max3_f32 v160, v160, v21, v22
    v_min3_f32 v162, v162, v21, v22
    v_max3_f32 v160, v160, v23, v24
    v_min3_f32 v162, v162, v23, v24
    v_max3_f32 v160, v160, v25, v26
    v_min3_f32 v162, v162, v25, v26
    v_max3_f32 v160, v160, v27, v28
    v_min3_f32 v162, v162, v27, v28
    v_max3_f32 v160, v160, v29, v30
    v_min3_f32 v162, v162, v29, v30
    v_max_f32 v160, v160, v31
    v_min_f32 v162, v162, v31
    v_max3_f32 v164, v32, v33, v34
    v_min3_f32 v166, v32, v33, v34
    v_max3_f32 v164, v164, v35, v36
    v_min3_f32 v166, v166, v35, v36
    v_max3_f32 v164, v164, v37, v38
    v_min3_f32 v166, v166, v37, v38
    v_max3_f32 v164, v164, v39, v40
    v_min3_f32 v166, v166, v39, v40
    v_max3_f32 v164, v164, v41, v42
    v_min3_f32 v166, v166, v41, v42
    v_max3_f32 v164, v164, v43, v44
    v_min3_f32 v166, v166, v43, v44
    v_max3_f32 v164, v164, v45, v46
    v_min3_f32 v166, v166, v45, v46
    v_max_f32 v164, v164, v47
    v_min_f32 v166, v166, v47
    v_mov_b32 v161, v160
    v_mov_b32 v163, v162
    v_mov_b32 v165, v164
    v_mov_b32 v167, v166
    v_permlane32_swap_b32 v160, v161
    v_permlane32_swap_b32 v162, v163
    v_permlane32_swap_b32 v164, v165
    v_permlane32_swap_b32 v166, v167
    v_max_f32 v160, v160, v161
    v_min_f32 v162, v162, v163
    v_max_f32 v164, v164, v165
    v_min_f32 v166, v166, v167
    v_mul_f32 v160, v160, v251
    v_mul_f32 v162, v162, v251
    v_mul_f32 v164, v164, v253
    v_mul_f32 v166, v166, v253
    v_pk_fma_f32 v[128:129], v[16:17], v[250:251], v[160:161] op_sel:[0,1,0] op_sel_hi:[1,1,0] neg_lo:[0,0,1] neg_hi:[0,0,1]
    v_pk_fma_f32 v[16:17], v[16:17], v[250:251], v[162:163] op_sel:[0,1,0] op_sel_hi:[1,1,0] neg_lo:[0,1,0] neg_hi:[0,1,0]
    v_pk_fma_f32 v[130:131], v[18:19], v[250:251], v[160:161] op_sel:[0,1,0] op_sel_hi:[1,1,0] neg_lo:[0,0,1] neg_hi:[0,0,1]
    v_pk_fma_f32 v[18:19], v[18:19], v[250:251], v[162:163] op_sel:[0,1,0] op_sel_hi:[1,1,0] neg_lo:[0,1,0] neg_hi:[0,1,0]
    v_pk_fma_f32 v[132:133], v[20:21], v[250:251], v[160:161] op_sel:[0,1,0] op_sel_hi:[1,1,0] neg_lo:[0,0,1] neg_hi:[0,0,1]
    v_pk_fma_f32 v[20:21], v[20:21], v[250:251], v[162:163] op_sel:[0,1,0] op_sel_hi:[1,1,0] neg_lo:[0,1,0] neg_hi:[0,1,0]
    v_pk_fma_f32 v[134:135], v[22:23], v[250:251], v[160:161] op_sel:[0,1,0] op_sel_hi:[1,1,0] neg_lo:[0,0,1] neg_hi:[0,0,1]
    v_pk_fma_f32 v[22:23], v[22:23], v[250:251], v[162:163] op_sel:[0,1,0] op_sel_hi:[1,1,0] neg_lo:[0,1,0] neg_hi:[0,1,0]
    v_pk_fma_f32 v[136:137], v[24:25], v[250:251], v[160:161] op_sel:[0,1,0] op_sel_hi:[1,1,0] neg_lo:[0,0,1] neg_hi:[0,0,1]
    v_pk_fma_f32 v[24:25], v[24:25], v[250:251], v[162:163] op_sel:[0,1,0] op_sel_hi:[1,1,0] neg_lo:[0,1,0] neg_hi:[0,1,0]
    v_pk_fma_f32 v[138:139], v[26:27], v[250:251], v[160:161] op_sel:[0,1,0] op_sel_hi:[1,1,0] neg_lo:[0,0,1] neg_hi:[0,0,1]
    v_pk_fma_f32 v[26:27], v[26:27], v[250:251], v[162:163] op_sel:[0,1,0] op_sel_hi:[1,1,0] neg_lo:[0,1,0] neg_hi:[0,1,0]
    v_pk_fma_f32 v[140:141], v[28:29], v[250:251], v[160:161] op_sel:[0,1,0] op_sel_hi:[1,1,0] neg_lo:[0,0,1] neg_hi:[0,0,1]
    v_pk_fma_f32 v[28:29], v[28:29], v[250:251], v[162:163] op_sel:[0,1,0] op_sel_hi:[1,1,0] neg_lo:[0,1,0] neg_hi:[0,1,0]
    v_pk_fma_f32 v[142:143], v[30:31], v[250:251], v[160:161] op_sel:[0,1,0] op_sel_hi:[1,1,0] neg_lo:[0,0,1] neg_hi:[0,0,1]
    v_pk_fma_f32 v[30:31], v[30:31], v[250:251], v[162:163] op_sel:[0,1,0] op_sel_hi:[1,1,0] neg_lo:[0,1,0] neg_hi:[0,1,0]
    v_pk_fma_f32 v[144:145], v[32:33], v[252:253], v[164:165] op_sel:[0,1,0] op_sel_hi:[1,1,0] neg_lo:[0,0,1] neg_hi:[0,0,1]
    v_pk_fma_f32 v[32:33], v[32:33], v[252:253], v[166:167] op_sel:[0,1,0] op_sel_hi:[1,1,0] neg_lo:[0,1,0] neg_hi:[0,1,0]
    v_pk_fma_f32 v[146:147], v[34:35], v[252:253], v[164:165] op_sel:[0,1,0] op_sel_hi:[1,1,0] neg_lo:[0,0,1] neg_hi:[0,0,1]
    v_pk_fma_f32 v[34:35], v[34:35], v[252:253], v[166:167] op_sel:[0,1,0] op_sel_hi:[1,1,0] neg_lo:[0,1,0] neg_hi:[0,1,0]
    v_pk_fma_f32 v[148:149], v[36:37], v[252:253], v[164:165] op_sel:[0,1,0] op_sel_hi:[1,1,0] neg_lo:[0,0,1] neg_hi:[0,0,1]
    v_pk_fma_f32 v[36:37], v[36:37], v[252:253], v[166:167] op_sel:[0,1,0] op_sel_hi:[1,1,0] neg_lo:[0,1,0] neg_hi:[0,1,0]
    v_pk_fma_f32 v[150:151], v[38:39], v[252:253], v[164:165] op_sel:[0,1,0] op_sel_hi:[1,1,0] neg_lo:[0,0,1] neg_hi:[0,0,1]
    v_pk_fma_f32 v[38:39], v[38:39], v[252:253], v[166:167] op_sel:[0,1,0] op_sel_hi:[1,1,0] neg_lo:[0,1,0] neg_hi:[0,1,0]
    v_pk_fma_f32 v[152:153], v[40:41], v[252:253], v[164:165] op_sel:[0,1,0] op_sel_hi:[1,1,0] neg_lo:[0,0,1] neg_hi:[0,0,1]
    v_pk_fma_f32 v[40:41], v[40:41], v[252:253], v[166:167] op_sel:[0,1,0] op_sel_hi:[1,1,0] neg_lo:[0,1,0] neg_hi:[0,1,0]
    v_pk_fma_f32 v[154:155], v[42:43], v[252:253], v[164:165] op_sel:[0,1,0] op_sel_hi:[1,1,0] neg_lo:[0,0,1] neg_hi:[0,0,1]
    v_pk_fma_f32 v[42:43], v[42:43], v[252:253], v[166:167] op_sel:[0,1,0] op_sel_hi:[1,1,0] neg_lo:[0,1,0] neg_hi:[0,1,0]
    v_pk_fma_f32 v[156:157], v[44:45], v[252:253], v[164:165] op_sel:[0,1,0] op_sel_hi:[1,1,0] neg_lo:[0,0,1] neg_hi:[0,0,1]
    v_pk_fma_f32 v[44:45], v[44:45], v[252:253], v[166:167] op_sel:[0,1,0] op_sel_hi:[1,1,0] neg_lo:[0,1,0] neg_hi:[0,1,0]
    v_pk_fma_f32 v[158:159], v[46:47], v[252:253], v[164:165] op_sel:[0,1,0] op_sel_hi:[1,1,0] neg_lo:[0,0,1] neg_hi:[0,0,1]
    v_pk_fma_f32 v[46:47], v[46:47], v[252:253], v[166:167] op_sel:[0,1,0] op_sel_hi:[1,1,0] neg_lo:[0,1,0] neg_hi:[0,1,0]
    v_exp_f32 v128, v128
    v_exp_f32 v16, v16
    v_exp_f32 v129, v129
    v_exp_f32 v17, v17
    v_exp_f32 v130, v130
    v_exp_f32 v18, v18
    v_exp_f32 v131, v131
    v_exp_f32 v19, v19
    v_exp_f32 v132, v132
    v_exp_f32 v20, v20
    v_exp_f32 v133, v133
    v_exp_f32 v21, v21
    v_exp_f32 v134, v134
    v_exp_f32 v22, v22
    v_exp_f32 v135, v135
    v_exp_f32 v23, v23
    v_exp_f32 v136, v136
    v_exp_f32 v24, v24
    v_exp_f32 v137, v137
    v_exp_f32 v25, v25
    v_exp_f32 v138, v138
    v_exp_f32 v26, v26
    v_exp_f32 v139, v139
    v_exp_f32 v27, v27
    v_exp_f32 v140, v140
    v_exp_f32 v28, v28
    v_exp_f32 v141, v141
    v_exp_f32 v29, v29
    v_exp_f32 v142, v142
    v_exp_f32 v30, v30
    v_exp_f32 v143, v143
    v_exp_f32 v31, v31
    v_cvt_pk_bf16_f32 v218, v128, v129
    v_cvt_pk_bf16_f32 v219, v130, v131
    v_cvt_pk_bf16_f32 v220, v132, v133
    v_cvt_pk_bf16_f32 v221, v134, v135
    v_cvt_pk_bf16_f32 v222, v136, v137
    v_cvt_pk_bf16_f32 v223, v138, v139
    v_cvt_pk_bf16_f32 v224, v140, v141
    v_cvt_pk_bf16_f32 v225, v142, v143
    v_cvt_pk_bf16_f32 v226, v16, v17
    v_cvt_pk_bf16_f32 v227, v18, v19
    v_cvt_pk_bf16_f32 v228, v20, v21
    v_cvt_pk_bf16_f32 v229, v22, v23
    v_cvt_pk_bf16_f32 v230, v24, v25
    v_cvt_pk_bf16_f32 v231, v26, v27
    v_cvt_pk_bf16_f32 v232, v28, v29
    v_cvt_pk_bf16_f32 v233, v30, v31
    v_exp_f32 v144, v144
    v_exp_f32 v32, v32
    v_exp_f32 v145, v145
    v_exp_f32 v33, v33
    v_exp_f32 v146, v146
    v_exp_f32 v34, v34
    v_exp_f32 v147, v147
    v_exp_f32 v35, v35
    v_exp_f32 v148, v148
    v_exp_f32 v36, v36
    v_exp_f32 v149, v149
    v_exp_f32 v37, v37
    v_exp_f32 v150, v150
    v_exp_f32 v38, v38
    v_exp_f32 v151, v151
    v_exp_f32_e64 v39, v39
    s_barrier
    buffer_load_dwordx4 v[48:51], v13, s[40:43], s78 offen offset:3072 sc1
    buffer_load_dwordx4 v[52:55], v13, s[40:43], s79 offen offset:3072 sc1
    buffer_load_dwordx4 v[56:59], v13, s[40:43], s78 offen offset:3200 sc1
    buffer_load_dwordx4 v[60:63], v13, s[40:43], s79 offen offset:3200 sc1
    ds_read_b128 v[168:171], v216 offset:24576
    ds_read_b128 v[172:175], v216 offset:24608
    ds_read_b128 v[176:179], v216 offset:24640
    ds_read_b128 v[180:183], v216 offset:24672
    v_exp_f32 v152, v152
    v_exp_f32 v40, v40
    v_exp_f32 v153, v153
    v_exp_f32 v41, v41
    v_exp_f32 v154, v154
    v_exp_f32 v42, v42
    v_exp_f32 v155, v155
    v_exp_f32 v43, v43
    v_exp_f32 v156, v156
    v_exp_f32_e64 v44, v44
    s_waitcnt lgkmcnt(0)
    v_mfma_f32_32x32x16_bf16 v[64:79], v[168:171], v[218:221], 0
    v_exp_f32 v157, v157
    v_exp_f32 v45, v45
    v_exp_f32_e64 v158, v158
    v_mfma_f32_32x32x16_bf16 v[80:95], v[176:179], v[226:229], 0
    v_exp_f32 v46, v46
    v_exp_f32 v159, v159
    v_exp_f32_e64 v47, v47
    v_mfma_f32_32x32x16_bf16 v[64:79], v[172:175], v[222:225], v[64:79]
    v_cvt_pk_bf16_f32 v234, v144, v145
    v_cvt_pk_bf16_f32 v235, v146, v147
    v_cvt_pk_bf16_f32 v236, v148, v149
    v_cvt_pk_bf16_f32 v237, v150, v151
    v_cvt_pk_bf16_f32 v238, v152, v153
    v_cvt_pk_bf16_f32 v239, v154, v155
    v_mfma_f32_32x32x16_bf16 v[80:95], v[180:183], v[230:233], v[80:95]
    v_cvt_pk_bf16_f32 v240, v156, v157
    v_cvt_pk_bf16_f32 v241, v158, v159
    v_cvt_pk_bf16_f32 v242, v32, v33
    v_cvt_pk_bf16_f32 v243, v34, v35
    v_cvt_pk_bf16_f32 v244, v36, v37
    v_cvt_pk_bf16_f32 v245, v38, v39
    v_cvt_pk_bf16_f32 v246, v40, v41
    v_cvt_pk_bf16_f32 v247, v42, v43
    v_cvt_pk_bf16_f32 v248, v44, v45
    v_cvt_pk_bf16_f32 v249, v46, v47
    v_mfma_f32_32x32x16_bf16 v[96:111], v[168:171], v[234:237], 0
    v_rcp_f32 v184, v65
    v_rcp_f32 v185, v81
    v_mul_f32 v6, v64, v184
    v_fmac_f32 v6, v80, v185
    v_add_f32 v6, 0x358637bd, v6
    v_mfma_f32_32x32x16_bf16 v[112:127], v[176:179], v[242:245], 0
    v_rcp_f32 v6, v6
    v_mov_b32 v8, 0
    v_mul_f32 v184, v184, v6
    v_mul_f32_e64 v185, v185, v6
    s_lshl4_add_u32 s76, s60, s61
    v_mfma_f32_32x32x16_bf16 v[96:111], v[172:175], v[238:241], v[96:111]
    s_mul_i32 s76, s76, 32768
    s_lshl2_add_u32 s77, s63, s64
    s_lshl_b32 s77, s77, 12
    s_add_u32 s76, s76, s77
    s_add_u32 s76, s76, 16777216
    v_mfma_f32_32x32x16_bf16 v[112:127], v[180:183], v[246:249], v[112:127]
    s_add_u32 s77, s76, 8192
    v_add_u32 v14, 128, v12
    v_cmp_gt_u32 vcc, 24, v1
    s_nop 0
    s_nop 0
    v_cndmask_b32_e64 v14, v14, v12, vcc
    s_mov_b32 s88, 0
    s_branch L_pfirst_64
L_poll_63:
    buffer_load_dwordx4 v[48:51], v13, s[40:43], s78 offen offset:3072 sc1
    buffer_load_dwordx4 v[52:55], v13, s[40:43], s79 offen offset:3072 sc1
    buffer_load_dwordx4 v[56:59], v13, s[40:43], s78 offen offset:3200 sc1
    buffer_load_dwordx4 v[60:63], v13, s[40:43], s79 offen offset:3200 sc1
L_pfirst_64:
    s_waitcnt vmcnt(0)
    v_max3_u32 v9, v48, v49, v50
    v_max3_u32 v9, v9, v51, v52
    v_max3_u32 v9, v9, v53, v54
    v_max3_u32 v9, v9, v55, v56
    v_max3_u32 v9, v9, v57, v58
    v_max3_u32 v9, v9, v59, v60
    v_max3_u32 v9, v9, v61, v62
    v_max_u32 v9, v9, v63
    v_cmp_eq_u32 vcc, -1, v9
    s_nop 0
    s_cbranch_vccz L_ok_65
    s_add_u32 s88, s88, 1
    s_cmp_lt_u32 s88, 65536
    s_cbranch_scc1 L_poll_63
L_ok_65:
    v_mfma_f32_32x32x16_bf16 v[16:31], v[48:51], v[218:221], 0
    s_barrier
    v_rcp_f32 v186, v97
    v_rcp_f32 v187, v113
    v_mul_f32_e64 v7, v96, v186
    v_mfma_f32_32x32x16_bf16 v[128:143], v[56:59], v[226:229], 0
    v_fmac_f32_e64 v7, v112, v187
    v_add_f32 v7, 0x358637bd, v7
    v_rcp_f32_e64 v7, v7
    v_bfe_u32 v4, v2, 1, 3
    v_lshlrev_b32_e64 v4, 4, v4
    v_mfma_f32_32x32x16_bf16 v[16:31], v[52:55], v[222:225], v[16:31]
    v_mov_b32 v8, 0
    v_mul_f32 v186, v186, v7
    v_mul_f32_e64 v187, v187, v7
    v_lshl_add_u32 v4, v3, 3, v4
    v_lshl_add_u32 v4, v2, 7, v4
    s_lshl_b32 s56, s62, 12
    v_mfma_f32_32x32x16_bf16 v[128:143], v[60:63], v[230:233], v[128:143]
    s_add_u32 s57, s56, 0
    v_add_u32 v64, s57, v4
    v_xor_b32 v65, 16, v64
    v_xor_b32 v66, 32, v64
    v_xor_b32 v67, 48, v64
    v_xor_b32_e64 v68, 64, v64
    v_mfma_f32_32x32x16_bf16 v[32:47], v[48:51], v[234:237], 0
    v_xor_b32 v69, 80, v64
    v_xor_b32 v70, 96, v64
    v_xor_b32 v71, 112, v64
    v_bfe_u32 v4, v1, 2, 2
    v_lshl_add_u32 v5, v3, 2, v4
    v_lshlrev_b32 v5, 7, v5
    s_bitcmp1_b32 s100, 2
    v_mfma_f32_32x32x16_bf16 v[144:159], v[56:59], v[242:245], 0
    v_mul_f32 v16, v16, v184
    v_mul_f32 v17, v17, v184
    v_mul_f32 v18, v18, v184
    v_mul_f32 v19, v19, v184
    v_mul_f32 v20, v20, v184
    v_mul_f32 v21, v21, v184
    v_mfma_f32_32x32x16_bf16 v[32:47], v[52:55], v[238:241], v[32:47]
    v_mul_f32 v22, v22, v184
    v_mul_f32 v23, v23, v184
    v_mul_f32 v24, v24, v184
    v_mul_f32 v25, v25, v184
    v_mul_f32 v26, v26, v184
    v_mul_f32 v27, v27, v184
    v_mfma_f32_32x32x16_bf16 v[144:159], v[60:63], v[246:249], v[144:159]
    v_mul_f32 v28, v28, v184
    v_mul_f32 v29, v29, v184
    v_mul_f32 v30, v30, v184
    v_mul_f32 v31, v31, v184
    v_fmac_f32 v16, v128, v185
    v_fmac_f32 v17, v129, v185
    v_cvt_pk_bf16_f32 v96, v16, v17
    v_fmac_f32 v18, v130, v185
    v_fmac_f32 v19, v131, v185
    v_cvt_pk_bf16_f32 v97, v18, v19
    v_fmac_f32 v20, v132, v185
    v_fmac_f32 v21, v133, v185
    v_cvt_pk_bf16_f32 v98, v20, v21
    v_fmac_f32 v22, v134, v185
    v_fmac_f32 v23, v135, v185
    v_cvt_pk_bf16_f32 v99, v22, v23
    buffer_store_dwordx4 v[96:99], v14, s[40:43], s76 offen offset:0 sc1
    v_fmac_f32 v24, v136, v185
    v_fmac_f32 v25, v137, v185
    v_cvt_pk_bf16_f32 v100, v24, v25
    v_fmac_f32 v26, v138, v185
    v_fmac_f32 v27, v139, v185
    v_cvt_pk_bf16_f32 v101, v26, v27
    v_fmac_f32 v28, v140, v185
    v_fmac_f32 v29, v141, v185
    v_cvt_pk_bf16_f32 v102, v28, v29
    v_fmac_f32 v30, v142, v185
    v_fmac_f32 v31, v143, v185
    v_cvt_pk_bf16_f32 v103, v30, v31
    buffer_store_dwordx4 v[100:103], v14, s[40:43], s76 offen offset:2048 sc1
    v_pk_mul_f32 v[32:33], v[32:33], v[186:187] op_sel_hi:[1,0]
    v_pk_fma_f32 v[32:33], v[144:145], v[186:187], v[32:33] op_sel:[0,1,0] op_sel_hi:[1,1,1]
    v_cvt_pk_bf16_f32 v104, v32, v33
    v_pk_mul_f32 v[34:35], v[34:35], v[186:187] op_sel_hi:[1,0]
    v_pk_fma_f32 v[34:35], v[146:147], v[186:187], v[34:35] op_sel:[0,1,0] op_sel_hi:[1,1,1]
    v_cvt_pk_bf16_f32 v105, v34, v35
    v_pk_mul_f32 v[36:37], v[36:37], v[186:187] op_sel_hi:[1,0]
    v_pk_fma_f32 v[36:37], v[148:149], v[186:187], v[36:37] op_sel:[0,1,0] op_sel_hi:[1,1,1]
    v_cvt_pk_bf16_f32 v106, v36, v37
    v_pk_mul_f32 v[38:39], v[38:39], v[186:187] op_sel_hi:[1,0]
    v_pk_fma_f32 v[38:39], v[150:151], v[186:187], v[38:39] op_sel:[0,1,0] op_sel_hi:[1,1,1]
    v_cvt_pk_bf16_f32 v107, v38, v39
    buffer_store_dwordx4 v[104:107], v14, s[40:43], s77 offen offset:0 sc1
    v_pk_mul_f32 v[40:41], v[40:41], v[186:187] op_sel_hi:[1,0]
    v_pk_fma_f32 v[40:41], v[152:153], v[186:187], v[40:41] op_sel:[0,1,0] op_sel_hi:[1,1,1]
    v_cvt_pk_bf16_f32 v108, v40, v41
    v_pk_mul_f32 v[42:43], v[42:43], v[186:187] op_sel_hi:[1,0]
    v_pk_fma_f32 v[42:43], v[154:155], v[186:187], v[42:43] op_sel:[0,1,0] op_sel_hi:[1,1,1]
    v_cvt_pk_bf16_f32 v109, v42, v43
    v_pk_mul_f32 v[44:45], v[44:45], v[186:187] op_sel_hi:[1,0]
    v_pk_fma_f32 v[44:45], v[156:157], v[186:187], v[44:45] op_sel:[0,1,0] op_sel_hi:[1,1,1]
    v_cvt_pk_bf16_f32 v110, v44, v45
    v_pk_mul_f32 v[46:47], v[46:47], v[186:187] op_sel_hi:[1,0]
    v_pk_fma_f32 v[46:47], v[158:159], v[186:187], v[46:47] op_sel:[0,1,0] op_sel_hi:[1,1,1]
    v_cvt_pk_bf16_f32 v111, v46, v47
    buffer_store_dwordx4 v[108:111], v14, s[40:43], s77 offen offset:2048 sc1
    v_lshrrev_b32_e64 v4, 1, v4
    v_lshl_add_u32 v5, v4, 6, v5
    v_bfe_u32 v4, v1, 4, 1
    v_lshl_add_u32 v5, v4, 5, v5
    v_and_b32_e64 v4, 3, v1
    v_lshl_add_u32 v5, v4, 3, v5
    v_add_u32 v72, 32768, v5
    v_xor_b32_e64 v73, 64, v72
    s_mul_i32 s80, s97, 524288
    s_mul_i32 s56, s62, 8192
    s_add_u32 s80, s80, s56
    s_add_u32 s80, s80, 16777216
    v_add_u32 v78, 4096, v14
    v_mov_b32 v74, 1
    s_mov_b32 s52, 0xffff
    s_mov_b32 s53, 0
    s_barrier
    ds_read_b32 v79, v8 offset:25984
    ds_read_b64 v[88:89], v64
    ds_read_b64 v[90:91], v65
    ds_read_b64 v[92:93], v66
    ds_read_b64 v[94:95], v67
    ds_read_b64 v[96:97], v68
    ds_read_b64 v[98:99], v69
    ds_read_b64 v[100:101], v70
    ds_read_b64 v[102:103], v71
    s_waitcnt lgkmcnt(8)
    v_readfirstlane_b32 s76, v79
    s_nop 0
    s_and_b32 s76, s76, s52
    s_cbranch_scc0 L_tr0
L_bk0:
    s_ff1_i32_b32 s76, s76
    s_bitset0_b32 s52, s76
    s_add_u32 s77, s76, s65
    s_and_b32 s77, s77, 15
    s_mul_i32 s77, s77, 32768
    s_add_u32 s28, s77, s80
    s_add_u32 s76, s76, 3
    s_and_b32 s76, s76, 15
    s_lshl_b32 s4, s76, 13
    buffer_load_dwordx4 v[128:131], v14, s[40:43], s28 offen offset:0 sc1
    buffer_load_dwordx4 v[132:135], v14, s[40:43], s28 offen offset:2048 sc1
    buffer_load_dwordx4 v[136:139], v78, s[40:43], s28 offen offset:0 sc1
    buffer_load_dwordx4 v[140:143], v78, s[40:43], s28 offen offset:2048 sc1
    v_readfirstlane_b32 s76, v79
    s_nop 0
    s_and_b32 s76, s76, s52
    s_cbranch_scc0 L_tr1
L_bk1:
    s_ff1_i32_b32 s76, s76
    s_bitset0_b32 s52, s76
    s_add_u32 s77, s76, s65
    s_and_b32 s77, s77, 15
    s_mul_i32 s77, s77, 32768
    s_add_u32 s29, s77, s80
    s_add_u32 s76, s76, 3
    s_and_b32 s76, s76, 15
    s_lshl_b32 s5, s76, 13
    buffer_load_dwordx4 v[144:147], v14, s[40:43], s29 offen offset:0 sc1
    buffer_load_dwordx4 v[148:151], v14, s[40:43], s29 offen offset:2048 sc1
    v_add_u32 v80, s4, v72
    v_add_u32 v81, s4, v73
    s_waitcnt lgkmcnt(0)
    v_lshlrev_b32 v16, 16, v88
    v_and_b32 v17, s90, v88
    v_lshlrev_b32 v18, 16, v89
    v_and_b32 v19, s90, v89
    v_lshlrev_b32 v20, 16, v90
    v_and_b32 v21, s90, v90
    v_lshlrev_b32 v22, 16, v91
    v_and_b32 v23, s90, v91
    v_lshlrev_b32 v24, 16, v92
    v_and_b32 v25, s90, v92
    v_lshlrev_b32 v26, 16, v93
    v_and_b32 v27, s90, v93
    v_lshlrev_b32 v28, 16, v94
    v_and_b32 v29, s90, v94
    v_lshlrev_b32 v30, 16, v95
    v_and_b32 v31, s90, v95
    v_lshlrev_b32 v32, 16, v96
    v_and_b32 v33, s90, v96
    v_lshlrev_b32 v34, 16, v97
    v_and_b32 v35, s90, v97
    v_lshlrev_b32 v36, 16, v98
    v_and_b32 v37, s90, v98
    v_lshlrev_b32 v38, 16, v99
    v_and_b32 v39, s90, v99
    v_lshlrev_b32 v40, 16, v100
    v_and_b32 v41, s90, v100
    v_lshlrev_b32 v42, 16, v101
    v_and_b32 v43, s90, v101
    v_lshlrev_b32 v44, 16, v102
    v_and_b32 v45, s90, v102
    v_lshlrev_b32 v46, 16, v103
    v_and_b32 v47, s90, v103
    s_cmp_eq_u32 s53, 0
    s_cbranch_scc0 L_sent_66
    s_waitcnt vmcnt(6)
    s_mov_b64 exec, 1
    ds_add_u32 v8, v74 offset:25988
    s_mov_b64 exec, -1
    s_mov_b32 s53, 1
L_sent_66:
    ds_read_b32 v79, v8 offset:25984
    ds_read_b64_tr_b16 v[104:105], v80 offset:0
    ds_read_b64_tr_b16 v[106:107], v80 offset:1024
    ds_read_b64_tr_b16 v[108:109], v81 offset:0
    ds_read_b64_tr_b16 v[110:111], v81 offset:1024
    ds_read_b64_tr_b16 v[112:113], v80 offset:2048
    ds_read_b64_tr_b16 v[114:115], v80 offset:3072
    ds_read_b64_tr_b16 v[116:117], v81 offset:2048
    ds_read_b64_tr_b16 v[118:119], v81 offset:3072
    s_waitcnt vmcnt(5) lgkmcnt(4)
    v_mfma_f32_32x32x16_bf16 v[16:31], v[104:107], v[128:131], v[16:31]
    ds_read_b64_tr_b16 v[120:121], v80 offset:4096
    ds_read_b64_tr_b16 v[122:123], v80 offset:5120
    buffer_load_dwordx4 v[152:155], v78, s[40:43], s29 offen offset:0 sc1
    v_mfma_f32_32x32x16_bf16 v[32:47], v[108:111], v[128:131], v[32:47]
    ds_read_b64_tr_b16 v[124:125], v81 offset:4096
    ds_read_b64_tr_b16 v[126:127], v81 offset:5120
    buffer_load_dwordx4 v[156:159], v78, s[40:43], s29 offen offset:2048 sc1
    v_readfirstlane_b32 s76, v79
    s_nop 0
    s_and_b32 s76, s76, s52
    s_cbranch_scc0 L_tr2
L_bk2:
    s_ff1_i32_b32 s76, s76
    s_bitset0_b32 s52, s76
    s_add_u32 s77, s76, s65
    s_and_b32 s77, s77, 15
    s_mul_i32 s77, s77, 32768
    s_add_u32 s30, s77, s80
    s_waitcnt vmcnt(6) lgkmcnt(4)
    v_mfma_f32_32x32x16_bf16 v[16:31], v[112:115], v[132:135], v[16:31]
    ds_read_b32 v79, v8 offset:25984
    ds_read_b64_tr_b16 v[104:105], v80 offset:6144
    ds_read_b64_tr_b16 v[106:107], v80 offset:7168
    buffer_load_dwordx4 v[160:163], v14, s[40:43], s30 offen offset:0 sc1
    s_add_u32 s76, s76, 3
    s_and_b32 s76, s76, 15
    s_lshl_b32 s6, s76, 13
    v_mfma_f32_32x32x16_bf16 v[32:47], v[116:119], v[132:135], v[32:47]
    ds_read_b64_tr_b16 v[108:109], v81 offset:6144
    ds_read_b64_tr_b16 v[110:111], v81 offset:7168
    buffer_load_dwordx4 v[164:167], v14, s[40:43], s30 offen offset:2048 sc1
    v_add_u32 v82, s5, v72
    v_add_u32_e64 v83, s5, v73
    s_waitcnt vmcnt(7) lgkmcnt(4)
    v_mfma_f32_32x32x16_bf16 v[16:31], v[120:123], v[136:139], v[16:31]
    ds_read_b64_tr_b16 v[112:113], v82 offset:0
    ds_read_b64_tr_b16 v[114:115], v82 offset:1024
    buffer_load_dwordx4 v[168:171], v78, s[40:43], s30 offen offset:0 sc1
    v_mfma_f32_32x32x16_bf16 v[32:47], v[124:127], v[136:139], v[32:47]
    ds_read_b64_tr_b16 v[116:117], v83 offset:0
    ds_read_b64_tr_b16 v[118:119], v83 offset:1024
    buffer_load_dwordx4 v[172:175], v78, s[40:43], s30 offen offset:2048 sc1
    v_readfirstlane_b32 s76, v79
    s_nop 0
    s_and_b32 s76, s76, s52
    s_cbranch_scc0 L_tr3
L_bk3:
    s_ff1_i32_b32 s76, s76
    s_bitset0_b32 s52, s76
    s_add_u32 s77, s76, s65
    s_and_b32 s77, s77, 15
    s_mul_i32 s77, s77, 32768
    s_add_u32 s31, s77, s80
    s_waitcnt vmcnt(8) lgkmcnt(4)
    v_mfma_f32_32x32x16_bf16 v[16:31], v[104:107], v[140:143], v[16:31]
    ds_read_b32 v79, v8 offset:25984
    ds_read_b64_tr_b16 v[120:121], v82 offset:2048
    ds_read_b64_tr_b16 v[122:123], v82 offset:3072
    buffer_load_dwordx4 v[176:179], v14, s[40:43], s31 offen offset:0 sc1
    s_add_u32 s76, s76, 3
    s_and_b32 s76, s76, 15
    s_lshl_b32 s7, s76, 13
    v_mfma_f32_32x32x16_bf16 v[32:47], v[108:111], v[140:143], v[32:47]
    ds_read_b64_tr_b16 v[124:125], v83 offset:2048
    ds_read_b64_tr_b16 v[126:127], v83 offset:3072
    buffer_load_dwordx4 v[180:183], v14, s[40:43], s31 offen offset:2048 sc1
    s_waitcnt vmcnt(9) lgkmcnt(4)
    v_mfma_f32_32x32x16_bf16 v[16:31], v[112:115], v[144:147], v[16:31]
    ds_read_b64_tr_b16 v[104:105], v82 offset:4096
    ds_read_b64_tr_b16 v[106:107], v82 offset:5120
    buffer_load_dwordx4 v[184:187], v78, s[40:43], s31 offen offset:0 sc1
    v_mfma_f32_32x32x16_bf16 v[32:47], v[116:119], v[144:147], v[32:47]
    ds_read_b64_tr_b16 v[108:109], v83 offset:4096
    ds_read_b64_tr_b16 v[110:111], v83 offset:5120
    buffer_load_dwordx4 v[188:191], v78, s[40:43], s31 offen offset:2048 sc1
    v_readfirstlane_b32 s76, v79
    s_nop 0
    s_and_b32 s76, s76, s52
    s_cbranch_scc0 L_tr4
L_bk4:
    s_ff1_i32_b32 s76, s76
    s_bitset0_b32 s52, s76
    s_add_u32 s77, s76, s65
    s_and_b32 s77, s77, 15
    s_mul_i32 s77, s77, 32768
    s_add_u32 s32, s77, s80
    s_waitcnt vmcnt(10) lgkmcnt(4)
    v_mfma_f32_32x32x16_bf16 v[16:31], v[120:123], v[148:151], v[16:31]
    ds_read_b64_tr_b16 v[112:113], v82 offset:6144
    ds_read_b64_tr_b16 v[114:115], v82 offset:7168
    buffer_load_dwordx4 v[128:131], v14, s[40:43], s32 offen offset:0 sc1
    s_add_u32 s76, s76, 3
    s_and_b32 s76, s76, 15
    s_lshl_b32 s8, s76, 13
    v_mfma_f32_32x32x16_bf16 v[32:47], v[124:127], v[148:151], v[32:47]
    ds_read_b64_tr_b16 v[116:117], v83 offset:6144
    ds_read_b64_tr_b16 v[118:119], v83 offset:7168
    buffer_load_dwordx4 v[132:135], v14, s[40:43], s32 offen offset:2048 sc1
    v_add_u32 v80, s6, v72
    v_add_u32 v81, s6, v73
    s_waitcnt vmcnt(11) lgkmcnt(4)
    v_mfma_f32_32x32x16_bf16 v[16:31], v[104:107], v[152:155], v[16:31]
    ds_read_b32 v79, v8 offset:25984
    ds_read_b64_tr_b16 v[120:121], v80 offset:0
    ds_read_b64_tr_b16 v[122:123], v80 offset:1024
    buffer_load_dwordx4 v[136:139], v78, s[40:43], s32 offen offset:0 sc1
    v_mfma_f32_32x32x16_bf16 v[32:47], v[108:111], v[152:155], v[32:47]
    ds_read_b64_tr_b16 v[124:125], v81 offset:0
    ds_read_b64_tr_b16 v[126:127], v81 offset:1024
    s_waitcnt vmcnt(11) lgkmcnt(4)
    v_mfma_f32_32x32x16_bf16 v[16:31], v[112:115], v[156:159], v[16:31]
    ds_read_b64_tr_b16 v[104:105], v80 offset:2048
    ds_read_b64_tr_b16 v[106:107], v80 offset:3072
    buffer_load_dwordx4 v[140:143], v78, s[40:43], s32 offen offset:2048 sc1
    v_mfma_f32_32x32x16_bf16 v[32:47], v[116:119], v[156:159], v[32:47]
    ds_read_b64_tr_b16 v[108:109], v81 offset:2048
    ds_read_b64_tr_b16 v[110:111], v81 offset:3072
    v_readfirstlane_b32 s76, v79
    s_nop 0
    s_and_b32 s76, s76, s52
    s_cbranch_scc0 L_tr5
L_bk5:
    s_ff1_i32_b32 s76, s76
    s_bitset0_b32 s52, s76
    s_add_u32 s77, s76, s65
    s_and_b32 s77, s77, 15
    s_mul_i32 s77, s77, 32768
    s_add_u32 s33, s77, s80
    s_waitcnt vmcnt(11) lgkmcnt(4)
    v_mfma_f32_32x32x16_bf16 v[16:31], v[120:123], v[160:163], v[16:31]
    ds_read_b64_tr_b16 v[112:113], v80 offset:4096
    ds_read_b64_tr_b16 v[114:115], v80 offset:5120
    buffer_load_dwordx4 v[144:147], v14, s[40:43], s33 offen offset:0 sc1
    s_add_u32 s76, s76, 3
    s_and_b32 s76, s76, 15
    s_lshl_b32 s9, s76, 13
    v_mfma_f32_32x32x16_bf16 v[32:47], v[124:127], v[160:163], v[32:47]
    ds_read_b64_tr_b16 v[116:117], v81 offset:4096
    ds_read_b64_tr_b16 v[118:119], v81 offset:5120
    s_waitcnt vmcnt(11) lgkmcnt(4)
    v_mfma_f32_32x32x16_bf16 v[16:31], v[104:107], v[164:167], v[16:31]
    ds_read_b64_tr_b16 v[120:121], v80 offset:6144
    ds_read_b64_tr_b16 v[122:123], v80 offset:7168
    buffer_load_dwordx4 v[148:151], v14, s[40:43], s33 offen offset:2048 sc1
    v_mfma_f32_32x32x16_bf16 v[32:47], v[108:111], v[164:167], v[32:47]
    ds_read_b64_tr_b16 v[124:125], v81 offset:6144
    ds_read_b64_tr_b16 v[126:127], v81 offset:7168
    v_add_u32 v82, s7, v72
    v_add_u32 v83, s7, v73
    s_waitcnt vmcnt(11) lgkmcnt(4)
    v_mfma_f32_32x32x16_bf16 v[16:31], v[112:115], v[168:171], v[16:31]
    ds_read_b32 v79, v8 offset:25984
    ds_read_b64_tr_b16 v[104:105], v82 offset:0
    ds_read_b64_tr_b16 v[106:107], v82 offset:1024
    buffer_load_dwordx4 v[152:155], v78, s[40:43], s33 offen offset:0 sc1
    v_mfma_f32_32x32x16_bf16 v[32:47], v[116:119], v[168:171], v[32:47]
    ds_read_b64_tr_b16 v[108:109], v83 offset:0
    ds_read_b64_tr_b16 v[110:111], v83 offset:1024
    s_waitcnt vmcnt(11) lgkmcnt(4)
    v_mfma_f32_32x32x16_bf16 v[16:31], v[120:123], v[172:175], v[16:31]
    ds_read_b64_tr_b16 v[112:113], v82 offset:2048
    ds_read_b64_tr_b16 v[114:115], v82 offset:3072
    buffer_load_dwordx4 v[156:159], v78, s[40:43], s33 offen offset:2048 sc1
    v_mfma_f32_32x32x16_bf16 v[32:47], v[124:127], v[172:175], v[32:47]
    ds_read_b64_tr_b16 v[116:117], v83 offset:2048
    ds_read_b64_tr_b16 v[118:119], v83 offset:3072
    v_readfirstlane_b32 s76, v79
    s_nop 0
    s_and_b32 s76, s76, s52
    s_cbranch_scc0 L_tr6
L_bk6:
    s_ff1_i32_b32 s76, s76
    s_bitset0_b32 s52, s76
    s_add_u32 s77, s76, s65
    s_and_b32 s77, s77, 15
    s_mul_i32 s77, s77, 32768
    s_add_u32 s34, s77, s80
    s_waitcnt vmcnt(11) lgkmcnt(4)
    v_mfma_f32_32x32x16_bf16 v[16:31], v[104:107], v[176:179], v[16:31]
    ds_read_b64_tr_b16 v[120:121], v82 offset:4096
    ds_read_b64_tr_b16 v[122:123], v82 offset:5120
    buffer_load_dwordx4 v[160:163], v14, s[40:43], s34 offen offset:0 sc1
    s_add_u32 s76, s76, 3
    s_and_b32 s76, s76, 15
    s_lshl_b32 s10, s76, 13
    v_mfma_f32_32x32x16_bf16 v[32:47], v[108:111], v[176:179], v[32:47]
    ds_read_b64_tr_b16 v[124:125], v83 offset:4096
    ds_read_b64_tr_b16 v[126:127], v83 offset:5120
    s_waitcnt vmcnt(11) lgkmcnt(4)
    v_mfma_f32_32x32x16_bf16 v[16:31], v[112:115], v[180:183], v[16:31]
    ds_read_b64_tr_b16 v[104:105], v82 offset:6144
    ds_read_b64_tr_b16 v[106:107], v82 offset:7168
    buffer_load_dwordx4 v[164:167], v14, s[40:43], s34 offen offset:2048 sc1
    v_mfma_f32_32x32x16_bf16 v[32:47], v[116:119], v[180:183], v[32:47]
    ds_read_b64_tr_b16 v[108:109], v83 offset:6144
    ds_read_b64_tr_b16 v[110:111], v83 offset:7168
    v_add_u32 v80, s8, v72
    v_add_u32 v81, s8, v73
    s_waitcnt vmcnt(11) lgkmcnt(4)
    v_mfma_f32_32x32x16_bf16 v[16:31], v[120:123], v[184:187], v[16:31]
    ds_read_b32 v79, v8 offset:25984
    ds_read_b64_tr_b16 v[112:113], v80 offset:0
    ds_read_b64_tr_b16 v[114:115], v80 offset:1024
    buffer_load_dwordx4 v[168:171], v78, s[40:43], s34 offen offset:0 sc1
    v_mfma_f32_32x32x16_bf16 v[32:47], v[124:127], v[184:187], v[32:47]
    ds_read_b64_tr_b16 v[116:117], v81 offset:0
    ds_read_b64_tr_b16 v[118:119], v81 offset:1024
    s_waitcnt vmcnt(11) lgkmcnt(4)
    v_mfma_f32_32x32x16_bf16 v[16:31], v[104:107], v[188:191], v[16:31]
    ds_read_b64_tr_b16 v[120:121], v80 offset:2048
    ds_read_b64_tr_b16 v[122:123], v80 offset:3072
    buffer_load_dwordx4 v[172:175], v78, s[40:43], s34 offen offset:2048 sc1
    v_mfma_f32_32x32x16_bf16 v[32:47], v[108:111], v[188:191], v[32:47]
    ds_read_b64_tr_b16 v[124:125], v81 offset:2048
    ds_read_b64_tr_b16 v[126:127], v81 offset:3072
    v_readfirstlane_b32 s76, v79
    s_nop 0
    s_and_b32 s76, s76, s52
    s_cbranch_scc0 L_tr7
L_bk7:
    s_ff1_i32_b32 s76, s76
    s_bitset0_b32 s52, s76
    s_add_u32 s77, s76, s65
    s_and_b32 s77, s77, 15
    s_mul_i32 s77, s77, 32768
    s_add_u32 s35, s77, s80
    s_waitcnt vmcnt(11) lgkmcnt(4)
    v_mfma_f32_32x32x16_bf16 v[16:31], v[112:115], v[128:131], v[16:31]
    ds_read_b64_tr_b16 v[104:105], v80 offset:4096
    ds_read_b64_tr_b16 v[106:107], v80 offset:5120
    buffer_load_dwordx4 v[176:179], v14, s[40:43], s35 offen offset:0 sc1
    s_add_u32 s76, s76, 3
    s_and_b32 s76, s76, 15
    s_lshl_b32 s11, s76, 13
    v_mfma_f32_32x32x16_bf16 v[32:47], v[116:119], v[128:131], v[32:47]
    ds_read_b64_tr_b16 v[108:109], v81 offset:4096
    ds_read_b64_tr_b16 v[110:111], v81 offset:5120
    s_waitcnt vmcnt(11) lgkmcnt(4)
    v_mfma_f32_32x32x16_bf16 v[16:31], v[120:123], v[132:135], v[16:31]
    ds_read_b64_tr_b16 v[112:113], v80 offset:6144
    ds_read_b64_tr_b16 v[114:115], v80 offset:7168
    buffer_load_dwordx4 v[180:183], v14, s[40:43], s35 offen offset:2048 sc1
    v_mfma_f32_32x32x16_bf16 v[32:47], v[124:127], v[132:135], v[32:47]
    ds_read_b64_tr_b16 v[116:117], v81 offset:6144
    ds_read_b64_tr_b16 v[118:119], v81 offset:7168
    v_add_u32 v82, s9, v72
    v_add_u32 v83, s9, v73
    s_waitcnt vmcnt(11) lgkmcnt(4)
    v_mfma_f32_32x32x16_bf16 v[16:31], v[104:107], v[136:139], v[16:31]
    ds_read_b32 v79, v8 offset:25984
    ds_read_b64_tr_b16 v[120:121], v82 offset:0
    ds_read_b64_tr_b16 v[122:123], v82 offset:1024
    buffer_load_dwordx4 v[184:187], v78, s[40:43], s35 offen offset:0 sc1
    v_mfma_f32_32x32x16_bf16 v[32:47], v[108:111], v[136:139], v[32:47]
    ds_read_b64_tr_b16 v[124:125], v83 offset:0
    ds_read_b64_tr_b16 v[126:127], v83 offset:1024
    s_waitcnt vmcnt(11) lgkmcnt(4)
    v_mfma_f32_32x32x16_bf16 v[16:31], v[112:115], v[140:143], v[16:31]
    ds_read_b64_tr_b16 v[104:105], v82 offset:2048
    ds_read_b64_tr_b16 v[106:107], v82 offset:3072
    buffer_load_dwordx4 v[188:191], v78, s[40:43], s35 offen offset:2048 sc1
    v_mfma_f32_32x32x16_bf16 v[32:47], v[116:119], v[140:143], v[32:47]
    ds_read_b64_tr_b16 v[108:109], v83 offset:2048
    ds_read_b64_tr_b16 v[110:111], v83 offset:3072
    v_readfirstlane_b32 s76, v79
    s_nop 0
    s_and_b32 s76, s76, s52
    s_cbranch_scc0 L_tr8
L_bk8:
    s_ff1_i32_b32 s76, s76
    s_bitset0_b32 s52, s76
    s_add_u32 s77, s76, s65
    s_and_b32 s77, s77, 15
    s_mul_i32 s77, s77, 32768
    s_add_u32 s36, s77, s80
    s_waitcnt vmcnt(11) lgkmcnt(4)
    v_mfma_f32_32x32x16_bf16 v[16:31], v[120:123], v[144:147], v[16:31]
    ds_read_b64_tr_b16 v[112:113], v82 offset:4096
    ds_read_b64_tr_b16 v[114:115], v82 offset:5120
    buffer_load_dwordx4 v[128:131], v14, s[40:43], s36 offen offset:0 sc1
    s_add_u32 s76, s76, 3
    s_and_b32 s76, s76, 15
    s_lshl_b32 s12, s76, 13
    v_mfma_f32_32x32x16_bf16 v[32:47], v[124:127], v[144:147], v[32:47]
    ds_read_b64_tr_b16 v[116:117], v83 offset:4096
    ds_read_b64_tr_b16 v[118:119], v83 offset:5120
    s_waitcnt vmcnt(11) lgkmcnt(4)
    v_mfma_f32_32x32x16_bf16 v[16:31], v[104:107], v[148:151], v[16:31]
    ds_read_b64_tr_b16 v[120:121], v82 offset:6144
    ds_read_b64_tr_b16 v[122:123], v82 offset:7168
    buffer_load_dwordx4 v[132:135], v14, s[40:43], s36 offen offset:2048 sc1
    v_mfma_f32_32x32x16_bf16 v[32:47], v[108:111], v[148:151], v[32:47]
    ds_read_b64_tr_b16 v[124:125], v83 offset:6144
    ds_read_b64_tr_b16 v[126:127], v83 offset:7168
    v_add_u32 v80, s10, v72
    v_add_u32 v81, s10, v73
    s_waitcnt vmcnt(11) lgkmcnt(4)
    v_mfma_f32_32x32x16_bf16 v[16:31], v[112:115], v[152:155], v[16:31]
    ds_read_b32 v79, v8 offset:25984
    ds_read_b64_tr_b16 v[104:105], v80 offset:0
    ds_read_b64_tr_b16 v[106:107], v80 offset:1024
    buffer_load_dwordx4 v[136:139], v78, s[40:43], s36 offen offset:0 sc1
    v_mfma_f32_32x32x16_bf16 v[32:47], v[116:119], v[152:155], v[32:47]
    ds_read_b64_tr_b16 v[108:109], v81 offset:0
    ds_read_b64_tr_b16 v[110:111], v81 offset:1024
    s_waitcnt vmcnt(11) lgkmcnt(4)
    v_mfma_f32_32x32x16_bf16 v[16:31], v[120:123], v[156:159], v[16:31]
    ds_read_b64_tr_b16 v[112:113], v80 offset:2048
    ds_read_b64_tr_b16 v[114:115], v80 offset:3072
    buffer_load_dwordx4 v[140:143], v78, s[40:43], s36 offen offset:2048 sc1
    v_mfma_f32_32x32x16_bf16 v[32:47], v[124:127], v[156:159], v[32:47]
    ds_read_b64_tr_b16 v[116:117], v81 offset:2048
    ds_read_b64_tr_b16 v[118:119], v81 offset:3072
    v_readfirstlane_b32 s76, v79
    s_nop 0
    s_and_b32 s76, s76, s52
    s_cbranch_scc0 L_tr9
L_bk9:
    s_ff1_i32_b32 s76, s76
    s_bitset0_b32 s52, s76
    s_add_u32 s77, s76, s65
    s_and_b32 s77, s77, 15
    s_mul_i32 s77, s77, 32768
    s_add_u32 s37, s77, s80
    s_waitcnt vmcnt(11) lgkmcnt(4)
    v_mfma_f32_32x32x16_bf16 v[16:31], v[104:107], v[160:163], v[16:31]
    ds_read_b64_tr_b16 v[120:121], v80 offset:4096
    ds_read_b64_tr_b16 v[122:123], v80 offset:5120
    buffer_load_dwordx4 v[144:147], v14, s[40:43], s37 offen offset:0 sc1
    s_add_u32 s76, s76, 3
    s_and_b32 s76, s76, 15
    s_lshl_b32 s13, s76, 13
    v_mfma_f32_32x32x16_bf16 v[32:47], v[108:111], v[160:163], v[32:47]
    ds_read_b64_tr_b16 v[124:125], v81 offset:4096
    ds_read_b64_tr_b16 v[126:127], v81 offset:5120
    s_waitcnt vmcnt(11) lgkmcnt(4)
    v_mfma_f32_32x32x16_bf16 v[16:31], v[112:115], v[164:167], v[16:31]
    ds_read_b64_tr_b16 v[104:105], v80 offset:6144
    ds_read_b64_tr_b16 v[106:107], v80 offset:7168
    buffer_load_dwordx4 v[148:151], v14, s[40:43], s37 offen offset:2048 sc1
    v_mfma_f32_32x32x16_bf16 v[32:47], v[116:119], v[164:167], v[32:47]
    ds_read_b64_tr_b16 v[108:109], v81 offset:6144
    ds_read_b64_tr_b16 v[110:111], v81 offset:7168
    v_add_u32 v82, s11, v72
    v_add_u32 v83, s11, v73
    s_waitcnt vmcnt(11) lgkmcnt(4)
    v_mfma_f32_32x32x16_bf16 v[16:31], v[120:123], v[168:171], v[16:31]
    ds_read_b32 v79, v8 offset:25984
    ds_read_b64_tr_b16 v[112:113], v82 offset:0
    ds_read_b64_tr_b16 v[114:115], v82 offset:1024
    buffer_load_dwordx4 v[152:155], v78, s[40:43], s37 offen offset:0 sc1
    v_mfma_f32_32x32x16_bf16 v[32:47], v[124:127], v[168:171], v[32:47]
    ds_read_b64_tr_b16 v[116:117], v83 offset:0
    ds_read_b64_tr_b16 v[118:119], v83 offset:1024
    s_waitcnt vmcnt(11) lgkmcnt(4)
    v_mfma_f32_32x32x16_bf16 v[16:31], v[104:107], v[172:175], v[16:31]
    ds_read_b64_tr_b16 v[120:121], v82 offset:2048
    ds_read_b64_tr_b16 v[122:123], v82 offset:3072
    buffer_load_dwordx4 v[156:159], v78, s[40:43], s37 offen offset:2048 sc1
    v_mfma_f32_32x32x16_bf16 v[32:47], v[108:111], v[172:175], v[32:47]
    ds_read_b64_tr_b16 v[124:125], v83 offset:2048
    ds_read_b64_tr_b16 v[126:127], v83 offset:3072
    v_readfirstlane_b32 s76, v79
    s_nop 0
    s_and_b32 s76, s76, s52
    s_cbranch_scc0 L_tr10
L_bk10:
    s_ff1_i32_b32 s76, s76
    s_bitset0_b32 s52, s76
    s_add_u32 s77, s76, s65
    s_and_b32 s77, s77, 15
    s_mul_i32 s77, s77, 32768
    s_add_u32 s38, s77, s80
    s_waitcnt vmcnt(11) lgkmcnt(4)
    v_mfma_f32_32x32x16_bf16 v[16:31], v[112:115], v[176:179], v[16:31]
    ds_read_b64_tr_b16 v[104:105], v82 offset:4096
    ds_read_b64_tr_b16 v[106:107], v82 offset:5120
    buffer_load_dwordx4 v[160:163], v14, s[40:43], s38 offen offset:0 sc1
    s_add_u32 s76, s76, 3
    s_and_b32 s76, s76, 15
    s_lshl_b32 s14, s76, 13
    v_mfma_f32_32x32x16_bf16 v[32:47], v[116:119], v[176:179], v[32:47]
    ds_read_b64_tr_b16 v[108:109], v83 offset:4096
    ds_read_b64_tr_b16 v[110:111], v83 offset:5120
    s_waitcnt vmcnt(11) lgkmcnt(4)
    v_mfma_f32_32x32x16_bf16 v[16:31], v[120:123], v[180:183], v[16:31]
    ds_read_b64_tr_b16 v[112:113], v82 offset:6144
    ds_read_b64_tr_b16 v[114:115], v82 offset:7168
    buffer_load_dwordx4 v[164:167], v14, s[40:43], s38 offen offset:2048 sc1
    v_mfma_f32_32x32x16_bf16 v[32:47], v[124:127], v[180:183], v[32:47]
    ds_read_b64_tr_b16 v[116:117], v83 offset:6144
    ds_read_b64_tr_b16 v[118:119], v83 offset:7168
    v_add_u32 v80, s12, v72
    v_add_u32 v81, s12, v73
    s_waitcnt vmcnt(11) lgkmcnt(4)
    v_mfma_f32_32x32x16_bf16 v[16:31], v[104:107], v[184:187], v[16:31]
    ds_read_b32 v79, v8 offset:25984
    ds_read_b64_tr_b16 v[120:121], v80 offset:0
    ds_read_b64_tr_b16 v[122:123], v80 offset:1024
    buffer_load_dwordx4 v[168:171], v78, s[40:43], s38 offen offset:0 sc1
    v_mfma_f32_32x32x16_bf16 v[32:47], v[108:111], v[184:187], v[32:47]
    ds_read_b64_tr_b16 v[124:125], v81 offset:0
    ds_read_b64_tr_b16 v[126:127], v81 offset:1024
    s_waitcnt vmcnt(11) lgkmcnt(4)
    v_mfma_f32_32x32x16_bf16 v[16:31], v[112:115], v[188:191], v[16:31]
    ds_read_b64_tr_b16 v[104:105], v80 offset:2048
    ds_read_b64_tr_b16 v[106:107], v80 offset:3072
    buffer_load_dwordx4 v[172:175], v78, s[40:43], s38 offen offset:2048 sc1
    v_mfma_f32_32x32x16_bf16 v[32:47], v[116:119], v[188:191], v[32:47]
    ds_read_b64_tr_b16 v[108:109], v81 offset:2048
    ds_read_b64_tr_b16 v[110:111], v81 offset:3072
    v_readfirstlane_b32 s76, v79
    s_nop 0
    s_and_b32 s76, s76, s52
    s_cbranch_scc0 L_tr11
L_bk11:
    s_ff1_i32_b32 s76, s76
    s_bitset0_b32 s52, s76
    s_add_u32 s77, s76, s65
    s_and_b32 s77, s77, 15
    s_mul_i32 s77, s77, 32768
    s_add_u32 s39, s77, s80
    s_waitcnt vmcnt(11) lgkmcnt(4)
    v_mfma_f32_32x32x16_bf16 v[16:31], v[120:123], v[128:131], v[16:31]
    ds_read_b64_tr_b16 v[112:113], v80 offset:4096
    ds_read_b64_tr_b16 v[114:115], v80 offset:5120
    buffer_load_dwordx4 v[176:179], v14, s[40:43], s39 offen offset:0 sc1
    s_add_u32 s76, s76, 3
    s_and_b32 s76, s76, 15
    s_lshl_b32 s15, s76, 13
    v_mfma_f32_32x32x16_bf16 v[32:47], v[124:127], v[128:131], v[32:47]
    ds_read_b64_tr_b16 v[116:117], v81 offset:4096
    ds_read_b64_tr_b16 v[118:119], v81 offset:5120
    s_waitcnt vmcnt(11) lgkmcnt(4)
    v_mfma_f32_32x32x16_bf16 v[16:31], v[104:107], v[132:135], v[16:31]
    ds_read_b64_tr_b16 v[120:121], v80 offset:6144
    ds_read_b64_tr_b16 v[122:123], v80 offset:7168
    buffer_load_dwordx4 v[180:183], v14, s[40:43], s39 offen offset:2048 sc1
    v_mfma_f32_32x32x16_bf16 v[32:47], v[108:111], v[132:135], v[32:47]
    ds_read_b64_tr_b16 v[124:125], v81 offset:6144
    ds_read_b64_tr_b16 v[126:127], v81 offset:7168
    v_add_u32 v82, s13, v72
    v_add_u32 v83, s13, v73
    s_waitcnt vmcnt(11) lgkmcnt(4)
    v_mfma_f32_32x32x16_bf16 v[16:31], v[112:115], v[136:139], v[16:31]
    ds_read_b32 v79, v8 offset:25984
    ds_read_b64_tr_b16 v[104:105], v82 offset:0
    ds_read_b64_tr_b16 v[106:107], v82 offset:1024
    buffer_load_dwordx4 v[184:187], v78, s[40:43], s39 offen offset:0 sc1
    v_mfma_f32_32x32x16_bf16 v[32:47], v[116:119], v[136:139], v[32:47]
    ds_read_b64_tr_b16 v[108:109], v83 offset:0
    ds_read_b64_tr_b16 v[110:111], v83 offset:1024
    s_waitcnt vmcnt(11) lgkmcnt(4)
    v_mfma_f32_32x32x16_bf16 v[16:31], v[120:123], v[140:143], v[16:31]
    ds_read_b64_tr_b16 v[112:113], v82 offset:2048
    ds_read_b64_tr_b16 v[114:115], v82 offset:3072
    buffer_load_dwordx4 v[188:191], v78, s[40:43], s39 offen offset:2048 sc1
    v_mfma_f32_32x32x16_bf16 v[32:47], v[124:127], v[140:143], v[32:47]
    ds_read_b64_tr_b16 v[116:117], v83 offset:2048
    ds_read_b64_tr_b16 v[118:119], v83 offset:3072
    v_readfirstlane_b32 s76, v79
    s_nop 0
    s_and_b32 s76, s76, s52
    s_cbranch_scc0 L_tr12
L_bk12:
    s_ff1_i32_b32 s76, s76
    s_bitset0_b32 s52, s76
    s_add_u32 s77, s76, s65
    s_and_b32 s77, s77, 15
    s_mul_i32 s77, s77, 32768
    s_add_u32 s48, s77, s80
    s_waitcnt vmcnt(11) lgkmcnt(4)
    v_mfma_f32_32x32x16_bf16 v[16:31], v[104:107], v[144:147], v[16:31]
    ds_read_b64_tr_b16 v[120:121], v82 offset:4096
    ds_read_b64_tr_b16 v[122:123], v82 offset:5120
    buffer_load_dwordx4 v[128:131], v14, s[40:43], s48 offen offset:0 sc1
    s_add_u32 s76, s76, 3
    s_and_b32 s76, s76, 15
    s_lshl_b32 s16, s76, 13
    v_mfma_f32_32x32x16_bf16 v[32:47], v[108:111], v[144:147], v[32:47]
    ds_read_b64_tr_b16 v[124:125], v83 offset:4096
    ds_read_b64_tr_b16 v[126:127], v83 offset:5120
    s_waitcnt vmcnt(11) lgkmcnt(4)
    v_mfma_f32_32x32x16_bf16 v[16:31], v[112:115], v[148:151], v[16:31]
    ds_read_b64_tr_b16 v[104:105], v82 offset:6144
    ds_read_b64_tr_b16 v[106:107], v82 offset:7168
    buffer_load_dwordx4 v[132:135], v14, s[40:43], s48 offen offset:2048 sc1
    v_mfma_f32_32x32x16_bf16 v[32:47], v[116:119], v[148:151], v[32:47]
    ds_read_b64_tr_b16 v[108:109], v83 offset:6144
    ds_read_b64_tr_b16 v[110:111], v83 offset:7168
    v_add_u32 v80, s14, v72
    v_add_u32 v81, s14, v73
    s_waitcnt vmcnt(11) lgkmcnt(4)
    v_mfma_f32_32x32x16_bf16 v[16:31], v[120:123], v[152:155], v[16:31]
    ds_read_b32 v79, v8 offset:25984
    ds_read_b64_tr_b16 v[112:113], v80 offset:0
    ds_read_b64_tr_b16 v[114:115], v80 offset:1024
    buffer_load_dwordx4 v[136:139], v78, s[40:43], s48 offen offset:0 sc1
    v_mfma_f32_32x32x16_bf16 v[32:47], v[124:127], v[152:155], v[32:47]
    ds_read_b64_tr_b16 v[116:117], v81 offset:0
    ds_read_b64_tr_b16 v[118:119], v81 offset:1024
    s_waitcnt vmcnt(11) lgkmcnt(4)
    v_mfma_f32_32x32x16_bf16 v[16:31], v[104:107], v[156:159], v[16:31]
    ds_read_b64_tr_b16 v[120:121], v80 offset:2048
    ds_read_b64_tr_b16 v[122:123], v80 offset:3072
    buffer_load_dwordx4 v[140:143], v78, s[40:43], s48 offen offset:2048 sc1
    v_mfma_f32_32x32x16_bf16 v[32:47], v[108:111], v[156:159], v[32:47]
    ds_read_b64_tr_b16 v[124:125], v81 offset:2048
    ds_read_b64_tr_b16 v[126:127], v81 offset:3072
    v_readfirstlane_b32 s76, v79
    s_nop 0
    s_and_b32 s76, s76, s52
    s_cbranch_scc0 L_tr13
L_bk13:
    s_ff1_i32_b32 s76, s76
    s_bitset0_b32 s52, s76
    s_add_u32 s77, s76, s65
    s_and_b32 s77, s77, 15
    s_mul_i32 s77, s77, 32768
    s_add_u32 s49, s77, s80
    s_waitcnt vmcnt(11) lgkmcnt(4)
    v_mfma_f32_32x32x16_bf16 v[16:31], v[112:115], v[160:163], v[16:31]
    ds_read_b64_tr_b16 v[104:105], v80 offset:4096
    ds_read_b64_tr_b16 v[106:107], v80 offset:5120
    buffer_load_dwordx4 v[144:147], v14, s[40:43], s49 offen offset:0 sc1
    s_add_u32 s76, s76, 3
    s_and_b32 s76, s76, 15
    s_lshl_b32 s17, s76, 13
    v_mfma_f32_32x32x16_bf16 v[32:47], v[116:119], v[160:163], v[32:47]
    ds_read_b64_tr_b16 v[108:109], v81 offset:4096
    ds_read_b64_tr_b16 v[110:111], v81 offset:5120
    s_waitcnt vmcnt(11) lgkmcnt(4)
    v_mfma_f32_32x32x16_bf16 v[16:31], v[120:123], v[164:167], v[16:31]
    ds_read_b64_tr_b16 v[112:113], v80 offset:6144
    ds_read_b64_tr_b16 v[114:115], v80 offset:7168
    buffer_load_dwordx4 v[148:151], v14, s[40:43], s49 offen offset:2048 sc1
    v_mfma_f32_32x32x16_bf16 v[32:47], v[124:127], v[164:167], v[32:47]
    ds_read_b64_tr_b16 v[116:117], v81 offset:6144
    ds_read_b64_tr_b16 v[118:119], v81 offset:7168
    v_add_u32 v82, s15, v72
    v_add_u32 v83, s15, v73
    s_waitcnt vmcnt(11) lgkmcnt(4)
    v_mfma_f32_32x32x16_bf16 v[16:31], v[104:107], v[168:171], v[16:31]
    ds_read_b32 v79, v8 offset:25984
    ds_read_b64_tr_b16 v[120:121], v82 offset:0
    ds_read_b64_tr_b16 v[122:123], v82 offset:1024
    buffer_load_dwordx4 v[152:155], v78, s[40:43], s49 offen offset:0 sc1
    v_mfma_f32_32x32x16_bf16 v[32:47], v[108:111], v[168:171], v[32:47]
    ds_read_b64_tr_b16 v[124:125], v83 offset:0
    ds_read_b64_tr_b16 v[126:127], v83 offset:1024
    s_waitcnt vmcnt(11) lgkmcnt(4)
    v_mfma_f32_32x32x16_bf16 v[16:31], v[112:115], v[172:175], v[16:31]
    ds_read_b64_tr_b16 v[104:105], v82 offset:2048
    ds_read_b64_tr_b16 v[106:107], v82 offset:3072
    buffer_load_dwordx4 v[156:159], v78, s[40:43], s49 offen offset:2048 sc1
    v_mfma_f32_32x32x16_bf16 v[32:47], v[116:119], v[172:175], v[32:47]
    ds_read_b64_tr_b16 v[108:109], v83 offset:2048
    ds_read_b64_tr_b16 v[110:111], v83 offset:3072
    v_readfirstlane_b32 s76, v79
    s_nop 0
    s_and_b32 s76, s76, s52
    s_cbranch_scc0 L_tr14
L_bk14:
    s_ff1_i32_b32 s76, s76
    s_bitset0_b32 s52, s76
    s_add_u32 s77, s76, s65
    s_and_b32 s77, s77, 15
    s_mul_i32 s77, s77, 32768
    s_add_u32 s50, s77, s80
    s_waitcnt vmcnt(11) lgkmcnt(4)
    v_mfma_f32_32x32x16_bf16 v[16:31], v[120:123], v[176:179], v[16:31]
    ds_read_b64_tr_b16 v[112:113], v82 offset:4096
    ds_read_b64_tr_b16 v[114:115], v82 offset:5120
    buffer_load_dwordx4 v[160:163], v14, s[40:43], s50 offen offset:0 sc1
    s_add_u32 s76, s76, 3
    s_and_b32 s76, s76, 15
    s_lshl_b32 s18, s76, 13
    v_mfma_f32_32x32x16_bf16 v[32:47], v[124:127], v[176:179], v[32:47]
    ds_read_b64_tr_b16 v[116:117], v83 offset:4096
    ds_read_b64_tr_b16 v[118:119], v83 offset:5120
    s_waitcnt vmcnt(11) lgkmcnt(4)
    v_mfma_f32_32x32x16_bf16 v[16:31], v[104:107], v[180:183], v[16:31]
    ds_read_b64_tr_b16 v[120:121], v82 offset:6144
    ds_read_b64_tr_b16 v[122:123], v82 offset:7168
    buffer_load_dwordx4 v[164:167], v14, s[40:43], s50 offen offset:2048 sc1
    v_mfma_f32_32x32x16_bf16 v[32:47], v[108:111], v[180:183], v[32:47]
    ds_read_b64_tr_b16 v[124:125], v83 offset:6144
    ds_read_b64_tr_b16 v[126:127], v83 offset:7168
    v_add_u32 v80, s16, v72
    v_add_u32 v81, s16, v73
    s_waitcnt vmcnt(11) lgkmcnt(4)
    v_mfma_f32_32x32x16_bf16 v[16:31], v[112:115], v[184:187], v[16:31]
    ds_read_b32 v79, v8 offset:25984
    ds_read_b64_tr_b16 v[104:105], v80 offset:0
    ds_read_b64_tr_b16 v[106:107], v80 offset:1024
    buffer_load_dwordx4 v[168:171], v78, s[40:43], s50 offen offset:0 sc1
    v_mfma_f32_32x32x16_bf16 v[32:47], v[116:119], v[184:187], v[32:47]
    ds_read_b64_tr_b16 v[108:109], v81 offset:0
    ds_read_b64_tr_b16 v[110:111], v81 offset:1024
    s_waitcnt vmcnt(11) lgkmcnt(4)
    v_mfma_f32_32x32x16_bf16 v[16:31], v[120:123], v[188:191], v[16:31]
    ds_read_b64_tr_b16 v[112:113], v80 offset:2048
    ds_read_b64_tr_b16 v[114:115], v80 offset:3072
    buffer_load_dwordx4 v[172:175], v78, s[40:43], s50 offen offset:2048 sc1
    v_mfma_f32_32x32x16_bf16 v[32:47], v[124:127], v[188:191], v[32:47]
    ds_read_b64_tr_b16 v[116:117], v81 offset:2048
    ds_read_b64_tr_b16 v[118:119], v81 offset:3072
    v_readfirstlane_b32 s76, v79
    s_nop 0
    s_and_b32 s76, s76, s52
    s_cbranch_scc0 L_tr15
L_bk15:
    s_ff1_i32_b32 s76, s76
    s_bitset0_b32 s52, s76
    s_add_u32 s77, s76, s65
    s_and_b32 s77, s77, 15
    s_mul_i32 s77, s77, 32768
    s_add_u32 s51, s77, s80
    s_waitcnt vmcnt(11) lgkmcnt(4)
    v_mfma_f32_32x32x16_bf16 v[16:31], v[104:107], v[128:131], v[16:31]
    ds_read_b64_tr_b16 v[120:121], v80 offset:4096
    ds_read_b64_tr_b16 v[122:123], v80 offset:5120
    buffer_load_dwordx4 v[176:179], v14, s[40:43], s51 offen offset:0 sc1
    s_add_u32 s76, s76, 3
    s_and_b32 s76, s76, 15
    s_lshl_b32 s19, s76, 13
    v_mfma_f32_32x32x16_bf16 v[32:47], v[108:111], v[128:131], v[32:47]
    ds_read_b64_tr_b16 v[124:125], v81 offset:4096
    ds_read_b64_tr_b16 v[126:127], v81 offset:5120
    s_waitcnt vmcnt(11) lgkmcnt(4)
    v_mfma_f32_32x32x16_bf16 v[16:31], v[112:115], v[132:135], v[16:31]
    ds_read_b64_tr_b16 v[104:105], v80 offset:6144
    ds_read_b64_tr_b16 v[106:107], v80 offset:7168
    buffer_load_dwordx4 v[180:183], v14, s[40:43], s51 offen offset:2048 sc1
    v_mfma_f32_32x32x16_bf16 v[32:47], v[116:119], v[132:135], v[32:47]
    ds_read_b64_tr_b16 v[108:109], v81 offset:6144
    ds_read_b64_tr_b16 v[110:111], v81 offset:7168
    v_add_u32 v82, s17, v72
    v_add_u32 v83, s17, v73
    s_waitcnt vmcnt(11) lgkmcnt(4)
    v_mfma_f32_32x32x16_bf16 v[16:31], v[120:123], v[136:139], v[16:31]
    ds_read_b64 v[192:193], v10 offset:16384
    ds_read_b64_tr_b16 v[112:113], v82 offset:0
    ds_read_b64_tr_b16 v[114:115], v82 offset:1024
    buffer_load_dwordx4 v[184:187], v78, s[40:43], s51 offen offset:0 sc1
    v_mfma_f32_32x32x16_bf16 v[32:47], v[124:127], v[136:139], v[32:47]
    ds_read_b64_tr_b16 v[116:117], v83 offset:0
    ds_read_b64_tr_b16 v[118:119], v83 offset:1024
    s_waitcnt vmcnt(11) lgkmcnt(4)
    v_mfma_f32_32x32x16_bf16 v[16:31], v[104:107], v[140:143], v[16:31]
    ds_read_b64 v[194:195], v10 offset:16400
    ds_read_b64_tr_b16 v[120:121], v82 offset:2048
    ds_read_b64_tr_b16 v[122:123], v82 offset:3072
    buffer_load_dwordx4 v[188:191], v78, s[40:43], s51 offen offset:2048 sc1
    s_barrier
    v_mfma_f32_32x32x16_bf16 v[32:47], v[108:111], v[140:143], v[32:47]
    ds_read_b64_tr_b16 v[124:125], v83 offset:2048
    ds_read_b64_tr_b16 v[126:127], v83 offset:3072
    s_waitcnt vmcnt(11) lgkmcnt(4)
    v_mfma_f32_32x32x16_bf16 v[16:31], v[112:115], v[144:147], v[16:31]
    ds_read_b64 v[196:197], v10 offset:16416
    ds_read_b64_tr_b16 v[104:105], v82 offset:4096
    ds_read_b64_tr_b16 v[106:107], v82 offset:5120
    v_mfma_f32_32x32x16_bf16 v[32:47], v[116:119], v[144:147], v[32:47]
    ds_read_b64_tr_b16 v[108:109], v83 offset:4096
    ds_read_b64_tr_b16 v[110:111], v83 offset:5120
    s_waitcnt vmcnt(10) lgkmcnt(4)
    v_mfma_f32_32x32x16_bf16 v[16:31], v[120:123], v[148:151], v[16:31]
    ds_read_b64 v[198:199], v10 offset:16432
    ds_read_b64_tr_b16 v[112:113], v82 offset:6144
    ds_read_b64_tr_b16 v[114:115], v82 offset:7168
    v_mfma_f32_32x32x16_bf16 v[32:47], v[124:127], v[148:151], v[32:47]
    ds_read_b64_tr_b16 v[116:117], v83 offset:6144
    ds_read_b64_tr_b16 v[118:119], v83 offset:7168
    v_add_u32 v80, s18, v72
    v_add_u32_e64 v81, s18, v73
    s_waitcnt vmcnt(9) lgkmcnt(4)
    v_mfma_f32_32x32x16_bf16 v[16:31], v[104:107], v[152:155], v[16:31]
    ds_read_b64 v[200:201], v10 offset:16448
    ds_read_b64_tr_b16 v[120:121], v80 offset:0
    ds_read_b64_tr_b16 v[122:123], v80 offset:1024
    v_mfma_f32_32x32x16_bf16 v[32:47], v[108:111], v[152:155], v[32:47]
    ds_read_b64_tr_b16 v[124:125], v81 offset:0
    ds_read_b64_tr_b16 v[126:127], v81 offset:1024
    s_waitcnt vmcnt(8) lgkmcnt(4)
    v_mfma_f32_32x32x16_bf16 v[16:31], v[112:115], v[156:159], v[16:31]
    ds_read_b64 v[202:203], v10 offset:16464
    ds_read_b64_tr_b16 v[104:105], v80 offset:2048
    ds_read_b64_tr_b16 v[106:107], v80 offset:3072
    v_mfma_f32_32x32x16_bf16 v[32:47], v[116:119], v[156:159], v[32:47]
    ds_read_b64_tr_b16 v[108:109], v81 offset:2048
    ds_read_b64_tr_b16 v[110:111], v81 offset:3072
    s_waitcnt vmcnt(7) lgkmcnt(4)
    v_mfma_f32_32x32x16_bf16 v[16:31], v[120:123], v[160:163], v[16:31]
    ds_read_b64 v[204:205], v10 offset:16480
    ds_read_b64_tr_b16 v[112:113], v80 offset:4096
    ds_read_b64_tr_b16 v[114:115], v80 offset:5120
    v_mfma_f32_32x32x16_bf16 v[32:47], v[124:127], v[160:163], v[32:47]
    ds_read_b64_tr_b16 v[116:117], v81 offset:4096
    ds_read_b64_tr_b16 v[118:119], v81 offset:5120
    s_waitcnt vmcnt(6) lgkmcnt(4)
    v_mfma_f32_32x32x16_bf16 v[16:31], v[104:107], v[164:167], v[16:31]
    ds_read_b64 v[206:207], v10 offset:16496
    ds_read_b64_tr_b16 v[120:121], v80 offset:6144
    ds_read_b64_tr_b16 v[122:123], v80 offset:7168
    v_mfma_f32_32x32x16_bf16 v[32:47], v[108:111], v[164:167], v[32:47]
    ds_read_b64_tr_b16 v[124:125], v81 offset:6144
    ds_read_b64_tr_b16 v[126:127], v81 offset:7168
    v_add_u32 v82, s19, v72
    v_add_u32 v83, s19, v73
    s_waitcnt vmcnt(5) lgkmcnt(4)
    v_mfma_f32_32x32x16_bf16 v[16:31], v[112:115], v[168:171], v[16:31]
    ds_read_b128 v[208:211], v11 offset:16384
    ds_read_b64_tr_b16 v[104:105], v82 offset:0
    ds_read_b64_tr_b16 v[106:107], v82 offset:1024
    v_mfma_f32_32x32x16_bf16 v[32:47], v[116:119], v[168:171], v[32:47]
    ds_read_b64_tr_b16 v[108:109], v83 offset:0
    ds_read_b64_tr_b16 v[110:111], v83 offset:1024
    s_waitcnt vmcnt(4) lgkmcnt(4)
    v_mfma_f32_32x32x16_bf16 v[16:31], v[120:123], v[172:175], v[16:31]
    ds_read_b128 v[212:215], v11 offset:16400
    ds_read_b64_tr_b16 v[112:113], v82 offset:2048
    ds_read_b64_tr_b16 v[114:115], v82 offset:3072
    v_mfma_f32_32x32x16_bf16 v[32:47], v[124:127], v[172:175], v[32:47]
    ds_read_b64_tr_b16 v[116:117], v83 offset:2048
    ds_read_b64_tr_b16 v[118:119], v83 offset:3072
    s_waitcnt vmcnt(3) lgkmcnt(4)
    v_mfma_f32_32x32x16_bf16 v[16:31], v[104:107], v[176:179], v[16:31]
    ds_read_b64_tr_b16 v[120:121], v82 offset:4096
    ds_read_b64_tr_b16 v[122:123], v82 offset:5120
    v_mfma_f32_32x32x16_bf16 v[32:47], v[108:111], v[176:179], v[32:47]
    ds_read_b64_tr_b16 v[124:125], v83 offset:4096
    ds_read_b64_tr_b16 v[126:127], v83 offset:5120
    s_waitcnt vmcnt(2) lgkmcnt(4)
    v_mfma_f32_32x32x16_bf16 v[16:31], v[112:115], v[180:183], v[16:31]
    ds_read_b64_tr_b16 v[104:105], v82 offset:6144
    ds_read_b64_tr_b16 v[106:107], v82 offset:7168
    v_mfma_f32_32x32x16_bf16 v[32:47], v[116:119], v[180:183], v[32:47]
    ds_read_b64_tr_b16 v[108:109], v83 offset:6144
    ds_read_b64_tr_b16 v[110:111], v83 offset:7168
    s_waitcnt vmcnt(1) lgkmcnt(4)
    v_mfma_f32_32x32x16_bf16 v[16:31], v[120:123], v[184:187], v[16:31]
    v_mfma_f32_32x32x16_bf16 v[32:47], v[124:127], v[184:187], v[32:47]
    s_waitcnt vmcnt(0) lgkmcnt(0)
    v_mfma_f32_32x32x16_bf16 v[16:31], v[104:107], v[188:191], v[16:31]
    v_mfma_f32_32x32x16_bf16 v[32:47], v[108:111], v[188:191], v[32:47]
    s_nop 10
    v_cvt_pk_bf16_f32 v88, v16, v17
    v_cvt_pk_bf16_f32 v89, v18, v19
    v_cvt_pk_bf16_f32 v90, v20, v21
    v_cvt_pk_bf16_f32 v91, v22, v23
    v_cvt_pk_bf16_f32 v92, v24, v25
    v_cvt_pk_bf16_f32 v93, v26, v27
    v_cvt_pk_bf16_f32 v94, v28, v29
    v_cvt_pk_bf16_f32 v95, v30, v31
    v_cvt_pk_bf16_f32 v96, v32, v33
    v_cvt_pk_bf16_f32 v97, v34, v35
    v_cvt_pk_bf16_f32 v98, v36, v37
    v_cvt_pk_bf16_f32 v99, v38, v39
    v_cvt_pk_bf16_f32 v100, v40, v41
    v_cvt_pk_bf16_f32 v101, v42, v43
    v_cvt_pk_bf16_f32 v102, v44, v45
    v_cvt_pk_bf16_f32 v103, v46, v47
    v_dot2_f32_bf16 v104, v88, s89, 0
    v_dot2_f32_bf16 v105, v88, v88, 0
    v_dot2_f32_bf16 v106, v88, v192, 0
    v_dot2_f32_bf16 v104, v89, s89, v104
    v_dot2_f32_bf16 v105, v89, v89, v105
    v_dot2_f32_bf16 v106, v89, v193, v106
    v_dot2_f32_bf16 v104, v90, s89, v104
    v_dot2_f32_bf16 v105, v90, v90, v105
    v_dot2_f32_bf16 v106, v90, v194, v106
    v_dot2_f32_bf16 v104, v91, s89, v104
    v_dot2_f32_bf16 v105, v91, v91, v105
    v_dot2_f32_bf16 v106, v91, v195, v106
    v_dot2_f32_bf16 v104, v92, s89, v104
    v_dot2_f32_bf16 v105, v92, v92, v105
    v_dot2_f32_bf16 v106, v92, v196, v106
    v_dot2_f32_bf16 v104, v93, s89, v104
    v_dot2_f32_bf16 v105, v93, v93, v105
    v_dot2_f32_bf16 v106, v93, v197, v106
    v_dot2_f32_bf16 v104, v94, s89, v104
    v_dot2_f32_bf16 v105, v94, v94, v105
    v_dot2_f32_bf16 v106, v94, v198, v106
    v_dot2_f32_bf16 v104, v95, s89, v104
    v_dot2_f32_bf16 v105, v95, v95, v105
    v_dot2_f32_bf16 v106, v95, v199, v106
    v_dot2_f32_bf16 v104, v96, s89, v104
    v_dot2_f32_bf16 v105, v96, v96, v105
    v_dot2_f32_bf16 v106, v96, v200, v106
    v_dot2_f32_bf16 v104, v97, s89, v104
    v_dot2_f32_bf16 v105, v97, v97, v105
    v_dot2_f32_bf16 v106, v97, v201, v106
    v_dot2_f32_bf16 v104, v98, s89, v104
    v_dot2_f32_bf16 v105, v98, v98, v105
    v_dot2_f32_bf16 v106, v98, v202, v106
    v_dot2_f32_bf16 v104, v99, s89, v104
    v_dot2_f32_bf16 v105, v99, v99, v105
    v_dot2_f32_bf16 v106, v99, v203, v106
    v_dot2_f32_bf16 v104, v100, s89, v104
    v_dot2_f32_bf16 v105, v100, v100, v105
    v_dot2_f32_bf16 v106, v100, v204, v106
    v_dot2_f32_bf16 v104, v101, s89, v104
    v_dot2_f32_bf16 v105, v101, v101, v105
    v_dot2_f32_bf16 v106, v101, v205, v106
    v_dot2_f32_bf16 v104, v102, s89, v104
    v_dot2_f32_bf16 v105, v102, v102, v105
    v_dot2_f32_bf16 v106, v102, v206, v106
    v_dot2_f32_bf16 v104, v103, s89, v104
    v_dot2_f32_bf16 v105, v103, v103, v105
    v_dot2_f32_bf16 v106, v103, v207, v106
    s_lshl_b32 s76, s62, 9
    s_add_u32 s77, s76, s99
    v_mov_b32 v107, 0
    v_mov_b32 v4, v104
    v_mov_b32 v5, v105
    v_mov_b32 v6, v106
    v_permlane32_swap_b32 v104, v4
    v_permlane32_swap_b32 v105, v5
    v_permlane32_swap_b32 v106, v6
    v_add_f32 v104, v104, v4
    v_add_f32 v105, v105, v5
    v_add_f32_e64 v106, v106, v6
    s_mov_b32 exec_hi, 0
    s_bitcmp1_b32 s100, 1
    s_cbranch_scc1 L_loc_68
    buffer_store_dwordx4 v[104:107], v12, s[40:43], s77 offen offset:1024 sc1
    s_branch L_pubd_69
L_loc_68:
    buffer_store_dwordx4 v[104:107], v12, s[40:43], s77 offen offset:1024
L_pubd_69:
    s_mov_b64 exec, -1
    ds_write_b64 v64, v[88:89]
    ds_write_b64 v65, v[90:91]
    ds_write_b64 v66, v[92:93]
    ds_write_b64 v67, v[94:95]
    ds_write_b64 v68, v[96:97]
    ds_write_b64 v69, v[98:99]
    ds_write_b64 v70, v[100:101]
    ds_write_b64 v71, v[102:103]
    v_bfe_u32 v4, v1, 1, 3
    v_bfe_u32 v5, v1, 4, 1
    v_lshlrev_b32_e64 v176, 4, v4
    v_lshl_add_u32 v176, v5, 3, v176
    v_and_b32_e64 v5, 1, v1
    v_lshl_add_u32 v176, v5, 2, v176
    v_lshlrev_b32_e64 v177, 2, v2
    v_lshl_add_u32 v177, v3, 8, v177
    v_and_b32 v4, 15, v1
    v_lshrrev_b32 v5, 4, v1
    v_mul_u32_u24 v179, 149504, v4
    v_lshl_add_u32 v180, v5, 4, v179
    s_lshl_b32 s82, s97, 7
    s_lshl_b32 s79, s62, 5
    s_add_u32 s82, s82, s79
    s_lshl_b32 s79, s62, 2
    v_mov_b32_e64 v7, s79
    v_mul_u32_u24 v178, 9344, v3
    v_lshl_add_u32 v178, v2, 4, v178
    s_mul_i32 s78, s97, 149504
    s_add_u32 s78, s78, s76
    s_add_u32 s78, s78, 8388608
    s_add_u32 s48, s78, 18688
    s_add_u32 s49, s48, 18688
    s_add_u32 s50, s49, 18688
    s_add_u32 s51, s50, 18688
    s_add_u32 s52, s51, 18688
    s_add_u32 s53, s52, 18688
    s_add_u32 s54, s53, 18688
    buffer_load_dwordx4 v[112:115], v178, s[40:43], s78 offen offset:1024 sc1
    buffer_load_dwordx4 v[116:119], v178, s[40:43], s48 offen offset:1024 sc1
    buffer_load_dwordx4 v[120:123], v178, s[40:43], s49 offen offset:1024 sc1
    buffer_load_dwordx4 v[124:127], v178, s[40:43], s50 offen offset:1024 sc1
    buffer_load_dwordx4 v[128:131], v178, s[40:43], s51 offen offset:1024 sc1
    buffer_load_dwordx4 v[132:135], v178, s[40:43], s52 offen offset:1024 sc1
    buffer_load_dwordx4 v[136:139], v178, s[40:43], s53 offen offset:1024 sc1
    buffer_load_dwordx4 v[140:143], v178, s[40:43], s54 offen offset:1024 sc1
    v_dot2_f32_bf16 v76, v208, s89, 0
    v_dot2_f32_bf16 v76, v209, s89, v76
    v_dot2_f32_bf16 v76, v210, s89, v76
    v_dot2_f32_bf16 v76, v211, s89, v76
    v_dot2_f32_bf16 v76, v212, s89, v76
    v_dot2_f32_bf16 v76, v213, s89, v76
    v_dot2_f32_bf16 v76, v214, s89, v76
    v_dot2_f32_bf16 v76, v215, s89, v76
    s_nop 2
    v_add_f32_dpp v76, v76, v76 row_ror:8 row_mask:0xf bank_mask:0xf
    s_nop 1
    v_add_f32_dpp v76, v76, v76 row_ror:4 row_mask:0xf bank_mask:0xf
    s_nop 1
    v_add_f32_dpp v76, v76, v76 row_ror:2 row_mask:0xf bank_mask:0xf
    s_nop 1
    v_add_f32_dpp v76, v76, v76 row_ror:1 row_mask:0xf bank_mask:0xf
    v_mov_b32 v4, v76
    s_nop 1
    v_permlane16_swap_b32 v76, v4
    v_add_f32 v76, v76, v4
    v_mov_b32 v4, v76
    s_nop 1
    v_permlane32_swap_b32 v76, v4
    v_add_f32_e64 v76, v76, v4
    s_mov_b32 s88, 0
    s_waitcnt vmcnt(6)
    v_pk_add_f32 v[108:109], v[112:113], v[116:117]
    v_pk_add_f32 v[110:111], v[114:115], v[118:119]
    s_waitcnt vmcnt(5)
    v_pk_add_f32 v[108:109], v[108:109], v[120:121]
    v_pk_add_f32 v[110:111], v[110:111], v[122:123]
    s_waitcnt vmcnt(4)
    v_pk_add_f32 v[108:109], v[108:109], v[124:125]
    v_pk_add_f32 v[110:111], v[110:111], v[126:127]
    s_waitcnt vmcnt(3)
    v_pk_add_f32 v[108:109], v[108:109], v[128:129]
    v_pk_add_f32 v[110:111], v[110:111], v[130:131]
    s_waitcnt vmcnt(2)
    v_pk_add_f32 v[108:109], v[108:109], v[132:133]
    v_pk_add_f32 v[110:111], v[110:111], v[134:135]
    s_waitcnt vmcnt(1)
    v_pk_add_f32 v[108:109], v[108:109], v[136:137]
    v_pk_add_f32 v[110:111], v[110:111], v[138:139]
    s_waitcnt vmcnt(0)
    v_pk_add_f32 v[108:109], v[108:109], v[140:141]
    v_pk_add_f32 v[110:111], v[110:111], v[142:143]
    v_cmp_u_f32 vcc, v111, v111
    v_mov_b32 v4, v108
    v_mov_b32 v5, v109
    v_mov_b32 v6, v110
    s_cbranch_vccnz L_s3_71
L_s3ok_72:
    v_permlane32_swap_b32 v108, v4
    v_permlane32_swap_b32 v109, v5
    v_permlane32_swap_b32 v110, v6
    s_barrier
    v_add_f32 v108, v108, v4
    v_add_f32 v109, v109, v5
    v_add_f32 v110, v110, v6
    v_mul_f32 v108, 0x3a800000, v108
    v_mul_f32 v109, 0x3a800000, v109
    v_fma_f32 v4, -v108, v108, v109
    v_max_f32_e64 v4, 0, v4
    v_cvt_pk_bf16_f32 v116, v108, v108
    v_and_b32_e64 v116, s90, v116
    v_cvt_pk_bf16_f32 v4, v4, v4
    v_and_b32_e64 v4, s90, v4
    v_add_f32 v4, 0x3727c5ac, v4
    v_cvt_pk_bf16_f32 v4, v4, v4
    v_and_b32 v4, s90, v4
    v_sqrt_f32_e64 v4, v4
    s_nop 0
    v_cvt_pk_bf16_f32 v4, v4, v4
    v_and_b32 v4, s90, v4
    v_rcp_f32 v118, v4
    v_fma_f32 v120, -v116, v76, v110
    v_mul_f32 v119, v116, v118
    v_mul_f32 v120, v120, v118
    v_and_b32 v6, 3, v1
    v_lshlrev_b32 v6, 2, v6
    v_max_f32_dpp v4, v120, v120 row_ror:8 row_mask:0xf bank_mask:0xf
    s_lshl_b32 s83, s62, 12
    v_cmp_gt_u32 s[84:85], 32, v1
    v_max_f32_dpp v4, v4, v4 row_ror:4 row_mask:0xf bank_mask:0xf
    s_lshl_b32 s55, 1, s62
    s_sub_u32 s55, s55, 1
    v_max_f32_dpp v4, v4, v4 row_ror:2 row_mask:0xf bank_mask:0xf
    s_nop 1
    v_max_f32_dpp v4, v4, v4 row_ror:1 row_mask:0xf bank_mask:0xf
    v_mov_b32 v5, v4
    s_nop 1
    v_permlane16_swap_b32 v4, v5
    v_max_f32 v4, v4, v5
    v_cmp_eq_f32_e64 vcc, v4, v120
    ds_write_b32 v7, v4 offset:25600
    s_ff1_i32_b32 s77, vcc_lo
    s_and_b32 s77, s77, 31
    s_bfe_u32 s79, s77, 0x30001
    s_lshl3_add_u32 s79, s77, s79
    s_lshl4_add_u32 s79, s79, s83
    v_xor_b32_e64 v176, s79, v176
    ds_read_b32 v182, v176 offset:0
    s_waitcnt lgkmcnt(1)
    s_barrier
    ds_read_b32 v8, v6 offset:25600
    v_readlane_b32 s80, v118, s77
    v_readlane_b32 s81, v119, s77
    s_add_u32 s79, s82, s77
    v_writelane_b32 v4, s79, 33
    v_mov_b32 v5, s81
    s_waitcnt lgkmcnt(1)
    v_lshlrev_b32 v184, 16, v182
    v_and_b32_e64 v185, s90, v182
    v_fma_f32 v184, v184, s80, -v5
    v_fma_f32 v185, v185, s80, -v5
    v_cvt_pk_bf16_f32 v184, v184, v185
    v_cndmask_b32 v184, v4, v184, s[84:85]
    s_waitcnt lgkmcnt(0)
    v_cmp_eq_f32 s[56:57], v8, v4
    v_cmp_gt_f32 vcc, v8, v4
    s_and_b32 s56, s56, s55
    s_or_b32 s56, s56, vcc_lo
    s_cbranch_scc1 L_nopub_81
    buffer_store_dword v184, v177, s[40:43], s99 offen offset:0 sc1
L_nopub_81:
    v_lshlrev_b32 v16, 16, v88
    v_and_b32_e64 v17, s90, v88
    v_pk_fma_f32 v[144:145], v[16:17], v[118:119], v[118:119] op_sel:[0,0,1] op_sel_hi:[1,0,1] neg_lo:[0,0,1] neg_hi:[0,0,1]
    v_cvt_pk_bf16_f32 v124, v144, v145
    v_lshlrev_b32 v144, 16, v124
    v_and_b32 v145, s90, v124
    v_pk_add_f32 v[144:145], v[144:145], v[16:17]
    v_cvt_pk_bf16_f32 v124, v144, v145
    v_lshlrev_b32 v18, 16, v89
    v_and_b32 v19, s90, v89
    v_pk_fma_f32 v[146:147], v[18:19], v[118:119], v[118:119] op_sel:[0,0,1] op_sel_hi:[1,0,1] neg_lo:[0,0,1] neg_hi:[0,0,1]
    v_cvt_pk_bf16_f32 v125, v146, v147
    v_lshlrev_b32 v146, 16, v125
    v_and_b32 v147, s90, v125
    v_pk_add_f32 v[146:147], v[146:147], v[18:19]
    v_cvt_pk_bf16_f32 v125, v146, v147
    ds_write_b64 v64, v[124:125]
    v_lshlrev_b32 v20, 16, v90
    v_and_b32 v21, s90, v90
    v_pk_fma_f32 v[148:149], v[20:21], v[118:119], v[118:119] op_sel:[0,0,1] op_sel_hi:[1,0,1] neg_lo:[0,0,1] neg_hi:[0,0,1]
    v_cvt_pk_bf16_f32 v126, v148, v149
    v_lshlrev_b32 v148, 16, v126
    v_and_b32 v149, s90, v126
    v_pk_add_f32 v[148:149], v[148:149], v[20:21]
    v_cvt_pk_bf16_f32 v126, v148, v149
    v_lshlrev_b32 v22, 16, v91
    v_and_b32 v23, s90, v91
    v_pk_fma_f32 v[150:151], v[22:23], v[118:119], v[118:119] op_sel:[0,0,1] op_sel_hi:[1,0,1] neg_lo:[0,0,1] neg_hi:[0,0,1]
    v_cvt_pk_bf16_f32 v127, v150, v151
    v_lshlrev_b32 v150, 16, v127
    v_and_b32 v151, s90, v127
    v_pk_add_f32 v[150:151], v[150:151], v[22:23]
    v_cvt_pk_bf16_f32 v127, v150, v151
    ds_write_b64 v65, v[126:127]
    s_cmp_eq_u32 s56, 0
    s_cbranch_scc1 L_stay_82
    s_cmp_gt_u32 s62, 1
    s_cbranch_scc0 L_stay_82
    s_mov_b32 s91, -1
    v_lshlrev_b32 v24, 16, v92
    v_and_b32_e64 v25, s90, v92
    v_pk_fma_f32 v[152:153], v[24:25], v[118:119], v[118:119] op_sel:[0,0,1] op_sel_hi:[1,0,1] neg_lo:[0,0,1] neg_hi:[0,0,1]
    v_cvt_pk_bf16_f32 v128, v152, v153
    v_lshlrev_b32 v152, 16, v128
    v_and_b32 v153, s90, v128
    v_pk_add_f32 v[152:153], v[152:153], v[24:25]
    v_cvt_pk_bf16_f32 v128, v152, v153
    v_lshlrev_b32 v26, 16, v93
    v_and_b32 v27, s90, v93
    v_pk_fma_f32 v[154:155], v[26:27], v[118:119], v[118:119] op_sel:[0,0,1] op_sel_hi:[1,0,1] neg_lo:[0,0,1] neg_hi:[0,0,1]
    v_cvt_pk_bf16_f32 v129, v154, v155
    v_lshlrev_b32 v154, 16, v129
    v_and_b32 v155, s90, v129
    v_pk_add_f32 v[154:155], v[154:155], v[26:27]
    v_cvt_pk_bf16_f32 v129, v154, v155
    ds_write_b64 v66, v[128:129]
    v_lshlrev_b32 v28, 16, v94
    v_and_b32 v29, s90, v94
    v_pk_fma_f32 v[156:157], v[28:29], v[118:119], v[118:119] op_sel:[0,0,1] op_sel_hi:[1,0,1] neg_lo:[0,0,1] neg_hi:[0,0,1]
    v_cvt_pk_bf16_f32 v130, v156, v157
    v_lshlrev_b32 v156, 16, v130
    v_and_b32 v157, s90, v130
    v_pk_add_f32 v[156:157], v[156:157], v[28:29]
    v_cvt_pk_bf16_f32 v130, v156, v157
    v_lshlrev_b32 v30, 16, v95
    v_and_b32 v31, s90, v95
    v_pk_fma_f32 v[158:159], v[30:31], v[118:119], v[118:119] op_sel:[0,0,1] op_sel_hi:[1,0,1] neg_lo:[0,0,1] neg_hi:[0,0,1]
    v_cvt_pk_bf16_f32 v131, v158, v159
    v_lshlrev_b32 v158, 16, v131
    v_and_b32 v159, s90, v131
    v_pk_add_f32 v[158:159], v[158:159], v[30:31]
    v_cvt_pk_bf16_f32 v131, v158, v159
    ds_write_b64 v67, v[130:131]
    v_lshlrev_b32 v32, 16, v96
    v_and_b32 v33, s90, v96
    v_pk_fma_f32 v[160:161], v[32:33], v[118:119], v[118:119] op_sel:[0,0,1] op_sel_hi:[1,0,1] neg_lo:[0,0,1] neg_hi:[0,0,1]
    v_cvt_pk_bf16_f32 v132, v160, v161
    v_lshlrev_b32 v160, 16, v132
    v_and_b32 v161, s90, v132
    v_pk_add_f32 v[160:161], v[160:161], v[32:33]
    v_cvt_pk_bf16_f32 v132, v160, v161
    v_lshlrev_b32 v34, 16, v97
    v_and_b32 v35, s90, v97
    v_pk_fma_f32 v[162:163], v[34:35], v[118:119], v[118:119] op_sel:[0,0,1] op_sel_hi:[1,0,1] neg_lo:[0,0,1] neg_hi:[0,0,1]
    v_cvt_pk_bf16_f32 v133, v162, v163
    v_lshlrev_b32 v162, 16, v133
    v_and_b32 v163, s90, v133
    v_pk_add_f32 v[162:163], v[162:163], v[34:35]
    v_cvt_pk_bf16_f32 v133, v162, v163
    ds_write_b64 v68, v[132:133]
    v_lshlrev_b32 v36, 16, v98
    v_and_b32 v37, s90, v98
    v_pk_fma_f32 v[164:165], v[36:37], v[118:119], v[118:119] op_sel:[0,0,1] op_sel_hi:[1,0,1] neg_lo:[0,0,1] neg_hi:[0,0,1]
    v_cvt_pk_bf16_f32 v134, v164, v165
    v_lshlrev_b32 v164, 16, v134
    v_and_b32 v165, s90, v134
    v_pk_add_f32 v[164:165], v[164:165], v[36:37]
    v_cvt_pk_bf16_f32 v134, v164, v165
    v_lshlrev_b32 v38, 16, v99
    v_and_b32 v39, s90, v99
    v_pk_fma_f32 v[166:167], v[38:39], v[118:119], v[118:119] op_sel:[0,0,1] op_sel_hi:[1,0,1] neg_lo:[0,0,1] neg_hi:[0,0,1]
    v_cvt_pk_bf16_f32 v135, v166, v167
    v_lshlrev_b32 v166, 16, v135
    v_and_b32 v167, s90, v135
    v_pk_add_f32 v[166:167], v[166:167], v[38:39]
    v_cvt_pk_bf16_f32 v135, v166, v167
    ds_write_b64 v69, v[134:135]
    v_lshlrev_b32 v40, 16, v100
    v_and_b32 v41, s90, v100
    v_pk_fma_f32 v[168:169], v[40:41], v[118:119], v[118:119] op_sel:[0,0,1] op_sel_hi:[1,0,1] neg_lo:[0,0,1] neg_hi:[0,0,1]
    v_cvt_pk_bf16_f32 v136, v168, v169
    v_lshlrev_b32 v168, 16, v136
    v_and_b32 v169, s90, v136
    v_pk_add_f32 v[168:169], v[168:169], v[40:41]
    v_cvt_pk_bf16_f32 v136, v168, v169
    v_lshlrev_b32 v42, 16, v101
    v_and_b32 v43, s90, v101
    v_pk_fma_f32 v[170:171], v[42:43], v[118:119], v[118:119] op_sel:[0,0,1] op_sel_hi:[1,0,1] neg_lo:[0,0,1] neg_hi:[0,0,1]
    v_cvt_pk_bf16_f32 v137, v170, v171
    v_lshlrev_b32 v170, 16, v137
    v_and_b32 v171, s90, v137
    v_pk_add_f32 v[170:171], v[170:171], v[42:43]
    v_cvt_pk_bf16_f32 v137, v170, v171
    ds_write_b64 v70, v[136:137]
    v_lshlrev_b32 v44, 16, v102
    v_and_b32 v45, s90, v102
    v_pk_fma_f32 v[172:173], v[44:45], v[118:119], v[118:119] op_sel:[0,0,1] op_sel_hi:[1,0,1] neg_lo:[0,0,1] neg_hi:[0,0,1]
    v_cvt_pk_bf16_f32 v138, v172, v173
    v_lshlrev_b32 v172, 16, v138
    v_and_b32 v173, s90, v138
    v_pk_add_f32 v[172:173], v[172:173], v[44:45]
    v_cvt_pk_bf16_f32 v138, v172, v173
    v_lshlrev_b32 v46, 16, v103
    v_and_b32 v47, s90, v103
    v_pk_fma_f32 v[174:175], v[46:47], v[118:119], v[118:119] op_sel:[0,0,1] op_sel_hi:[1,0,1] neg_lo:[0,0,1] neg_hi:[0,0,1]
    v_cvt_pk_bf16_f32 v139, v174, v175
    v_lshlrev_b32 v174, 16, v139
    v_and_b32 v175, s90, v139
    v_pk_add_f32 v[174:175], v[174:175], v[46:47]
    v_cvt_pk_bf16_f32 v139, v174, v175
    ds_write_b64 v71, v[138:139]
    s_sub_u32 s77, s91, s82
    v_lshrrev_b32 v7, 3, v1
    v_sub_u32_e64 v5, s77, v7
    v_mov_b32 v6, 2146435072
    v_and_b32 v8, 7, v1
    v_lshrrev_b32 v9, 4, v1
    v_xor_b32 v8, v8, v9
    v_lshlrev_b32 v8, 4, v8
    v_lshl_add_u32 v7, v7, 11, v8
    v_xor_b32 v8, 64, v7
    s_lshl_b32 s58, s82, 11
    s_lshl_b32 s59, s98, 7
    s_add_u32 s58, s58, s59
    v_cmp_eq_u32 vcc, 0, v5
    s_nop 1
    v_cndmask_b32 v200, v7, v6, vcc
    v_cmp_eq_u32 vcc, 8, v5
    s_nop 1
    v_cndmask_b32 v201, v8, v6, vcc
    v_cmp_eq_u32 vcc, 16, v5
    s_nop 1
    v_cndmask_b32 v202, v7, v6, vcc
    v_cmp_eq_u32 vcc, 24, v5
    s_nop 1
    v_cndmask_b32 v203, v8, v6, vcc
    s_lshl_b32 s77, s62, 12
    s_add_u32 s77, s77, 0
    v_add_u32 v4, s77, v12
    s_waitcnt lgkmcnt(0)
    ds_read_b128 v[48:51], v4 offset:0
    ds_read_b128 v[52:55], v4 offset:1024
    ds_read_b128 v[56:59], v4 offset:2048
    ds_read_b128 v[60:63], v4 offset:3072
    s_waitcnt lgkmcnt(3)
    buffer_store_dwordx4 v[48:51], v200, s[44:47], s58 offen sc1
    s_add_u32 s58, s58, 16384
    s_waitcnt lgkmcnt(2)
    buffer_store_dwordx4 v[52:55], v201, s[44:47], s58 offen sc1
    s_add_u32 s58, s58, 16384
    s_waitcnt lgkmcnt(1)
    buffer_store_dwordx4 v[56:59], v202, s[44:47], s58 offen sc1
    s_add_u32 s58, s58, 16384
    s_waitcnt lgkmcnt(0)
    buffer_store_dwordx4 v[60:63], v203, s[44:47], s58 offen sc1
    s_barrier
    s_barrier
    s_branch L_cdone
L_stay_82:
    v_and_b32 v7, 15, v1
    v_lshlrev_b32_e64 v7, 3, v7
    s_cmp_eq_u32 s62, 0
    s_cbranch_scc0 L_nos4_83
    s_mul_i32 s76, s98, 9344
    s_add_u32 s76, s76, 8388608
    s_add_u32 s20, s26, s99
    s_addc_u32 s21, s27, 0
    s_mov_b32 s88, 0
L_spin_84:
    s_load_dwordx16 s[4:19], s[20:21], 768 glc
    s_waitcnt lgkmcnt(0)
    s_or_b64 s[4:5], s[4:5], s[6:7]
    s_or_b64 s[4:5], s[4:5], s[8:9]
    s_or_b64 s[4:5], s[4:5], s[10:11]
    s_or_b64 s[4:5], s[4:5], s[12:13]
    s_or_b64 s[4:5], s[4:5], s[14:15]
    s_or_b64 s[4:5], s[4:5], s[16:17]
    s_or_b64 s[4:5], s[4:5], s[18:19]
    s_cbranch_scc0 L_gate_85
    s_add_u32 s88, s88, 1
    s_cmp_lt_u32 s88, 65536
    s_cbranch_scc1 L_spin_84
L_gate_85:
    s_mov_b32 s88, 0
L_poll_86:
    buffer_load_dwordx2 v[196:197], v179, s[40:43], s76 offen offset:256 sc1
    buffer_load_dwordx4 v[188:191], v180, s[40:43], s76 offen offset:0 sc1
    buffer_load_dwordx4 v[192:195], v180, s[40:43], s76 offen offset:64 sc1
    s_waitcnt vmcnt(0)
    v_max3_u32 v4, v196, v197, v188
    v_max3_u32 v4, v4, v189, v190
    v_max3_u32 v4, v4, v191, v192
    v_max3_u32 v4, v4, v193, v194
    v_max_u32 v4, v4, v195
    v_cmp_eq_u32_e64 vcc, -1, v4
    s_nop 0
    s_cbranch_vccz L_ok_87
    s_add_u32 s88, s88, 1
    s_cmp_lt_u32 s88, 65536
    s_cbranch_scc1 L_poll_86
L_ok_87:
    ds_write_b128 v12, v[188:191] offset:28672
    ds_write_b128 v12, v[192:195] offset:29696
    ds_write_b64 v7, v[196:197] offset:25728
L_nos4_83:
    s_waitcnt lgkmcnt(0)
    s_barrier
    ds_read_b64 v[8:9], v7 offset:25728
    s_waitcnt lgkmcnt(0)
    v_max_f32_dpp v4, v8, v8 row_ror:8 row_mask:0xf bank_mask:0xf
    s_nop 1
    v_max_f32_dpp v4, v4, v4 row_ror:4 row_mask:0xf bank_mask:0xf
    s_nop 1
    v_max_f32_dpp v4, v4, v4 row_ror:2 row_mask:0xf bank_mask:0xf
    s_nop 1
    v_max_f32_dpp v4, v4, v4 row_ror:1 row_mask:0xf bank_mask:0xf
    v_cmp_eq_f32 vcc, v4, v8
    s_nop 0
    s_ff1_i32_b32 s92, vcc_lo
    s_and_b32 s92, s92, 15
    s_nop 3
    v_readlane_b32 s91, v9, s92
    s_nop 0
    s_cmp_eq_u32 s91, s79
    s_cbranch_scc0 L_noh_88
    s_mov_b32 exec_hi, 0
    buffer_store_dword v182, v177, s[40:43], s99 offen offset:128 sc1
    s_mov_b64 exec, -1
L_noh_88:
    s_sub_u32 s77, s91, s82
    v_lshrrev_b32 v7, 3, v1
    v_sub_u32 v5, s77, v7
    v_mov_b32 v6, 2146435072
    v_and_b32 v8, 7, v1
    v_lshrrev_b32 v9, 4, v1
    v_xor_b32 v8, v8, v9
    v_lshlrev_b32 v8, 4, v8
    v_lshl_add_u32 v7, v7, 11, v8
    v_xor_b32 v8, 64, v7
    s_lshl_b32 s58, s82, 11
    s_lshl_b32 s59, s98, 7
    s_add_u32 s58, s58, s59
    v_cmp_eq_u32 vcc, 0, v5
    s_nop 1
    v_cndmask_b32 v200, v7, v6, vcc
    v_cmp_eq_u32 vcc, 8, v5
    s_nop 1
    v_cndmask_b32 v201, v8, v6, vcc
    v_cmp_eq_u32 vcc, 16, v5
    s_nop 1
    v_cndmask_b32 v202, v7, v6, vcc
    v_cmp_eq_u32 vcc, 24, v5
    s_nop 1
    v_cndmask_b32 v203, v8, v6, vcc
    s_lshl_b32 s77, s62, 12
    s_add_u32 s77, s77, 0
    v_add_u32 v4, s77, v12
    v_lshlrev_b32 v24, 16, v92
    v_and_b32_e64 v25, s90, v92
    v_pk_fma_f32 v[152:153], v[24:25], v[118:119], v[118:119] op_sel:[0,0,1] op_sel_hi:[1,0,1] neg_lo:[0,0,1] neg_hi:[0,0,1]
    v_cvt_pk_bf16_f32 v128, v152, v153
    v_lshlrev_b32 v152, 16, v128
    v_and_b32 v153, s90, v128
    v_pk_add_f32 v[152:153], v[152:153], v[24:25]
    v_cvt_pk_bf16_f32 v128, v152, v153
    v_lshlrev_b32 v26, 16, v93
    v_and_b32 v27, s90, v93
    v_pk_fma_f32 v[154:155], v[26:27], v[118:119], v[118:119] op_sel:[0,0,1] op_sel_hi:[1,0,1] neg_lo:[0,0,1] neg_hi:[0,0,1]
    v_cvt_pk_bf16_f32 v129, v154, v155
    v_lshlrev_b32 v154, 16, v129
    v_and_b32 v155, s90, v129
    v_pk_add_f32 v[154:155], v[154:155], v[26:27]
    v_cvt_pk_bf16_f32 v129, v154, v155
    ds_write_b64 v66, v[128:129]
    v_lshlrev_b32 v28, 16, v94
    v_and_b32 v29, s90, v94
    v_pk_fma_f32 v[156:157], v[28:29], v[118:119], v[118:119] op_sel:[0,0,1] op_sel_hi:[1,0,1] neg_lo:[0,0,1] neg_hi:[0,0,1]
    v_cvt_pk_bf16_f32 v130, v156, v157
    v_lshlrev_b32 v156, 16, v130
    v_and_b32 v157, s90, v130
    v_pk_add_f32 v[156:157], v[156:157], v[28:29]
    v_cvt_pk_bf16_f32 v130, v156, v157
    v_lshlrev_b32 v30, 16, v95
    v_and_b32 v31, s90, v95
    v_pk_fma_f32 v[158:159], v[30:31], v[118:119], v[118:119] op_sel:[0,0,1] op_sel_hi:[1,0,1] neg_lo:[0,0,1] neg_hi:[0,0,1]
    v_cvt_pk_bf16_f32 v131, v158, v159
    v_lshlrev_b32 v158, 16, v131
    v_and_b32 v159, s90, v131
    v_pk_add_f32 v[158:159], v[158:159], v[30:31]
    v_cvt_pk_bf16_f32 v131, v158, v159
    ds_write_b64 v67, v[130:131]
    v_lshlrev_b32 v32, 16, v96
    v_and_b32 v33, s90, v96
    v_pk_fma_f32 v[160:161], v[32:33], v[118:119], v[118:119] op_sel:[0,0,1] op_sel_hi:[1,0,1] neg_lo:[0,0,1] neg_hi:[0,0,1]
    v_cvt_pk_bf16_f32 v132, v160, v161
    v_lshlrev_b32 v160, 16, v132
    v_and_b32 v161, s90, v132
    v_pk_add_f32 v[160:161], v[160:161], v[32:33]
    v_cvt_pk_bf16_f32 v132, v160, v161
    v_lshlrev_b32 v34, 16, v97
    v_and_b32 v35, s90, v97
    v_pk_fma_f32 v[162:163], v[34:35], v[118:119], v[118:119] op_sel:[0,0,1] op_sel_hi:[1,0,1] neg_lo:[0,0,1] neg_hi:[0,0,1]
    v_cvt_pk_bf16_f32 v133, v162, v163
    v_lshlrev_b32 v162, 16, v133
    v_and_b32 v163, s90, v133
    v_pk_add_f32 v[162:163], v[162:163], v[34:35]
    v_cvt_pk_bf16_f32 v133, v162, v163
    ds_write_b64 v68, v[132:133]
    v_lshlrev_b32 v36, 16, v98
    v_and_b32 v37, s90, v98
    v_pk_fma_f32 v[164:165], v[36:37], v[118:119], v[118:119] op_sel:[0,0,1] op_sel_hi:[1,0,1] neg_lo:[0,0,1] neg_hi:[0,0,1]
    v_cvt_pk_bf16_f32 v134, v164, v165
    v_lshlrev_b32 v164, 16, v134
    v_and_b32 v165, s90, v134
    v_pk_add_f32 v[164:165], v[164:165], v[36:37]
    v_cvt_pk_bf16_f32 v134, v164, v165
    v_lshlrev_b32 v38, 16, v99
    v_and_b32 v39, s90, v99
    v_pk_fma_f32 v[166:167], v[38:39], v[118:119], v[118:119] op_sel:[0,0,1] op_sel_hi:[1,0,1] neg_lo:[0,0,1] neg_hi:[0,0,1]
    v_cvt_pk_bf16_f32 v135, v166, v167
    v_lshlrev_b32 v166, 16, v135
    v_and_b32 v167, s90, v135
    v_pk_add_f32 v[166:167], v[166:167], v[38:39]
    v_cvt_pk_bf16_f32 v135, v166, v167
    ds_write_b64 v69, v[134:135]
    v_lshlrev_b32 v40, 16, v100
    v_and_b32 v41, s90, v100
    v_pk_fma_f32 v[168:169], v[40:41], v[118:119], v[118:119] op_sel:[0,0,1] op_sel_hi:[1,0,1] neg_lo:[0,0,1] neg_hi:[0,0,1]
    v_cvt_pk_bf16_f32 v136, v168, v169
    v_lshlrev_b32 v168, 16, v136
    v_and_b32 v169, s90, v136
    v_pk_add_f32 v[168:169], v[168:169], v[40:41]
    v_cvt_pk_bf16_f32 v136, v168, v169
    v_lshlrev_b32 v42, 16, v101
    v_and_b32 v43, s90, v101
    v_pk_fma_f32 v[170:171], v[42:43], v[118:119], v[118:119] op_sel:[0,0,1] op_sel_hi:[1,0,1] neg_lo:[0,0,1] neg_hi:[0,0,1]
    v_cvt_pk_bf16_f32 v137, v170, v171
    v_lshlrev_b32 v170, 16, v137
    v_and_b32 v171, s90, v137
    v_pk_add_f32 v[170:171], v[170:171], v[42:43]
    v_cvt_pk_bf16_f32 v137, v170, v171
    ds_write_b64 v70, v[136:137]
    v_lshlrev_b32 v44, 16, v102
    v_and_b32 v45, s90, v102
    v_pk_fma_f32 v[172:173], v[44:45], v[118:119], v[118:119] op_sel:[0,0,1] op_sel_hi:[1,0,1] neg_lo:[0,0,1] neg_hi:[0,0,1]
    v_cvt_pk_bf16_f32 v138, v172, v173
    v_lshlrev_b32 v172, 16, v138
    v_and_b32 v173, s90, v138
    v_pk_add_f32 v[172:173], v[172:173], v[44:45]
    v_cvt_pk_bf16_f32 v138, v172, v173
    v_lshlrev_b32 v46, 16, v103
    v_and_b32 v47, s90, v103
    v_pk_fma_f32 v[174:175], v[46:47], v[118:119], v[118:119] op_sel:[0,0,1] op_sel_hi:[1,0,1] neg_lo:[0,0,1] neg_hi:[0,0,1]
    v_cvt_pk_bf16_f32 v139, v174, v175
    v_lshlrev_b32 v174, 16, v139
    v_and_b32 v175, s90, v139
    v_pk_add_f32 v[174:175], v[174:175], v[46:47]
    v_cvt_pk_bf16_f32 v139, v174, v175
    ds_write_b64 v71, v[138:139]
    s_barrier
    s_waitcnt lgkmcnt(0)
    ds_read_b128 v[48:51], v4 offset:0
    ds_read_b128 v[52:55], v4 offset:1024
    ds_read_b128 v[56:59], v4 offset:2048
    ds_read_b128 v[60:63], v4 offset:3072
    s_waitcnt lgkmcnt(3)
    buffer_store_dwordx4 v[48:51], v200, s[44:47], s58 offen sc1
    s_add_u32 s58, s58, 16384
    s_waitcnt lgkmcnt(2)
    buffer_store_dwordx4 v[52:55], v201, s[44:47], s58 offen sc1
    s_add_u32 s58, s58, 16384
    s_waitcnt lgkmcnt(1)
    buffer_store_dwordx4 v[56:59], v202, s[44:47], s58 offen sc1
    s_add_u32 s58, s58, 16384
    s_waitcnt lgkmcnt(0)
    buffer_store_dwordx4 v[60:63], v203, s[44:47], s58 offen sc1
L_cdone:
L_cfin:
L_end:
    s_endpgm
L_tr0:
    s_call_b64 s[54:55], L_stall
    s_branch L_bk0
L_tr1:
    s_call_b64 s[54:55], L_stall
    s_branch L_bk1
L_tr2:
    s_call_b64 s[54:55], L_stall
    s_branch L_bk2
L_tr3:
    s_call_b64 s[54:55], L_stall
    s_branch L_bk3
L_tr4:
    s_call_b64 s[54:55], L_stall
    s_branch L_bk4
L_tr5:
    s_call_b64 s[54:55], L_stall
    s_branch L_bk5
L_tr6:
    s_call_b64 s[54:55], L_stall
    s_branch L_bk6
L_tr7:
    s_call_b64 s[54:55], L_stall
    s_branch L_bk7
L_tr8:
    s_call_b64 s[54:55], L_stall
    s_branch L_bk8
L_tr9:
    s_call_b64 s[54:55], L_stall
    s_branch L_bk9
L_tr10:
    s_call_b64 s[54:55], L_stall
    s_branch L_bk10
L_tr11:
    s_call_b64 s[54:55], L_stall
    s_branch L_bk11
L_tr12:
    s_call_b64 s[54:55], L_stall
    s_branch L_bk12
L_tr13:
    s_call_b64 s[54:55], L_stall
    s_branch L_bk13
L_tr14:
    s_call_b64 s[54:55], L_stall
    s_branch L_bk14
L_tr15:
    s_call_b64 s[54:55], L_stall
    s_branch L_bk15
L_stall:
    s_cmp_eq_u32 s53, 0
    s_cbranch_scc0 L_sent_67
    s_waitcnt vmcnt(0)
    s_mov_b64 exec, 1
    ds_add_u32 v8, v74 offset:25988
    s_mov_b64 exec, -1
    s_mov_b32 s53, 1
L_sent_67:
    s_mov_b32 s88, 0
L_stall1:
    ds_read_b32 v79, v8 offset:25984
    s_waitcnt lgkmcnt(0)
    v_readfirstlane_b32 s76, v79
    s_nop 0
    s_and_b32 s76, s76, s52
    s_cbranch_scc1 L_stall2
    s_add_u32 s88, s88, 1
    s_cmp_lt_u32 s88, 1048576
    s_cbranch_scc1 L_stall1
    s_mov_b32 s76, s52
L_stall2:
    s_setpc_b64 s[54:55]
L_s3_71:
    v_cmp_eq_u32 vcc, -1, v115
    s_nop 0
    s_cbranch_vccz L_s3skip_73
    buffer_load_dwordx4 v[112:115], v178, s[40:43], s78 offen offset:1024 sc1
L_s3skip_73:
    v_cmp_eq_u32_e64 vcc, -1, v119
    s_nop 0
    s_cbranch_vccz L_s3skip_74
    buffer_load_dwordx4 v[116:119], v178, s[40:43], s48 offen offset:1024 sc1
L_s3skip_74:
    v_cmp_eq_u32_e64 vcc, -1, v123
    s_nop 0
    s_cbranch_vccz L_s3skip_75
    buffer_load_dwordx4 v[120:123], v178, s[40:43], s49 offen offset:1024 sc1
L_s3skip_75:
    v_cmp_eq_u32_e64 vcc, -1, v127
    s_nop 0
    s_cbranch_vccz L_s3skip_76
    buffer_load_dwordx4 v[124:127], v178, s[40:43], s50 offen offset:1024 sc1
L_s3skip_76:
    v_cmp_eq_u32_e64 vcc, -1, v131
    s_nop 0
    s_cbranch_vccz L_s3skip_77
    buffer_load_dwordx4 v[128:131], v178, s[40:43], s51 offen offset:1024 sc1
L_s3skip_77:
    v_cmp_eq_u32_e64 vcc, -1, v135
    s_nop 0
    s_cbranch_vccz L_s3skip_78
    buffer_load_dwordx4 v[132:135], v178, s[40:43], s52 offen offset:1024 sc1
L_s3skip_78:
    v_cmp_eq_u32_e64 vcc, -1, v139
    s_nop 0
    s_cbranch_vccz L_s3skip_79
    buffer_load_dwordx4 v[136:139], v178, s[40:43], s53 offen offset:1024 sc1
L_s3skip_79:
    v_cmp_eq_u32_e64 vcc, -1, v143
    s_nop 0
    s_cbranch_vccz L_s3skip_80
    buffer_load_dwordx4 v[140:143], v178, s[40:43], s54 offen offset:1024 sc1
L_s3skip_80:
    s_waitcnt vmcnt(0)
    v_pk_add_f32 v[108:109], v[112:113], v[116:117]
    v_pk_add_f32 v[110:111], v[114:115], v[118:119]
    v_pk_add_f32 v[108:109], v[108:109], v[120:121]
    v_pk_add_f32 v[110:111], v[110:111], v[122:123]
    v_pk_add_f32 v[108:109], v[108:109], v[124:125]
    v_pk_add_f32 v[110:111], v[110:111], v[126:127]
    v_pk_add_f32 v[108:109], v[108:109], v[128:129]
    v_pk_add_f32 v[110:111], v[110:111], v[130:131]
    v_pk_add_f32 v[108:109], v[108:109], v[132:133]
    v_pk_add_f32 v[110:111], v[110:111], v[134:135]
    v_pk_add_f32 v[108:109], v[108:109], v[136:137]
    v_pk_add_f32 v[110:111], v[110:111], v[138:139]
    v_pk_add_f32 v[108:109], v[108:109], v[140:141]
    v_pk_add_f32 v[110:111], v[110:111], v[142:143]
    v_cmp_u_f32 vcc, v111, v111
    v_mov_b32 v4, v108
    v_mov_b32 v5, v109
    v_mov_b32_e64 v6, v110
    s_cbranch_vccz L_s3ok_72
    s_add_u32 s88, s88, 1
    s_cmp_lt_u32 s88, 65536
    s_cbranch_scc1 L_s3_71
    s_branch L_s3ok_72
L_code_end:
s_endpgm
.p2align 7
.type L_table,@object
L_table:
.long 0x650c3824, 0xfedba97, 0x50102, 0x3006
.long 0x650c3824, 0xfedba97, 0x510200, 0x3060
.long 0x641d0935, 0xfecba87, 0x5020001, 0x3600
.long 0x76543218, 0xfedcba9, 0x15000002, 0x6300
.long 0x641d0935, 0xfecba87, 0x25100, 0x3006
.long 0x54e2a160, 0xfdcb987, 0x502001, 0x3060
.long 0x54e2a160, 0xfdcb987, 0x5002010, 0x3600
.long 0x54f3b271, 0xedca986, 0x50201000, 0x6300
.long 0x54f3b271, 0xedca986, 0x152000, 0x3006
.long 0x650c3824, 0xfedba97, 0x520010, 0x3060
.long 0x650c3824, 0xfedba97, 0x5020001, 0x3600
.long 0x76543218, 0xfedcba9, 0x50000012, 0x6300
.long 0x641d0935, 0xfecba87, 0x25010, 0x3006
.long 0x641d0935, 0xfecba87, 0x510020, 0x3060
.long 0x54e2a160, 0xfdcb987, 0x5100002, 0x3600
.long 0x54e2a160, 0xfdcb987, 0x50001002, 0x6300
.long 0x641d0935, 0xfecba87, 0x500210, 0x3060
.long 0x641d0935, 0xfecba87, 0x5010200, 0x3600
.long 0x54e2a160, 0xfdcb987, 0x50100002, 0x6300
.long 0x76543209, 0xfedcba8, 0x15002, 0x3006
.long 0x54e2a160, 0xfdcb987, 0x501002, 0x3060
.long 0x54f3b271, 0xedca986, 0x5000120, 0x3600
.long 0x54f3b271, 0xedca986, 0x50000012, 0x6300
.long 0x650c3824, 0xfedba97, 0x15200, 0x3006
.long 0x650c3824, 0xfedba97, 0x520100, 0x3060
.long 0x641d0935, 0xfecba87, 0x5001200, 0x3600
.long 0x641d0935, 0xfecba87, 0x50020001, 0x6300
.long 0x76543209, 0xfedcba8, 0x25001, 0x3006
.long 0x54e2a160, 0xfdcb987, 0x502100, 0x3060
.long 0x54e2a160, 0xfdcb987, 0x5002010, 0x3600
.long 0x54f3b271, 0xedca986, 0x50001002, 0x6300
.long 0x54f3b271, 0xedca986, 0x152000, 0x3006
.long 0x54e2a160, 0xfdcb987, 0x5001002, 0x3600
.long 0x54e2a160, 0xfdcb987, 0x50000012, 0x6300
.long 0x54f3b271, 0xedca986, 0x51020, 0x3006
.long 0x765431a0, 0xfedcb98, 0x150200, 0x3060
.long 0x54f3b271, 0xedca986, 0x5102000, 0x3600
.long 0x650c3824, 0xfedba97, 0x50000102, 0x6300
.long 0x650c3824, 0xfedba97, 0x15020, 0x3006
.long 0x641d0935, 0xfecba87, 0x510200, 0x3060
.long 0x641d0935, 0xfecba87, 0x5020100, 0x3600
.long 0x54e2a160, 0xfdcb987, 0x50100002, 0x6300
.long 0x54e2a160, 0xfdcb987, 0x250001, 0x3006
.long 0x765431a0, 0xfedcb98, 0x251000, 0x3060
.long 0x54f3b271, 0xedca986, 0x5200010, 0x3600
.long 0x54f3b271, 0xedca986, 0x50200001, 0x6300
.long 0x650c3824, 0xfedba97, 0x50021, 0x3006
.long 0x650c3824, 0xfedba97, 0x520010, 0x3060
.long 0x54f3b271, 0xedca986, 0x50200010, 0x6300
.long 0x54f3b271, 0xedca986, 0x152000, 0x3006
.long 0x650c3824, 0xfedba97, 0x500102, 0x3060
.long 0x765421b0, 0xfedca98, 0x2500010, 0x3600
.long 0x650c3824, 0xfedba97, 0x50010200, 0x6300
.long 0x641d0935, 0xfecba87, 0x15200, 0x3006
.long 0x641d0935, 0xfecba87, 0x520001, 0x3060
.long 0x54e2a160, 0xfdcb987, 0x5100020, 0x3600
.long 0x54e2a160, 0xfdcb987, 0x50001020, 0x6300
.long 0x54f3b271, 0xedca986, 0x52001, 0x3006
.long 0x54f3b271, 0xedca986, 0x500102, 0x3060
.long 0x765421b0, 0xfedca98, 0x1500020, 0x3600
.long 0x650c3824, 0xfedba97, 0x50000021, 0x6300
.long 0x650c3824, 0xfedba97, 0x521000, 0x3006
.long 0x641d0935, 0xfecba87, 0x520100, 0x3060
.long 0x641d0935, 0xfecba87, 0x5001002, 0x3600
.long 0x650c3824, 0xfedba97, 0x50021, 0x3006
.long 0x650c3824, 0xfedba97, 0x520010, 0x3060
.long 0x641d0935, 0xfecba87, 0x5010002, 0x3600
.long 0x76532c10, 0xfedba98, 0x15002000, 0x6300
.long 0x641d0935, 0xfecba87, 0x50021, 0x3006
.long 0x54e2a160, 0xfdcb987, 0x251000, 0x3060
.long 0x54e2a160, 0xfdcb987, 0x5000012, 0x3600
.long 0x54f3b271, 0xedca986, 0x50100002, 0x6300
.long 0x54f3b271, 0xedca986, 0x51020, 0x3006
.long 0x650c3824, 0xfedba97, 0x510200, 0x3060
.long 0x650c3824, 0xfedba97, 0x5000102, 0x3600
.long 0x76532c10, 0xfedba98, 0x50000210, 0x6300
.long 0x641d0935, 0xfecba87, 0x50210, 0x3006
.long 0x641d0935, 0xfecba87, 0x520100, 0x3060
.long 0x54e2a160, 0xfdcb987, 0x5100020, 0x3600
.long 0x54e2a160, 0xfdcb987, 0x50000021, 0x6300
.long 0x641d0935, 0xfecba87, 0x500120, 0x3060
.long 0x641d0935, 0xfecba87, 0x5000012, 0x3600
.long 0x54e2a160, 0xfdcb987, 0x50002010, 0x6300
.long 0x76432d10, 0xfecba98, 0x150002, 0x3006
.long 0x54e2a160, 0xfdcb987, 0x510020, 0x3060
.long 0x54f3b271, 0xedca986, 0x5201000, 0x3600
.long 0x54f3b271, 0xedca986, 0x50100020, 0x6300
.long 0x650c3824, 0xfedba97, 0x50102, 0x3006
.long 0x650c3824, 0xfedba97, 0x510200, 0x3060
.long 0x641d0935, 0xfecba87, 0x5000021, 0x3600
.long 0x641d0935, 0xfecba87, 0x50010020, 0x6300
.long 0x76432d10, 0xfecba98, 0x50201, 0x3006
.long 0x54e2a160, 0xfdcb987, 0x251000, 0x3060
.long 0x54e2a160, 0xfdcb987, 0x5100002, 0x3600
.long 0x54f3b271, 0xedca986, 0x50200010, 0x6300
.long 0x54f3b271, 0xedca986, 0x250001, 0x3006
.long 0x54e2a160, 0xfdcb987, 0x5001020, 0x3600
.long 0x54e2a160, 0xfdcb987, 0x50002100, 0x6300
.long 0x54f3b271, 0xedca986, 0x250100, 0x3006
.long 0x7543e210, 0xfdcba98, 0x1502000, 0x3060
.long 0x54f3b271, 0xedca986, 0x5200010, 0x3600
.long 0x650c3824, 0xfedba97, 0x50000201, 0x6300
.long 0x650c3824, 0xfedba97, 0x15200, 0x3006
.long 0x641d0935, 0xfecba87, 0x500120, 0x3060
.long 0x641d0935, 0xfecba87, 0x5010200, 0x3600
.long 0x54e2a160, 0xfdcb987, 0x50100020, 0x6300
.long 0x54e2a160, 0xfdcb987, 0x52010, 0x3006
.long 0x7543e210, 0xfdcba98, 0x500021, 0x3060
.long 0x54f3b271, 0xedca986, 0x5100020, 0x3600
.long 0x54f3b271, 0xedca986, 0x50001020, 0x6300
.long 0x650c3824, 0xfedba97, 0x51200, 0x3006
.long 0x650c3824, 0xfedba97, 0x500120, 0x3060
.long 0x54f3b271, 0xedca986, 0x50000102, 0x6300
.long 0x54f3b271, 0xedca986, 0x50012, 0x3006
.long 0x650c3824, 0xfedba97, 0x500120, 0x3060
.long 0x6543f210, 0xedcba98, 0x15200000, 0x3600
.long 0x650c3824, 0xfedba97, 0x50001020, 0x6300
.long 0x641d0935, 0xfecba87, 0x15002, 0x3006
.long 0x641d0935, 0xfecba87, 0x500102, 0x3060
.long 0x54e2a160, 0xfdcb987, 0x5102000, 0x3600
.long 0x54e2a160, 0xfdcb987, 0x50201000, 0x6300
.long 0x54f3b271, 0xedca986, 0x150020, 0x3006
.long 0x54f3b271, 0xedca986, 0x501020, 0x3060
.long 0x6543f210, 0xedcba98, 0x25000010, 0x3600
.long 0x650c3824, 0xfedba97, 0x50000201, 0x6300
.long 0x650c3824, 0xfedba97, 0x15200, 0x3006
.long 0x641d0935, 0xfecba87, 0x501200, 0x3060
.long 0x641d0935, 0xfecba87, 0x5000201, 0x3600
.long 0x650c3824, 0xfedba97, 0x50210, 0x3006
.long 0x650c3824, 0xfedba97, 0x510002, 0x3060
.long 0x641d0935, 0xfecba87, 0x5000120, 0x3600
.long 0x76543218, 0xfedcba9, 0x25000010, 0x6300
.long 0x641d0935, 0xfecba87, 0x50210, 0x3006
.long 0x54e2a160, 0xfdcb987, 0x150002, 0x3060
.long 0x54e2a160, 0xfdcb987, 0x5200010, 0x3600
.long 0x54f3b271, 0xedca986, 0x50102000, 0x6300
.long 0x54f3b271, 0xedca986, 0x251000, 0x3006
.long 0x650c3824, 0xfedba97, 0x500120, 0x3060
.long 0x650c3824, 0xfedba97, 0x5000021, 0x3600
.long 0x76543218, 0xfedcba9, 0x15002000, 0x6300
.long 0x641d0935, 0xfecba87, 0x50021, 0x3006
.long 0x641d0935, 0xfecba87, 0x510200, 0x3060
.long 0x54e2a160, 0xfdcb987, 0x5201000, 0x3600
.long 0x54e2a160, 0xfdcb987, 0x50200001, 0x6300
.long 0x641d0935, 0xfecba87, 0x500102, 0x3060
.long 0x641d0935, 0xfecba87, 0x5020010, 0x3600
.long 0x54e2a160, 0xfdcb987, 0x50201000, 0x6300
.long 0x76543209, 0xfedcba8, 0x215000, 0x3006
.long 0x54e2a160, 0xfdcb987, 0x502010, 0x3060
.long 0x54f3b271, 0xedca986, 0x5001002, 0x3600
.long 0x54f3b271, 0xedca986, 0x50200001, 0x6300
.long 0x650c3824, 0xfedba97, 0x50120, 0x3006
.long 0x650c3824, 0xfedba97, 0x510002, 0x3060
.long 0x641d0935, 0xfecba87, 0x5020001, 0x3600
.long 0x641d0935, 0xfecba87, 0x50010200, 0x6300
.long 0x76543209, 0xfedcba8, 0x50102, 0x3006
.long 0x54e2a160, 0xfdcb987, 0x150020, 0x3060
.long 0x54e2a160, 0xfdcb987, 0x5000021, 0x3600
.long 0x54f3b271, 0xedca986, 0x50102000, 0x6300
.long 0x54f3b271, 0xedca986, 0x50012, 0x3006
.long 0x54e2a160, 0xfdcb987, 0x5002010, 0x3600
.long 0x54e2a160, 0xfdcb987, 0x50001020, 0x6300
.long 0x54f3b271, 0xedca986, 0x150002, 0x3006
.long 0x765431a0, 0xfedcb98, 0x500021, 0x3060
.long 0x54f3b271, 0xedca986, 0x5001020, 0x3600
.long 0x650c3824, 0xfedba97, 0x50020001, 0x6300
.long 0x650c3824, 0xfedba97, 0x15002, 0x3006
.long 0x641d0935, 0xfecba87, 0x520100, 0x3060
.long 0x641d0935, 0xfecba87, 0x5010020, 0x3600
.long 0x54e2a160, 0xfdcb987, 0x50002100, 0x6300
.long 0x54e2a160, 0xfdcb987, 0x150002, 0x3006
.long 0x765431a0, 0xfedcb98, 0x150020, 0x3060
.long 0x54f3b271, 0xedca986, 0x5000102, 0x3600
.long 0x54f3b271, 0xedca986, 0x50002010, 0x6300
.long 0x650c3824, 0xfedba97, 0x50102, 0x3006
.long 0x650c3824, 0xfedba97, 0x501002, 0x3060
.long 0x54f3b271, 0xedca986, 0x50102000, 0x6300
.long 0x54f3b271, 0xedca986, 0x250001, 0x3006
.long 0x650c3824, 0xfedba97, 0x520001, 0x3060
.long 0x765421b0, 0xfedca98, 0x1500020, 0x3600
.long 0x650c3824, 0xfedba97, 0x50000102, 0x6300
.long 0x641d0935, 0xfecba87, 0x51020, 0x3006
.long 0x641d0935, 0xfecba87, 0x510020, 0x3060
.long 0x54e2a160, 0xfdcb987, 0x5001002, 0x3600
.long 0x54e2a160, 0xfdcb987, 0x50102000, 0x6300
.long 0x54f3b271, 0xedca986, 0x51002, 0x3006
.long 0x54f3b271, 0xedca986, 0x502010, 0x3060
.long 0x765421b0, 0xfedca98, 0x5100002, 0x3600
.long 0x650c3824, 0xfedba97, 0x50020010, 0x6300
.long 0x650c3824, 0xfedba97, 0x15002, 0x3006
.long 0x641d0935, 0xfecba87, 0x500102, 0x3060
.long 0x641d0935, 0xfecba87, 0x5020010, 0x3600
.long 0x650c3824, 0xfedba97, 0x521000, 0x3006
.long 0x650c3824, 0xfedba97, 0x500021, 0x3060
.long 0x641d0935, 0xfecba87, 0x5000201, 0x3600
.long 0x76532c10, 0xfedba98, 0x15000200, 0x6300
.long 0x641d0935, 0xfecba87, 0x15002, 0x3006
.long 0x54e2a160, 0xfdcb987, 0x501020, 0x3060
.long 0x54e2a160, 0xfdcb987, 0x5000120, 0x3600
.long 0x54f3b271, 0xedca986, 0x50100020, 0x6300
.long 0x54f3b271, 0xedca986, 0x51002, 0x3006
.long 0x650c3824, 0xfedba97, 0x500102, 0x3060
.long 0x650c3824, 0xfedba97, 0x5000210, 0x3600
.long 0x76532c10, 0xfedba98, 0x25000100, 0x6300
.long 0x641d0935, 0xfecba87, 0x50102, 0x3006
.long 0x641d0935, 0xfecba87, 0x501002, 0x3060
.long 0x54e2a160, 0xfdcb987, 0x5002010, 0x3600
.long 0x54e2a160, 0xfdcb987, 0x50102000, 0x6300
.long 0x641d0935, 0xfecba87, 0x520001, 0x3060
.long 0x641d0935, 0xfecba87, 0x5010020, 0x3600
.long 0x54e2a160, 0xfdcb987, 0x50100020, 0x6300
.long 0x76432d10, 0xfecba98, 0x50201, 0x3006
.long 0x54e2a160, 0xfdcb987, 0x251000, 0x3060
.long 0x54f3b271, 0xedca986, 0x5002001, 0x3600
.long 0x54f3b271, 0xedca986, 0x50002010, 0x6300
.long 0x650c3824, 0xfedba97, 0x25100, 0x3006
.long 0x650c3824, 0xfedba97, 0x510020, 0x3060
.long 0x641d0935, 0xfecba87, 0x5000102, 0x3600
.long 0x641d0935, 0xfecba87, 0x50000012, 0x6300
.long 0x76432d10, 0xfecba98, 0x152000, 0x3006
.long 0x54e2a160, 0xfdcb987, 0x500012, 0x3060
.long 0x54e2a160, 0xfdcb987, 0x5210000, 0x3600
.long 0x54f3b271, 0xedca986, 0x50001020, 0x6300
.long 0x54f3b271, 0xedca986, 0x150020, 0x3006
.long 0x54e2a160, 0xfdcb987, 0x5200010, 0x3600
.long 0x54e2a160, 0xfdcb987, 0x50201000, 0x6300
.long 0x54f3b271, 0xedca986, 0x52100, 0x3006
.long 0x7543e210, 0xfdcba98, 0x520001, 0x3060
.long 0x54f3b271, 0xedca986, 0x5100002, 0x3600
.long 0x650c3824, 0xfedba97, 0x50000120, 0x6300
.long 0x650c3824, 0xfedba97, 0x521000, 0x3006
.long 0x641d0935, 0xfecba87, 0x500102, 0x3060
.long 0x641d0935, 0xfecba87, 0x5010002, 0x3600
.long 0x54e2a160, 0xfdcb987, 0x51200000, 0x6300
.long 0x54e2a160, 0xfdcb987, 0x150020, 0x3006
.long 0x7543e210, 0xfdcba98, 0x502010, 0x3060
.long 0x54f3b271, 0xedca986, 0x5002010, 0x3600
.long 0x54f3b271, 0xedca986, 0x50001002, 0x6300
.long 0x650c3824, 0xfedba97, 0x1025000, 0x3006
.long 0x650c3824, 0xfedba97, 0x510200, 0x3060
.long 0x54f3b271, 0xedca986, 0x50100020, 0x6300
.long 0x54f3b271, 0xedca986, 0x51020, 0x3006
.long 0x650c3824, 0xfedba97, 0x510200, 0x3060
.long 0x6543f210, 0xedcba98, 0x5102000, 0x3600
.long 0x650c3824, 0xfedba97, 0x15020000, 0x6300
.long 0x641d0935, 0xfecba87, 0x25100, 0x3006
.long 0x641d0935, 0xfecba87, 0x500210, 0x3060
.long 0x54e2a160, 0xfdcb987, 0x5201000, 0x3600
.long 0x54e2a160, 0xfdcb987, 0x50100002, 0x6300
.long 0x54f3b271, 0xedca986, 0x250001, 0x3006
.long 0x54f3b271, 0xedca986, 0x250010, 0x3060
.long 0x6543f210, 0xedcba98, 0x5002001, 0x3600
.long 0x650c3824, 0xfedba97, 0x50000012, 0x6300
.long 0x650c3824, 0xfedba97, 0x50120, 0x3006
.long 0x641d0935, 0xfecba87, 0x510020, 0x3060
.long 0x641d0935, 0xfecba87, 0x5000021, 0x3600
.fill 1, 4, 0
.size L_table, .-L_table
.section .rodata,"a"
.p2align 6
.amdhsa_kernel sequential_preLN__linear_kernel_hedgehog__moe_arch_mod__prompt_kernel
  .amdhsa_next_free_vgpr 256
  .amdhsa_next_free_sgpr 102
  .amdhsa_accum_offset 256
  .amdhsa_group_segment_fixed_size 0
  .amdhsa_kernarg_size 96
  .amdhsa_user_sgpr_count 2
  .amdhsa_user_sgpr_kernarg_segment_ptr 1
  .amdhsa_system_sgpr_workgroup_id_x 1
  .amdhsa_float_denorm_mode_32 3
.end_amdhsa_kernel
```

```asm
; @launch grid=(256,1,1) block=(512,1,1) lds=163840
.amdgcn_target "amdgcn-amd-amdhsa--gfx950"
.text
.p2align 10
.fill 64, 4, 0xbf800000
.globl sequential_preLN__linear_kernel_hedgehog__moe_arch_mod__prompt_kernel
.p2align 8
.type sequential_preLN__linear_kernel_hedgehog__moe_arch_mod__prompt_kernel,@function
sequential_preLN__linear_kernel_hedgehog__moe_arch_mod__prompt_kernel:
    s_load_dwordx2 s[28:29], s[0:1], 0
    s_load_dwordx2 s[32:33], s[0:1], 8
    s_getpc_b64 s[66:67]
L_pc:
    v_readfirstlane_b32 s79, v0
    s_lshr_b32 s60, s2, 3
    s_cmp_ge_u32 s60, 32
    s_cbranch_scc1 L_end
    v_and_b32_e64 v1, 63, v0
    s_and_b32 s60, s60, 15
    s_lshr_b32 s62, s79, 6
    s_cmp_ge_u32 s62, 4
    s_cbranch_scc1 L_compute
    s_setprio 3
    s_lshr_b32 s76, s2, 3
    s_lshl2_add_u32 s76, s76, s62
    s_mul_i32 s76, s76, 256
    v_lshl_add_u32 v91, v1, 7, s76
    s_mov_b64 exec, 3
    global_load_dword v27, v91, s[66:67]
    s_mov_b64 exec, -1
    s_add_u32 s84, s60, s2
    s_and_b32 s84, s84, 3
    s_and_b32 s76, s60, 7
    s_and_b32 s77, s2, 7
    s_cselect_b32 s84, s84, s76
    v_lshrrev_b32 v4, 3, v1
    v_and_b32 v5, 7, v1
    v_lshrrev_b32 v6, 4, v1
    s_lshl2_add_u32 s76, s60, s62
    s_lshl_b32 s76, s76, 16
    s_movk_i32 s70, 10240
    s_mul_i32 s70, s70, s62
    v_xor_b32 v7, v5, v6
    v_lshlrev_b32 v7, 4, v7
    v_lshl_add_u32 v78, v4, 11, v7
    v_add_u32_e64 v16, s76, v78
    s_mov_b32 s30, 4194304
    s_mov_b32 s31, 0x20000
    s_and_b32 s72, s84, 15
    s_mov_b32 m0, s70
    s_lshl_b32 s71, s72, 7
    s_waitcnt lgkmcnt(0)
    buffer_load_dwordx4 v16, s[28:31], s71 offen offset:0 lds
    s_mul_i32 s72, s72, 393216
    s_lshr_b64 s[84:85], s[84:85], 4
    s_load_dwordx4 s[8:11], s[0:1], 16
    s_load_dwordx16 s[12:27], s[0:1], 32
    v_xor_b32 v7, 64, v16
    v_add_u32 v17, 15360, v7
    buffer_load_dwordx4 v17, s[28:31], s71 offen offset:1024 lds
    v_add_u32 v18, 30720, v16
    buffer_load_dwordx4 v18, s[28:31], s71 offen offset:2048 lds
    v_add_u32 v19, 46080, v7
    buffer_load_dwordx4 v19, s[28:31], s71 offen offset:3072 lds
    s_and_b32 s76, s2, 7
    s_lshl_b32 s76, s76, 3
    s_lshr_b32 s77, s2, 7
    s_lshl2_add_u32 s76, s77, s76
    s_mov_b32 s80, 0x654210b3
    s_mov_b32 s81, 0xfedca987
    s_lshr_b64 s[80:81], s[80:81], s76
    s_and_b32 s61, s80, 15
    v_and_b32 v6, 1, v6
    v_lshlrev_b32 v6, 2, v6
    v_xor_b32 v8, v5, v6
    v_lshlrev_b32_e64 v8, 4, v8
    s_lshl_b32 s76, s61, 7
    s_mul_i32 s77, s62, 98304
    s_add_u32 s76, s76, s77
    v_mul_u32_u24 v7, 6144, v4
    v_add3_u32 v20, v7, v8, s76
    v_xor_b32 v7, 32, v20
    s_mov_b32 s34, 6291456
    s_mov_b32 s35, 0x20000
    s_add_u32 m0, s70, 4096
    s_nop 0
    buffer_load_dwordx4 v20, s[32:35], s72 offen offset:0 lds
    v_add_u32 v21, 48128, v7
    buffer_load_dwordx4 v21, s[32:35], s72 offen offset:1024 lds
    v_add_u32 v22, 0, v20
    buffer_load_dwordx4 v22, s[32:35], s72 offen offset:2048 lds
    v_add_u32 v23, 48128, v7
    buffer_load_dwordx4 v23, s[32:35], s72 offen offset:3072 lds
    v_add_u32 v24, 4096, v20
    s_add_u32 m0, s70, 8192
    s_nop 0
    buffer_load_dwordx4 v24, s[32:35], s72 offen offset:0 lds
    v_add_u32 v25, 52224, v7
    buffer_load_dwordx4 v25, s[32:35], s72 offen offset:1024 lds
    s_add_u32 s70, s70, 40960
    s_cmp_ge_u32 s70, 122880
    s_cselect_b32 s76, 122880, 0
    s_sub_u32 s70, s70, s76
    s_lshl_b32 s76, s60, 8
    s_lshl_b32 s77, s61, 4
    s_add_u32 s76, s76, s77
    s_add_u32 s76, s76, 30700
    s_load_dwordx4 s[84:87], s[66:67], s76
    v_lshl_add_u32 v26, v4, 11, v8
    v_xor_b32 v79, 64, v78
    s_and_b32 s63, s62, 1
    s_lshr_b32 s64, s62, 1
    s_lshl_b32 s73, s60, 4
    s_add_u32 s73, s73, s61
    s_mul_i32 s73, s73, 28800
    s_add_u32 s76, s2, 7
    s_and_b32 s76, s76, 7
    s_bfe_u32 s77, s2, 0x10003
    s_lshl1_add_u32 s97, s76, s77
    s_lshr_b32 s98, s2, 4
    s_lshl_b32 s99, s97, 4
    s_add_u32 s99, s99, s98
    s_mul_i32 s99, s99, 9344
    s_add_u32 s99, s99, 8388608
    s_lshr_b32 s65, s97, 1
    s_lshl_b32 s76, s97, 3
    s_add_u32 s65, s65, s76
    s_mul_i32 s76, s98, 4
    s_add_u32 s65, s65, s76
    s_and_b32 s65, s65, 15
    s_mov_b32 s89, 0x3f803f80
    s_mov_b32 s90, 0xffff0000
    v_and_b32 v2, 31, v1
    v_lshrrev_b32 v3, 5, v1
    v_lshlrev_b32 v12, 4, v1
    v_lshrrev_b32 v4, 3, v1
    v_mul_u32_u24 v13, 460800, v4
    v_and_b32_e64 v4, 7, v1
    v_lshl_add_u32 v13, v4, 4, v13
    s_lshl_b32 s76, s98, 7
    s_lshl_b32 s77, s62, 15
    s_add_u32 s76, s76, s77
    v_add_u32 v26, s76, v26
    v_mov_b32 v28, -1
    v_mov_b32 v29, -1
    v_mov_b32 v30, -1
    v_mov_b32 v31, -1
    s_waitcnt lgkmcnt(0)
    s_and_b32 s72, s84, 15
    s_mov_b32 m0, s70
    s_lshl_b32 s71, s72, 7
    buffer_load_dwordx4 v16, s[28:31], s71 offen offset:0 lds
    s_mul_i32 s72, s72, 393216
    s_lshr_b64 s[84:85], s[84:85], 4
    buffer_load_dwordx4 v17, s[28:31], s71 offen offset:1024 lds
    s_mov_b32 s40, s26
    s_and_b32 s41, s27, 0xffff
    s_mov_b32 s42, 33554432
    s_mov_b32 s43, 0x20000
    buffer_load_dwordx4 v18, s[28:31], s71 offen offset:2048 lds
    s_mov_b32 s56, s8
    s_and_b32 s57, s9, 0xffff
    s_mov_b32 s58, 65536
    s_mov_b32 s59, 0x20000
    buffer_load_dwordx4 v19, s[28:31], s71 offen offset:3072 lds
    s_add_u32 m0, s70, 4096
    s_nop 0
    buffer_load_dwordx4 v20, s[32:35], s72 offen offset:0 lds
    buffer_load_dwordx4 v21, s[32:35], s72 offen offset:1024 lds
    buffer_load_dwordx4 v22, s[32:35], s72 offen offset:2048 lds
    buffer_load_dwordx4 v23, s[32:35], s72 offen offset:3072 lds
    s_add_u32 m0, s70, 8192
    s_nop 0
    buffer_load_dwordx4 v24, s[32:35], s72 offen offset:0 lds
    buffer_load_dwordx4 v25, s[32:35], s72 offen offset:1024 lds
    s_add_u32 s70, s70, 40960
    s_cmp_ge_u32 s70, 122880
    s_cselect_b32 s76, 122880, 0
    s_sub_u32 s70, s70, s76
    s_lshl_b32 s77, s62, 10
    s_add_u32 s76, s77, s73
    buffer_store_dwordx4 v[28:31], v12, s[40:43], s76 offen sc1
    s_lshl_b32 s76, s61, 12
    s_add_u32 s76, s76, s77
    s_add_u32 m0, s77, 122880
    s_nop 0
    buffer_load_dwordx4 v12, s[56:59], s76 offen lds
    v_mov_b32 v4, 13631488
    buffer_load_dwordx2 v[88:89], v4, s[40:43], 0 offen
    s_setprio 0
    s_waitcnt vmcnt(13)
    s_barrier
    s_and_b32 s72, s84, 15
    s_mov_b32 m0, s70
    s_lshl_b32 s71, s72, 7
    buffer_load_dwordx4 v16, s[28:31], s71 offen offset:0 lds
    s_mul_i32 s72, s72, 393216
    s_lshr_b64 s[84:85], s[84:85], 4
    buffer_load_dwordx4 v17, s[28:31], s71 offen offset:1024 lds
    buffer_load_dwordx4 v18, s[28:31], s71 offen offset:2048 lds
    buffer_load_dwordx4 v19, s[28:31], s71 offen offset:3072 lds
    s_add_u32 m0, s70, 4096
    s_nop 0
    buffer_load_dwordx4 v20, s[32:35], s72 offen offset:0 lds
    buffer_load_dwordx4 v21, s[32:35], s72 offen offset:1024 lds
    buffer_load_dwordx4 v22, s[32:35], s72 offen offset:2048 lds
    buffer_load_dwordx4 v23, s[32:35], s72 offen offset:3072 lds
    s_add_u32 m0, s70, 8192
    s_nop 0
    buffer_load_dwordx4 v24, s[32:35], s72 offen offset:0 lds
    buffer_load_dwordx4 v25, s[32:35], s72 offen offset:1024 lds
    s_add_u32 s70, s70, 40960
    s_cmp_ge_u32 s70, 122880
    s_cselect_b32 s76, 122880, 0
    s_sub_u32 s70, s70, s76
    s_mov_b32 s36, s10
    s_and_b32 s37, s11, 0xffff
    s_mov_b32 s38, 2097152
    s_mov_b32 s39, 0x20000
    s_mov_b32 s44, s22
    s_and_b32 s45, s23, 0xffff
    s_mov_b32 s46, 4194304
    s_mov_b32 s47, 0x20000
    s_mov_b32 s52, s20
    s_and_b32 s53, s21, 0xffff
    s_mov_b32 s54, 7340032
    s_mov_b32 s55, 0x20000
    s_cmp_eq_u32 s64, 0
    s_cselect_b32 s48, s16, s18
    s_cselect_b32 s49, s17, s19
    s_and_b32 s49, s49, 0xffff
    s_mov_b32 s51, 0x20000
    s_cmp_lt_u32 s97, 14
    s_cselect_b32 s50, 7340032, 0
    s_cselect_b32 s54, 7340032, 0
    v_bfe_u32 v4, v2, 1, 3
    v_xor_b32 v4, v4, v3
    v_lshlrev_b32 v4, 4, v4
    v_lshl_add_u32 v72, v2, 7, v4
    v_bfe_u32 v4, v1, 2, 2
    v_lshl_add_u32 v5, v3, 3, v4
    v_lshlrev_b32 v5, 7, v5
    v_lshrrev_b32 v4, 1, v4
    v_xor_b32_e64 v4, s64, v4
    v_lshl_add_u32 v5, v4, 6, v5
    v_bfe_u32 v4, v1, 4, 1
    v_xor_b32_e64 v4, v4, v3
    v_lshl_add_u32 v5, v4, 5, v5
    v_and_b32_e64 v4, 3, v1
    v_lshl_add_u32 v5, v4, 3, v5
    s_mul_i32 s76, s62, 10240
    s_sub_u32 s76, 4096, s76
    v_add_u32 v73, s76, v5
    v_lshlrev_b32 v74, 3, v2
    v_lshrrev_b32 v4, 4, v1
    v_and_b32 v5, 15, v1
    v_mul_u32_u24 v66, 28800, v4
    v_lshl_add_u32 v66, v5, 4, v66
    v_mul_u32_u24 v75, 460800, v4
    v_lshl_add_u32 v75, v5, 4, v75
    v_lshrrev_b32 v4, 4, v1
    v_and_b32 v5, 15, v1
    v_mul_u32_u24 v76, 114688, v4
    v_lshl_add_u32 v76, v5, 4, v76
    v_lshlrev_b32_e64 v77, 4, v2
    v_lshl_add_u32 v77, v3, 11, v77
    s_mul_i32 s75, s98, 458752
    s_lshl_b32 s77, s97, 9
    s_add_u32 s75, s75, s77
    s_lshl_b32 s77, s63, 8
    s_add_u32 s75, s75, s77
    s_lshl_b32 s96, s97, 19
    s_lshl_b32 s77, s98, 15
    s_add_u32 s96, s96, s77
    s_lshl_b32 s77, s62, 9
    s_add_u32 s96, s96, s77
    s_mov_b32 s68, 1
    s_getreg_b32 s101, hwreg(HW_REG_XCC_ID, 0, 4)
    s_lshl_b32 s76, s61, 8
    s_add_u32 s76, s76, 12582912
    s_lshl_b32 s77, s60, 8
    s_add_u32 s77, s77, 12586752
    s_lshr_b32 s78, s97, 1
    s_lshl_b32 s78, s78, 9
    s_add_u32 s78, s78, 12590592
    v_mov_b32 v4, s76
    v_mov_b32 v5, s77
    v_mov_b32 v6, s78
    v_cmp_gt_u32 vcc, 16, v1
    s_nop 1
    v_cndmask_b32 v4, v5, v4, vcc
    v_cmp_gt_u32 vcc, 32, v1
    s_nop 1
    v_cndmask_b32 v4, v6, v4, vcc
    v_add_u32 v90, v4, v12
    s_waitcnt vmcnt(10)
    s_barrier
L_hloop:
    s_and_b32 s77, s86, 15
    s_cbranch_scc1 L_event
L_evret:
    s_and_b32 s72, s84, 15
    s_mov_b32 m0, s70
    s_lshl_b32 s71, s72, 7
    buffer_load_dwordx4 v16, s[28:31], s71 offen offset:0 lds
    s_mul_i32 s72, s72, 393216
    s_lshr_b64 s[84:85], s[84:85], 4
    buffer_load_dwordx4 v17, s[28:31], s71 offen offset:1024 lds
    buffer_load_dwordx4 v18, s[28:31], s71 offen offset:2048 lds
    buffer_load_dwordx4 v19, s[28:31], s71 offen offset:3072 lds
    s_add_u32 m0, s70, 4096
    s_nop 0
    buffer_load_dwordx4 v20, s[32:35], s72 offen offset:0 lds
    buffer_load_dwordx4 v21, s[32:35], s72 offen offset:1024 lds
    buffer_load_dwordx4 v22, s[32:35], s72 offen offset:2048 lds
    buffer_load_dwordx4 v23, s[32:35], s72 offen offset:3072 lds
    s_add_u32 m0, s70, 8192
    s_nop 0
    buffer_load_dwordx4 v24, s[32:35], s72 offen offset:0 lds
    buffer_load_dwordx4 v25, s[32:35], s72 offen offset:1024 lds
    s_add_u32 s70, s70, 40960
    s_cmp_ge_u32 s70, 122880
    s_cselect_b32 s76, 122880, 0
    s_sub_u32 s70, s70, s76
    s_waitcnt vmcnt(10)
L_hbar:
    s_lshr_b64 s[86:87], s[86:87], 4
    s_add_u32 s68, s68, 1
    s_cmp_lt_u32 s68, 14
    s_barrier
    s_cbranch_scc1 L_hloop
L_hdone:
    v_add_co_u32 v88, vcc, 1, v88
    s_nop 1
    v_addc_co_u32 v89, vcc, 0, v89, vcc
    v_cmp_ne_u64 vcc, v[92:93], v[88:89]
    s_nop 0
    s_cbranch_vccz L_hello_ok_1
    s_mov_b32 s88, 0
L_spin_2:
    buffer_load_dwordx4 v[92:95], v90, s[40:43], 0 offen sc1
    s_waitcnt vmcnt(0)
    v_cmp_ne_u64 vcc, v[92:93], v[88:89]
    s_nop 0
    s_cbranch_vccz L_hello_ok_1
    s_add_u32 s88, s88, 1
    s_cmp_lt_u32 s88, 65536
    s_cbranch_scc1 L_spin_2
L_hello_ok_1:
    v_cmp_ne_u32_e64 vcc, s101, v94
    s_nop 0
    s_and_b32 s76, vcc_lo, 0xffff
    s_cselect_b32 s100, 0, 1
    s_cmp_eq_u32 vcc_hi, 0
    s_cselect_b32 s76, 2, 0
    s_or_b32 s100, s100, s76
    v_mov_b32 v4, s100
    v_mov_b32 v5, 0
    ds_write_b32 v5, v4 offset:53248
    s_lshl_b32 s81, s62, 8
    s_mul_i32 s80, s60, 460800
    s_add_u32 s80, s80, s81
    buffer_load_dwordx4 v[32:35], v66, s[40:43], s80 offen offset:0 sc1
    s_add_u32 s80, s80, 115200
    buffer_load_dwordx4 v[36:39], v66, s[40:43], s80 offen offset:0 sc1
    s_add_u32 s80, s80, 115200
    buffer_load_dwordx4 v[40:43], v66, s[40:43], s80 offen offset:0 sc1
    s_add_u32 s80, s80, 115200
    buffer_load_dwordx4 v[44:47], v66, s[40:43], s80 offen offset:0 sc1
    s_mul_i32 s80, s61, 28800
    s_add_u32 s80, s80, s81
    buffer_load_dwordx4 v[48:51], v75, s[40:43], s80 offen offset:1024 sc1
    s_add_u32 s80, s80, 1843200
    buffer_load_dwordx4 v[52:55], v75, s[40:43], s80 offen offset:1024 sc1
    s_add_u32 s80, s80, 1843200
    buffer_load_dwordx4 v[56:59], v75, s[40:43], s80 offen offset:1024 sc1
    s_add_u32 s80, s80, 1843200
    buffer_load_dwordx4 v[60:63], v75, s[40:43], s80 offen offset:1024 sc1
    v_bfe_u32 v10, v1, 4, 1
    v_lshl_add_u32 v10, v10, 1, v3
    v_min_u32 v10, 2, v10
    v_and_b32 v7, 15, v1
    v_lshlrev_b32_e64 v7, 3, v7
    s_lshl_b32 s76, s62, 7
    v_lshl_add_u32 v10, v10, 9, v7
    v_add_u32_e64 v64, s76, v10
    v_lshl_add_u32 v65, v7, 1, s81
    v_bfe_u32 v10, v1, 4, 1
    v_lshl_add_u32 v65, v10, 3, v65
    s_waitcnt vmcnt(8)
    s_barrier
    s_mul_i32 s78, s62, 2048
    s_add_u32 s78, s78, s99
    s_add_u32 s78, s78, 1024
    v_lshlrev_b32 v11, 7, v1
    s_mov_b64 exec, 65535
    buffer_load_dword v27, v11, s[40:43], s78 offen sc1
    s_mov_b64 exec, -1
    buffer_load_dwordx4 v[152:155], v76, s[48:51], s75 offen nt
    s_add_u32 s75, s75, 7168
    s_add_u32 s78, s65, 0
    s_and_b32 s78, s78, 15
    s_lshl_b32 s78, s78, 17
    s_lshl_b32 s79, s62, 11
    s_add_u32 m0, s79, 57344
    s_add_u32 s79, s78, 15360
    buffer_load_dwordx4 v26, s[36:39], s78 offen lds
    buffer_load_dwordx4 v26, s[36:39], s79 offen offset:1024 lds
    s_add_u32 s78, s65, 1
    s_and_b32 s78, s78, 15
    s_lshl_b32 s78, s78, 17
    s_lshl_b32 s79, s62, 11
    s_add_u32 m0, s79, 65536
    s_add_u32 s79, s78, 15360
    buffer_load_dwordx4 v26, s[36:39], s78 offen lds
    buffer_load_dwordx4 v26, s[36:39], s79 offen offset:1024 lds
    s_setprio 3
    s_mov_b32 s88, 0
    s_waitcnt vmcnt(10)
    s_branch L_g1first_3
L_g1_4:
    s_mul_i32 s80, s60, 460800
    s_add_u32 s80, s80, s81
    buffer_load_dwordx4 v[32:35], v66, s[40:43], s80 offen offset:0 sc1
    s_add_u32 s80, s80, 115200
    buffer_load_dwordx4 v[36:39], v66, s[40:43], s80 offen offset:0 sc1
    s_add_u32 s80, s80, 115200
    buffer_load_dwordx4 v[40:43], v66, s[40:43], s80 offen offset:0 sc1
    s_add_u32 s80, s80, 115200
    buffer_load_dwordx4 v[44:47], v66, s[40:43], s80 offen offset:0 sc1
    s_waitcnt vmcnt(0)
L_g1first_3:
    v_max3_u32 v4, v32, v34, v36
    v_max3_u32 v4, v4, v38, v40
    v_max3_u32 v4, v4, v42, v44
    v_max_u32 v4, v4, v46
    v_cmp_eq_u32 vcc, -1, v4
    s_nop 0
    s_cbranch_vccz L_ok_5
    s_add_u32 s88, s88, 1
    s_cmp_lt_u32 s88, 65536
    s_cbranch_scc1 L_g1_4
L_ok_5:
    v_add_f32 v32, v32, v40
    v_add_f32 v33, v33, v41
    v_add_f32 v34, v34, v42
    v_add_f32 v35, v35, v43
    v_add_f32 v36, v36, v44
    v_add_f32 v37, v37, v45
    v_add_f32 v38, v38, v46
    v_add_f32 v39, v39, v47
    v_add_f32 v32, v32, v36
    v_add_f32 v33, v33, v37
    v_add_f32 v34, v34, v38
    v_add_f32_e64 v35, v35, v39
    s_add_u32 s78, s65, 2
    s_and_b32 s78, s78, 15
    s_lshl_b32 s78, s78, 17
    s_lshl_b32 s79, s62, 11
    s_add_u32 m0, s79, 73728
    s_add_u32 s79, s78, 15360
    buffer_load_dwordx4 v26, s[36:39], s78 offen lds
    buffer_load_dwordx4 v26, s[36:39], s79 offen offset:1024 lds
    v_permlane32_swap_b32 v32, v33
    v_permlane32_swap_b32 v34, v35
    v_add_f32 v32, v32, v33
    v_add_f32 v34, v34, v35
    s_nop 1
    v_permlane16_swap_b32 v32, v34
    v_add_f32 v32, v32, v34
    v_mov_b32 v33, v32
    s_nop 1
    v_permlane32_swap_b32 v32, v33
    v_mul_f32 v32, 0x3a800000, v32
    v_mul_f32 v33, 0x3a800000, v33
    v_fma_f32 v7, -v32, v32, v33
    v_max_f32_e64 v7, 0, v7
    v_cvt_pk_bf16_f32 v5, v32, v32
    v_and_b32_e64 v5, s90, v5
    v_cvt_pk_bf16_f32 v7, v7, v7
    v_and_b32_e64 v7, s90, v7
    v_add_f32 v7, 0x3727c5ac, v7
    v_cvt_pk_bf16_f32 v7, v7, v7
    v_and_b32 v7, s90, v7
    v_sqrt_f32_e64 v7, v7
    s_nop 0
    v_cvt_pk_bf16_f32 v7, v7, v7
    v_and_b32 v7, s90, v7
    v_rcp_f32 v9, v7
    v_xor_b32 v5, 0x80000000, v5
    v_cvt_pk_bf16_f32 v8, v5, v5
    ds_write_b64 v65, v[8:9] offset:49152
    s_mov_b32 s88, 0
    s_waitcnt vmcnt(8)
    s_branch L_g1first_6
L_g1_7:
    s_mul_i32 s80, s61, 28800
    s_add_u32 s80, s80, s81
    buffer_load_dwordx4 v[48:51], v75, s[40:43], s80 offen offset:1024 sc1
    s_add_u32 s80, s80, 1843200
    buffer_load_dwordx4 v[52:55], v75, s[40:43], s80 offen offset:1024 sc1
    s_add_u32 s80, s80, 1843200
    buffer_load_dwordx4 v[56:59], v75, s[40:43], s80 offen offset:1024 sc1
    s_add_u32 s80, s80, 1843200
    buffer_load_dwordx4 v[60:63], v75, s[40:43], s80 offen offset:1024 sc1
    s_waitcnt vmcnt(0)
L_g1first_6:
    v_max3_u32 v4, v48, v50, v52
    v_max3_u32 v4, v4, v54, v56
    v_max3_u32 v4, v4, v58, v60
    v_max_u32 v4, v4, v62
    v_cmp_eq_u32 vcc, -1, v4
    s_nop 0
    s_cbranch_vccz L_ok_8
    s_add_u32 s88, s88, 1
    s_cmp_lt_u32 s88, 65536
    s_cbranch_scc1 L_g1_7
L_ok_8:
    v_add_f32 v48, v48, v56
    v_add_f32 v49, v49, v57
    v_add_f32 v50, v50, v58
    v_add_f32 v51, v51, v59
    v_add_f32 v52, v52, v60
    v_add_f32 v53, v53, v61
    v_add_f32 v54, v54, v62
    v_add_f32 v55, v55, v63
    v_add_f32 v48, v48, v52
    v_add_f32 v49, v49, v53
    v_add_f32 v50, v50, v54
    v_add_f32 v51, v51, v55
    v_add_f32 v49, v49, v51
    v_mov_b32 v51, v49
    v_permlane32_swap_b32 v48, v50
    s_nop 0
    v_permlane32_swap_b32 v49, v51
    v_add_f32 v48, v48, v50
    v_add_f32 v49, v49, v51
    s_nop 1
    v_permlane16_swap_b32 v48, v49
    v_add_f32_e64 v48, v48, v49
    v_cvt_pk_bf16_f32 v49, v48, v48
    v_and_b32 v49, s90, v49
    v_sub_f32 v49, v48, v49
    v_cvt_pk_bf16_f32 v50, v48, v49
    v_and_b32 v51, s90, v50
    v_sub_f32 v49, v49, v51
    v_cvt_pk_bf16_f32 v51, v49, 0
    ds_write_b64 v64, v[50:51] offset:50176
    s_setprio 0
    s_waitcnt lgkmcnt(0)
    s_barrier
    s_add_u32 s78, s65, 3
    s_and_b32 s78, s78, 15
    s_lshl_b32 s78, s78, 17
    s_lshl_b32 s79, s62, 11
    s_add_u32 m0, s79, 81920
    s_add_u32 s79, s78, 15360
    buffer_load_dwordx4 v26, s[36:39], s78 offen lds
    buffer_load_dwordx4 v26, s[36:39], s79 offen offset:1024 lds
    s_add_u32 s78, s65, 4
    s_and_b32 s78, s78, 15
    s_lshl_b32 s78, s78, 17
    s_lshl_b32 s79, s62, 11
    s_add_u32 m0, s79, 90112
    s_add_u32 s79, s78, 15360
    buffer_load_dwordx4 v26, s[36:39], s78 offen lds
    buffer_load_dwordx4 v26, s[36:39], s79 offen offset:1024 lds
    s_lshl_b32 s78, s62, 11
    s_add_u32 s79, s78, s99
    s_bitcmp1_b32 s100, 0
    s_cbranch_scc1 L_loc_9
    buffer_store_dwordx4 v[28:31], v12, s[40:43], s79 offen offset:1024 sc1
    buffer_store_dwordx4 v[28:31], v12, s[40:43], s79 offen offset:2048 sc1
    s_branch L_pubd_10
L_loc_9:
    buffer_store_dwordx4 v[28:31], v12, s[40:43], s79 offen offset:1024
    buffer_store_dwordx4 v[28:31], v12, s[40:43], s79 offen offset:2048
L_pubd_10:
    s_lshl_b32 s79, s62, 8
    s_add_u32 s79, s79, s99
    s_mov_b64 exec, 0xffff
    buffer_store_dwordx4 v[28:31], v12, s[40:43], s79 offen sc1
    s_mov_b64 exec, -1
    s_add_u32 s78, s65, 5
    s_and_b32 s78, s78, 15
    s_lshl_b32 s78, s78, 17
    s_lshl_b32 s79, s62, 11
    s_add_u32 m0, s79, 98304
    s_add_u32 s79, s78, 15360
    buffer_load_dwordx4 v26, s[36:39], s78 offen lds
    buffer_load_dwordx4 v26, s[36:39], s79 offen offset:1024 lds
    s_add_u32 s78, s65, 6
    s_and_b32 s78, s78, 15
    s_lshl_b32 s78, s78, 17
    s_lshl_b32 s79, s62, 11
    s_add_u32 m0, s79, 106496
    s_add_u32 s79, s78, 15360
    buffer_load_dwordx4 v26, s[36:39], s78 offen lds
    buffer_load_dwordx4 v26, s[36:39], s79 offen offset:1024 lds
    s_add_u32 s78, s65, 7
    s_and_b32 s78, s78, 15
    s_lshl_b32 s78, s78, 17
    s_lshl_b32 s79, s62, 11
    s_add_u32 m0, s79, 114688
    s_add_u32 s79, s78, 15360
    buffer_load_dwordx4 v26, s[36:39], s78 offen lds
    buffer_load_dwordx4 v26, s[36:39], s79 offen offset:1024 lds
    s_mul_i32 s78, s62, 384
    s_add_u32 s78, s78, s73
    s_add_u32 s78, s78, 2048
    v_lshlrev_b32 v11, 7, v1
    s_mov_b64 exec, 7
    buffer_load_dword v27, v11, s[40:43], s78 offen sc1
    s_mov_b64 exec, -1
    s_waitcnt vmcnt(7)
    s_lshl_b32 s76, s62, 2
    s_add_u32 s76, s76, s73
    v_mov_b32 v4, 0
    s_mov_b64 exec, 1
    s_bitcmp1_b32 s100, 0
    s_cbranch_scc1 L_loc_11
    buffer_store_dword v4, v4, s[40:43], s76 offen offset:2560 sc1
    s_branch L_pubd_12
L_loc_11:
    buffer_store_dword v4, v4, s[40:43], s76 offen offset:2560
L_pubd_12:
    s_mov_b64 exec, -1
    s_add_u32 s78, s65, 8
    s_and_b32 s78, s78, 15
    s_lshl_b32 s78, s78, 17
    s_lshl_b32 s79, s62, 11
    s_add_u32 m0, s79, 122880
    s_add_u32 s79, s78, 15360
    buffer_load_dwordx4 v26, s[36:39], s78 offen lds
    buffer_load_dwordx4 v26, s[36:39], s79 offen offset:1024 lds
    s_add_u32 s78, s65, 9
    s_and_b32 s78, s78, 15
    s_lshl_b32 s78, s78, 17
    s_lshl_b32 s79, s62, 11
    s_add_u32 m0, s79, 131072
    s_add_u32 s79, s78, 15360
    buffer_load_dwordx4 v26, s[36:39], s78 offen lds
    buffer_load_dwordx4 v26, s[36:39], s79 offen offset:1024 lds
    s_add_u32 s78, s65, 10
    s_and_b32 s78, s78, 15
    s_lshl_b32 s78, s78, 17
    s_lshl_b32 s79, s62, 11
    s_add_u32 m0, s79, 139264
    s_add_u32 s79, s78, 15360
    buffer_load_dwordx4 v26, s[36:39], s78 offen lds
    buffer_load_dwordx4 v26, s[36:39], s79 offen offset:1024 lds
    v_and_b32_e64 v65, 15, v1
    v_mul_u32_u24 v65, 460800, v65
    s_mul_i32 s80, s61, 28800
    s_lshl_b32 s82, s62, 2
    s_add_u32 s82, s82, s80
    v_bfe_u32 v4, v1, 4, 1
    v_lshl_add_u32 v4, v4, 1, v3
    s_lshl_b32 s77, s62, 6
    v_lshl_add_u32 v66, v4, 1, s77
    v_bfe_u32 v4, v1, 2, 1
    v_lshl_add_u32 v66, v4, 5, v66
    v_bfe_u32 v4, v1, 0, 1
    v_lshl_add_u32 v66, v4, 4, v66
    v_bfe_u32 v4, v1, 1, 1
    v_lshl_add_u32 v66, v4, 3, v66
    s_lshl_b32 s83, s62, 7
    s_add_u32 s81, s83, s80
    s_add_u32 s68, s81, 3686400
    s_add_u32 s83, s83, s73
    v_and_b32 v4, 7, v1
    v_lshrrev_b32 v5, 4, v1
    v_lshlrev_b32_e64 v5, 2, v5
    v_lshl_add_u32 v67, v4, 4, v5
    v_bfe_u32 v5, v1, 3, 1
    v_lshrrev_b32_e64 v6, 4, v1
    v_lshl_add_u32 v5, v5, 4, v6
    v_mul_u32_u24 v5, 9344, v5
    v_lshl_add_u32 v61, v4, 4, v5
    s_lshr_b32 s69, s97, 1
    s_lshr_b32 s76, s2, 7
    s_lshl2_add_u32 s69, s69, s76
    s_mul_i32 s69, s69, 74752
    s_add_u32 s69, s69, 8389632
    s_barrier
    s_add_u32 s78, s65, 11
    s_and_b32 s78, s78, 15
    s_lshl_b32 s78, s78, 17
    s_lshl_b32 s79, s62, 11
    s_add_u32 m0, s79, 147456
    s_add_u32 s79, s78, 15360
    buffer_load_dwordx4 v26, s[36:39], s78 offen lds
    buffer_load_dwordx4 v26, s[36:39], s79 offen offset:1024 lds
    s_add_u32 s78, s65, 12
    s_and_b32 s78, s78, 15
    s_lshl_b32 s78, s78, 17
    s_lshl_b32 s79, s62, 11
    s_add_u32 m0, s79, 155648
    s_add_u32 s79, s78, 15360
    buffer_load_dwordx4 v26, s[36:39], s78 offen lds
    buffer_load_dwordx4 v26, s[36:39], s79 offen offset:1024 lds
    buffer_load_dword v64, v65, s[40:43], s82 offen offset:2560 sc1
    s_barrier
    s_setprio 3
    v_mov_b32 v4, s89
    v_lshlrev_b32 v5, 2, v1
    ds_write_b32 v5, v4 offset:24832
    v_mov_b32 v70, 0
    v_mov_b32 v71, 0
    ds_write_b64 v70, v[70:71] offset:25984
    s_mov_b32 s88, 0
    s_branch L_p2first_13
L_p2_14:
    buffer_load_dword v64, v65, s[40:43], s82 offen offset:2560 sc1
L_p2first_13:
    s_waitcnt vmcnt(0)
    v_cmp_eq_u32_e64 vcc, -1, v64
    s_nop 0
    s_cbranch_vccz L_ok_15
    s_add_u32 s88, s88, 1
    s_cmp_lt_u32 s88, 65536
    s_cbranch_scc1 L_p2_14
L_ok_15:
    s_add_u32 s78, s65, 13
    s_and_b32 s78, s78, 15
    s_lshl_b32 s78, s78, 17
    s_lshl_b32 s79, s62, 11
    s_add_u32 m0, s79, 32768
    s_add_u32 s79, s78, 15360
    buffer_load_dwordx4 v26, s[36:39], s78 offen lds
    buffer_load_dwordx4 v26, s[36:39], s79 offen offset:1024 lds
    s_add_u32 s78, s65, 14
    s_and_b32 s78, s78, 15
    s_lshl_b32 s78, s78, 17
    s_lshl_b32 s79, s62, 11
    s_add_u32 m0, s79, 40960
    s_add_u32 s79, s78, 15360
    buffer_load_dwordx4 v26, s[36:39], s78 offen lds
    buffer_load_dwordx4 v26, s[36:39], s79 offen offset:1024 lds
    s_add_u32 s78, s65, 15
    s_and_b32 s78, s78, 15
    s_lshl_b32 s78, s78, 17
    s_lshl_b32 s79, s62, 11
    s_add_u32 m0, s79, 49152
    s_add_u32 s79, s78, 15360
    buffer_load_dwordx4 v26, s[36:39], s78 offen lds
    buffer_load_dwordx4 v26, s[36:39], s79 offen offset:1024 lds
    s_lshl_b32 s76, s62, 11
    s_lshl_b32 s77, s60, 7
    s_add_u32 s76, s76, s77
    s_add_u32 s76, s76, s69
    s_add_u32 s77, s76, 37376
    s_mov_b32 s78, 0x00003f80
    s_mov_b32 s79, 0x3f800000
    s_mov_b32 s88, 0
L_poll_16:
    buffer_load_dwordx4 v[32:35], v61, s[40:43], s76 offen sc1
    buffer_load_dwordx4 v[36:39], v61, s[40:43], s77 offen sc1
    s_waitcnt vmcnt(0)
    v_max_u32 v4, v32, v36
    v_cmp_eq_u32_e64 vcc, -1, v4
    s_nop 0
    s_cbranch_vccz L_ok_17
    s_add_u32 s88, s88, 1
    s_cmp_lt_u32 s88, 65536
    s_cbranch_scc1 L_poll_16
L_ok_17:
    v_dot2_f32_bf16 v48, v32, s78, 0
    v_dot2_f32_bf16 v49, v32, s79, 0
    v_dot2_f32_bf16 v50, v33, s78, 0
    v_dot2_f32_bf16 v51, v33, s79, 0
    v_dot2_f32_bf16 v52, v34, s78, 0
    v_dot2_f32_bf16 v53, v34, s79, 0
    v_dot2_f32_bf16 v54, v35, s78, 0
    v_dot2_f32_bf16 v55, v35, s79, 0
    v_dot2_f32_bf16 v48, v36, s78, v48
    v_dot2_f32_bf16 v49, v36, s79, v49
    v_dot2_f32_bf16 v50, v37, s78, v50
    v_dot2_f32_bf16 v51, v37, s79, v51
    v_dot2_f32_bf16 v52, v38, s78, v52
    v_dot2_f32_bf16 v53, v38, s79, v53
    v_dot2_f32_bf16 v54, v39, s78, v54
    v_dot2_f32_bf16 v55, v39, s79, v55
    buffer_load_dwordx4 v[40:43], v13, s[40:43], s81 offen offset:2048 sc1
    buffer_load_dwordx4 v[44:47], v13, s[40:43], s68 offen offset:2048 sc1
    v_permlane32_swap_b32 v48, v52
    v_permlane32_swap_b32 v49, v53
    v_permlane32_swap_b32 v50, v54
    v_permlane32_swap_b32 v51, v55
    v_add_f32 v48, v48, v52
    v_add_f32 v49, v49, v53
    v_add_f32 v50, v50, v54
    v_add_f32 v51, v51, v55
    s_nop 0
    v_permlane16_swap_b32 v48, v50
    v_permlane16_swap_b32 v49, v51
    v_add_f32 v48, v48, v50
    v_add_f32_e64 v49, v49, v51
    s_nop 0
    v_add_f32_dpp v48, v48, v48 row_ror:8 row_mask:0xf bank_mask:0xf
    v_add_f32_dpp v49, v49, v49 row_ror:8 row_mask:0xf bank_mask:0xf
    v_cvt_pk_bf16_f32 v48, v48, v49
    s_bitcmp1_b32 s100, 0
    s_cbranch_scc1 L_loc_18
    buffer_store_dword v48, v67, s[40:43], s83 offen offset:3072 sc1
    s_branch L_pubd_19
L_loc_18:
    buffer_store_dword v48, v67, s[40:43], s83 offen offset:3072
L_pubd_19:
    s_mov_b32 s88, 0
    s_waitcnt vmcnt(1)
    s_branch L_zfirst_20
L_z_21:
    buffer_load_dwordx4 v[40:43], v13, s[40:43], s81 offen offset:2048 sc1
    buffer_load_dwordx4 v[44:47], v13, s[40:43], s68 offen offset:2048 sc1
    s_waitcnt vmcnt(0)
L_zfirst_20:
    v_max3_u32 v4, v40, v41, v42
    v_max3_u32 v4, v4, v43, v44
    v_max3_u32 v4, v4, v45, v46
    v_max_u32 v4, v4, v47
    v_cmp_eq_u32 vcc, -1, v4
    s_nop 0
    s_cbranch_vccz L_ok_22
    s_add_u32 s88, s88, 1
    s_cmp_lt_u32 s88, 65536
    s_cbranch_scc1 L_z_21
L_ok_22:
    v_add_f32 v40, v40, v44
    v_add_f32 v41, v41, v45
    v_add_f32 v42, v42, v46
    v_add_f32 v43, v43, v47
    v_permlane32_swap_b32 v40, v41
    s_nop 0
    v_permlane32_swap_b32 v42, v43
    v_add_f32 v40, v40, v41
    v_add_f32 v42, v42, v43
    s_nop 1
    v_permlane16_swap_b32 v40, v42
    v_add_f32 v40, v40, v42
    s_nop 1
    v_add_f32_dpp v40, v40, v40 row_ror:8 row_mask:0xf bank_mask:0xf
    v_cvt_pk_bf16_f32 v40, v40, v40
    ds_write_b16 v66, v40 offset:24576
    s_waitcnt lgkmcnt(0)
    s_barrier
    s_setprio 0
    s_mov_b64 exec, 3
    global_load_dword v27, v91, s[66:67]
    s_mov_b64 exec, -1
    s_lshl_b32 s78, s97, 18
    s_lshl_b32 s79, s62, 16
    s_add_u32 s78, s78, s79
    s_lshl_b32 s79, s98, 7
    s_add_u32 s78, s78, s79
    s_lshl_b32 s79, s62, 12
    s_add_u32 m0, s79, 0
    s_nop 0
    buffer_load_dwordx4 v78, s[28:31], s78 offen offset:0 lds
    s_add_u32 s78, s78, 15360
    buffer_load_dwordx4 v79, s[28:31], s78 offen offset:1024 lds
    s_add_u32 s78, s78, 15360
    buffer_load_dwordx4 v78, s[28:31], s78 offen offset:2048 lds
    s_add_u32 s78, s78, 15360
    buffer_load_dwordx4 v79, s[28:31], s78 offen offset:3072 lds
    s_mov_b32 s56, s14
    s_and_b32 s57, s15, 0xffff
    s_mov_b32 s58, 2048
    s_mov_b32 s59, 0x20000
    s_lshl_b32 s78, s62, 9
    s_add_u32 m0, s78, 16384
    s_mov_b32 exec_hi, 0
    buffer_load_dwordx4 v12, s[56:59], s78 offen lds
    s_mov_b64 exec, -1
    s_barrier
    s_lshl4_add_u32 s76, s97, s98
    s_mul_i32 s76, s76, 28800
    s_add_u32 s20, s26, s76
    s_addc_u32 s21, s27, 0
    s_cmp_eq_u32 s62, 0
    s_cbranch_scc0 L_now0_25
    s_load_dwordx16 s[4:19], s[20:21], 3584 glc
    s_waitcnt lgkmcnt(0)
    s_and_b64 s[4:5], s[4:5], s[6:7]
    s_and_b64 s[4:5], s[4:5], s[8:9]
    s_and_b64 s[4:5], s[4:5], s[10:11]
    s_and_b64 s[4:5], s[4:5], s[12:13]
    s_and_b64 s[4:5], s[4:5], s[14:15]
    s_and_b64 s[4:5], s[4:5], s[16:17]
    s_and_b64 s[4:5], s[4:5], s[18:19]
    s_nand_b32 s4, s4, s5
    s_and_b32 s4, s4, 0xffff
    s_mul_i32 s4, s4, 0x10001
    s_lshr_b32 s4, s4, s65
    s_and_b32 s77, s4, 0xffff
    v_mov_b32_e64 v69, s77
    s_mov_b64 exec, 1
    ds_or_b32 v70, v69 offset:25984
    s_mov_b64 exec, -1
    s_waitcnt vmcnt(0) lgkmcnt(0)
    s_load_dwordx16 s[4:19], s[20:21], 3584 glc
    s_barrier
    s_mov_b32 s88, 0
    s_branch L_fo2
L_now0_25:
    s_waitcnt vmcnt(0) lgkmcnt(0)
    s_barrier
    s_cmp_eq_u32 s62, 0
    s_cbranch_scc0 L_now1_23
    s_mov_b32 s88, 0
L_spin_26:
    s_load_dwordx16 s[4:19], s[20:21], 3584 glc
L_fo2:
    s_waitcnt lgkmcnt(0)
    s_and_b64 s[4:5], s[4:5], s[6:7]
    s_and_b64 s[4:5], s[4:5], s[8:9]
    s_and_b64 s[4:5], s[4:5], s[10:11]
    s_and_b64 s[4:5], s[4:5], s[12:13]
    s_and_b64 s[4:5], s[4:5], s[14:15]
    s_and_b64 s[4:5], s[4:5], s[16:17]
    s_and_b64 s[4:5], s[4:5], s[18:19]
    s_nand_b32 s4, s4, s5
    s_and_b32 s4, s4, 0xffff
    s_mul_i32 s4, s4, 0x10001
    s_lshr_b32 s4, s4, s65
    s_and_b32 s77, s4, 0xffff
    v_mov_b32 v69, s77
    s_mov_b64 exec, 1
    ds_or_b32 v70, v69 offset:25984
    s_mov_b64 exec, -1
    s_cmp_eq_u32 s77, 0xffff
    s_cbranch_scc1 L_s2done_24
    s_add_u32 s88, s88, 1
    s_cmp_lt_u32 s88, 65536
    s_cbranch_scc1 L_spin_26
    s_branch L_s2done_24
L_now1_23:
    s_cmp_eq_u32 s62, 1
    s_cbranch_scc0 L_s2done_24
    s_lshl_b32 s77, 1, s61
    s_not_b32 s77, s77
    v_mov_b32 v4, s77
    v_mul_u32_u24 v5, 28800, v1
    s_mul_i32 s76, s60, 460800
    s_lshl2_add_u32 s76, s61, s76
    s_mov_b32 s88, 0
L_spin_27:
    ds_read_b32 v69, v70 offset:25988
    s_waitcnt lgkmcnt(0)
    v_cmp_eq_u32_e64 vcc, 4, v69
    s_nop 0
    s_cbranch_vccnz L_drained_28
    s_add_u32 s88, s88, 1
    s_cmp_lt_u32 s88, 1048576
    s_cbranch_scc1 L_spin_27
L_drained_28:
    s_mov_b64 exec, 0xffff
    buffer_store_dword v4, v5, s[40:43], s76 offen offset:3584 sc1
    s_mov_b64 exec, -1
L_s2done_24:
    s_waitcnt vmcnt(0)
    v_lshlrev_b32 v17, 5, v2
    v_lshl_add_u32 v17, v3, 4, v17
    v_and_b32 v4, 15, v1
    v_lshrrev_b32 v5, 1, v4
    v_and_b32 v4, 1, v4
    v_lshlrev_b32 v4, 5, v4
    v_lshl_add_u32 v16, v5, 7, v4
    v_lshrrev_b32 v4, 3, v1
    v_and_b32 v5, 7, v1
    v_lshlrev_b32_e64 v5, 4, v5
    v_mul_u32_u24 v18, 9344, v4
    v_add_u32_e64 v18, v18, v5
    v_bfe_u32 v6, v1, 4, 1
    v_lshl_add_u32 v6, v6, 1, v3
    v_lshl_add_u32 v19, v6, 2, v5
    s_mul_i32 s84, s97, 149504
    s_lshl_b32 s77, s98, 7
    s_add_u32 s84, s84, s77
    s_add_u32 s84, s84, 8388608
    s_lshl_b32 s85, s62, 10
    s_add_u32 s85, s85, s99
    s_add_u32 s85, s85, 5120
    s_and_b32 s87, s97, 1
    s_lshl_b32 s87, s87, 4
    s_add_u32 s87, s87, s98
    s_lshr_b32 s86, s97, 1
    s_mul_i32 s86, s86, 299008
    s_lshl_b32 s77, s87, 7
    s_add_u32 s86, s86, s77
    s_add_u32 s86, s86, 8393728
    s_lshl_b32 s78, s62, 11
    s_add_u32 s79, s78, s99
    s_bitcmp1_b32 s100, 1
    s_cbranch_scc1 L_loc_29
    buffer_store_dwordx4 v[28:31], v12, s[40:43], s79 offen offset:1024 sc1
    buffer_store_dwordx4 v[28:31], v12, s[40:43], s79 offen offset:2048 sc1
    s_branch L_pubd_30
L_loc_29:
    buffer_store_dwordx4 v[28:31], v12, s[40:43], s79 offen offset:1024
    buffer_store_dwordx4 v[28:31], v12, s[40:43], s79 offen offset:2048
L_pubd_30:
    s_lshl4_add_u32 s78, s97, s98
    s_lshl4_add_u32 s78, s78, s62
    s_add_u32 s78, s78, 12591116
    s_waitcnt vmcnt(0)
    s_mov_b64 exec, 1
    s_bitcmp1_b32 s100, 1
    s_cbranch_scc1 L_loc_31
    buffer_store_byte v28, v70, s[40:43], s78 offen sc1
    s_branch L_pubd_32
L_loc_31:
    buffer_store_byte v28, v70, s[40:43], s78 offen
L_pubd_32:
    s_mov_b64 exec, -1
    s_cmp_eq_u32 s62, 0
    s_cbranch_scc0 L_nop3c_33
    s_mov_b32 exec_lo, 0
    s_mov_b32 s88, 0
L_spin_34:
    buffer_load_dword v4, v90, s[40:43], 0 offen offset:12 sc1
    s_waitcnt vmcnt(0)
    v_cmp_ne_u32 vcc, -1, v4
    s_nop 0
    s_cbranch_vccz L_p3ok_35
    s_add_u32 s88, s88, 1
    s_cmp_lt_u32 s88, 65536
    s_cbranch_scc1 L_spin_34
L_p3ok_35:
    s_mov_b64 exec, -1
L_nop3c_33:
    s_barrier
    buffer_load_dwordx4 v[156:159], v76, s[48:51], s75 offen nt
    s_add_u32 s75, s75, 7168
    buffer_load_dwordx4 v[32:35], v77, s[52:55], s96 offen nt
    s_add_u32 s96, s96, 4096
    buffer_load_dwordx4 v[36:39], v77, s[52:55], s96 offen nt
    s_add_u32 s96, s96, 4096
    buffer_load_dwordx4 v[40:43], v77, s[52:55], s96 offen nt
    s_add_u32 s96, s96, 4096
    buffer_load_dwordx4 v[44:47], v77, s[52:55], s96 offen nt
    s_add_u32 s96, s96, 4096
    buffer_load_dwordx4 v[48:51], v77, s[52:55], s96 offen nt
    s_add_u32 s96, s96, 4096
    v_mul_u32_u24 v20, 149504, v1
    s_mul_i32 s72, s98, 9344
    s_lshl2_add_u32 s72, s97, s72
    s_add_u32 s72, s72, 8388608
    s_barrier
    s_cmp_eq_u32 s62, 1
    s_cbranch_scc0 L_nopre_36
    s_mov_b64 exec, 0xffff
    buffer_store_dword v70, v20, s[40:43], s72 offen offset:768 sc1
    s_mov_b64 exec, -1
L_nopre_36:
    buffer_load_dwordx4 v[52:55], v77, s[52:55], s96 offen nt
    s_add_u32 s96, s96, 4096
    buffer_load_dwordx4 v[56:59], v77, s[52:55], s96 offen nt
    s_add_u32 s96, s96, 4096
    buffer_load_dwordx4 v[60:63], v77, s[52:55], s96 offen nt
    s_add_u32 s96, s96, 4096
    s_barrier
    s_waitcnt vmcnt(8)
    s_mov_b32 s78, 0x05040100
    s_mov_b32 s79, 0x07060302
    v_perm_b32 v160, v100, v96, s78
    v_perm_b32 v164, v100, v96, s79
    v_perm_b32 v168, v101, v97, s78
    v_perm_b32 v172, v101, v97, s79
    v_perm_b32 v176, v102, v98, s78
    v_perm_b32 v180, v102, v98, s79
    v_perm_b32 v184, v103, v99, s78
    v_perm_b32 v188, v103, v99, s79
    v_perm_b32 v161, v108, v104, s78
    v_perm_b32 v165, v108, v104, s79
    v_perm_b32 v169, v109, v105, s78
    v_perm_b32 v173, v109, v105, s79
    v_perm_b32 v177, v110, v106, s78
    v_perm_b32 v181, v110, v106, s79
    v_perm_b32 v185, v111, v107, s78
    v_perm_b32 v189, v111, v107, s79
    v_perm_b32 v162, v116, v112, s78
    v_perm_b32 v166, v116, v112, s79
    v_perm_b32 v170, v117, v113, s78
    v_perm_b32 v174, v117, v113, s79
    v_perm_b32 v178, v118, v114, s78
    v_perm_b32 v182, v118, v114, s79
    v_perm_b32 v186, v119, v115, s78
    v_perm_b32 v190, v119, v115, s79
    v_perm_b32 v163, v124, v120, s78
    v_perm_b32 v167, v124, v120, s79
    v_perm_b32 v171, v125, v121, s78
    v_perm_b32 v175, v125, v121, s79
    v_perm_b32 v179, v126, v122, s78
    v_perm_b32 v183, v126, v122, s79
    v_perm_b32 v187, v127, v123, s78
    v_perm_b32 v191, v127, v123, s79
    v_perm_b32 v192, v132, v128, s78
    v_perm_b32 v196, v132, v128, s79
    v_perm_b32 v200, v133, v129, s78
    v_perm_b32 v204, v133, v129, s79
    v_perm_b32 v208, v134, v130, s78
    v_perm_b32 v212, v134, v130, s79
    v_perm_b32 v216, v135, v131, s78
    v_perm_b32 v220, v135, v131, s79
    v_perm_b32 v193, v140, v136, s78
    v_perm_b32 v197, v140, v136, s79
    v_perm_b32 v201, v141, v137, s78
    v_perm_b32 v205, v141, v137, s79
    v_perm_b32 v209, v142, v138, s78
    v_perm_b32 v213, v142, v138, s79
    v_perm_b32 v217, v143, v139, s78
    v_perm_b32 v221, v143, v139, s79
    v_perm_b32 v194, v148, v144, s78
    v_perm_b32 v198, v148, v144, s79
    v_perm_b32 v202, v149, v145, s78
    v_perm_b32 v206, v149, v145, s79
    v_perm_b32 v210, v150, v146, s78
    v_perm_b32 v214, v150, v146, s79
    v_perm_b32 v218, v151, v147, s78
    v_perm_b32 v222, v151, v147, s79
    v_perm_b32 v195, v156, v152, s78
    v_perm_b32 v199, v156, v152, s79
    v_perm_b32 v203, v157, v153, s78
    v_perm_b32 v207, v157, v153, s79
    v_perm_b32 v211, v158, v154, s78
    v_perm_b32 v215, v158, v154, s79
    v_perm_b32 v219, v159, v155, s78
    v_perm_b32 v223, v159, v155, s79
    s_waitcnt vmcnt(6)
    s_mov_b32 s78, 0x05040100
    s_mov_b32 s79, 0x07060302
    v_permlane32_swap_b32 v32, v34
    v_permlane32_swap_b32 v33, v35
    v_permlane32_swap_b32 v36, v38
    v_permlane32_swap_b32_e64 v37, v39
    v_perm_b32 v224, v34, v32, s78
    v_perm_b32 v225, v34, v32, s79
    v_perm_b32 v226, v35, v33, s78
    v_perm_b32 v227, v35, v33, s79
    v_perm_b32 v228, v38, v36, s78
    v_perm_b32 v229, v38, v36, s79
    v_perm_b32 v230, v39, v37, s78
    v_perm_b32 v231, v39, v37, s79
    s_waitcnt vmcnt(4)
    s_mov_b32 s78, 0x05040100
    s_mov_b32 s79, 0x07060302
    v_permlane32_swap_b32 v40, v42
    v_permlane32_swap_b32 v41, v43
    v_permlane32_swap_b32 v44, v46
    v_permlane32_swap_b32_e64 v45, v47
    v_perm_b32 v232, v42, v40, s78
    v_perm_b32 v233, v42, v40, s79
    v_perm_b32 v234, v43, v41, s78
    v_perm_b32 v235, v43, v41, s79
    v_perm_b32 v236, v46, v44, s78
    v_perm_b32 v237, v46, v44, s79
    v_perm_b32 v238, v47, v45, s78
    v_perm_b32 v239, v47, v45, s79
    s_waitcnt vmcnt(2)
    s_mov_b32 s78, 0x05040100
    s_mov_b32 s79, 0x07060302
    v_permlane32_swap_b32 v48, v50
    v_permlane32_swap_b32 v49, v51
    v_permlane32_swap_b32 v52, v54
    v_permlane32_swap_b32_e64 v53, v55
    v_perm_b32 v240, v50, v48, s78
    v_perm_b32 v241, v50, v48, s79
    v_perm_b32 v242, v51, v49, s78
    v_perm_b32 v243, v51, v49, s79
    v_perm_b32 v244, v54, v52, s78
    v_perm_b32 v245, v54, v52, s79
    v_perm_b32 v246, v55, v53, s78
    v_perm_b32 v247, v55, v53, s79
    s_waitcnt vmcnt(0)
    s_mov_b32 s78, 0x05040100
    s_mov_b32 s79, 0x07060302
    v_permlane32_swap_b32 v56, v58
    v_permlane32_swap_b32 v57, v59
    v_permlane32_swap_b32 v60, v62
    v_permlane32_swap_b32_e64 v61, v63
    v_perm_b32 v248, v58, v56, s78
    v_perm_b32 v249, v58, v56, s79
    v_perm_b32 v250, v59, v57, s78
    v_perm_b32 v251, v59, v57, s79
    v_perm_b32 v252, v62, v60, s78
    v_perm_b32 v253, v62, v60, s79
    v_perm_b32 v254, v63, v61, s78
    v_perm_b32 v255, v63, v61, s79
    v_and_b32 v5, 15, v1
    v_lshlrev_b32 v5, 3, v5
    s_lshl_b32 s76, s63, 10
    s_lshl_b32 s77, s64, 6
    s_add_u32 s76, s76, s77
    s_add_u32 s76, s76, s99
    s_mov_b64 s[80:81], 0xffff
    s_add_u32 s68, s84, 74752
    s_add_u32 s69, s86, 74752
    s_add_u32 s70, s86, 149504
    s_add_u32 s71, s86, 224256
    s_setprio 3
    s_barrier
    ds_read_b128 v[64:67], v12 offset:28672
    ds_read_b128 v[68:71], v12 offset:29696
    ds_read_b64 v[8:9], v5 offset:25728
    s_waitcnt lgkmcnt(2)
    v_mfma_f32_16x16x32_bf16 v[96:99], v[64:67], v[160:163], 0
    v_mfma_f32_16x16x32_bf16 v[100:103], v[64:67], v[164:167], 0
    s_waitcnt lgkmcnt(0)
    v_max_f32_dpp v4, v8, v8 row_ror:8 row_mask:0xf bank_mask:0xf
    v_mfma_f32_16x16x32_bf16 v[104:107], v[64:67], v[168:171], 0
    v_mfma_f32_16x16x32_bf16 v[108:111], v[64:67], v[172:175], 0
    v_max_f32_dpp v4, v4, v4 row_ror:4 row_mask:0xf bank_mask:0xf
    v_mfma_f32_16x16x32_bf16 v[112:115], v[64:67], v[176:179], 0
    v_mfma_f32_16x16x32_bf16 v[116:119], v[64:67], v[180:183], 0
    v_max_f32_dpp v4, v4, v4 row_ror:2 row_mask:0xf bank_mask:0xf
    v_mfma_f32_16x16x32_bf16 v[120:123], v[64:67], v[184:187], 0
    v_mfma_f32_16x16x32_bf16 v[124:127], v[64:67], v[188:191], 0
    v_max_f32_dpp v4, v4, v4 row_ror:1 row_mask:0xf bank_mask:0xf
    v_mfma_f32_16x16x32_bf16 v[96:99], v[68:71], v[192:195], v[96:99]
    v_cmp_eq_f32_e64 vcc, v4, v8
    v_mfma_f32_16x16x32_bf16 v[100:103], v[68:71], v[196:199], v[100:103]
    s_ff1_i32_b32 s92, vcc_lo
    s_and_b32 s92, s92, 15
    v_mfma_f32_16x16x32_bf16 v[104:107], v[68:71], v[200:203], v[104:107]
    s_lshr_b32 s78, s92, 2
    s_lshl_b32 s78, s78, 4
    v_mfma_f32_16x16x32_bf16 v[108:111], v[68:71], v[204:207], v[108:111]
    s_and_b32 s77, s92, 3
    v_mfma_f32_16x16x32_bf16 v[112:115], v[68:71], v[208:211], v[112:115]
    v_readlane_b32 s91, v9, s92
    v_readlane_b32 s93, v8, s92
    v_mfma_f32_16x16x32_bf16 v[116:119], v[68:71], v[212:215], v[116:119]
    v_mfma_f32_16x16x32_bf16 v[120:123], v[68:71], v[216:219], v[120:123]
    v_mfma_f32_16x16x32_bf16 v[124:127], v[68:71], v[220:223], v[124:127]
    s_cmp_ge_u32 s97, 14
    s_cbranch_scc1 L_final
    s_cmp_eq_u32 s77, 0
    s_cbranch_scc0 L_sel_38
    v_mov_b32 v64, v96
    v_mov_b32 v65, v100
    v_mov_b32 v66, v104
    v_mov_b32 v67, v108
    v_mov_b32 v68, v112
    v_mov_b32 v69, v116
    v_mov_b32 v70, v120
    v_mov_b32 v71, v124
    s_branch L_seldone_37
L_sel_38:
    s_cmp_eq_u32 s77, 1
    s_cbranch_scc0 L_sel_39
    v_mov_b32 v64, v97
    v_mov_b32 v65, v101
    v_mov_b32 v66, v105
    v_mov_b32 v67, v109
    v_mov_b32 v68, v113
    v_mov_b32 v69, v117
    v_mov_b32 v70, v121
    v_mov_b32 v71, v125
    s_branch L_seldone_37
L_sel_39:
    s_cmp_eq_u32 s77, 2
    s_cbranch_scc0 L_sel_40
    v_mov_b32 v64, v98
    v_mov_b32 v65, v102
    v_mov_b32 v66, v106
    v_mov_b32 v67, v110
    v_mov_b32 v68, v114
    v_mov_b32 v69, v118
    v_mov_b32 v70, v122
    v_mov_b32 v71, v126
    s_branch L_seldone_37
L_sel_40:
    v_mov_b32 v64, v99
    v_mov_b32 v65, v103
    v_mov_b32 v66, v107
    v_mov_b32 v67, v111
    v_mov_b32 v68, v115
    v_mov_b32 v69, v119
    v_mov_b32 v70, v123
    v_mov_b32_e64 v71, v127
L_seldone_37:
    s_lshl_b64 exec, s[80:81], s78
    s_bitcmp1_b32 s100, 1
    s_cbranch_scc1 L_loc_42
    buffer_store_dwordx4 v[64:67], v16, s[40:43], s76 offen offset:3072 sc1
    buffer_store_dwordx4 v[68:71], v16, s[40:43], s76 offen offset:3088 sc1
    s_branch L_pubd_43
L_loc_42:
    buffer_store_dwordx4 v[64:67], v16, s[40:43], s76 offen offset:3072
    buffer_store_dwordx4 v[68:71], v16, s[40:43], s76 offen offset:3088
L_pubd_43:
    s_mov_b64 exec, -1
    s_mov_b32 s88, 0
L_poll_44:
    buffer_load_dwordx4 v[128:131], v18, s[40:43], s84 offen offset:3072 sc1
    buffer_load_dwordx4 v[132:135], v18, s[40:43], s68 offen offset:3072 sc1
    s_waitcnt vmcnt(0)
    v_max_u32 v4, v128, v132
    v_cmp_eq_u32_e64 vcc, -1, v4
    s_nop 0
    s_cbranch_vccz L_ok_45
    s_add_u32 s88, s88, 1
    s_cmp_lt_u32 s88, 65536
    s_cbranch_scc1 L_poll_44
L_ok_45:
    v_pk_add_f32 v[48:49], v[128:129], v[132:133]
    v_pk_add_f32 v[50:51], v[130:131], v[134:135]
    s_nop 0
    v_permlane32_swap_b32 v48, v49
    v_permlane32_swap_b32 v50, v51
    v_add_f32 v48, v48, v49
    v_add_f32 v50, v50, v51
    s_nop 1
    v_permlane16_swap_b32 v48, v50
    v_add_f32 v48, v48, v50
    s_nop 1
    v_add_f32_dpp v48, v48, v48 row_ror:8 row_mask:0xf bank_mask:0xf
    v_cvt_pk_bf16_f32 v48, v48, v48
    v_and_b32_e64 v48, s90, v48
    v_mul_f32 v4, 0xbfb8aa3b, v48
    v_exp_f32_e64 v4, v4
    v_mov_b32_dpp v49, v48 row_ror:12 row_mask:0xf bank_mask:0xf
    v_add_f32 v4, 1.0, v4
    v_rcp_f32 v4, v4
    s_nop 0
    v_mul_f32 v4, v4, v48
    v_cvt_pk_bf16_f32 v4, v4, v4
    v_and_b32 v4, s90, v4
    v_mul_f32 v4, v4, v49
    v_mov_b32 v5, v4
    s_nop 1
    v_permlane32_swap_b32_e64 v4, v5
    v_cvt_pk_bf16_f32 v4, v4, v5
    s_nop 0
    v_readlane_b32 s76, v4, 0
    v_readlane_b32 s77, v4, 16
    v_readlane_b32 s78, v4, 1
    v_readlane_b32 s79, v4, 17
    v_readlane_b32 s80, v4, 2
    v_readlane_b32 s81, v4, 18
    v_readlane_b32 s82, v4, 3
    v_readlane_b32 s83, v4, 19
    v_dot2_f32_bf16 v40, v224, s76, 0
    v_dot2_f32_bf16 v41, v225, s76, 0
    v_dot2_f32_bf16 v42, v226, s76, 0
    v_dot2_f32_bf16 v43, v227, s76, 0
    v_dot2_f32_bf16 v40, v228, s77, v40
    v_dot2_f32_bf16 v41, v229, s77, v41
    v_dot2_f32_bf16 v42, v230, s77, v42
    v_dot2_f32_bf16 v43, v231, s77, v43
    v_dot2_f32_bf16 v40, v232, s78, v40
    v_dot2_f32_bf16 v41, v233, s78, v41
    v_dot2_f32_bf16 v42, v234, s78, v42
    v_dot2_f32_bf16 v43, v235, s78, v43
    v_dot2_f32_bf16 v40, v236, s79, v40
    v_dot2_f32_bf16 v41, v237, s79, v41
    v_dot2_f32_bf16 v42, v238, s79, v42
    v_dot2_f32_bf16 v43, v239, s79, v43
    v_dot2_f32_bf16 v40, v240, s80, v40
    v_dot2_f32_bf16 v41, v241, s80, v41
    v_dot2_f32_bf16 v42, v242, s80, v42
    v_dot2_f32_bf16 v43, v243, s80, v43
    v_dot2_f32_bf16 v40, v244, s81, v40
    v_dot2_f32_bf16 v41, v245, s81, v41
    v_dot2_f32_bf16 v42, v246, s81, v42
    v_dot2_f32_bf16 v43, v247, s81, v43
    v_dot2_f32_bf16 v40, v248, s82, v40
    v_dot2_f32_bf16 v41, v249, s82, v41
    v_dot2_f32_bf16 v42, v250, s82, v42
    v_dot2_f32_bf16 v43, v251, s82, v43
    v_dot2_f32_bf16 v40, v252, s83, v40
    v_dot2_f32_bf16 v41, v253, s83, v41
    v_dot2_f32_bf16 v42, v254, s83, v42
    v_dot2_f32_bf16 v43, v255, s83, v43
    s_bitcmp1_b32 s100, 1
    s_cbranch_scc1 L_loc_46
    s_nop 0
    buffer_store_dwordx4 v[40:43], v17, s[40:43], s85 offen sc1
    s_branch L_pubd_47
L_loc_46:
    s_nop 0
    buffer_store_dwordx4 v[40:43], v17, s[40:43], s85 offen
L_pubd_47:
    s_cmp_eq_u32 s62, 0
    s_cbranch_scc0 L_hby
    s_mov_b32 s88, 0
L_poll_48:
    buffer_load_dwordx4 v[136:139], v18, s[40:43], s86 offen sc1
    buffer_load_dwordx4 v[140:143], v18, s[40:43], s69 offen sc1
    buffer_load_dwordx4 v[144:147], v18, s[40:43], s70 offen sc1
    buffer_load_dwordx4 v[148:151], v18, s[40:43], s71 offen sc1
    s_waitcnt vmcnt(0)
    v_max3_u32 v4, v136, v140, v144
    v_max_u32 v4, v4, v148
    v_cmp_eq_u32_e64 vcc, -1, v4
    s_nop 0
    s_cbranch_vccz L_ok_49
    s_add_u32 s88, s88, 1
    s_cmp_lt_u32 s88, 65536
    s_cbranch_scc1 L_poll_48
L_ok_49:
    v_pk_add_f32 v[48:49], v[136:137], v[144:145]
    v_pk_add_f32 v[50:51], v[138:139], v[146:147]
    v_pk_add_f32 v[52:53], v[140:141], v[148:149]
    v_pk_add_f32 v[54:55], v[142:143], v[150:151]
    v_pk_add_f32 v[48:49], v[48:49], v[52:53]
    v_pk_add_f32 v[50:51], v[50:51], v[54:55]
    s_nop 0
    v_permlane32_swap_b32 v48, v49
    v_permlane32_swap_b32 v50, v51
    v_add_f32 v48, v48, v49
    v_add_f32 v50, v50, v51
    s_nop 1
    v_permlane16_swap_b32 v48, v50
    v_add_f32 v48, v48, v50
    s_nop 1
    v_add_f32_dpp v48, v48, v48 row_ror:8 row_mask:0xf bank_mask:0xf
    buffer_store_dword v48, v19, s[40:43], s99 offen offset:512 sc1
L_hby:
    s_barrier
    s_lshl2_add_u32 s72, s87, s62
    s_cmp_eq_u32 s72, 0
    s_cbranch_scc0 L_nowb_50
    s_waitcnt vmcnt(0)
    buffer_wbl2 sc1
L_nowb_50:
    s_branch L_hfin
L_final:
    s_barrier
    s_lshl2_add_u32 s72, s87, s62
    s_cmp_eq_u32 s72, 3
    s_cbranch_scc0 L_nowb_51
    s_waitcnt vmcnt(0)
    buffer_wbl2 sc1
L_nowb_51:
    s_cmp_eq_u32 s62, 1
    s_cbranch_scc0 L_noep_52
    s_cmp_eq_u32 s87, 0
    s_cbranch_scc0 L_noep_52
    v_mov_b32 v4, 13631488
    s_mov_b64 exec, 1
    buffer_store_dwordx2 v[88:89], v4, s[40:43], 0 offen sc1
    s_mov_b64 exec, -1
L_noep_52:
    s_cmp_eq_u32 s62, 0
    s_cbranch_scc0 L_hfin
    v_mov_b32 v8, s93
    v_cvt_pk_bf16_f32 v8, v8, v8
    v_and_b32_e64 v8, s90, v8
    v_mul_f32 v8, 0xbfb8aa3b, v8
    v_exp_f32 v8, v8
    s_nop 0
    v_add_f32 v8, 1.0, v8
    v_rcp_f32_e64 v8, v8
    s_nop 0
    v_cvt_pk_bf16_f32 v8, v8, v8
    v_and_b32 v8, s90, v8
    s_lshl_b32 s76, s92, 4
    s_lshr_b32 s77, s87, 1
    s_add_u32 s76, s76, s77
    s_mul_i32 s76, s76, 9344
    s_add_u32 s76, s76, 8388608
    s_and_b32 s77, s87, 1
    s_lshl_b32 s77, s77, 5
    s_add_u32 s76, s76, s77
    v_and_b32 v10, 1, v1
    v_lshlrev_b32_e64 v10, 6, v10
    v_bfe_u32 v4, v1, 1, 2
    v_lshl_add_u32 v10, v4, 3, v10
    v_bfe_u32 v4, v1, 4, 1
    v_lshl_add_u32 v10, v4, 2, v10
    v_lshrrev_b32_e64 v4, 3, v1
    v_mul_u32_u24 v6, 299008, v4
    v_and_b32_e64 v5, 7, v1
    v_lshl_add_u32 v6, v5, 4, v6
    v_mov_b32 v7, 2146435072
    v_cmp_gt_u32 vcc, 56, v1
    s_nop 1
    v_cndmask_b32_e64 v6, v7, v6, vcc
    s_mul_i32 s79, s87, 9344
    s_add_u32 s79, s79, 8388608
    s_lshl_b32 s80, s91, 11
    s_lshl_b32 s77, s87, 6
    s_add_u32 s80, s80, s77
    s_mov_b32 s88, 0
L_spin_53:
    buffer_load_dword v64, v10, s[40:43], s76 offen offset:0 sc1
    buffer_load_dword v65, v10, s[40:43], s76 offen offset:128 sc1
    s_waitcnt vmcnt(0)
    v_max_u32 v4, v64, v65
    v_cmp_eq_u32 vcc, -1, v4
    s_nop 0
    s_cbranch_vccz L_ok_54
    s_add_u32 s88, s88, 1
    s_cmp_lt_u32 s88, 65536
    s_cbranch_scc1 L_spin_53
L_ok_54:
    v_lshlrev_b32 v4, 4, v3
    v_lshrrev_b32 v64, v4, v64
    v_lshrrev_b32 v65, v4, v65
    v_lshlrev_b32 v64, 16, v64
    v_lshlrev_b32 v65, 16, v65
    v_lshrrev_b32 v9, 1, v19
    s_mov_b32 s88, 0
    buffer_load_dwordx4 v[128:131], v6, s[40:43], s79 offen offset:512 sc1
    buffer_load_dwordx4 v[128:131], v6, s[40:43], s79 offen offset:512 sc1
L_poll_55:
    buffer_load_dwordx4 v[128:131], v6, s[40:43], s79 offen offset:512 sc1
    s_waitcnt vmcnt(2)
    v_max3_u32 v4, v128, v129, v130
    v_max_u32 v4, v4, v131
    v_cmp_eq_u32 vcc, -1, v4
    s_nop 0
    s_cbranch_vccz L_ok_56
    s_add_u32 s88, s88, 1
    s_cmp_lt_u32 s88, 65536
    s_cbranch_scc1 L_poll_55
L_ok_56:
    v_mov_b32 v48, v128
    v_mov_b32 v49, v129
    v_mov_b32 v50, v130
    v_mov_b32 v51, v131
    v_permlane32_swap_b32 v48, v49
    s_nop 0
    v_permlane32_swap_b32 v50, v51
    v_add_f32 v48, v48, v49
    v_add_f32 v50, v50, v51
    s_nop 1
    v_permlane16_swap_b32 v48, v50
    v_add_f32 v48, v48, v50
    s_nop 1
    v_add_f32_dpp v48, v48, v48 row_ror:8 row_mask:0xf bank_mask:0xf
    v_cvt_pk_bf16_f32 v48, v48, v48
    v_and_b32 v48, s90, v48
    v_mul_f32 v48, v48, v8
    v_cvt_pk_bf16_f32 v48, v48, v48
    v_and_b32 v48, s90, v48
    v_add_f32 v48, v48, v64
    v_cvt_pk_bf16_f32 v48, v48, v48
    v_and_b32 v48, s90, v48
    v_add_f32 v48, v48, v65
    v_cvt_pk_bf16_f32 v48, v48, v48
    s_mov_b32 exec_lo, 0x00ff00ff
    s_mov_b32 exec_hi, 0x00ff00ff
    buffer_store_short v48, v9, s[44:47], s80 offen sc1
    s_mov_b64 exec, -1
L_hfin:
    s_endpgm
L_event:
    s_cmp_eq_u32 s77, 3
    s_cbranch_scc0 L_ev1
    buffer_load_dwordx4 v[92:95], v90, s[40:43], 0 offen sc1
    s_mov_b64 exec, 3
    global_load_dword v27, v91, s[66:67]
    s_mov_b64 exec, -1
    s_branch L_evret
L_ev1:
    s_cmp_eq_u32 s77, 5
    s_cbranch_scc0 L_ev_57
    s_and_b32 s72, s84, 15
    s_mov_b32 m0, s70
    s_lshl_b32 s71, s72, 7
    buffer_load_dwordx4 v16, s[28:31], s71 offen offset:0 lds
    s_mul_i32 s72, s72, 393216
    s_lshr_b64 s[84:85], s[84:85], 4
    buffer_load_dwordx4 v17, s[28:31], s71 offen offset:1024 lds
    buffer_load_dwordx4 v18, s[28:31], s71 offen offset:2048 lds
    buffer_load_dwordx4 v19, s[28:31], s71 offen offset:3072 lds
    s_add_u32 m0, s70, 4096
    s_nop 0
    buffer_load_dwordx4 v20, s[32:35], s72 offen offset:0 lds
    buffer_load_dwordx4 v21, s[32:35], s72 offen offset:1024 lds
    buffer_load_dwordx4 v22, s[32:35], s72 offen offset:2048 lds
    buffer_load_dwordx4 v23, s[32:35], s72 offen offset:3072 lds
    s_add_u32 m0, s70, 8192
    s_nop 0
    buffer_load_dwordx4 v24, s[32:35], s72 offen offset:0 lds
    buffer_load_dwordx4 v25, s[32:35], s72 offen offset:1024 lds
    s_add_u32 s70, s70, 40960
    s_cmp_ge_u32 s70, 122880
    s_cselect_b32 s76, 122880, 0
    s_sub_u32 s70, s70, s76
    buffer_load_dwordx4 v[96:99], v76, s[48:51], s75 offen nt
    s_add_u32 s75, s75, 7168
    buffer_load_dwordx4 v[100:103], v76, s[48:51], s75 offen nt
    s_add_u32 s75, s75, 7168
    buffer_load_dwordx4 v[104:107], v76, s[48:51], s75 offen nt
    s_add_u32 s75, s75, 7168
    buffer_load_dwordx4 v[108:111], v76, s[48:51], s75 offen nt
    s_add_u32 s75, s75, 7168
    buffer_load_dwordx4 v[128:131], v76, s[48:51], s75 offen nt
    s_add_u32 s75, s75, 7168
    buffer_load_dwordx4 v[132:135], v76, s[48:51], s75 offen nt
    s_add_u32 s75, s75, 7168
    buffer_load_dwordx4 v[136:139], v76, s[48:51], s75 offen nt
    s_add_u32 s75, s75, 7168
    buffer_load_dwordx4 v[140:143], v76, s[48:51], s75 offen nt
    s_add_u32 s75, s75, 7168
    s_waitcnt vmcnt(18)
    s_branch L_hbar
L_ev_57:
    s_cmp_eq_u32 s77, 6
    s_cbranch_scc0 L_ev_58
    s_and_b32 s72, s84, 15
    s_mov_b32 m0, s70
    s_lshl_b32 s71, s72, 7
    buffer_load_dwordx4 v16, s[28:31], s71 offen offset:0 lds
    s_mul_i32 s72, s72, 393216
    s_lshr_b64 s[84:85], s[84:85], 4
    buffer_load_dwordx4 v17, s[28:31], s71 offen offset:1024 lds
    buffer_load_dwordx4 v18, s[28:31], s71 offen offset:2048 lds
    buffer_load_dwordx4 v19, s[28:31], s71 offen offset:3072 lds
    s_add_u32 m0, s70, 4096
    s_nop 0
    buffer_load_dwordx4 v20, s[32:35], s72 offen offset:0 lds
    buffer_load_dwordx4 v21, s[32:35], s72 offen offset:1024 lds
    buffer_load_dwordx4 v22, s[32:35], s72 offen offset:2048 lds
    buffer_load_dwordx4 v23, s[32:35], s72 offen offset:3072 lds
    s_add_u32 m0, s70, 8192
    s_nop 0
    buffer_load_dwordx4 v24, s[32:35], s72 offen offset:0 lds
    buffer_load_dwordx4 v25, s[32:35], s72 offen offset:1024 lds
    s_add_u32 s70, s70, 40960
    s_cmp_ge_u32 s70, 122880
    s_cselect_b32 s76, 122880, 0
    s_sub_u32 s70, s70, s76
    s_lshr_b32 s78, s2, 3
    s_lshl2_add_u32 s78, s78, s62
    s_lshl_b32 s78, s78, 14
    v_lshlrev_b32_e64 v11, 10, v1
    s_mov_b64 exec, 65535
    buffer_load_dword v27, v11, s[36:39], s78 offen offset:384
    s_mov_b64 exec, -1
    s_lshl_b32 s78, s62, 9
    v_lshl_add_u32 v11, v1, 7, s78
    s_mov_b64 exec, 15
    global_load_dword v27, v11, s[14:15]
    s_mov_b64 exec, -1
    buffer_load_dwordx4 v[112:115], v76, s[48:51], s75 offen nt
    s_add_u32 s75, s75, 7168
    buffer_load_dwordx4 v[116:119], v76, s[48:51], s75 offen nt
    s_add_u32 s75, s75, 7168
    buffer_load_dwordx4 v[120:123], v76, s[48:51], s75 offen nt
    s_add_u32 s75, s75, 7168
    buffer_load_dwordx4 v[124:127], v76, s[48:51], s75 offen nt
    s_add_u32 s75, s75, 7168
    buffer_load_dwordx4 v[144:147], v76, s[48:51], s75 offen nt
    s_add_u32 s75, s75, 7168
    buffer_load_dwordx4 v[148:151], v76, s[48:51], s75 offen nt
    s_add_u32 s75, s75, 7168
    s_waitcnt vmcnt(18)
    s_branch L_hbar
L_ev_58:
    s_add_u32 s78, s70, 40960
    s_cmp_ge_u32 s78, 122880
    s_cselect_b32 s76, 122880, 0
    s_sub_u32 s78, s78, s76
    s_cmp_eq_u32 s77, 2
    s_cbranch_scc1 L_evw
    v_add_u32 v4, s78, v72
    v_xor_b32 v5, 32, v4
    v_xor_b32 v6, 64, v4
    v_xor_b32 v7, 96, v4
    s_and_b32 s72, s84, 15
    s_mov_b32 m0, s70
    s_lshl_b32 s71, s72, 7
    buffer_load_dwordx4 v16, s[28:31], s71 offen offset:0 lds
    s_mul_i32 s72, s72, 393216
    s_lshr_b64 s[84:85], s[84:85], 4
    ds_read_b128 v[32:35], v4
    ds_read_b128 v[36:39], v5
    ds_read_b128 v[40:43], v6
    ds_read_b128 v[44:47], v7
    buffer_load_dwordx4 v17, s[28:31], s71 offen offset:1024 lds
    s_lshl_b32 s79, s62, 8
    s_add_u32 s79, s79, s73
    s_waitcnt lgkmcnt(0)
    v_lshlrev_b32 v80, 16, v32
    v_and_b32 v82, s90, v32
    v_mul_f32 v81, v80, v80
    v_mul_f32 v83, v82, v82
    v_lshlrev_b32 v10, 16, v33
    v_and_b32 v11, s90, v33
    v_add_f32 v80, v80, v10
    v_add_f32 v82, v82, v11
    v_fmac_f32 v81, v10, v10
    v_fmac_f32 v83, v11, v11
    v_lshlrev_b32 v8, 16, v34
    v_and_b32_e64 v9, s90, v34
    buffer_load_dwordx4 v18, s[28:31], s71 offen offset:2048 lds
    v_add_f32 v80, v80, v8
    v_add_f32 v82, v82, v9
    v_fmac_f32 v81, v8, v8
    v_fmac_f32 v83, v9, v9
    v_lshlrev_b32 v10, 16, v35
    v_and_b32 v11, s90, v35
    v_add_f32 v80, v80, v10
    v_add_f32 v82, v82, v11
    v_fmac_f32 v81, v10, v10
    v_fmac_f32 v83, v11, v11
    v_lshlrev_b32 v8, 16, v36
    v_and_b32 v9, s90, v36
    buffer_load_dwordx4 v19, s[28:31], s71 offen offset:3072 lds
    v_add_f32 v80, v80, v8
    v_add_f32 v82, v82, v9
    v_fmac_f32 v81, v8, v8
    v_fmac_f32 v83, v9, v9
    v_lshlrev_b32 v10, 16, v37
    v_and_b32 v11, s90, v37
    v_add_f32 v80, v80, v10
    v_add_f32 v82, v82, v11
    v_fmac_f32 v81, v10, v10
    v_fmac_f32 v83, v11, v11
    v_lshlrev_b32 v8, 16, v38
    v_and_b32 v9, s90, v38
    s_add_u32 m0, s70, 4096
    s_nop 0
    buffer_load_dwordx4 v20, s[32:35], s72 offen offset:0 lds
    v_add_f32 v80, v80, v8
    v_add_f32 v82, v82, v9
    v_fmac_f32 v81, v8, v8
    v_fmac_f32 v83, v9, v9
    v_lshlrev_b32 v10, 16, v39
    v_and_b32 v11, s90, v39
    v_add_f32 v80, v80, v10
    v_add_f32 v82, v82, v11
    v_fmac_f32 v81, v10, v10
    v_fmac_f32 v83, v11, v11
    v_lshlrev_b32 v8, 16, v40
    v_and_b32_e64 v9, s90, v40
    buffer_load_dwordx4 v21, s[32:35], s72 offen offset:1024 lds
    v_add_f32 v80, v80, v8
    v_add_f32 v82, v82, v9
    v_fmac_f32 v81, v8, v8
    v_fmac_f32 v83, v9, v9
    v_lshlrev_b32 v10, 16, v41
    v_and_b32 v11, s90, v41
    v_add_f32 v80, v80, v10
    v_add_f32 v82, v82, v11
    v_fmac_f32 v81, v10, v10
    v_fmac_f32 v83, v11, v11
    v_lshlrev_b32 v8, 16, v42
    v_and_b32 v9, s90, v42
    buffer_load_dwordx4 v22, s[32:35], s72 offen offset:2048 lds
    v_add_f32 v80, v80, v8
    v_add_f32 v82, v82, v9
    v_fmac_f32 v81, v8, v8
    v_fmac_f32 v83, v9, v9
    v_lshlrev_b32 v10, 16, v43
    v_and_b32 v11, s90, v43
    v_add_f32 v80, v80, v10
    v_add_f32 v82, v82, v11
    v_fmac_f32 v81, v10, v10
    v_fmac_f32 v83, v11, v11
    v_lshlrev_b32 v8, 16, v44
    v_and_b32 v9, s90, v44
    buffer_load_dwordx4 v23, s[32:35], s72 offen offset:3072 lds
    v_add_f32 v80, v80, v8
    v_add_f32 v82, v82, v9
    v_fmac_f32 v81, v8, v8
    v_fmac_f32 v83, v9, v9
    v_lshlrev_b32 v10, 16, v45
    v_and_b32 v11, s90, v45
    v_add_f32 v80, v80, v10
    v_add_f32 v82, v82, v11
    v_fmac_f32 v81, v10, v10
    v_fmac_f32 v83, v11, v11
    v_lshlrev_b32 v8, 16, v46
    v_and_b32 v9, s90, v46
    s_add_u32 m0, s70, 8192
    s_nop 0
    buffer_load_dwordx4 v24, s[32:35], s72 offen offset:0 lds
    v_add_f32 v80, v80, v8
    v_add_f32 v82, v82, v9
    v_fmac_f32 v81, v8, v8
    v_fmac_f32 v83, v9, v9
    v_lshlrev_b32 v10, 16, v47
    v_and_b32 v11, s90, v47
    v_add_f32 v80, v80, v10
    v_add_f32 v82, v82, v11
    v_fmac_f32 v81, v10, v10
    v_fmac_f32_e64 v83, v11, v11
    buffer_load_dwordx4 v25, s[32:35], s72 offen offset:1024 lds
    s_add_u32 s70, s70, 40960
    s_cmp_ge_u32 s70, 122880
    s_cselect_b32 s76, 122880, 0
    s_sub_u32 s70, s70, s76
    v_add_f32 v80, v80, v82
    v_add_f32 v81, v81, v83
    v_mov_b32 v82, v80
    v_mov_b32 v83, v81
    s_nop 0
    v_permlane32_swap_b32 v80, v82
    v_permlane32_swap_b32 v81, v83
    v_add_f32 v80, v80, v82
    v_add_f32_e64 v81, v81, v83
    s_mov_b32 exec_hi, 0
    buffer_store_dwordx2 v[80:81], v74, s[40:43], s79 offen offset:0 sc1
    s_mov_b64 exec, -1
    s_waitcnt vmcnt(11)
    s_branch L_hbar
L_evw:
    s_mul_i32 s79, s63, 2048
    s_add_u32 s79, s79, s78
    v_add_u32_e64 v4, s79, v73
    s_mul_i32 s79, s63, 20480
    s_add_u32 s79, s79, s78
    v_add_u32_e64 v5, s79, v73
    s_and_b32 s72, s84, 15
    s_mov_b32 m0, s70
    s_lshl_b32 s71, s72, 7
    buffer_load_dwordx4 v16, s[28:31], s71 offen offset:0 lds
    s_mul_i32 s72, s72, 393216
    s_lshr_b64 s[84:85], s[84:85], 4
    ds_read_b64_tr_b16 v[32:33], v4 offset:0
    ds_read_b64_tr_b16 v[34:35], v4 offset:512
    ds_read_b64_tr_b16 v[36:37], v4 offset:10240
    ds_read_b64_tr_b16 v[38:39], v4 offset:10752
    ds_read_b64_tr_b16 v[40:41], v4 offset:20480
    ds_read_b64_tr_b16 v[42:43], v4 offset:20992
    ds_read_b64_tr_b16 v[44:45], v4 offset:30720
    ds_read_b64_tr_b16 v[46:47], v4 offset:31232
    ds_read_b64_tr_b16 v[48:49], v5 offset:4096
    ds_read_b64_tr_b16 v[50:51], v5 offset:4608
    ds_read_b64_tr_b16 v[52:53], v5 offset:14336
    ds_read_b64_tr_b16 v[54:55], v5 offset:14848
    buffer_load_dwordx4 v17, s[28:31], s71 offen offset:1024 lds
    s_lshl_b32 s79, s64, 9
    s_lshl_b32 s80, s63, 3
    s_add_u32 s79, s79, s80
    s_add_u32 s79, s79, s73
    s_waitcnt lgkmcnt(0)
    v_lshlrev_b32 v80, 16, v32
    v_and_b32 v82, s90, v32
    v_lshlrev_b32 v10, 16, v33
    v_and_b32 v11, s90, v33
    v_add_f32 v80, v80, v10
    v_add_f32 v82, v82, v11
    v_lshlrev_b32 v8, 16, v34
    v_and_b32 v9, s90, v34
    v_add_f32 v80, v80, v8
    v_add_f32 v82, v82, v9
    v_lshlrev_b32 v10, 16, v35
    v_and_b32 v11, s90, v35
    buffer_load_dwordx4 v18, s[28:31], s71 offen offset:2048 lds
    v_add_f32 v80, v80, v10
    v_add_f32 v82, v82, v11
    v_lshlrev_b32 v8, 16, v36
    v_and_b32 v9, s90, v36
    v_add_f32 v80, v80, v8
    v_add_f32 v82, v82, v9
    v_lshlrev_b32 v10, 16, v37
    v_and_b32 v11, s90, v37
    v_add_f32 v80, v80, v10
    v_add_f32 v82, v82, v11
    v_lshlrev_b32 v8, 16, v38
    v_and_b32 v9, s90, v38
    buffer_load_dwordx4 v19, s[28:31], s71 offen offset:3072 lds
    v_add_f32 v80, v80, v8
    v_add_f32 v82, v82, v9
    v_lshlrev_b32 v10, 16, v39
    v_and_b32 v11, s90, v39
    v_add_f32 v80, v80, v10
    v_add_f32 v82, v82, v11
    v_lshlrev_b32 v8, 16, v40
    v_and_b32 v9, s90, v40
    v_add_f32 v80, v80, v8
    v_add_f32 v82, v82, v9
    v_lshlrev_b32 v10, 16, v41
    v_and_b32 v11, s90, v41
    s_add_u32 m0, s70, 4096
    s_nop 0
    buffer_load_dwordx4 v20, s[32:35], s72 offen offset:0 lds
    v_add_f32 v80, v80, v10
    v_add_f32 v82, v82, v11
    v_lshlrev_b32 v8, 16, v42
    v_and_b32 v9, s90, v42
    v_add_f32 v80, v80, v8
    v_add_f32 v82, v82, v9
    v_lshlrev_b32 v10, 16, v43
    v_and_b32 v11, s90, v43
    v_add_f32 v80, v80, v10
    v_add_f32 v82, v82, v11
    v_lshlrev_b32 v8, 16, v44
    v_and_b32_e64 v9, s90, v44
    buffer_load_dwordx4 v21, s[32:35], s72 offen offset:1024 lds
    v_add_f32 v80, v80, v8
    v_add_f32 v82, v82, v9
    v_lshlrev_b32 v10, 16, v45
    v_and_b32 v11, s90, v45
    v_add_f32 v80, v80, v10
    v_add_f32 v82, v82, v11
    v_lshlrev_b32 v8, 16, v46
    v_and_b32 v9, s90, v46
    v_add_f32 v80, v80, v8
    v_add_f32 v82, v82, v9
    v_lshlrev_b32 v10, 16, v47
    v_and_b32 v11, s90, v47
    buffer_load_dwordx4 v22, s[32:35], s72 offen offset:2048 lds
    v_add_f32 v80, v80, v10
    v_add_f32 v82, v82, v11
    v_lshlrev_b32 v81, 16, v48
    v_and_b32 v83, s90, v48
    v_lshlrev_b32 v10, 16, v49
    v_and_b32 v11, s90, v49
    v_add_f32 v81, v81, v10
    v_add_f32 v83, v83, v11
    v_lshlrev_b32 v8, 16, v50
    v_and_b32 v9, s90, v50
    v_add_f32 v81, v81, v8
    v_add_f32 v83, v83, v9
    buffer_load_dwordx4 v23, s[32:35], s72 offen offset:3072 lds
    v_lshlrev_b32 v10, 16, v51
    v_and_b32 v11, s90, v51
    v_add_f32 v81, v81, v10
    v_add_f32 v83, v83, v11
    v_lshlrev_b32 v8, 16, v52
    v_and_b32 v9, s90, v52
    v_add_f32 v81, v81, v8
    v_add_f32 v83, v83, v9
    v_lshlrev_b32 v10, 16, v53
    v_and_b32 v11, s90, v53
    v_add_f32 v81, v81, v10
    v_add_f32 v83, v83, v11
    s_add_u32 m0, s70, 8192
    s_nop 0
    buffer_load_dwordx4 v24, s[32:35], s72 offen offset:0 lds
    v_lshlrev_b32 v8, 16, v54
    v_and_b32 v9, s90, v54
    v_add_f32 v81, v81, v8
    v_add_f32 v83, v83, v9
    v_lshlrev_b32 v10, 16, v55
    v_and_b32 v11, s90, v55
    v_add_f32 v81, v81, v10
    v_add_f32_e64 v83, v83, v11
    buffer_load_dwordx4 v25, s[32:35], s72 offen offset:1024 lds
    s_add_u32 s70, s70, 40960
    s_cmp_ge_u32 s70, 122880
    s_cselect_b32 s76, 122880, 0
    s_sub_u32 s70, s70, s76
    v_add_f32 v80, v80, v82
    v_add_f32 v81, v81, v83
    v_mov_b32 v82, v80
    v_mov_b32 v83, v81
    s_nop 0
    v_permlane32_swap_b32 v80, v82
    v_permlane32_swap_b32 v81, v83
    v_add_f32 v80, v80, v82
    v_add_f32_e64 v81, v81, v83
    s_mov_b32 exec_hi, 0
    buffer_store_dwordx2 v[80:81], v12, s[40:43], s79 offen offset:1024 sc1
    s_mov_b64 exec, -1
    s_waitcnt vmcnt(11)
    s_branch L_hbar
L_compute:
    s_load_dwordx4 s[8:11], s[0:1], 16
    s_load_dwordx16 s[12:27], s[0:1], 32
    s_and_b32 s62, s62, 3
    s_and_b32 s76, s2, 7
    s_lshl_b32 s76, s76, 3
    s_lshr_b32 s77, s2, 7
    s_lshl2_add_u32 s76, s77, s76
    s_mov_b32 s80, 0x654210b3
    s_mov_b32 s81, 0xfedca987
    s_lshr_b64 s[80:81], s[80:81], s76
    s_and_b32 s61, s80, 15
    s_setprio 2
    s_and_b32 s63, s62, 1
    s_lshr_b32 s64, s62, 1
    s_lshl_b32 s73, s60, 4
    s_add_u32 s73, s73, s61
    s_mul_i32 s73, s73, 28800
    s_add_u32 s76, s2, 7
    s_and_b32 s76, s76, 7
    s_bfe_u32 s77, s2, 0x10003
    s_lshl1_add_u32 s97, s76, s77
    s_lshr_b32 s98, s2, 4
    s_lshl_b32 s99, s97, 4
    s_add_u32 s99, s99, s98
    s_mul_i32 s99, s99, 9344
    s_add_u32 s99, s99, 8388608
    s_lshr_b32 s65, s97, 1
    s_lshl_b32 s76, s97, 3
    s_add_u32 s65, s65, s76
    s_mul_i32 s76, s98, 4
    s_add_u32 s65, s65, s76
    s_and_b32 s65, s65, 15
    s_mov_b32 s89, 0x3f803f80
    s_mov_b32 s90, 0xffff0000
    v_and_b32 v2, 31, v1
    v_lshrrev_b32 v3, 5, v1
    v_lshlrev_b32 v12, 4, v1
    v_lshrrev_b32_e64 v4, 3, v1
    v_mul_u32_u24 v13, 460800, v4
    v_and_b32_e64 v4, 7, v1
    v_lshl_add_u32 v13, v4, 4, v13
    v_and_b32 v10, 15, v1
    v_lshrrev_b32 v11, 4, v1
    s_mul_i32 s76, s63, 20480
    v_lshrrev_b32 v4, 1, v10
    v_xor_b32 v4, v4, v11
    v_lshlrev_b32_e64 v4, 4, v4
    v_lshl_add_u32 v4, v10, 7, v4
    v_add_u32 v192, s76, v4
    v_xor_b32 v193, 64, v192
    v_bfe_u32 v4, v1, 2, 2
    v_and_b32_e64 v6, 1, v11
    v_lshl_add_u32 v5, v6, 3, v4
    v_lshlrev_b32 v5, 7, v5
    v_lshrrev_b32 v4, 1, v4
    v_xor_b32_e64 v4, s64, v4
    v_lshl_add_u32 v5, v4, 6, v5
    v_lshl_add_u32 v5, v6, 5, v5
    v_and_b32_e64 v4, 3, v1
    v_lshl_add_u32 v5, v4, 3, v5
    v_mul_u32_u24 v4, 10240, v3
    v_add_u32_e64 v5, v5, v4
    v_add_u32 v194, 4096, v5
    v_xor_b32_e64 v195, 32, v194
    v_add_u32 v196, 40960, v192
    v_add_u32 v197, 40960, v193
    v_add_u32 v198, 40960, v194
    v_add_u32 v199, 40960, v195
    v_add_u32 v200, 81920, v192
    v_add_u32 v201, 81920, v193
    v_add_u32 v202, 81920, v194
    v_add_u32 v203, 81920, v195
    v_bfe_u32 v4, v1, 2, 2
    v_lshl_add_u32 v4, v3, 3, v4
    v_lshlrev_b32 v4, 6, v4
    v_and_b32 v5, 1, v11
    v_lshl_add_u32 v4, v5, 5, v4
    v_and_b32_e64 v5, 3, v1
    v_lshl_add_u32 v4, v5, 3, v4
    s_lshl_b32 s76, s64, 11
    s_add_u32 s76, s76, 122880
    v_add_u32_e64 v212, s76, v4
    s_lshl_b32 s76, s63, 9
    v_lshl_add_u32 v213, v10, 3, s76
    v_lshl_add_u32 v214, v2, 3, s76
    s_lshl_b32 s76, s64, 8
    v_lshl_add_u32 v215, v10, 3, s76
    v_bfe_u32 v4, v10, 1, 1
    v_xor_b32 v4, s64, v4
    v_lshrrev_b32 v5, 2, v10
    v_xor_b32 v5, v5, v3
    v_xor_b32 v6, v10, v11
    v_and_b32 v6, 1, v6
    v_lshlrev_b32_e64 v4, 6, v4
    v_lshl_add_u32 v4, v5, 4, v4
    v_lshl_add_u32 v4, v6, 3, v4
    v_lshl_add_u32 v4, v10, 7, v4
    s_lshl_b32 s76, s63, 13
    v_add_u32 v216, s76, v4
    v_bfe_u32 v4, v2, 1, 1
    v_bfe_u32 v5, v2, 2, 2
    v_and_b32 v6, 1, v2
    v_xor_b32 v6, v6, v3
    v_lshlrev_b32_e64 v4, 6, v4
    v_lshl_add_u32 v4, v5, 4, v4
    v_lshl_add_u32 v4, v6, 3, v4
    v_lshl_add_u32 v4, v2, 7, v4
    s_lshl_b32 s77, s64, 14
    s_add_u32 s76, s76, s77
    v_add_u32_e64 v217, s76, v4
    v_bfe_u32 v4, v1, 2, 2
    v_lshl_add_u32 v5, v3, 3, v4
    v_lshlrev_b32 v5, 7, v5
    v_lshrrev_b32 v6, 1, v4
    v_lshl_add_u32 v5, v6, 6, v5
    v_bfe_u32 v6, v1, 4, 1
    v_xor_b32_e64 v6, v6, v3
    v_lshl_add_u32 v5, v6, 5, v5
    v_bfe_u32 v6, v1, 1, 1
    v_lshl_add_u32 v5, v6, 4, v5
    v_xor_b32 v6, v1, v4
    v_and_b32 v6, 1, v6
    v_lshl_add_u32 v5, v6, 3, v5
    s_lshl_b32 s76, s63, 13
    v_xor_b32 v5, s76, v5
    s_lshl_b32 s76, s63, 6
    s_or_b32 s76, s76, s77
    v_xor_b32 v218, s76, v5
    s_lshl_b32 s76, s64, 6
    v_xor_b32_e64 v220, s76, v5
    v_xor_b32 v219, 528, v218
    v_xor_b32 v221, 528, v220
    v_cmp_gt_u32 s[86:87], 16, v1
    s_waitcnt lgkmcnt(0)
    s_mov_b32 s40, s26
    s_and_b32 s41, s27, 0xffff
    s_mov_b32 s42, 33554432
    s_mov_b32 s43, 0x20000
    s_mov_b32 s44, s22
    s_and_b32 s45, s23, 0xffff
    s_mov_b32 s46, 4194304
    s_mov_b32 s47, 0x20000
    s_mov_b32 s68, 0
    s_getreg_b32 s101, hwreg(HW_REG_XCC_ID, 0, 4)
    v_mov_b32 v9, 13631488
    s_lshl_b32 s76, s61, 8
    s_lshl4_add_u32 s76, s60, s76
    s_add_u32 s76, s76, 12582912
    v_mov_b32 v8, s76
    s_lshl_b32 s76, s60, 8
    s_lshl4_add_u32 s76, s61, s76
    s_add_u32 s76, s76, 12587008
    v_writelane_b32 v8, s76, 1
    s_lshl_b32 s76, s97, 8
    s_lshl4_add_u32 s76, s98, s76
    s_add_u32 s76, s76, 12591104
    v_writelane_b32 v8, s76, 2
    v_mov_b32 v6, s101
    v_mov_b32 v7, 0
    v_mov_b32_e64 v10, 0
    s_cmp_eq_u32 s62, 0
    s_cbranch_scc0 L_noep
    buffer_load_dwordx2 v[4:5], v9, s[40:43], 0 offen
L_noep:
    s_barrier
    ds_read_b128 v[112:115], v192 offset:0
    ds_read_b64_tr_b16 v[128:129], v194 offset:0
    ds_read_b64_tr_b16 v[130:131], v194 offset:512
    ds_read_b128 v[116:119], v192 offset:2048
    ds_read_b128 v[120:123], v192 offset:10240
    ds_read_b128 v[124:127], v192 offset:12288
    ds_read_b64_tr_b16 v[132:133], v195 offset:0
    ds_read_b64_tr_b16 v[134:135], v195 offset:512
    ds_read_b64_tr_b16 v[136:137], v194 offset:2048
    ds_read_b64_tr_b16 v[138:139], v194 offset:2560
    ds_read_b64_tr_b16 v[140:141], v195 offset:2048
    ds_read_b64_tr_b16 v[142:143], v195 offset:2560
    ds_read_b64_tr_b16 v[144:145], v194 offset:4096
    ds_read_b64_tr_b16 v[146:147], v194 offset:4608
    s_waitcnt lgkmcnt(8)
    ds_read_b64_tr_b16 v[148:149], v195 offset:4096
    ds_read_b64_tr_b16 v[150:151], v195 offset:4608
    v_mfma_f32_16x16x32_bf16 v[16:19], v[128:131], v[112:115], 0
    ds_read_b128 v[152:155], v193 offset:0
    v_mfma_f32_16x16x32_bf16 v[20:23], v[128:131], v[116:119], 0
    ds_read_b64_tr_b16 v[168:169], v194 offset:20480
    v_mfma_f32_16x16x32_bf16 v[24:27], v[128:131], v[120:123], 0
    ds_read_b64_tr_b16 v[170:171], v194 offset:20992
    v_mfma_f32_16x16x32_bf16 v[28:31], v[128:131], v[124:127], 0
    ds_read_b128 v[156:159], v193 offset:2048
    s_waitcnt lgkmcnt(4)
    v_mfma_f32_16x16x32_bf16 v[44:47], v[132:135], v[124:127], 0
    ds_read_b128 v[160:163], v193 offset:10240
    v_mfma_f32_16x16x32_bf16 v[40:43], v[132:135], v[120:123], 0
    ds_read_b128 v[164:167], v193 offset:12288
    v_mfma_f32_16x16x32_bf16 v[36:39], v[132:135], v[116:119], 0
    ds_read_b64_tr_b16 v[172:173], v195 offset:20480
    v_mfma_f32_16x16x32_bf16 v[32:35], v[132:135], v[112:115], 0
    ds_read_b64_tr_b16 v[174:175], v195 offset:20992
    v_mfma_f32_16x16x32_bf16 v[48:51], v[136:139], v[112:115], 0
    ds_read_b64_tr_b16 v[176:177], v194 offset:22528
    v_mfma_f32_16x16x32_bf16 v[52:55], v[136:139], v[116:119], 0
    ds_read_b64_tr_b16 v[178:179], v194 offset:23040
    v_mfma_f32_16x16x32_bf16 v[56:59], v[136:139], v[120:123], 0
    ds_read_b64_tr_b16 v[180:181], v195 offset:22528
    v_mfma_f32_16x16x32_bf16 v[60:63], v[136:139], v[124:127], 0
    ds_read_b64_tr_b16 v[182:183], v195 offset:23040
    v_mfma_f32_16x16x32_bf16 v[76:79], v[140:143], v[124:127], 0
    ds_read_b64_tr_b16 v[184:185], v194 offset:24576
    v_mfma_f32_16x16x32_bf16 v[72:75], v[140:143], v[120:123], 0
    ds_read_b64_tr_b16 v[186:187], v194 offset:25088
    v_mfma_f32_16x16x32_bf16 v[68:71], v[140:143], v[116:119], 0
    ds_read_b64_tr_b16 v[188:189], v195 offset:24576
    v_mfma_f32_16x16x32_bf16 v[64:67], v[140:143], v[112:115], 0
    ds_read_b64_tr_b16 v[190:191], v195 offset:25088
    v_mfma_f32_16x16x32_bf16 v[80:83], v[144:147], v[112:115], 0
    v_mfma_f32_16x16x32_bf16 v[84:87], v[144:147], v[116:119], 0
    v_mfma_f32_16x16x32_bf16 v[88:91], v[144:147], v[120:123], 0
    v_mfma_f32_16x16x32_bf16 v[92:95], v[144:147], v[124:127], 0
    v_mfma_f32_16x16x32_bf16 v[108:111], v[148:151], v[124:127], 0
    v_mfma_f32_16x16x32_bf16 v[104:107], v[148:151], v[120:123], 0
    v_mfma_f32_16x16x32_bf16 v[100:103], v[148:151], v[116:119], 0
    v_mfma_f32_16x16x32_bf16 v[96:99], v[148:151], v[112:115], 0
    s_waitcnt lgkmcnt(0)
    v_mfma_f32_16x16x32_bf16 v[16:19], v[168:171], v[152:155], v[16:19]
    s_barrier
    v_mfma_f32_16x16x32_bf16 v[20:23], v[168:171], v[156:159], v[20:23]
    ds_read_b128 v[112:115], v196 offset:0
    ds_read_b64_tr_b16 v[204:205], v212 offset:0
    ds_read_b64_tr_b16 v[206:207], v212 offset:256
    ds_read_b64_tr_b16 v[208:209], v212 offset:1024
    ds_read_b64_tr_b16 v[210:211], v212 offset:1280
    v_mfma_f32_16x16x32_bf16 v[24:27], v[168:171], v[160:163], v[24:27]
    ds_read_b64_tr_b16 v[128:129], v198 offset:0
    s_cmp_eq_u32 s62, 0
    s_cbranch_scc0 L_cloop
    s_waitcnt vmcnt(0)
    v_add_co_u32 v4, vcc, 1, v4
    s_nop 1
    v_addc_co_u32 v5, vcc, 0, v5, vcc
    s_mov_b64 exec, 7
    buffer_store_dwordx4 v[4:7], v8, s[40:43], 0 offen sc1
    s_mov_b64 exec, -1
.p2align 3
L_cloop:
    v_mfma_f32_16x16x32_bf16 v[28:31], v[168:171], v[164:167], v[28:31]
    ds_read_b64_tr_b16 v[130:131], v198 offset:512
    v_mfma_f32_16x16x32_bf16 v[44:47], v[172:175], v[164:167], v[44:47]
    ds_read_b128 v[116:119], v196 offset:2048
    v_mfma_f32_16x16x32_bf16 v[40:43], v[172:175], v[160:163], v[40:43]
    ds_read_b128 v[120:123], v196 offset:10240
    v_mfma_f32_16x16x32_bf16 v[36:39], v[172:175], v[156:159], v[36:39]
    ds_read_b128 v[124:127], v196 offset:12288
    v_mfma_f32_16x16x32_bf16 v[32:35], v[172:175], v[152:155], v[32:35]
    ds_read_b64_tr_b16 v[132:133], v199 offset:0
    v_mfma_f32_16x16x32_bf16 v[48:51], v[176:179], v[152:155], v[48:51]
    ds_read_b64_tr_b16 v[134:135], v199 offset:512
    v_mfma_f32_16x16x32_bf16 v[52:55], v[176:179], v[156:159], v[52:55]
    ds_read_b64_tr_b16 v[136:137], v198 offset:2048
    v_mfma_f32_16x16x32_bf16 v[56:59], v[176:179], v[160:163], v[56:59]
    ds_read_b64_tr_b16 v[138:139], v198 offset:2560
    v_mfma_f32_16x16x32_bf16 v[60:63], v[176:179], v[164:167], v[60:63]
    ds_read_b64_tr_b16 v[140:141], v199 offset:2048
    v_mfma_f32_16x16x32_bf16 v[76:79], v[180:183], v[164:167], v[76:79]
    ds_read_b64_tr_b16 v[142:143], v199 offset:2560
    v_mfma_f32_16x16x32_bf16 v[72:75], v[180:183], v[160:163], v[72:75]
    ds_read_b64_tr_b16 v[144:145], v198 offset:4096
    v_mfma_f32_16x16x32_bf16 v[68:71], v[180:183], v[156:159], v[68:71]
    ds_read_b64_tr_b16 v[146:147], v198 offset:4608
    v_mfma_f32_16x16x32_bf16 v[64:67], v[180:183], v[152:155], v[64:67]
    ds_read_b64_tr_b16 v[148:149], v199 offset:4096
    v_mfma_f32_16x16x32_bf16 v[80:83], v[184:187], v[152:155], v[80:83]
    ds_read_b64_tr_b16 v[150:151], v199 offset:4608
    v_mfma_f32_16x16x32_bf16 v[84:87], v[184:187], v[156:159], v[84:87]
    v_mfma_f32_16x16x32_bf16 v[88:91], v[184:187], v[160:163], v[88:91]
    v_mfma_f32_16x16x32_bf16 v[92:95], v[184:187], v[164:167], v[92:95]
    v_mfma_f32_16x16x32_bf16 v[108:111], v[188:191], v[164:167], v[108:111]
    v_mfma_f32_16x16x32_bf16 v[104:107], v[188:191], v[160:163], v[104:107]
    v_mfma_f32_16x16x32_bf16 v[100:103], v[188:191], v[156:159], v[100:103]
    v_mfma_f32_16x16x32_bf16 v[96:99], v[188:191], v[152:155], v[96:99]
    s_waitcnt lgkmcnt(0)
    v_mfma_f32_16x16x32_bf16 v[16:19], v[128:131], v[112:115], v[16:19]
    ds_read_b128 v[152:155], v197 offset:0
    v_mfma_f32_16x16x32_bf16 v[20:23], v[128:131], v[116:119], v[20:23]
    ds_read_b64_tr_b16 v[168:169], v198 offset:20480
    v_mfma_f32_16x16x32_bf16 v[24:27], v[128:131], v[120:123], v[24:27]
    ds_read_b64_tr_b16 v[170:171], v198 offset:20992
    v_mfma_f32_16x16x32_bf16 v[28:31], v[128:131], v[124:127], v[28:31]
    ds_read_b128 v[156:159], v197 offset:2048
    v_mfma_f32_16x16x32_bf16 v[44:47], v[132:135], v[124:127], v[44:47]
    ds_read_b128 v[160:163], v197 offset:10240
    v_mfma_f32_16x16x32_bf16 v[40:43], v[132:135], v[120:123], v[40:43]
    ds_read_b128 v[164:167], v197 offset:12288
    v_mfma_f32_16x16x32_bf16 v[36:39], v[132:135], v[116:119], v[36:39]
    ds_read_b64_tr_b16 v[172:173], v199 offset:20480
    v_mfma_f32_16x16x32_bf16 v[32:35], v[132:135], v[112:115], v[32:35]
    ds_read_b64_tr_b16 v[174:175], v199 offset:20992
    v_mfma_f32_16x16x32_bf16 v[48:51], v[136:139], v[112:115], v[48:51]
    ds_read_b64_tr_b16 v[176:177], v198 offset:22528
    v_mfma_f32_16x16x32_bf16 v[52:55], v[136:139], v[116:119], v[52:55]
    ds_read_b64_tr_b16 v[178:179], v198 offset:23040
    v_mfma_f32_16x16x32_bf16 v[56:59], v[136:139], v[120:123], v[56:59]
    ds_read_b64_tr_b16 v[180:181], v199 offset:22528
    v_mfma_f32_16x16x32_bf16 v[60:63], v[136:139], v[124:127], v[60:63]
    ds_read_b64_tr_b16 v[182:183], v199 offset:23040
    v_mfma_f32_16x16x32_bf16 v[76:79], v[140:143], v[124:127], v[76:79]
    ds_read_b64_tr_b16 v[184:185], v198 offset:24576
    v_mfma_f32_16x16x32_bf16 v[72:75], v[140:143], v[120:123], v[72:75]
    ds_read_b64_tr_b16 v[186:187], v198 offset:25088
    v_mfma_f32_16x16x32_bf16 v[68:71], v[140:143], v[116:119], v[68:71]
    ds_read_b64_tr_b16 v[188:189], v199 offset:24576
    v_mfma_f32_16x16x32_bf16 v[64:67], v[140:143], v[112:115], v[64:67]
    ds_read_b64_tr_b16 v[190:191], v199 offset:25088
    v_mfma_f32_16x16x32_bf16 v[80:83], v[144:147], v[112:115], v[80:83]
    v_mfma_f32_16x16x32_bf16 v[84:87], v[144:147], v[116:119], v[84:87]
    v_mfma_f32_16x16x32_bf16 v[88:91], v[144:147], v[120:123], v[88:91]
    v_mfma_f32_16x16x32_bf16 v[92:95], v[144:147], v[124:127], v[92:95]
    v_mfma_f32_16x16x32_bf16 v[108:111], v[148:151], v[124:127], v[108:111]
    v_mfma_f32_16x16x32_bf16 v[104:107], v[148:151], v[120:123], v[104:107]
    v_mfma_f32_16x16x32_bf16 v[100:103], v[148:151], v[116:119], v[100:103]
    v_mfma_f32_16x16x32_bf16 v[96:99], v[148:151], v[112:115], v[96:99]
    s_waitcnt lgkmcnt(0)
    v_mfma_f32_16x16x32_bf16 v[16:19], v[168:171], v[152:155], v[16:19]
    s_barrier
    v_mfma_f32_16x16x32_bf16 v[20:23], v[168:171], v[156:159], v[20:23]
    ds_read_b128 v[112:115], v200 offset:0
    v_mfma_f32_16x16x32_bf16 v[24:27], v[168:171], v[160:163], v[24:27]
    ds_read_b64_tr_b16 v[128:129], v202 offset:0
    v_mfma_f32_16x16x32_bf16 v[28:31], v[168:171], v[164:167], v[28:31]
    ds_read_b64_tr_b16 v[130:131], v202 offset:512
    v_mfma_f32_16x16x32_bf16 v[44:47], v[172:175], v[164:167], v[44:47]
    ds_read_b128 v[116:119], v200 offset:2048
    v_mfma_f32_16x16x32_bf16 v[40:43], v[172:175], v[160:163], v[40:43]
    ds_read_b128 v[120:123], v200 offset:10240
    v_mfma_f32_16x16x32_bf16 v[36:39], v[172:175], v[156:159], v[36:39]
    ds_read_b128 v[124:127], v200 offset:12288
    v_mfma_f32_16x16x32_bf16 v[32:35], v[172:175], v[152:155], v[32:35]
    ds_read_b64_tr_b16 v[132:133], v203 offset:0
    v_mfma_f32_16x16x32_bf16 v[48:51], v[176:179], v[152:155], v[48:51]
    ds_read_b64_tr_b16 v[134:135], v203 offset:512
    v_mfma_f32_16x16x32_bf16 v[52:55], v[176:179], v[156:159], v[52:55]
    ds_read_b64_tr_b16 v[136:137], v202 offset:2048
    v_mfma_f32_16x16x32_bf16 v[56:59], v[176:179], v[160:163], v[56:59]
    ds_read_b64_tr_b16 v[138:139], v202 offset:2560
    v_mfma_f32_16x16x32_bf16 v[60:63], v[176:179], v[164:167], v[60:63]
    ds_read_b64_tr_b16 v[140:141], v203 offset:2048
    v_mfma_f32_16x16x32_bf16 v[76:79], v[180:183], v[164:167], v[76:79]
    ds_read_b64_tr_b16 v[142:143], v203 offset:2560
    v_mfma_f32_16x16x32_bf16 v[72:75], v[180:183], v[160:163], v[72:75]
    ds_read_b64_tr_b16 v[144:145], v202 offset:4096
    v_mfma_f32_16x16x32_bf16 v[68:71], v[180:183], v[156:159], v[68:71]
    ds_read_b64_tr_b16 v[146:147], v202 offset:4608
    v_mfma_f32_16x16x32_bf16 v[64:67], v[180:183], v[152:155], v[64:67]
    ds_read_b64_tr_b16 v[148:149], v203 offset:4096
    v_mfma_f32_16x16x32_bf16 v[80:83], v[184:187], v[152:155], v[80:83]
    ds_read_b64_tr_b16 v[150:151], v203 offset:4608
    v_mfma_f32_16x16x32_bf16 v[84:87], v[184:187], v[156:159], v[84:87]
    v_mfma_f32_16x16x32_bf16 v[88:91], v[184:187], v[160:163], v[88:91]
    v_mfma_f32_16x16x32_bf16 v[92:95], v[184:187], v[164:167], v[92:95]
    v_mfma_f32_16x16x32_bf16 v[108:111], v[188:191], v[164:167], v[108:111]
    v_mfma_f32_16x16x32_bf16 v[104:107], v[188:191], v[160:163], v[104:107]
    v_mfma_f32_16x16x32_bf16 v[100:103], v[188:191], v[156:159], v[100:103]
    v_mfma_f32_16x16x32_bf16 v[96:99], v[188:191], v[152:155], v[96:99]
    s_waitcnt lgkmcnt(0)
    v_mfma_f32_16x16x32_bf16 v[16:19], v[128:131], v[112:115], v[16:19]
    ds_read_b128 v[152:155], v201 offset:0
    v_mfma_f32_16x16x32_bf16 v[20:23], v[128:131], v[116:119], v[20:23]
    ds_read_b64_tr_b16 v[168:169], v202 offset:20480
    v_mfma_f32_16x16x32_bf16 v[24:27], v[128:131], v[120:123], v[24:27]
    ds_read_b64_tr_b16 v[170:171], v202 offset:20992
    v_mfma_f32_16x16x32_bf16 v[28:31], v[128:131], v[124:127], v[28:31]
    ds_read_b128 v[156:159], v201 offset:2048
    v_mfma_f32_16x16x32_bf16 v[44:47], v[132:135], v[124:127], v[44:47]
    ds_read_b128 v[160:163], v201 offset:10240
    v_mfma_f32_16x16x32_bf16 v[40:43], v[132:135], v[120:123], v[40:43]
    ds_read_b128 v[164:167], v201 offset:12288
    v_mfma_f32_16x16x32_bf16 v[36:39], v[132:135], v[116:119], v[36:39]
    ds_read_b64_tr_b16 v[172:173], v203 offset:20480
    v_mfma_f32_16x16x32_bf16 v[32:35], v[132:135], v[112:115], v[32:35]
    ds_read_b64_tr_b16 v[174:175], v203 offset:20992
    v_mfma_f32_16x16x32_bf16 v[48:51], v[136:139], v[112:115], v[48:51]
    ds_read_b64_tr_b16 v[176:177], v202 offset:22528
    v_mfma_f32_16x16x32_bf16 v[52:55], v[136:139], v[116:119], v[52:55]
    ds_read_b64_tr_b16 v[178:179], v202 offset:23040
    v_mfma_f32_16x16x32_bf16 v[56:59], v[136:139], v[120:123], v[56:59]
    ds_read_b64_tr_b16 v[180:181], v203 offset:22528
    v_mfma_f32_16x16x32_bf16 v[60:63], v[136:139], v[124:127], v[60:63]
    ds_read_b64_tr_b16 v[182:183], v203 offset:23040
    v_mfma_f32_16x16x32_bf16 v[76:79], v[140:143], v[124:127], v[76:79]
    ds_read_b64_tr_b16 v[184:185], v202 offset:24576
    v_mfma_f32_16x16x32_bf16 v[72:75], v[140:143], v[120:123], v[72:75]
    ds_read_b64_tr_b16 v[186:187], v202 offset:25088
    v_mfma_f32_16x16x32_bf16 v[68:71], v[140:143], v[116:119], v[68:71]
    ds_read_b64_tr_b16 v[188:189], v203 offset:24576
    v_mfma_f32_16x16x32_bf16 v[64:67], v[140:143], v[112:115], v[64:67]
    ds_read_b64_tr_b16 v[190:191], v203 offset:25088
    v_mfma_f32_16x16x32_bf16 v[80:83], v[144:147], v[112:115], v[80:83]
    v_mfma_f32_16x16x32_bf16 v[84:87], v[144:147], v[116:119], v[84:87]
    v_mfma_f32_16x16x32_bf16 v[88:91], v[144:147], v[120:123], v[88:91]
    v_mfma_f32_16x16x32_bf16 v[92:95], v[144:147], v[124:127], v[92:95]
    v_mfma_f32_16x16x32_bf16 v[108:111], v[148:151], v[124:127], v[108:111]
    v_mfma_f32_16x16x32_bf16 v[104:107], v[148:151], v[120:123], v[104:107]
    v_mfma_f32_16x16x32_bf16 v[100:103], v[148:151], v[116:119], v[100:103]
    v_mfma_f32_16x16x32_bf16 v[96:99], v[148:151], v[112:115], v[96:99]
    s_waitcnt lgkmcnt(0)
    v_mfma_f32_16x16x32_bf16 v[16:19], v[168:171], v[152:155], v[16:19]
    s_barrier
    v_mfma_f32_16x16x32_bf16 v[20:23], v[168:171], v[156:159], v[20:23]
    ds_read_b128 v[112:115], v192 offset:0
    v_mfma_f32_16x16x32_bf16 v[24:27], v[168:171], v[160:163], v[24:27]
    ds_read_b64_tr_b16 v[128:129], v194 offset:0
    v_mfma_f32_16x16x32_bf16 v[28:31], v[168:171], v[164:167], v[28:31]
    ds_read_b64_tr_b16 v[130:131], v194 offset:512
    v_mfma_f32_16x16x32_bf16 v[44:47], v[172:175], v[164:167], v[44:47]
    ds_read_b128 v[116:119], v192 offset:2048
    v_mfma_f32_16x16x32_bf16 v[40:43], v[172:175], v[160:163], v[40:43]
    ds_read_b128 v[120:123], v192 offset:10240
    v_mfma_f32_16x16x32_bf16 v[36:39], v[172:175], v[156:159], v[36:39]
    ds_read_b128 v[124:127], v192 offset:12288
    v_mfma_f32_16x16x32_bf16 v[32:35], v[172:175], v[152:155], v[32:35]
    ds_read_b64_tr_b16 v[132:133], v195 offset:0
    v_mfma_f32_16x16x32_bf16 v[48:51], v[176:179], v[152:155], v[48:51]
    ds_read_b64_tr_b16 v[134:135], v195 offset:512
    v_mfma_f32_16x16x32_bf16 v[52:55], v[176:179], v[156:159], v[52:55]
    ds_read_b64_tr_b16 v[136:137], v194 offset:2048
    v_mfma_f32_16x16x32_bf16 v[56:59], v[176:179], v[160:163], v[56:59]
    ds_read_b64_tr_b16 v[138:139], v194 offset:2560
    v_mfma_f32_16x16x32_bf16 v[60:63], v[176:179], v[164:167], v[60:63]
    ds_read_b64_tr_b16 v[140:141], v195 offset:2048
    v_mfma_f32_16x16x32_bf16 v[76:79], v[180:183], v[164:167], v[76:79]
    ds_read_b64_tr_b16 v[142:143], v195 offset:2560
    v_mfma_f32_16x16x32_bf16 v[72:75], v[180:183], v[160:163], v[72:75]
    ds_read_b64_tr_b16 v[144:145], v194 offset:4096
    v_mfma_f32_16x16x32_bf16 v[68:71], v[180:183], v[156:159], v[68:71]
    ds_read_b64_tr_b16 v[146:147], v194 offset:4608
    v_mfma_f32_16x16x32_bf16 v[64:67], v[180:183], v[152:155], v[64:67]
    ds_read_b64_tr_b16 v[148:149], v195 offset:4096
    v_mfma_f32_16x16x32_bf16 v[80:83], v[184:187], v[152:155], v[80:83]
    ds_read_b64_tr_b16 v[150:151], v195 offset:4608
    v_mfma_f32_16x16x32_bf16 v[84:87], v[184:187], v[156:159], v[84:87]
    v_mfma_f32_16x16x32_bf16 v[88:91], v[184:187], v[160:163], v[88:91]
    v_mfma_f32_16x16x32_bf16 v[92:95], v[184:187], v[164:167], v[92:95]
    v_mfma_f32_16x16x32_bf16 v[108:111], v[188:191], v[164:167], v[108:111]
    v_mfma_f32_16x16x32_bf16 v[104:107], v[188:191], v[160:163], v[104:107]
    v_mfma_f32_16x16x32_bf16 v[100:103], v[188:191], v[156:159], v[100:103]
    v_mfma_f32_16x16x32_bf16 v[96:99], v[188:191], v[152:155], v[96:99]
    s_waitcnt lgkmcnt(0)
    v_mfma_f32_16x16x32_bf16 v[16:19], v[128:131], v[112:115], v[16:19]
    ds_read_b128 v[152:155], v193 offset:0
    v_mfma_f32_16x16x32_bf16 v[20:23], v[128:131], v[116:119], v[20:23]
    ds_read_b64_tr_b16 v[168:169], v194 offset:20480
    v_mfma_f32_16x16x32_bf16 v[24:27], v[128:131], v[120:123], v[24:27]
    ds_read_b64_tr_b16 v[170:171], v194 offset:20992
    v_mfma_f32_16x16x32_bf16 v[28:31], v[128:131], v[124:127], v[28:31]
    ds_read_b128 v[156:159], v193 offset:2048
    v_mfma_f32_16x16x32_bf16 v[44:47], v[132:135], v[124:127], v[44:47]
    ds_read_b128 v[160:163], v193 offset:10240
    v_mfma_f32_16x16x32_bf16 v[40:43], v[132:135], v[120:123], v[40:43]
    ds_read_b128 v[164:167], v193 offset:12288
    v_mfma_f32_16x16x32_bf16 v[36:39], v[132:135], v[116:119], v[36:39]
    ds_read_b64_tr_b16 v[172:173], v195 offset:20480
    v_mfma_f32_16x16x32_bf16 v[32:35], v[132:135], v[112:115], v[32:35]
    ds_read_b64_tr_b16 v[174:175], v195 offset:20992
    v_mfma_f32_16x16x32_bf16 v[48:51], v[136:139], v[112:115], v[48:51]
    ds_read_b64_tr_b16 v[176:177], v194 offset:22528
    v_mfma_f32_16x16x32_bf16 v[52:55], v[136:139], v[116:119], v[52:55]
    ds_read_b64_tr_b16 v[178:179], v194 offset:23040
    v_mfma_f32_16x16x32_bf16 v[56:59], v[136:139], v[120:123], v[56:59]
    ds_read_b64_tr_b16 v[180:181], v195 offset:22528
    v_mfma_f32_16x16x32_bf16 v[60:63], v[136:139], v[124:127], v[60:63]
    ds_read_b64_tr_b16 v[182:183], v195 offset:23040
    v_mfma_f32_16x16x32_bf16 v[76:79], v[140:143], v[124:127], v[76:79]
    ds_read_b64_tr_b16 v[184:185], v194 offset:24576
    v_mfma_f32_16x16x32_bf16 v[72:75], v[140:143], v[120:123], v[72:75]
    ds_read_b64_tr_b16 v[186:187], v194 offset:25088
    v_mfma_f32_16x16x32_bf16 v[68:71], v[140:143], v[116:119], v[68:71]
    ds_read_b64_tr_b16 v[188:189], v195 offset:24576
    v_mfma_f32_16x16x32_bf16 v[64:67], v[140:143], v[112:115], v[64:67]
    ds_read_b64_tr_b16 v[190:191], v195 offset:25088
    v_mfma_f32_16x16x32_bf16 v[80:83], v[144:147], v[112:115], v[80:83]
    v_mfma_f32_16x16x32_bf16 v[84:87], v[144:147], v[116:119], v[84:87]
    v_mfma_f32_16x16x32_bf16 v[88:91], v[144:147], v[120:123], v[88:91]
    v_mfma_f32_16x16x32_bf16 v[92:95], v[144:147], v[124:127], v[92:95]
    v_mfma_f32_16x16x32_bf16 v[108:111], v[148:151], v[124:127], v[108:111]
    s_add_u32 s68, s68, 1
    s_cmp_lt_u32 s68, 5
    v_mfma_f32_16x16x32_bf16 v[104:107], v[148:151], v[120:123], v[104:107]
    v_mfma_f32_16x16x32_bf16 v[100:103], v[148:151], v[116:119], v[100:103]
    v_mfma_f32_16x16x32_bf16 v[96:99], v[148:151], v[112:115], v[96:99]
    s_waitcnt lgkmcnt(0)
    v_mfma_f32_16x16x32_bf16 v[16:19], v[168:171], v[152:155], v[16:19]
    s_cbranch_scc0 L_cexit
    s_barrier
    v_mfma_f32_16x16x32_bf16 v[20:23], v[168:171], v[156:159], v[20:23]
    ds_read_b128 v[112:115], v196 offset:0
    v_mfma_f32_16x16x32_bf16 v[24:27], v[168:171], v[160:163], v[24:27]
    ds_read_b64_tr_b16 v[128:129], v198 offset:0
    s_branch L_cloop
L_cexit:
    v_mfma_f32_16x16x32_bf16 v[20:23], v[168:171], v[156:159], v[20:23]
    v_mfma_f32_16x16x32_bf16 v[24:27], v[168:171], v[160:163], v[24:27]
    v_mfma_f32_16x16x32_bf16 v[28:31], v[168:171], v[164:167], v[28:31]
    v_mfma_f32_16x16x32_bf16 v[44:47], v[172:175], v[164:167], v[44:47]
    v_mfma_f32_16x16x32_bf16 v[40:43], v[172:175], v[160:163], v[40:43]
    v_mfma_f32_16x16x32_bf16 v[36:39], v[172:175], v[156:159], v[36:39]
    v_mfma_f32_16x16x32_bf16 v[32:35], v[172:175], v[152:155], v[32:35]
    v_mfma_f32_16x16x32_bf16 v[48:51], v[176:179], v[152:155], v[48:51]
    v_mfma_f32_16x16x32_bf16 v[52:55], v[176:179], v[156:159], v[52:55]
    v_mfma_f32_16x16x32_bf16 v[56:59], v[176:179], v[160:163], v[56:59]
    s_barrier
    ds_read_b32 v11, v10 offset:53248
    ds_read_b64 v[222:223], v213 offset:49152
    ds_read_b64 v[224:225], v213 offset:49280
    v_mfma_f32_16x16x32_bf16 v[60:63], v[176:179], v[164:167], v[60:63]
    ds_read_b64 v[226:227], v213 offset:49408
    ds_read_b64 v[228:229], v213 offset:49536
    v_mfma_f32_16x16x32_bf16 v[76:79], v[180:183], v[164:167], v[76:79]
    ds_read_b64 v[238:239], v215 offset:50176
    ds_read_b64 v[240:241], v215 offset:50304
    v_mfma_f32_16x16x32_bf16 v[72:75], v[180:183], v[160:163], v[72:75]
    ds_read_b64 v[242:243], v215 offset:50688
    ds_read_b64 v[244:245], v215 offset:50816
    v_mfma_f32_16x16x32_bf16 v[68:71], v[180:183], v[156:159], v[68:71]
    ds_read_b64 v[246:247], v215 offset:51200
    ds_read_b64 v[248:249], v215 offset:51328
    v_mfma_f32_16x16x32_bf16 v[64:67], v[180:183], v[152:155], v[64:67]
    ds_read_b32 v250, v214 offset:49156
    ds_read_b32 v252, v214 offset:49412
    v_mfma_f32_16x16x32_bf16 v[80:83], v[184:187], v[152:155], v[80:83]
    s_waitcnt lgkmcnt(8)
    v_readfirstlane_b32 s100, v11
    v_mov_b32_e64 v230, v223
    v_cndmask_b32 v222, 0, v222, s[86:87]
    v_mfma_f32_16x16x32_bf16 v[84:87], v[184:187], v[156:159], v[84:87]
    v_mov_b32_e64 v232, v225
    v_cndmask_b32 v224, 0, v224, s[86:87]
    v_mov_b32_e64 v234, v227
    v_cndmask_b32 v226, 0, v226, s[86:87]
    v_mfma_f32_16x16x32_bf16 v[88:91], v[184:187], v[160:163], v[88:91]
    v_mov_b32_e64 v236, v229
    v_cndmask_b32 v228, 0, v228, s[86:87]
    v_mov_b32 v223, v222
    v_mov_b32 v225, v224
    v_mfma_f32_16x16x32_bf16 v[92:95], v[184:187], v[164:167], v[92:95]
    v_mov_b32 v227, v226
    v_mov_b32_e64 v229, v228
    s_waitcnt lgkmcnt(0)
    v_mul_f32 v251, 0x3fb8aa3b, v250
    v_mfma_f32_16x16x32_bf16 v[108:111], v[188:191], v[164:167], v[108:111]
    v_mul_f32 v253, 0x3fb8aa3b, v252
    v_mfma_f32_16x16x32_bf16 v[104:107], v[188:191], v[160:163], v[104:107]
    v_mfma_f32_16x16x32_bf16 v[100:103], v[188:191], v[156:159], v[100:103]
    v_mfma_f32_16x16x32_bf16 v[96:99], v[188:191], v[152:155], v[96:99]
    v_mfma_f32_16x16x16_bf16 v[48:51], v[242:243], v[222:223], v[48:51]
    v_xor_b32 v168, 0, v217
    v_xor_b32 v169, 16, v217
    v_mfma_f32_16x16x16_bf16 v[52:55], v[242:243], v[224:225], v[52:55]
    v_xor_b32 v170, 32, v217
    v_xor_b32 v171, 48, v217
    v_mfma_f32_16x16x16_bf16 v[64:67], v[244:245], v[222:223], v[64:67]
    v_xor_b32_e64 v172, 64, v217
    v_xor_b32 v173, 80, v217
    v_mfma_f32_16x16x16_bf16 v[68:71], v[244:245], v[224:225], v[68:71]
    v_xor_b32 v174, 96, v217
    v_xor_b32 v175, 112, v217
    v_mfma_f32_16x16x16_bf16 v[56:59], v[242:243], v[226:227], v[56:59]
    v_xor_b32_e64 v4, 32, v216
    v_mfma_f32_16x16x16_bf16 v[60:63], v[242:243], v[228:229], v[60:63]
    v_mfma_f32_16x16x16_bf16 v[72:75], v[244:245], v[226:227], v[72:75]
    v_mfma_f32_16x16x16_bf16 v[76:79], v[244:245], v[228:229], v[76:79]
    v_mfma_f32_16x16x16_bf16 v[80:83], v[246:247], v[222:223], v[80:83]
    v_cvt_pk_bf16_f32 v112, v48, v49
    v_cvt_pk_bf16_f32 v113, v50, v51
    v_mfma_f32_16x16x16_bf16 v[84:87], v[246:247], v[224:225], v[84:87]
    v_cvt_pk_bf16_f32 v114, v52, v53
    v_cvt_pk_bf16_f32 v115, v54, v55
    v_mfma_f32_16x16x16_bf16 v[88:91], v[246:247], v[226:227], v[88:91]
    v_cvt_pk_bf16_f32 v116, v64, v65
    v_cvt_pk_bf16_f32 v117, v66, v67
    v_mfma_f32_16x16x16_bf16 v[92:95], v[246:247], v[228:229], v[92:95]
    v_cvt_pk_bf16_f32 v118, v68, v69
    v_cvt_pk_bf16_f32 v119, v70, v71
    v_mfma_f32_16x16x16_bf16 v[96:99], v[248:249], v[222:223], v[96:99]
    v_cvt_pk_bf16_f32 v120, v56, v57
    v_cvt_pk_bf16_f32 v121, v58, v59
    v_mfma_f32_16x16x16_bf16 v[100:103], v[248:249], v[224:225], v[100:103]
    v_cvt_pk_bf16_f32 v122, v60, v61
    v_cvt_pk_bf16_f32 v123, v62, v63
    v_mfma_f32_16x16x16_bf16 v[104:107], v[248:249], v[226:227], v[104:107]
    v_permlane16_swap_b32 v112, v114
    v_permlane16_swap_b32 v113, v115
    v_mfma_f32_16x16x16_bf16 v[108:111], v[248:249], v[228:229], v[108:111]
    v_permlane16_swap_b32 v116, v118
    v_permlane16_swap_b32 v117, v119
    v_cvt_pk_bf16_f32 v124, v72, v73
    v_cvt_pk_bf16_f32 v125, v74, v75
    v_cvt_pk_bf16_f32 v126, v76, v77
    v_cvt_pk_bf16_f32 v127, v78, v79
    v_permlane16_swap_b32 v120, v122
    v_permlane16_swap_b32 v121, v123
    v_permlane16_swap_b32 v124, v126
    v_permlane16_swap_b32 v125, v127
    v_mfma_f32_32x32x16_bf16 v[48:63], v[204:207], v[112:115], 0
    v_mul_f32 v80, v80, v230
    v_mul_f32 v81, v81, v230
    v_mul_f32 v82, v82, v230
    v_mul_f32 v83, v83, v230
    v_cvt_pk_bf16_f32 v80, v80, v81
    v_cvt_pk_bf16_f32 v81, v82, v83
    v_mfma_f32_32x32x16_bf16 v[64:79], v[204:207], v[120:123], 0
    v_mul_f32 v96, v96, v230
    v_mul_f32 v97, v97, v230
    v_mul_f32 v98, v98, v230
    v_mul_f32 v99, v99, v230
    v_cvt_pk_bf16_f32 v96, v96, v97
    v_cvt_pk_bf16_f32 v97, v98, v99
    v_mfma_f32_32x32x16_bf16 v[48:63], v[208:211], v[116:119], v[48:63]
    v_mul_f32 v84, v84, v232
    v_mul_f32 v85, v85, v232
    v_mul_f32 v86, v86, v232
    v_mul_f32 v87, v87, v232
    v_cvt_pk_bf16_f32 v84, v84, v85
    v_cvt_pk_bf16_f32 v85, v86, v87
    v_mfma_f32_32x32x16_bf16 v[64:79], v[208:211], v[124:127], v[64:79]
    v_mul_f32 v100, v100, v232
    v_mul_f32 v101, v101, v232
    v_mul_f32 v102, v102, v232
    v_mul_f32 v103, v103, v232
    v_cvt_pk_bf16_f32 v100, v100, v101
    v_cvt_pk_bf16_f32 v101, v102, v103
    v_mul_f32 v88, v88, v234
    v_mul_f32 v89, v89, v234
    v_mul_f32 v90, v90, v234
    v_mul_f32 v91, v91, v234
    v_cvt_pk_bf16_f32 v88, v88, v89
    v_cvt_pk_bf16_f32 v89, v90, v91
    v_mul_f32 v104, v104, v234
    v_mul_f32 v105, v105, v234
    v_mul_f32 v106, v106, v234
    v_mul_f32 v107, v107, v234
    v_cvt_pk_bf16_f32 v104, v104, v105
    v_cvt_pk_bf16_f32 v105, v106, v107
    v_mul_f32 v92, v92, v236
    v_mul_f32 v93, v93, v236
    v_mul_f32 v94, v94, v236
    v_mul_f32 v95, v95, v236
    v_cvt_pk_bf16_f32 v92, v92, v93
    v_cvt_pk_bf16_f32 v93, v94, v95
    v_mul_f32 v108, v108, v236
    v_mul_f32 v109, v109, v236
    v_mul_f32 v110, v110, v236
    v_mul_f32 v111, v111, v236
    v_cvt_pk_bf16_f32 v108, v108, v109
    v_cvt_pk_bf16_f32 v109, v110, v111
    v_max3_f32 v160, v48, v49, v50
    v_min3_f32 v162, v48, v49, v50
    v_max3_f32 v160, v160, v51, v52
    v_min3_f32 v162, v162, v51, v52
    v_max3_f32 v160, v160, v53, v54
    v_min3_f32 v162, v162, v53, v54
    v_max3_f32 v160, v160, v55, v56
    v_min3_f32 v162, v162, v55, v56
    v_max3_f32 v160, v160, v57, v58
    v_min3_f32 v162, v162, v57, v58
    v_max3_f32 v160, v160, v59, v60
    v_min3_f32 v162, v162, v59, v60
    v_max3_f32 v160, v160, v61, v62
    v_min3_f32 v162, v162, v61, v62
    v_max_f32 v160, v160, v63
    v_min_f32 v162, v162, v63
    v_max3_f32 v164, v64, v65, v66
    v_min3_f32 v166, v64, v65, v66
    v_max3_f32 v164, v164, v67, v68
    v_min3_f32 v166, v166, v67, v68
    v_max3_f32 v164, v164, v69, v70
    v_min3_f32 v166, v166, v69, v70
    v_max3_f32 v164, v164, v71, v72
    v_min3_f32 v166, v166, v71, v72
    v_max3_f32 v164, v164, v73, v74
    v_min3_f32 v166, v166, v73, v74
    v_max3_f32 v164, v164, v75, v76
    v_min3_f32 v166, v166, v75, v76
    v_max3_f32 v164, v164, v77, v78
    v_min3_f32 v166, v166, v77, v78
    v_max_f32 v164, v164, v79
    v_min_f32 v166, v166, v79
    v_mov_b32 v161, v160
    v_mov_b32 v163, v162
    v_mov_b32 v165, v164
    v_mov_b32 v167, v166
    v_permlane32_swap_b32 v160, v161
    v_permlane32_swap_b32 v162, v163
    v_permlane32_swap_b32 v164, v165
    v_permlane32_swap_b32 v166, v167
    v_max_f32 v160, v160, v161
    v_min_f32 v162, v162, v163
    v_max_f32 v164, v164, v165
    v_min_f32 v166, v166, v167
    v_mul_f32 v160, v160, v251
    v_mul_f32 v162, v162, v251
    v_mul_f32 v164, v164, v253
    v_mul_f32 v166, v166, v253
    v_pk_fma_f32 v[128:129], v[48:49], v[250:251], v[160:161] op_sel:[0,1,0] op_sel_hi:[1,1,0] neg_lo:[0,0,1] neg_hi:[0,0,1]
    v_pk_fma_f32 v[48:49], v[48:49], v[250:251], v[162:163] op_sel:[0,1,0] op_sel_hi:[1,1,0] neg_lo:[0,1,0] neg_hi:[0,1,0]
    v_pk_fma_f32 v[130:131], v[50:51], v[250:251], v[160:161] op_sel:[0,1,0] op_sel_hi:[1,1,0] neg_lo:[0,0,1] neg_hi:[0,0,1]
    v_pk_fma_f32 v[50:51], v[50:51], v[250:251], v[162:163] op_sel:[0,1,0] op_sel_hi:[1,1,0] neg_lo:[0,1,0] neg_hi:[0,1,0]
    v_pk_fma_f32 v[132:133], v[52:53], v[250:251], v[160:161] op_sel:[0,1,0] op_sel_hi:[1,1,0] neg_lo:[0,0,1] neg_hi:[0,0,1]
    v_pk_fma_f32 v[52:53], v[52:53], v[250:251], v[162:163] op_sel:[0,1,0] op_sel_hi:[1,1,0] neg_lo:[0,1,0] neg_hi:[0,1,0]
    v_pk_fma_f32 v[134:135], v[54:55], v[250:251], v[160:161] op_sel:[0,1,0] op_sel_hi:[1,1,0] neg_lo:[0,0,1] neg_hi:[0,0,1]
    v_pk_fma_f32 v[54:55], v[54:55], v[250:251], v[162:163] op_sel:[0,1,0] op_sel_hi:[1,1,0] neg_lo:[0,1,0] neg_hi:[0,1,0]
    v_pk_fma_f32 v[136:137], v[56:57], v[250:251], v[160:161] op_sel:[0,1,0] op_sel_hi:[1,1,0] neg_lo:[0,0,1] neg_hi:[0,0,1]
    v_pk_fma_f32 v[56:57], v[56:57], v[250:251], v[162:163] op_sel:[0,1,0] op_sel_hi:[1,1,0] neg_lo:[0,1,0] neg_hi:[0,1,0]
    v_pk_fma_f32 v[138:139], v[58:59], v[250:251], v[160:161] op_sel:[0,1,0] op_sel_hi:[1,1,0] neg_lo:[0,0,1] neg_hi:[0,0,1]
    v_pk_fma_f32 v[58:59], v[58:59], v[250:251], v[162:163] op_sel:[0,1,0] op_sel_hi:[1,1,0] neg_lo:[0,1,0] neg_hi:[0,1,0]
    v_pk_fma_f32 v[140:141], v[60:61], v[250:251], v[160:161] op_sel:[0,1,0] op_sel_hi:[1,1,0] neg_lo:[0,0,1] neg_hi:[0,0,1]
    v_pk_fma_f32 v[60:61], v[60:61], v[250:251], v[162:163] op_sel:[0,1,0] op_sel_hi:[1,1,0] neg_lo:[0,1,0] neg_hi:[0,1,0]
    v_pk_fma_f32 v[142:143], v[62:63], v[250:251], v[160:161] op_sel:[0,1,0] op_sel_hi:[1,1,0] neg_lo:[0,0,1] neg_hi:[0,0,1]
    v_pk_fma_f32 v[62:63], v[62:63], v[250:251], v[162:163] op_sel:[0,1,0] op_sel_hi:[1,1,0] neg_lo:[0,1,0] neg_hi:[0,1,0]
    v_pk_fma_f32 v[144:145], v[64:65], v[252:253], v[164:165] op_sel:[0,1,0] op_sel_hi:[1,1,0] neg_lo:[0,0,1] neg_hi:[0,0,1]
    v_pk_fma_f32 v[64:65], v[64:65], v[252:253], v[166:167] op_sel:[0,1,0] op_sel_hi:[1,1,0] neg_lo:[0,1,0] neg_hi:[0,1,0]
    v_pk_fma_f32 v[146:147], v[66:67], v[252:253], v[164:165] op_sel:[0,1,0] op_sel_hi:[1,1,0] neg_lo:[0,0,1] neg_hi:[0,0,1]
    v_pk_fma_f32 v[66:67], v[66:67], v[252:253], v[166:167] op_sel:[0,1,0] op_sel_hi:[1,1,0] neg_lo:[0,1,0] neg_hi:[0,1,0]
    v_pk_fma_f32 v[148:149], v[68:69], v[252:253], v[164:165] op_sel:[0,1,0] op_sel_hi:[1,1,0] neg_lo:[0,0,1] neg_hi:[0,0,1]
    v_pk_fma_f32 v[68:69], v[68:69], v[252:253], v[166:167] op_sel:[0,1,0] op_sel_hi:[1,1,0] neg_lo:[0,1,0] neg_hi:[0,1,0]
    v_pk_fma_f32 v[150:151], v[70:71], v[252:253], v[164:165] op_sel:[0,1,0] op_sel_hi:[1,1,0] neg_lo:[0,0,1] neg_hi:[0,0,1]
    v_pk_fma_f32 v[70:71], v[70:71], v[252:253], v[166:167] op_sel:[0,1,0] op_sel_hi:[1,1,0] neg_lo:[0,1,0] neg_hi:[0,1,0]
    v_pk_fma_f32 v[152:153], v[72:73], v[252:253], v[164:165] op_sel:[0,1,0] op_sel_hi:[1,1,0] neg_lo:[0,0,1] neg_hi:[0,0,1]
    v_pk_fma_f32 v[72:73], v[72:73], v[252:253], v[166:167] op_sel:[0,1,0] op_sel_hi:[1,1,0] neg_lo:[0,1,0] neg_hi:[0,1,0]
    v_pk_fma_f32 v[154:155], v[74:75], v[252:253], v[164:165] op_sel:[0,1,0] op_sel_hi:[1,1,0] neg_lo:[0,0,1] neg_hi:[0,0,1]
    v_pk_fma_f32 v[74:75], v[74:75], v[252:253], v[166:167] op_sel:[0,1,0] op_sel_hi:[1,1,0] neg_lo:[0,1,0] neg_hi:[0,1,0]
    v_pk_fma_f32 v[156:157], v[76:77], v[252:253], v[164:165] op_sel:[0,1,0] op_sel_hi:[1,1,0] neg_lo:[0,0,1] neg_hi:[0,0,1]
    v_pk_fma_f32 v[76:77], v[76:77], v[252:253], v[166:167] op_sel:[0,1,0] op_sel_hi:[1,1,0] neg_lo:[0,1,0] neg_hi:[0,1,0]
    v_pk_fma_f32 v[158:159], v[78:79], v[252:253], v[164:165] op_sel:[0,1,0] op_sel_hi:[1,1,0] neg_lo:[0,0,1] neg_hi:[0,0,1]
    v_pk_fma_f32 v[78:79], v[78:79], v[252:253], v[166:167] op_sel:[0,1,0] op_sel_hi:[1,1,0] neg_lo:[0,1,0] neg_hi:[0,1,0]
    v_exp_f32_e64 v128, v128
    v_mfma_f32_16x16x16_bf16 v[16:19], v[238:239], v[222:223], v[16:19]
    v_exp_f32 v144, v144
    v_exp_f32 v129, v129
    v_exp_f32_e64 v145, v145
    v_mfma_f32_16x16x16_bf16 v[20:23], v[238:239], v[224:225], v[20:23]
    ds_write2st64_b64 v216, v[80:81], v[84:85] offset0:64 offset1:68
    v_exp_f32 v130, v130
    v_exp_f32 v146, v146
    v_exp_f32_e64 v131, v131
    v_mfma_f32_16x16x16_bf16 v[24:27], v[238:239], v[226:227], v[24:27]
    v_exp_f32 v147, v147
    v_exp_f32 v132, v132
    v_exp_f32_e64 v148, v148
    v_mfma_f32_16x16x16_bf16 v[28:31], v[238:239], v[228:229], v[28:31]
    ds_write2st64_b64 v4, v[96:97], v[100:101] offset0:64 offset1:68
    v_exp_f32 v133, v133
    v_exp_f32 v149, v149
    v_exp_f32_e64 v134, v134
    v_mfma_f32_16x16x16_bf16 v[32:35], v[240:241], v[222:223], v[32:35]
    v_exp_f32 v150, v150
    v_exp_f32 v135, v135
    v_exp_f32_e64 v151, v151
    v_mfma_f32_16x16x16_bf16 v[36:39], v[240:241], v[224:225], v[36:39]
    ds_write2st64_b64 v216, v[88:89], v[92:93] offset0:72 offset1:76
    v_exp_f32 v136, v136
    v_exp_f32 v152, v152
    v_exp_f32_e64 v137, v137
    v_mfma_f32_16x16x16_bf16 v[40:43], v[240:241], v[226:227], v[40:43]
    v_exp_f32 v153, v153
    v_exp_f32 v138, v138
    v_exp_f32_e64 v154, v154
    v_mfma_f32_16x16x16_bf16 v[44:47], v[240:241], v[228:229], v[44:47]
    ds_write2st64_b64 v4, v[104:105], v[108:109] offset0:72 offset1:76
    v_exp_f32 v139, v139
    v_exp_f32 v155, v155
    v_exp_f32 v140, v140
    v_exp_f32 v156, v156
    v_exp_f32 v141, v141
    v_exp_f32 v157, v157
    v_exp_f32 v142, v142
    v_exp_f32 v158, v158
    v_exp_f32 v143, v143
    v_exp_f32 v159, v159
    v_pk_add_f32 v[176:177], v[128:129], v[130:131]
    v_pk_add_f32 v[178:179], v[144:145], v[146:147]
    v_pk_add_f32 v[176:177], v[176:177], v[132:133]
    v_pk_add_f32 v[178:179], v[178:179], v[148:149]
    v_pk_add_f32 v[176:177], v[176:177], v[134:135]
    v_pk_add_f32 v[178:179], v[178:179], v[150:151]
    v_pk_add_f32 v[176:177], v[176:177], v[136:137]
    v_pk_add_f32 v[178:179], v[178:179], v[152:153]
    v_pk_add_f32 v[176:177], v[176:177], v[138:139]
    v_pk_add_f32 v[178:179], v[178:179], v[154:155]
    v_pk_add_f32 v[176:177], v[176:177], v[140:141]
    v_pk_add_f32 v[178:179], v[178:179], v[156:157]
    v_pk_add_f32 v[176:177], v[176:177], v[142:143]
    v_pk_add_f32 v[178:179], v[178:179], v[158:159]
    v_exp_f32 v48, v48
    v_add_f32 v176, v176, v177
    v_add_f32 v178, v178, v179
    v_exp_f32 v64, v64
    v_mov_b32 v177, v176
    v_mov_b32 v179, v178
    v_exp_f32 v49, v49
    v_permlane32_swap_b32 v176, v177
    v_permlane32_swap_b32 v178, v179
    v_exp_f32 v65, v65
    v_add_f32 v176, v176, v177
    v_add_f32 v178, v178, v179
    v_exp_f32 v50, v50
    v_rcp_f32 v176, v176
    v_rcp_f32 v178, v178
    v_exp_f32 v66, v66
    v_exp_f32 v51, v51
    v_exp_f32 v67, v67
    v_exp_f32 v52, v52
    v_exp_f32 v68, v68
    v_exp_f32 v53, v53
    v_exp_f32 v69, v69
    v_exp_f32 v54, v54
    v_exp_f32 v70, v70
    v_exp_f32 v55, v55
    v_exp_f32 v71, v71
    v_exp_f32 v56, v56
    v_exp_f32 v72, v72
    v_exp_f32 v57, v57
    v_exp_f32 v73, v73
    v_exp_f32 v58, v58
    v_exp_f32 v74, v74
    v_exp_f32 v59, v59
    v_exp_f32 v75, v75
    v_exp_f32 v60, v60
    v_exp_f32 v76, v76
    v_exp_f32 v61, v61
    v_exp_f32 v77, v77
    v_exp_f32 v62, v62
    v_exp_f32 v78, v78
    v_exp_f32 v63, v63
    v_exp_f32 v79, v79
    v_pk_add_f32 v[180:181], v[48:49], v[50:51]
    v_pk_add_f32 v[182:183], v[64:65], v[66:67]
    v_pk_add_f32 v[180:181], v[180:181], v[52:53]
    v_pk_add_f32 v[182:183], v[182:183], v[68:69]
    v_pk_add_f32 v[180:181], v[180:181], v[54:55]
    v_pk_add_f32 v[182:183], v[182:183], v[70:71]
    v_pk_add_f32 v[180:181], v[180:181], v[56:57]
    v_pk_add_f32 v[182:183], v[182:183], v[72:73]
    v_pk_add_f32 v[180:181], v[180:181], v[58:59]
    v_pk_add_f32 v[182:183], v[182:183], v[74:75]
    v_pk_add_f32 v[180:181], v[180:181], v[60:61]
    v_pk_add_f32 v[182:183], v[182:183], v[76:77]
    v_pk_add_f32 v[180:181], v[180:181], v[62:63]
    v_pk_add_f32 v[182:183], v[182:183], v[78:79]
    v_add_f32 v180, v180, v181
    v_add_f32 v182, v182, v183
    v_mov_b32 v181, v180
    v_mov_b32 v183, v182
    v_pk_mul_f32 v[128:129], v[128:129], v[176:177] op_sel_hi:[1,0]
    v_pk_mul_f32 v[130:131], v[130:131], v[176:177] op_sel_hi:[1,0]
    v_cvt_pk_bf16_f32 v128, v128, v129
    v_permlane32_swap_b32 v180, v181
    v_permlane32_swap_b32 v182, v183
    v_cvt_pk_bf16_f32 v129, v130, v131
    v_pk_mul_f32 v[144:145], v[144:145], v[178:179] op_sel_hi:[1,0]
    v_pk_mul_f32 v[146:147], v[146:147], v[178:179] op_sel_hi:[1,0]
    v_cvt_pk_bf16_f32 v144, v144, v145
    v_cvt_pk_bf16_f32 v145, v146, v147
    v_add_f32 v180, v180, v181
    v_add_f32 v182, v182, v183
    ds_write2st64_b64 v168, v[128:129], v[144:145] offset0:0 offset1:8
    v_pk_mul_f32 v[132:133], v[132:133], v[176:177] op_sel_hi:[1,0]
    v_pk_mul_f32 v[134:135], v[134:135], v[176:177] op_sel_hi:[1,0]
    v_cvt_pk_bf16_f32 v132, v132, v133
    v_cvt_pk_bf16_f32 v133, v134, v135
    v_pk_mul_f32 v[148:149], v[148:149], v[178:179] op_sel_hi:[1,0]
    v_rcp_f32 v180, v180
    v_rcp_f32 v182, v182
    v_pk_mul_f32 v[150:151], v[150:151], v[178:179] op_sel_hi:[1,0]
    v_cvt_pk_bf16_f32 v148, v148, v149
    v_cvt_pk_bf16_f32 v149, v150, v151
    ds_write2st64_b64 v169, v[132:133], v[148:149] offset0:0 offset1:8
    v_pk_mul_f32 v[136:137], v[136:137], v[176:177] op_sel_hi:[1,0]
    v_pk_mul_f32 v[138:139], v[138:139], v[176:177] op_sel_hi:[1,0]
    v_cvt_pk_bf16_f32 v136, v136, v137
    v_cvt_pk_bf16_f32 v137, v138, v139
    v_pk_mul_f32 v[152:153], v[152:153], v[178:179] op_sel_hi:[1,0]
    v_pk_mul_f32 v[154:155], v[154:155], v[178:179] op_sel_hi:[1,0]
    v_cvt_pk_bf16_f32 v152, v152, v153
    v_cvt_pk_bf16_f32 v153, v154, v155
    ds_write2st64_b64 v170, v[136:137], v[152:153] offset0:0 offset1:8
    v_pk_mul_f32 v[140:141], v[140:141], v[176:177] op_sel_hi:[1,0]
    v_pk_mul_f32 v[142:143], v[142:143], v[176:177] op_sel_hi:[1,0]
    v_cvt_pk_bf16_f32 v140, v140, v141
    v_cvt_pk_bf16_f32 v141, v142, v143
    v_pk_mul_f32 v[156:157], v[156:157], v[178:179] op_sel_hi:[1,0]
    v_pk_mul_f32 v[158:159], v[158:159], v[178:179] op_sel_hi:[1,0]
    v_cvt_pk_bf16_f32 v156, v156, v157
    v_cvt_pk_bf16_f32 v157, v158, v159
    ds_write2st64_b64 v171, v[140:141], v[156:157] offset0:0 offset1:8
    v_pk_mul_f32 v[48:49], v[48:49], v[180:181] op_sel_hi:[1,0]
    v_pk_mul_f32 v[50:51], v[50:51], v[180:181] op_sel_hi:[1,0]
    v_cvt_pk_bf16_f32 v48, v48, v49
    v_cvt_pk_bf16_f32 v49, v50, v51
    v_pk_mul_f32 v[64:65], v[64:65], v[182:183] op_sel_hi:[1,0]
    v_pk_mul_f32 v[66:67], v[66:67], v[182:183] op_sel_hi:[1,0]
    v_cvt_pk_bf16_f32 v64, v64, v65
    v_cvt_pk_bf16_f32 v65, v66, v67
    ds_write2st64_b64 v172, v[48:49], v[64:65] offset0:0 offset1:8
    v_pk_mul_f32 v[52:53], v[52:53], v[180:181] op_sel_hi:[1,0]
    v_pk_mul_f32 v[54:55], v[54:55], v[180:181] op_sel_hi:[1,0]
    v_cvt_pk_bf16_f32 v52, v52, v53
    v_cvt_pk_bf16_f32 v53, v54, v55
    v_pk_mul_f32 v[68:69], v[68:69], v[182:183] op_sel_hi:[1,0]
    v_pk_mul_f32 v[70:71], v[70:71], v[182:183] op_sel_hi:[1,0]
    v_cvt_pk_bf16_f32 v68, v68, v69
    v_cvt_pk_bf16_f32 v69, v70, v71
    ds_write2st64_b64 v173, v[52:53], v[68:69] offset0:0 offset1:8
    v_pk_mul_f32 v[56:57], v[56:57], v[180:181] op_sel_hi:[1,0]
    v_pk_mul_f32 v[58:59], v[58:59], v[180:181] op_sel_hi:[1,0]
    v_cvt_pk_bf16_f32 v56, v56, v57
    v_cvt_pk_bf16_f32 v57, v58, v59
    v_pk_mul_f32 v[72:73], v[72:73], v[182:183] op_sel_hi:[1,0]
    v_pk_mul_f32 v[74:75], v[74:75], v[182:183] op_sel_hi:[1,0]
    v_cvt_pk_bf16_f32 v72, v72, v73
    v_cvt_pk_bf16_f32 v73, v74, v75
    ds_write2st64_b64 v174, v[56:57], v[72:73] offset0:0 offset1:8
    v_pk_mul_f32 v[60:61], v[60:61], v[180:181] op_sel_hi:[1,0]
    v_pk_mul_f32 v[62:63], v[62:63], v[180:181] op_sel_hi:[1,0]
    v_cvt_pk_bf16_f32 v60, v60, v61
    v_cvt_pk_bf16_f32 v61, v62, v63
    v_pk_mul_f32 v[76:77], v[76:77], v[182:183] op_sel_hi:[1,0]
    v_pk_mul_f32 v[78:79], v[78:79], v[182:183] op_sel_hi:[1,0]
    v_cvt_pk_bf16_f32 v76, v76, v77
    v_cvt_pk_bf16_f32 v77, v78, v79
    ds_write2st64_b64 v175, v[60:61], v[76:77] offset0:0 offset1:8
    ds_read_b64_tr_b16 v[112:113], v218 offset:0
    ds_read_b64_tr_b16 v[114:115], v219 offset:0
    ds_read_b64_tr_b16 v[144:145], v220 offset:32768
    ds_read_b64_tr_b16 v[146:147], v221 offset:32768
    ds_read_b64_tr_b16 v[116:117], v218 offset:2048
    ds_read_b64_tr_b16 v[118:119], v219 offset:2048
    ds_read_b64_tr_b16 v[148:149], v220 offset:34816
    ds_read_b64_tr_b16 v[150:151], v221 offset:34816
    ds_read_b64_tr_b16 v[120:121], v218 offset:4096
    ds_read_b64_tr_b16 v[122:123], v219 offset:4096
    ds_read_b64_tr_b16 v[152:153], v220 offset:36864
    ds_read_b64_tr_b16 v[154:155], v221 offset:36864
    v_cvt_pk_bf16_f32 v176, v16, v17
    v_cvt_pk_bf16_f32 v177, v18, v19
    v_cvt_pk_bf16_f32 v178, v20, v21
    v_cvt_pk_bf16_f32 v179, v22, v23
    v_cvt_pk_bf16_f32 v180, v32, v33
    v_cvt_pk_bf16_f32 v181, v34, v35
    v_cvt_pk_bf16_f32 v182, v36, v37
    v_cvt_pk_bf16_f32 v183, v38, v39
    v_cvt_pk_bf16_f32 v184, v24, v25
    v_cvt_pk_bf16_f32 v185, v26, v27
    v_cvt_pk_bf16_f32 v186, v28, v29
    v_cvt_pk_bf16_f32 v187, v30, v31
    v_cvt_pk_bf16_f32 v188, v40, v41
    v_cvt_pk_bf16_f32 v189, v42, v43
    v_cvt_pk_bf16_f32 v190, v44, v45
    v_cvt_pk_bf16_f32 v191, v46, v47
    s_waitcnt lgkmcnt(8)
    v_mfma_f32_32x32x16_bf16 v[48:63], v[112:115], v[144:147], 0
    ds_read_b64_tr_b16 v[124:125], v218 offset:6144
    ds_read_b64_tr_b16 v[126:127], v219 offset:6144
    ds_read_b64_tr_b16 v[156:157], v220 offset:38912
    ds_read_b64_tr_b16 v[158:159], v221 offset:38912
    s_waitcnt lgkmcnt(8)
    v_mfma_f32_32x32x16_bf16 v[48:63], v[116:119], v[148:151], v[48:63]
    v_xor_b32 v218, 8192, v218
    v_xor_b32 v219, 8192, v219
    v_xor_b32 v220, 8192, v220
    v_xor_b32 v221, 8192, v221
    s_barrier
    ds_read_b64_tr_b16 v[128:129], v218 offset:0
    ds_read_b64_tr_b16 v[130:131], v219 offset:0
    ds_read_b64_tr_b16 v[160:161], v220 offset:32768
    ds_read_b64_tr_b16 v[162:163], v221 offset:32768
    s_waitcnt lgkmcnt(8)
    v_mfma_f32_32x32x16_bf16 v[48:63], v[120:123], v[152:155], v[48:63]
    ds_read_b64_tr_b16 v[132:133], v218 offset:2048
    ds_read_b64_tr_b16 v[134:135], v219 offset:2048
    ds_read_b64_tr_b16 v[164:165], v220 offset:34816
    ds_read_b64_tr_b16 v[166:167], v221 offset:34816
    s_waitcnt lgkmcnt(8)
    v_mfma_f32_32x32x16_bf16 v[48:63], v[124:127], v[156:159], v[48:63]
    ds_read_b64_tr_b16 v[136:137], v218 offset:4096
    ds_read_b64_tr_b16 v[138:139], v219 offset:4096
    ds_read_b64_tr_b16 v[168:169], v220 offset:36864
    ds_read_b64_tr_b16 v[170:171], v221 offset:36864
    s_waitcnt lgkmcnt(8)
    v_mfma_f32_32x32x16_bf16 v[48:63], v[128:131], v[160:163], v[48:63]
    ds_read_b64_tr_b16 v[140:141], v218 offset:6144
    ds_read_b64_tr_b16 v[142:143], v219 offset:6144
    ds_read_b64_tr_b16 v[172:173], v220 offset:38912
    ds_read_b64_tr_b16 v[174:175], v221 offset:38912
    s_waitcnt lgkmcnt(8)
    v_mfma_f32_32x32x16_bf16 v[48:63], v[132:135], v[164:167], v[48:63]
    v_permlane16_swap_b32 v176, v178
    v_permlane16_swap_b32 v177, v179
    s_waitcnt lgkmcnt(4)
    v_mfma_f32_32x32x16_bf16 v[48:63], v[136:139], v[168:171], v[48:63]
    v_permlane16_swap_b32 v180, v182
    v_permlane16_swap_b32 v181, v183
    v_permlane16_swap_b32 v184, v186
    s_waitcnt lgkmcnt(0)
    v_mfma_f32_32x32x16_bf16 v[48:63], v[140:143], v[172:175], v[48:63]
    s_barrier
    v_permlane16_swap_b32 v185, v187
    v_permlane16_swap_b32 v188, v190
    v_permlane16_swap_b32 v189, v191
    s_lshl_b32 s76, s62, 11
    s_add_u32 s76, s76, s99
    v_mfma_f32_32x32x16_bf16 v[16:31], v[204:207], v[176:179], 0
    s_add_u32 s76, s76, 1024
    s_lshl_b32 s77, s62, 7
    s_add_u32 s77, s77, s73
    v_lshlrev_b32_e64 v4, 2, v2
    v_mfma_f32_32x32x16_bf16 v[32:47], v[204:207], v[184:187], 0
    v_cvt_pk_bf16_f32 v64, v48, v49
    v_cvt_pk_bf16_f32 v65, v50, v51
    v_cvt_pk_bf16_f32 v66, v52, v53
    v_cvt_pk_bf16_f32 v67, v54, v55
    v_cvt_pk_bf16_f32 v68, v56, v57
    v_mfma_f32_32x32x16_bf16 v[16:31], v[208:211], v[180:183], v[16:31]
    v_cvt_pk_bf16_f32 v69, v58, v59
    v_cvt_pk_bf16_f32 v70, v60, v61
    v_cvt_pk_bf16_f32 v71, v62, v63
    s_bitcmp1_b32 s100, 0
    s_cbranch_scc1 L_loc_59
    buffer_store_dwordx4 v[64:67], v12, s[40:43], s76 offen offset:0 sc1
    buffer_store_dwordx4 v[68:71], v12, s[40:43], s76 offen offset:1024 sc1
    s_branch L_pubd_60
L_loc_59:
    buffer_store_dwordx4 v[64:67], v12, s[40:43], s76 offen offset:0
    buffer_store_dwordx4 v[68:71], v12, s[40:43], s76 offen offset:1024
L_pubd_60:
    v_mfma_f32_32x32x16_bf16 v[32:47], v[208:211], v[188:191], v[32:47]
    v_and_b32 v216, 1, v1
    v_lshlrev_b32_e64 v216, 8, v216
    v_lshl_add_u32 v216, v3, 4, v216
    s_lshl_b32 s76, s64, 7
    v_add_u32 v216, s76, v216
    s_mul_i32 s78, s61, 28800
    s_lshl_b32 s79, s64, 8
    s_add_u32 s78, s78, s79
    s_add_u32 s79, s78, 3686400
    v_dot2_f32_bf16 v72, v112, s89, 0
    v_dot2_f32_bf16 v73, v113, s89, 0
    v_dot2_f32_bf16 v72, v114, s89, v72
    v_dot2_f32_bf16 v73, v115, s89, v73
    v_dot2_f32_bf16 v72, v116, s89, v72
    v_dot2_f32_bf16 v73, v117, s89, v73
    v_dot2_f32_bf16 v72, v118, s89, v72
    v_dot2_f32_bf16 v73, v119, s89, v73
    v_dot2_f32_bf16 v72, v120, s89, v72
    v_dot2_f32_bf16 v73, v121, s89, v73
    v_dot2_f32_bf16 v72, v122, s89, v72
    v_dot2_f32_bf16 v73, v123, s89, v73
    v_dot2_f32_bf16 v72, v124, s89, v72
    v_dot2_f32_bf16 v73, v125, s89, v73
    v_dot2_f32_bf16 v72, v126, s89, v72
    v_dot2_f32_bf16 v73, v127, s89, v73
    v_dot2_f32_bf16 v72, v128, s89, v72
    v_dot2_f32_bf16 v73, v129, s89, v73
    v_dot2_f32_bf16 v72, v130, s89, v72
    v_dot2_f32_bf16 v73, v131, s89, v73
    v_dot2_f32_bf16 v72, v132, s89, v72
    v_dot2_f32_bf16 v73, v133, s89, v73
    v_dot2_f32_bf16 v72, v134, s89, v72
    v_dot2_f32_bf16 v73, v135, s89, v73
    v_dot2_f32_bf16 v72, v136, s89, v72
    v_dot2_f32_bf16 v73, v137, s89, v73
    v_dot2_f32_bf16 v72, v138, s89, v72
    v_dot2_f32_bf16 v73, v139, s89, v73
    v_dot2_f32_bf16 v72, v140, s89, v72
    v_dot2_f32_bf16 v73, v141, s89, v73
    v_dot2_f32_bf16 v72, v142, s89, v72
    v_dot2_f32_bf16 v73, v143, s89, v73
    s_lshl_b32 s76, s98, 7
    v_lshl_add_u32 v10, v3, 3, s76
    v_lshlrev_b32 v11, 5, v1
    v_add_f32 v72, v72, v73
    v_mov_b32 v73, v72
    s_nop 1
    v_permlane32_swap_b32 v72, v73
    v_add_f32 v72, v72, v73
    s_mov_b32 exec_hi, 0
    s_bitcmp1_b32 s100, 0
    s_cbranch_scc1 L_loc_61
    buffer_store_dword v72, v4, s[40:43], s77 offen offset:2048 sc1
    s_branch L_pubd_62
L_loc_61:
    buffer_store_dword v72, v4, s[40:43], s77 offen offset:2048
L_pubd_62:
    s_mov_b64 exec, -1
    v_max3_f32 v160, v16, v17, v18
    v_min3_f32 v162, v16, v17, v18
    v_max3_f32 v160, v160, v19, v20
    v_min3_f32 v162, v162, v19, v20
    v_max3_f32 v160, v160, v21, v22
    v_min3_f32 v162, v162, v21, v22
    v_max3_f32 v160, v160, v23, v24
    v_min3_f32 v162, v162, v23, v24
    v_max3_f32 v160, v160, v25, v26
    v_min3_f32 v162, v162, v25, v26
    v_max3_f32 v160, v160, v27, v28
    v_min3_f32 v162, v162, v27, v28
    v_max3_f32 v160, v160, v29, v30
    v_min3_f32 v162, v162, v29, v30
    v_max_f32 v160, v160, v31
    v_min_f32 v162, v162, v31
    v_max3_f32 v164, v32, v33, v34
    v_min3_f32 v166, v32, v33, v34
    v_max3_f32 v164, v164, v35, v36
    v_min3_f32 v166, v166, v35, v36
    v_max3_f32 v164, v164, v37, v38
    v_min3_f32 v166, v166, v37, v38
    v_max3_f32 v164, v164, v39, v40
    v_min3_f32 v166, v166, v39, v40
    v_max3_f32 v164, v164, v41, v42
    v_min3_f32 v166, v166, v41, v42
    v_max3_f32 v164, v164, v43, v44
    v_min3_f32 v166, v166, v43, v44
    v_max3_f32 v164, v164, v45, v46
    v_min3_f32 v166, v166, v45, v46
    v_max_f32 v164, v164, v47
    v_min_f32 v166, v166, v47
    v_mov_b32 v161, v160
    v_mov_b32 v163, v162
    v_mov_b32 v165, v164
    v_mov_b32 v167, v166
    v_permlane32_swap_b32 v160, v161
    v_permlane32_swap_b32 v162, v163
    v_permlane32_swap_b32 v164, v165
    v_permlane32_swap_b32 v166, v167
    v_max_f32 v160, v160, v161
    v_min_f32 v162, v162, v163
    v_max_f32 v164, v164, v165
    v_min_f32 v166, v166, v167
    v_mul_f32 v160, v160, v251
    v_mul_f32 v162, v162, v251
    v_mul_f32 v164, v164, v253
    v_mul_f32 v166, v166, v253
    v_pk_fma_f32 v[128:129], v[16:17], v[250:251], v[160:161] op_sel:[0,1,0] op_sel_hi:[1,1,0] neg_lo:[0,0,1] neg_hi:[0,0,1]
    v_pk_fma_f32 v[16:17], v[16:17], v[250:251], v[162:163] op_sel:[0,1,0] op_sel_hi:[1,1,0] neg_lo:[0,1,0] neg_hi:[0,1,0]
    v_pk_fma_f32 v[130:131], v[18:19], v[250:251], v[160:161] op_sel:[0,1,0] op_sel_hi:[1,1,0] neg_lo:[0,0,1] neg_hi:[0,0,1]
    v_pk_fma_f32 v[18:19], v[18:19], v[250:251], v[162:163] op_sel:[0,1,0] op_sel_hi:[1,1,0] neg_lo:[0,1,0] neg_hi:[0,1,0]
    v_pk_fma_f32 v[132:133], v[20:21], v[250:251], v[160:161] op_sel:[0,1,0] op_sel_hi:[1,1,0] neg_lo:[0,0,1] neg_hi:[0,0,1]
    v_pk_fma_f32 v[20:21], v[20:21], v[250:251], v[162:163] op_sel:[0,1,0] op_sel_hi:[1,1,0] neg_lo:[0,1,0] neg_hi:[0,1,0]
    v_pk_fma_f32 v[134:135], v[22:23], v[250:251], v[160:161] op_sel:[0,1,0] op_sel_hi:[1,1,0] neg_lo:[0,0,1] neg_hi:[0,0,1]
    v_pk_fma_f32 v[22:23], v[22:23], v[250:251], v[162:163] op_sel:[0,1,0] op_sel_hi:[1,1,0] neg_lo:[0,1,0] neg_hi:[0,1,0]
    v_pk_fma_f32 v[136:137], v[24:25], v[250:251], v[160:161] op_sel:[0,1,0] op_sel_hi:[1,1,0] neg_lo:[0,0,1] neg_hi:[0,0,1]
    v_pk_fma_f32 v[24:25], v[24:25], v[250:251], v[162:163] op_sel:[0,1,0] op_sel_hi:[1,1,0] neg_lo:[0,1,0] neg_hi:[0,1,0]
    v_pk_fma_f32 v[138:139], v[26:27], v[250:251], v[160:161] op_sel:[0,1,0] op_sel_hi:[1,1,0] neg_lo:[0,0,1] neg_hi:[0,0,1]
    v_pk_fma_f32 v[26:27], v[26:27], v[250:251], v[162:163] op_sel:[0,1,0] op_sel_hi:[1,1,0] neg_lo:[0,1,0] neg_hi:[0,1,0]
    v_pk_fma_f32 v[140:141], v[28:29], v[250:251], v[160:161] op_sel:[0,1,0] op_sel_hi:[1,1,0] neg_lo:[0,0,1] neg_hi:[0,0,1]
    v_pk_fma_f32 v[28:29], v[28:29], v[250:251], v[162:163] op_sel:[0,1,0] op_sel_hi:[1,1,0] neg_lo:[0,1,0] neg_hi:[0,1,0]
    v_pk_fma_f32 v[142:143], v[30:31], v[250:251], v[160:161] op_sel:[0,1,0] op_sel_hi:[1,1,0] neg_lo:[0,0,1] neg_hi:[0,0,1]
    v_pk_fma_f32 v[30:31], v[30:31], v[250:251], v[162:163] op_sel:[0,1,0] op_sel_hi:[1,1,0] neg_lo:[0,1,0] neg_hi:[0,1,0]
    v_pk_fma_f32 v[144:145], v[32:33], v[252:253], v[164:165] op_sel:[0,1,0] op_sel_hi:[1,1,0] neg_lo:[0,0,1] neg_hi:[0,0,1]
    v_pk_fma_f32 v[32:33], v[32:33], v[252:253], v[166:167] op_sel:[0,1,0] op_sel_hi:[1,1,0] neg_lo:[0,1,0] neg_hi:[0,1,0]
    v_pk_fma_f32 v[146:147], v[34:35], v[252:253], v[164:165] op_sel:[0,1,0] op_sel_hi:[1,1,0] neg_lo:[0,0,1] neg_hi:[0,0,1]
    v_pk_fma_f32 v[34:35], v[34:35], v[252:253], v[166:167] op_sel:[0,1,0] op_sel_hi:[1,1,0] neg_lo:[0,1,0] neg_hi:[0,1,0]
    v_pk_fma_f32 v[148:149], v[36:37], v[252:253], v[164:165] op_sel:[0,1,0] op_sel_hi:[1,1,0] neg_lo:[0,0,1] neg_hi:[0,0,1]
    v_pk_fma_f32 v[36:37], v[36:37], v[252:253], v[166:167] op_sel:[0,1,0] op_sel_hi:[1,1,0] neg_lo:[0,1,0] neg_hi:[0,1,0]
    v_pk_fma_f32 v[150:151], v[38:39], v[252:253], v[164:165] op_sel:[0,1,0] op_sel_hi:[1,1,0] neg_lo:[0,0,1] neg_hi:[0,0,1]
    v_pk_fma_f32 v[38:39], v[38:39], v[252:253], v[166:167] op_sel:[0,1,0] op_sel_hi:[1,1,0] neg_lo:[0,1,0] neg_hi:[0,1,0]
    v_pk_fma_f32 v[152:153], v[40:41], v[252:253], v[164:165] op_sel:[0,1,0] op_sel_hi:[1,1,0] neg_lo:[0,0,1] neg_hi:[0,0,1]
    v_pk_fma_f32 v[40:41], v[40:41], v[252:253], v[166:167] op_sel:[0,1,0] op_sel_hi:[1,1,0] neg_lo:[0,1,0] neg_hi:[0,1,0]
    v_pk_fma_f32 v[154:155], v[42:43], v[252:253], v[164:165] op_sel:[0,1,0] op_sel_hi:[1,1,0] neg_lo:[0,0,1] neg_hi:[0,0,1]
    v_pk_fma_f32 v[42:43], v[42:43], v[252:253], v[166:167] op_sel:[0,1,0] op_sel_hi:[1,1,0] neg_lo:[0,1,0] neg_hi:[0,1,0]
    v_pk_fma_f32 v[156:157], v[44:45], v[252:253], v[164:165] op_sel:[0,1,0] op_sel_hi:[1,1,0] neg_lo:[0,0,1] neg_hi:[0,0,1]
    v_pk_fma_f32 v[44:45], v[44:45], v[252:253], v[166:167] op_sel:[0,1,0] op_sel_hi:[1,1,0] neg_lo:[0,1,0] neg_hi:[0,1,0]
    v_pk_fma_f32 v[158:159], v[46:47], v[252:253], v[164:165] op_sel:[0,1,0] op_sel_hi:[1,1,0] neg_lo:[0,0,1] neg_hi:[0,0,1]
    v_pk_fma_f32 v[46:47], v[46:47], v[252:253], v[166:167] op_sel:[0,1,0] op_sel_hi:[1,1,0] neg_lo:[0,1,0] neg_hi:[0,1,0]
    v_exp_f32 v128, v128
    v_exp_f32 v16, v16
    v_exp_f32 v129, v129
    v_exp_f32 v17, v17
    v_exp_f32 v130, v130
    v_exp_f32 v18, v18
    v_exp_f32 v131, v131
    v_exp_f32 v19, v19
    v_exp_f32 v132, v132
    v_exp_f32 v20, v20
    v_exp_f32 v133, v133
    v_exp_f32 v21, v21
    v_exp_f32 v134, v134
    v_exp_f32 v22, v22
    v_exp_f32 v135, v135
    v_exp_f32 v23, v23
    v_exp_f32 v136, v136
    v_exp_f32 v24, v24
    v_exp_f32 v137, v137
    v_exp_f32 v25, v25
    v_exp_f32 v138, v138
    v_exp_f32 v26, v26
    v_exp_f32 v139, v139
    v_exp_f32 v27, v27
    v_exp_f32 v140, v140
    v_exp_f32 v28, v28
    v_exp_f32 v141, v141
    v_exp_f32 v29, v29
    v_exp_f32 v142, v142
    v_exp_f32 v30, v30
    v_exp_f32 v143, v143
    v_exp_f32 v31, v31
    v_cvt_pk_bf16_f32 v218, v128, v129
    v_cvt_pk_bf16_f32 v219, v130, v131
    v_cvt_pk_bf16_f32 v220, v132, v133
    v_cvt_pk_bf16_f32 v221, v134, v135
    v_cvt_pk_bf16_f32 v222, v136, v137
    v_cvt_pk_bf16_f32 v223, v138, v139
    v_cvt_pk_bf16_f32 v224, v140, v141
    v_cvt_pk_bf16_f32 v225, v142, v143
    v_cvt_pk_bf16_f32 v226, v16, v17
    v_cvt_pk_bf16_f32 v227, v18, v19
    v_cvt_pk_bf16_f32 v228, v20, v21
    v_cvt_pk_bf16_f32 v229, v22, v23
    v_cvt_pk_bf16_f32 v230, v24, v25
    v_cvt_pk_bf16_f32 v231, v26, v27
    v_cvt_pk_bf16_f32 v232, v28, v29
    v_cvt_pk_bf16_f32 v233, v30, v31
    v_exp_f32 v144, v144
    v_exp_f32 v32, v32
    v_exp_f32 v145, v145
    v_exp_f32 v33, v33
    v_exp_f32 v146, v146
    v_exp_f32 v34, v34
    v_exp_f32 v147, v147
    v_exp_f32 v35, v35
    v_exp_f32 v148, v148
    v_exp_f32 v36, v36
    v_exp_f32 v149, v149
    v_exp_f32 v37, v37
    v_exp_f32 v150, v150
    v_exp_f32 v38, v38
    v_exp_f32 v151, v151
    v_exp_f32_e64 v39, v39
    s_barrier
    buffer_load_dwordx4 v[48:51], v13, s[40:43], s78 offen offset:3072 sc1
    buffer_load_dwordx4 v[52:55], v13, s[40:43], s79 offen offset:3072 sc1
    buffer_load_dwordx4 v[56:59], v13, s[40:43], s78 offen offset:3200 sc1
    buffer_load_dwordx4 v[60:63], v13, s[40:43], s79 offen offset:3200 sc1
    ds_read_b128 v[168:171], v216 offset:24576
    ds_read_b128 v[172:175], v216 offset:24608
    ds_read_b128 v[176:179], v216 offset:24640
    ds_read_b128 v[180:183], v216 offset:24672
    v_exp_f32 v152, v152
    v_exp_f32 v40, v40
    v_exp_f32 v153, v153
    v_exp_f32 v41, v41
    v_exp_f32 v154, v154
    v_exp_f32 v42, v42
    v_exp_f32 v155, v155
    v_exp_f32 v43, v43
    v_exp_f32 v156, v156
    v_exp_f32_e64 v44, v44
    s_waitcnt lgkmcnt(0)
    v_mfma_f32_32x32x16_bf16 v[64:79], v[168:171], v[218:221], 0
    v_exp_f32 v157, v157
    v_exp_f32 v45, v45
    v_exp_f32_e64 v158, v158
    v_mfma_f32_32x32x16_bf16 v[80:95], v[176:179], v[226:229], 0
    v_exp_f32 v46, v46
    v_exp_f32 v159, v159
    v_exp_f32_e64 v47, v47
    v_mfma_f32_32x32x16_bf16 v[64:79], v[172:175], v[222:225], v[64:79]
    v_cvt_pk_bf16_f32 v234, v144, v145
    v_cvt_pk_bf16_f32 v235, v146, v147
    v_cvt_pk_bf16_f32 v236, v148, v149
    v_cvt_pk_bf16_f32 v237, v150, v151
    v_cvt_pk_bf16_f32 v238, v152, v153
    v_cvt_pk_bf16_f32 v239, v154, v155
    v_mfma_f32_32x32x16_bf16 v[80:95], v[180:183], v[230:233], v[80:95]
    v_cvt_pk_bf16_f32 v240, v156, v157
    v_cvt_pk_bf16_f32 v241, v158, v159
    v_cvt_pk_bf16_f32 v242, v32, v33
    v_cvt_pk_bf16_f32 v243, v34, v35
    v_cvt_pk_bf16_f32 v244, v36, v37
    v_cvt_pk_bf16_f32 v245, v38, v39
    v_cvt_pk_bf16_f32 v246, v40, v41
    v_cvt_pk_bf16_f32 v247, v42, v43
    v_cvt_pk_bf16_f32 v248, v44, v45
    v_cvt_pk_bf16_f32 v249, v46, v47
    v_mfma_f32_32x32x16_bf16 v[96:111], v[168:171], v[234:237], 0
    v_rcp_f32 v184, v65
    v_rcp_f32 v185, v81
    v_mul_f32 v6, v64, v184
    v_fmac_f32 v6, v80, v185
    v_add_f32 v6, 0x358637bd, v6
    v_mfma_f32_32x32x16_bf16 v[112:127], v[176:179], v[242:245], 0
    v_rcp_f32 v6, v6
    v_mov_b32 v8, 0
    v_mul_f32 v184, v184, v6
    v_mul_f32_e64 v185, v185, v6
    s_lshl4_add_u32 s76, s60, s61
    v_mfma_f32_32x32x16_bf16 v[96:111], v[172:175], v[238:241], v[96:111]
    s_mul_i32 s76, s76, 32768
    s_lshl2_add_u32 s77, s63, s64
    s_lshl_b32 s77, s77, 12
    s_add_u32 s76, s76, s77
    s_add_u32 s76, s76, 16777216
    v_mfma_f32_32x32x16_bf16 v[112:127], v[180:183], v[246:249], v[112:127]
    s_add_u32 s77, s76, 8192
    v_add_u32 v14, 128, v12
    v_cmp_gt_u32 vcc, 24, v1
    s_nop 0
    s_nop 0
    v_cndmask_b32_e64 v14, v14, v12, vcc
    s_mov_b32 s88, 0
    s_branch L_pfirst_64
L_poll_63:
    buffer_load_dwordx4 v[48:51], v13, s[40:43], s78 offen offset:3072 sc1
    buffer_load_dwordx4 v[52:55], v13, s[40:43], s79 offen offset:3072 sc1
    buffer_load_dwordx4 v[56:59], v13, s[40:43], s78 offen offset:3200 sc1
    buffer_load_dwordx4 v[60:63], v13, s[40:43], s79 offen offset:3200 sc1
L_pfirst_64:
    s_waitcnt vmcnt(0)
    v_max3_u32 v9, v48, v49, v50
    v_max3_u32 v9, v9, v51, v52
    v_max3_u32 v9, v9, v53, v54
    v_max3_u32 v9, v9, v55, v56
    v_max3_u32 v9, v9, v57, v58
    v_max3_u32 v9, v9, v59, v60
    v_max3_u32 v9, v9, v61, v62
    v_max_u32 v9, v9, v63
    v_cmp_eq_u32 vcc, -1, v9
    s_nop 0
    s_cbranch_vccz L_ok_65
    s_add_u32 s88, s88, 1
    s_cmp_lt_u32 s88, 65536
    s_cbranch_scc1 L_poll_63
L_ok_65:
    v_mfma_f32_32x32x16_bf16 v[16:31], v[48:51], v[218:221], 0
    s_barrier
    v_rcp_f32 v186, v97
    v_rcp_f32 v187, v113
    v_mul_f32_e64 v7, v96, v186
    v_mfma_f32_32x32x16_bf16 v[128:143], v[56:59], v[226:229], 0
    v_fmac_f32_e64 v7, v112, v187
    v_add_f32 v7, 0x358637bd, v7
    v_rcp_f32_e64 v7, v7
    v_bfe_u32 v4, v2, 1, 3
    v_lshlrev_b32_e64 v4, 4, v4
    v_mfma_f32_32x32x16_bf16 v[16:31], v[52:55], v[222:225], v[16:31]
    v_mov_b32 v8, 0
    v_mul_f32 v186, v186, v7
    v_mul_f32_e64 v187, v187, v7
    v_lshl_add_u32 v4, v3, 3, v4
    v_lshl_add_u32 v4, v2, 7, v4
    s_lshl_b32 s56, s62, 12
    v_mfma_f32_32x32x16_bf16 v[128:143], v[60:63], v[230:233], v[128:143]
    s_add_u32 s57, s56, 0
    v_add_u32 v64, s57, v4
    v_xor_b32 v65, 16, v64
    v_xor_b32 v66, 32, v64
    v_xor_b32 v67, 48, v64
    v_xor_b32_e64 v68, 64, v64
    v_mfma_f32_32x32x16_bf16 v[32:47], v[48:51], v[234:237], 0
    v_xor_b32 v69, 80, v64
    v_xor_b32 v70, 96, v64
    v_xor_b32 v71, 112, v64
    v_bfe_u32 v4, v1, 2, 2
    v_lshl_add_u32 v5, v3, 2, v4
    v_lshlrev_b32 v5, 7, v5
    s_bitcmp1_b32 s100, 2
    v_mfma_f32_32x32x16_bf16 v[144:159], v[56:59], v[242:245], 0
    v_mul_f32 v16, v16, v184
    v_mul_f32 v17, v17, v184
    v_mul_f32 v18, v18, v184
    v_mul_f32 v19, v19, v184
    v_mul_f32 v20, v20, v184
    v_mul_f32 v21, v21, v184
    v_mfma_f32_32x32x16_bf16 v[32:47], v[52:55], v[238:241], v[32:47]
    v_mul_f32 v22, v22, v184
    v_mul_f32 v23, v23, v184
    v_mul_f32 v24, v24, v184
    v_mul_f32 v25, v25, v184
    v_mul_f32 v26, v26, v184
    v_mul_f32 v27, v27, v184
    v_mfma_f32_32x32x16_bf16 v[144:159], v[60:63], v[246:249], v[144:159]
    v_mul_f32 v28, v28, v184
    v_mul_f32 v29, v29, v184
    v_mul_f32 v30, v30, v184
    v_mul_f32 v31, v31, v184
    v_fmac_f32 v16, v128, v185
    v_fmac_f32 v17, v129, v185
    v_cvt_pk_bf16_f32 v96, v16, v17
    v_fmac_f32 v18, v130, v185
    v_fmac_f32 v19, v131, v185
    v_cvt_pk_bf16_f32 v97, v18, v19
    v_fmac_f32 v20, v132, v185
    v_fmac_f32 v21, v133, v185
    v_cvt_pk_bf16_f32 v98, v20, v21
    v_fmac_f32 v22, v134, v185
    v_fmac_f32 v23, v135, v185
    v_cvt_pk_bf16_f32 v99, v22, v23
    buffer_store_dwordx4 v[96:99], v14, s[40:43], s76 offen offset:0 sc1
    v_fmac_f32 v24, v136, v185
    v_fmac_f32 v25, v137, v185
    v_cvt_pk_bf16_f32 v100, v24, v25
    v_fmac_f32 v26, v138, v185
    v_fmac_f32 v27, v139, v185
    v_cvt_pk_bf16_f32 v101, v26, v27
    v_fmac_f32 v28, v140, v185
    v_fmac_f32 v29, v141, v185
    v_cvt_pk_bf16_f32 v102, v28, v29
    v_fmac_f32 v30, v142, v185
    v_fmac_f32 v31, v143, v185
    v_cvt_pk_bf16_f32 v103, v30, v31
    buffer_store_dwordx4 v[100:103], v14, s[40:43], s76 offen offset:2048 sc1
    v_pk_mul_f32 v[32:33], v[32:33], v[186:187] op_sel_hi:[1,0]
    v_pk_fma_f32 v[32:33], v[144:145], v[186:187], v[32:33] op_sel:[0,1,0] op_sel_hi:[1,1,1]
    v_cvt_pk_bf16_f32 v104, v32, v33
    v_pk_mul_f32 v[34:35], v[34:35], v[186:187] op_sel_hi:[1,0]
    v_pk_fma_f32 v[34:35], v[146:147], v[186:187], v[34:35] op_sel:[0,1,0] op_sel_hi:[1,1,1]
    v_cvt_pk_bf16_f32 v105, v34, v35
    v_pk_mul_f32 v[36:37], v[36:37], v[186:187] op_sel_hi:[1,0]
    v_pk_fma_f32 v[36:37], v[148:149], v[186:187], v[36:37] op_sel:[0,1,0] op_sel_hi:[1,1,1]
    v_cvt_pk_bf16_f32 v106, v36, v37
    v_pk_mul_f32 v[38:39], v[38:39], v[186:187] op_sel_hi:[1,0]
    v_pk_fma_f32 v[38:39], v[150:151], v[186:187], v[38:39] op_sel:[0,1,0] op_sel_hi:[1,1,1]
    v_cvt_pk_bf16_f32 v107, v38, v39
    buffer_store_dwordx4 v[104:107], v14, s[40:43], s77 offen offset:0 sc1
    v_pk_mul_f32 v[40:41], v[40:41], v[186:187] op_sel_hi:[1,0]
    v_pk_fma_f32 v[40:41], v[152:153], v[186:187], v[40:41] op_sel:[0,1,0] op_sel_hi:[1,1,1]
    v_cvt_pk_bf16_f32 v108, v40, v41
    v_pk_mul_f32 v[42:43], v[42:43], v[186:187] op_sel_hi:[1,0]
    v_pk_fma_f32 v[42:43], v[154:155], v[186:187], v[42:43] op_sel:[0,1,0] op_sel_hi:[1,1,1]
    v_cvt_pk_bf16_f32 v109, v42, v43
    v_pk_mul_f32 v[44:45], v[44:45], v[186:187] op_sel_hi:[1,0]
    v_pk_fma_f32 v[44:45], v[156:157], v[186:187], v[44:45] op_sel:[0,1,0] op_sel_hi:[1,1,1]
    v_cvt_pk_bf16_f32 v110, v44, v45
    v_pk_mul_f32 v[46:47], v[46:47], v[186:187] op_sel_hi:[1,0]
    v_pk_fma_f32 v[46:47], v[158:159], v[186:187], v[46:47] op_sel:[0,1,0] op_sel_hi:[1,1,1]
    v_cvt_pk_bf16_f32 v111, v46, v47
    buffer_store_dwordx4 v[108:111], v14, s[40:43], s77 offen offset:2048 sc1
    v_lshrrev_b32_e64 v4, 1, v4
    v_lshl_add_u32 v5, v4, 6, v5
    v_bfe_u32 v4, v1, 4, 1
    v_lshl_add_u32 v5, v4, 5, v5
    v_and_b32_e64 v4, 3, v1
    v_lshl_add_u32 v5, v4, 3, v5
    v_add_u32 v72, 32768, v5
    v_xor_b32_e64 v73, 64, v72
    s_mul_i32 s80, s97, 524288
    s_mul_i32 s56, s62, 8192
    s_add_u32 s80, s80, s56
    s_add_u32 s80, s80, 16777216
    v_add_u32 v78, 4096, v14
    v_mov_b32 v74, 1
    s_mov_b32 s52, 0xffff
    s_mov_b32 s53, 0
    s_barrier
    ds_read_b32 v79, v8 offset:25984
    ds_read_b64 v[88:89], v64
    ds_read_b64 v[90:91], v65
    ds_read_b64 v[92:93], v66
    ds_read_b64 v[94:95], v67
    ds_read_b64 v[96:97], v68
    ds_read_b64 v[98:99], v69
    ds_read_b64 v[100:101], v70
    ds_read_b64 v[102:103], v71
    s_waitcnt lgkmcnt(8)
    v_readfirstlane_b32 s76, v79
    s_nop 0
    s_and_b32 s76, s76, s52
    s_cbranch_scc0 L_tr0
L_bk0:
    s_ff1_i32_b32 s76, s76
    s_bitset0_b32 s52, s76
    s_add_u32 s77, s76, s65
    s_and_b32 s77, s77, 15
    s_mul_i32 s77, s77, 32768
    s_add_u32 s28, s77, s80
    s_add_u32 s76, s76, 3
    s_and_b32 s76, s76, 15
    s_lshl_b32 s4, s76, 13
    buffer_load_dwordx4 v[128:131], v14, s[40:43], s28 offen offset:0 sc1
    buffer_load_dwordx4 v[132:135], v14, s[40:43], s28 offen offset:2048 sc1
    buffer_load_dwordx4 v[136:139], v78, s[40:43], s28 offen offset:0 sc1
    buffer_load_dwordx4 v[140:143], v78, s[40:43], s28 offen offset:2048 sc1
    v_readfirstlane_b32 s76, v79
    s_nop 0
    s_and_b32 s76, s76, s52
    s_cbranch_scc0 L_tr1
L_bk1:
    s_ff1_i32_b32 s76, s76
    s_bitset0_b32 s52, s76
    s_add_u32 s77, s76, s65
    s_and_b32 s77, s77, 15
    s_mul_i32 s77, s77, 32768
    s_add_u32 s29, s77, s80
    s_add_u32 s76, s76, 3
    s_and_b32 s76, s76, 15
    s_lshl_b32 s5, s76, 13
    buffer_load_dwordx4 v[144:147], v14, s[40:43], s29 offen offset:0 sc1
    buffer_load_dwordx4 v[148:151], v14, s[40:43], s29 offen offset:2048 sc1
    v_add_u32 v80, s4, v72
    v_add_u32 v81, s4, v73
    s_waitcnt lgkmcnt(0)
    v_lshlrev_b32 v16, 16, v88
    v_and_b32 v17, s90, v88
    v_lshlrev_b32 v18, 16, v89
    v_and_b32 v19, s90, v89
    v_lshlrev_b32 v20, 16, v90
    v_and_b32 v21, s90, v90
    v_lshlrev_b32 v22, 16, v91
    v_and_b32 v23, s90, v91
    v_lshlrev_b32 v24, 16, v92
    v_and_b32 v25, s90, v92
    v_lshlrev_b32 v26, 16, v93
    v_and_b32 v27, s90, v93
    v_lshlrev_b32 v28, 16, v94
    v_and_b32 v29, s90, v94
    v_lshlrev_b32 v30, 16, v95
    v_and_b32 v31, s90, v95
    v_lshlrev_b32 v32, 16, v96
    v_and_b32 v33, s90, v96
    v_lshlrev_b32 v34, 16, v97
    v_and_b32 v35, s90, v97
    v_lshlrev_b32 v36, 16, v98
    v_and_b32 v37, s90, v98
    v_lshlrev_b32 v38, 16, v99
    v_and_b32 v39, s90, v99
    v_lshlrev_b32 v40, 16, v100
    v_and_b32 v41, s90, v100
    v_lshlrev_b32 v42, 16, v101
    v_and_b32 v43, s90, v101
    v_lshlrev_b32 v44, 16, v102
    v_and_b32 v45, s90, v102
    v_lshlrev_b32 v46, 16, v103
    v_and_b32 v47, s90, v103
    s_cmp_eq_u32 s53, 0
    s_cbranch_scc0 L_sent_66
    s_waitcnt vmcnt(6)
    s_mov_b64 exec, 1
    ds_add_u32 v8, v74 offset:25988
    s_mov_b64 exec, -1
    s_mov_b32 s53, 1
L_sent_66:
    ds_read_b32 v79, v8 offset:25984
    ds_read_b64_tr_b16 v[104:105], v80 offset:0
    ds_read_b64_tr_b16 v[106:107], v80 offset:1024
    ds_read_b64_tr_b16 v[108:109], v81 offset:0
    ds_read_b64_tr_b16 v[110:111], v81 offset:1024
    ds_read_b64_tr_b16 v[112:113], v80 offset:2048
    ds_read_b64_tr_b16 v[114:115], v80 offset:3072
    ds_read_b64_tr_b16 v[116:117], v81 offset:2048
    ds_read_b64_tr_b16 v[118:119], v81 offset:3072
    s_waitcnt vmcnt(5) lgkmcnt(4)
    v_mfma_f32_32x32x16_bf16 v[16:31], v[104:107], v[128:131], v[16:31]
    ds_read_b64_tr_b16 v[120:121], v80 offset:4096
    ds_read_b64_tr_b16 v[122:123], v80 offset:5120
    buffer_load_dwordx4 v[152:155], v78, s[40:43], s29 offen offset:0 sc1
    v_mfma_f32_32x32x16_bf16 v[32:47], v[108:111], v[128:131], v[32:47]
    ds_read_b64_tr_b16 v[124:125], v81 offset:4096
    ds_read_b64_tr_b16 v[126:127], v81 offset:5120
    buffer_load_dwordx4 v[156:159], v78, s[40:43], s29 offen offset:2048 sc1
    v_readfirstlane_b32 s76, v79
    s_nop 0
    s_and_b32 s76, s76, s52
    s_cbranch_scc0 L_tr2
L_bk2:
    s_ff1_i32_b32 s76, s76
    s_bitset0_b32 s52, s76
    s_add_u32 s77, s76, s65
    s_and_b32 s77, s77, 15
    s_mul_i32 s77, s77, 32768
    s_add_u32 s30, s77, s80
    s_waitcnt vmcnt(6) lgkmcnt(4)
    v_mfma_f32_32x32x16_bf16 v[16:31], v[112:115], v[132:135], v[16:31]
    ds_read_b32 v79, v8 offset:25984
    ds_read_b64_tr_b16 v[104:105], v80 offset:6144
    ds_read_b64_tr_b16 v[106:107], v80 offset:7168
    buffer_load_dwordx4 v[160:163], v14, s[40:43], s30 offen offset:0 sc1
    s_add_u32 s76, s76, 3
    s_and_b32 s76, s76, 15
    s_lshl_b32 s6, s76, 13
    v_mfma_f32_32x32x16_bf16 v[32:47], v[116:119], v[132:135], v[32:47]
    ds_read_b64_tr_b16 v[108:109], v81 offset:6144
    ds_read_b64_tr_b16 v[110:111], v81 offset:7168
    buffer_load_dwordx4 v[164:167], v14, s[40:43], s30 offen offset:2048 sc1
    v_add_u32 v82, s5, v72
    v_add_u32_e64 v83, s5, v73
    s_waitcnt vmcnt(7) lgkmcnt(4)
    v_mfma_f32_32x32x16_bf16 v[16:31], v[120:123], v[136:139], v[16:31]
    ds_read_b64_tr_b16 v[112:113], v82 offset:0
    ds_read_b64_tr_b16 v[114:115], v82 offset:1024
    buffer_load_dwordx4 v[168:171], v78, s[40:43], s30 offen offset:0 sc1
    v_mfma_f32_32x32x16_bf16 v[32:47], v[124:127], v[136:139], v[32:47]
    ds_read_b64_tr_b16 v[116:117], v83 offset:0
    ds_read_b64_tr_b16 v[118:119], v83 offset:1024
    buffer_load_dwordx4 v[172:175], v78, s[40:43], s30 offen offset:2048 sc1
    v_readfirstlane_b32 s76, v79
    s_nop 0
    s_and_b32 s76, s76, s52
    s_cbranch_scc0 L_tr3
L_bk3:
    s_ff1_i32_b32 s76, s76
    s_bitset0_b32 s52, s76
    s_add_u32 s77, s76, s65
    s_and_b32 s77, s77, 15
    s_mul_i32 s77, s77, 32768
    s_add_u32 s31, s77, s80
    s_waitcnt vmcnt(8) lgkmcnt(4)
    v_mfma_f32_32x32x16_bf16 v[16:31], v[104:107], v[140:143], v[16:31]
    ds_read_b32 v79, v8 offset:25984
    ds_read_b64_tr_b16 v[120:121], v82 offset:2048
    ds_read_b64_tr_b16 v[122:123], v82 offset:3072
    buffer_load_dwordx4 v[176:179], v14, s[40:43], s31 offen offset:0 sc1
    s_add_u32 s76, s76, 3
    s_and_b32 s76, s76, 15
    s_lshl_b32 s7, s76, 13
    v_mfma_f32_32x32x16_bf16 v[32:47], v[108:111], v[140:143], v[32:47]
    ds_read_b64_tr_b16 v[124:125], v83 offset:2048
    ds_read_b64_tr_b16 v[126:127], v83 offset:3072
    buffer_load_dwordx4 v[180:183], v14, s[40:43], s31 offen offset:2048 sc1
    s_waitcnt vmcnt(9) lgkmcnt(4)
    v_mfma_f32_32x32x16_bf16 v[16:31], v[112:115], v[144:147], v[16:31]
    ds_read_b64_tr_b16 v[104:105], v82 offset:4096
    ds_read_b64_tr_b16 v[106:107], v82 offset:5120
    buffer_load_dwordx4 v[184:187], v78, s[40:43], s31 offen offset:0 sc1
    v_mfma_f32_32x32x16_bf16 v[32:47], v[116:119], v[144:147], v[32:47]
    ds_read_b64_tr_b16 v[108:109], v83 offset:4096
    ds_read_b64_tr_b16 v[110:111], v83 offset:5120
    buffer_load_dwordx4 v[188:191], v78, s[40:43], s31 offen offset:2048 sc1
    v_readfirstlane_b32 s76, v79
    s_nop 0
    s_and_b32 s76, s76, s52
    s_cbranch_scc0 L_tr4
L_bk4:
    s_ff1_i32_b32 s76, s76
    s_bitset0_b32 s52, s76
    s_add_u32 s77, s76, s65
    s_and_b32 s77, s77, 15
    s_mul_i32 s77, s77, 32768
    s_add_u32 s32, s77, s80
    s_waitcnt vmcnt(10) lgkmcnt(4)
    v_mfma_f32_32x32x16_bf16 v[16:31], v[120:123], v[148:151], v[16:31]
    ds_read_b64_tr_b16 v[112:113], v82 offset:6144
    ds_read_b64_tr_b16 v[114:115], v82 offset:7168
    buffer_load_dwordx4 v[128:131], v14, s[40:43], s32 offen offset:0 sc1
    s_add_u32 s76, s76, 3
    s_and_b32 s76, s76, 15
    s_lshl_b32 s8, s76, 13
    v_mfma_f32_32x32x16_bf16 v[32:47], v[124:127], v[148:151], v[32:47]
    ds_read_b64_tr_b16 v[116:117], v83 offset:6144
    ds_read_b64_tr_b16 v[118:119], v83 offset:7168
    buffer_load_dwordx4 v[132:135], v14, s[40:43], s32 offen offset:2048 sc1
    v_add_u32 v80, s6, v72
    v_add_u32 v81, s6, v73
    s_waitcnt vmcnt(11) lgkmcnt(4)
    v_mfma_f32_32x32x16_bf16 v[16:31], v[104:107], v[152:155], v[16:31]
    ds_read_b32 v79, v8 offset:25984
    ds_read_b64_tr_b16 v[120:121], v80 offset:0
    ds_read_b64_tr_b16 v[122:123], v80 offset:1024
    buffer_load_dwordx4 v[136:139], v78, s[40:43], s32 offen offset:0 sc1
    v_mfma_f32_32x32x16_bf16 v[32:47], v[108:111], v[152:155], v[32:47]
    ds_read_b64_tr_b16 v[124:125], v81 offset:0
    ds_read_b64_tr_b16 v[126:127], v81 offset:1024
    s_waitcnt vmcnt(11) lgkmcnt(4)
    v_mfma_f32_32x32x16_bf16 v[16:31], v[112:115], v[156:159], v[16:31]
    ds_read_b64_tr_b16 v[104:105], v80 offset:2048
    ds_read_b64_tr_b16 v[106:107], v80 offset:3072
    buffer_load_dwordx4 v[140:143], v78, s[40:43], s32 offen offset:2048 sc1
    v_mfma_f32_32x32x16_bf16 v[32:47], v[116:119], v[156:159], v[32:47]
    ds_read_b64_tr_b16 v[108:109], v81 offset:2048
    ds_read_b64_tr_b16 v[110:111], v81 offset:3072
    v_readfirstlane_b32 s76, v79
    s_nop 0
    s_and_b32 s76, s76, s52
    s_cbranch_scc0 L_tr5
L_bk5:
    s_ff1_i32_b32 s76, s76
    s_bitset0_b32 s52, s76
    s_add_u32 s77, s76, s65
    s_and_b32 s77, s77, 15
    s_mul_i32 s77, s77, 32768
    s_add_u32 s33, s77, s80
    s_waitcnt vmcnt(11) lgkmcnt(4)
    v_mfma_f32_32x32x16_bf16 v[16:31], v[120:123], v[160:163], v[16:31]
    ds_read_b64_tr_b16 v[112:113], v80 offset:4096
    ds_read_b64_tr_b16 v[114:115], v80 offset:5120
    buffer_load_dwordx4 v[144:147], v14, s[40:43], s33 offen offset:0 sc1
    s_add_u32 s76, s76, 3
    s_and_b32 s76, s76, 15
    s_lshl_b32 s9, s76, 13
    v_mfma_f32_32x32x16_bf16 v[32:47], v[124:127], v[160:163], v[32:47]
    ds_read_b64_tr_b16 v[116:117], v81 offset:4096
    ds_read_b64_tr_b16 v[118:119], v81 offset:5120
    s_waitcnt vmcnt(11) lgkmcnt(4)
    v_mfma_f32_32x32x16_bf16 v[16:31], v[104:107], v[164:167], v[16:31]
    ds_read_b64_tr_b16 v[120:121], v80 offset:6144
    ds_read_b64_tr_b16 v[122:123], v80 offset:7168
    buffer_load_dwordx4 v[148:151], v14, s[40:43], s33 offen offset:2048 sc1
    v_mfma_f32_32x32x16_bf16 v[32:47], v[108:111], v[164:167], v[32:47]
    ds_read_b64_tr_b16 v[124:125], v81 offset:6144
    ds_read_b64_tr_b16 v[126:127], v81 offset:7168
    v_add_u32 v82, s7, v72
    v_add_u32 v83, s7, v73
    s_waitcnt vmcnt(11) lgkmcnt(4)
    v_mfma_f32_32x32x16_bf16 v[16:31], v[112:115], v[168:171], v[16:31]
    ds_read_b32 v79, v8 offset:25984
    ds_read_b64_tr_b16 v[104:105], v82 offset:0
    ds_read_b64_tr_b16 v[106:107], v82 offset:1024
    buffer_load_dwordx4 v[152:155], v78, s[40:43], s33 offen offset:0 sc1
    v_mfma_f32_32x32x16_bf16 v[32:47], v[116:119], v[168:171], v[32:47]
    ds_read_b64_tr_b16 v[108:109], v83 offset:0
    ds_read_b64_tr_b16 v[110:111], v83 offset:1024
    s_waitcnt vmcnt(11) lgkmcnt(4)
    v_mfma_f32_32x32x16_bf16 v[16:31], v[120:123], v[172:175], v[16:31]
    ds_read_b64_tr_b16 v[112:113], v82 offset:2048
    ds_read_b64_tr_b16 v[114:115], v82 offset:3072
    buffer_load_dwordx4 v[156:159], v78, s[40:43], s33 offen offset:2048 sc1
    v_mfma_f32_32x32x16_bf16 v[32:47], v[124:127], v[172:175], v[32:47]
    ds_read_b64_tr_b16 v[116:117], v83 offset:2048
    ds_read_b64_tr_b16 v[118:119], v83 offset:3072
    v_readfirstlane_b32 s76, v79
    s_nop 0
    s_and_b32 s76, s76, s52
    s_cbranch_scc0 L_tr6
L_bk6:
    s_ff1_i32_b32 s76, s76
    s_bitset0_b32 s52, s76
    s_add_u32 s77, s76, s65
    s_and_b32 s77, s77, 15
    s_mul_i32 s77, s77, 32768
    s_add_u32 s34, s77, s80
    s_waitcnt vmcnt(11) lgkmcnt(4)
    v_mfma_f32_32x32x16_bf16 v[16:31], v[104:107], v[176:179], v[16:31]
    ds_read_b64_tr_b16 v[120:121], v82 offset:4096
    ds_read_b64_tr_b16 v[122:123], v82 offset:5120
    buffer_load_dwordx4 v[160:163], v14, s[40:43], s34 offen offset:0 sc1
    s_add_u32 s76, s76, 3
    s_and_b32 s76, s76, 15
    s_lshl_b32 s10, s76, 13
    v_mfma_f32_32x32x16_bf16 v[32:47], v[108:111], v[176:179], v[32:47]
    ds_read_b64_tr_b16 v[124:125], v83 offset:4096
    ds_read_b64_tr_b16 v[126:127], v83 offset:5120
    s_waitcnt vmcnt(11) lgkmcnt(4)
    v_mfma_f32_32x32x16_bf16 v[16:31], v[112:115], v[180:183], v[16:31]
    ds_read_b64_tr_b16 v[104:105], v82 offset:6144
    ds_read_b64_tr_b16 v[106:107], v82 offset:7168
    buffer_load_dwordx4 v[164:167], v14, s[40:43], s34 offen offset:2048 sc1
    v_mfma_f32_32x32x16_bf16 v[32:47], v[116:119], v[180:183], v[32:47]
    ds_read_b64_tr_b16 v[108:109], v83 offset:6144
    ds_read_b64_tr_b16 v[110:111], v83 offset:7168
    v_add_u32 v80, s8, v72
    v_add_u32 v81, s8, v73
    s_waitcnt vmcnt(11) lgkmcnt(4)
    v_mfma_f32_32x32x16_bf16 v[16:31], v[120:123], v[184:187], v[16:31]
    ds_read_b32 v79, v8 offset:25984
    ds_read_b64_tr_b16 v[112:113], v80 offset:0
    ds_read_b64_tr_b16 v[114:115], v80 offset:1024
    buffer_load_dwordx4 v[168:171], v78, s[40:43], s34 offen offset:0 sc1
    v_mfma_f32_32x32x16_bf16 v[32:47], v[124:127], v[184:187], v[32:47]
    ds_read_b64_tr_b16 v[116:117], v81 offset:0
    ds_read_b64_tr_b16 v[118:119], v81 offset:1024
    s_waitcnt vmcnt(11) lgkmcnt(4)
    v_mfma_f32_32x32x16_bf16 v[16:31], v[104:107], v[188:191], v[16:31]
    ds_read_b64_tr_b16 v[120:121], v80 offset:2048
    ds_read_b64_tr_b16 v[122:123], v80 offset:3072
    buffer_load_dwordx4 v[172:175], v78, s[40:43], s34 offen offset:2048 sc1
    v_mfma_f32_32x32x16_bf16 v[32:47], v[108:111], v[188:191], v[32:47]
    ds_read_b64_tr_b16 v[124:125], v81 offset:2048
    ds_read_b64_tr_b16 v[126:127], v81 offset:3072
    v_readfirstlane_b32 s76, v79
    s_nop 0
    s_and_b32 s76, s76, s52
    s_cbranch_scc0 L_tr7
L_bk7:
    s_ff1_i32_b32 s76, s76
    s_bitset0_b32 s52, s76
    s_add_u32 s77, s76, s65
    s_and_b32 s77, s77, 15
    s_mul_i32 s77, s77, 32768
    s_add_u32 s35, s77, s80
    s_waitcnt vmcnt(11) lgkmcnt(4)
    v_mfma_f32_32x32x16_bf16 v[16:31], v[112:115], v[128:131], v[16:31]
    ds_read_b64_tr_b16 v[104:105], v80 offset:4096
    ds_read_b64_tr_b16 v[106:107], v80 offset:5120
    buffer_load_dwordx4 v[176:179], v14, s[40:43], s35 offen offset:0 sc1
    s_add_u32 s76, s76, 3
    s_and_b32 s76, s76, 15
    s_lshl_b32 s11, s76, 13
    v_mfma_f32_32x32x16_bf16 v[32:47], v[116:119], v[128:131], v[32:47]
    ds_read_b64_tr_b16 v[108:109], v81 offset:4096
    ds_read_b64_tr_b16 v[110:111], v81 offset:5120
    s_waitcnt vmcnt(11) lgkmcnt(4)
    v_mfma_f32_32x32x16_bf16 v[16:31], v[120:123], v[132:135], v[16:31]
    ds_read_b64_tr_b16 v[112:113], v80 offset:6144
    ds_read_b64_tr_b16 v[114:115], v80 offset:7168
    buffer_load_dwordx4 v[180:183], v14, s[40:43], s35 offen offset:2048 sc1
    v_mfma_f32_32x32x16_bf16 v[32:47], v[124:127], v[132:135], v[32:47]
    ds_read_b64_tr_b16 v[116:117], v81 offset:6144
    ds_read_b64_tr_b16 v[118:119], v81 offset:7168
    v_add_u32 v82, s9, v72
    v_add_u32 v83, s9, v73
    s_waitcnt vmcnt(11) lgkmcnt(4)
    v_mfma_f32_32x32x16_bf16 v[16:31], v[104:107], v[136:139], v[16:31]
    ds_read_b32 v79, v8 offset:25984
    ds_read_b64_tr_b16 v[120:121], v82 offset:0
    ds_read_b64_tr_b16 v[122:123], v82 offset:1024
    buffer_load_dwordx4 v[184:187], v78, s[40:43], s35 offen offset:0 sc1
    v_mfma_f32_32x32x16_bf16 v[32:47], v[108:111], v[136:139], v[32:47]
    ds_read_b64_tr_b16 v[124:125], v83 offset:0
    ds_read_b64_tr_b16 v[126:127], v83 offset:1024
    s_waitcnt vmcnt(11) lgkmcnt(4)
    v_mfma_f32_32x32x16_bf16 v[16:31], v[112:115], v[140:143], v[16:31]
    ds_read_b64_tr_b16 v[104:105], v82 offset:2048
    ds_read_b64_tr_b16 v[106:107], v82 offset:3072
    buffer_load_dwordx4 v[188:191], v78, s[40:43], s35 offen offset:2048 sc1
    v_mfma_f32_32x32x16_bf16 v[32:47], v[116:119], v[140:143], v[32:47]
    ds_read_b64_tr_b16 v[108:109], v83 offset:2048
    ds_read_b64_tr_b16 v[110:111], v83 offset:3072
    v_readfirstlane_b32 s76, v79
    s_nop 0
    s_and_b32 s76, s76, s52
    s_cbranch_scc0 L_tr8
L_bk8:
    s_ff1_i32_b32 s76, s76
    s_bitset0_b32 s52, s76
    s_add_u32 s77, s76, s65
    s_and_b32 s77, s77, 15
    s_mul_i32 s77, s77, 32768
    s_add_u32 s36, s77, s80
    s_waitcnt vmcnt(11) lgkmcnt(4)
    v_mfma_f32_32x32x16_bf16 v[16:31], v[120:123], v[144:147], v[16:31]
    ds_read_b64_tr_b16 v[112:113], v82 offset:4096
    ds_read_b64_tr_b16 v[114:115], v82 offset:5120
    buffer_load_dwordx4 v[128:131], v14, s[40:43], s36 offen offset:0 sc1
    s_add_u32 s76, s76, 3
    s_and_b32 s76, s76, 15
    s_lshl_b32 s12, s76, 13
    v_mfma_f32_32x32x16_bf16 v[32:47], v[124:127], v[144:147], v[32:47]
    ds_read_b64_tr_b16 v[116:117], v83 offset:4096
    ds_read_b64_tr_b16 v[118:119], v83 offset:5120
    s_waitcnt vmcnt(11) lgkmcnt(4)
    v_mfma_f32_32x32x16_bf16 v[16:31], v[104:107], v[148:151], v[16:31]
    ds_read_b64_tr_b16 v[120:121], v82 offset:6144
    ds_read_b64_tr_b16 v[122:123], v82 offset:7168
    buffer_load_dwordx4 v[132:135], v14, s[40:43], s36 offen offset:2048 sc1
    v_mfma_f32_32x32x16_bf16 v[32:47], v[108:111], v[148:151], v[32:47]
    ds_read_b64_tr_b16 v[124:125], v83 offset:6144
    ds_read_b64_tr_b16 v[126:127], v83 offset:7168
    v_add_u32 v80, s10, v72
    v_add_u32 v81, s10, v73
    s_waitcnt vmcnt(11) lgkmcnt(4)
    v_mfma_f32_32x32x16_bf16 v[16:31], v[112:115], v[152:155], v[16:31]
    ds_read_b32 v79, v8 offset:25984
    ds_read_b64_tr_b16 v[104:105], v80 offset:0
    ds_read_b64_tr_b16 v[106:107], v80 offset:1024
    buffer_load_dwordx4 v[136:139], v78, s[40:43], s36 offen offset:0 sc1
    v_mfma_f32_32x32x16_bf16 v[32:47], v[116:119], v[152:155], v[32:47]
    ds_read_b64_tr_b16 v[108:109], v81 offset:0
    ds_read_b64_tr_b16 v[110:111], v81 offset:1024
    s_waitcnt vmcnt(11) lgkmcnt(4)
    v_mfma_f32_32x32x16_bf16 v[16:31], v[120:123], v[156:159], v[16:31]
    ds_read_b64_tr_b16 v[112:113], v80 offset:2048
    ds_read_b64_tr_b16 v[114:115], v80 offset:3072
    buffer_load_dwordx4 v[140:143], v78, s[40:43], s36 offen offset:2048 sc1
    v_mfma_f32_32x32x16_bf16 v[32:47], v[124:127], v[156:159], v[32:47]
    ds_read_b64_tr_b16 v[116:117], v81 offset:2048
    ds_read_b64_tr_b16 v[118:119], v81 offset:3072
    v_readfirstlane_b32 s76, v79
    s_nop 0
    s_and_b32 s76, s76, s52
    s_cbranch_scc0 L_tr9
L_bk9:
    s_ff1_i32_b32 s76, s76
    s_bitset0_b32 s52, s76
    s_add_u32 s77, s76, s65
    s_and_b32 s77, s77, 15
    s_mul_i32 s77, s77, 32768
    s_add_u32 s37, s77, s80
    s_waitcnt vmcnt(11) lgkmcnt(4)
    v_mfma_f32_32x32x16_bf16 v[16:31], v[104:107], v[160:163], v[16:31]
    ds_read_b64_tr_b16 v[120:121], v80 offset:4096
    ds_read_b64_tr_b16 v[122:123], v80 offset:5120
    buffer_load_dwordx4 v[144:147], v14, s[40:43], s37 offen offset:0 sc1
    s_add_u32 s76, s76, 3
    s_and_b32 s76, s76, 15
    s_lshl_b32 s13, s76, 13
    v_mfma_f32_32x32x16_bf16 v[32:47], v[108:111], v[160:163], v[32:47]
    ds_read_b64_tr_b16 v[124:125], v81 offset:4096
    ds_read_b64_tr_b16 v[126:127], v81 offset:5120
    s_waitcnt vmcnt(11) lgkmcnt(4)
    v_mfma_f32_32x32x16_bf16 v[16:31], v[112:115], v[164:167], v[16:31]
    ds_read_b64_tr_b16 v[104:105], v80 offset:6144
    ds_read_b64_tr_b16 v[106:107], v80 offset:7168
    buffer_load_dwordx4 v[148:151], v14, s[40:43], s37 offen offset:2048 sc1
    v_mfma_f32_32x32x16_bf16 v[32:47], v[116:119], v[164:167], v[32:47]
    ds_read_b64_tr_b16 v[108:109], v81 offset:6144
    ds_read_b64_tr_b16 v[110:111], v81 offset:7168
    v_add_u32 v82, s11, v72
    v_add_u32 v83, s11, v73
    s_waitcnt vmcnt(11) lgkmcnt(4)
    v_mfma_f32_32x32x16_bf16 v[16:31], v[120:123], v[168:171], v[16:31]
    ds_read_b32 v79, v8 offset:25984
    ds_read_b64_tr_b16 v[112:113], v82 offset:0
    ds_read_b64_tr_b16 v[114:115], v82 offset:1024
    buffer_load_dwordx4 v[152:155], v78, s[40:43], s37 offen offset:0 sc1
    v_mfma_f32_32x32x16_bf16 v[32:47], v[124:127], v[168:171], v[32:47]
    ds_read_b64_tr_b16 v[116:117], v83 offset:0
    ds_read_b64_tr_b16 v[118:119], v83 offset:1024
    s_waitcnt vmcnt(11) lgkmcnt(4)
    v_mfma_f32_32x32x16_bf16 v[16:31], v[104:107], v[172:175], v[16:31]
    ds_read_b64_tr_b16 v[120:121], v82 offset:2048
    ds_read_b64_tr_b16 v[122:123], v82 offset:3072
    buffer_load_dwordx4 v[156:159], v78, s[40:43], s37 offen offset:2048 sc1
    v_mfma_f32_32x32x16_bf16 v[32:47], v[108:111], v[172:175], v[32:47]
    ds_read_b64_tr_b16 v[124:125], v83 offset:2048
    ds_read_b64_tr_b16 v[126:127], v83 offset:3072
    v_readfirstlane_b32 s76, v79
    s_nop 0
    s_and_b32 s76, s76, s52
    s_cbranch_scc0 L_tr10
L_bk10:
    s_ff1_i32_b32 s76, s76
    s_bitset0_b32 s52, s76
    s_add_u32 s77, s76, s65
    s_and_b32 s77, s77, 15
    s_mul_i32 s77, s77, 32768
    s_add_u32 s38, s77, s80
    s_waitcnt vmcnt(11) lgkmcnt(4)
    v_mfma_f32_32x32x16_bf16 v[16:31], v[112:115], v[176:179], v[16:31]
    ds_read_b64_tr_b16 v[104:105], v82 offset:4096
    ds_read_b64_tr_b16 v[106:107], v82 offset:5120
    buffer_load_dwordx4 v[160:163], v14, s[40:43], s38 offen offset:0 sc1
    s_add_u32 s76, s76, 3
    s_and_b32 s76, s76, 15
    s_lshl_b32 s14, s76, 13
    v_mfma_f32_32x32x16_bf16 v[32:47], v[116:119], v[176:179], v[32:47]
    ds_read_b64_tr_b16 v[108:109], v83 offset:4096
    ds_read_b64_tr_b16 v[110:111], v83 offset:5120
    s_waitcnt vmcnt(11) lgkmcnt(4)
    v_mfma_f32_32x32x16_bf16 v[16:31], v[120:123], v[180:183], v[16:31]
    ds_read_b64_tr_b16 v[112:113], v82 offset:6144
    ds_read_b64_tr_b16 v[114:115], v82 offset:7168
    buffer_load_dwordx4 v[164:167], v14, s[40:43], s38 offen offset:2048 sc1
    v_mfma_f32_32x32x16_bf16 v[32:47], v[124:127], v[180:183], v[32:47]
    ds_read_b64_tr_b16 v[116:117], v83 offset:6144
    ds_read_b64_tr_b16 v[118:119], v83 offset:7168
    v_add_u32 v80, s12, v72
    v_add_u32 v81, s12, v73
    s_waitcnt vmcnt(11) lgkmcnt(4)
    v_mfma_f32_32x32x16_bf16 v[16:31], v[104:107], v[184:187], v[16:31]
    ds_read_b32 v79, v8 offset:25984
    ds_read_b64_tr_b16 v[120:121], v80 offset:0
    ds_read_b64_tr_b16 v[122:123], v80 offset:1024
    buffer_load_dwordx4 v[168:171], v78, s[40:43], s38 offen offset:0 sc1
    v_mfma_f32_32x32x16_bf16 v[32:47], v[108:111], v[184:187], v[32:47]
    ds_read_b64_tr_b16 v[124:125], v81 offset:0
    ds_read_b64_tr_b16 v[126:127], v81 offset:1024
    s_waitcnt vmcnt(11) lgkmcnt(4)
    v_mfma_f32_32x32x16_bf16 v[16:31], v[112:115], v[188:191], v[16:31]
    ds_read_b64_tr_b16 v[104:105], v80 offset:2048
    ds_read_b64_tr_b16 v[106:107], v80 offset:3072
    buffer_load_dwordx4 v[172:175], v78, s[40:43], s38 offen offset:2048 sc1
    v_mfma_f32_32x32x16_bf16 v[32:47], v[116:119], v[188:191], v[32:47]
    ds_read_b64_tr_b16 v[108:109], v81 offset:2048
    ds_read_b64_tr_b16 v[110:111], v81 offset:3072
    v_readfirstlane_b32 s76, v79
    s_nop 0
    s_and_b32 s76, s76, s52
    s_cbranch_scc0 L_tr11
L_bk11:
    s_ff1_i32_b32 s76, s76
    s_bitset0_b32 s52, s76
    s_add_u32 s77, s76, s65
    s_and_b32 s77, s77, 15
    s_mul_i32 s77, s77, 32768
    s_add_u32 s39, s77, s80
    s_waitcnt vmcnt(11) lgkmcnt(4)
    v_mfma_f32_32x32x16_bf16 v[16:31], v[120:123], v[128:131], v[16:31]
    ds_read_b64_tr_b16 v[112:113], v80 offset:4096
    ds_read_b64_tr_b16 v[114:115], v80 offset:5120
    buffer_load_dwordx4 v[176:179], v14, s[40:43], s39 offen offset:0 sc1
    s_add_u32 s76, s76, 3
    s_and_b32 s76, s76, 15
    s_lshl_b32 s15, s76, 13
    v_mfma_f32_32x32x16_bf16 v[32:47], v[124:127], v[128:131], v[32:47]
    ds_read_b64_tr_b16 v[116:117], v81 offset:4096
    ds_read_b64_tr_b16 v[118:119], v81 offset:5120
    s_waitcnt vmcnt(11) lgkmcnt(4)
    v_mfma_f32_32x32x16_bf16 v[16:31], v[104:107], v[132:135], v[16:31]
    ds_read_b64_tr_b16 v[120:121], v80 offset:6144
    ds_read_b64_tr_b16 v[122:123], v80 offset:7168
    buffer_load_dwordx4 v[180:183], v14, s[40:43], s39 offen offset:2048 sc1
    v_mfma_f32_32x32x16_bf16 v[32:47], v[108:111], v[132:135], v[32:47]
    ds_read_b64_tr_b16 v[124:125], v81 offset:6144
    ds_read_b64_tr_b16 v[126:127], v81 offset:7168
    v_add_u32 v82, s13, v72
    v_add_u32 v83, s13, v73
    s_waitcnt vmcnt(11) lgkmcnt(4)
    v_mfma_f32_32x32x16_bf16 v[16:31], v[112:115], v[136:139], v[16:31]
    ds_read_b32 v79, v8 offset:25984
    ds_read_b64_tr_b16 v[104:105], v82 offset:0
    ds_read_b64_tr_b16 v[106:107], v82 offset:1024
    buffer_load_dwordx4 v[184:187], v78, s[40:43], s39 offen offset:0 sc1
    v_mfma_f32_32x32x16_bf16 v[32:47], v[116:119], v[136:139], v[32:47]
    ds_read_b64_tr_b16 v[108:109], v83 offset:0
    ds_read_b64_tr_b16 v[110:111], v83 offset:1024
    s_waitcnt vmcnt(11) lgkmcnt(4)
    v_mfma_f32_32x32x16_bf16 v[16:31], v[120:123], v[140:143], v[16:31]
    ds_read_b64_tr_b16 v[112:113], v82 offset:2048
    ds_read_b64_tr_b16 v[114:115], v82 offset:3072
    buffer_load_dwordx4 v[188:191], v78, s[40:43], s39 offen offset:2048 sc1
    v_mfma_f32_32x32x16_bf16 v[32:47], v[124:127], v[140:143], v[32:47]
    ds_read_b64_tr_b16 v[116:117], v83 offset:2048
    ds_read_b64_tr_b16 v[118:119], v83 offset:3072
    v_readfirstlane_b32 s76, v79
    s_nop 0
    s_and_b32 s76, s76, s52
    s_cbranch_scc0 L_tr12
L_bk12:
    s_ff1_i32_b32 s76, s76
    s_bitset0_b32 s52, s76
    s_add_u32 s77, s76, s65
    s_and_b32 s77, s77, 15
    s_mul_i32 s77, s77, 32768
    s_add_u32 s48, s77, s80
    s_waitcnt vmcnt(11) lgkmcnt(4)
    v_mfma_f32_32x32x16_bf16 v[16:31], v[104:107], v[144:147], v[16:31]
    ds_read_b64_tr_b16 v[120:121], v82 offset:4096
    ds_read_b64_tr_b16 v[122:123], v82 offset:5120
    buffer_load_dwordx4 v[128:131], v14, s[40:43], s48 offen offset:0 sc1
    s_add_u32 s76, s76, 3
    s_and_b32 s76, s76, 15
    s_lshl_b32 s16, s76, 13
    v_mfma_f32_32x32x16_bf16 v[32:47], v[108:111], v[144:147], v[32:47]
    ds_read_b64_tr_b16 v[124:125], v83 offset:4096
    ds_read_b64_tr_b16 v[126:127], v83 offset:5120
    s_waitcnt vmcnt(11) lgkmcnt(4)
    v_mfma_f32_32x32x16_bf16 v[16:31], v[112:115], v[148:151], v[16:31]
    ds_read_b64_tr_b16 v[104:105], v82 offset:6144
    ds_read_b64_tr_b16 v[106:107], v82 offset:7168
    buffer_load_dwordx4 v[132:135], v14, s[40:43], s48 offen offset:2048 sc1
    v_mfma_f32_32x32x16_bf16 v[32:47], v[116:119], v[148:151], v[32:47]
    ds_read_b64_tr_b16 v[108:109], v83 offset:6144
    ds_read_b64_tr_b16 v[110:111], v83 offset:7168
    v_add_u32 v80, s14, v72
    v_add_u32 v81, s14, v73
    s_waitcnt vmcnt(11) lgkmcnt(4)
    v_mfma_f32_32x32x16_bf16 v[16:31], v[120:123], v[152:155], v[16:31]
    ds_read_b32 v79, v8 offset:25984
    ds_read_b64_tr_b16 v[112:113], v80 offset:0
    ds_read_b64_tr_b16 v[114:115], v80 offset:1024
    buffer_load_dwordx4 v[136:139], v78, s[40:43], s48 offen offset:0 sc1
    v_mfma_f32_32x32x16_bf16 v[32:47], v[124:127], v[152:155], v[32:47]
    ds_read_b64_tr_b16 v[116:117], v81 offset:0
    ds_read_b64_tr_b16 v[118:119], v81 offset:1024
    s_waitcnt vmcnt(11) lgkmcnt(4)
    v_mfma_f32_32x32x16_bf16 v[16:31], v[104:107], v[156:159], v[16:31]
    ds_read_b64_tr_b16 v[120:121], v80 offset:2048
    ds_read_b64_tr_b16 v[122:123], v80 offset:3072
    buffer_load_dwordx4 v[140:143], v78, s[40:43], s48 offen offset:2048 sc1
    v_mfma_f32_32x32x16_bf16 v[32:47], v[108:111], v[156:159], v[32:47]
    ds_read_b64_tr_b16 v[124:125], v81 offset:2048
    ds_read_b64_tr_b16 v[126:127], v81 offset:3072
    v_readfirstlane_b32 s76, v79
    s_nop 0
    s_and_b32 s76, s76, s52
    s_cbranch_scc0 L_tr13
L_bk13:
    s_ff1_i32_b32 s76, s76
    s_bitset0_b32 s52, s76
    s_add_u32 s77, s76, s65
    s_and_b32 s77, s77, 15
    s_mul_i32 s77, s77, 32768
    s_add_u32 s49, s77, s80
    s_waitcnt vmcnt(11) lgkmcnt(4)
    v_mfma_f32_32x32x16_bf16 v[16:31], v[112:115], v[160:163], v[16:31]
    ds_read_b64_tr_b16 v[104:105], v80 offset:4096
    ds_read_b64_tr_b16 v[106:107], v80 offset:5120
    buffer_load_dwordx4 v[144:147], v14, s[40:43], s49 offen offset:0 sc1
    s_add_u32 s76, s76, 3
    s_and_b32 s76, s76, 15
    s_lshl_b32 s17, s76, 13
    v_mfma_f32_32x32x16_bf16 v[32:47], v[116:119], v[160:163], v[32:47]
    ds_read_b64_tr_b16 v[108:109], v81 offset:4096
    ds_read_b64_tr_b16 v[110:111], v81 offset:5120
    s_waitcnt vmcnt(11) lgkmcnt(4)
    v_mfma_f32_32x32x16_bf16 v[16:31], v[120:123], v[164:167], v[16:31]
    ds_read_b64_tr_b16 v[112:113], v80 offset:6144
    ds_read_b64_tr_b16 v[114:115], v80 offset:7168
    buffer_load_dwordx4 v[148:151], v14, s[40:43], s49 offen offset:2048 sc1
    v_mfma_f32_32x32x16_bf16 v[32:47], v[124:127], v[164:167], v[32:47]
    ds_read_b64_tr_b16 v[116:117], v81 offset:6144
    ds_read_b64_tr_b16 v[118:119], v81 offset:7168
    v_add_u32 v82, s15, v72
    v_add_u32 v83, s15, v73
    s_waitcnt vmcnt(11) lgkmcnt(4)
    v_mfma_f32_32x32x16_bf16 v[16:31], v[104:107], v[168:171], v[16:31]
    ds_read_b32 v79, v8 offset:25984
    ds_read_b64_tr_b16 v[120:121], v82 offset:0
    ds_read_b64_tr_b16 v[122:123], v82 offset:1024
    buffer_load_dwordx4 v[152:155], v78, s[40:43], s49 offen offset:0 sc1
    v_mfma_f32_32x32x16_bf16 v[32:47], v[108:111], v[168:171], v[32:47]
    ds_read_b64_tr_b16 v[124:125], v83 offset:0
    ds_read_b64_tr_b16 v[126:127], v83 offset:1024
    s_waitcnt vmcnt(11) lgkmcnt(4)
    v_mfma_f32_32x32x16_bf16 v[16:31], v[112:115], v[172:175], v[16:31]
    ds_read_b64_tr_b16 v[104:105], v82 offset:2048
    ds_read_b64_tr_b16 v[106:107], v82 offset:3072
    buffer_load_dwordx4 v[156:159], v78, s[40:43], s49 offen offset:2048 sc1
    v_mfma_f32_32x32x16_bf16 v[32:47], v[116:119], v[172:175], v[32:47]
    ds_read_b64_tr_b16 v[108:109], v83 offset:2048
    ds_read_b64_tr_b16 v[110:111], v83 offset:3072
    v_readfirstlane_b32 s76, v79
    s_nop 0
    s_and_b32 s76, s76, s52
    s_cbranch_scc0 L_tr14
L_bk14:
    s_ff1_i32_b32 s76, s76
    s_bitset0_b32 s52, s76
    s_add_u32 s77, s76, s65
    s_and_b32 s77, s77, 15
    s_mul_i32 s77, s77, 32768
    s_add_u32 s50, s77, s80
    s_waitcnt vmcnt(11) lgkmcnt(4)
    v_mfma_f32_32x32x16_bf16 v[16:31], v[120:123], v[176:179], v[16:31]
    ds_read_b64_tr_b16 v[112:113], v82 offset:4096
    ds_read_b64_tr_b16 v[114:115], v82 offset:5120
    buffer_load_dwordx4 v[160:163], v14, s[40:43], s50 offen offset:0 sc1
    s_add_u32 s76, s76, 3
    s_and_b32 s76, s76, 15
    s_lshl_b32 s18, s76, 13
    v_mfma_f32_32x32x16_bf16 v[32:47], v[124:127], v[176:179], v[32:47]
    ds_read_b64_tr_b16 v[116:117], v83 offset:4096
    ds_read_b64_tr_b16 v[118:119], v83 offset:5120
    s_waitcnt vmcnt(11) lgkmcnt(4)
    v_mfma_f32_32x32x16_bf16 v[16:31], v[104:107], v[180:183], v[16:31]
    ds_read_b64_tr_b16 v[120:121], v82 offset:6144
    ds_read_b64_tr_b16 v[122:123], v82 offset:7168
    buffer_load_dwordx4 v[164:167], v14, s[40:43], s50 offen offset:2048 sc1
    v_mfma_f32_32x32x16_bf16 v[32:47], v[108:111], v[180:183], v[32:47]
    ds_read_b64_tr_b16 v[124:125], v83 offset:6144
    ds_read_b64_tr_b16 v[126:127], v83 offset:7168
    v_add_u32 v80, s16, v72
    v_add_u32 v81, s16, v73
    s_waitcnt vmcnt(11) lgkmcnt(4)
    v_mfma_f32_32x32x16_bf16 v[16:31], v[112:115], v[184:187], v[16:31]
    ds_read_b32 v79, v8 offset:25984
    ds_read_b64_tr_b16 v[104:105], v80 offset:0
    ds_read_b64_tr_b16 v[106:107], v80 offset:1024
    buffer_load_dwordx4 v[168:171], v78, s[40:43], s50 offen offset:0 sc1
    v_mfma_f32_32x32x16_bf16 v[32:47], v[116:119], v[184:187], v[32:47]
    ds_read_b64_tr_b16 v[108:109], v81 offset:0
    ds_read_b64_tr_b16 v[110:111], v81 offset:1024
    s_waitcnt vmcnt(11) lgkmcnt(4)
    v_mfma_f32_32x32x16_bf16 v[16:31], v[120:123], v[188:191], v[16:31]
    ds_read_b64_tr_b16 v[112:113], v80 offset:2048
    ds_read_b64_tr_b16 v[114:115], v80 offset:3072
    buffer_load_dwordx4 v[172:175], v78, s[40:43], s50 offen offset:2048 sc1
    v_mfma_f32_32x32x16_bf16 v[32:47], v[124:127], v[188:191], v[32:47]
    ds_read_b64_tr_b16 v[116:117], v81 offset:2048
    ds_read_b64_tr_b16 v[118:119], v81 offset:3072
    v_readfirstlane_b32 s76, v79
    s_nop 0
    s_and_b32 s76, s76, s52
    s_cbranch_scc0 L_tr15
L_bk15:
    s_ff1_i32_b32 s76, s76
    s_bitset0_b32 s52, s76
    s_add_u32 s77, s76, s65
    s_and_b32 s77, s77, 15
    s_mul_i32 s77, s77, 32768
    s_add_u32 s51, s77, s80
    s_waitcnt vmcnt(11) lgkmcnt(4)
    v_mfma_f32_32x32x16_bf16 v[16:31], v[104:107], v[128:131], v[16:31]
    ds_read_b64_tr_b16 v[120:121], v80 offset:4096
    ds_read_b64_tr_b16 v[122:123], v80 offset:5120
    buffer_load_dwordx4 v[176:179], v14, s[40:43], s51 offen offset:0 sc1
    s_add_u32 s76, s76, 3
    s_and_b32 s76, s76, 15
    s_lshl_b32 s19, s76, 13
    v_mfma_f32_32x32x16_bf16 v[32:47], v[108:111], v[128:131], v[32:47]
    ds_read_b64_tr_b16 v[124:125], v81 offset:4096
    ds_read_b64_tr_b16 v[126:127], v81 offset:5120
    s_waitcnt vmcnt(11) lgkmcnt(4)
    v_mfma_f32_32x32x16_bf16 v[16:31], v[112:115], v[132:135], v[16:31]
    ds_read_b64_tr_b16 v[104:105], v80 offset:6144
    ds_read_b64_tr_b16 v[106:107], v80 offset:7168
    buffer_load_dwordx4 v[180:183], v14, s[40:43], s51 offen offset:2048 sc1
    v_mfma_f32_32x32x16_bf16 v[32:47], v[116:119], v[132:135], v[32:47]
    ds_read_b64_tr_b16 v[108:109], v81 offset:6144
    ds_read_b64_tr_b16 v[110:111], v81 offset:7168
    v_add_u32 v82, s17, v72
    v_add_u32 v83, s17, v73
    s_waitcnt vmcnt(11) lgkmcnt(4)
    v_mfma_f32_32x32x16_bf16 v[16:31], v[120:123], v[136:139], v[16:31]
    ds_read_b64 v[192:193], v10 offset:16384
    ds_read_b64_tr_b16 v[112:113], v82 offset:0
    ds_read_b64_tr_b16 v[114:115], v82 offset:1024
    buffer_load_dwordx4 v[184:187], v78, s[40:43], s51 offen offset:0 sc1
    v_mfma_f32_32x32x16_bf16 v[32:47], v[124:127], v[136:139], v[32:47]
    ds_read_b64_tr_b16 v[116:117], v83 offset:0
    ds_read_b64_tr_b16 v[118:119], v83 offset:1024
    s_waitcnt vmcnt(11) lgkmcnt(4)
    v_mfma_f32_32x32x16_bf16 v[16:31], v[104:107], v[140:143], v[16:31]
    ds_read_b64 v[194:195], v10 offset:16400
    ds_read_b64_tr_b16 v[120:121], v82 offset:2048
    ds_read_b64_tr_b16 v[122:123], v82 offset:3072
    buffer_load_dwordx4 v[188:191], v78, s[40:43], s51 offen offset:2048 sc1
    s_barrier
    v_mfma_f32_32x32x16_bf16 v[32:47], v[108:111], v[140:143], v[32:47]
    ds_read_b64_tr_b16 v[124:125], v83 offset:2048
    ds_read_b64_tr_b16 v[126:127], v83 offset:3072
    s_waitcnt vmcnt(11) lgkmcnt(4)
    v_mfma_f32_32x32x16_bf16 v[16:31], v[112:115], v[144:147], v[16:31]
    ds_read_b64 v[196:197], v10 offset:16416
    ds_read_b64_tr_b16 v[104:105], v82 offset:4096
    ds_read_b64_tr_b16 v[106:107], v82 offset:5120
    v_mfma_f32_32x32x16_bf16 v[32:47], v[116:119], v[144:147], v[32:47]
    ds_read_b64_tr_b16 v[108:109], v83 offset:4096
    ds_read_b64_tr_b16 v[110:111], v83 offset:5120
    s_waitcnt vmcnt(10) lgkmcnt(4)
    v_mfma_f32_32x32x16_bf16 v[16:31], v[120:123], v[148:151], v[16:31]
    ds_read_b64 v[198:199], v10 offset:16432
    ds_read_b64_tr_b16 v[112:113], v82 offset:6144
    ds_read_b64_tr_b16 v[114:115], v82 offset:7168
    v_mfma_f32_32x32x16_bf16 v[32:47], v[124:127], v[148:151], v[32:47]
    ds_read_b64_tr_b16 v[116:117], v83 offset:6144
    ds_read_b64_tr_b16 v[118:119], v83 offset:7168
    v_add_u32 v80, s18, v72
    v_add_u32_e64 v81, s18, v73
    s_waitcnt vmcnt(9) lgkmcnt(4)
    v_mfma_f32_32x32x16_bf16 v[16:31], v[104:107], v[152:155], v[16:31]
    ds_read_b64 v[200:201], v10 offset:16448
    ds_read_b64_tr_b16 v[120:121], v80 offset:0
    ds_read_b64_tr_b16 v[122:123], v80 offset:1024
    v_mfma_f32_32x32x16_bf16 v[32:47], v[108:111], v[152:155], v[32:47]
    ds_read_b64_tr_b16 v[124:125], v81 offset:0
    ds_read_b64_tr_b16 v[126:127], v81 offset:1024
    s_waitcnt vmcnt(8) lgkmcnt(4)
    v_mfma_f32_32x32x16_bf16 v[16:31], v[112:115], v[156:159], v[16:31]
    ds_read_b64 v[202:203], v10 offset:16464
    ds_read_b64_tr_b16 v[104:105], v80 offset:2048
    ds_read_b64_tr_b16 v[106:107], v80 offset:3072
    v_mfma_f32_32x32x16_bf16 v[32:47], v[116:119], v[156:159], v[32:47]
    ds_read_b64_tr_b16 v[108:109], v81 offset:2048
    ds_read_b64_tr_b16 v[110:111], v81 offset:3072
    s_waitcnt vmcnt(7) lgkmcnt(4)
    v_mfma_f32_32x32x16_bf16 v[16:31], v[120:123], v[160:163], v[16:31]
    ds_read_b64 v[204:205], v10 offset:16480
    ds_read_b64_tr_b16 v[112:113], v80 offset:4096
    ds_read_b64_tr_b16 v[114:115], v80 offset:5120
    v_mfma_f32_32x32x16_bf16 v[32:47], v[124:127], v[160:163], v[32:47]
    ds_read_b64_tr_b16 v[116:117], v81 offset:4096
    ds_read_b64_tr_b16 v[118:119], v81 offset:5120
    s_waitcnt vmcnt(6) lgkmcnt(4)
    v_mfma_f32_32x32x16_bf16 v[16:31], v[104:107], v[164:167], v[16:31]
    ds_read_b64 v[206:207], v10 offset:16496
    ds_read_b64_tr_b16 v[120:121], v80 offset:6144
    ds_read_b64_tr_b16 v[122:123], v80 offset:7168
    v_mfma_f32_32x32x16_bf16 v[32:47], v[108:111], v[164:167], v[32:47]
    ds_read_b64_tr_b16 v[124:125], v81 offset:6144
    ds_read_b64_tr_b16 v[126:127], v81 offset:7168
    v_add_u32 v82, s19, v72
    v_add_u32 v83, s19, v73
    s_waitcnt vmcnt(5) lgkmcnt(4)
    v_mfma_f32_32x32x16_bf16 v[16:31], v[112:115], v[168:171], v[16:31]
    ds_read_b128 v[208:211], v11 offset:16384
    ds_read_b64_tr_b16 v[104:105], v82 offset:0
    ds_read_b64_tr_b16 v[106:107], v82 offset:1024
    v_mfma_f32_32x32x16_bf16 v[32:47], v[116:119], v[168:171], v[32:47]
    ds_read_b64_tr_b16 v[108:109], v83 offset:0
    ds_read_b64_tr_b16 v[110:111], v83 offset:1024
    s_waitcnt vmcnt(4) lgkmcnt(4)
    v_mfma_f32_32x32x16_bf16 v[16:31], v[120:123], v[172:175], v[16:31]
    ds_read_b128 v[212:215], v11 offset:16400
    ds_read_b64_tr_b16 v[112:113], v82 offset:2048
    ds_read_b64_tr_b16 v[114:115], v82 offset:3072
    v_mfma_f32_32x32x16_bf16 v[32:47], v[124:127], v[172:175], v[32:47]
    ds_read_b64_tr_b16 v[116:117], v83 offset:2048
    ds_read_b64_tr_b16 v[118:119], v83 offset:3072
    s_waitcnt vmcnt(3) lgkmcnt(4)
    v_mfma_f32_32x32x16_bf16 v[16:31], v[104:107], v[176:179], v[16:31]
    ds_read_b64_tr_b16 v[120:121], v82 offset:4096
    ds_read_b64_tr_b16 v[122:123], v82 offset:5120
    v_mfma_f32_32x32x16_bf16 v[32:47], v[108:111], v[176:179], v[32:47]
    ds_read_b64_tr_b16 v[124:125], v83 offset:4096
    ds_read_b64_tr_b16 v[126:127], v83 offset:5120
    s_waitcnt vmcnt(2) lgkmcnt(4)
    v_mfma_f32_32x32x16_bf16 v[16:31], v[112:115], v[180:183], v[16:31]
    ds_read_b64_tr_b16 v[104:105], v82 offset:6144
    ds_read_b64_tr_b16 v[106:107], v82 offset:7168
    v_mfma_f32_32x32x16_bf16 v[32:47], v[116:119], v[180:183], v[32:47]
    ds_read_b64_tr_b16 v[108:109], v83 offset:6144
    ds_read_b64_tr_b16 v[110:111], v83 offset:7168
    s_waitcnt vmcnt(1) lgkmcnt(4)
    v_mfma_f32_32x32x16_bf16 v[16:31], v[120:123], v[184:187], v[16:31]
    v_mfma_f32_32x32x16_bf16 v[32:47], v[124:127], v[184:187], v[32:47]
    s_waitcnt vmcnt(0) lgkmcnt(0)
    v_mfma_f32_32x32x16_bf16 v[16:31], v[104:107], v[188:191], v[16:31]
    v_mfma_f32_32x32x16_bf16 v[32:47], v[108:111], v[188:191], v[32:47]
    s_nop 10
    v_cvt_pk_bf16_f32 v88, v16, v17
    v_cvt_pk_bf16_f32 v89, v18, v19
    v_cvt_pk_bf16_f32 v90, v20, v21
    v_cvt_pk_bf16_f32 v91, v22, v23
    v_cvt_pk_bf16_f32 v92, v24, v25
    v_cvt_pk_bf16_f32 v93, v26, v27
    v_cvt_pk_bf16_f32 v94, v28, v29
    v_cvt_pk_bf16_f32 v95, v30, v31
    v_cvt_pk_bf16_f32 v96, v32, v33
    v_cvt_pk_bf16_f32 v97, v34, v35
    v_cvt_pk_bf16_f32 v98, v36, v37
    v_cvt_pk_bf16_f32 v99, v38, v39
    v_cvt_pk_bf16_f32 v100, v40, v41
    v_cvt_pk_bf16_f32 v101, v42, v43
    v_cvt_pk_bf16_f32 v102, v44, v45
    v_cvt_pk_bf16_f32 v103, v46, v47
    v_dot2_f32_bf16 v104, v88, s89, 0
    v_dot2_f32_bf16 v105, v88, v88, 0
    v_dot2_f32_bf16 v106, v88, v192, 0
    v_dot2_f32_bf16 v104, v89, s89, v104
    v_dot2_f32_bf16 v105, v89, v89, v105
    v_dot2_f32_bf16 v106, v89, v193, v106
    v_dot2_f32_bf16 v104, v90, s89, v104
    v_dot2_f32_bf16 v105, v90, v90, v105
    v_dot2_f32_bf16 v106, v90, v194, v106
    v_dot2_f32_bf16 v104, v91, s89, v104
    v_dot2_f32_bf16 v105, v91, v91, v105
    v_dot2_f32_bf16 v106, v91, v195, v106
    v_dot2_f32_bf16 v104, v92, s89, v104
    v_dot2_f32_bf16 v105, v92, v92, v105
    v_dot2_f32_bf16 v106, v92, v196, v106
    v_dot2_f32_bf16 v104, v93, s89, v104
    v_dot2_f32_bf16 v105, v93, v93, v105
    v_dot2_f32_bf16 v106, v93, v197, v106
    v_dot2_f32_bf16 v104, v94, s89, v104
    v_dot2_f32_bf16 v105, v94, v94, v105
    v_dot2_f32_bf16 v106, v94, v198, v106
    v_dot2_f32_bf16 v104, v95, s89, v104
    v_dot2_f32_bf16 v105, v95, v95, v105
    v_dot2_f32_bf16 v106, v95, v199, v106
    v_dot2_f32_bf16 v104, v96, s89, v104
    v_dot2_f32_bf16 v105, v96, v96, v105
    v_dot2_f32_bf16 v106, v96, v200, v106
    v_dot2_f32_bf16 v104, v97, s89, v104
    v_dot2_f32_bf16 v105, v97, v97, v105
    v_dot2_f32_bf16 v106, v97, v201, v106
    v_dot2_f32_bf16 v104, v98, s89, v104
    v_dot2_f32_bf16 v105, v98, v98, v105
    v_dot2_f32_bf16 v106, v98, v202, v106
    v_dot2_f32_bf16 v104, v99, s89, v104
    v_dot2_f32_bf16 v105, v99, v99, v105
    v_dot2_f32_bf16 v106, v99, v203, v106
    v_dot2_f32_bf16 v104, v100, s89, v104
    v_dot2_f32_bf16 v105, v100, v100, v105
    v_dot2_f32_bf16 v106, v100, v204, v106
    v_dot2_f32_bf16 v104, v101, s89, v104
    v_dot2_f32_bf16 v105, v101, v101, v105
    v_dot2_f32_bf16 v106, v101, v205, v106
    v_dot2_f32_bf16 v104, v102, s89, v104
    v_dot2_f32_bf16 v105, v102, v102, v105
    v_dot2_f32_bf16 v106, v102, v206, v106
    v_dot2_f32_bf16 v104, v103, s89, v104
    v_dot2_f32_bf16 v105, v103, v103, v105
    v_dot2_f32_bf16 v106, v103, v207, v106
    s_lshl_b32 s76, s62, 9
    s_add_u32 s77, s76, s99
    v_mov_b32 v107, 0
    v_mov_b32 v4, v104
    v_mov_b32 v5, v105
    v_mov_b32 v6, v106
    v_permlane32_swap_b32 v104, v4
    v_permlane32_swap_b32 v105, v5
    v_permlane32_swap_b32 v106, v6
    v_add_f32 v104, v104, v4
    v_add_f32 v105, v105, v5
    v_add_f32_e64 v106, v106, v6
    s_mov_b32 exec_hi, 0
    s_bitcmp1_b32 s100, 1
    s_cbranch_scc1 L_loc_70
    buffer_store_dwordx4 v[104:107], v12, s[40:43], s77 offen offset:1024 sc1
    s_branch L_pubd_71
L_loc_70:
    buffer_store_dwordx4 v[104:107], v12, s[40:43], s77 offen offset:1024
L_pubd_71:
    s_mov_b64 exec, -1
    ds_write_b64 v64, v[88:89]
    ds_write_b64 v65, v[90:91]
    ds_write_b64 v66, v[92:93]
    ds_write_b64 v67, v[94:95]
    ds_write_b64 v68, v[96:97]
    ds_write_b64 v69, v[98:99]
    ds_write_b64 v70, v[100:101]
    ds_write_b64 v71, v[102:103]
    v_bfe_u32 v4, v1, 1, 3
    v_bfe_u32 v5, v1, 4, 1
    v_lshlrev_b32_e64 v176, 4, v4
    v_lshl_add_u32 v176, v5, 3, v176
    v_and_b32_e64 v5, 1, v1
    v_lshl_add_u32 v176, v5, 2, v176
    v_lshlrev_b32_e64 v177, 2, v2
    v_lshl_add_u32 v177, v3, 8, v177
    v_and_b32 v4, 15, v1
    v_lshrrev_b32 v5, 4, v1
    v_mul_u32_u24 v179, 149504, v4
    v_lshl_add_u32 v180, v5, 4, v179
    s_lshl_b32 s82, s97, 7
    s_lshl_b32 s79, s62, 5
    s_add_u32 s82, s82, s79
    s_lshl_b32 s79, s62, 2
    v_mov_b32_e64 v7, s79
    v_mul_u32_u24 v178, 9344, v3
    v_lshl_add_u32 v178, v2, 4, v178
    s_mul_i32 s78, s97, 149504
    s_add_u32 s78, s78, s76
    s_add_u32 s78, s78, 8388608
    s_add_u32 s48, s78, 18688
    s_add_u32 s49, s48, 18688
    s_add_u32 s50, s49, 18688
    s_add_u32 s51, s50, 18688
    s_add_u32 s52, s51, 18688
    s_add_u32 s53, s52, 18688
    s_add_u32 s54, s53, 18688
    buffer_load_dwordx4 v[112:115], v178, s[40:43], s78 offen offset:1024 sc1
    buffer_load_dwordx4 v[116:119], v178, s[40:43], s48 offen offset:1024 sc1
    buffer_load_dwordx4 v[120:123], v178, s[40:43], s49 offen offset:1024 sc1
    buffer_load_dwordx4 v[124:127], v178, s[40:43], s50 offen offset:1024 sc1
    buffer_load_dwordx4 v[128:131], v178, s[40:43], s51 offen offset:1024 sc1
    buffer_load_dwordx4 v[132:135], v178, s[40:43], s52 offen offset:1024 sc1
    buffer_load_dwordx4 v[136:139], v178, s[40:43], s53 offen offset:1024 sc1
    buffer_load_dwordx4 v[140:143], v178, s[40:43], s54 offen offset:1024 sc1
    v_dot2_f32_bf16 v76, v208, s89, 0
    v_dot2_f32_bf16 v76, v209, s89, v76
    v_dot2_f32_bf16 v76, v210, s89, v76
    v_dot2_f32_bf16 v76, v211, s89, v76
    v_dot2_f32_bf16 v76, v212, s89, v76
    v_dot2_f32_bf16 v76, v213, s89, v76
    v_dot2_f32_bf16 v76, v214, s89, v76
    v_dot2_f32_bf16 v76, v215, s89, v76
    s_nop 2
    v_add_f32_dpp v76, v76, v76 row_ror:8 row_mask:0xf bank_mask:0xf
    s_nop 1
    v_add_f32_dpp v76, v76, v76 row_ror:4 row_mask:0xf bank_mask:0xf
    s_nop 1
    v_add_f32_dpp v76, v76, v76 row_ror:2 row_mask:0xf bank_mask:0xf
    s_nop 1
    v_add_f32_dpp v76, v76, v76 row_ror:1 row_mask:0xf bank_mask:0xf
    v_mov_b32 v4, v76
    s_nop 1
    v_permlane16_swap_b32 v76, v4
    v_add_f32 v76, v76, v4
    v_mov_b32 v4, v76
    s_nop 1
    v_permlane32_swap_b32 v76, v4
    v_add_f32_e64 v76, v76, v4
    s_mov_b32 s88, 0
    s_waitcnt vmcnt(6)
    v_pk_add_f32 v[108:109], v[112:113], v[116:117]
    v_pk_add_f32 v[110:111], v[114:115], v[118:119]
    s_waitcnt vmcnt(5)
    v_pk_add_f32 v[108:109], v[108:109], v[120:121]
    v_pk_add_f32 v[110:111], v[110:111], v[122:123]
    s_waitcnt vmcnt(4)
    v_pk_add_f32 v[108:109], v[108:109], v[124:125]
    v_pk_add_f32 v[110:111], v[110:111], v[126:127]
    s_waitcnt vmcnt(3)
    v_pk_add_f32 v[108:109], v[108:109], v[128:129]
    v_pk_add_f32 v[110:111], v[110:111], v[130:131]
    s_waitcnt vmcnt(2)
    v_pk_add_f32 v[108:109], v[108:109], v[132:133]
    v_pk_add_f32 v[110:111], v[110:111], v[134:135]
    s_waitcnt vmcnt(1)
    v_pk_add_f32 v[108:109], v[108:109], v[136:137]
    v_pk_add_f32 v[110:111], v[110:111], v[138:139]
    s_waitcnt vmcnt(0)
    v_pk_add_f32 v[108:109], v[108:109], v[140:141]
    v_pk_add_f32 v[110:111], v[110:111], v[142:143]
    v_cmp_u_f32 vcc, v111, v111
    v_mov_b32 v4, v108
    v_mov_b32 v5, v109
    v_mov_b32 v6, v110
    s_cbranch_vccnz L_s3_73
L_s3ok_74:
    v_permlane32_swap_b32 v108, v4
    v_permlane32_swap_b32 v109, v5
    v_permlane32_swap_b32 v110, v6
    s_barrier
    v_add_f32 v108, v108, v4
    v_add_f32 v109, v109, v5
    v_add_f32 v110, v110, v6
    v_mul_f32 v108, 0x3a800000, v108
    v_mul_f32 v109, 0x3a800000, v109
    v_fma_f32 v4, -v108, v108, v109
    v_max_f32_e64 v4, 0, v4
    v_cvt_pk_bf16_f32 v116, v108, v108
    v_and_b32_e64 v116, s90, v116
    v_cvt_pk_bf16_f32 v4, v4, v4
    v_and_b32_e64 v4, s90, v4
    v_add_f32 v4, 0x3727c5ac, v4
    v_cvt_pk_bf16_f32 v4, v4, v4
    v_and_b32 v4, s90, v4
    v_sqrt_f32_e64 v4, v4
    s_nop 0
    v_cvt_pk_bf16_f32 v4, v4, v4
    v_and_b32 v4, s90, v4
    v_rcp_f32 v118, v4
    v_fma_f32 v120, -v116, v76, v110
    v_mul_f32 v119, v116, v118
    v_mul_f32 v120, v120, v118
    v_and_b32 v6, 3, v1
    v_lshlrev_b32 v6, 2, v6
    v_max_f32_dpp v4, v120, v120 row_ror:8 row_mask:0xf bank_mask:0xf
    s_lshl_b32 s83, s62, 12
    v_cmp_gt_u32 s[84:85], 32, v1
    v_max_f32_dpp v4, v4, v4 row_ror:4 row_mask:0xf bank_mask:0xf
    s_lshl_b32 s55, 1, s62
    s_sub_u32 s55, s55, 1
    v_max_f32_dpp v4, v4, v4 row_ror:2 row_mask:0xf bank_mask:0xf
    s_nop 1
    v_max_f32_dpp v4, v4, v4 row_ror:1 row_mask:0xf bank_mask:0xf
    v_mov_b32 v5, v4
    s_nop 1
    v_permlane16_swap_b32 v4, v5
    v_max_f32 v4, v4, v5
    v_cmp_eq_f32_e64 vcc, v4, v120
    ds_write_b32 v7, v4 offset:25600
    s_ff1_i32_b32 s77, vcc_lo
    s_and_b32 s77, s77, 31
    s_bfe_u32 s79, s77, 0x30001
    s_lshl3_add_u32 s79, s77, s79
    s_lshl4_add_u32 s79, s79, s83
    v_xor_b32_e64 v176, s79, v176
    ds_read_b32 v182, v176 offset:0
    s_waitcnt lgkmcnt(1)
    s_barrier
    ds_read_b32 v8, v6 offset:25600
    v_readlane_b32 s80, v118, s77
    v_readlane_b32 s81, v119, s77
    s_add_u32 s79, s82, s77
    v_writelane_b32 v4, s79, 33
    v_mov_b32 v5, s81
    s_waitcnt lgkmcnt(1)
    v_lshlrev_b32 v184, 16, v182
    v_and_b32_e64 v185, s90, v182
    v_fma_f32 v184, v184, s80, -v5
    v_fma_f32 v185, v185, s80, -v5
    v_cvt_pk_bf16_f32 v184, v184, v185
    v_cndmask_b32 v184, v4, v184, s[84:85]
    s_waitcnt lgkmcnt(0)
    v_cmp_eq_f32 s[56:57], v8, v4
    v_cmp_gt_f32 vcc, v8, v4
    s_and_b32 s56, s56, s55
    s_or_b32 s56, s56, vcc_lo
    s_cbranch_scc1 L_nopub_83
    buffer_store_dword v184, v177, s[40:43], s99 offen offset:0 sc1
L_nopub_83:
    v_lshlrev_b32 v16, 16, v88
    v_and_b32_e64 v17, s90, v88
    v_pk_fma_f32 v[144:145], v[16:17], v[118:119], v[118:119] op_sel:[0,0,1] op_sel_hi:[1,0,1] neg_lo:[0,0,1] neg_hi:[0,0,1]
    v_cvt_pk_bf16_f32 v124, v144, v145
    v_lshlrev_b32 v144, 16, v124
    v_and_b32 v145, s90, v124
    v_pk_add_f32 v[144:145], v[144:145], v[16:17]
    v_cvt_pk_bf16_f32 v124, v144, v145
    v_lshlrev_b32 v18, 16, v89
    v_and_b32 v19, s90, v89
    v_pk_fma_f32 v[146:147], v[18:19], v[118:119], v[118:119] op_sel:[0,0,1] op_sel_hi:[1,0,1] neg_lo:[0,0,1] neg_hi:[0,0,1]
    v_cvt_pk_bf16_f32 v125, v146, v147
    v_lshlrev_b32 v146, 16, v125
    v_and_b32 v147, s90, v125
    v_pk_add_f32 v[146:147], v[146:147], v[18:19]
    v_cvt_pk_bf16_f32 v125, v146, v147
    ds_write_b64 v64, v[124:125]
    v_lshlrev_b32 v20, 16, v90
    v_and_b32 v21, s90, v90
    v_pk_fma_f32 v[148:149], v[20:21], v[118:119], v[118:119] op_sel:[0,0,1] op_sel_hi:[1,0,1] neg_lo:[0,0,1] neg_hi:[0,0,1]
    v_cvt_pk_bf16_f32 v126, v148, v149
    v_lshlrev_b32 v148, 16, v126
    v_and_b32 v149, s90, v126
    v_pk_add_f32 v[148:149], v[148:149], v[20:21]
    v_cvt_pk_bf16_f32 v126, v148, v149
    v_lshlrev_b32 v22, 16, v91
    v_and_b32 v23, s90, v91
    v_pk_fma_f32 v[150:151], v[22:23], v[118:119], v[118:119] op_sel:[0,0,1] op_sel_hi:[1,0,1] neg_lo:[0,0,1] neg_hi:[0,0,1]
    v_cvt_pk_bf16_f32 v127, v150, v151
    v_lshlrev_b32 v150, 16, v127
    v_and_b32 v151, s90, v127
    v_pk_add_f32 v[150:151], v[150:151], v[22:23]
    v_cvt_pk_bf16_f32 v127, v150, v151
    ds_write_b64 v65, v[126:127]
    s_cmp_eq_u32 s56, 0
    s_cbranch_scc1 L_stay_84
    s_cmp_gt_u32 s62, 1
    s_cbranch_scc0 L_stay_84
    s_mov_b32 s91, -1
    v_lshlrev_b32 v24, 16, v92
    v_and_b32_e64 v25, s90, v92
    v_pk_fma_f32 v[152:153], v[24:25], v[118:119], v[118:119] op_sel:[0,0,1] op_sel_hi:[1,0,1] neg_lo:[0,0,1] neg_hi:[0,0,1]
    v_cvt_pk_bf16_f32 v128, v152, v153
    v_lshlrev_b32 v152, 16, v128
    v_and_b32 v153, s90, v128
    v_pk_add_f32 v[152:153], v[152:153], v[24:25]
    v_cvt_pk_bf16_f32 v128, v152, v153
    v_lshlrev_b32 v26, 16, v93
    v_and_b32 v27, s90, v93
    v_pk_fma_f32 v[154:155], v[26:27], v[118:119], v[118:119] op_sel:[0,0,1] op_sel_hi:[1,0,1] neg_lo:[0,0,1] neg_hi:[0,0,1]
    v_cvt_pk_bf16_f32 v129, v154, v155
    v_lshlrev_b32 v154, 16, v129
    v_and_b32 v155, s90, v129
    v_pk_add_f32 v[154:155], v[154:155], v[26:27]
    v_cvt_pk_bf16_f32 v129, v154, v155
    ds_write_b64 v66, v[128:129]
    v_lshlrev_b32 v28, 16, v94
    v_and_b32 v29, s90, v94
    v_pk_fma_f32 v[156:157], v[28:29], v[118:119], v[118:119] op_sel:[0,0,1] op_sel_hi:[1,0,1] neg_lo:[0,0,1] neg_hi:[0,0,1]
    v_cvt_pk_bf16_f32 v130, v156, v157
    v_lshlrev_b32 v156, 16, v130
    v_and_b32 v157, s90, v130
    v_pk_add_f32 v[156:157], v[156:157], v[28:29]
    v_cvt_pk_bf16_f32 v130, v156, v157
    v_lshlrev_b32 v30, 16, v95
    v_and_b32 v31, s90, v95
    v_pk_fma_f32 v[158:159], v[30:31], v[118:119], v[118:119] op_sel:[0,0,1] op_sel_hi:[1,0,1] neg_lo:[0,0,1] neg_hi:[0,0,1]
    v_cvt_pk_bf16_f32 v131, v158, v159
    v_lshlrev_b32 v158, 16, v131
    v_and_b32 v159, s90, v131
    v_pk_add_f32 v[158:159], v[158:159], v[30:31]
    v_cvt_pk_bf16_f32 v131, v158, v159
    ds_write_b64 v67, v[130:131]
    v_lshlrev_b32 v32, 16, v96
    v_and_b32 v33, s90, v96
    v_pk_fma_f32 v[160:161], v[32:33], v[118:119], v[118:119] op_sel:[0,0,1] op_sel_hi:[1,0,1] neg_lo:[0,0,1] neg_hi:[0,0,1]
    v_cvt_pk_bf16_f32 v132, v160, v161
    v_lshlrev_b32 v160, 16, v132
    v_and_b32 v161, s90, v132
    v_pk_add_f32 v[160:161], v[160:161], v[32:33]
    v_cvt_pk_bf16_f32 v132, v160, v161
    v_lshlrev_b32 v34, 16, v97
    v_and_b32 v35, s90, v97
    v_pk_fma_f32 v[162:163], v[34:35], v[118:119], v[118:119] op_sel:[0,0,1] op_sel_hi:[1,0,1] neg_lo:[0,0,1] neg_hi:[0,0,1]
    v_cvt_pk_bf16_f32 v133, v162, v163
    v_lshlrev_b32 v162, 16, v133
    v_and_b32 v163, s90, v133
    v_pk_add_f32 v[162:163], v[162:163], v[34:35]
    v_cvt_pk_bf16_f32 v133, v162, v163
    ds_write_b64 v68, v[132:133]
    v_lshlrev_b32 v36, 16, v98
    v_and_b32 v37, s90, v98
    v_pk_fma_f32 v[164:165], v[36:37], v[118:119], v[118:119] op_sel:[0,0,1] op_sel_hi:[1,0,1] neg_lo:[0,0,1] neg_hi:[0,0,1]
    v_cvt_pk_bf16_f32 v134, v164, v165
    v_lshlrev_b32 v164, 16, v134
    v_and_b32 v165, s90, v134
    v_pk_add_f32 v[164:165], v[164:165], v[36:37]
    v_cvt_pk_bf16_f32 v134, v164, v165
    v_lshlrev_b32 v38, 16, v99
    v_and_b32 v39, s90, v99
    v_pk_fma_f32 v[166:167], v[38:39], v[118:119], v[118:119] op_sel:[0,0,1] op_sel_hi:[1,0,1] neg_lo:[0,0,1] neg_hi:[0,0,1]
    v_cvt_pk_bf16_f32 v135, v166, v167
    v_lshlrev_b32 v166, 16, v135
    v_and_b32 v167, s90, v135
    v_pk_add_f32 v[166:167], v[166:167], v[38:39]
    v_cvt_pk_bf16_f32 v135, v166, v167
    ds_write_b64 v69, v[134:135]
    v_lshlrev_b32 v40, 16, v100
    v_and_b32 v41, s90, v100
    v_pk_fma_f32 v[168:169], v[40:41], v[118:119], v[118:119] op_sel:[0,0,1] op_sel_hi:[1,0,1] neg_lo:[0,0,1] neg_hi:[0,0,1]
    v_cvt_pk_bf16_f32 v136, v168, v169
    v_lshlrev_b32 v168, 16, v136
    v_and_b32 v169, s90, v136
    v_pk_add_f32 v[168:169], v[168:169], v[40:41]
    v_cvt_pk_bf16_f32 v136, v168, v169
    v_lshlrev_b32 v42, 16, v101
    v_and_b32 v43, s90, v101
    v_pk_fma_f32 v[170:171], v[42:43], v[118:119], v[118:119] op_sel:[0,0,1] op_sel_hi:[1,0,1] neg_lo:[0,0,1] neg_hi:[0,0,1]
    v_cvt_pk_bf16_f32 v137, v170, v171
    v_lshlrev_b32 v170, 16, v137
    v_and_b32 v171, s90, v137
    v_pk_add_f32 v[170:171], v[170:171], v[42:43]
    v_cvt_pk_bf16_f32 v137, v170, v171
    ds_write_b64 v70, v[136:137]
    v_lshlrev_b32 v44, 16, v102
    v_and_b32 v45, s90, v102
    v_pk_fma_f32 v[172:173], v[44:45], v[118:119], v[118:119] op_sel:[0,0,1] op_sel_hi:[1,0,1] neg_lo:[0,0,1] neg_hi:[0,0,1]
    v_cvt_pk_bf16_f32 v138, v172, v173
    v_lshlrev_b32 v172, 16, v138
    v_and_b32 v173, s90, v138
    v_pk_add_f32 v[172:173], v[172:173], v[44:45]
    v_cvt_pk_bf16_f32 v138, v172, v173
    v_lshlrev_b32 v46, 16, v103
    v_and_b32 v47, s90, v103
    v_pk_fma_f32 v[174:175], v[46:47], v[118:119], v[118:119] op_sel:[0,0,1] op_sel_hi:[1,0,1] neg_lo:[0,0,1] neg_hi:[0,0,1]
    v_cvt_pk_bf16_f32 v139, v174, v175
    v_lshlrev_b32 v174, 16, v139
    v_and_b32 v175, s90, v139
    v_pk_add_f32 v[174:175], v[174:175], v[46:47]
    v_cvt_pk_bf16_f32 v139, v174, v175
    ds_write_b64 v71, v[138:139]
    s_sub_u32 s77, s91, s82
    v_lshrrev_b32 v7, 3, v1
    v_sub_u32_e64 v5, s77, v7
    v_mov_b32 v6, 2146435072
    v_and_b32 v8, 7, v1
    v_lshrrev_b32 v9, 4, v1
    v_xor_b32 v8, v8, v9
    v_lshlrev_b32 v8, 4, v8
    v_lshl_add_u32 v7, v7, 11, v8
    v_xor_b32 v8, 64, v7
    s_lshl_b32 s58, s82, 11
    s_lshl_b32 s59, s98, 7
    s_add_u32 s58, s58, s59
    v_cmp_eq_u32 vcc, 0, v5
    s_nop 1
    v_cndmask_b32 v200, v7, v6, vcc
    v_cmp_eq_u32 vcc, 8, v5
    s_nop 1
    v_cndmask_b32 v201, v8, v6, vcc
    v_cmp_eq_u32 vcc, 16, v5
    s_nop 1
    v_cndmask_b32 v202, v7, v6, vcc
    v_cmp_eq_u32 vcc, 24, v5
    s_nop 1
    v_cndmask_b32 v203, v8, v6, vcc
    s_lshl_b32 s77, s62, 12
    s_add_u32 s77, s77, 0
    v_add_u32 v4, s77, v12
    s_waitcnt lgkmcnt(0)
    ds_read_b128 v[48:51], v4 offset:0
    ds_read_b128 v[52:55], v4 offset:1024
    ds_read_b128 v[56:59], v4 offset:2048
    ds_read_b128 v[60:63], v4 offset:3072
    s_waitcnt lgkmcnt(3)
    buffer_store_dwordx4 v[48:51], v200, s[44:47], s58 offen sc1
    s_add_u32 s58, s58, 16384
    s_waitcnt lgkmcnt(2)
    buffer_store_dwordx4 v[52:55], v201, s[44:47], s58 offen sc1
    s_add_u32 s58, s58, 16384
    s_waitcnt lgkmcnt(1)
    buffer_store_dwordx4 v[56:59], v202, s[44:47], s58 offen sc1
    s_add_u32 s58, s58, 16384
    s_waitcnt lgkmcnt(0)
    buffer_store_dwordx4 v[60:63], v203, s[44:47], s58 offen sc1
    s_barrier
    s_barrier
    s_branch L_cdone
L_stay_84:
    v_and_b32 v7, 15, v1
    v_lshlrev_b32_e64 v7, 3, v7
    s_cmp_eq_u32 s62, 0
    s_cbranch_scc0 L_nos4_85
    s_mul_i32 s76, s98, 9344
    s_add_u32 s76, s76, 8388608
    s_add_u32 s20, s26, s99
    s_addc_u32 s21, s27, 0
    s_mov_b32 s88, 0
L_spin_86:
    s_load_dwordx16 s[4:19], s[20:21], 768 glc
    s_waitcnt lgkmcnt(0)
    s_or_b64 s[4:5], s[4:5], s[6:7]
    s_or_b64 s[4:5], s[4:5], s[8:9]
    s_or_b64 s[4:5], s[4:5], s[10:11]
    s_or_b64 s[4:5], s[4:5], s[12:13]
    s_or_b64 s[4:5], s[4:5], s[14:15]
    s_or_b64 s[4:5], s[4:5], s[16:17]
    s_or_b64 s[4:5], s[4:5], s[18:19]
    s_cbranch_scc0 L_gate_87
    s_add_u32 s88, s88, 1
    s_cmp_lt_u32 s88, 65536
    s_cbranch_scc1 L_spin_86
L_gate_87:
    s_mov_b32 s88, 0
L_poll_88:
    buffer_load_dwordx2 v[196:197], v179, s[40:43], s76 offen offset:256 sc1
    buffer_load_dwordx4 v[188:191], v180, s[40:43], s76 offen offset:0 sc1
    buffer_load_dwordx4 v[192:195], v180, s[40:43], s76 offen offset:64 sc1
    s_waitcnt vmcnt(0)
    v_max3_u32 v4, v196, v197, v188
    v_max3_u32 v4, v4, v189, v190
    v_max3_u32 v4, v4, v191, v192
    v_max3_u32 v4, v4, v193, v194
    v_max_u32 v4, v4, v195
    v_cmp_eq_u32_e64 vcc, -1, v4
    s_nop 0
    s_cbranch_vccz L_ok_89
    s_add_u32 s88, s88, 1
    s_cmp_lt_u32 s88, 65536
    s_cbranch_scc1 L_poll_88
L_ok_89:
    ds_write_b128 v12, v[188:191] offset:28672
    ds_write_b128 v12, v[192:195] offset:29696
    ds_write_b64 v7, v[196:197] offset:25728
L_nos4_85:
    s_waitcnt lgkmcnt(0)
    s_barrier
    ds_read_b64 v[8:9], v7 offset:25728
    s_waitcnt lgkmcnt(0)
    v_max_f32_dpp v4, v8, v8 row_ror:8 row_mask:0xf bank_mask:0xf
    s_nop 1
    v_max_f32_dpp v4, v4, v4 row_ror:4 row_mask:0xf bank_mask:0xf
    s_nop 1
    v_max_f32_dpp v4, v4, v4 row_ror:2 row_mask:0xf bank_mask:0xf
    s_nop 1
    v_max_f32_dpp v4, v4, v4 row_ror:1 row_mask:0xf bank_mask:0xf
    v_cmp_eq_f32 vcc, v4, v8
    s_nop 0
    s_ff1_i32_b32 s92, vcc_lo
    s_and_b32 s92, s92, 15
    s_nop 3
    v_readlane_b32 s91, v9, s92
    s_nop 0
    s_cmp_eq_u32 s91, s79
    s_cbranch_scc0 L_noh_90
    s_mov_b32 exec_hi, 0
    buffer_store_dword v182, v177, s[40:43], s99 offen offset:128 sc1
    s_mov_b64 exec, -1
L_noh_90:
    s_sub_u32 s77, s91, s82
    v_lshrrev_b32 v7, 3, v1
    v_sub_u32 v5, s77, v7
    v_mov_b32 v6, 2146435072
    v_and_b32 v8, 7, v1
    v_lshrrev_b32 v9, 4, v1
    v_xor_b32 v8, v8, v9
    v_lshlrev_b32 v8, 4, v8
    v_lshl_add_u32 v7, v7, 11, v8
    v_xor_b32 v8, 64, v7
    s_lshl_b32 s58, s82, 11
    s_lshl_b32 s59, s98, 7
    s_add_u32 s58, s58, s59
    v_cmp_eq_u32 vcc, 0, v5
    s_nop 1
    v_cndmask_b32 v200, v7, v6, vcc
    v_cmp_eq_u32 vcc, 8, v5
    s_nop 1
    v_cndmask_b32 v201, v8, v6, vcc
    v_cmp_eq_u32 vcc, 16, v5
    s_nop 1
    v_cndmask_b32 v202, v7, v6, vcc
    v_cmp_eq_u32 vcc, 24, v5
    s_nop 1
    v_cndmask_b32 v203, v8, v6, vcc
    s_lshl_b32 s77, s62, 12
    s_add_u32 s77, s77, 0
    v_add_u32 v4, s77, v12
    v_lshlrev_b32 v24, 16, v92
    v_and_b32_e64 v25, s90, v92
    v_pk_fma_f32 v[152:153], v[24:25], v[118:119], v[118:119] op_sel:[0,0,1] op_sel_hi:[1,0,1] neg_lo:[0,0,1] neg_hi:[0,0,1]
    v_cvt_pk_bf16_f32 v128, v152, v153
    v_lshlrev_b32 v152, 16, v128
    v_and_b32 v153, s90, v128
    v_pk_add_f32 v[152:153], v[152:153], v[24:25]
    v_cvt_pk_bf16_f32 v128, v152, v153
    v_lshlrev_b32 v26, 16, v93
    v_and_b32 v27, s90, v93
    v_pk_fma_f32 v[154:155], v[26:27], v[118:119], v[118:119] op_sel:[0,0,1] op_sel_hi:[1,0,1] neg_lo:[0,0,1] neg_hi:[0,0,1]
    v_cvt_pk_bf16_f32 v129, v154, v155
    v_lshlrev_b32 v154, 16, v129
    v_and_b32 v155, s90, v129
    v_pk_add_f32 v[154:155], v[154:155], v[26:27]
    v_cvt_pk_bf16_f32 v129, v154, v155
    ds_write_b64 v66, v[128:129]
    v_lshlrev_b32 v28, 16, v94
    v_and_b32 v29, s90, v94
    v_pk_fma_f32 v[156:157], v[28:29], v[118:119], v[118:119] op_sel:[0,0,1] op_sel_hi:[1,0,1] neg_lo:[0,0,1] neg_hi:[0,0,1]
    v_cvt_pk_bf16_f32 v130, v156, v157
    v_lshlrev_b32 v156, 16, v130
    v_and_b32 v157, s90, v130
    v_pk_add_f32 v[156:157], v[156:157], v[28:29]
    v_cvt_pk_bf16_f32 v130, v156, v157
    v_lshlrev_b32 v30, 16, v95
    v_and_b32 v31, s90, v95
    v_pk_fma_f32 v[158:159], v[30:31], v[118:119], v[118:119] op_sel:[0,0,1] op_sel_hi:[1,0,1] neg_lo:[0,0,1] neg_hi:[0,0,1]
    v_cvt_pk_bf16_f32 v131, v158, v159
    v_lshlrev_b32 v158, 16, v131
    v_and_b32 v159, s90, v131
    v_pk_add_f32 v[158:159], v[158:159], v[30:31]
    v_cvt_pk_bf16_f32 v131, v158, v159
    ds_write_b64 v67, v[130:131]
    v_lshlrev_b32 v32, 16, v96
    v_and_b32 v33, s90, v96
    v_pk_fma_f32 v[160:161], v[32:33], v[118:119], v[118:119] op_sel:[0,0,1] op_sel_hi:[1,0,1] neg_lo:[0,0,1] neg_hi:[0,0,1]
    v_cvt_pk_bf16_f32 v132, v160, v161
    v_lshlrev_b32 v160, 16, v132
    v_and_b32 v161, s90, v132
    v_pk_add_f32 v[160:161], v[160:161], v[32:33]
    v_cvt_pk_bf16_f32 v132, v160, v161
    v_lshlrev_b32 v34, 16, v97
    v_and_b32 v35, s90, v97
    v_pk_fma_f32 v[162:163], v[34:35], v[118:119], v[118:119] op_sel:[0,0,1] op_sel_hi:[1,0,1] neg_lo:[0,0,1] neg_hi:[0,0,1]
    v_cvt_pk_bf16_f32 v133, v162, v163
    v_lshlrev_b32 v162, 16, v133
    v_and_b32 v163, s90, v133
    v_pk_add_f32 v[162:163], v[162:163], v[34:35]
    v_cvt_pk_bf16_f32 v133, v162, v163
    ds_write_b64 v68, v[132:133]
    v_lshlrev_b32 v36, 16, v98
    v_and_b32 v37, s90, v98
    v_pk_fma_f32 v[164:165], v[36:37], v[118:119], v[118:119] op_sel:[0,0,1] op_sel_hi:[1,0,1] neg_lo:[0,0,1] neg_hi:[0,0,1]
    v_cvt_pk_bf16_f32 v134, v164, v165
    v_lshlrev_b32 v164, 16, v134
    v_and_b32 v165, s90, v134
    v_pk_add_f32 v[164:165], v[164:165], v[36:37]
    v_cvt_pk_bf16_f32 v134, v164, v165
    v_lshlrev_b32 v38, 16, v99
    v_and_b32 v39, s90, v99
    v_pk_fma_f32 v[166:167], v[38:39], v[118:119], v[118:119] op_sel:[0,0,1] op_sel_hi:[1,0,1] neg_lo:[0,0,1] neg_hi:[0,0,1]
    v_cvt_pk_bf16_f32 v135, v166, v167
    v_lshlrev_b32 v166, 16, v135
    v_and_b32 v167, s90, v135
    v_pk_add_f32 v[166:167], v[166:167], v[38:39]
    v_cvt_pk_bf16_f32 v135, v166, v167
    ds_write_b64 v69, v[134:135]
    v_lshlrev_b32 v40, 16, v100
    v_and_b32 v41, s90, v100
    v_pk_fma_f32 v[168:169], v[40:41], v[118:119], v[118:119] op_sel:[0,0,1] op_sel_hi:[1,0,1] neg_lo:[0,0,1] neg_hi:[0,0,1]
    v_cvt_pk_bf16_f32 v136, v168, v169
    v_lshlrev_b32 v168, 16, v136
    v_and_b32 v169, s90, v136
    v_pk_add_f32 v[168:169], v[168:169], v[40:41]
    v_cvt_pk_bf16_f32 v136, v168, v169
    v_lshlrev_b32 v42, 16, v101
    v_and_b32 v43, s90, v101
    v_pk_fma_f32 v[170:171], v[42:43], v[118:119], v[118:119] op_sel:[0,0,1] op_sel_hi:[1,0,1] neg_lo:[0,0,1] neg_hi:[0,0,1]
    v_cvt_pk_bf16_f32 v137, v170, v171
    v_lshlrev_b32 v170, 16, v137
    v_and_b32 v171, s90, v137
    v_pk_add_f32 v[170:171], v[170:171], v[42:43]
    v_cvt_pk_bf16_f32 v137, v170, v171
    ds_write_b64 v70, v[136:137]
    v_lshlrev_b32 v44, 16, v102
    v_and_b32 v45, s90, v102
    v_pk_fma_f32 v[172:173], v[44:45], v[118:119], v[118:119] op_sel:[0,0,1] op_sel_hi:[1,0,1] neg_lo:[0,0,1] neg_hi:[0,0,1]
    v_cvt_pk_bf16_f32 v138, v172, v173
    v_lshlrev_b32 v172, 16, v138
    v_and_b32 v173, s90, v138
    v_pk_add_f32 v[172:173], v[172:173], v[44:45]
    v_cvt_pk_bf16_f32 v138, v172, v173
    v_lshlrev_b32 v46, 16, v103
    v_and_b32 v47, s90, v103
    v_pk_fma_f32 v[174:175], v[46:47], v[118:119], v[118:119] op_sel:[0,0,1] op_sel_hi:[1,0,1] neg_lo:[0,0,1] neg_hi:[0,0,1]
    v_cvt_pk_bf16_f32 v139, v174, v175
    v_lshlrev_b32 v174, 16, v139
    v_and_b32 v175, s90, v139
    v_pk_add_f32 v[174:175], v[174:175], v[46:47]
    v_cvt_pk_bf16_f32 v139, v174, v175
    ds_write_b64 v71, v[138:139]
    s_barrier
    s_waitcnt lgkmcnt(0)
    ds_read_b128 v[48:51], v4 offset:0
    ds_read_b128 v[52:55], v4 offset:1024
    ds_read_b128 v[56:59], v4 offset:2048
    ds_read_b128 v[60:63], v4 offset:3072
    s_waitcnt lgkmcnt(3)
    buffer_store_dwordx4 v[48:51], v200, s[44:47], s58 offen sc1
    s_add_u32 s58, s58, 16384
    s_waitcnt lgkmcnt(2)
    buffer_store_dwordx4 v[52:55], v201, s[44:47], s58 offen sc1
    s_add_u32 s58, s58, 16384
    s_waitcnt lgkmcnt(1)
    buffer_store_dwordx4 v[56:59], v202, s[44:47], s58 offen sc1
    s_add_u32 s58, s58, 16384
    s_waitcnt lgkmcnt(0)
    buffer_store_dwordx4 v[60:63], v203, s[44:47], s58 offen sc1
L_cdone:
L_cfin:
L_end:
    s_endpgm
L_tr0:
    s_mov_b32 s88, 0
L_trq:
    ds_read_b32 v79, v8 offset:25984
    s_waitcnt lgkmcnt(0)
    v_readfirstlane_b32 s76, v79
    s_nop 0
    s_and_b32 s76, s76, s52
    s_cbranch_scc1 L_bk0
    s_add_u32 s88, s88, 1
    s_cmp_lt_u32 s88, 5
    s_cbranch_scc1 L_trq
    s_cmp_eq_u32 s53, 0
    s_cbranch_scc0 L_sent_68
    s_waitcnt vmcnt(0)
    s_mov_b64 exec, 1
    ds_add_u32 v8, v74 offset:25988
    s_mov_b64 exec, -1
    s_mov_b32 s53, 1
L_sent_68:
    s_call_b64 s[54:55], L_stall
    s_branch L_bk0
L_tr1:
    s_cmp_eq_u32 s53, 0
    s_cbranch_scc0 L_sent_69
    s_waitcnt vmcnt(4)
    s_mov_b64 exec, 1
    ds_add_u32 v8, v74 offset:25988
    s_mov_b64 exec, -1
    s_mov_b32 s53, 1
L_sent_69:
    s_call_b64 s[54:55], L_stall
    s_branch L_bk1
L_tr2:
    s_call_b64 s[54:55], L_stall
    s_branch L_bk2
L_tr3:
    s_call_b64 s[54:55], L_stall
    s_branch L_bk3
L_tr4:
    s_call_b64 s[54:55], L_stall
    s_branch L_bk4
L_tr5:
    s_call_b64 s[54:55], L_stall
    s_branch L_bk5
L_tr6:
    s_call_b64 s[54:55], L_stall
    s_branch L_bk6
L_tr7:
    s_call_b64 s[54:55], L_stall
    s_branch L_bk7
L_tr8:
    s_call_b64 s[54:55], L_stall
    s_branch L_bk8
L_tr9:
    s_call_b64 s[54:55], L_stall
    s_branch L_bk9
L_tr10:
    s_call_b64 s[54:55], L_stall
    s_branch L_bk10
L_tr11:
    s_call_b64 s[54:55], L_stall
    s_branch L_bk11
L_tr12:
    s_call_b64 s[54:55], L_stall
    s_branch L_bk12
L_tr13:
    s_call_b64 s[54:55], L_stall
    s_branch L_bk13
L_tr14:
    s_call_b64 s[54:55], L_stall
    s_branch L_bk14
L_tr15:
    s_call_b64 s[54:55], L_stall
    s_branch L_bk15
L_stall:
    s_cmp_eq_u32 s53, 0
    s_cbranch_scc0 L_sent_67
    s_waitcnt vmcnt(0)
    s_mov_b64 exec, 1
    ds_add_u32 v8, v74 offset:25988
    s_mov_b64 exec, -1
    s_mov_b32 s53, 1
L_sent_67:
    s_mov_b32 s88, 0
L_stall1:
    ds_read_b32 v79, v8 offset:25984
    s_waitcnt lgkmcnt(0)
    v_readfirstlane_b32 s76, v79
    s_nop 0
    s_and_b32 s76, s76, s52
    s_cbranch_scc1 L_stall2
    s_add_u32 s88, s88, 1
    s_cmp_lt_u32 s88, 1048576
    s_cbranch_scc1 L_stall1
    s_mov_b32 s76, s52
L_stall2:
    s_setpc_b64 s[54:55]
L_s3_73:
    v_cmp_eq_u32_e64 vcc, -1, v115
    s_nop 0
    s_cbranch_vccz L_s3skip_75
    buffer_load_dwordx4 v[112:115], v178, s[40:43], s78 offen offset:1024 sc1
L_s3skip_75:
    v_cmp_eq_u32_e64 vcc, -1, v119
    s_nop 0
    s_cbranch_vccz L_s3skip_76
    buffer_load_dwordx4 v[116:119], v178, s[40:43], s48 offen offset:1024 sc1
L_s3skip_76:
    v_cmp_eq_u32_e64 vcc, -1, v123
    s_nop 0
    s_cbranch_vccz L_s3skip_77
    buffer_load_dwordx4 v[120:123], v178, s[40:43], s49 offen offset:1024 sc1
L_s3skip_77:
    v_cmp_eq_u32_e64 vcc, -1, v127
    s_nop 0
    s_cbranch_vccz L_s3skip_78
    buffer_load_dwordx4 v[124:127], v178, s[40:43], s50 offen offset:1024 sc1
L_s3skip_78:
    v_cmp_eq_u32_e64 vcc, -1, v131
    s_nop 0
    s_cbranch_vccz L_s3skip_79
    buffer_load_dwordx4 v[128:131], v178, s[40:43], s51 offen offset:1024 sc1
L_s3skip_79:
    v_cmp_eq_u32_e64 vcc, -1, v135
    s_nop 0
    s_cbranch_vccz L_s3skip_80
    buffer_load_dwordx4 v[132:135], v178, s[40:43], s52 offen offset:1024 sc1
L_s3skip_80:
    v_cmp_eq_u32_e64 vcc, -1, v139
    s_nop 0
    s_cbranch_vccz L_s3skip_81
    buffer_load_dwordx4 v[136:139], v178, s[40:43], s53 offen offset:1024 sc1
L_s3skip_81:
    v_cmp_eq_u32_e64 vcc, -1, v143
    s_nop 0
    s_cbranch_vccz L_s3skip_82
    buffer_load_dwordx4 v[140:143], v178, s[40:43], s54 offen offset:1024 sc1
L_s3skip_82:
    s_waitcnt vmcnt(0)
    v_pk_add_f32 v[108:109], v[112:113], v[116:117]
    v_pk_add_f32 v[110:111], v[114:115], v[118:119]
    v_pk_add_f32 v[108:109], v[108:109], v[120:121]
    v_pk_add_f32 v[110:111], v[110:111], v[122:123]
    v_pk_add_f32 v[108:109], v[108:109], v[124:125]
    v_pk_add_f32 v[110:111], v[110:111], v[126:127]
    v_pk_add_f32 v[108:109], v[108:109], v[128:129]
    v_pk_add_f32 v[110:111], v[110:111], v[130:131]
    v_pk_add_f32 v[108:109], v[108:109], v[132:133]
    v_pk_add_f32 v[110:111], v[110:111], v[134:135]
    v_pk_add_f32 v[108:109], v[108:109], v[136:137]
    v_pk_add_f32 v[110:111], v[110:111], v[138:139]
    v_pk_add_f32 v[108:109], v[108:109], v[140:141]
    v_pk_add_f32 v[110:111], v[110:111], v[142:143]
    v_cmp_u_f32 vcc, v111, v111
    v_mov_b32 v4, v108
    v_mov_b32 v5, v109
    v_mov_b32_e64 v6, v110
    s_cbranch_vccz L_s3ok_74
    s_add_u32 s88, s88, 1
    s_cmp_lt_u32 s88, 65536
    s_cbranch_scc1 L_s3_73
    s_branch L_s3ok_74
L_code_end:
s_endpgm
.p2align 7
.type L_table,@object
L_table:
.long 0x650c3824, 0xfedba97, 0x50102, 0x3006
.long 0x650c3824, 0xfedba97, 0x510200, 0x3060
.long 0x641d0935, 0xfecba87, 0x5020001, 0x3600
.long 0x76543218, 0xfedcba9, 0x15000002, 0x6300
.long 0x641d0935, 0xfecba87, 0x25100, 0x3006
.long 0x54e2a160, 0xfdcb987, 0x502001, 0x3060
.long 0x54e2a160, 0xfdcb987, 0x5002010, 0x3600
.long 0x54f3b271, 0xedca986, 0x50201000, 0x6300
.long 0x54f3b271, 0xedca986, 0x152000, 0x3006
.long 0x650c3824, 0xfedba97, 0x520010, 0x3060
.long 0x650c3824, 0xfedba97, 0x5020001, 0x3600
.long 0x76543218, 0xfedcba9, 0x50000012, 0x6300
.long 0x641d0935, 0xfecba87, 0x25010, 0x3006
.long 0x641d0935, 0xfecba87, 0x510020, 0x3060
.long 0x54e2a160, 0xfdcb987, 0x5100002, 0x3600
.long 0x54e2a160, 0xfdcb987, 0x50001002, 0x6300
.long 0x641d0935, 0xfecba87, 0x500210, 0x3060
.long 0x641d0935, 0xfecba87, 0x5010200, 0x3600
.long 0x54e2a160, 0xfdcb987, 0x50100002, 0x6300
.long 0x76543209, 0xfedcba8, 0x15002, 0x3006
.long 0x54e2a160, 0xfdcb987, 0x501002, 0x3060
.long 0x54f3b271, 0xedca986, 0x5000120, 0x3600
.long 0x54f3b271, 0xedca986, 0x50000012, 0x6300
.long 0x650c3824, 0xfedba97, 0x15200, 0x3006
.long 0x650c3824, 0xfedba97, 0x520100, 0x3060
.long 0x641d0935, 0xfecba87, 0x5001200, 0x3600
.long 0x641d0935, 0xfecba87, 0x50020001, 0x6300
.long 0x76543209, 0xfedcba8, 0x25001, 0x3006
.long 0x54e2a160, 0xfdcb987, 0x502100, 0x3060
.long 0x54e2a160, 0xfdcb987, 0x5002010, 0x3600
.long 0x54f3b271, 0xedca986, 0x50001002, 0x6300
.long 0x54f3b271, 0xedca986, 0x152000, 0x3006
.long 0x54e2a160, 0xfdcb987, 0x5001002, 0x3600
.long 0x54e2a160, 0xfdcb987, 0x50000012, 0x6300
.long 0x54f3b271, 0xedca986, 0x51020, 0x3006
.long 0x765431a0, 0xfedcb98, 0x150200, 0x3060
.long 0x54f3b271, 0xedca986, 0x5102000, 0x3600
.long 0x650c3824, 0xfedba97, 0x50000102, 0x6300
.long 0x650c3824, 0xfedba97, 0x15020, 0x3006
.long 0x641d0935, 0xfecba87, 0x510200, 0x3060
.long 0x641d0935, 0xfecba87, 0x5020100, 0x3600
.long 0x54e2a160, 0xfdcb987, 0x50100002, 0x6300
.long 0x54e2a160, 0xfdcb987, 0x250001, 0x3006
.long 0x765431a0, 0xfedcb98, 0x251000, 0x3060
.long 0x54f3b271, 0xedca986, 0x5200010, 0x3600
.long 0x54f3b271, 0xedca986, 0x50200001, 0x6300
.long 0x650c3824, 0xfedba97, 0x50021, 0x3006
.long 0x650c3824, 0xfedba97, 0x520010, 0x3060
.long 0x54f3b271, 0xedca986, 0x50200010, 0x6300
.long 0x54f3b271, 0xedca986, 0x152000, 0x3006
.long 0x650c3824, 0xfedba97, 0x500102, 0x3060
.long 0x765421b0, 0xfedca98, 0x2500010, 0x3600
.long 0x650c3824, 0xfedba97, 0x50010200, 0x6300
.long 0x641d0935, 0xfecba87, 0x15200, 0x3006
.long 0x641d0935, 0xfecba87, 0x520001, 0x3060
.long 0x54e2a160, 0xfdcb987, 0x5100020, 0x3600
.long 0x54e2a160, 0xfdcb987, 0x50001020, 0x6300
.long 0x54f3b271, 0xedca986, 0x52001, 0x3006
.long 0x54f3b271, 0xedca986, 0x500102, 0x3060
.long 0x765421b0, 0xfedca98, 0x1500020, 0x3600
.long 0x650c3824, 0xfedba97, 0x50000021, 0x6300
.long 0x650c3824, 0xfedba97, 0x521000, 0x3006
.long 0x641d0935, 0xfecba87, 0x520100, 0x3060
.long 0x641d0935, 0xfecba87, 0x5001002, 0x3600
.long 0x650c3824, 0xfedba97, 0x50021, 0x3006
.long 0x650c3824, 0xfedba97, 0x520010, 0x3060
.long 0x641d0935, 0xfecba87, 0x5010002, 0x3600
.long 0x76532c10, 0xfedba98, 0x15002000, 0x6300
.long 0x641d0935, 0xfecba87, 0x50021, 0x3006
.long 0x54e2a160, 0xfdcb987, 0x251000, 0x3060
.long 0x54e2a160, 0xfdcb987, 0x5000012, 0x3600
.long 0x54f3b271, 0xedca986, 0x50100002, 0x6300
.long 0x54f3b271, 0xedca986, 0x51020, 0x3006
.long 0x650c3824, 0xfedba97, 0x510200, 0x3060
.long 0x650c3824, 0xfedba97, 0x5000102, 0x3600
.long 0x76532c10, 0xfedba98, 0x50000210, 0x6300
.long 0x641d0935, 0xfecba87, 0x50210, 0x3006
.long 0x641d0935, 0xfecba87, 0x520100, 0x3060
.long 0x54e2a160, 0xfdcb987, 0x5100020, 0x3600
.long 0x54e2a160, 0xfdcb987, 0x50000021, 0x6300
.long 0x641d0935, 0xfecba87, 0x500120, 0x3060
.long 0x641d0935, 0xfecba87, 0x5000012, 0x3600
.long 0x54e2a160, 0xfdcb987, 0x50002010, 0x6300
.long 0x76432d10, 0xfecba98, 0x150002, 0x3006
.long 0x54e2a160, 0xfdcb987, 0x510020, 0x3060
.long 0x54f3b271, 0xedca986, 0x5201000, 0x3600
.long 0x54f3b271, 0xedca986, 0x50100020, 0x6300
.long 0x650c3824, 0xfedba97, 0x50102, 0x3006
.long 0x650c3824, 0xfedba97, 0x510200, 0x3060
.long 0x641d0935, 0xfecba87, 0x5000021, 0x3600
.long 0x641d0935, 0xfecba87, 0x50010020, 0x6300
.long 0x76432d10, 0xfecba98, 0x50201, 0x3006
.long 0x54e2a160, 0xfdcb987, 0x251000, 0x3060
.long 0x54e2a160, 0xfdcb987, 0x5100002, 0x3600
.long 0x54f3b271, 0xedca986, 0x50200010, 0x6300
.long 0x54f3b271, 0xedca986, 0x250001, 0x3006
.long 0x54e2a160, 0xfdcb987, 0x5001020, 0x3600
.long 0x54e2a160, 0xfdcb987, 0x50002100, 0x6300
.long 0x54f3b271, 0xedca986, 0x250100, 0x3006
.long 0x7543e210, 0xfdcba98, 0x1502000, 0x3060
.long 0x54f3b271, 0xedca986, 0x5200010, 0x3600
.long 0x650c3824, 0xfedba97, 0x50000201, 0x6300
.long 0x650c3824, 0xfedba97, 0x15200, 0x3006
.long 0x641d0935, 0xfecba87, 0x500120, 0x3060
.long 0x641d0935, 0xfecba87, 0x5010200, 0x3600
.long 0x54e2a160, 0xfdcb987, 0x50100020, 0x6300
.long 0x54e2a160, 0xfdcb987, 0x52010, 0x3006
.long 0x7543e210, 0xfdcba98, 0x500021, 0x3060
.long 0x54f3b271, 0xedca986, 0x5100020, 0x3600
.long 0x54f3b271, 0xedca986, 0x50001020, 0x6300
.long 0x650c3824, 0xfedba97, 0x51200, 0x3006
.long 0x650c3824, 0xfedba97, 0x500120, 0x3060
.long 0x54f3b271, 0xedca986, 0x50000102, 0x6300
.long 0x54f3b271, 0xedca986, 0x50012, 0x3006
.long 0x650c3824, 0xfedba97, 0x500120, 0x3060
.long 0x6543f210, 0xedcba98, 0x15200000, 0x3600
.long 0x650c3824, 0xfedba97, 0x50001020, 0x6300
.long 0x641d0935, 0xfecba87, 0x15002, 0x3006
.long 0x641d0935, 0xfecba87, 0x500102, 0x3060
.long 0x54e2a160, 0xfdcb987, 0x5102000, 0x3600
.long 0x54e2a160, 0xfdcb987, 0x50201000, 0x6300
.long 0x54f3b271, 0xedca986, 0x150020, 0x3006
.long 0x54f3b271, 0xedca986, 0x501020, 0x3060
.long 0x6543f210, 0xedcba98, 0x25000010, 0x3600
.long 0x650c3824, 0xfedba97, 0x50000201, 0x6300
.long 0x650c3824, 0xfedba97, 0x15200, 0x3006
.long 0x641d0935, 0xfecba87, 0x501200, 0x3060
.long 0x641d0935, 0xfecba87, 0x5000201, 0x3600
.long 0x650c3824, 0xfedba97, 0x50210, 0x3006
.long 0x650c3824, 0xfedba97, 0x510002, 0x3060
.long 0x641d0935, 0xfecba87, 0x5000120, 0x3600
.long 0x76543218, 0xfedcba9, 0x25000010, 0x6300
.long 0x641d0935, 0xfecba87, 0x50210, 0x3006
.long 0x54e2a160, 0xfdcb987, 0x150002, 0x3060
.long 0x54e2a160, 0xfdcb987, 0x5200010, 0x3600
.long 0x54f3b271, 0xedca986, 0x50102000, 0x6300
.long 0x54f3b271, 0xedca986, 0x251000, 0x3006
.long 0x650c3824, 0xfedba97, 0x500120, 0x3060
.long 0x650c3824, 0xfedba97, 0x5000021, 0x3600
.long 0x76543218, 0xfedcba9, 0x15002000, 0x6300
.long 0x641d0935, 0xfecba87, 0x50021, 0x3006
.long 0x641d0935, 0xfecba87, 0x510200, 0x3060
.long 0x54e2a160, 0xfdcb987, 0x5201000, 0x3600
.long 0x54e2a160, 0xfdcb987, 0x50200001, 0x6300
.long 0x641d0935, 0xfecba87, 0x500102, 0x3060
.long 0x641d0935, 0xfecba87, 0x5020010, 0x3600
.long 0x54e2a160, 0xfdcb987, 0x50201000, 0x6300
.long 0x76543209, 0xfedcba8, 0x215000, 0x3006
.long 0x54e2a160, 0xfdcb987, 0x502010, 0x3060
.long 0x54f3b271, 0xedca986, 0x5001002, 0x3600
.long 0x54f3b271, 0xedca986, 0x50200001, 0x6300
.long 0x650c3824, 0xfedba97, 0x50120, 0x3006
.long 0x650c3824, 0xfedba97, 0x510002, 0x3060
.long 0x641d0935, 0xfecba87, 0x5020001, 0x3600
.long 0x641d0935, 0xfecba87, 0x50010200, 0x6300
.long 0x76543209, 0xfedcba8, 0x50102, 0x3006
.long 0x54e2a160, 0xfdcb987, 0x150020, 0x3060
.long 0x54e2a160, 0xfdcb987, 0x5000021, 0x3600
.long 0x54f3b271, 0xedca986, 0x50102000, 0x6300
.long 0x54f3b271, 0xedca986, 0x50012, 0x3006
.long 0x54e2a160, 0xfdcb987, 0x5002010, 0x3600
.long 0x54e2a160, 0xfdcb987, 0x50001020, 0x6300
.long 0x54f3b271, 0xedca986, 0x150002, 0x3006
.long 0x765431a0, 0xfedcb98, 0x500021, 0x3060
.long 0x54f3b271, 0xedca986, 0x5001020, 0x3600
.long 0x650c3824, 0xfedba97, 0x50020001, 0x6300
.long 0x650c3824, 0xfedba97, 0x15002, 0x3006
.long 0x641d0935, 0xfecba87, 0x520100, 0x3060
.long 0x641d0935, 0xfecba87, 0x5010020, 0x3600
.long 0x54e2a160, 0xfdcb987, 0x50002100, 0x6300
.long 0x54e2a160, 0xfdcb987, 0x150002, 0x3006
.long 0x765431a0, 0xfedcb98, 0x150020, 0x3060
.long 0x54f3b271, 0xedca986, 0x5000102, 0x3600
.long 0x54f3b271, 0xedca986, 0x50002010, 0x6300
.long 0x650c3824, 0xfedba97, 0x50102, 0x3006
.long 0x650c3824, 0xfedba97, 0x501002, 0x3060
.long 0x54f3b271, 0xedca986, 0x50102000, 0x6300
.long 0x54f3b271, 0xedca986, 0x250001, 0x3006
.long 0x650c3824, 0xfedba97, 0x520001, 0x3060
.long 0x765421b0, 0xfedca98, 0x1500020, 0x3600
.long 0x650c3824, 0xfedba97, 0x50000102, 0x6300
.long 0x641d0935, 0xfecba87, 0x51020, 0x3006
.long 0x641d0935, 0xfecba87, 0x510020, 0x3060
.long 0x54e2a160, 0xfdcb987, 0x5001002, 0x3600
.long 0x54e2a160, 0xfdcb987, 0x50102000, 0x6300
.long 0x54f3b271, 0xedca986, 0x51002, 0x3006
.long 0x54f3b271, 0xedca986, 0x502010, 0x3060
.long 0x765421b0, 0xfedca98, 0x5100002, 0x3600
.long 0x650c3824, 0xfedba97, 0x50020010, 0x6300
.long 0x650c3824, 0xfedba97, 0x15002, 0x3006
.long 0x641d0935, 0xfecba87, 0x500102, 0x3060
.long 0x641d0935, 0xfecba87, 0x5020010, 0x3600
.long 0x650c3824, 0xfedba97, 0x521000, 0x3006
.long 0x650c3824, 0xfedba97, 0x500021, 0x3060
.long 0x641d0935, 0xfecba87, 0x5000201, 0x3600
.long 0x76532c10, 0xfedba98, 0x15000200, 0x6300
.long 0x641d0935, 0xfecba87, 0x15002, 0x3006
.long 0x54e2a160, 0xfdcb987, 0x501020, 0x3060
.long 0x54e2a160, 0xfdcb987, 0x5000120, 0x3600
.long 0x54f3b271, 0xedca986, 0x50100020, 0x6300
.long 0x54f3b271, 0xedca986, 0x51002, 0x3006
.long 0x650c3824, 0xfedba97, 0x500102, 0x3060
.long 0x650c3824, 0xfedba97, 0x5000210, 0x3600
.long 0x76532c10, 0xfedba98, 0x25000100, 0x6300
.long 0x641d0935, 0xfecba87, 0x50102, 0x3006
.long 0x641d0935, 0xfecba87, 0x501002, 0x3060
.long 0x54e2a160, 0xfdcb987, 0x5002010, 0x3600
.long 0x54e2a160, 0xfdcb987, 0x50102000, 0x6300
.long 0x641d0935, 0xfecba87, 0x520001, 0x3060
.long 0x641d0935, 0xfecba87, 0x5010020, 0x3600
.long 0x54e2a160, 0xfdcb987, 0x50100020, 0x6300
.long 0x76432d10, 0xfecba98, 0x50201, 0x3006
.long 0x54e2a160, 0xfdcb987, 0x251000, 0x3060
.long 0x54f3b271, 0xedca986, 0x5002001, 0x3600
.long 0x54f3b271, 0xedca986, 0x50002010, 0x6300
.long 0x650c3824, 0xfedba97, 0x25100, 0x3006
.long 0x650c3824, 0xfedba97, 0x510020, 0x3060
.long 0x641d0935, 0xfecba87, 0x5000102, 0x3600
.long 0x641d0935, 0xfecba87, 0x50000012, 0x6300
.long 0x76432d10, 0xfecba98, 0x152000, 0x3006
.long 0x54e2a160, 0xfdcb987, 0x500012, 0x3060
.long 0x54e2a160, 0xfdcb987, 0x5210000, 0x3600
.long 0x54f3b271, 0xedca986, 0x50001020, 0x6300
.long 0x54f3b271, 0xedca986, 0x150020, 0x3006
.long 0x54e2a160, 0xfdcb987, 0x5200010, 0x3600
.long 0x54e2a160, 0xfdcb987, 0x50201000, 0x6300
.long 0x54f3b271, 0xedca986, 0x52100, 0x3006
.long 0x7543e210, 0xfdcba98, 0x520001, 0x3060
.long 0x54f3b271, 0xedca986, 0x5100002, 0x3600
.long 0x650c3824, 0xfedba97, 0x50000120, 0x6300
.long 0x650c3824, 0xfedba97, 0x521000, 0x3006
.long 0x641d0935, 0xfecba87, 0x500102, 0x3060
.long 0x641d0935, 0xfecba87, 0x5010002, 0x3600
.long 0x54e2a160, 0xfdcb987, 0x51200000, 0x6300
.long 0x54e2a160, 0xfdcb987, 0x150020, 0x3006
.long 0x7543e210, 0xfdcba98, 0x502010, 0x3060
.long 0x54f3b271, 0xedca986, 0x5002010, 0x3600
.long 0x54f3b271, 0xedca986, 0x50001002, 0x6300
.long 0x650c3824, 0xfedba97, 0x1025000, 0x3006
.long 0x650c3824, 0xfedba97, 0x510200, 0x3060
.long 0x54f3b271, 0xedca986, 0x50100020, 0x6300
.long 0x54f3b271, 0xedca986, 0x51020, 0x3006
.long 0x650c3824, 0xfedba97, 0x510200, 0x3060
.long 0x6543f210, 0xedcba98, 0x5102000, 0x3600
.long 0x650c3824, 0xfedba97, 0x15020000, 0x6300
.long 0x641d0935, 0xfecba87, 0x25100, 0x3006
.long 0x641d0935, 0xfecba87, 0x500210, 0x3060
.long 0x54e2a160, 0xfdcb987, 0x5201000, 0x3600
.long 0x54e2a160, 0xfdcb987, 0x50100002, 0x6300
.long 0x54f3b271, 0xedca986, 0x250001, 0x3006
.long 0x54f3b271, 0xedca986, 0x250010, 0x3060
.long 0x6543f210, 0xedcba98, 0x5002001, 0x3600
.long 0x650c3824, 0xfedba97, 0x50000012, 0x6300
.long 0x650c3824, 0xfedba97, 0x50120, 0x3006
.long 0x641d0935, 0xfecba87, 0x510020, 0x3060
.long 0x641d0935, 0xfecba87, 0x5000021, 0x3600
.fill 1, 4, 0
.size L_table, .-L_table
.section .rodata,"a"
.p2align 6
.amdhsa_kernel sequential_preLN__linear_kernel_hedgehog__moe_arch_mod__prompt_kernel
  .amdhsa_next_free_vgpr 256
  .amdhsa_next_free_sgpr 102
  .amdhsa_accum_offset 256
  .amdhsa_group_segment_fixed_size 0
  .amdhsa_kernarg_size 96
  .amdhsa_user_sgpr_count 2
  .amdhsa_user_sgpr_kernarg_segment_ptr 1
  .amdhsa_system_sgpr_workgroup_id_x 1
  .amdhsa_float_denorm_mode_32 3
.end_amdhsa_kernel
```

```asm
; @launch grid=(256,1,1) block=(512,1,1) lds=163840
.amdgcn_target "amdgcn-amd-amdhsa--gfx950"
.text
.p2align 10
.fill 64, 4, 0xbf800000
.globl sequential_preLN__linear_kernel_hedgehog__moe_arch_mod__prompt_kernel
.p2align 8
.type sequential_preLN__linear_kernel_hedgehog__moe_arch_mod__prompt_kernel,@function
sequential_preLN__linear_kernel_hedgehog__moe_arch_mod__prompt_kernel:
    s_load_dwordx2 s[28:29], s[0:1], 0
    s_load_dwordx2 s[32:33], s[0:1], 8
    s_getpc_b64 s[66:67]
L_pc:
    v_readfirstlane_b32 s79, v0
    s_lshr_b32 s60, s2, 3
    s_cmp_ge_u32 s60, 32
    s_cbranch_scc1 L_end
    v_and_b32_e64 v1, 63, v0
    s_and_b32 s60, s60, 15
    s_lshr_b32 s62, s79, 6
    s_cmp_ge_u32 s62, 4
    s_cbranch_scc1 L_compute
    s_setprio 3
    s_lshr_b32 s76, s2, 3
    s_lshl2_add_u32 s76, s76, s62
    s_mul_i32 s76, s76, 256
    v_lshl_add_u32 v91, v1, 7, s76
    s_mov_b64 exec, 3
    global_load_dword v27, v91, s[66:67]
    s_mov_b64 exec, -1
    s_add_u32 s84, s60, s2
    s_and_b32 s84, s84, 3
    s_and_b32 s76, s60, 7
    s_and_b32 s77, s2, 7
    s_cselect_b32 s84, s84, s76
    v_lshrrev_b32 v4, 3, v1
    v_and_b32 v5, 7, v1
    v_lshrrev_b32 v6, 4, v1
    s_lshl2_add_u32 s76, s60, s62
    s_lshl_b32 s76, s76, 16
    s_movk_i32 s70, 10240
    s_mul_i32 s70, s70, s62
    v_xor_b32 v7, v5, v6
    v_lshlrev_b32 v7, 4, v7
    v_lshl_add_u32 v78, v4, 11, v7
    v_add_u32_e64 v16, s76, v78
    s_mov_b32 s30, 4194304
    s_mov_b32 s31, 0x20000
    s_and_b32 s72, s84, 15
    s_mov_b32 m0, s70
    s_lshl_b32 s71, s72, 7
    s_waitcnt lgkmcnt(0)
    buffer_load_dwordx4 v16, s[28:31], s71 offen offset:0 lds
    s_mul_i32 s72, s72, 393216
    s_lshr_b64 s[84:85], s[84:85], 4
    s_load_dwordx4 s[8:11], s[0:1], 16
    s_load_dwordx16 s[12:27], s[0:1], 32
    v_xor_b32 v7, 64, v16
    v_add_u32 v17, 15360, v7
    buffer_load_dwordx4 v17, s[28:31], s71 offen offset:1024 lds
    v_add_u32 v18, 30720, v16
    buffer_load_dwordx4 v18, s[28:31], s71 offen offset:2048 lds
    v_add_u32 v19, 46080, v7
    buffer_load_dwordx4 v19, s[28:31], s71 offen offset:3072 lds
    s_and_b32 s76, s2, 7
    s_lshl_b32 s76, s76, 3
    s_lshr_b32 s77, s2, 7
    s_lshl2_add_u32 s76, s77, s76
    s_mov_b32 s80, 0x654210b3
    s_mov_b32 s81, 0xfedca987
    s_lshr_b64 s[80:81], s[80:81], s76
    s_and_b32 s61, s80, 15
    v_and_b32 v6, 1, v6
    v_lshlrev_b32 v6, 2, v6
    v_xor_b32 v8, v5, v6
    v_lshlrev_b32_e64 v8, 4, v8
    s_lshl_b32 s76, s61, 7
    s_mul_i32 s77, s62, 98304
    s_add_u32 s76, s76, s77
    v_mul_u32_u24 v7, 6144, v4
    v_add3_u32 v20, v7, v8, s76
    v_xor_b32 v7, 32, v20
    s_mov_b32 s34, 6291456
    s_mov_b32 s35, 0x20000
    s_add_u32 m0, s70, 4096
    s_nop 0
    buffer_load_dwordx4 v20, s[32:35], s72 offen offset:0 lds
    v_add_u32 v21, 48128, v7
    buffer_load_dwordx4 v21, s[32:35], s72 offen offset:1024 lds
    v_add_u32 v22, 0, v20
    buffer_load_dwordx4 v22, s[32:35], s72 offen offset:2048 lds
    v_add_u32 v23, 48128, v7
    buffer_load_dwordx4 v23, s[32:35], s72 offen offset:3072 lds
    v_add_u32 v24, 4096, v20
    s_add_u32 m0, s70, 8192
    s_nop 0
    buffer_load_dwordx4 v24, s[32:35], s72 offen offset:0 lds
    v_add_u32 v25, 52224, v7
    buffer_load_dwordx4 v25, s[32:35], s72 offen offset:1024 lds
    s_add_u32 s70, s70, 40960
    s_cmp_ge_u32 s70, 122880
    s_cselect_b32 s76, 122880, 0
    s_sub_u32 s70, s70, s76
    s_lshl_b32 s76, s60, 8
    s_lshl_b32 s77, s61, 4
    s_add_u32 s76, s76, s77
    s_add_u32 s76, s76, 30572
    s_load_dwordx4 s[84:87], s[66:67], s76
    v_lshl_add_u32 v26, v4, 11, v8
    v_xor_b32 v79, 64, v78
    s_and_b32 s63, s62, 1
    s_lshr_b32 s64, s62, 1
    s_lshl_b32 s73, s60, 4
    s_add_u32 s73, s73, s61
    s_mul_i32 s73, s73, 28800
    s_add_u32 s76, s2, 7
    s_and_b32 s76, s76, 7
    s_bfe_u32 s77, s2, 0x10003
    s_lshl1_add_u32 s97, s76, s77
    s_lshr_b32 s98, s2, 4
    s_lshl_b32 s99, s97, 4
    s_add_u32 s99, s99, s98
    s_mul_i32 s99, s99, 9344
    s_add_u32 s99, s99, 8388608
    s_lshr_b32 s65, s97, 1
    s_lshl_b32 s76, s97, 3
    s_add_u32 s65, s65, s76
    s_mul_i32 s76, s98, 4
    s_add_u32 s65, s65, s76
    s_and_b32 s65, s65, 15
    s_mov_b32 s89, 0x3f803f80
    s_mov_b32 s90, 0xffff0000
    v_and_b32 v2, 31, v1
    v_lshrrev_b32 v3, 5, v1
    v_lshlrev_b32 v12, 4, v1
    v_lshrrev_b32 v4, 3, v1
    v_mul_u32_u24 v13, 460800, v4
    v_and_b32_e64 v4, 7, v1
    v_lshl_add_u32 v13, v4, 4, v13
    s_lshl_b32 s76, s98, 7
    s_lshl_b32 s77, s62, 15
    s_add_u32 s76, s76, s77
    v_add_u32 v26, s76, v26
    v_mov_b32 v28, -1
    v_mov_b32 v29, -1
    v_mov_b32 v30, -1
    v_mov_b32 v31, -1
    s_waitcnt lgkmcnt(0)
    s_and_b32 s72, s84, 15
    s_mov_b32 m0, s70
    s_lshl_b32 s71, s72, 7
    buffer_load_dwordx4 v16, s[28:31], s71 offen offset:0 lds
    s_mul_i32 s72, s72, 393216
    s_lshr_b64 s[84:85], s[84:85], 4
    buffer_load_dwordx4 v17, s[28:31], s71 offen offset:1024 lds
    s_mov_b32 s40, s26
    s_and_b32 s41, s27, 0xffff
    s_mov_b32 s42, 33554432
    s_mov_b32 s43, 0x20000
    buffer_load_dwordx4 v18, s[28:31], s71 offen offset:2048 lds
    s_mov_b32 s56, s8
    s_and_b32 s57, s9, 0xffff
    s_mov_b32 s58, 65536
    s_mov_b32 s59, 0x20000
    buffer_load_dwordx4 v19, s[28:31], s71 offen offset:3072 lds
    s_add_u32 m0, s70, 4096
    s_nop 0
    buffer_load_dwordx4 v20, s[32:35], s72 offen offset:0 lds
    buffer_load_dwordx4 v21, s[32:35], s72 offen offset:1024 lds
    buffer_load_dwordx4 v22, s[32:35], s72 offen offset:2048 lds
    buffer_load_dwordx4 v23, s[32:35], s72 offen offset:3072 lds
    s_add_u32 m0, s70, 8192
    s_nop 0
    buffer_load_dwordx4 v24, s[32:35], s72 offen offset:0 lds
    buffer_load_dwordx4 v25, s[32:35], s72 offen offset:1024 lds
    s_add_u32 s70, s70, 40960
    s_cmp_ge_u32 s70, 122880
    s_cselect_b32 s76, 122880, 0
    s_sub_u32 s70, s70, s76
    s_lshl_b32 s77, s62, 10
    s_add_u32 s76, s77, s73
    buffer_store_dwordx4 v[28:31], v12, s[40:43], s76 offen sc1
    s_lshl_b32 s76, s61, 12
    s_add_u32 s76, s76, s77
    s_add_u32 m0, s77, 122880
    s_nop 0
    buffer_load_dwordx4 v12, s[56:59], s76 offen lds
    v_mov_b32 v4, 13631488
    buffer_load_dwordx2 v[88:89], v4, s[40:43], 0 offen
    s_setprio 0
    s_waitcnt vmcnt(13)
    s_barrier
    s_and_b32 s72, s84, 15
    s_mov_b32 m0, s70
    s_lshl_b32 s71, s72, 7
    buffer_load_dwordx4 v16, s[28:31], s71 offen offset:0 lds
    s_mul_i32 s72, s72, 393216
    s_lshr_b64 s[84:85], s[84:85], 4
    buffer_load_dwordx4 v17, s[28:31], s71 offen offset:1024 lds
    buffer_load_dwordx4 v18, s[28:31], s71 offen offset:2048 lds
    buffer_load_dwordx4 v19, s[28:31], s71 offen offset:3072 lds
    s_add_u32 m0, s70, 4096
    s_nop 0
    buffer_load_dwordx4 v20, s[32:35], s72 offen offset:0 lds
    buffer_load_dwordx4 v21, s[32:35], s72 offen offset:1024 lds
    buffer_load_dwordx4 v22, s[32:35], s72 offen offset:2048 lds
    buffer_load_dwordx4 v23, s[32:35], s72 offen offset:3072 lds
    s_add_u32 m0, s70, 8192
    s_nop 0
    buffer_load_dwordx4 v24, s[32:35], s72 offen offset:0 lds
    buffer_load_dwordx4 v25, s[32:35], s72 offen offset:1024 lds
    s_add_u32 s70, s70, 40960
    s_cmp_ge_u32 s70, 122880
    s_cselect_b32 s76, 122880, 0
    s_sub_u32 s70, s70, s76
    s_mov_b32 s36, s10
    s_and_b32 s37, s11, 0xffff
    s_mov_b32 s38, 2097152
    s_mov_b32 s39, 0x20000
    s_mov_b32 s44, s22
    s_and_b32 s45, s23, 0xffff
    s_mov_b32 s46, 4194304
    s_mov_b32 s47, 0x20000
    s_mov_b32 s52, s20
    s_and_b32 s53, s21, 0xffff
    s_mov_b32 s54, 7340032
    s_mov_b32 s55, 0x20000
    s_cmp_eq_u32 s64, 0
    s_cselect_b32 s48, s16, s18
    s_cselect_b32 s49, s17, s19
    s_and_b32 s49, s49, 0xffff
    s_mov_b32 s51, 0x20000
    s_cmp_lt_u32 s97, 14
    s_cselect_b32 s50, 7340032, 0
    s_cselect_b32 s54, 7340032, 0
    v_bfe_u32 v4, v2, 1, 3
    v_xor_b32 v4, v4, v3
    v_lshlrev_b32 v4, 4, v4
    v_lshl_add_u32 v72, v2, 7, v4
    v_bfe_u32 v4, v1, 2, 2
    v_lshl_add_u32 v5, v3, 3, v4
    v_lshlrev_b32 v5, 7, v5
    v_lshrrev_b32 v4, 1, v4
    v_xor_b32_e64 v4, s64, v4
    v_lshl_add_u32 v5, v4, 6, v5
    v_bfe_u32 v4, v1, 4, 1
    v_xor_b32_e64 v4, v4, v3
    v_lshl_add_u32 v5, v4, 5, v5
    v_and_b32_e64 v4, 3, v1
    v_lshl_add_u32 v5, v4, 3, v5
    s_mul_i32 s76, s62, 10240
    s_sub_u32 s76, 4096, s76
    v_add_u32 v73, s76, v5
    v_lshlrev_b32 v74, 3, v2
    v_lshrrev_b32 v4, 4, v1
    v_and_b32 v5, 15, v1
    v_mul_u32_u24 v66, 28800, v4
    v_lshl_add_u32 v66, v5, 4, v66
    v_mul_u32_u24 v75, 460800, v4
    v_lshl_add_u32 v75, v5, 4, v75
    s_lshr_b32 s76, s60, 3
    s_lshl_b32 s76, s76, 2
    v_lshl_add_u32 v6, v4, 3, s76
    s_mov_b32 s69, 0
    v_mov_b32 v7, 0x654210b3
    v_bfe_u32 v7, v7, v6, 4
    v_mul_u32_u24 v7, 28800, v7
    v_lshl_add_u32 v66, v5, 4, v7
    v_mov_b32 v7, 0xfedca987
    v_bfe_u32 v7, v7, v6, 4
    v_mul_u32_u24 v7, 28800, v7
    v_lshl_add_u32 v67, v5, 4, v7
    v_mov_b32 v80, 0
    v_mov_b32 v81, 0
    v_mov_b32 v82, 0
    v_mov_b32 v83, 0
    v_lshrrev_b32 v4, 4, v1
    v_and_b32_e64 v5, 15, v1
    v_mul_u32_u24 v76, 114688, v4
    v_lshl_add_u32 v76, v5, 4, v76
    v_lshlrev_b32_e64 v77, 4, v2
    v_lshl_add_u32 v77, v3, 11, v77
    s_mul_i32 s75, s98, 458752
    s_lshl_b32 s77, s97, 9
    s_add_u32 s75, s75, s77
    s_lshl_b32 s77, s63, 8
    s_add_u32 s75, s75, s77
    s_lshl_b32 s96, s97, 19
    s_lshl_b32 s77, s98, 15
    s_add_u32 s96, s96, s77
    s_lshl_b32 s77, s62, 9
    s_add_u32 s96, s96, s77
    s_mov_b32 s68, 1
    s_getreg_b32 s101, hwreg(HW_REG_XCC_ID, 0, 4)
    s_lshl_b32 s76, s61, 8
    s_add_u32 s76, s76, 12582912
    s_lshl_b32 s77, s60, 8
    s_add_u32 s77, s77, 12586752
    s_lshr_b32 s78, s97, 1
    s_lshl_b32 s78, s78, 9
    s_add_u32 s78, s78, 12590592
    v_mov_b32 v4, s76
    v_mov_b32 v5, s77
    v_mov_b32 v6, s78
    v_cmp_gt_u32 vcc, 16, v1
    s_nop 1
    v_cndmask_b32 v4, v5, v4, vcc
    v_cmp_gt_u32 vcc, 32, v1
    s_nop 1
    v_cndmask_b32 v4, v6, v4, vcc
    v_add_u32 v90, v4, v12
    s_waitcnt vmcnt(10)
    s_barrier
L_hloop:
    s_and_b32 s77, s86, 15
    s_cbranch_scc1 L_event
L_evret:
    s_and_b32 s72, s84, 15
    s_mov_b32 m0, s70
    s_lshl_b32 s71, s72, 7
    buffer_load_dwordx4 v16, s[28:31], s71 offen offset:0 lds
    s_mul_i32 s72, s72, 393216
    s_lshr_b64 s[84:85], s[84:85], 4
    buffer_load_dwordx4 v17, s[28:31], s71 offen offset:1024 lds
    buffer_load_dwordx4 v18, s[28:31], s71 offen offset:2048 lds
    buffer_load_dwordx4 v19, s[28:31], s71 offen offset:3072 lds
    s_add_u32 m0, s70, 4096
    s_nop 0
    buffer_load_dwordx4 v20, s[32:35], s72 offen offset:0 lds
    buffer_load_dwordx4 v21, s[32:35], s72 offen offset:1024 lds
    buffer_load_dwordx4 v22, s[32:35], s72 offen offset:2048 lds
    buffer_load_dwordx4 v23, s[32:35], s72 offen offset:3072 lds
    s_add_u32 m0, s70, 8192
    s_nop 0
    buffer_load_dwordx4 v24, s[32:35], s72 offen offset:0 lds
    buffer_load_dwordx4 v25, s[32:35], s72 offen offset:1024 lds
    s_add_u32 s70, s70, 40960
    s_cmp_ge_u32 s70, 122880
    s_cselect_b32 s76, 122880, 0
    s_sub_u32 s70, s70, s76
L_hw10:
    s_waitcnt vmcnt(10)
L_hbar:
    s_lshr_b64 s[86:87], s[86:87], 4
    s_add_u32 s68, s68, 1
    s_cmp_lt_u32 s68, 14
    s_barrier
    s_cbranch_scc1 L_hloop
L_hdone:
    v_add_co_u32 v88, vcc, 1, v88
    s_nop 1
    v_addc_co_u32 v89, vcc, 0, v89, vcc
    v_cmp_ne_u64 vcc, v[92:93], v[88:89]
    s_nop 0
    s_cbranch_vccz L_hello_ok_1
    s_mov_b32 s88, 0
L_spin_2:
    buffer_load_dwordx4 v[92:95], v90, s[40:43], 0 offen sc1
    s_waitcnt vmcnt(0)
    v_cmp_ne_u64 vcc, v[92:93], v[88:89]
    s_nop 0
    s_cbranch_vccz L_hello_ok_1
    s_add_u32 s88, s88, 1
    s_cmp_lt_u32 s88, 65536
    s_cbranch_scc1 L_spin_2
L_hello_ok_1:
    v_cmp_ne_u32_e64 vcc, s101, v94
    s_nop 0
    s_and_b32 s76, vcc_lo, 0xffff
    s_cselect_b32 s100, 0, 1
    s_cmp_eq_u32 vcc_hi, 0
    s_cselect_b32 s76, 2, 0
    s_or_b32 s100, s100, s76
    v_mov_b32 v4, s100
    v_mov_b32 v5, 0
    ds_write_b32 v5, v4 offset:53248
    s_lshl_b32 s81, s62, 8
    s_mul_i32 s80, s60, 460800
    s_add_u32 s80, s80, s81
    buffer_load_dwordx4 v[32:35], v66, s[40:43], s80 offen offset:0 sc1
    buffer_load_dwordx4 v[36:39], v67, s[40:43], s80 offen offset:0 sc1
    s_mul_i32 s80, s61, 28800
    s_add_u32 s80, s80, s81
    s_bitcmp1_b32 s2, 7
    s_cselect_b32 s79, 0, 3686400
    s_add_u32 s80, s80, s79
    buffer_load_dwordx4 v[48:51], v75, s[40:43], s80 offen offset:1024 sc1
    s_add_u32 s80, s80, 1843200
    buffer_load_dwordx4 v[52:55], v75, s[40:43], s80 offen offset:1024 sc1
    v_bfe_u32 v10, v1, 4, 1
    v_lshl_add_u32 v10, v10, 1, v3
    v_min_u32 v10, 2, v10
    v_and_b32 v7, 15, v1
    v_lshlrev_b32_e64 v7, 3, v7
    s_lshl_b32 s76, s62, 7
    v_lshl_add_u32 v10, v10, 9, v7
    v_add_u32_e64 v64, s76, v10
    v_lshl_add_u32 v65, v7, 1, s81
    v_bfe_u32 v10, v1, 4, 1
    v_lshl_add_u32 v65, v10, 3, v65
    s_mul_i32 s78, s62, 2048
    s_add_u32 s78, s78, s99
    s_add_u32 s78, s78, 1024
    v_lshlrev_b32 v11, 7, v1
    s_mov_b64 exec, 65535
    buffer_load_dword v27, v11, s[40:43], s78 offen sc1
    s_mov_b64 exec, -1
    buffer_load_dwordx4 v[152:155], v76, s[48:51], s75 offen nt
    s_add_u32 s75, s75, 7168
    s_waitcnt vmcnt(6)
    s_barrier
    s_add_u32 s78, s65, 0
    s_and_b32 s78, s78, 15
    s_lshl_b32 s78, s78, 17
    s_lshl_b32 s79, s62, 11
    s_add_u32 m0, s79, 57344
    s_add_u32 s79, s78, 15360
    buffer_load_dwordx4 v26, s[36:39], s78 offen lds
    buffer_load_dwordx4 v26, s[36:39], s79 offen offset:1024 lds
    s_add_u32 s78, s65, 1
    s_and_b32 s78, s78, 15
    s_lshl_b32 s78, s78, 17
    s_lshl_b32 s79, s62, 11
    s_add_u32 m0, s79, 65536
    s_add_u32 s79, s78, 15360
    buffer_load_dwordx4 v26, s[36:39], s78 offen lds
    buffer_load_dwordx4 v26, s[36:39], s79 offen offset:1024 lds
    s_setprio 3
    s_mov_b32 s88, 0
    s_waitcnt vmcnt(8)
    s_branch L_g1first_3
L_g1_4:
    s_mul_i32 s80, s60, 460800
    s_add_u32 s80, s80, s81
    buffer_load_dwordx4 v[32:35], v66, s[40:43], s80 offen offset:0 sc1
    buffer_load_dwordx4 v[36:39], v67, s[40:43], s80 offen offset:0 sc1
    s_waitcnt vmcnt(0)
L_g1first_3:
    v_max3_u32 v4, v32, v34, v36
    v_max_u32 v4, v4, v38
    v_cmp_eq_u32 vcc, -1, v4
    s_nop 0
    s_cbranch_vccz L_ok_5
    s_add_u32 s88, s88, 1
    s_cmp_lt_u32 s88, 65536
    s_cbranch_scc1 L_g1_4
L_ok_5:
    v_add_f32 v32, v32, v36
    v_add_f32 v33, v33, v37
    v_add_f32 v34, v34, v38
    v_add_f32_e64 v35, v35, v39
    s_add_u32 s78, s65, 2
    s_and_b32 s78, s78, 15
    s_lshl_b32 s78, s78, 17
    s_lshl_b32 s79, s62, 11
    s_add_u32 m0, s79, 73728
    s_add_u32 s79, s78, 15360
    buffer_load_dwordx4 v26, s[36:39], s78 offen lds
    buffer_load_dwordx4 v26, s[36:39], s79 offen offset:1024 lds
    v_permlane32_swap_b32 v32, v33
    v_permlane32_swap_b32 v34, v35
    v_add_f32 v32, v32, v33
    v_add_f32 v34, v34, v35
    s_nop 1
    v_permlane16_swap_b32 v32, v34
    v_add_f32 v32, v32, v34
    v_mov_b32 v33, v32
    s_nop 1
    v_permlane32_swap_b32 v32, v33
    v_mul_f32 v32, 0x3a800000, v32
    v_mul_f32 v33, 0x3a800000, v33
    v_fma_f32 v7, -v32, v32, v33
    v_max_f32_e64 v7, 0, v7
    v_cvt_pk_bf16_f32 v5, v32, v32
    v_and_b32_e64 v5, s90, v5
    v_cvt_pk_bf16_f32 v7, v7, v7
    v_and_b32_e64 v7, s90, v7
    v_add_f32 v7, 0x3727c5ac, v7
    v_cvt_pk_bf16_f32 v7, v7, v7
    v_and_b32 v7, s90, v7
    v_sqrt_f32_e64 v7, v7
    s_nop 0
    v_cvt_pk_bf16_f32 v7, v7, v7
    v_and_b32 v7, s90, v7
    v_rcp_f32 v9, v7
    v_xor_b32 v5, 0x80000000, v5
    v_cvt_pk_bf16_f32 v8, v5, v5
    ds_write_b64 v65, v[8:9] offset:49152
    s_mov_b32 s88, 0
    s_waitcnt vmcnt(8)
    s_branch L_g1first_6
L_g1_7:
    s_mul_i32 s80, s61, 28800
    s_add_u32 s80, s80, s81
    s_bitcmp1_b32 s2, 7
    s_cselect_b32 s79, 0, 3686400
    s_add_u32 s80, s80, s79
    buffer_load_dwordx4 v[48:51], v75, s[40:43], s80 offen offset:1024 sc1
    s_add_u32 s80, s80, 1843200
    buffer_load_dwordx4 v[52:55], v75, s[40:43], s80 offen offset:1024 sc1
    s_waitcnt vmcnt(0)
L_g1first_6:
    v_max3_u32 v4, v48, v50, v52
    v_max_u32 v4, v4, v54
    v_cmp_eq_u32 vcc, -1, v4
    s_nop 0
    s_cbranch_vccz L_ok_8
    s_add_u32 s88, s88, 1
    s_cmp_lt_u32 s88, 65536
    s_cbranch_scc1 L_g1_7
L_ok_8:
    v_add_f32 v48, v48, v52
    v_add_f32 v49, v49, v53
    v_add_f32 v50, v50, v54
    v_add_f32 v51, v51, v55
    v_add_f32 v49, v49, v51
    v_mov_b32 v51, v49
    v_permlane32_swap_b32 v48, v50
    s_nop 0
    v_permlane32_swap_b32 v49, v51
    v_add_f32 v48, v48, v50
    v_add_f32 v49, v49, v51
    s_nop 1
    v_permlane16_swap_b32 v48, v49
    v_add_f32_e64 v48, v48, v49
    v_cvt_pk_bf16_f32 v49, v48, v48
    v_and_b32 v49, s90, v49
    v_sub_f32 v49, v48, v49
    v_cvt_pk_bf16_f32 v50, v48, v49
    v_and_b32 v51, s90, v50
    v_sub_f32 v49, v49, v51
    v_cvt_pk_bf16_f32 v51, v49, 0
    ds_write_b64 v64, v[50:51] offset:50176
    s_setprio 0
    s_waitcnt lgkmcnt(0)
    s_barrier
    s_add_u32 s78, s65, 3
    s_and_b32 s78, s78, 15
    s_lshl_b32 s78, s78, 17
    s_lshl_b32 s79, s62, 11
    s_add_u32 m0, s79, 81920
    s_add_u32 s79, s78, 15360
    buffer_load_dwordx4 v26, s[36:39], s78 offen lds
    buffer_load_dwordx4 v26, s[36:39], s79 offen offset:1024 lds
    s_add_u32 s78, s65, 4
    s_and_b32 s78, s78, 15
    s_lshl_b32 s78, s78, 17
    s_lshl_b32 s79, s62, 11
    s_add_u32 m0, s79, 90112
    s_add_u32 s79, s78, 15360
    buffer_load_dwordx4 v26, s[36:39], s78 offen lds
    buffer_load_dwordx4 v26, s[36:39], s79 offen offset:1024 lds
    s_lshl_b32 s78, s62, 11
    s_add_u32 s79, s78, s99
    s_bitcmp1_b32 s100, 0
    s_cbranch_scc1 L_loc_9
    buffer_store_dwordx4 v[28:31], v12, s[40:43], s79 offen offset:1024 sc1
    buffer_store_dwordx4 v[28:31], v12, s[40:43], s79 offen offset:2048 sc1
    s_branch L_pubd_10
L_loc_9:
    buffer_store_dwordx4 v[28:31], v12, s[40:43], s79 offen offset:1024
    buffer_store_dwordx4 v[28:31], v12, s[40:43], s79 offen offset:2048
L_pubd_10:
    s_lshl_b32 s79, s62, 8
    s_add_u32 s79, s79, s99
    s_mov_b64 exec, 0xffff
    buffer_store_dwordx4 v[28:31], v12, s[40:43], s79 offen sc1
    s_mov_b64 exec, -1
    s_add_u32 s78, s65, 5
    s_and_b32 s78, s78, 15
    s_lshl_b32 s78, s78, 17
    s_lshl_b32 s79, s62, 11
    s_add_u32 m0, s79, 98304
    s_add_u32 s79, s78, 15360
    buffer_load_dwordx4 v26, s[36:39], s78 offen lds
    buffer_load_dwordx4 v26, s[36:39], s79 offen offset:1024 lds
    s_add_u32 s78, s65, 6
    s_and_b32 s78, s78, 15
    s_lshl_b32 s78, s78, 17
    s_lshl_b32 s79, s62, 11
    s_add_u32 m0, s79, 106496
    s_add_u32 s79, s78, 15360
    buffer_load_dwordx4 v26, s[36:39], s78 offen lds
    buffer_load_dwordx4 v26, s[36:39], s79 offen offset:1024 lds
    s_add_u32 s78, s65, 7
    s_and_b32 s78, s78, 15
    s_lshl_b32 s78, s78, 17
    s_lshl_b32 s79, s62, 11
    s_add_u32 m0, s79, 114688
    s_add_u32 s79, s78, 15360
    buffer_load_dwordx4 v26, s[36:39], s78 offen lds
    buffer_load_dwordx4 v26, s[36:39], s79 offen offset:1024 lds
    s_mul_i32 s78, s62, 384
    s_add_u32 s78, s78, s73
    s_add_u32 s78, s78, 2048
    v_lshlrev_b32 v11, 7, v1
    s_mov_b64 exec, 7
    buffer_load_dword v27, v11, s[40:43], s78 offen sc1
    s_mov_b64 exec, -1
    s_waitcnt vmcnt(7)
    s_lshl_b32 s76, s62, 2
    s_add_u32 s76, s76, s73
    v_mov_b32 v4, 0
    s_mov_b64 exec, 1
    s_bitcmp1_b32 s100, 0
    s_cbranch_scc1 L_loc_11
    buffer_store_dword v4, v4, s[40:43], s76 offen offset:2560 sc1
    s_branch L_pubd_12
L_loc_11:
    buffer_store_dword v4, v4, s[40:43], s76 offen offset:2560
L_pubd_12:
    s_mov_b64 exec, -1
    s_add_u32 s78, s65, 8
    s_and_b32 s78, s78, 15
    s_lshl_b32 s78, s78, 17
    s_lshl_b32 s79, s62, 11
    s_add_u32 m0, s79, 122880
    s_add_u32 s79, s78, 15360
    buffer_load_dwordx4 v26, s[36:39], s78 offen lds
    buffer_load_dwordx4 v26, s[36:39], s79 offen offset:1024 lds
    s_add_u32 s78, s65, 9
    s_and_b32 s78, s78, 15
    s_lshl_b32 s78, s78, 17
    s_lshl_b32 s79, s62, 11
    s_add_u32 m0, s79, 131072
    s_add_u32 s79, s78, 15360
    buffer_load_dwordx4 v26, s[36:39], s78 offen lds
    buffer_load_dwordx4 v26, s[36:39], s79 offen offset:1024 lds
    s_add_u32 s78, s65, 10
    s_and_b32 s78, s78, 15
    s_lshl_b32 s78, s78, 17
    s_lshl_b32 s79, s62, 11
    s_add_u32 m0, s79, 139264
    s_add_u32 s79, s78, 15360
    buffer_load_dwordx4 v26, s[36:39], s78 offen lds
    buffer_load_dwordx4 v26, s[36:39], s79 offen offset:1024 lds
    v_and_b32_e64 v65, 15, v1
    v_mul_u32_u24 v65, 460800, v65
    s_mul_i32 s80, s61, 28800
    s_lshl_b32 s82, s62, 2
    s_add_u32 s82, s82, s80
    v_bfe_u32 v4, v1, 4, 1
    v_lshl_add_u32 v4, v4, 1, v3
    s_lshl_b32 s77, s62, 6
    v_lshl_add_u32 v66, v4, 1, s77
    v_bfe_u32 v4, v1, 2, 1
    v_lshl_add_u32 v66, v4, 5, v66
    v_bfe_u32 v4, v1, 0, 1
    v_lshl_add_u32 v66, v4, 4, v66
    v_bfe_u32 v4, v1, 1, 1
    v_lshl_add_u32 v66, v4, 3, v66
    s_lshl_b32 s83, s62, 7
    s_add_u32 s81, s83, s80
    s_add_u32 s68, s81, 3686400
    s_add_u32 s83, s83, s73
    v_and_b32 v4, 7, v1
    v_lshrrev_b32 v5, 4, v1
    v_lshlrev_b32_e64 v5, 2, v5
    v_lshl_add_u32 v67, v4, 4, v5
    v_bfe_u32 v5, v1, 3, 1
    v_lshrrev_b32_e64 v6, 4, v1
    v_lshl_add_u32 v5, v5, 4, v6
    v_mul_u32_u24 v5, 9344, v5
    v_lshl_add_u32 v61, v4, 4, v5
    s_lshr_b32 s69, s97, 1
    s_lshr_b32 s76, s2, 7
    s_lshl2_add_u32 s69, s69, s76
    s_mul_i32 s69, s69, 74752
    s_add_u32 s69, s69, 8389632
    s_barrier
    s_add_u32 s78, s65, 11
    s_and_b32 s78, s78, 15
    s_lshl_b32 s78, s78, 17
    s_lshl_b32 s79, s62, 11
    s_add_u32 m0, s79, 147456
    s_add_u32 s79, s78, 15360
    buffer_load_dwordx4 v26, s[36:39], s78 offen lds
    buffer_load_dwordx4 v26, s[36:39], s79 offen offset:1024 lds
    s_add_u32 s78, s65, 12
    s_and_b32 s78, s78, 15
    s_lshl_b32 s78, s78, 17
    s_lshl_b32 s79, s62, 11
    s_add_u32 m0, s79, 155648
    s_add_u32 s79, s78, 15360
    buffer_load_dwordx4 v26, s[36:39], s78 offen lds
    buffer_load_dwordx4 v26, s[36:39], s79 offen offset:1024 lds
    buffer_load_dword v64, v65, s[40:43], s82 offen offset:2560 sc1
    s_barrier
    s_setprio 3
    v_mov_b32 v4, s89
    v_lshlrev_b32 v5, 2, v1
    ds_write_b32 v5, v4 offset:24832
    v_mov_b32 v70, 0
    v_mov_b32 v71, 0
    ds_write_b64 v70, v[70:71] offset:25984
    s_mov_b32 s88, 0
    s_branch L_p2first_13
L_p2_14:
    buffer_load_dword v64, v65, s[40:43], s82 offen offset:2560 sc1
L_p2first_13:
    s_waitcnt vmcnt(0)
    v_cmp_eq_u32_e64 vcc, -1, v64
    s_nop 0
    s_cbranch_vccz L_ok_15
    s_add_u32 s88, s88, 1
    s_cmp_lt_u32 s88, 65536
    s_cbranch_scc1 L_p2_14
L_ok_15:
    s_add_u32 s78, s65, 13
    s_and_b32 s78, s78, 15
    s_lshl_b32 s78, s78, 17
    s_lshl_b32 s79, s62, 11
    s_add_u32 m0, s79, 32768
    s_add_u32 s79, s78, 15360
    buffer_load_dwordx4 v26, s[36:39], s78 offen lds
    buffer_load_dwordx4 v26, s[36:39], s79 offen offset:1024 lds
    s_add_u32 s78, s65, 14
    s_and_b32 s78, s78, 15
    s_lshl_b32 s78, s78, 17
    s_lshl_b32 s79, s62, 11
    s_add_u32 m0, s79, 40960
    s_add_u32 s79, s78, 15360
    buffer_load_dwordx4 v26, s[36:39], s78 offen lds
    buffer_load_dwordx4 v26, s[36:39], s79 offen offset:1024 lds
    s_add_u32 s78, s65, 15
    s_and_b32 s78, s78, 15
    s_lshl_b32 s78, s78, 17
    s_lshl_b32 s79, s62, 11
    s_add_u32 m0, s79, 49152
    s_add_u32 s79, s78, 15360
    buffer_load_dwordx4 v26, s[36:39], s78 offen lds
    buffer_load_dwordx4 v26, s[36:39], s79 offen offset:1024 lds
    s_lshl_b32 s76, s62, 11
    s_lshl_b32 s77, s60, 7
    s_add_u32 s76, s76, s77
    s_add_u32 s76, s76, s69
    s_add_u32 s77, s76, 37376
    s_mov_b32 s78, 0x00003f80
    s_mov_b32 s79, 0x3f800000
    s_mov_b32 s88, 0
L_poll_16:
    buffer_load_dwordx4 v[32:35], v61, s[40:43], s76 offen sc1
    buffer_load_dwordx4 v[36:39], v61, s[40:43], s77 offen sc1
    s_waitcnt vmcnt(0)
    v_max_u32 v4, v32, v36
    v_cmp_eq_u32_e64 vcc, -1, v4
    s_nop 0
    s_cbranch_vccz L_ok_17
    s_add_u32 s88, s88, 1
    s_cmp_lt_u32 s88, 65536
    s_cbranch_scc1 L_poll_16
L_ok_17:
    v_dot2_f32_bf16 v48, v32, s78, 0
    v_dot2_f32_bf16 v49, v32, s79, 0
    v_dot2_f32_bf16 v50, v33, s78, 0
    v_dot2_f32_bf16 v51, v33, s79, 0
    v_dot2_f32_bf16 v52, v34, s78, 0
    v_dot2_f32_bf16 v53, v34, s79, 0
    v_dot2_f32_bf16 v54, v35, s78, 0
    v_dot2_f32_bf16 v55, v35, s79, 0
    v_dot2_f32_bf16 v48, v36, s78, v48
    v_dot2_f32_bf16 v49, v36, s79, v49
    v_dot2_f32_bf16 v50, v37, s78, v50
    v_dot2_f32_bf16 v51, v37, s79, v51
    v_dot2_f32_bf16 v52, v38, s78, v52
    v_dot2_f32_bf16 v53, v38, s79, v53
    v_dot2_f32_bf16 v54, v39, s78, v54
    v_dot2_f32_bf16 v55, v39, s79, v55
    buffer_load_dwordx4 v[40:43], v13, s[40:43], s81 offen offset:2048 sc1
    buffer_load_dwordx4 v[44:47], v13, s[40:43], s68 offen offset:2048 sc1
    v_permlane32_swap_b32 v48, v52
    v_permlane32_swap_b32 v49, v53
    v_permlane32_swap_b32 v50, v54
    v_permlane32_swap_b32 v51, v55
    v_add_f32 v48, v48, v52
    v_add_f32 v49, v49, v53
    v_add_f32 v50, v50, v54
    v_add_f32 v51, v51, v55
    s_nop 0
    v_permlane16_swap_b32 v48, v50
    v_permlane16_swap_b32 v49, v51
    v_add_f32 v48, v48, v50
    v_add_f32_e64 v49, v49, v51
    s_nop 0
    v_add_f32_dpp v48, v48, v48 row_ror:8 row_mask:0xf bank_mask:0xf
    v_add_f32_dpp v49, v49, v49 row_ror:8 row_mask:0xf bank_mask:0xf
    v_cvt_pk_bf16_f32 v48, v48, v49
    s_bitcmp1_b32 s100, 0
    s_cbranch_scc1 L_loc_18
    buffer_store_dword v48, v67, s[40:43], s83 offen offset:3072 sc1
    s_branch L_pubd_19
L_loc_18:
    buffer_store_dword v48, v67, s[40:43], s83 offen offset:3072
L_pubd_19:
    s_mov_b32 s88, 0
    s_waitcnt vmcnt(1)
    s_branch L_zfirst_20
L_z_21:
    buffer_load_dwordx4 v[40:43], v13, s[40:43], s81 offen offset:2048 sc1
    buffer_load_dwordx4 v[44:47], v13, s[40:43], s68 offen offset:2048 sc1
    s_waitcnt vmcnt(0)
L_zfirst_20:
    v_max3_u32 v4, v40, v41, v42
    v_max3_u32 v4, v4, v43, v44
    v_max3_u32 v4, v4, v45, v46
    v_max_u32 v4, v4, v47
    v_cmp_eq_u32 vcc, -1, v4
    s_nop 0
    s_cbranch_vccz L_ok_22
    s_add_u32 s88, s88, 1
    s_cmp_lt_u32 s88, 65536
    s_cbranch_scc1 L_z_21
L_ok_22:
    v_add_f32 v40, v40, v44
    v_add_f32 v41, v41, v45
    v_add_f32 v42, v42, v46
    v_add_f32 v43, v43, v47
    v_permlane32_swap_b32 v40, v41
    s_nop 0
    v_permlane32_swap_b32 v42, v43
    v_add_f32 v40, v40, v41
    v_add_f32 v42, v42, v43
    s_nop 1
    v_permlane16_swap_b32 v40, v42
    v_add_f32 v40, v40, v42
    s_nop 1
    v_add_f32_dpp v40, v40, v40 row_ror:8 row_mask:0xf bank_mask:0xf
    v_cvt_pk_bf16_f32 v40, v40, v40
    ds_write_b16 v66, v40 offset:24576
    s_waitcnt lgkmcnt(0)
    s_barrier
    s_setprio 0
    s_mov_b64 exec, 3
    global_load_dword v27, v91, s[66:67]
    s_mov_b64 exec, -1
    s_lshl_b32 s78, s97, 18
    s_lshl_b32 s79, s62, 16
    s_add_u32 s78, s78, s79
    s_lshl_b32 s79, s98, 7
    s_add_u32 s78, s78, s79
    s_lshl_b32 s79, s62, 12
    s_add_u32 m0, s79, 0
    s_nop 0
    buffer_load_dwordx4 v78, s[28:31], s78 offen offset:0 lds
    s_add_u32 s78, s78, 15360
    buffer_load_dwordx4 v79, s[28:31], s78 offen offset:1024 lds
    s_add_u32 s78, s78, 15360
    buffer_load_dwordx4 v78, s[28:31], s78 offen offset:2048 lds
    s_add_u32 s78, s78, 15360
    buffer_load_dwordx4 v79, s[28:31], s78 offen offset:3072 lds
    s_mov_b32 s56, s14
    s_and_b32 s57, s15, 0xffff
    s_mov_b32 s58, 2048
    s_mov_b32 s59, 0x20000
    s_lshl_b32 s78, s62, 9
    s_add_u32 m0, s78, 16384
    s_mov_b32 exec_hi, 0
    buffer_load_dwordx4 v12, s[56:59], s78 offen lds
    s_mov_b64 exec, -1
    s_barrier
    s_lshl4_add_u32 s76, s97, s98
    s_mul_i32 s76, s76, 28800
    s_add_u32 s20, s26, s76
    s_addc_u32 s21, s27, 0
    s_cmp_eq_u32 s62, 0
    s_cbranch_scc0 L_now0_25
    s_load_dwordx16 s[4:19], s[20:21], 3584 glc
    s_waitcnt lgkmcnt(0)
    s_and_b64 s[4:5], s[4:5], s[6:7]
    s_and_b64 s[4:5], s[4:5], s[8:9]
    s_and_b64 s[4:5], s[4:5], s[10:11]
    s_and_b64 s[4:5], s[4:5], s[12:13]
    s_and_b64 s[4:5], s[4:5], s[14:15]
    s_and_b64 s[4:5], s[4:5], s[16:17]
    s_and_b64 s[4:5], s[4:5], s[18:19]
    s_nand_b32 s4, s4, s5
    s_and_b32 s4, s4, 0xffff
    s_mul_i32 s4, s4, 0x10001
    s_lshr_b32 s4, s4, s65
    s_and_b32 s77, s4, 0xffff
    v_mov_b32_e64 v69, s77
    s_mov_b64 exec, 1
    ds_or_b32 v70, v69 offset:25984
    s_mov_b64 exec, -1
    s_waitcnt vmcnt(0) lgkmcnt(0)
    s_load_dwordx16 s[4:19], s[20:21], 3584 glc
    s_barrier
    s_mov_b32 s88, 0
    s_branch L_fo2
L_now0_25:
    s_waitcnt vmcnt(0) lgkmcnt(0)
    s_barrier
    s_cmp_eq_u32 s62, 0
    s_cbranch_scc0 L_now1_23
    s_mov_b32 s88, 0
L_spin_26:
    s_load_dwordx16 s[4:19], s[20:21], 3584 glc
L_fo2:
    s_waitcnt lgkmcnt(0)
    s_and_b64 s[4:5], s[4:5], s[6:7]
    s_and_b64 s[4:5], s[4:5], s[8:9]
    s_and_b64 s[4:5], s[4:5], s[10:11]
    s_and_b64 s[4:5], s[4:5], s[12:13]
    s_and_b64 s[4:5], s[4:5], s[14:15]
    s_and_b64 s[4:5], s[4:5], s[16:17]
    s_and_b64 s[4:5], s[4:5], s[18:19]
    s_nand_b32 s4, s4, s5
    s_and_b32 s4, s4, 0xffff
    s_mul_i32 s4, s4, 0x10001
    s_lshr_b32 s4, s4, s65
    s_and_b32 s77, s4, 0xffff
    v_mov_b32 v69, s77
    s_mov_b64 exec, 1
    ds_or_b32 v70, v69 offset:25984
    s_mov_b64 exec, -1
    s_cmp_eq_u32 s77, 0xffff
    s_cbranch_scc1 L_s2done_24
    s_add_u32 s88, s88, 1
    s_cmp_lt_u32 s88, 65536
    s_cbranch_scc1 L_spin_26
    s_branch L_s2done_24
L_now1_23:
    s_cmp_eq_u32 s62, 1
    s_cbranch_scc0 L_s2done_24
    s_lshl_b32 s77, 1, s61
    s_not_b32 s77, s77
    v_mov_b32 v4, s77
    v_mul_u32_u24 v5, 28800, v1
    s_mul_i32 s76, s60, 460800
    s_lshl2_add_u32 s76, s61, s76
    s_mov_b32 s88, 0
L_spin_27:
    ds_read_b32 v69, v70 offset:25988
    s_waitcnt lgkmcnt(0)
    v_cmp_eq_u32_e64 vcc, 4, v69
    s_nop 0
    s_cbranch_vccnz L_drained_28
    s_add_u32 s88, s88, 1
    s_cmp_lt_u32 s88, 1048576
    s_cbranch_scc1 L_spin_27
L_drained_28:
    s_mov_b64 exec, 0xffff
    buffer_store_dword v4, v5, s[40:43], s76 offen offset:3584 sc1
    s_mov_b64 exec, -1
L_s2done_24:
    s_waitcnt vmcnt(0)
    v_lshlrev_b32 v17, 5, v2
    v_lshl_add_u32 v17, v3, 4, v17
    v_and_b32 v4, 15, v1
    v_lshrrev_b32 v5, 1, v4
    v_and_b32 v4, 1, v4
    v_lshlrev_b32 v4, 5, v4
    v_lshl_add_u32 v16, v5, 7, v4
    v_lshrrev_b32 v4, 3, v1
    v_and_b32 v5, 7, v1
    v_lshlrev_b32_e64 v5, 4, v5
    v_mul_u32_u24 v18, 9344, v4
    v_add_u32_e64 v18, v18, v5
    v_bfe_u32 v6, v1, 4, 1
    v_lshl_add_u32 v6, v6, 1, v3
    v_lshl_add_u32 v19, v6, 2, v5
    s_mul_i32 s84, s97, 149504
    s_lshl_b32 s77, s98, 7
    s_add_u32 s84, s84, s77
    s_add_u32 s84, s84, 8388608
    s_lshl_b32 s85, s62, 10
    s_add_u32 s85, s85, s99
    s_add_u32 s85, s85, 5120
    s_and_b32 s87, s97, 1
    s_lshl_b32 s87, s87, 4
    s_add_u32 s87, s87, s98
    s_lshr_b32 s86, s97, 1
    s_mul_i32 s86, s86, 299008
    s_lshl_b32 s77, s87, 7
    s_add_u32 s86, s86, s77
    s_add_u32 s86, s86, 8393728
    s_lshl_b32 s78, s62, 11
    s_add_u32 s79, s78, s99
    s_bitcmp1_b32 s100, 1
    s_cbranch_scc1 L_loc_29
    buffer_store_dwordx4 v[28:31], v12, s[40:43], s79 offen offset:1024 sc1
    buffer_store_dwordx4 v[28:31], v12, s[40:43], s79 offen offset:2048 sc1
    s_branch L_pubd_30
L_loc_29:
    buffer_store_dwordx4 v[28:31], v12, s[40:43], s79 offen offset:1024
    buffer_store_dwordx4 v[28:31], v12, s[40:43], s79 offen offset:2048
L_pubd_30:
    s_lshl4_add_u32 s78, s97, s98
    s_lshl4_add_u32 s78, s78, s62
    s_add_u32 s78, s78, 12591116
    s_waitcnt vmcnt(0)
    s_mov_b64 exec, 1
    s_bitcmp1_b32 s100, 1
    s_cbranch_scc1 L_loc_31
    buffer_store_byte v28, v70, s[40:43], s78 offen sc1
    s_branch L_pubd_32
L_loc_31:
    buffer_store_byte v28, v70, s[40:43], s78 offen
L_pubd_32:
    s_mov_b64 exec, -1
    s_cmp_eq_u32 s62, 0
    s_cbranch_scc0 L_nop3c_33
    s_mov_b32 exec_lo, 0
    s_mov_b32 s88, 0
L_spin_34:
    buffer_load_dword v4, v90, s[40:43], 0 offen offset:12 sc1
    s_waitcnt vmcnt(0)
    v_cmp_ne_u32 vcc, -1, v4
    s_nop 0
    s_cbranch_vccz L_p3ok_35
    s_add_u32 s88, s88, 1
    s_cmp_lt_u32 s88, 65536
    s_cbranch_scc1 L_spin_34
L_p3ok_35:
    s_mov_b64 exec, -1
L_nop3c_33:
    s_barrier
    buffer_load_dwordx4 v[156:159], v76, s[48:51], s75 offen nt
    s_add_u32 s75, s75, 7168
    buffer_load_dwordx4 v[32:35], v77, s[52:55], s96 offen nt
    s_add_u32 s96, s96, 4096
    buffer_load_dwordx4 v[36:39], v77, s[52:55], s96 offen nt
    s_add_u32 s96, s96, 4096
    buffer_load_dwordx4 v[40:43], v77, s[52:55], s96 offen nt
    s_add_u32 s96, s96, 4096
    buffer_load_dwordx4 v[44:47], v77, s[52:55], s96 offen nt
    s_add_u32 s96, s96, 4096
    buffer_load_dwordx4 v[48:51], v77, s[52:55], s96 offen nt
    s_add_u32 s96, s96, 4096
    v_mul_u32_u24 v20, 149504, v1
    s_mul_i32 s72, s98, 9344
    s_lshl2_add_u32 s72, s97, s72
    s_add_u32 s72, s72, 8388608
    s_barrier
    s_cmp_eq_u32 s62, 1
    s_cbranch_scc0 L_nopre_36
    s_mov_b64 exec, 0xffff
    buffer_store_dword v70, v20, s[40:43], s72 offen offset:768 sc1
    s_mov_b64 exec, -1
L_nopre_36:
    buffer_load_dwordx4 v[52:55], v77, s[52:55], s96 offen nt
    s_add_u32 s96, s96, 4096
    buffer_load_dwordx4 v[56:59], v77, s[52:55], s96 offen nt
    s_add_u32 s96, s96, 4096
    buffer_load_dwordx4 v[60:63], v77, s[52:55], s96 offen nt
    s_add_u32 s96, s96, 4096
    s_barrier
    s_waitcnt vmcnt(8)
    s_mov_b32 s78, 0x05040100
    s_mov_b32 s79, 0x07060302
    v_perm_b32 v160, v100, v96, s78
    v_perm_b32 v164, v100, v96, s79
    v_perm_b32 v168, v101, v97, s78
    v_perm_b32 v172, v101, v97, s79
    v_perm_b32 v176, v102, v98, s78
    v_perm_b32 v180, v102, v98, s79
    v_perm_b32 v184, v103, v99, s78
    v_perm_b32 v188, v103, v99, s79
    v_perm_b32 v161, v108, v104, s78
    v_perm_b32 v165, v108, v104, s79
    v_perm_b32 v169, v109, v105, s78
    v_perm_b32 v173, v109, v105, s79
    v_perm_b32 v177, v110, v106, s78
    v_perm_b32 v181, v110, v106, s79
    v_perm_b32 v185, v111, v107, s78
    v_perm_b32 v189, v111, v107, s79
    v_perm_b32 v162, v116, v112, s78
    v_perm_b32 v166, v116, v112, s79
    v_perm_b32 v170, v117, v113, s78
    v_perm_b32 v174, v117, v113, s79
    v_perm_b32 v178, v118, v114, s78
    v_perm_b32 v182, v118, v114, s79
    v_perm_b32 v186, v119, v115, s78
    v_perm_b32 v190, v119, v115, s79
    v_perm_b32 v163, v124, v120, s78
    v_perm_b32 v167, v124, v120, s79
    v_perm_b32 v171, v125, v121, s78
    v_perm_b32 v175, v125, v121, s79
    v_perm_b32 v179, v126, v122, s78
    v_perm_b32 v183, v126, v122, s79
    v_perm_b32 v187, v127, v123, s78
    v_perm_b32 v191, v127, v123, s79
    v_perm_b32 v192, v132, v128, s78
    v_perm_b32 v196, v132, v128, s79
    v_perm_b32 v200, v133, v129, s78
    v_perm_b32 v204, v133, v129, s79
    v_perm_b32 v208, v134, v130, s78
    v_perm_b32 v212, v134, v130, s79
    v_perm_b32 v216, v135, v131, s78
    v_perm_b32 v220, v135, v131, s79
    v_perm_b32 v193, v140, v136, s78
    v_perm_b32 v197, v140, v136, s79
    v_perm_b32 v201, v141, v137, s78
    v_perm_b32 v205, v141, v137, s79
    v_perm_b32 v209, v142, v138, s78
    v_perm_b32 v213, v142, v138, s79
    v_perm_b32 v217, v143, v139, s78
    v_perm_b32 v221, v143, v139, s79
    v_perm_b32 v194, v148, v144, s78
    v_perm_b32 v198, v148, v144, s79
    v_perm_b32 v202, v149, v145, s78
    v_perm_b32 v206, v149, v145, s79
    v_perm_b32 v210, v150, v146, s78
    v_perm_b32 v214, v150, v146, s79
    v_perm_b32 v218, v151, v147, s78
    v_perm_b32 v222, v151, v147, s79
    v_perm_b32 v195, v156, v152, s78
    v_perm_b32 v199, v156, v152, s79
    v_perm_b32 v203, v157, v153, s78
    v_perm_b32 v207, v157, v153, s79
    v_perm_b32 v211, v158, v154, s78
    v_perm_b32 v215, v158, v154, s79
    v_perm_b32 v219, v159, v155, s78
    v_perm_b32 v223, v159, v155, s79
    s_waitcnt vmcnt(6)
    s_mov_b32 s78, 0x05040100
    s_mov_b32 s79, 0x07060302
    v_permlane32_swap_b32 v32, v34
    v_permlane32_swap_b32 v33, v35
    v_permlane32_swap_b32 v36, v38
    v_permlane32_swap_b32_e64 v37, v39
    v_perm_b32 v224, v34, v32, s78
    v_perm_b32 v225, v34, v32, s79
    v_perm_b32 v226, v35, v33, s78
    v_perm_b32 v227, v35, v33, s79
    v_perm_b32 v228, v38, v36, s78
    v_perm_b32 v229, v38, v36, s79
    v_perm_b32 v230, v39, v37, s78
    v_perm_b32 v231, v39, v37, s79
    s_waitcnt vmcnt(4)
    s_mov_b32 s78, 0x05040100
    s_mov_b32 s79, 0x07060302
    v_permlane32_swap_b32 v40, v42
    v_permlane32_swap_b32 v41, v43
    v_permlane32_swap_b32 v44, v46
    v_permlane32_swap_b32_e64 v45, v47
    v_perm_b32 v232, v42, v40, s78
    v_perm_b32 v233, v42, v40, s79
    v_perm_b32 v234, v43, v41, s78
    v_perm_b32 v235, v43, v41, s79
    v_perm_b32 v236, v46, v44, s78
    v_perm_b32 v237, v46, v44, s79
    v_perm_b32 v238, v47, v45, s78
    v_perm_b32 v239, v47, v45, s79
    s_waitcnt vmcnt(2)
    s_mov_b32 s78, 0x05040100
    s_mov_b32 s79, 0x07060302
    v_permlane32_swap_b32 v48, v50
    v_permlane32_swap_b32 v49, v51
    v_permlane32_swap_b32 v52, v54
    v_permlane32_swap_b32_e64 v53, v55
    v_perm_b32 v240, v50, v48, s78
    v_perm_b32 v241, v50, v48, s79
    v_perm_b32 v242, v51, v49, s78
    v_perm_b32 v243, v51, v49, s79
    v_perm_b32 v244, v54, v52, s78
    v_perm_b32 v245, v54, v52, s79
    v_perm_b32 v246, v55, v53, s78
    v_perm_b32 v247, v55, v53, s79
    s_waitcnt vmcnt(0)
    s_mov_b32 s78, 0x05040100
    s_mov_b32 s79, 0x07060302
    v_permlane32_swap_b32 v56, v58
    v_permlane32_swap_b32 v57, v59
    v_permlane32_swap_b32 v60, v62
    v_permlane32_swap_b32_e64 v61, v63
    v_perm_b32 v248, v58, v56, s78
    v_perm_b32 v249, v58, v56, s79
    v_perm_b32 v250, v59, v57, s78
    v_perm_b32 v251, v59, v57, s79
    v_perm_b32 v252, v62, v60, s78
    v_perm_b32 v253, v62, v60, s79
    v_perm_b32 v254, v63, v61, s78
    v_perm_b32 v255, v63, v61, s79
    v_and_b32 v5, 15, v1
    v_lshlrev_b32 v5, 3, v5
    s_lshl_b32 s76, s63, 10
    s_lshl_b32 s77, s64, 6
    s_add_u32 s76, s76, s77
    s_add_u32 s76, s76, s99
    s_mov_b64 s[80:81], 0xffff
    s_add_u32 s68, s84, 74752
    s_add_u32 s69, s86, 74752
    s_add_u32 s70, s86, 149504
    s_add_u32 s71, s86, 224256
    s_setprio 3
    s_barrier
    ds_read_b128 v[64:67], v12 offset:28672
    ds_read_b128 v[68:71], v12 offset:29696
    ds_read_b64 v[8:9], v5 offset:25728
    s_waitcnt lgkmcnt(2)
    v_mfma_f32_16x16x32_bf16 v[96:99], v[64:67], v[160:163], 0
    v_mfma_f32_16x16x32_bf16 v[100:103], v[64:67], v[164:167], 0
    s_waitcnt lgkmcnt(0)
    v_max_f32_dpp v4, v8, v8 row_ror:8 row_mask:0xf bank_mask:0xf
    v_mfma_f32_16x16x32_bf16 v[104:107], v[64:67], v[168:171], 0
    v_mfma_f32_16x16x32_bf16 v[108:111], v[64:67], v[172:175], 0
    v_max_f32_dpp v4, v4, v4 row_ror:4 row_mask:0xf bank_mask:0xf
    v_mfma_f32_16x16x32_bf16 v[112:115], v[64:67], v[176:179], 0
    v_mfma_f32_16x16x32_bf16 v[116:119], v[64:67], v[180:183], 0
    v_max_f32_dpp v4, v4, v4 row_ror:2 row_mask:0xf bank_mask:0xf
    v_mfma_f32_16x16x32_bf16 v[120:123], v[64:67], v[184:187], 0
    v_mfma_f32_16x16x32_bf16 v[124:127], v[64:67], v[188:191], 0
    v_max_f32_dpp v4, v4, v4 row_ror:1 row_mask:0xf bank_mask:0xf
    v_mfma_f32_16x16x32_bf16 v[96:99], v[68:71], v[192:195], v[96:99]
    v_cmp_eq_f32_e64 vcc, v4, v8
    v_mfma_f32_16x16x32_bf16 v[100:103], v[68:71], v[196:199], v[100:103]
    s_ff1_i32_b32 s92, vcc_lo
    s_and_b32 s92, s92, 15
    v_mfma_f32_16x16x32_bf16 v[104:107], v[68:71], v[200:203], v[104:107]
    s_lshr_b32 s78, s92, 2
    s_lshl_b32 s78, s78, 4
    v_mfma_f32_16x16x32_bf16 v[108:111], v[68:71], v[204:207], v[108:111]
    s_and_b32 s77, s92, 3
    v_mfma_f32_16x16x32_bf16 v[112:115], v[68:71], v[208:211], v[112:115]
    v_readlane_b32 s91, v9, s92
    v_readlane_b32 s93, v8, s92
    v_mfma_f32_16x16x32_bf16 v[116:119], v[68:71], v[212:215], v[116:119]
    v_mfma_f32_16x16x32_bf16 v[120:123], v[68:71], v[216:219], v[120:123]
    v_mfma_f32_16x16x32_bf16 v[124:127], v[68:71], v[220:223], v[124:127]
    s_cmp_ge_u32 s97, 14
    s_cbranch_scc1 L_final
    s_cmp_eq_u32 s77, 0
    s_cbranch_scc0 L_sel_38
    v_mov_b32 v64, v96
    v_mov_b32 v65, v100
    v_mov_b32 v66, v104
    v_mov_b32 v67, v108
    v_mov_b32 v68, v112
    v_mov_b32 v69, v116
    v_mov_b32 v70, v120
    v_mov_b32 v71, v124
    s_branch L_seldone_37
L_sel_38:
    s_cmp_eq_u32 s77, 1
    s_cbranch_scc0 L_sel_39
    v_mov_b32 v64, v97
    v_mov_b32 v65, v101
    v_mov_b32 v66, v105
    v_mov_b32 v67, v109
    v_mov_b32 v68, v113
    v_mov_b32 v69, v117
    v_mov_b32 v70, v121
    v_mov_b32 v71, v125
    s_branch L_seldone_37
L_sel_39:
    s_cmp_eq_u32 s77, 2
    s_cbranch_scc0 L_sel_40
    v_mov_b32 v64, v98
    v_mov_b32 v65, v102
    v_mov_b32 v66, v106
    v_mov_b32 v67, v110
    v_mov_b32 v68, v114
    v_mov_b32 v69, v118
    v_mov_b32 v70, v122
    v_mov_b32 v71, v126
    s_branch L_seldone_37
L_sel_40:
    v_mov_b32 v64, v99
    v_mov_b32 v65, v103
    v_mov_b32 v66, v107
    v_mov_b32 v67, v111
    v_mov_b32 v68, v115
    v_mov_b32 v69, v119
    v_mov_b32 v70, v123
    v_mov_b32_e64 v71, v127
L_seldone_37:
    s_lshl_b64 exec, s[80:81], s78
    s_bitcmp1_b32 s100, 1
    s_cbranch_scc1 L_loc_42
    buffer_store_dwordx4 v[64:67], v16, s[40:43], s76 offen offset:3072 sc1
    buffer_store_dwordx4 v[68:71], v16, s[40:43], s76 offen offset:3088 sc1
    s_branch L_pubd_43
L_loc_42:
    buffer_store_dwordx4 v[64:67], v16, s[40:43], s76 offen offset:3072
    buffer_store_dwordx4 v[68:71], v16, s[40:43], s76 offen offset:3088
L_pubd_43:
    s_mov_b64 exec, -1
    s_mov_b32 s88, 0
L_poll_44:
    buffer_load_dwordx4 v[128:131], v18, s[40:43], s84 offen offset:3072 sc1
    buffer_load_dwordx4 v[132:135], v18, s[40:43], s68 offen offset:3072 sc1
    s_waitcnt vmcnt(0)
    v_max_u32 v4, v128, v132
    v_cmp_eq_u32_e64 vcc, -1, v4
    s_nop 0
    s_cbranch_vccz L_ok_45
    s_add_u32 s88, s88, 1
    s_cmp_lt_u32 s88, 65536
    s_cbranch_scc1 L_poll_44
L_ok_45:
    v_pk_add_f32 v[48:49], v[128:129], v[132:133]
    v_pk_add_f32 v[50:51], v[130:131], v[134:135]
    s_nop 0
    v_permlane32_swap_b32 v48, v49
    v_permlane32_swap_b32 v50, v51
    v_add_f32 v48, v48, v49
    v_add_f32 v50, v50, v51
    s_nop 1
    v_permlane16_swap_b32 v48, v50
    v_add_f32 v48, v48, v50
    s_nop 1
    v_add_f32_dpp v48, v48, v48 row_ror:8 row_mask:0xf bank_mask:0xf
    v_cvt_pk_bf16_f32 v48, v48, v48
    v_and_b32_e64 v48, s90, v48
    v_mul_f32 v4, 0xbfb8aa3b, v48
    v_exp_f32_e64 v4, v4
    v_mov_b32_dpp v49, v48 row_ror:12 row_mask:0xf bank_mask:0xf
    v_add_f32 v4, 1.0, v4
    v_rcp_f32 v4, v4
    s_nop 0
    v_mul_f32 v4, v4, v48
    v_cvt_pk_bf16_f32 v4, v4, v4
    v_and_b32 v4, s90, v4
    v_mul_f32 v4, v4, v49
    v_mov_b32 v5, v4
    s_nop 1
    v_permlane32_swap_b32_e64 v4, v5
    v_cvt_pk_bf16_f32 v4, v4, v5
    s_nop 0
    v_readlane_b32 s76, v4, 0
    v_readlane_b32 s77, v4, 16
    v_readlane_b32 s78, v4, 1
    v_readlane_b32 s79, v4, 17
    v_readlane_b32 s80, v4, 2
    v_readlane_b32 s81, v4, 18
    v_readlane_b32 s82, v4, 3
    v_readlane_b32 s83, v4, 19
    v_dot2_f32_bf16 v40, v224, s76, 0
    v_dot2_f32_bf16 v41, v225, s76, 0
    v_dot2_f32_bf16 v42, v226, s76, 0
    v_dot2_f32_bf16 v43, v227, s76, 0
    v_dot2_f32_bf16 v40, v228, s77, v40
    v_dot2_f32_bf16 v41, v229, s77, v41
    v_dot2_f32_bf16 v42, v230, s77, v42
    v_dot2_f32_bf16 v43, v231, s77, v43
    v_dot2_f32_bf16 v40, v232, s78, v40
    v_dot2_f32_bf16 v41, v233, s78, v41
    v_dot2_f32_bf16 v42, v234, s78, v42
    v_dot2_f32_bf16 v43, v235, s78, v43
    v_dot2_f32_bf16 v40, v236, s79, v40
    v_dot2_f32_bf16 v41, v237, s79, v41
    v_dot2_f32_bf16 v42, v238, s79, v42
    v_dot2_f32_bf16 v43, v239, s79, v43
    v_dot2_f32_bf16 v40, v240, s80, v40
    v_dot2_f32_bf16 v41, v241, s80, v41
    v_dot2_f32_bf16 v42, v242, s80, v42
    v_dot2_f32_bf16 v43, v243, s80, v43
    v_dot2_f32_bf16 v40, v244, s81, v40
    v_dot2_f32_bf16 v41, v245, s81, v41
    v_dot2_f32_bf16 v42, v246, s81, v42
    v_dot2_f32_bf16 v43, v247, s81, v43
    v_dot2_f32_bf16 v40, v248, s82, v40
    v_dot2_f32_bf16 v41, v249, s82, v41
    v_dot2_f32_bf16 v42, v250, s82, v42
    v_dot2_f32_bf16 v43, v251, s82, v43
    v_dot2_f32_bf16 v40, v252, s83, v40
    v_dot2_f32_bf16 v41, v253, s83, v41
    v_dot2_f32_bf16 v42, v254, s83, v42
    v_dot2_f32_bf16 v43, v255, s83, v43
    s_bitcmp1_b32 s100, 1
    s_cbranch_scc1 L_loc_46
    s_nop 0
    buffer_store_dwordx4 v[40:43], v17, s[40:43], s85 offen sc1
    s_branch L_pubd_47
L_loc_46:
    s_nop 0
    buffer_store_dwordx4 v[40:43], v17, s[40:43], s85 offen
L_pubd_47:
    s_cmp_eq_u32 s62, 0
    s_cbranch_scc0 L_hby
    s_mov_b32 s88, 0
L_poll_48:
    buffer_load_dwordx4 v[136:139], v18, s[40:43], s86 offen sc1
    buffer_load_dwordx4 v[140:143], v18, s[40:43], s69 offen sc1
    buffer_load_dwordx4 v[144:147], v18, s[40:43], s70 offen sc1
    buffer_load_dwordx4 v[148:151], v18, s[40:43], s71 offen sc1
    s_waitcnt vmcnt(0)
    v_max3_u32 v4, v136, v140, v144
    v_max_u32 v4, v4, v148
    v_cmp_eq_u32_e64 vcc, -1, v4
    s_nop 0
    s_cbranch_vccz L_ok_49
    s_add_u32 s88, s88, 1
    s_cmp_lt_u32 s88, 65536
    s_cbranch_scc1 L_poll_48
L_ok_49:
    v_pk_add_f32 v[48:49], v[136:137], v[144:145]
    v_pk_add_f32 v[50:51], v[138:139], v[146:147]
    v_pk_add_f32 v[52:53], v[140:141], v[148:149]
    v_pk_add_f32 v[54:55], v[142:143], v[150:151]
    v_pk_add_f32 v[48:49], v[48:49], v[52:53]
    v_pk_add_f32 v[50:51], v[50:51], v[54:55]
    s_nop 0
    v_permlane32_swap_b32 v48, v49
    v_permlane32_swap_b32 v50, v51
    v_add_f32 v48, v48, v49
    v_add_f32 v50, v50, v51
    s_nop 1
    v_permlane16_swap_b32 v48, v50
    v_add_f32 v48, v48, v50
    s_nop 1
    v_add_f32_dpp v48, v48, v48 row_ror:8 row_mask:0xf bank_mask:0xf
    buffer_store_dword v48, v19, s[40:43], s99 offen offset:512 sc1
L_hby:
    s_barrier
    s_lshl2_add_u32 s72, s87, s62
    s_cmp_eq_u32 s72, 0
    s_cbranch_scc0 L_nowb_50
    s_waitcnt vmcnt(0)
    buffer_wbl2 sc1
L_nowb_50:
    s_branch L_hfin
L_final:
    s_barrier
    s_lshl2_add_u32 s72, s87, s62
    s_cmp_eq_u32 s72, 3
    s_cbranch_scc0 L_nowb_51
    s_waitcnt vmcnt(0)
    buffer_wbl2 sc1
L_nowb_51:
    s_cmp_eq_u32 s62, 1
    s_cbranch_scc0 L_noep_52
    s_cmp_eq_u32 s87, 0
    s_cbranch_scc0 L_noep_52
    v_mov_b32 v4, 13631488
    s_mov_b64 exec, 1
    buffer_store_dwordx2 v[88:89], v4, s[40:43], 0 offen sc1
    s_mov_b64 exec, -1
L_noep_52:
    s_cmp_eq_u32 s62, 0
    s_cbranch_scc0 L_hfin
    v_mov_b32 v8, s93
    v_cvt_pk_bf16_f32 v8, v8, v8
    v_and_b32_e64 v8, s90, v8
    v_mul_f32 v8, 0xbfb8aa3b, v8
    v_exp_f32 v8, v8
    s_nop 0
    v_add_f32 v8, 1.0, v8
    v_rcp_f32_e64 v8, v8
    s_nop 0
    v_cvt_pk_bf16_f32 v8, v8, v8
    v_and_b32 v8, s90, v8
    s_lshl_b32 s76, s92, 4
    s_lshr_b32 s77, s87, 1
    s_add_u32 s76, s76, s77
    s_mul_i32 s76, s76, 9344
    s_add_u32 s76, s76, 8388608
    s_and_b32 s77, s87, 1
    s_lshl_b32 s77, s77, 5
    s_add_u32 s76, s76, s77
    v_and_b32 v10, 1, v1
    v_lshlrev_b32_e64 v10, 6, v10
    v_bfe_u32 v4, v1, 1, 2
    v_lshl_add_u32 v10, v4, 3, v10
    v_bfe_u32 v4, v1, 4, 1
    v_lshl_add_u32 v10, v4, 2, v10
    v_lshrrev_b32_e64 v4, 3, v1
    v_mul_u32_u24 v6, 299008, v4
    v_and_b32_e64 v5, 7, v1
    v_lshl_add_u32 v6, v5, 4, v6
    v_mov_b32 v7, 2146435072
    v_cmp_gt_u32 vcc, 56, v1
    s_nop 1
    v_cndmask_b32_e64 v6, v7, v6, vcc
    s_mul_i32 s79, s87, 9344
    s_add_u32 s79, s79, 8388608
    s_lshl_b32 s80, s91, 11
    s_lshl_b32 s77, s87, 6
    s_add_u32 s80, s80, s77
    s_mov_b32 s88, 0
L_spin_53:
    buffer_load_dword v64, v10, s[40:43], s76 offen offset:0 sc1
    buffer_load_dword v65, v10, s[40:43], s76 offen offset:128 sc1
    s_waitcnt vmcnt(0)
    v_max_u32 v4, v64, v65
    v_cmp_eq_u32 vcc, -1, v4
    s_nop 0
    s_cbranch_vccz L_ok_54
    s_add_u32 s88, s88, 1
    s_cmp_lt_u32 s88, 65536
    s_cbranch_scc1 L_spin_53
L_ok_54:
    v_lshlrev_b32 v4, 4, v3
    v_lshrrev_b32 v64, v4, v64
    v_lshrrev_b32 v65, v4, v65
    v_lshlrev_b32 v64, 16, v64
    v_lshlrev_b32 v65, 16, v65
    v_lshrrev_b32 v9, 1, v19
    s_mov_b32 s88, 0
    buffer_load_dwordx4 v[128:131], v6, s[40:43], s79 offen offset:512 sc1
    buffer_load_dwordx4 v[128:131], v6, s[40:43], s79 offen offset:512 sc1
L_poll_55:
    buffer_load_dwordx4 v[128:131], v6, s[40:43], s79 offen offset:512 sc1
    s_waitcnt vmcnt(2)
    v_max3_u32 v4, v128, v129, v130
    v_max_u32 v4, v4, v131
    v_cmp_eq_u32 vcc, -1, v4
    s_nop 0
    s_cbranch_vccz L_ok_56
    s_add_u32 s88, s88, 1
    s_cmp_lt_u32 s88, 65536
    s_cbranch_scc1 L_poll_55
L_ok_56:
    v_mov_b32 v48, v128
    v_mov_b32 v49, v129
    v_mov_b32 v50, v130
    v_mov_b32 v51, v131
    v_permlane32_swap_b32 v48, v49
    s_nop 0
    v_permlane32_swap_b32 v50, v51
    v_add_f32 v48, v48, v49
    v_add_f32 v50, v50, v51
    s_nop 1
    v_permlane16_swap_b32 v48, v50
    v_add_f32 v48, v48, v50
    s_nop 1
    v_add_f32_dpp v48, v48, v48 row_ror:8 row_mask:0xf bank_mask:0xf
    v_cvt_pk_bf16_f32 v48, v48, v48
    v_and_b32 v48, s90, v48
    v_mul_f32 v48, v48, v8
    v_cvt_pk_bf16_f32 v48, v48, v48
    v_and_b32 v48, s90, v48
    v_add_f32 v48, v48, v64
    v_cvt_pk_bf16_f32 v48, v48, v48
    v_and_b32 v48, s90, v48
    v_add_f32 v48, v48, v65
    v_cvt_pk_bf16_f32 v48, v48, v48
    s_mov_b32 exec_lo, 0x00ff00ff
    s_mov_b32 exec_hi, 0x00ff00ff
    buffer_store_short v48, v9, s[44:47], s80 offen sc1
    s_mov_b64 exec, -1
L_hfin:
    s_endpgm
L_event:
    s_cmp_eq_u32 s77, 3
    s_cbranch_scc0 L_ev1
    buffer_load_dwordx4 v[92:95], v90, s[40:43], 0 offen sc1
    s_mov_b64 exec, 3
    global_load_dword v27, v91, s[66:67]
    s_mov_b64 exec, -1
    s_branch L_evret
L_ev1:
    s_cmp_eq_u32 s77, 5
    s_cbranch_scc0 L_ev_57
    s_and_b32 s72, s84, 15
    s_mov_b32 m0, s70
    s_lshl_b32 s71, s72, 7
    buffer_load_dwordx4 v16, s[28:31], s71 offen offset:0 lds
    s_mul_i32 s72, s72, 393216
    s_lshr_b64 s[84:85], s[84:85], 4
    buffer_load_dwordx4 v17, s[28:31], s71 offen offset:1024 lds
    buffer_load_dwordx4 v18, s[28:31], s71 offen offset:2048 lds
    buffer_load_dwordx4 v19, s[28:31], s71 offen offset:3072 lds
    s_add_u32 m0, s70, 4096
    s_nop 0
    buffer_load_dwordx4 v20, s[32:35], s72 offen offset:0 lds
    buffer_load_dwordx4 v21, s[32:35], s72 offen offset:1024 lds
    buffer_load_dwordx4 v22, s[32:35], s72 offen offset:2048 lds
    buffer_load_dwordx4 v23, s[32:35], s72 offen offset:3072 lds
    s_add_u32 m0, s70, 8192
    s_nop 0
    buffer_load_dwordx4 v24, s[32:35], s72 offen offset:0 lds
    buffer_load_dwordx4 v25, s[32:35], s72 offen offset:1024 lds
    s_add_u32 s70, s70, 40960
    s_cmp_ge_u32 s70, 122880
    s_cselect_b32 s76, 122880, 0
    s_sub_u32 s70, s70, s76
    buffer_load_dwordx4 v[96:99], v76, s[48:51], s75 offen nt
    s_add_u32 s75, s75, 7168
    buffer_load_dwordx4 v[100:103], v76, s[48:51], s75 offen nt
    s_add_u32 s75, s75, 7168
    buffer_load_dwordx4 v[104:107], v76, s[48:51], s75 offen nt
    s_add_u32 s75, s75, 7168
    buffer_load_dwordx4 v[108:111], v76, s[48:51], s75 offen nt
    s_add_u32 s75, s75, 7168
    buffer_load_dwordx4 v[128:131], v76, s[48:51], s75 offen nt
    s_add_u32 s75, s75, 7168
    buffer_load_dwordx4 v[132:135], v76, s[48:51], s75 offen nt
    s_add_u32 s75, s75, 7168
    buffer_load_dwordx4 v[136:139], v76, s[48:51], s75 offen nt
    s_add_u32 s75, s75, 7168
    buffer_load_dwordx4 v[140:143], v76, s[48:51], s75 offen nt
    s_add_u32 s75, s75, 7168
    s_waitcnt vmcnt(18)
    s_branch L_hbar
L_ev_57:
    s_cmp_eq_u32 s77, 6
    s_cbranch_scc0 L_ev_58
    s_and_b32 s72, s84, 15
    s_mov_b32 m0, s70
    s_lshl_b32 s71, s72, 7
    buffer_load_dwordx4 v16, s[28:31], s71 offen offset:0 lds
    s_mul_i32 s72, s72, 393216
    s_lshr_b64 s[84:85], s[84:85], 4
    buffer_load_dwordx4 v17, s[28:31], s71 offen offset:1024 lds
    buffer_load_dwordx4 v18, s[28:31], s71 offen offset:2048 lds
    buffer_load_dwordx4 v19, s[28:31], s71 offen offset:3072 lds
    s_add_u32 m0, s70, 4096
    s_nop 0
    buffer_load_dwordx4 v20, s[32:35], s72 offen offset:0 lds
    buffer_load_dwordx4 v21, s[32:35], s72 offen offset:1024 lds
    buffer_load_dwordx4 v22, s[32:35], s72 offen offset:2048 lds
    buffer_load_dwordx4 v23, s[32:35], s72 offen offset:3072 lds
    s_add_u32 m0, s70, 8192
    s_nop 0
    buffer_load_dwordx4 v24, s[32:35], s72 offen offset:0 lds
    buffer_load_dwordx4 v25, s[32:35], s72 offen offset:1024 lds
    s_add_u32 s70, s70, 40960
    s_cmp_ge_u32 s70, 122880
    s_cselect_b32 s76, 122880, 0
    s_sub_u32 s70, s70, s76
    s_lshr_b32 s78, s2, 3
    s_lshl2_add_u32 s78, s78, s62
    s_lshl_b32 s78, s78, 14
    v_lshlrev_b32_e64 v11, 10, v1
    s_mov_b64 exec, 65535
    buffer_load_dword v27, v11, s[36:39], s78 offen offset:384
    s_mov_b64 exec, -1
    s_lshl_b32 s78, s62, 9
    v_lshl_add_u32 v11, v1, 7, s78
    s_mov_b64 exec, 15
    global_load_dword v27, v11, s[14:15]
    s_mov_b64 exec, -1
    buffer_load_dwordx4 v[112:115], v76, s[48:51], s75 offen nt
    s_add_u32 s75, s75, 7168
    buffer_load_dwordx4 v[116:119], v76, s[48:51], s75 offen nt
    s_add_u32 s75, s75, 7168
    buffer_load_dwordx4 v[120:123], v76, s[48:51], s75 offen nt
    s_add_u32 s75, s75, 7168
    buffer_load_dwordx4 v[124:127], v76, s[48:51], s75 offen nt
    s_add_u32 s75, s75, 7168
    buffer_load_dwordx4 v[144:147], v76, s[48:51], s75 offen nt
    s_add_u32 s75, s75, 7168
    buffer_load_dwordx4 v[148:151], v76, s[48:51], s75 offen nt
    s_add_u32 s75, s75, 7168
    s_waitcnt vmcnt(18)
    s_branch L_hbar
L_ev_58:
    s_add_u32 s78, s70, 40960
    s_cmp_ge_u32 s78, 122880
    s_cselect_b32 s76, 122880, 0
    s_sub_u32 s78, s78, s76
    s_cmp_eq_u32 s77, 2
    s_cbranch_scc1 L_evw
    v_add_u32 v4, s78, v72
    v_xor_b32 v5, 32, v4
    v_xor_b32 v6, 64, v4
    v_xor_b32 v7, 96, v4
    s_and_b32 s72, s84, 15
    s_mov_b32 m0, s70
    s_lshl_b32 s71, s72, 7
    buffer_load_dwordx4 v16, s[28:31], s71 offen offset:0 lds
    s_mul_i32 s72, s72, 393216
    s_lshr_b64 s[84:85], s[84:85], 4
    ds_read_b128 v[32:35], v4
    ds_read_b128 v[36:39], v5
    ds_read_b128 v[40:43], v6
    ds_read_b128 v[44:47], v7
    buffer_load_dwordx4 v17, s[28:31], s71 offen offset:1024 lds
    s_lshl_b32 s79, s62, 8
    s_add_u32 s79, s79, s73
    s_waitcnt lgkmcnt(0)
    v_lshlrev_b32 v8, 16, v32
    v_and_b32 v9, s90, v32
    v_add_f32 v80, v80, v8
    v_add_f32 v82, v82, v9
    v_fmac_f32 v81, v8, v8
    v_fmac_f32 v83, v9, v9
    v_lshlrev_b32 v10, 16, v33
    v_and_b32 v11, s90, v33
    v_add_f32 v80, v80, v10
    v_add_f32 v82, v82, v11
    v_fmac_f32 v81, v10, v10
    v_fmac_f32_e64 v83, v11, v11
    buffer_load_dwordx4 v18, s[28:31], s71 offen offset:2048 lds
    v_lshlrev_b32 v8, 16, v34
    v_and_b32 v9, s90, v34
    v_add_f32 v80, v80, v8
    v_add_f32 v82, v82, v9
    v_fmac_f32 v81, v8, v8
    v_fmac_f32 v83, v9, v9
    v_lshlrev_b32 v10, 16, v35
    v_and_b32 v11, s90, v35
    v_add_f32 v80, v80, v10
    v_add_f32 v82, v82, v11
    v_fmac_f32 v81, v10, v10
    v_fmac_f32 v83, v11, v11
    buffer_load_dwordx4 v19, s[28:31], s71 offen offset:3072 lds
    v_lshlrev_b32 v8, 16, v36
    v_and_b32 v9, s90, v36
    v_add_f32 v80, v80, v8
    v_add_f32 v82, v82, v9
    v_fmac_f32 v81, v8, v8
    v_fmac_f32 v83, v9, v9
    v_lshlrev_b32 v10, 16, v37
    v_and_b32 v11, s90, v37
    v_add_f32 v80, v80, v10
    v_add_f32 v82, v82, v11
    v_fmac_f32 v81, v10, v10
    v_fmac_f32 v83, v11, v11
    s_add_u32 m0, s70, 4096
    s_nop 0
    buffer_load_dwordx4 v20, s[32:35], s72 offen offset:0 lds
    v_lshlrev_b32 v8, 16, v38
    v_and_b32 v9, s90, v38
    v_add_f32 v80, v80, v8
    v_add_f32 v82, v82, v9
    v_fmac_f32 v81, v8, v8
    v_fmac_f32 v83, v9, v9
    v_lshlrev_b32 v10, 16, v39
    v_and_b32 v11, s90, v39
    v_add_f32 v80, v80, v10
    v_add_f32 v82, v82, v11
    v_fmac_f32 v81, v10, v10
    v_fmac_f32_e64 v83, v11, v11
    buffer_load_dwordx4 v21, s[32:35], s72 offen offset:1024 lds
    v_lshlrev_b32 v8, 16, v40
    v_and_b32 v9, s90, v40
    v_add_f32 v80, v80, v8
    v_add_f32 v82, v82, v9
    v_fmac_f32 v81, v8, v8
    v_fmac_f32 v83, v9, v9
    v_lshlrev_b32 v10, 16, v41
    v_and_b32 v11, s90, v41
    v_add_f32 v80, v80, v10
    v_add_f32 v82, v82, v11
    v_fmac_f32 v81, v10, v10
    v_fmac_f32 v83, v11, v11
    buffer_load_dwordx4 v22, s[32:35], s72 offen offset:2048 lds
    v_lshlrev_b32 v8, 16, v42
    v_and_b32 v9, s90, v42
    v_add_f32 v80, v80, v8
    v_add_f32 v82, v82, v9
    v_fmac_f32 v81, v8, v8
    v_fmac_f32 v83, v9, v9
    v_lshlrev_b32 v10, 16, v43
    v_and_b32 v11, s90, v43
    v_add_f32 v80, v80, v10
    v_add_f32 v82, v82, v11
    v_fmac_f32 v81, v10, v10
    v_fmac_f32 v83, v11, v11
    buffer_load_dwordx4 v23, s[32:35], s72 offen offset:3072 lds
    v_lshlrev_b32 v8, 16, v44
    v_and_b32 v9, s90, v44
    v_add_f32 v80, v80, v8
    v_add_f32 v82, v82, v9
    v_fmac_f32 v81, v8, v8
    v_fmac_f32 v83, v9, v9
    v_lshlrev_b32 v10, 16, v45
    v_and_b32 v11, s90, v45
    v_add_f32 v80, v80, v10
    v_add_f32 v82, v82, v11
    v_fmac_f32 v81, v10, v10
    v_fmac_f32 v83, v11, v11
    s_add_u32 m0, s70, 8192
    s_nop 0
    buffer_load_dwordx4 v24, s[32:35], s72 offen offset:0 lds
    v_lshlrev_b32 v8, 16, v46
    v_and_b32 v9, s90, v46
    v_add_f32 v80, v80, v8
    v_add_f32 v82, v82, v9
    v_fmac_f32 v81, v8, v8
    v_fmac_f32 v83, v9, v9
    v_lshlrev_b32 v10, 16, v47
    v_and_b32 v11, s90, v47
    v_add_f32 v80, v80, v10
    v_add_f32 v82, v82, v11
    v_fmac_f32 v81, v10, v10
    v_fmac_f32_e64 v83, v11, v11
    buffer_load_dwordx4 v25, s[32:35], s72 offen offset:1024 lds
    s_add_u32 s70, s70, 40960
    s_cmp_ge_u32 s70, 122880
    s_cselect_b32 s76, 122880, 0
    s_sub_u32 s70, s70, s76
    s_xor_b32 s69, s69, 1
    s_cbranch_scc1 L_hw10
    v_add_f32 v80, v80, v82
    v_add_f32 v81, v81, v83
    v_mov_b32 v82, v80
    v_mov_b32 v83, v81
    s_nop 0
    v_permlane32_swap_b32 v80, v82
    v_permlane32_swap_b32 v81, v83
    v_add_f32 v80, v80, v82
    v_add_f32_e64 v81, v81, v83
    s_mov_b32 exec_hi, 0
    buffer_store_dwordx2 v[80:81], v74, s[40:43], s79 offen offset:0 sc1
    s_mov_b64 exec, -1
    s_waitcnt vmcnt(11)
    s_branch L_hbar
L_evw:
    s_mul_i32 s79, s63, 2048
    s_add_u32 s79, s79, s78
    v_add_u32_e64 v4, s79, v73
    s_mul_i32 s79, s63, 20480
    s_add_u32 s79, s79, s78
    v_add_u32_e64 v5, s79, v73
    s_and_b32 s72, s84, 15
    s_mov_b32 m0, s70
    s_lshl_b32 s71, s72, 7
    buffer_load_dwordx4 v16, s[28:31], s71 offen offset:0 lds
    s_mul_i32 s72, s72, 393216
    s_lshr_b64 s[84:85], s[84:85], 4
    ds_read_b64_tr_b16 v[32:33], v4 offset:0
    ds_read_b64_tr_b16 v[34:35], v4 offset:512
    ds_read_b64_tr_b16 v[36:37], v4 offset:10240
    ds_read_b64_tr_b16 v[38:39], v4 offset:10752
    ds_read_b64_tr_b16 v[40:41], v4 offset:20480
    ds_read_b64_tr_b16 v[42:43], v4 offset:20992
    ds_read_b64_tr_b16 v[44:45], v4 offset:30720
    ds_read_b64_tr_b16 v[46:47], v4 offset:31232
    ds_read_b64_tr_b16 v[48:49], v5 offset:4096
    ds_read_b64_tr_b16 v[50:51], v5 offset:4608
    ds_read_b64_tr_b16 v[52:53], v5 offset:14336
    ds_read_b64_tr_b16 v[54:55], v5 offset:14848
    buffer_load_dwordx4 v17, s[28:31], s71 offen offset:1024 lds
    s_lshl_b32 s79, s64, 9
    s_lshl_b32 s80, s63, 3
    s_add_u32 s79, s79, s80
    s_add_u32 s79, s79, s73
    s_waitcnt lgkmcnt(0)
    v_lshlrev_b32 v8, 16, v32
    v_and_b32 v9, s90, v32
    v_add_f32 v80, v80, v8
    v_add_f32 v82, v82, v9
    v_lshlrev_b32 v10, 16, v33
    v_and_b32 v11, s90, v33
    v_add_f32 v80, v80, v10
    v_add_f32 v82, v82, v11
    v_lshlrev_b32 v8, 16, v34
    v_and_b32 v9, s90, v34
    v_add_f32 v80, v80, v8
    v_add_f32 v82, v82, v9
    buffer_load_dwordx4 v18, s[28:31], s71 offen offset:2048 lds
    v_lshlrev_b32 v10, 16, v35
    v_and_b32 v11, s90, v35
    v_add_f32 v80, v80, v10
    v_add_f32 v82, v82, v11
    v_lshlrev_b32 v8, 16, v36
    v_and_b32 v9, s90, v36
    v_add_f32 v80, v80, v8
    v_add_f32 v82, v82, v9
    v_lshlrev_b32 v10, 16, v37
    v_and_b32 v11, s90, v37
    v_add_f32 v80, v80, v10
    v_add_f32 v82, v82, v11
    buffer_load_dwordx4 v19, s[28:31], s71 offen offset:3072 lds
    v_lshlrev_b32 v8, 16, v38
    v_and_b32 v9, s90, v38
    v_add_f32 v80, v80, v8
    v_add_f32 v82, v82, v9
    v_lshlrev_b32 v10, 16, v39
    v_and_b32 v11, s90, v39
    v_add_f32 v80, v80, v10
    v_add_f32 v82, v82, v11
    v_lshlrev_b32 v8, 16, v40
    v_and_b32 v9, s90, v40
    v_add_f32 v80, v80, v8
    v_add_f32 v82, v82, v9
    s_add_u32 m0, s70, 4096
    s_nop 0
    buffer_load_dwordx4 v20, s[32:35], s72 offen offset:0 lds
    v_lshlrev_b32 v10, 16, v41
    v_and_b32 v11, s90, v41
    v_add_f32 v80, v80, v10
    v_add_f32 v82, v82, v11
    v_lshlrev_b32 v8, 16, v42
    v_and_b32 v9, s90, v42
    v_add_f32 v80, v80, v8
    v_add_f32 v82, v82, v9
    v_lshlrev_b32 v10, 16, v43
    v_and_b32 v11, s90, v43
    v_add_f32 v80, v80, v10
    v_add_f32_e64 v82, v82, v11
    buffer_load_dwordx4 v21, s[32:35], s72 offen offset:1024 lds
    v_lshlrev_b32 v8, 16, v44
    v_and_b32 v9, s90, v44
    v_add_f32 v80, v80, v8
    v_add_f32 v82, v82, v9
    v_lshlrev_b32 v10, 16, v45
    v_and_b32 v11, s90, v45
    v_add_f32 v80, v80, v10
    v_add_f32 v82, v82, v11
    v_lshlrev_b32 v8, 16, v46
    v_and_b32 v9, s90, v46
    v_add_f32 v80, v80, v8
    v_add_f32 v82, v82, v9
    buffer_load_dwordx4 v22, s[32:35], s72 offen offset:2048 lds
    v_lshlrev_b32 v10, 16, v47
    v_and_b32 v11, s90, v47
    v_add_f32 v80, v80, v10
    v_add_f32 v82, v82, v11
    v_lshlrev_b32 v8, 16, v48
    v_and_b32 v9, s90, v48
    v_add_f32 v81, v81, v8
    v_add_f32 v83, v83, v9
    v_lshlrev_b32 v10, 16, v49
    v_and_b32 v11, s90, v49
    v_add_f32 v81, v81, v10
    v_add_f32 v83, v83, v11
    buffer_load_dwordx4 v23, s[32:35], s72 offen offset:3072 lds
    v_lshlrev_b32 v8, 16, v50
    v_and_b32 v9, s90, v50
    v_add_f32 v81, v81, v8
    v_add_f32 v83, v83, v9
    v_lshlrev_b32 v10, 16, v51
    v_and_b32 v11, s90, v51
    v_add_f32 v81, v81, v10
    v_add_f32 v83, v83, v11
    v_lshlrev_b32 v8, 16, v52
    v_and_b32 v9, s90, v52
    v_add_f32 v81, v81, v8
    v_add_f32 v83, v83, v9
    s_add_u32 m0, s70, 8192
    s_nop 0
    buffer_load_dwordx4 v24, s[32:35], s72 offen offset:0 lds
    v_lshlrev_b32 v10, 16, v53
    v_and_b32 v11, s90, v53
    v_add_f32 v81, v81, v10
    v_add_f32 v83, v83, v11
    v_lshlrev_b32 v8, 16, v54
    v_and_b32 v9, s90, v54
    v_add_f32 v81, v81, v8
    v_add_f32 v83, v83, v9
    v_lshlrev_b32 v10, 16, v55
    v_and_b32 v11, s90, v55
    v_add_f32 v81, v81, v10
    v_add_f32_e64 v83, v83, v11
    buffer_load_dwordx4 v25, s[32:35], s72 offen offset:1024 lds
    s_add_u32 s70, s70, 40960
    s_cmp_ge_u32 s70, 122880
    s_cselect_b32 s76, 122880, 0
    s_sub_u32 s70, s70, s76
    s_xor_b32 s69, s69, 1
    s_cbranch_scc1 L_hw10
    v_add_f32 v80, v80, v82
    v_add_f32 v81, v81, v83
    v_mov_b32 v82, v80
    v_mov_b32 v83, v81
    s_nop 0
    v_permlane32_swap_b32 v80, v82
    v_permlane32_swap_b32 v81, v83
    v_add_f32 v80, v80, v82
    v_add_f32_e64 v81, v81, v83
    s_mov_b32 exec_hi, 0
    buffer_store_dwordx2 v[80:81], v12, s[40:43], s79 offen offset:1024 sc1
    s_mov_b64 exec, -1
    s_waitcnt vmcnt(11)
    s_branch L_hbar
L_compute:
    s_load_dwordx4 s[8:11], s[0:1], 16
    s_load_dwordx16 s[12:27], s[0:1], 32
    s_and_b32 s62, s62, 3
    s_and_b32 s76, s2, 7
    s_lshl_b32 s76, s76, 3
    s_lshr_b32 s77, s2, 7
    s_lshl2_add_u32 s76, s77, s76
    s_mov_b32 s80, 0x654210b3
    s_mov_b32 s81, 0xfedca987
    s_lshr_b64 s[80:81], s[80:81], s76
    s_and_b32 s61, s80, 15
    s_setprio 2
    s_and_b32 s63, s62, 1
    s_lshr_b32 s64, s62, 1
    s_lshl_b32 s73, s60, 4
    s_add_u32 s73, s73, s61
    s_mul_i32 s73, s73, 28800
    s_add_u32 s76, s2, 7
    s_and_b32 s76, s76, 7
    s_bfe_u32 s77, s2, 0x10003
    s_lshl1_add_u32 s97, s76, s77
    s_lshr_b32 s98, s2, 4
    s_lshl_b32 s99, s97, 4
    s_add_u32 s99, s99, s98
    s_mul_i32 s99, s99, 9344
    s_add_u32 s99, s99, 8388608
    s_lshr_b32 s65, s97, 1
    s_lshl_b32 s76, s97, 3
    s_add_u32 s65, s65, s76
    s_mul_i32 s76, s98, 4
    s_add_u32 s65, s65, s76
    s_and_b32 s65, s65, 15
    s_mov_b32 s89, 0x3f803f80
    s_mov_b32 s90, 0xffff0000
    v_and_b32 v2, 31, v1
    v_lshrrev_b32 v3, 5, v1
    v_lshlrev_b32 v12, 4, v1
    v_lshrrev_b32_e64 v4, 3, v1
    v_mul_u32_u24 v13, 460800, v4
    v_and_b32_e64 v4, 7, v1
    v_lshl_add_u32 v13, v4, 4, v13
    v_and_b32 v10, 15, v1
    v_lshrrev_b32 v11, 4, v1
    s_mul_i32 s76, s63, 20480
    v_lshrrev_b32 v4, 1, v10
    v_xor_b32 v4, v4, v11
    v_lshlrev_b32_e64 v4, 4, v4
    v_lshl_add_u32 v4, v10, 7, v4
    v_add_u32 v192, s76, v4
    v_xor_b32 v193, 64, v192
    v_bfe_u32 v4, v1, 2, 2
    v_and_b32_e64 v6, 1, v11
    v_lshl_add_u32 v5, v6, 3, v4
    v_lshlrev_b32 v5, 7, v5
    v_lshrrev_b32 v4, 1, v4
    v_xor_b32_e64 v4, s64, v4
    v_lshl_add_u32 v5, v4, 6, v5
    v_lshl_add_u32 v5, v6, 5, v5
    v_and_b32_e64 v4, 3, v1
    v_lshl_add_u32 v5, v4, 3, v5
    v_mul_u32_u24 v4, 10240, v3
    v_add_u32_e64 v5, v5, v4
    v_add_u32 v194, 4096, v5
    v_xor_b32_e64 v195, 32, v194
    v_add_u32 v196, 40960, v192
    v_add_u32 v197, 40960, v193
    v_add_u32 v198, 40960, v194
    v_add_u32 v199, 40960, v195
    v_add_u32 v200, 81920, v192
    v_add_u32 v201, 81920, v193
    v_add_u32 v202, 81920, v194
    v_add_u32 v203, 81920, v195
    v_bfe_u32 v4, v1, 2, 2
    v_lshl_add_u32 v4, v3, 3, v4
    v_lshlrev_b32 v4, 6, v4
    v_and_b32 v5, 1, v11
    v_lshl_add_u32 v4, v5, 5, v4
    v_and_b32_e64 v5, 3, v1
    v_lshl_add_u32 v4, v5, 3, v4
    s_lshl_b32 s76, s64, 11
    s_add_u32 s76, s76, 122880
    v_add_u32_e64 v212, s76, v4
    s_lshl_b32 s76, s63, 9
    v_lshl_add_u32 v213, v10, 3, s76
    v_lshl_add_u32 v214, v2, 3, s76
    s_lshl_b32 s76, s64, 8
    v_lshl_add_u32 v215, v10, 3, s76
    v_bfe_u32 v4, v10, 1, 1
    v_xor_b32 v4, s64, v4
    v_lshrrev_b32 v5, 2, v10
    v_xor_b32 v5, v5, v3
    v_xor_b32 v6, v10, v11
    v_and_b32 v6, 1, v6
    v_lshlrev_b32_e64 v4, 6, v4
    v_lshl_add_u32 v4, v5, 4, v4
    v_lshl_add_u32 v4, v6, 3, v4
    v_lshl_add_u32 v4, v10, 7, v4
    s_lshl_b32 s76, s63, 13
    v_add_u32 v216, s76, v4
    v_bfe_u32 v4, v2, 1, 1
    v_bfe_u32 v5, v2, 2, 2
    v_and_b32 v6, 1, v2
    v_xor_b32 v6, v6, v3
    v_lshlrev_b32_e64 v4, 6, v4
    v_lshl_add_u32 v4, v5, 4, v4
    v_lshl_add_u32 v4, v6, 3, v4
    v_lshl_add_u32 v4, v2, 7, v4
    s_lshl_b32 s77, s64, 14
    s_add_u32 s76, s76, s77
    v_add_u32_e64 v217, s76, v4
    v_bfe_u32 v4, v1, 2, 2
    v_lshl_add_u32 v5, v3, 3, v4
    v_lshlrev_b32 v5, 7, v5
    v_lshrrev_b32 v6, 1, v4
    v_lshl_add_u32 v5, v6, 6, v5
    v_bfe_u32 v6, v1, 4, 1
    v_xor_b32_e64 v6, v6, v3
    v_lshl_add_u32 v5, v6, 5, v5
    v_bfe_u32 v6, v1, 1, 1
    v_lshl_add_u32 v5, v6, 4, v5
    v_xor_b32 v6, v1, v4
    v_and_b32 v6, 1, v6
    v_lshl_add_u32 v5, v6, 3, v5
    s_lshl_b32 s76, s63, 13
    v_xor_b32 v5, s76, v5
    s_lshl_b32 s76, s63, 6
    s_or_b32 s76, s76, s77
    v_xor_b32 v218, s76, v5
    s_lshl_b32 s76, s64, 6
    v_xor_b32_e64 v220, s76, v5
    v_xor_b32 v219, 528, v218
    v_xor_b32 v221, 528, v220
    v_cmp_gt_u32 s[86:87], 16, v1
    s_waitcnt lgkmcnt(0)
    s_mov_b32 s40, s26
    s_and_b32 s41, s27, 0xffff
    s_mov_b32 s42, 33554432
    s_mov_b32 s43, 0x20000
    s_mov_b32 s44, s22
    s_and_b32 s45, s23, 0xffff
    s_mov_b32 s46, 4194304
    s_mov_b32 s47, 0x20000
    s_mov_b32 s68, 0
    s_getreg_b32 s101, hwreg(HW_REG_XCC_ID, 0, 4)
    v_mov_b32 v9, 13631488
    s_lshl_b32 s76, s61, 8
    s_lshl4_add_u32 s76, s60, s76
    s_add_u32 s76, s76, 12582912
    v_mov_b32 v8, s76
    s_lshl_b32 s76, s60, 8
    s_lshl4_add_u32 s76, s61, s76
    s_add_u32 s76, s76, 12587008
    v_writelane_b32 v8, s76, 1
    s_lshl_b32 s76, s97, 8
    s_lshl4_add_u32 s76, s98, s76
    s_add_u32 s76, s76, 12591104
    v_writelane_b32 v8, s76, 2
    v_mov_b32 v6, s101
    v_mov_b32 v7, 0
    v_mov_b32_e64 v10, 0
    s_cmp_eq_u32 s62, 0
    s_cbranch_scc0 L_noep
    buffer_load_dwordx2 v[4:5], v9, s[40:43], 0 offen
L_noep:
    s_barrier
    ds_read_b128 v[112:115], v192 offset:0
    ds_read_b64_tr_b16 v[128:129], v194 offset:0
    ds_read_b64_tr_b16 v[130:131], v194 offset:512
    ds_read_b128 v[116:119], v192 offset:2048
    ds_read_b128 v[120:123], v192 offset:10240
    ds_read_b128 v[124:127], v192 offset:12288
    ds_read_b64_tr_b16 v[132:133], v195 offset:0
    ds_read_b64_tr_b16 v[134:135], v195 offset:512
    ds_read_b64_tr_b16 v[136:137], v194 offset:2048
    ds_read_b64_tr_b16 v[138:139], v194 offset:2560
    ds_read_b64_tr_b16 v[140:141], v195 offset:2048
    ds_read_b64_tr_b16 v[142:143], v195 offset:2560
    ds_read_b64_tr_b16 v[144:145], v194 offset:4096
    ds_read_b64_tr_b16 v[146:147], v194 offset:4608
    s_waitcnt lgkmcnt(8)
    ds_read_b64_tr_b16 v[148:149], v195 offset:4096
    ds_read_b64_tr_b16 v[150:151], v195 offset:4608
    v_mfma_f32_16x16x32_bf16 v[16:19], v[128:131], v[112:115], 0
    ds_read_b128 v[152:155], v193 offset:0
    v_mfma_f32_16x16x32_bf16 v[20:23], v[128:131], v[116:119], 0
    ds_read_b64_tr_b16 v[168:169], v194 offset:20480
    v_mfma_f32_16x16x32_bf16 v[24:27], v[128:131], v[120:123], 0
    ds_read_b64_tr_b16 v[170:171], v194 offset:20992
    v_mfma_f32_16x16x32_bf16 v[28:31], v[128:131], v[124:127], 0
    ds_read_b128 v[156:159], v193 offset:2048
    s_waitcnt lgkmcnt(4)
    v_mfma_f32_16x16x32_bf16 v[44:47], v[132:135], v[124:127], 0
    ds_read_b128 v[160:163], v193 offset:10240
    v_mfma_f32_16x16x32_bf16 v[40:43], v[132:135], v[120:123], 0
    ds_read_b128 v[164:167], v193 offset:12288
    v_mfma_f32_16x16x32_bf16 v[36:39], v[132:135], v[116:119], 0
    ds_read_b64_tr_b16 v[172:173], v195 offset:20480
    v_mfma_f32_16x16x32_bf16 v[32:35], v[132:135], v[112:115], 0
    ds_read_b64_tr_b16 v[174:175], v195 offset:20992
    v_mfma_f32_16x16x32_bf16 v[48:51], v[136:139], v[112:115], 0
    ds_read_b64_tr_b16 v[176:177], v194 offset:22528
    v_mfma_f32_16x16x32_bf16 v[52:55], v[136:139], v[116:119], 0
    ds_read_b64_tr_b16 v[178:179], v194 offset:23040
    v_mfma_f32_16x16x32_bf16 v[56:59], v[136:139], v[120:123], 0
    ds_read_b64_tr_b16 v[180:181], v195 offset:22528
    v_mfma_f32_16x16x32_bf16 v[60:63], v[136:139], v[124:127], 0
    ds_read_b64_tr_b16 v[182:183], v195 offset:23040
    v_mfma_f32_16x16x32_bf16 v[76:79], v[140:143], v[124:127], 0
    ds_read_b64_tr_b16 v[184:185], v194 offset:24576
    v_mfma_f32_16x16x32_bf16 v[72:75], v[140:143], v[120:123], 0
    ds_read_b64_tr_b16 v[186:187], v194 offset:25088
    v_mfma_f32_16x16x32_bf16 v[68:71], v[140:143], v[116:119], 0
    ds_read_b64_tr_b16 v[188:189], v195 offset:24576
    v_mfma_f32_16x16x32_bf16 v[64:67], v[140:143], v[112:115], 0
    ds_read_b64_tr_b16 v[190:191], v195 offset:25088
    v_mfma_f32_16x16x32_bf16 v[80:83], v[144:147], v[112:115], 0
    v_mfma_f32_16x16x32_bf16 v[84:87], v[144:147], v[116:119], 0
    v_mfma_f32_16x16x32_bf16 v[88:91], v[144:147], v[120:123], 0
    v_mfma_f32_16x16x32_bf16 v[92:95], v[144:147], v[124:127], 0
    v_mfma_f32_16x16x32_bf16 v[108:111], v[148:151], v[124:127], 0
    v_mfma_f32_16x16x32_bf16 v[104:107], v[148:151], v[120:123], 0
    v_mfma_f32_16x16x32_bf16 v[100:103], v[148:151], v[116:119], 0
    v_mfma_f32_16x16x32_bf16 v[96:99], v[148:151], v[112:115], 0
    s_waitcnt lgkmcnt(0)
    v_mfma_f32_16x16x32_bf16 v[16:19], v[168:171], v[152:155], v[16:19]
    s_barrier
    v_mfma_f32_16x16x32_bf16 v[20:23], v[168:171], v[156:159], v[20:23]
    ds_read_b128 v[112:115], v196 offset:0
    ds_read_b64_tr_b16 v[204:205], v212 offset:0
    ds_read_b64_tr_b16 v[206:207], v212 offset:256
    ds_read_b64_tr_b16 v[208:209], v212 offset:1024
    ds_read_b64_tr_b16 v[210:211], v212 offset:1280
    v_mfma_f32_16x16x32_bf16 v[24:27], v[168:171], v[160:163], v[24:27]
    ds_read_b64_tr_b16 v[128:129], v198 offset:0
    s_cmp_eq_u32 s62, 0
    s_cbranch_scc0 L_cloop
    s_waitcnt vmcnt(0)
    v_add_co_u32 v4, vcc, 1, v4
    s_nop 1
    v_addc_co_u32 v5, vcc, 0, v5, vcc
    s_mov_b64 exec, 7
    buffer_store_dwordx4 v[4:7], v8, s[40:43], 0 offen sc1
    s_mov_b64 exec, -1
.p2align 3
L_cloop:
    v_mfma_f32_16x16x32_bf16 v[28:31], v[168:171], v[164:167], v[28:31]
    ds_read_b64_tr_b16 v[130:131], v198 offset:512
    v_mfma_f32_16x16x32_bf16 v[44:47], v[172:175], v[164:167], v[44:47]
    ds_read_b128 v[116:119], v196 offset:2048
    v_mfma_f32_16x16x32_bf16 v[40:43], v[172:175], v[160:163], v[40:43]
    ds_read_b128 v[120:123], v196 offset:10240
    v_mfma_f32_16x16x32_bf16 v[36:39], v[172:175], v[156:159], v[36:39]
    ds_read_b128 v[124:127], v196 offset:12288
    v_mfma_f32_16x16x32_bf16 v[32:35], v[172:175], v[152:155], v[32:35]
    ds_read_b64_tr_b16 v[132:133], v199 offset:0
    v_mfma_f32_16x16x32_bf16 v[48:51], v[176:179], v[152:155], v[48:51]
    ds_read_b64_tr_b16 v[134:135], v199 offset:512
    v_mfma_f32_16x16x32_bf16 v[52:55], v[176:179], v[156:159], v[52:55]
    ds_read_b64_tr_b16 v[136:137], v198 offset:2048
    v_mfma_f32_16x16x32_bf16 v[56:59], v[176:179], v[160:163], v[56:59]
    ds_read_b64_tr_b16 v[138:139], v198 offset:2560
    v_mfma_f32_16x16x32_bf16 v[60:63], v[176:179], v[164:167], v[60:63]
    ds_read_b64_tr_b16 v[140:141], v199 offset:2048
    v_mfma_f32_16x16x32_bf16 v[76:79], v[180:183], v[164:167], v[76:79]
    ds_read_b64_tr_b16 v[142:143], v199 offset:2560
    v_mfma_f32_16x16x32_bf16 v[72:75], v[180:183], v[160:163], v[72:75]
    ds_read_b64_tr_b16 v[144:145], v198 offset:4096
    v_mfma_f32_16x16x32_bf16 v[68:71], v[180:183], v[156:159], v[68:71]
    ds_read_b64_tr_b16 v[146:147], v198 offset:4608
    v_mfma_f32_16x16x32_bf16 v[64:67], v[180:183], v[152:155], v[64:67]
    ds_read_b64_tr_b16 v[148:149], v199 offset:4096
    v_mfma_f32_16x16x32_bf16 v[80:83], v[184:187], v[152:155], v[80:83]
    ds_read_b64_tr_b16 v[150:151], v199 offset:4608
    v_mfma_f32_16x16x32_bf16 v[84:87], v[184:187], v[156:159], v[84:87]
    v_mfma_f32_16x16x32_bf16 v[88:91], v[184:187], v[160:163], v[88:91]
    v_mfma_f32_16x16x32_bf16 v[92:95], v[184:187], v[164:167], v[92:95]
    v_mfma_f32_16x16x32_bf16 v[108:111], v[188:191], v[164:167], v[108:111]
    v_mfma_f32_16x16x32_bf16 v[104:107], v[188:191], v[160:163], v[104:107]
    v_mfma_f32_16x16x32_bf16 v[100:103], v[188:191], v[156:159], v[100:103]
    v_mfma_f32_16x16x32_bf16 v[96:99], v[188:191], v[152:155], v[96:99]
    s_waitcnt lgkmcnt(0)
    v_mfma_f32_16x16x32_bf16 v[16:19], v[128:131], v[112:115], v[16:19]
    ds_read_b128 v[152:155], v197 offset:0
    v_mfma_f32_16x16x32_bf16 v[20:23], v[128:131], v[116:119], v[20:23]
    ds_read_b64_tr_b16 v[168:169], v198 offset:20480
    v_mfma_f32_16x16x32_bf16 v[24:27], v[128:131], v[120:123], v[24:27]
    ds_read_b64_tr_b16 v[170:171], v198 offset:20992
    v_mfma_f32_16x16x32_bf16 v[28:31], v[128:131], v[124:127], v[28:31]
    ds_read_b128 v[156:159], v197 offset:2048
    v_mfma_f32_16x16x32_bf16 v[44:47], v[132:135], v[124:127], v[44:47]
    ds_read_b128 v[160:163], v197 offset:10240
    v_mfma_f32_16x16x32_bf16 v[40:43], v[132:135], v[120:123], v[40:43]
    ds_read_b128 v[164:167], v197 offset:12288
    v_mfma_f32_16x16x32_bf16 v[36:39], v[132:135], v[116:119], v[36:39]
    ds_read_b64_tr_b16 v[172:173], v199 offset:20480
    v_mfma_f32_16x16x32_bf16 v[32:35], v[132:135], v[112:115], v[32:35]
    ds_read_b64_tr_b16 v[174:175], v199 offset:20992
    v_mfma_f32_16x16x32_bf16 v[48:51], v[136:139], v[112:115], v[48:51]
    ds_read_b64_tr_b16 v[176:177], v198 offset:22528
    v_mfma_f32_16x16x32_bf16 v[52:55], v[136:139], v[116:119], v[52:55]
    ds_read_b64_tr_b16 v[178:179], v198 offset:23040
    v_mfma_f32_16x16x32_bf16 v[56:59], v[136:139], v[120:123], v[56:59]
    ds_read_b64_tr_b16 v[180:181], v199 offset:22528
    v_mfma_f32_16x16x32_bf16 v[60:63], v[136:139], v[124:127], v[60:63]
    ds_read_b64_tr_b16 v[182:183], v199 offset:23040
    v_mfma_f32_16x16x32_bf16 v[76:79], v[140:143], v[124:127], v[76:79]
    ds_read_b64_tr_b16 v[184:185], v198 offset:24576
    v_mfma_f32_16x16x32_bf16 v[72:75], v[140:143], v[120:123], v[72:75]
    ds_read_b64_tr_b16 v[186:187], v198 offset:25088
    v_mfma_f32_16x16x32_bf16 v[68:71], v[140:143], v[116:119], v[68:71]
    ds_read_b64_tr_b16 v[188:189], v199 offset:24576
    v_mfma_f32_16x16x32_bf16 v[64:67], v[140:143], v[112:115], v[64:67]
    ds_read_b64_tr_b16 v[190:191], v199 offset:25088
    v_mfma_f32_16x16x32_bf16 v[80:83], v[144:147], v[112:115], v[80:83]
    v_mfma_f32_16x16x32_bf16 v[84:87], v[144:147], v[116:119], v[84:87]
    v_mfma_f32_16x16x32_bf16 v[88:91], v[144:147], v[120:123], v[88:91]
    v_mfma_f32_16x16x32_bf16 v[92:95], v[144:147], v[124:127], v[92:95]
    v_mfma_f32_16x16x32_bf16 v[108:111], v[148:151], v[124:127], v[108:111]
    v_mfma_f32_16x16x32_bf16 v[104:107], v[148:151], v[120:123], v[104:107]
    v_mfma_f32_16x16x32_bf16 v[100:103], v[148:151], v[116:119], v[100:103]
    v_mfma_f32_16x16x32_bf16 v[96:99], v[148:151], v[112:115], v[96:99]
    s_waitcnt lgkmcnt(0)
    v_mfma_f32_16x16x32_bf16 v[16:19], v[168:171], v[152:155], v[16:19]
    s_barrier
    v_mfma_f32_16x16x32_bf16 v[20:23], v[168:171], v[156:159], v[20:23]
    ds_read_b128 v[112:115], v200 offset:0
    v_mfma_f32_16x16x32_bf16 v[24:27], v[168:171], v[160:163], v[24:27]
    ds_read_b64_tr_b16 v[128:129], v202 offset:0
    v_mfma_f32_16x16x32_bf16 v[28:31], v[168:171], v[164:167], v[28:31]
    ds_read_b64_tr_b16 v[130:131], v202 offset:512
    v_mfma_f32_16x16x32_bf16 v[44:47], v[172:175], v[164:167], v[44:47]
    ds_read_b128 v[116:119], v200 offset:2048
    v_mfma_f32_16x16x32_bf16 v[40:43], v[172:175], v[160:163], v[40:43]
    ds_read_b128 v[120:123], v200 offset:10240
    v_mfma_f32_16x16x32_bf16 v[36:39], v[172:175], v[156:159], v[36:39]
    ds_read_b128 v[124:127], v200 offset:12288
    v_mfma_f32_16x16x32_bf16 v[32:35], v[172:175], v[152:155], v[32:35]
    ds_read_b64_tr_b16 v[132:133], v203 offset:0
    v_mfma_f32_16x16x32_bf16 v[48:51], v[176:179], v[152:155], v[48:51]
    ds_read_b64_tr_b16 v[134:135], v203 offset:512
    v_mfma_f32_16x16x32_bf16 v[52:55], v[176:179], v[156:159], v[52:55]
    ds_read_b64_tr_b16 v[136:137], v202 offset:2048
    v_mfma_f32_16x16x32_bf16 v[56:59], v[176:179], v[160:163], v[56:59]
    ds_read_b64_tr_b16 v[138:139], v202 offset:2560
    v_mfma_f32_16x16x32_bf16 v[60:63], v[176:179], v[164:167], v[60:63]
    ds_read_b64_tr_b16 v[140:141], v203 offset:2048
    v_mfma_f32_16x16x32_bf16 v[76:79], v[180:183], v[164:167], v[76:79]
    ds_read_b64_tr_b16 v[142:143], v203 offset:2560
    v_mfma_f32_16x16x32_bf16 v[72:75], v[180:183], v[160:163], v[72:75]
    ds_read_b64_tr_b16 v[144:145], v202 offset:4096
    v_mfma_f32_16x16x32_bf16 v[68:71], v[180:183], v[156:159], v[68:71]
    ds_read_b64_tr_b16 v[146:147], v202 offset:4608
    v_mfma_f32_16x16x32_bf16 v[64:67], v[180:183], v[152:155], v[64:67]
    ds_read_b64_tr_b16 v[148:149], v203 offset:4096
    v_mfma_f32_16x16x32_bf16 v[80:83], v[184:187], v[152:155], v[80:83]
    ds_read_b64_tr_b16 v[150:151], v203 offset:4608
    v_mfma_f32_16x16x32_bf16 v[84:87], v[184:187], v[156:159], v[84:87]
    v_mfma_f32_16x16x32_bf16 v[88:91], v[184:187], v[160:163], v[88:91]
    v_mfma_f32_16x16x32_bf16 v[92:95], v[184:187], v[164:167], v[92:95]
    v_mfma_f32_16x16x32_bf16 v[108:111], v[188:191], v[164:167], v[108:111]
    v_mfma_f32_16x16x32_bf16 v[104:107], v[188:191], v[160:163], v[104:107]
    v_mfma_f32_16x16x32_bf16 v[100:103], v[188:191], v[156:159], v[100:103]
    v_mfma_f32_16x16x32_bf16 v[96:99], v[188:191], v[152:155], v[96:99]
    s_waitcnt lgkmcnt(0)
    v_mfma_f32_16x16x32_bf16 v[16:19], v[128:131], v[112:115], v[16:19]
    ds_read_b128 v[152:155], v201 offset:0
    v_mfma_f32_16x16x32_bf16 v[20:23], v[128:131], v[116:119], v[20:23]
    ds_read_b64_tr_b16 v[168:169], v202 offset:20480
    v_mfma_f32_16x16x32_bf16 v[24:27], v[128:131], v[120:123], v[24:27]
    ds_read_b64_tr_b16 v[170:171], v202 offset:20992
    v_mfma_f32_16x16x32_bf16 v[28:31], v[128:131], v[124:127], v[28:31]
    ds_read_b128 v[156:159], v201 offset:2048
    v_mfma_f32_16x16x32_bf16 v[44:47], v[132:135], v[124:127], v[44:47]
    ds_read_b128 v[160:163], v201 offset:10240
    v_mfma_f32_16x16x32_bf16 v[40:43], v[132:135], v[120:123], v[40:43]
    ds_read_b128 v[164:167], v201 offset:12288
    v_mfma_f32_16x16x32_bf16 v[36:39], v[132:135], v[116:119], v[36:39]
    ds_read_b64_tr_b16 v[172:173], v203 offset:20480
    v_mfma_f32_16x16x32_bf16 v[32:35], v[132:135], v[112:115], v[32:35]
    ds_read_b64_tr_b16 v[174:175], v203 offset:20992
    v_mfma_f32_16x16x32_bf16 v[48:51], v[136:139], v[112:115], v[48:51]
    ds_read_b64_tr_b16 v[176:177], v202 offset:22528
    v_mfma_f32_16x16x32_bf16 v[52:55], v[136:139], v[116:119], v[52:55]
    ds_read_b64_tr_b16 v[178:179], v202 offset:23040
    v_mfma_f32_16x16x32_bf16 v[56:59], v[136:139], v[120:123], v[56:59]
    ds_read_b64_tr_b16 v[180:181], v203 offset:22528
    v_mfma_f32_16x16x32_bf16 v[60:63], v[136:139], v[124:127], v[60:63]
    ds_read_b64_tr_b16 v[182:183], v203 offset:23040
    v_mfma_f32_16x16x32_bf16 v[76:79], v[140:143], v[124:127], v[76:79]
    ds_read_b64_tr_b16 v[184:185], v202 offset:24576
    v_mfma_f32_16x16x32_bf16 v[72:75], v[140:143], v[120:123], v[72:75]
    ds_read_b64_tr_b16 v[186:187], v202 offset:25088
    v_mfma_f32_16x16x32_bf16 v[68:71], v[140:143], v[116:119], v[68:71]
    ds_read_b64_tr_b16 v[188:189], v203 offset:24576
    v_mfma_f32_16x16x32_bf16 v[64:67], v[140:143], v[112:115], v[64:67]
    ds_read_b64_tr_b16 v[190:191], v203 offset:25088
    v_mfma_f32_16x16x32_bf16 v[80:83], v[144:147], v[112:115], v[80:83]
    v_mfma_f32_16x16x32_bf16 v[84:87], v[144:147], v[116:119], v[84:87]
    v_mfma_f32_16x16x32_bf16 v[88:91], v[144:147], v[120:123], v[88:91]
    v_mfma_f32_16x16x32_bf16 v[92:95], v[144:147], v[124:127], v[92:95]
    v_mfma_f32_16x16x32_bf16 v[108:111], v[148:151], v[124:127], v[108:111]
    v_mfma_f32_16x16x32_bf16 v[104:107], v[148:151], v[120:123], v[104:107]
    v_mfma_f32_16x16x32_bf16 v[100:103], v[148:151], v[116:119], v[100:103]
    v_mfma_f32_16x16x32_bf16 v[96:99], v[148:151], v[112:115], v[96:99]
    s_waitcnt lgkmcnt(0)
    v_mfma_f32_16x16x32_bf16 v[16:19], v[168:171], v[152:155], v[16:19]
    s_barrier
    v_mfma_f32_16x16x32_bf16 v[20:23], v[168:171], v[156:159], v[20:23]
    ds_read_b128 v[112:115], v192 offset:0
    v_mfma_f32_16x16x32_bf16 v[24:27], v[168:171], v[160:163], v[24:27]
    ds_read_b64_tr_b16 v[128:129], v194 offset:0
    v_mfma_f32_16x16x32_bf16 v[28:31], v[168:171], v[164:167], v[28:31]
    ds_read_b64_tr_b16 v[130:131], v194 offset:512
    v_mfma_f32_16x16x32_bf16 v[44:47], v[172:175], v[164:167], v[44:47]
    ds_read_b128 v[116:119], v192 offset:2048
    v_mfma_f32_16x16x32_bf16 v[40:43], v[172:175], v[160:163], v[40:43]
    ds_read_b128 v[120:123], v192 offset:10240
    v_mfma_f32_16x16x32_bf16 v[36:39], v[172:175], v[156:159], v[36:39]
    ds_read_b128 v[124:127], v192 offset:12288
    v_mfma_f32_16x16x32_bf16 v[32:35], v[172:175], v[152:155], v[32:35]
    ds_read_b64_tr_b16 v[132:133], v195 offset:0
    v_mfma_f32_16x16x32_bf16 v[48:51], v[176:179], v[152:155], v[48:51]
    ds_read_b64_tr_b16 v[134:135], v195 offset:512
    v_mfma_f32_16x16x32_bf16 v[52:55], v[176:179], v[156:159], v[52:55]
    ds_read_b64_tr_b16 v[136:137], v194 offset:2048
    v_mfma_f32_16x16x32_bf16 v[56:59], v[176:179], v[160:163], v[56:59]
    ds_read_b64_tr_b16 v[138:139], v194 offset:2560
    v_mfma_f32_16x16x32_bf16 v[60:63], v[176:179], v[164:167], v[60:63]
    ds_read_b64_tr_b16 v[140:141], v195 offset:2048
    v_mfma_f32_16x16x32_bf16 v[76:79], v[180:183], v[164:167], v[76:79]
    ds_read_b64_tr_b16 v[142:143], v195 offset:2560
    v_mfma_f32_16x16x32_bf16 v[72:75], v[180:183], v[160:163], v[72:75]
    ds_read_b64_tr_b16 v[144:145], v194 offset:4096
    v_mfma_f32_16x16x32_bf16 v[68:71], v[180:183], v[156:159], v[68:71]
    ds_read_b64_tr_b16 v[146:147], v194 offset:4608
    v_mfma_f32_16x16x32_bf16 v[64:67], v[180:183], v[152:155], v[64:67]
    ds_read_b64_tr_b16 v[148:149], v195 offset:4096
    v_mfma_f32_16x16x32_bf16 v[80:83], v[184:187], v[152:155], v[80:83]
    ds_read_b64_tr_b16 v[150:151], v195 offset:4608
    v_mfma_f32_16x16x32_bf16 v[84:87], v[184:187], v[156:159], v[84:87]
    v_mfma_f32_16x16x32_bf16 v[88:91], v[184:187], v[160:163], v[88:91]
    v_mfma_f32_16x16x32_bf16 v[92:95], v[184:187], v[164:167], v[92:95]
    v_mfma_f32_16x16x32_bf16 v[108:111], v[188:191], v[164:167], v[108:111]
    v_mfma_f32_16x16x32_bf16 v[104:107], v[188:191], v[160:163], v[104:107]
    v_mfma_f32_16x16x32_bf16 v[100:103], v[188:191], v[156:159], v[100:103]
    v_mfma_f32_16x16x32_bf16 v[96:99], v[188:191], v[152:155], v[96:99]
    s_waitcnt lgkmcnt(0)
    v_mfma_f32_16x16x32_bf16 v[16:19], v[128:131], v[112:115], v[16:19]
    ds_read_b128 v[152:155], v193 offset:0
    v_mfma_f32_16x16x32_bf16 v[20:23], v[128:131], v[116:119], v[20:23]
    ds_read_b64_tr_b16 v[168:169], v194 offset:20480
    v_mfma_f32_16x16x32_bf16 v[24:27], v[128:131], v[120:123], v[24:27]
    ds_read_b64_tr_b16 v[170:171], v194 offset:20992
    v_mfma_f32_16x16x32_bf16 v[28:31], v[128:131], v[124:127], v[28:31]
    ds_read_b128 v[156:159], v193 offset:2048
    v_mfma_f32_16x16x32_bf16 v[44:47], v[132:135], v[124:127], v[44:47]
    ds_read_b128 v[160:163], v193 offset:10240
    v_mfma_f32_16x16x32_bf16 v[40:43], v[132:135], v[120:123], v[40:43]
    ds_read_b128 v[164:167], v193 offset:12288
    v_mfma_f32_16x16x32_bf16 v[36:39], v[132:135], v[116:119], v[36:39]
    ds_read_b64_tr_b16 v[172:173], v195 offset:20480
    v_mfma_f32_16x16x32_bf16 v[32:35], v[132:135], v[112:115], v[32:35]
    ds_read_b64_tr_b16 v[174:175], v195 offset:20992
    v_mfma_f32_16x16x32_bf16 v[48:51], v[136:139], v[112:115], v[48:51]
    ds_read_b64_tr_b16 v[176:177], v194 offset:22528
    v_mfma_f32_16x16x32_bf16 v[52:55], v[136:139], v[116:119], v[52:55]
    ds_read_b64_tr_b16 v[178:179], v194 offset:23040
    v_mfma_f32_16x16x32_bf16 v[56:59], v[136:139], v[120:123], v[56:59]
    ds_read_b64_tr_b16 v[180:181], v195 offset:22528
    v_mfma_f32_16x16x32_bf16 v[60:63], v[136:139], v[124:127], v[60:63]
    ds_read_b64_tr_b16 v[182:183], v195 offset:23040
    v_mfma_f32_16x16x32_bf16 v[76:79], v[140:143], v[124:127], v[76:79]
    ds_read_b64_tr_b16 v[184:185], v194 offset:24576
    v_mfma_f32_16x16x32_bf16 v[72:75], v[140:143], v[120:123], v[72:75]
    ds_read_b64_tr_b16 v[186:187], v194 offset:25088
    v_mfma_f32_16x16x32_bf16 v[68:71], v[140:143], v[116:119], v[68:71]
    ds_read_b64_tr_b16 v[188:189], v195 offset:24576
    v_mfma_f32_16x16x32_bf16 v[64:67], v[140:143], v[112:115], v[64:67]
    ds_read_b64_tr_b16 v[190:191], v195 offset:25088
    v_mfma_f32_16x16x32_bf16 v[80:83], v[144:147], v[112:115], v[80:83]
    v_mfma_f32_16x16x32_bf16 v[84:87], v[144:147], v[116:119], v[84:87]
    v_mfma_f32_16x16x32_bf16 v[88:91], v[144:147], v[120:123], v[88:91]
    v_mfma_f32_16x16x32_bf16 v[92:95], v[144:147], v[124:127], v[92:95]
    v_mfma_f32_16x16x32_bf16 v[108:111], v[148:151], v[124:127], v[108:111]
    s_add_u32 s68, s68, 1
    s_cmp_lt_u32 s68, 5
    v_mfma_f32_16x16x32_bf16 v[104:107], v[148:151], v[120:123], v[104:107]
    v_mfma_f32_16x16x32_bf16 v[100:103], v[148:151], v[116:119], v[100:103]
    v_mfma_f32_16x16x32_bf16 v[96:99], v[148:151], v[112:115], v[96:99]
    s_waitcnt lgkmcnt(0)
    v_mfma_f32_16x16x32_bf16 v[16:19], v[168:171], v[152:155], v[16:19]
    s_cbranch_scc0 L_cexit
    s_barrier
    v_mfma_f32_16x16x32_bf16 v[20:23], v[168:171], v[156:159], v[20:23]
    ds_read_b128 v[112:115], v196 offset:0
    v_mfma_f32_16x16x32_bf16 v[24:27], v[168:171], v[160:163], v[24:27]
    ds_read_b64_tr_b16 v[128:129], v198 offset:0
    s_branch L_cloop
L_cexit:
    v_mfma_f32_16x16x32_bf16 v[20:23], v[168:171], v[156:159], v[20:23]
    v_mfma_f32_16x16x32_bf16 v[24:27], v[168:171], v[160:163], v[24:27]
    v_mfma_f32_16x16x32_bf16 v[28:31], v[168:171], v[164:167], v[28:31]
    v_mfma_f32_16x16x32_bf16 v[44:47], v[172:175], v[164:167], v[44:47]
    v_mfma_f32_16x16x32_bf16 v[40:43], v[172:175], v[160:163], v[40:43]
    v_mfma_f32_16x16x32_bf16 v[36:39], v[172:175], v[156:159], v[36:39]
    v_mfma_f32_16x16x32_bf16 v[32:35], v[172:175], v[152:155], v[32:35]
    v_mfma_f32_16x16x32_bf16 v[48:51], v[176:179], v[152:155], v[48:51]
    v_mfma_f32_16x16x32_bf16 v[52:55], v[176:179], v[156:159], v[52:55]
    v_mfma_f32_16x16x32_bf16 v[56:59], v[176:179], v[160:163], v[56:59]
    s_barrier
    ds_read_b32 v11, v10 offset:53248
    ds_read_b64 v[222:223], v213 offset:49152
    ds_read_b64 v[224:225], v213 offset:49280
    v_mfma_f32_16x16x32_bf16 v[60:63], v[176:179], v[164:167], v[60:63]
    ds_read_b64 v[226:227], v213 offset:49408
    ds_read_b64 v[228:229], v213 offset:49536
    v_mfma_f32_16x16x32_bf16 v[76:79], v[180:183], v[164:167], v[76:79]
    ds_read_b64 v[238:239], v215 offset:50176
    ds_read_b64 v[240:241], v215 offset:50304
    v_mfma_f32_16x16x32_bf16 v[72:75], v[180:183], v[160:163], v[72:75]
    ds_read_b64 v[242:243], v215 offset:50688
    ds_read_b64 v[244:245], v215 offset:50816
    v_mfma_f32_16x16x32_bf16 v[68:71], v[180:183], v[156:159], v[68:71]
    ds_read_b64 v[246:247], v215 offset:51200
    ds_read_b64 v[248:249], v215 offset:51328
    v_mfma_f32_16x16x32_bf16 v[64:67], v[180:183], v[152:155], v[64:67]
    ds_read_b32 v250, v214 offset:49156
    ds_read_b32 v252, v214 offset:49412
    v_mfma_f32_16x16x32_bf16 v[80:83], v[184:187], v[152:155], v[80:83]
    s_waitcnt lgkmcnt(8)
    v_readfirstlane_b32 s100, v11
    v_mov_b32_e64 v230, v223
    v_cndmask_b32 v222, 0, v222, s[86:87]
    v_mfma_f32_16x16x32_bf16 v[84:87], v[184:187], v[156:159], v[84:87]
    v_mov_b32_e64 v232, v225
    v_cndmask_b32 v224, 0, v224, s[86:87]
    v_mov_b32_e64 v234, v227
    v_cndmask_b32 v226, 0, v226, s[86:87]
    v_mfma_f32_16x16x32_bf16 v[88:91], v[184:187], v[160:163], v[88:91]
    v_mov_b32_e64 v236, v229
    v_cndmask_b32 v228, 0, v228, s[86:87]
    v_mov_b32 v223, v222
    v_mov_b32 v225, v224
    v_mfma_f32_16x16x32_bf16 v[92:95], v[184:187], v[164:167], v[92:95]
    v_mov_b32 v227, v226
    v_mov_b32_e64 v229, v228
    s_waitcnt lgkmcnt(0)
    v_mul_f32 v251, 0x3fb8aa3b, v250
    v_mfma_f32_16x16x32_bf16 v[108:111], v[188:191], v[164:167], v[108:111]
    v_mul_f32 v253, 0x3fb8aa3b, v252
    v_mfma_f32_16x16x32_bf16 v[104:107], v[188:191], v[160:163], v[104:107]
    v_mfma_f32_16x16x32_bf16 v[100:103], v[188:191], v[156:159], v[100:103]
    v_mfma_f32_16x16x32_bf16 v[96:99], v[188:191], v[152:155], v[96:99]
    v_mfma_f32_16x16x16_bf16 v[48:51], v[242:243], v[222:223], v[48:51]
    v_xor_b32 v168, 0, v217
    v_xor_b32 v169, 16, v217
    v_mfma_f32_16x16x16_bf16 v[52:55], v[242:243], v[224:225], v[52:55]
    v_xor_b32 v170, 32, v217
    v_xor_b32 v171, 48, v217
    v_mfma_f32_16x16x16_bf16 v[64:67], v[244:245], v[222:223], v[64:67]
    v_xor_b32_e64 v172, 64, v217
    v_xor_b32 v173, 80, v217
    v_mfma_f32_16x16x16_bf16 v[68:71], v[244:245], v[224:225], v[68:71]
    v_xor_b32 v174, 96, v217
    v_xor_b32 v175, 112, v217
    v_mfma_f32_16x16x16_bf16 v[56:59], v[242:243], v[226:227], v[56:59]
    v_xor_b32_e64 v4, 32, v216
    v_mfma_f32_16x16x16_bf16 v[60:63], v[242:243], v[228:229], v[60:63]
    v_mfma_f32_16x16x16_bf16 v[72:75], v[244:245], v[226:227], v[72:75]
    v_mfma_f32_16x16x16_bf16 v[76:79], v[244:245], v[228:229], v[76:79]
    v_mfma_f32_16x16x16_bf16 v[80:83], v[246:247], v[222:223], v[80:83]
    v_cvt_pk_bf16_f32 v112, v48, v49
    v_cvt_pk_bf16_f32 v113, v50, v51
    v_mfma_f32_16x16x16_bf16 v[84:87], v[246:247], v[224:225], v[84:87]
    v_cvt_pk_bf16_f32 v114, v52, v53
    v_cvt_pk_bf16_f32 v115, v54, v55
    v_mfma_f32_16x16x16_bf16 v[88:91], v[246:247], v[226:227], v[88:91]
    v_cvt_pk_bf16_f32 v116, v64, v65
    v_cvt_pk_bf16_f32 v117, v66, v67
    v_mfma_f32_16x16x16_bf16 v[92:95], v[246:247], v[228:229], v[92:95]
    v_cvt_pk_bf16_f32 v118, v68, v69
    v_cvt_pk_bf16_f32 v119, v70, v71
    v_mfma_f32_16x16x16_bf16 v[96:99], v[248:249], v[222:223], v[96:99]
    v_cvt_pk_bf16_f32 v120, v56, v57
    v_cvt_pk_bf16_f32 v121, v58, v59
    v_mfma_f32_16x16x16_bf16 v[100:103], v[248:249], v[224:225], v[100:103]
    v_cvt_pk_bf16_f32 v122, v60, v61
    v_cvt_pk_bf16_f32 v123, v62, v63
    v_mfma_f32_16x16x16_bf16 v[104:107], v[248:249], v[226:227], v[104:107]
    v_permlane16_swap_b32 v112, v114
    v_permlane16_swap_b32 v113, v115
    v_mfma_f32_16x16x16_bf16 v[108:111], v[248:249], v[228:229], v[108:111]
    v_permlane16_swap_b32 v116, v118
    v_permlane16_swap_b32 v117, v119
    v_cvt_pk_bf16_f32 v124, v72, v73
    v_cvt_pk_bf16_f32 v125, v74, v75
    v_cvt_pk_bf16_f32 v126, v76, v77
    v_cvt_pk_bf16_f32 v127, v78, v79
    v_permlane16_swap_b32 v120, v122
    v_permlane16_swap_b32 v121, v123
    v_permlane16_swap_b32 v124, v126
    v_permlane16_swap_b32 v125, v127
    v_mfma_f32_32x32x16_bf16 v[48:63], v[204:207], v[112:115], 0
    v_mul_f32 v80, v80, v230
    v_mul_f32 v81, v81, v230
    v_mul_f32 v82, v82, v230
    v_mul_f32 v83, v83, v230
    v_cvt_pk_bf16_f32 v80, v80, v81
    v_cvt_pk_bf16_f32 v81, v82, v83
    v_mfma_f32_32x32x16_bf16 v[64:79], v[204:207], v[120:123], 0
    v_mul_f32 v96, v96, v230
    v_mul_f32 v97, v97, v230
    v_mul_f32 v98, v98, v230
    v_mul_f32 v99, v99, v230
    v_cvt_pk_bf16_f32 v96, v96, v97
    v_cvt_pk_bf16_f32 v97, v98, v99
    v_mfma_f32_32x32x16_bf16 v[48:63], v[208:211], v[116:119], v[48:63]
    v_mul_f32 v84, v84, v232
    v_mul_f32 v85, v85, v232
    v_mul_f32 v86, v86, v232
    v_mul_f32 v87, v87, v232
    v_cvt_pk_bf16_f32 v84, v84, v85
    v_cvt_pk_bf16_f32 v85, v86, v87
    v_mfma_f32_32x32x16_bf16 v[64:79], v[208:211], v[124:127], v[64:79]
    v_mul_f32 v100, v100, v232
    v_mul_f32 v101, v101, v232
    v_mul_f32 v102, v102, v232
    v_mul_f32 v103, v103, v232
    v_cvt_pk_bf16_f32 v100, v100, v101
    v_cvt_pk_bf16_f32 v101, v102, v103
    v_mul_f32 v88, v88, v234
    v_mul_f32 v89, v89, v234
    v_mul_f32 v90, v90, v234
    v_mul_f32 v91, v91, v234
    v_cvt_pk_bf16_f32 v88, v88, v89
    v_cvt_pk_bf16_f32 v89, v90, v91
    v_mul_f32 v104, v104, v234
    v_mul_f32 v105, v105, v234
    v_mul_f32 v106, v106, v234
    v_mul_f32 v107, v107, v234
    v_cvt_pk_bf16_f32 v104, v104, v105
    v_cvt_pk_bf16_f32 v105, v106, v107
    v_mul_f32 v92, v92, v236
    v_mul_f32 v93, v93, v236
    v_mul_f32 v94, v94, v236
    v_mul_f32 v95, v95, v236
    v_cvt_pk_bf16_f32 v92, v92, v93
    v_cvt_pk_bf16_f32 v93, v94, v95
    v_mul_f32 v108, v108, v236
    v_mul_f32 v109, v109, v236
    v_mul_f32 v110, v110, v236
    v_mul_f32 v111, v111, v236
    v_cvt_pk_bf16_f32 v108, v108, v109
    v_cvt_pk_bf16_f32 v109, v110, v111
    v_max3_f32 v160, v48, v49, v50
    v_min3_f32 v162, v48, v49, v50
    v_max3_f32 v160, v160, v51, v52
    v_min3_f32 v162, v162, v51, v52
    v_max3_f32 v160, v160, v53, v54
    v_min3_f32 v162, v162, v53, v54
    v_max3_f32 v160, v160, v55, v56
    v_min3_f32 v162, v162, v55, v56
    v_max3_f32 v160, v160, v57, v58
    v_min3_f32 v162, v162, v57, v58
    v_max3_f32 v160, v160, v59, v60
    v_min3_f32 v162, v162, v59, v60
    v_max3_f32 v160, v160, v61, v62
    v_min3_f32 v162, v162, v61, v62
    v_max_f32 v160, v160, v63
    v_min_f32 v162, v162, v63
    v_max3_f32 v164, v64, v65, v66
    v_min3_f32 v166, v64, v65, v66
    v_max3_f32 v164, v164, v67, v68
    v_min3_f32 v166, v166, v67, v68
    v_max3_f32 v164, v164, v69, v70
    v_min3_f32 v166, v166, v69, v70
    v_max3_f32 v164, v164, v71, v72
    v_min3_f32 v166, v166, v71, v72
    v_max3_f32 v164, v164, v73, v74
    v_min3_f32 v166, v166, v73, v74
    v_max3_f32 v164, v164, v75, v76
    v_min3_f32 v166, v166, v75, v76
    v_max3_f32 v164, v164, v77, v78
    v_min3_f32 v166, v166, v77, v78
    v_max_f32 v164, v164, v79
    v_min_f32 v166, v166, v79
    v_mov_b32 v161, v160
    v_mov_b32 v163, v162
    v_mov_b32 v165, v164
    v_mov_b32 v167, v166
    v_permlane32_swap_b32 v160, v161
    v_permlane32_swap_b32 v162, v163
    v_permlane32_swap_b32 v164, v165
    v_permlane32_swap_b32 v166, v167
    v_max_f32 v160, v160, v161
    v_min_f32 v162, v162, v163
    v_max_f32 v164, v164, v165
    v_min_f32 v166, v166, v167
    v_mul_f32 v160, v160, v251
    v_mul_f32 v162, v162, v251
    v_mul_f32 v164, v164, v253
    v_mul_f32 v166, v166, v253
    v_pk_fma_f32 v[128:129], v[48:49], v[250:251], v[160:161] op_sel:[0,1,0] op_sel_hi:[1,1,0] neg_lo:[0,0,1] neg_hi:[0,0,1]
    v_pk_fma_f32 v[48:49], v[48:49], v[250:251], v[162:163] op_sel:[0,1,0] op_sel_hi:[1,1,0] neg_lo:[0,1,0] neg_hi:[0,1,0]
    v_pk_fma_f32 v[130:131], v[50:51], v[250:251], v[160:161] op_sel:[0,1,0] op_sel_hi:[1,1,0] neg_lo:[0,0,1] neg_hi:[0,0,1]
    v_pk_fma_f32 v[50:51], v[50:51], v[250:251], v[162:163] op_sel:[0,1,0] op_sel_hi:[1,1,0] neg_lo:[0,1,0] neg_hi:[0,1,0]
    v_pk_fma_f32 v[132:133], v[52:53], v[250:251], v[160:161] op_sel:[0,1,0] op_sel_hi:[1,1,0] neg_lo:[0,0,1] neg_hi:[0,0,1]
    v_pk_fma_f32 v[52:53], v[52:53], v[250:251], v[162:163] op_sel:[0,1,0] op_sel_hi:[1,1,0] neg_lo:[0,1,0] neg_hi:[0,1,0]
    v_pk_fma_f32 v[134:135], v[54:55], v[250:251], v[160:161] op_sel:[0,1,0] op_sel_hi:[1,1,0] neg_lo:[0,0,1] neg_hi:[0,0,1]
    v_pk_fma_f32 v[54:55], v[54:55], v[250:251], v[162:163] op_sel:[0,1,0] op_sel_hi:[1,1,0] neg_lo:[0,1,0] neg_hi:[0,1,0]
    v_pk_fma_f32 v[136:137], v[56:57], v[250:251], v[160:161] op_sel:[0,1,0] op_sel_hi:[1,1,0] neg_lo:[0,0,1] neg_hi:[0,0,1]
    v_pk_fma_f32 v[56:57], v[56:57], v[250:251], v[162:163] op_sel:[0,1,0] op_sel_hi:[1,1,0] neg_lo:[0,1,0] neg_hi:[0,1,0]
    v_pk_fma_f32 v[138:139], v[58:59], v[250:251], v[160:161] op_sel:[0,1,0] op_sel_hi:[1,1,0] neg_lo:[0,0,1] neg_hi:[0,0,1]
    v_pk_fma_f32 v[58:59], v[58:59], v[250:251], v[162:163] op_sel:[0,1,0] op_sel_hi:[1,1,0] neg_lo:[0,1,0] neg_hi:[0,1,0]
    v_pk_fma_f32 v[140:141], v[60:61], v[250:251], v[160:161] op_sel:[0,1,0] op_sel_hi:[1,1,0] neg_lo:[0,0,1] neg_hi:[0,0,1]
    v_pk_fma_f32 v[60:61], v[60:61], v[250:251], v[162:163] op_sel:[0,1,0] op_sel_hi:[1,1,0] neg_lo:[0,1,0] neg_hi:[0,1,0]
    v_pk_fma_f32 v[142:143], v[62:63], v[250:251], v[160:161] op_sel:[0,1,0] op_sel_hi:[1,1,0] neg_lo:[0,0,1] neg_hi:[0,0,1]
    v_pk_fma_f32 v[62:63], v[62:63], v[250:251], v[162:163] op_sel:[0,1,0] op_sel_hi:[1,1,0] neg_lo:[0,1,0] neg_hi:[0,1,0]
    v_pk_fma_f32 v[144:145], v[64:65], v[252:253], v[164:165] op_sel:[0,1,0] op_sel_hi:[1,1,0] neg_lo:[0,0,1] neg_hi:[0,0,1]
    v_pk_fma_f32 v[64:65], v[64:65], v[252:253], v[166:167] op_sel:[0,1,0] op_sel_hi:[1,1,0] neg_lo:[0,1,0] neg_hi:[0,1,0]
    v_pk_fma_f32 v[146:147], v[66:67], v[252:253], v[164:165] op_sel:[0,1,0] op_sel_hi:[1,1,0] neg_lo:[0,0,1] neg_hi:[0,0,1]
    v_pk_fma_f32 v[66:67], v[66:67], v[252:253], v[166:167] op_sel:[0,1,0] op_sel_hi:[1,1,0] neg_lo:[0,1,0] neg_hi:[0,1,0]
    v_pk_fma_f32 v[148:149], v[68:69], v[252:253], v[164:165] op_sel:[0,1,0] op_sel_hi:[1,1,0] neg_lo:[0,0,1] neg_hi:[0,0,1]
    v_pk_fma_f32 v[68:69], v[68:69], v[252:253], v[166:167] op_sel:[0,1,0] op_sel_hi:[1,1,0] neg_lo:[0,1,0] neg_hi:[0,1,0]
    v_pk_fma_f32 v[150:151], v[70:71], v[252:253], v[164:165] op_sel:[0,1,0] op_sel_hi:[1,1,0] neg_lo:[0,0,1] neg_hi:[0,0,1]
    v_pk_fma_f32 v[70:71], v[70:71], v[252:253], v[166:167] op_sel:[0,1,0] op_sel_hi:[1,1,0] neg_lo:[0,1,0] neg_hi:[0,1,0]
    v_pk_fma_f32 v[152:153], v[72:73], v[252:253], v[164:165] op_sel:[0,1,0] op_sel_hi:[1,1,0] neg_lo:[0,0,1] neg_hi:[0,0,1]
    v_pk_fma_f32 v[72:73], v[72:73], v[252:253], v[166:167] op_sel:[0,1,0] op_sel_hi:[1,1,0] neg_lo:[0,1,0] neg_hi:[0,1,0]
    v_pk_fma_f32 v[154:155], v[74:75], v[252:253], v[164:165] op_sel:[0,1,0] op_sel_hi:[1,1,0] neg_lo:[0,0,1] neg_hi:[0,0,1]
    v_pk_fma_f32 v[74:75], v[74:75], v[252:253], v[166:167] op_sel:[0,1,0] op_sel_hi:[1,1,0] neg_lo:[0,1,0] neg_hi:[0,1,0]
    v_pk_fma_f32 v[156:157], v[76:77], v[252:253], v[164:165] op_sel:[0,1,0] op_sel_hi:[1,1,0] neg_lo:[0,0,1] neg_hi:[0,0,1]
    v_pk_fma_f32 v[76:77], v[76:77], v[252:253], v[166:167] op_sel:[0,1,0] op_sel_hi:[1,1,0] neg_lo:[0,1,0] neg_hi:[0,1,0]
    v_pk_fma_f32 v[158:159], v[78:79], v[252:253], v[164:165] op_sel:[0,1,0] op_sel_hi:[1,1,0] neg_lo:[0,0,1] neg_hi:[0,0,1]
    v_pk_fma_f32 v[78:79], v[78:79], v[252:253], v[166:167] op_sel:[0,1,0] op_sel_hi:[1,1,0] neg_lo:[0,1,0] neg_hi:[0,1,0]
    v_exp_f32_e64 v128, v128
    v_mfma_f32_16x16x16_bf16 v[16:19], v[238:239], v[222:223], v[16:19]
    v_exp_f32 v144, v144
    v_exp_f32 v129, v129
    v_exp_f32_e64 v145, v145
    v_mfma_f32_16x16x16_bf16 v[20:23], v[238:239], v[224:225], v[20:23]
    ds_write2st64_b64 v216, v[80:81], v[84:85] offset0:64 offset1:68
    v_exp_f32 v130, v130
    v_exp_f32 v146, v146
    v_exp_f32_e64 v131, v131
    v_mfma_f32_16x16x16_bf16 v[24:27], v[238:239], v[226:227], v[24:27]
    v_exp_f32 v147, v147
    v_exp_f32 v132, v132
    v_exp_f32_e64 v148, v148
    v_mfma_f32_16x16x16_bf16 v[28:31], v[238:239], v[228:229], v[28:31]
    ds_write2st64_b64 v4, v[96:97], v[100:101] offset0:64 offset1:68
    v_exp_f32 v133, v133
    v_exp_f32 v149, v149
    v_exp_f32_e64 v134, v134
    v_mfma_f32_16x16x16_bf16 v[32:35], v[240:241], v[222:223], v[32:35]
    v_exp_f32 v150, v150
    v_exp_f32 v135, v135
    v_exp_f32_e64 v151, v151
    v_mfma_f32_16x16x16_bf16 v[36:39], v[240:241], v[224:225], v[36:39]
    ds_write2st64_b64 v216, v[88:89], v[92:93] offset0:72 offset1:76
    v_exp_f32 v136, v136
    v_exp_f32 v152, v152
    v_exp_f32_e64 v137, v137
    v_mfma_f32_16x16x16_bf16 v[40:43], v[240:241], v[226:227], v[40:43]
    v_exp_f32 v153, v153
    v_exp_f32 v138, v138
    v_exp_f32_e64 v154, v154
    v_mfma_f32_16x16x16_bf16 v[44:47], v[240:241], v[228:229], v[44:47]
    ds_write2st64_b64 v4, v[104:105], v[108:109] offset0:72 offset1:76
    v_exp_f32 v139, v139
    v_exp_f32 v155, v155
    v_exp_f32 v140, v140
    v_exp_f32 v156, v156
    v_exp_f32 v141, v141
    v_exp_f32 v157, v157
    v_exp_f32 v142, v142
    v_exp_f32 v158, v158
    v_exp_f32 v143, v143
    v_exp_f32 v159, v159
    v_pk_add_f32 v[176:177], v[128:129], v[130:131]
    v_pk_add_f32 v[178:179], v[144:145], v[146:147]
    v_pk_add_f32 v[176:177], v[176:177], v[132:133]
    v_pk_add_f32 v[178:179], v[178:179], v[148:149]
    v_pk_add_f32 v[176:177], v[176:177], v[134:135]
    v_pk_add_f32 v[178:179], v[178:179], v[150:151]
    v_pk_add_f32 v[176:177], v[176:177], v[136:137]
    v_pk_add_f32 v[178:179], v[178:179], v[152:153]
    v_pk_add_f32 v[176:177], v[176:177], v[138:139]
    v_pk_add_f32 v[178:179], v[178:179], v[154:155]
    v_pk_add_f32 v[176:177], v[176:177], v[140:141]
    v_pk_add_f32 v[178:179], v[178:179], v[156:157]
    v_pk_add_f32 v[176:177], v[176:177], v[142:143]
    v_pk_add_f32 v[178:179], v[178:179], v[158:159]
    v_exp_f32 v48, v48
    v_add_f32 v176, v176, v177
    v_add_f32 v178, v178, v179
    v_exp_f32 v64, v64
    v_mov_b32 v177, v176
    v_mov_b32 v179, v178
    v_exp_f32 v49, v49
    v_permlane32_swap_b32 v176, v177
    v_permlane32_swap_b32 v178, v179
    v_exp_f32 v65, v65
    v_add_f32 v176, v176, v177
    v_add_f32 v178, v178, v179
    v_exp_f32 v50, v50
    v_rcp_f32 v176, v176
    v_rcp_f32 v178, v178
    v_exp_f32 v66, v66
    v_exp_f32 v51, v51
    v_exp_f32 v67, v67
    v_exp_f32 v52, v52
    v_exp_f32 v68, v68
    v_exp_f32 v53, v53
    v_exp_f32 v69, v69
    v_exp_f32 v54, v54
    v_exp_f32 v70, v70
    v_exp_f32 v55, v55
    v_exp_f32 v71, v71
    v_exp_f32 v56, v56
    v_exp_f32 v72, v72
    v_exp_f32 v57, v57
    v_exp_f32 v73, v73
    v_exp_f32 v58, v58
    v_exp_f32 v74, v74
    v_exp_f32 v59, v59
    v_exp_f32 v75, v75
    v_exp_f32 v60, v60
    v_exp_f32 v76, v76
    v_exp_f32 v61, v61
    v_exp_f32 v77, v77
    v_exp_f32 v62, v62
    v_exp_f32 v78, v78
    v_exp_f32 v63, v63
    v_exp_f32 v79, v79
    v_pk_add_f32 v[180:181], v[48:49], v[50:51]
    v_pk_add_f32 v[182:183], v[64:65], v[66:67]
    v_pk_add_f32 v[180:181], v[180:181], v[52:53]
    v_pk_add_f32 v[182:183], v[182:183], v[68:69]
    v_pk_add_f32 v[180:181], v[180:181], v[54:55]
    v_pk_add_f32 v[182:183], v[182:183], v[70:71]
    v_pk_add_f32 v[180:181], v[180:181], v[56:57]
    v_pk_add_f32 v[182:183], v[182:183], v[72:73]
    v_pk_add_f32 v[180:181], v[180:181], v[58:59]
    v_pk_add_f32 v[182:183], v[182:183], v[74:75]
    v_pk_add_f32 v[180:181], v[180:181], v[60:61]
    v_pk_add_f32 v[182:183], v[182:183], v[76:77]
    v_pk_add_f32 v[180:181], v[180:181], v[62:63]
    v_pk_add_f32 v[182:183], v[182:183], v[78:79]
    v_add_f32 v180, v180, v181
    v_add_f32 v182, v182, v183
    v_mov_b32 v181, v180
    v_mov_b32 v183, v182
    v_pk_mul_f32 v[128:129], v[128:129], v[176:177] op_sel_hi:[1,0]
    v_pk_mul_f32 v[130:131], v[130:131], v[176:177] op_sel_hi:[1,0]
    v_cvt_pk_bf16_f32 v128, v128, v129
    v_permlane32_swap_b32 v180, v181
    v_permlane32_swap_b32 v182, v183
    v_cvt_pk_bf16_f32 v129, v130, v131
    v_pk_mul_f32 v[144:145], v[144:145], v[178:179] op_sel_hi:[1,0]
    v_pk_mul_f32 v[146:147], v[146:147], v[178:179] op_sel_hi:[1,0]
    v_cvt_pk_bf16_f32 v144, v144, v145
    v_cvt_pk_bf16_f32 v145, v146, v147
    v_add_f32 v180, v180, v181
    v_add_f32 v182, v182, v183
    ds_write2st64_b64 v168, v[128:129], v[144:145] offset0:0 offset1:8
    v_pk_mul_f32 v[132:133], v[132:133], v[176:177] op_sel_hi:[1,0]
    v_pk_mul_f32 v[134:135], v[134:135], v[176:177] op_sel_hi:[1,0]
    v_cvt_pk_bf16_f32 v132, v132, v133
    v_cvt_pk_bf16_f32 v133, v134, v135
    v_pk_mul_f32 v[148:149], v[148:149], v[178:179] op_sel_hi:[1,0]
    v_rcp_f32 v180, v180
    v_rcp_f32 v182, v182
    v_pk_mul_f32 v[150:151], v[150:151], v[178:179] op_sel_hi:[1,0]
    v_cvt_pk_bf16_f32 v148, v148, v149
    v_cvt_pk_bf16_f32 v149, v150, v151
    ds_write2st64_b64 v169, v[132:133], v[148:149] offset0:0 offset1:8
    v_pk_mul_f32 v[136:137], v[136:137], v[176:177] op_sel_hi:[1,0]
    v_pk_mul_f32 v[138:139], v[138:139], v[176:177] op_sel_hi:[1,0]
    v_cvt_pk_bf16_f32 v136, v136, v137
    v_cvt_pk_bf16_f32 v137, v138, v139
    v_pk_mul_f32 v[152:153], v[152:153], v[178:179] op_sel_hi:[1,0]
    v_pk_mul_f32 v[154:155], v[154:155], v[178:179] op_sel_hi:[1,0]
    v_cvt_pk_bf16_f32 v152, v152, v153
    v_cvt_pk_bf16_f32 v153, v154, v155
    ds_write2st64_b64 v170, v[136:137], v[152:153] offset0:0 offset1:8
    v_pk_mul_f32 v[140:141], v[140:141], v[176:177] op_sel_hi:[1,0]
    v_pk_mul_f32 v[142:143], v[142:143], v[176:177] op_sel_hi:[1,0]
    v_cvt_pk_bf16_f32 v140, v140, v141
    v_cvt_pk_bf16_f32 v141, v142, v143
    v_pk_mul_f32 v[156:157], v[156:157], v[178:179] op_sel_hi:[1,0]
    v_pk_mul_f32 v[158:159], v[158:159], v[178:179] op_sel_hi:[1,0]
    v_cvt_pk_bf16_f32 v156, v156, v157
    v_cvt_pk_bf16_f32 v157, v158, v159
    ds_write2st64_b64 v171, v[140:141], v[156:157] offset0:0 offset1:8
    v_pk_mul_f32 v[48:49], v[48:49], v[180:181] op_sel_hi:[1,0]
    v_pk_mul_f32 v[50:51], v[50:51], v[180:181] op_sel_hi:[1,0]
    v_cvt_pk_bf16_f32 v48, v48, v49
    v_cvt_pk_bf16_f32 v49, v50, v51
    v_pk_mul_f32 v[64:65], v[64:65], v[182:183] op_sel_hi:[1,0]
    v_pk_mul_f32 v[66:67], v[66:67], v[182:183] op_sel_hi:[1,0]
    v_cvt_pk_bf16_f32 v64, v64, v65
    v_cvt_pk_bf16_f32 v65, v66, v67
    ds_write2st64_b64 v172, v[48:49], v[64:65] offset0:0 offset1:8
    v_pk_mul_f32 v[52:53], v[52:53], v[180:181] op_sel_hi:[1,0]
    v_pk_mul_f32 v[54:55], v[54:55], v[180:181] op_sel_hi:[1,0]
    v_cvt_pk_bf16_f32 v52, v52, v53
    v_cvt_pk_bf16_f32 v53, v54, v55
    v_pk_mul_f32 v[68:69], v[68:69], v[182:183] op_sel_hi:[1,0]
    v_pk_mul_f32 v[70:71], v[70:71], v[182:183] op_sel_hi:[1,0]
    v_cvt_pk_bf16_f32 v68, v68, v69
    v_cvt_pk_bf16_f32 v69, v70, v71
    ds_write2st64_b64 v173, v[52:53], v[68:69] offset0:0 offset1:8
    v_pk_mul_f32 v[56:57], v[56:57], v[180:181] op_sel_hi:[1,0]
    v_pk_mul_f32 v[58:59], v[58:59], v[180:181] op_sel_hi:[1,0]
    v_cvt_pk_bf16_f32 v56, v56, v57
    v_cvt_pk_bf16_f32 v57, v58, v59
    v_pk_mul_f32 v[72:73], v[72:73], v[182:183] op_sel_hi:[1,0]
    v_pk_mul_f32 v[74:75], v[74:75], v[182:183] op_sel_hi:[1,0]
    v_cvt_pk_bf16_f32 v72, v72, v73
    v_cvt_pk_bf16_f32 v73, v74, v75
    ds_write2st64_b64 v174, v[56:57], v[72:73] offset0:0 offset1:8
    v_pk_mul_f32 v[60:61], v[60:61], v[180:181] op_sel_hi:[1,0]
    v_pk_mul_f32 v[62:63], v[62:63], v[180:181] op_sel_hi:[1,0]
    v_cvt_pk_bf16_f32 v60, v60, v61
    v_cvt_pk_bf16_f32 v61, v62, v63
    v_pk_mul_f32 v[76:77], v[76:77], v[182:183] op_sel_hi:[1,0]
    v_pk_mul_f32 v[78:79], v[78:79], v[182:183] op_sel_hi:[1,0]
    v_cvt_pk_bf16_f32 v76, v76, v77
    v_cvt_pk_bf16_f32 v77, v78, v79
    ds_write2st64_b64 v175, v[60:61], v[76:77] offset0:0 offset1:8
    ds_read_b64_tr_b16 v[112:113], v218 offset:0
    ds_read_b64_tr_b16 v[114:115], v219 offset:0
    ds_read_b64_tr_b16 v[144:145], v220 offset:32768
    ds_read_b64_tr_b16 v[146:147], v221 offset:32768
    ds_read_b64_tr_b16 v[116:117], v218 offset:2048
    ds_read_b64_tr_b16 v[118:119], v219 offset:2048
    ds_read_b64_tr_b16 v[148:149], v220 offset:34816
    ds_read_b64_tr_b16 v[150:151], v221 offset:34816
    ds_read_b64_tr_b16 v[120:121], v218 offset:4096
    ds_read_b64_tr_b16 v[122:123], v219 offset:4096
    ds_read_b64_tr_b16 v[152:153], v220 offset:36864
    ds_read_b64_tr_b16 v[154:155], v221 offset:36864
    v_cvt_pk_bf16_f32 v176, v16, v17
    v_cvt_pk_bf16_f32 v177, v18, v19
    v_cvt_pk_bf16_f32 v178, v20, v21
    v_cvt_pk_bf16_f32 v179, v22, v23
    v_cvt_pk_bf16_f32 v180, v32, v33
    v_cvt_pk_bf16_f32 v181, v34, v35
    v_cvt_pk_bf16_f32 v182, v36, v37
    v_cvt_pk_bf16_f32 v183, v38, v39
    v_cvt_pk_bf16_f32 v184, v24, v25
    v_cvt_pk_bf16_f32 v185, v26, v27
    v_cvt_pk_bf16_f32 v186, v28, v29
    v_cvt_pk_bf16_f32 v187, v30, v31
    v_cvt_pk_bf16_f32 v188, v40, v41
    v_cvt_pk_bf16_f32 v189, v42, v43
    v_cvt_pk_bf16_f32 v190, v44, v45
    v_cvt_pk_bf16_f32 v191, v46, v47
    s_waitcnt lgkmcnt(8)
    v_mfma_f32_32x32x16_bf16 v[48:63], v[112:115], v[144:147], 0
    ds_read_b64_tr_b16 v[124:125], v218 offset:6144
    ds_read_b64_tr_b16 v[126:127], v219 offset:6144
    ds_read_b64_tr_b16 v[156:157], v220 offset:38912
    ds_read_b64_tr_b16 v[158:159], v221 offset:38912
    s_waitcnt lgkmcnt(8)
    v_mfma_f32_32x32x16_bf16 v[48:63], v[116:119], v[148:151], v[48:63]
    v_xor_b32 v218, 8192, v218
    v_xor_b32 v219, 8192, v219
    v_xor_b32 v220, 8192, v220
    v_xor_b32 v221, 8192, v221
    s_barrier
    ds_read_b64_tr_b16 v[128:129], v218 offset:0
    ds_read_b64_tr_b16 v[130:131], v219 offset:0
    ds_read_b64_tr_b16 v[160:161], v220 offset:32768
    ds_read_b64_tr_b16 v[162:163], v221 offset:32768
    s_waitcnt lgkmcnt(8)
    v_mfma_f32_32x32x16_bf16 v[48:63], v[120:123], v[152:155], v[48:63]
    ds_read_b64_tr_b16 v[132:133], v218 offset:2048
    ds_read_b64_tr_b16 v[134:135], v219 offset:2048
    ds_read_b64_tr_b16 v[164:165], v220 offset:34816
    ds_read_b64_tr_b16 v[166:167], v221 offset:34816
    s_waitcnt lgkmcnt(8)
    v_mfma_f32_32x32x16_bf16 v[48:63], v[124:127], v[156:159], v[48:63]
    ds_read_b64_tr_b16 v[136:137], v218 offset:4096
    ds_read_b64_tr_b16 v[138:139], v219 offset:4096
    ds_read_b64_tr_b16 v[168:169], v220 offset:36864
    ds_read_b64_tr_b16 v[170:171], v221 offset:36864
    s_waitcnt lgkmcnt(8)
    v_mfma_f32_32x32x16_bf16 v[48:63], v[128:131], v[160:163], v[48:63]
    ds_read_b64_tr_b16 v[140:141], v218 offset:6144
    ds_read_b64_tr_b16 v[142:143], v219 offset:6144
    ds_read_b64_tr_b16 v[172:173], v220 offset:38912
    ds_read_b64_tr_b16 v[174:175], v221 offset:38912
    s_waitcnt lgkmcnt(8)
    v_mfma_f32_32x32x16_bf16 v[48:63], v[132:135], v[164:167], v[48:63]
    v_permlane16_swap_b32 v176, v178
    v_permlane16_swap_b32 v177, v179
    s_waitcnt lgkmcnt(4)
    v_mfma_f32_32x32x16_bf16 v[48:63], v[136:139], v[168:171], v[48:63]
    v_permlane16_swap_b32 v180, v182
    v_permlane16_swap_b32 v181, v183
    v_permlane16_swap_b32 v184, v186
    s_waitcnt lgkmcnt(0)
    v_mfma_f32_32x32x16_bf16 v[48:63], v[140:143], v[172:175], v[48:63]
    s_barrier
    v_permlane16_swap_b32 v185, v187
    v_permlane16_swap_b32 v188, v190
    v_permlane16_swap_b32 v189, v191
    s_lshl_b32 s76, s62, 11
    s_add_u32 s76, s76, s99
    v_mfma_f32_32x32x16_bf16 v[16:31], v[204:207], v[176:179], 0
    s_add_u32 s76, s76, 1024
    s_lshl_b32 s77, s62, 7
    s_add_u32 s77, s77, s73
    v_lshlrev_b32_e64 v4, 2, v2
    v_mfma_f32_32x32x16_bf16 v[32:47], v[204:207], v[184:187], 0
    v_cvt_pk_bf16_f32 v64, v48, v49
    v_cvt_pk_bf16_f32 v65, v50, v51
    v_cvt_pk_bf16_f32 v66, v52, v53
    v_cvt_pk_bf16_f32 v67, v54, v55
    v_cvt_pk_bf16_f32 v68, v56, v57
    v_mfma_f32_32x32x16_bf16 v[16:31], v[208:211], v[180:183], v[16:31]
    v_cvt_pk_bf16_f32 v69, v58, v59
    v_cvt_pk_bf16_f32 v70, v60, v61
    v_cvt_pk_bf16_f32 v71, v62, v63
    s_bitcmp1_b32 s100, 0
    s_cbranch_scc1 L_loc_59
    buffer_store_dwordx4 v[64:67], v12, s[40:43], s76 offen offset:0 sc1
    buffer_store_dwordx4 v[68:71], v12, s[40:43], s76 offen offset:1024 sc1
    s_branch L_pubd_60
L_loc_59:
    buffer_store_dwordx4 v[64:67], v12, s[40:43], s76 offen offset:0
    buffer_store_dwordx4 v[68:71], v12, s[40:43], s76 offen offset:1024
L_pubd_60:
    v_mfma_f32_32x32x16_bf16 v[32:47], v[208:211], v[188:191], v[32:47]
    v_and_b32 v216, 1, v1
    v_lshlrev_b32_e64 v216, 8, v216
    v_lshl_add_u32 v216, v3, 4, v216
    s_lshl_b32 s76, s64, 7
    v_add_u32 v216, s76, v216
    s_mul_i32 s78, s61, 28800
    s_lshl_b32 s79, s64, 8
    s_add_u32 s78, s78, s79
    s_add_u32 s79, s78, 3686400
    v_dot2_f32_bf16 v72, v112, s89, 0
    v_dot2_f32_bf16 v73, v113, s89, 0
    v_dot2_f32_bf16 v72, v114, s89, v72
    v_dot2_f32_bf16 v73, v115, s89, v73
    v_dot2_f32_bf16 v72, v116, s89, v72
    v_dot2_f32_bf16 v73, v117, s89, v73
    v_dot2_f32_bf16 v72, v118, s89, v72
    v_dot2_f32_bf16 v73, v119, s89, v73
    v_dot2_f32_bf16 v72, v120, s89, v72
    v_dot2_f32_bf16 v73, v121, s89, v73
    v_dot2_f32_bf16 v72, v122, s89, v72
    v_dot2_f32_bf16 v73, v123, s89, v73
    v_dot2_f32_bf16 v72, v124, s89, v72
    v_dot2_f32_bf16 v73, v125, s89, v73
    v_dot2_f32_bf16 v72, v126, s89, v72
    v_dot2_f32_bf16 v73, v127, s89, v73
    v_dot2_f32_bf16 v72, v128, s89, v72
    v_dot2_f32_bf16 v73, v129, s89, v73
    v_dot2_f32_bf16 v72, v130, s89, v72
    v_dot2_f32_bf16 v73, v131, s89, v73
    v_dot2_f32_bf16 v72, v132, s89, v72
    v_dot2_f32_bf16 v73, v133, s89, v73
    v_dot2_f32_bf16 v72, v134, s89, v72
    v_dot2_f32_bf16 v73, v135, s89, v73
    v_dot2_f32_bf16 v72, v136, s89, v72
    v_dot2_f32_bf16 v73, v137, s89, v73
    v_dot2_f32_bf16 v72, v138, s89, v72
    v_dot2_f32_bf16 v73, v139, s89, v73
    v_dot2_f32_bf16 v72, v140, s89, v72
    v_dot2_f32_bf16 v73, v141, s89, v73
    v_dot2_f32_bf16 v72, v142, s89, v72
    v_dot2_f32_bf16 v73, v143, s89, v73
    s_lshl_b32 s76, s98, 7
    v_lshl_add_u32 v10, v3, 3, s76
    v_lshlrev_b32 v11, 5, v1
    v_add_f32 v72, v72, v73
    v_mov_b32 v73, v72
    s_nop 1
    v_permlane32_swap_b32 v72, v73
    v_add_f32 v72, v72, v73
    s_mov_b32 exec_hi, 0
    s_bitcmp1_b32 s100, 0
    s_cbranch_scc1 L_loc_61
    buffer_store_dword v72, v4, s[40:43], s77 offen offset:2048 sc1
    s_branch L_pubd_62
L_loc_61:
    buffer_store_dword v72, v4, s[40:43], s77 offen offset:2048
L_pubd_62:
    s_mov_b64 exec, -1
    v_max3_f32 v160, v16, v17, v18
    v_min3_f32 v162, v16, v17, v18
    v_max3_f32 v160, v160, v19, v20
    v_min3_f32 v162, v162, v19, v20
    v_max3_f32 v160, v160, v21, v22
    v_min3_f32 v162, v162, v21, v22
    v_max3_f32 v160, v160, v23, v24
    v_min3_f32 v162, v162, v23, v24
    v_max3_f32 v160, v160, v25, v26
    v_min3_f32 v162, v162, v25, v26
    v_max3_f32 v160, v160, v27, v28
    v_min3_f32 v162, v162, v27, v28
    v_max3_f32 v160, v160, v29, v30
    v_min3_f32 v162, v162, v29, v30
    v_max_f32 v160, v160, v31
    v_min_f32 v162, v162, v31
    v_max3_f32 v164, v32, v33, v34
    v_min3_f32 v166, v32, v33, v34
    v_max3_f32 v164, v164, v35, v36
    v_min3_f32 v166, v166, v35, v36
    v_max3_f32 v164, v164, v37, v38
    v_min3_f32 v166, v166, v37, v38
    v_max3_f32 v164, v164, v39, v40
    v_min3_f32 v166, v166, v39, v40
    v_max3_f32 v164, v164, v41, v42
    v_min3_f32 v166, v166, v41, v42
    v_max3_f32 v164, v164, v43, v44
    v_min3_f32 v166, v166, v43, v44
    v_max3_f32 v164, v164, v45, v46
    v_min3_f32 v166, v166, v45, v46
    v_max_f32 v164, v164, v47
    v_min_f32 v166, v166, v47
    v_mov_b32 v161, v160
    v_mov_b32 v163, v162
    v_mov_b32 v165, v164
    v_mov_b32 v167, v166
    v_permlane32_swap_b32 v160, v161
    v_permlane32_swap_b32 v162, v163
    v_permlane32_swap_b32 v164, v165
    v_permlane32_swap_b32 v166, v167
    v_max_f32 v160, v160, v161
    v_min_f32 v162, v162, v163
    v_max_f32 v164, v164, v165
    v_min_f32 v166, v166, v167
    v_mul_f32 v160, v160, v251
    v_mul_f32 v162, v162, v251
    v_mul_f32 v164, v164, v253
    v_mul_f32 v166, v166, v253
    v_pk_fma_f32 v[128:129], v[16:17], v[250:251], v[160:161] op_sel:[0,1,0] op_sel_hi:[1,1,0] neg_lo:[0,0,1] neg_hi:[0,0,1]
    v_pk_fma_f32 v[16:17], v[16:17], v[250:251], v[162:163] op_sel:[0,1,0] op_sel_hi:[1,1,0] neg_lo:[0,1,0] neg_hi:[0,1,0]
    v_pk_fma_f32 v[130:131], v[18:19], v[250:251], v[160:161] op_sel:[0,1,0] op_sel_hi:[1,1,0] neg_lo:[0,0,1] neg_hi:[0,0,1]
    v_pk_fma_f32 v[18:19], v[18:19], v[250:251], v[162:163] op_sel:[0,1,0] op_sel_hi:[1,1,0] neg_lo:[0,1,0] neg_hi:[0,1,0]
    v_pk_fma_f32 v[132:133], v[20:21], v[250:251], v[160:161] op_sel:[0,1,0] op_sel_hi:[1,1,0] neg_lo:[0,0,1] neg_hi:[0,0,1]
    v_pk_fma_f32 v[20:21], v[20:21], v[250:251], v[162:163] op_sel:[0,1,0] op_sel_hi:[1,1,0] neg_lo:[0,1,0] neg_hi:[0,1,0]
    v_pk_fma_f32 v[134:135], v[22:23], v[250:251], v[160:161] op_sel:[0,1,0] op_sel_hi:[1,1,0] neg_lo:[0,0,1] neg_hi:[0,0,1]
    v_pk_fma_f32 v[22:23], v[22:23], v[250:251], v[162:163] op_sel:[0,1,0] op_sel_hi:[1,1,0] neg_lo:[0,1,0] neg_hi:[0,1,0]
    v_pk_fma_f32 v[136:137], v[24:25], v[250:251], v[160:161] op_sel:[0,1,0] op_sel_hi:[1,1,0] neg_lo:[0,0,1] neg_hi:[0,0,1]
    v_pk_fma_f32 v[24:25], v[24:25], v[250:251], v[162:163] op_sel:[0,1,0] op_sel_hi:[1,1,0] neg_lo:[0,1,0] neg_hi:[0,1,0]
    v_pk_fma_f32 v[138:139], v[26:27], v[250:251], v[160:161] op_sel:[0,1,0] op_sel_hi:[1,1,0] neg_lo:[0,0,1] neg_hi:[0,0,1]
    v_pk_fma_f32 v[26:27], v[26:27], v[250:251], v[162:163] op_sel:[0,1,0] op_sel_hi:[1,1,0] neg_lo:[0,1,0] neg_hi:[0,1,0]
    v_pk_fma_f32 v[140:141], v[28:29], v[250:251], v[160:161] op_sel:[0,1,0] op_sel_hi:[1,1,0] neg_lo:[0,0,1] neg_hi:[0,0,1]
    v_pk_fma_f32 v[28:29], v[28:29], v[250:251], v[162:163] op_sel:[0,1,0] op_sel_hi:[1,1,0] neg_lo:[0,1,0] neg_hi:[0,1,0]
    v_pk_fma_f32 v[142:143], v[30:31], v[250:251], v[160:161] op_sel:[0,1,0] op_sel_hi:[1,1,0] neg_lo:[0,0,1] neg_hi:[0,0,1]
    v_pk_fma_f32 v[30:31], v[30:31], v[250:251], v[162:163] op_sel:[0,1,0] op_sel_hi:[1,1,0] neg_lo:[0,1,0] neg_hi:[0,1,0]
    v_pk_fma_f32 v[144:145], v[32:33], v[252:253], v[164:165] op_sel:[0,1,0] op_sel_hi:[1,1,0] neg_lo:[0,0,1] neg_hi:[0,0,1]
    v_pk_fma_f32 v[32:33], v[32:33], v[252:253], v[166:167] op_sel:[0,1,0] op_sel_hi:[1,1,0] neg_lo:[0,1,0] neg_hi:[0,1,0]
    v_pk_fma_f32 v[146:147], v[34:35], v[252:253], v[164:165] op_sel:[0,1,0] op_sel_hi:[1,1,0] neg_lo:[0,0,1] neg_hi:[0,0,1]
    v_pk_fma_f32 v[34:35], v[34:35], v[252:253], v[166:167] op_sel:[0,1,0] op_sel_hi:[1,1,0] neg_lo:[0,1,0] neg_hi:[0,1,0]
    v_pk_fma_f32 v[148:149], v[36:37], v[252:253], v[164:165] op_sel:[0,1,0] op_sel_hi:[1,1,0] neg_lo:[0,0,1] neg_hi:[0,0,1]
    v_pk_fma_f32 v[36:37], v[36:37], v[252:253], v[166:167] op_sel:[0,1,0] op_sel_hi:[1,1,0] neg_lo:[0,1,0] neg_hi:[0,1,0]
    v_pk_fma_f32 v[150:151], v[38:39], v[252:253], v[164:165] op_sel:[0,1,0] op_sel_hi:[1,1,0] neg_lo:[0,0,1] neg_hi:[0,0,1]
    v_pk_fma_f32 v[38:39], v[38:39], v[252:253], v[166:167] op_sel:[0,1,0] op_sel_hi:[1,1,0] neg_lo:[0,1,0] neg_hi:[0,1,0]
    v_pk_fma_f32 v[152:153], v[40:41], v[252:253], v[164:165] op_sel:[0,1,0] op_sel_hi:[1,1,0] neg_lo:[0,0,1] neg_hi:[0,0,1]
    v_pk_fma_f32 v[40:41], v[40:41], v[252:253], v[166:167] op_sel:[0,1,0] op_sel_hi:[1,1,0] neg_lo:[0,1,0] neg_hi:[0,1,0]
    v_pk_fma_f32 v[154:155], v[42:43], v[252:253], v[164:165] op_sel:[0,1,0] op_sel_hi:[1,1,0] neg_lo:[0,0,1] neg_hi:[0,0,1]
    v_pk_fma_f32 v[42:43], v[42:43], v[252:253], v[166:167] op_sel:[0,1,0] op_sel_hi:[1,1,0] neg_lo:[0,1,0] neg_hi:[0,1,0]
    v_pk_fma_f32 v[156:157], v[44:45], v[252:253], v[164:165] op_sel:[0,1,0] op_sel_hi:[1,1,0] neg_lo:[0,0,1] neg_hi:[0,0,1]
    v_pk_fma_f32 v[44:45], v[44:45], v[252:253], v[166:167] op_sel:[0,1,0] op_sel_hi:[1,1,0] neg_lo:[0,1,0] neg_hi:[0,1,0]
    v_pk_fma_f32 v[158:159], v[46:47], v[252:253], v[164:165] op_sel:[0,1,0] op_sel_hi:[1,1,0] neg_lo:[0,0,1] neg_hi:[0,0,1]
    v_pk_fma_f32 v[46:47], v[46:47], v[252:253], v[166:167] op_sel:[0,1,0] op_sel_hi:[1,1,0] neg_lo:[0,1,0] neg_hi:[0,1,0]
    v_exp_f32 v128, v128
    v_exp_f32 v16, v16
    v_exp_f32 v129, v129
    v_exp_f32 v17, v17
    v_exp_f32 v130, v130
    v_exp_f32 v18, v18
    v_exp_f32 v131, v131
    v_exp_f32 v19, v19
    v_exp_f32 v132, v132
    v_exp_f32 v20, v20
    v_exp_f32 v133, v133
    v_exp_f32 v21, v21
    v_exp_f32 v134, v134
    v_exp_f32 v22, v22
    v_exp_f32 v135, v135
    v_exp_f32 v23, v23
    v_exp_f32 v136, v136
    v_exp_f32 v24, v24
    v_exp_f32 v137, v137
    v_exp_f32 v25, v25
    v_exp_f32 v138, v138
    v_exp_f32 v26, v26
    v_exp_f32 v139, v139
    v_exp_f32 v27, v27
    v_exp_f32 v140, v140
    v_exp_f32 v28, v28
    v_exp_f32 v141, v141
    v_exp_f32 v29, v29
    v_exp_f32 v142, v142
    v_exp_f32 v30, v30
    v_exp_f32 v143, v143
    v_exp_f32 v31, v31
    v_cvt_pk_bf16_f32 v218, v128, v129
    v_cvt_pk_bf16_f32 v219, v130, v131
    v_cvt_pk_bf16_f32 v220, v132, v133
    v_cvt_pk_bf16_f32 v221, v134, v135
    v_cvt_pk_bf16_f32 v222, v136, v137
    v_cvt_pk_bf16_f32 v223, v138, v139
    v_cvt_pk_bf16_f32 v224, v140, v141
    v_cvt_pk_bf16_f32 v225, v142, v143
    v_cvt_pk_bf16_f32 v226, v16, v17
    v_cvt_pk_bf16_f32 v227, v18, v19
    v_cvt_pk_bf16_f32 v228, v20, v21
    v_cvt_pk_bf16_f32 v229, v22, v23
    v_cvt_pk_bf16_f32 v230, v24, v25
    v_cvt_pk_bf16_f32 v231, v26, v27
    v_cvt_pk_bf16_f32 v232, v28, v29
    v_cvt_pk_bf16_f32 v233, v30, v31
    v_exp_f32 v144, v144
    v_exp_f32 v32, v32
    v_exp_f32 v145, v145
    v_exp_f32 v33, v33
    v_exp_f32 v146, v146
    v_exp_f32 v34, v34
    v_exp_f32 v147, v147
    v_exp_f32 v35, v35
    v_exp_f32 v148, v148
    v_exp_f32 v36, v36
    v_exp_f32 v149, v149
    v_exp_f32 v37, v37
    v_exp_f32 v150, v150
    v_exp_f32 v38, v38
    v_exp_f32 v151, v151
    v_exp_f32_e64 v39, v39
    s_barrier
    buffer_load_dwordx4 v[48:51], v13, s[40:43], s78 offen offset:3072 sc1
    buffer_load_dwordx4 v[52:55], v13, s[40:43], s79 offen offset:3072 sc1
    buffer_load_dwordx4 v[56:59], v13, s[40:43], s78 offen offset:3200 sc1
    buffer_load_dwordx4 v[60:63], v13, s[40:43], s79 offen offset:3200 sc1
    ds_read_b128 v[168:171], v216 offset:24576
    ds_read_b128 v[172:175], v216 offset:24608
    ds_read_b128 v[176:179], v216 offset:24640
    ds_read_b128 v[180:183], v216 offset:24672
    v_exp_f32 v152, v152
    v_exp_f32 v40, v40
    v_exp_f32 v153, v153
    v_exp_f32 v41, v41
    v_exp_f32 v154, v154
    v_exp_f32 v42, v42
    v_exp_f32 v155, v155
    v_exp_f32 v43, v43
    v_exp_f32 v156, v156
    v_exp_f32_e64 v44, v44
    s_waitcnt lgkmcnt(0)
    v_mfma_f32_32x32x16_bf16 v[64:79], v[168:171], v[218:221], 0
    v_exp_f32 v157, v157
    v_exp_f32 v45, v45
    v_exp_f32_e64 v158, v158
    v_mfma_f32_32x32x16_bf16 v[80:95], v[176:179], v[226:229], 0
    v_exp_f32 v46, v46
    v_exp_f32 v159, v159
    v_exp_f32_e64 v47, v47
    v_mfma_f32_32x32x16_bf16 v[64:79], v[172:175], v[222:225], v[64:79]
    v_cvt_pk_bf16_f32 v234, v144, v145
    v_cvt_pk_bf16_f32 v235, v146, v147
    v_cvt_pk_bf16_f32 v236, v148, v149
    v_cvt_pk_bf16_f32 v237, v150, v151
    v_cvt_pk_bf16_f32 v238, v152, v153
    v_cvt_pk_bf16_f32 v239, v154, v155
    v_mfma_f32_32x32x16_bf16 v[80:95], v[180:183], v[230:233], v[80:95]
    v_cvt_pk_bf16_f32 v240, v156, v157
    v_cvt_pk_bf16_f32 v241, v158, v159
    v_cvt_pk_bf16_f32 v242, v32, v33
    v_cvt_pk_bf16_f32 v243, v34, v35
    v_cvt_pk_bf16_f32 v244, v36, v37
    v_cvt_pk_bf16_f32 v245, v38, v39
    v_cvt_pk_bf16_f32 v246, v40, v41
    v_cvt_pk_bf16_f32 v247, v42, v43
    v_cvt_pk_bf16_f32 v248, v44, v45
    v_cvt_pk_bf16_f32 v249, v46, v47
    v_mfma_f32_32x32x16_bf16 v[96:111], v[168:171], v[234:237], 0
    v_rcp_f32 v184, v65
    v_rcp_f32 v185, v81
    v_mul_f32 v6, v64, v184
    v_fmac_f32 v6, v80, v185
    v_add_f32 v6, 0x358637bd, v6
    v_mfma_f32_32x32x16_bf16 v[112:127], v[176:179], v[242:245], 0
    v_rcp_f32 v6, v6
    v_mov_b32 v8, 0
    v_mul_f32 v184, v184, v6
    v_mul_f32_e64 v185, v185, v6
    s_lshl4_add_u32 s76, s60, s61
    v_mfma_f32_32x32x16_bf16 v[96:111], v[172:175], v[238:241], v[96:111]
    s_mul_i32 s76, s76, 32768
    s_lshl2_add_u32 s77, s63, s64
    s_lshl_b32 s77, s77, 12
    s_add_u32 s76, s76, s77
    s_add_u32 s76, s76, 16777216
    v_mfma_f32_32x32x16_bf16 v[112:127], v[180:183], v[246:249], v[112:127]
    s_add_u32 s77, s76, 8192
    v_add_u32 v14, 128, v12
    v_cmp_gt_u32 vcc, 24, v1
    s_nop 0
    s_nop 0
    v_cndmask_b32_e64 v14, v14, v12, vcc
    s_mov_b32 s88, 0
    s_branch L_pfirst_64
L_poll_63:
    buffer_load_dwordx4 v[48:51], v13, s[40:43], s78 offen offset:3072 sc1
    buffer_load_dwordx4 v[52:55], v13, s[40:43], s79 offen offset:3072 sc1
    buffer_load_dwordx4 v[56:59], v13, s[40:43], s78 offen offset:3200 sc1
    buffer_load_dwordx4 v[60:63], v13, s[40:43], s79 offen offset:3200 sc1
L_pfirst_64:
    s_waitcnt vmcnt(0)
    v_max3_u32 v9, v48, v49, v50
    v_max3_u32 v9, v9, v51, v52
    v_max3_u32 v9, v9, v53, v54
    v_max3_u32 v9, v9, v55, v56
    v_max3_u32 v9, v9, v57, v58
    v_max3_u32 v9, v9, v59, v60
    v_max3_u32 v9, v9, v61, v62
    v_max_u32 v9, v9, v63
    v_cmp_eq_u32 vcc, -1, v9
    s_nop 0
    s_cbranch_vccz L_ok_65
    s_add_u32 s88, s88, 1
    s_cmp_lt_u32 s88, 65536
    s_cbranch_scc1 L_poll_63
L_ok_65:
    v_mfma_f32_32x32x16_bf16 v[16:31], v[48:51], v[218:221], 0
    s_barrier
    v_rcp_f32 v186, v97
    v_rcp_f32 v187, v113
    v_mul_f32_e64 v7, v96, v186
    v_mfma_f32_32x32x16_bf16 v[128:143], v[56:59], v[226:229], 0
    v_fmac_f32_e64 v7, v112, v187
    v_add_f32 v7, 0x358637bd, v7
    v_rcp_f32_e64 v7, v7
    v_bfe_u32 v4, v2, 1, 3
    v_lshlrev_b32_e64 v4, 4, v4
    v_mfma_f32_32x32x16_bf16 v[16:31], v[52:55], v[222:225], v[16:31]
    v_mov_b32 v8, 0
    v_mul_f32 v186, v186, v7
    v_mul_f32_e64 v187, v187, v7
    v_lshl_add_u32 v4, v3, 3, v4
    v_lshl_add_u32 v4, v2, 7, v4
    s_lshl_b32 s56, s62, 12
    v_mfma_f32_32x32x16_bf16 v[128:143], v[60:63], v[230:233], v[128:143]
    s_add_u32 s57, s56, 0
    v_add_u32 v64, s57, v4
    v_xor_b32 v65, 16, v64
    v_xor_b32 v66, 32, v64
    v_xor_b32 v67, 48, v64
    v_xor_b32_e64 v68, 64, v64
    v_mfma_f32_32x32x16_bf16 v[32:47], v[48:51], v[234:237], 0
    v_xor_b32 v69, 80, v64
    v_xor_b32 v70, 96, v64
    v_xor_b32 v71, 112, v64
    v_bfe_u32 v4, v1, 2, 2
    v_lshl_add_u32 v5, v3, 2, v4
    v_lshlrev_b32 v5, 7, v5
    s_bitcmp1_b32 s100, 2
    v_mfma_f32_32x32x16_bf16 v[144:159], v[56:59], v[242:245], 0
    v_mul_f32 v16, v16, v184
    v_mul_f32 v17, v17, v184
    v_mul_f32 v18, v18, v184
    v_mul_f32 v19, v19, v184
    v_mul_f32 v20, v20, v184
    v_mul_f32 v21, v21, v184
    v_mfma_f32_32x32x16_bf16 v[32:47], v[52:55], v[238:241], v[32:47]
    v_mul_f32 v22, v22, v184
    v_mul_f32 v23, v23, v184
    v_mul_f32 v24, v24, v184
    v_mul_f32 v25, v25, v184
    v_mul_f32 v26, v26, v184
    v_mul_f32 v27, v27, v184
    v_mfma_f32_32x32x16_bf16 v[144:159], v[60:63], v[246:249], v[144:159]
    v_mul_f32 v28, v28, v184
    v_mul_f32 v29, v29, v184
    v_mul_f32 v30, v30, v184
    v_mul_f32 v31, v31, v184
    v_fmac_f32 v16, v128, v185
    v_fmac_f32 v17, v129, v185
    v_cvt_pk_bf16_f32 v96, v16, v17
    v_fmac_f32 v18, v130, v185
    v_fmac_f32 v19, v131, v185
    v_cvt_pk_bf16_f32 v97, v18, v19
    v_fmac_f32 v20, v132, v185
    v_fmac_f32 v21, v133, v185
    v_cvt_pk_bf16_f32 v98, v20, v21
    v_fmac_f32 v22, v134, v185
    v_fmac_f32 v23, v135, v185
    v_cvt_pk_bf16_f32 v99, v22, v23
    buffer_store_dwordx4 v[96:99], v14, s[40:43], s76 offen offset:0 sc1
    v_fmac_f32 v24, v136, v185
    v_fmac_f32 v25, v137, v185
    v_cvt_pk_bf16_f32 v100, v24, v25
    v_fmac_f32 v26, v138, v185
    v_fmac_f32 v27, v139, v185
    v_cvt_pk_bf16_f32 v101, v26, v27
    v_fmac_f32 v28, v140, v185
    v_fmac_f32 v29, v141, v185
    v_cvt_pk_bf16_f32 v102, v28, v29
    v_fmac_f32 v30, v142, v185
    v_fmac_f32 v31, v143, v185
    v_cvt_pk_bf16_f32 v103, v30, v31
    buffer_store_dwordx4 v[100:103], v14, s[40:43], s76 offen offset:2048 sc1
    v_pk_mul_f32 v[32:33], v[32:33], v[186:187] op_sel_hi:[1,0]
    v_pk_fma_f32 v[32:33], v[144:145], v[186:187], v[32:33] op_sel:[0,1,0] op_sel_hi:[1,1,1]
    v_cvt_pk_bf16_f32 v104, v32, v33
    v_pk_mul_f32 v[34:35], v[34:35], v[186:187] op_sel_hi:[1,0]
    v_pk_fma_f32 v[34:35], v[146:147], v[186:187], v[34:35] op_sel:[0,1,0] op_sel_hi:[1,1,1]
    v_cvt_pk_bf16_f32 v105, v34, v35
    v_pk_mul_f32 v[36:37], v[36:37], v[186:187] op_sel_hi:[1,0]
    v_pk_fma_f32 v[36:37], v[148:149], v[186:187], v[36:37] op_sel:[0,1,0] op_sel_hi:[1,1,1]
    v_cvt_pk_bf16_f32 v106, v36, v37
    v_pk_mul_f32 v[38:39], v[38:39], v[186:187] op_sel_hi:[1,0]
    v_pk_fma_f32 v[38:39], v[150:151], v[186:187], v[38:39] op_sel:[0,1,0] op_sel_hi:[1,1,1]
    v_cvt_pk_bf16_f32 v107, v38, v39
    buffer_store_dwordx4 v[104:107], v14, s[40:43], s77 offen offset:0 sc1
    v_pk_mul_f32 v[40:41], v[40:41], v[186:187] op_sel_hi:[1,0]
    v_pk_fma_f32 v[40:41], v[152:153], v[186:187], v[40:41] op_sel:[0,1,0] op_sel_hi:[1,1,1]
    v_cvt_pk_bf16_f32 v108, v40, v41
    v_pk_mul_f32 v[42:43], v[42:43], v[186:187] op_sel_hi:[1,0]
    v_pk_fma_f32 v[42:43], v[154:155], v[186:187], v[42:43] op_sel:[0,1,0] op_sel_hi:[1,1,1]
    v_cvt_pk_bf16_f32 v109, v42, v43
    v_pk_mul_f32 v[44:45], v[44:45], v[186:187] op_sel_hi:[1,0]
    v_pk_fma_f32 v[44:45], v[156:157], v[186:187], v[44:45] op_sel:[0,1,0] op_sel_hi:[1,1,1]
    v_cvt_pk_bf16_f32 v110, v44, v45
    v_pk_mul_f32 v[46:47], v[46:47], v[186:187] op_sel_hi:[1,0]
    v_pk_fma_f32 v[46:47], v[158:159], v[186:187], v[46:47] op_sel:[0,1,0] op_sel_hi:[1,1,1]
    v_cvt_pk_bf16_f32 v111, v46, v47
    buffer_store_dwordx4 v[108:111], v14, s[40:43], s77 offen offset:2048 sc1
    v_lshrrev_b32_e64 v4, 1, v4
    v_lshl_add_u32 v5, v4, 6, v5
    v_bfe_u32 v4, v1, 4, 1
    v_lshl_add_u32 v5, v4, 5, v5
    v_and_b32_e64 v4, 3, v1
    v_lshl_add_u32 v5, v4, 3, v5
    v_add_u32 v72, 32768, v5
    v_xor_b32_e64 v73, 64, v72
    s_mul_i32 s80, s97, 524288
    s_mul_i32 s56, s62, 8192
    s_add_u32 s80, s80, s56
    s_add_u32 s80, s80, 16777216
    v_add_u32 v78, 4096, v14
    v_mov_b32 v74, 1
    s_mov_b32 s52, 0xffff
    s_mov_b32 s53, 0
    s_barrier
    ds_read_b32 v79, v8 offset:25984
    ds_read_b64 v[88:89], v64
    ds_read_b64 v[90:91], v65
    ds_read_b64 v[92:93], v66
    ds_read_b64 v[94:95], v67
    ds_read_b64 v[96:97], v68
    ds_read_b64 v[98:99], v69
    ds_read_b64 v[100:101], v70
    ds_read_b64 v[102:103], v71
    s_waitcnt lgkmcnt(8)
    v_readfirstlane_b32 s76, v79
    s_nop 0
    s_and_b32 s76, s76, s52
    s_cbranch_scc0 L_tr0
L_bk0:
    s_ff1_i32_b32 s76, s76
    s_bitset0_b32 s52, s76
    s_add_u32 s77, s76, s65
    s_and_b32 s77, s77, 15
    s_mul_i32 s77, s77, 32768
    s_add_u32 s28, s77, s80
    s_add_u32 s76, s76, 3
    s_and_b32 s76, s76, 15
    s_lshl_b32 s4, s76, 13
    buffer_load_dwordx4 v[128:131], v14, s[40:43], s28 offen offset:0 sc1
    buffer_load_dwordx4 v[132:135], v14, s[40:43], s28 offen offset:2048 sc1
    buffer_load_dwordx4 v[136:139], v78, s[40:43], s28 offen offset:0 sc1
    buffer_load_dwordx4 v[140:143], v78, s[40:43], s28 offen offset:2048 sc1
    v_readfirstlane_b32 s76, v79
    s_nop 0
    s_and_b32 s76, s76, s52
    s_cbranch_scc0 L_tr1
L_bk1:
    s_ff1_i32_b32 s76, s76
    s_bitset0_b32 s52, s76
    s_add_u32 s77, s76, s65
    s_and_b32 s77, s77, 15
    s_mul_i32 s77, s77, 32768
    s_add_u32 s29, s77, s80
    s_add_u32 s76, s76, 3
    s_and_b32 s76, s76, 15
    s_lshl_b32 s5, s76, 13
    buffer_load_dwordx4 v[144:147], v14, s[40:43], s29 offen offset:0 sc1
    buffer_load_dwordx4 v[148:151], v14, s[40:43], s29 offen offset:2048 sc1
    v_add_u32 v80, s4, v72
    v_add_u32 v81, s4, v73
    s_waitcnt lgkmcnt(0)
    v_lshlrev_b32 v16, 16, v88
    v_and_b32 v17, s90, v88
    v_lshlrev_b32 v18, 16, v89
    v_and_b32 v19, s90, v89
    v_lshlrev_b32 v20, 16, v90
    v_and_b32 v21, s90, v90
    v_lshlrev_b32 v22, 16, v91
    v_and_b32 v23, s90, v91
    v_lshlrev_b32 v24, 16, v92
    v_and_b32 v25, s90, v92
    v_lshlrev_b32 v26, 16, v93
    v_and_b32 v27, s90, v93
    v_lshlrev_b32 v28, 16, v94
    v_and_b32 v29, s90, v94
    v_lshlrev_b32 v30, 16, v95
    v_and_b32 v31, s90, v95
    v_lshlrev_b32 v32, 16, v96
    v_and_b32 v33, s90, v96
    v_lshlrev_b32 v34, 16, v97
    v_and_b32 v35, s90, v97
    v_lshlrev_b32 v36, 16, v98
    v_and_b32 v37, s90, v98
    v_lshlrev_b32 v38, 16, v99
    v_and_b32 v39, s90, v99
    v_lshlrev_b32 v40, 16, v100
    v_and_b32 v41, s90, v100
    v_lshlrev_b32 v42, 16, v101
    v_and_b32 v43, s90, v101
    v_lshlrev_b32 v44, 16, v102
    v_and_b32 v45, s90, v102
    v_lshlrev_b32 v46, 16, v103
    v_and_b32 v47, s90, v103
    s_cmp_eq_u32 s53, 0
    s_cbranch_scc0 L_sent_66
    s_waitcnt vmcnt(6)
    s_mov_b64 exec, 1
    ds_add_u32 v8, v74 offset:25988
    s_mov_b64 exec, -1
    s_mov_b32 s53, 1
L_sent_66:
    ds_read_b32 v79, v8 offset:25984
    ds_read_b64_tr_b16 v[104:105], v80 offset:0
    ds_read_b64_tr_b16 v[106:107], v80 offset:1024
    ds_read_b64_tr_b16 v[108:109], v81 offset:0
    ds_read_b64_tr_b16 v[110:111], v81 offset:1024
    ds_read_b64_tr_b16 v[112:113], v80 offset:2048
    ds_read_b64_tr_b16 v[114:115], v80 offset:3072
    ds_read_b64_tr_b16 v[116:117], v81 offset:2048
    ds_read_b64_tr_b16 v[118:119], v81 offset:3072
    s_waitcnt vmcnt(5) lgkmcnt(4)
    v_mfma_f32_32x32x16_bf16 v[16:31], v[104:107], v[128:131], v[16:31]
    ds_read_b64_tr_b16 v[120:121], v80 offset:4096
    ds_read_b64_tr_b16 v[122:123], v80 offset:5120
    buffer_load_dwordx4 v[152:155], v78, s[40:43], s29 offen offset:0 sc1
    v_mfma_f32_32x32x16_bf16 v[32:47], v[108:111], v[128:131], v[32:47]
    ds_read_b64_tr_b16 v[124:125], v81 offset:4096
    ds_read_b64_tr_b16 v[126:127], v81 offset:5120
    buffer_load_dwordx4 v[156:159], v78, s[40:43], s29 offen offset:2048 sc1
    v_readfirstlane_b32 s76, v79
    s_nop 0
    s_and_b32 s76, s76, s52
    s_cbranch_scc0 L_tr2
L_bk2:
    s_ff1_i32_b32 s76, s76
    s_bitset0_b32 s52, s76
    s_add_u32 s77, s76, s65
    s_and_b32 s77, s77, 15
    s_mul_i32 s77, s77, 32768
    s_add_u32 s30, s77, s80
    s_waitcnt vmcnt(6) lgkmcnt(4)
    v_mfma_f32_32x32x16_bf16 v[16:31], v[112:115], v[132:135], v[16:31]
    ds_read_b32 v79, v8 offset:25984
    ds_read_b64_tr_b16 v[104:105], v80 offset:6144
    ds_read_b64_tr_b16 v[106:107], v80 offset:7168
    buffer_load_dwordx4 v[160:163], v14, s[40:43], s30 offen offset:0 sc1
    s_add_u32 s76, s76, 3
    s_and_b32 s76, s76, 15
    s_lshl_b32 s6, s76, 13
    v_mfma_f32_32x32x16_bf16 v[32:47], v[116:119], v[132:135], v[32:47]
    ds_read_b64_tr_b16 v[108:109], v81 offset:6144
    ds_read_b64_tr_b16 v[110:111], v81 offset:7168
    buffer_load_dwordx4 v[164:167], v14, s[40:43], s30 offen offset:2048 sc1
    v_add_u32 v82, s5, v72
    v_add_u32_e64 v83, s5, v73
    s_waitcnt vmcnt(7) lgkmcnt(4)
    v_mfma_f32_32x32x16_bf16 v[16:31], v[120:123], v[136:139], v[16:31]
    ds_read_b64_tr_b16 v[112:113], v82 offset:0
    ds_read_b64_tr_b16 v[114:115], v82 offset:1024
    buffer_load_dwordx4 v[168:171], v78, s[40:43], s30 offen offset:0 sc1
    v_mfma_f32_32x32x16_bf16 v[32:47], v[124:127], v[136:139], v[32:47]
    ds_read_b64_tr_b16 v[116:117], v83 offset:0
    ds_read_b64_tr_b16 v[118:119], v83 offset:1024
    buffer_load_dwordx4 v[172:175], v78, s[40:43], s30 offen offset:2048 sc1
    v_readfirstlane_b32 s76, v79
    s_nop 0
    s_and_b32 s76, s76, s52
    s_cbranch_scc0 L_tr3
L_bk3:
    s_ff1_i32_b32 s76, s76
    s_bitset0_b32 s52, s76
    s_add_u32 s77, s76, s65
    s_and_b32 s77, s77, 15
    s_mul_i32 s77, s77, 32768
    s_add_u32 s31, s77, s80
    s_waitcnt vmcnt(8) lgkmcnt(4)
    v_mfma_f32_32x32x16_bf16 v[16:31], v[104:107], v[140:143], v[16:31]
    ds_read_b32 v79, v8 offset:25984
    ds_read_b64_tr_b16 v[120:121], v82 offset:2048
    ds_read_b64_tr_b16 v[122:123], v82 offset:3072
    buffer_load_dwordx4 v[176:179], v14, s[40:43], s31 offen offset:0 sc1
    s_add_u32 s76, s76, 3
    s_and_b32 s76, s76, 15
    s_lshl_b32 s7, s76, 13
    v_mfma_f32_32x32x16_bf16 v[32:47], v[108:111], v[140:143], v[32:47]
    ds_read_b64_tr_b16 v[124:125], v83 offset:2048
    ds_read_b64_tr_b16 v[126:127], v83 offset:3072
    buffer_load_dwordx4 v[180:183], v14, s[40:43], s31 offen offset:2048 sc1
    s_waitcnt vmcnt(9) lgkmcnt(4)
    v_mfma_f32_32x32x16_bf16 v[16:31], v[112:115], v[144:147], v[16:31]
    ds_read_b64_tr_b16 v[104:105], v82 offset:4096
    ds_read_b64_tr_b16 v[106:107], v82 offset:5120
    buffer_load_dwordx4 v[184:187], v78, s[40:43], s31 offen offset:0 sc1
    v_mfma_f32_32x32x16_bf16 v[32:47], v[116:119], v[144:147], v[32:47]
    ds_read_b64_tr_b16 v[108:109], v83 offset:4096
    ds_read_b64_tr_b16 v[110:111], v83 offset:5120
    buffer_load_dwordx4 v[188:191], v78, s[40:43], s31 offen offset:2048 sc1
    v_readfirstlane_b32 s76, v79
    s_nop 0
    s_and_b32 s76, s76, s52
    s_cbranch_scc0 L_tr4
L_bk4:
    s_ff1_i32_b32 s76, s76
    s_bitset0_b32 s52, s76
    s_add_u32 s77, s76, s65
    s_and_b32 s77, s77, 15
    s_mul_i32 s77, s77, 32768
    s_add_u32 s32, s77, s80
    s_waitcnt vmcnt(10) lgkmcnt(4)
    v_mfma_f32_32x32x16_bf16 v[16:31], v[120:123], v[148:151], v[16:31]
    ds_read_b64_tr_b16 v[112:113], v82 offset:6144
    ds_read_b64_tr_b16 v[114:115], v82 offset:7168
    buffer_load_dwordx4 v[128:131], v14, s[40:43], s32 offen offset:0 sc1
    s_add_u32 s76, s76, 3
    s_and_b32 s76, s76, 15
    s_lshl_b32 s8, s76, 13
    v_mfma_f32_32x32x16_bf16 v[32:47], v[124:127], v[148:151], v[32:47]
    ds_read_b64_tr_b16 v[116:117], v83 offset:6144
    ds_read_b64_tr_b16 v[118:119], v83 offset:7168
    buffer_load_dwordx4 v[132:135], v14, s[40:43], s32 offen offset:2048 sc1
    v_add_u32 v80, s6, v72
    v_add_u32 v81, s6, v73
    s_waitcnt vmcnt(11) lgkmcnt(4)
    v_mfma_f32_32x32x16_bf16 v[16:31], v[104:107], v[152:155], v[16:31]
    ds_read_b32 v79, v8 offset:25984
    ds_read_b64_tr_b16 v[120:121], v80 offset:0
    ds_read_b64_tr_b16 v[122:123], v80 offset:1024
    buffer_load_dwordx4 v[136:139], v78, s[40:43], s32 offen offset:0 sc1
    v_mfma_f32_32x32x16_bf16 v[32:47], v[108:111], v[152:155], v[32:47]
    ds_read_b64_tr_b16 v[124:125], v81 offset:0
    ds_read_b64_tr_b16 v[126:127], v81 offset:1024
    s_waitcnt vmcnt(11) lgkmcnt(4)
    v_mfma_f32_32x32x16_bf16 v[16:31], v[112:115], v[156:159], v[16:31]
    ds_read_b64_tr_b16 v[104:105], v80 offset:2048
    ds_read_b64_tr_b16 v[106:107], v80 offset:3072
    buffer_load_dwordx4 v[140:143], v78, s[40:43], s32 offen offset:2048 sc1
    v_mfma_f32_32x32x16_bf16 v[32:47], v[116:119], v[156:159], v[32:47]
    ds_read_b64_tr_b16 v[108:109], v81 offset:2048
    ds_read_b64_tr_b16 v[110:111], v81 offset:3072
    v_readfirstlane_b32 s76, v79
    s_nop 0
    s_and_b32 s76, s76, s52
    s_cbranch_scc0 L_tr5
L_bk5:
    s_ff1_i32_b32 s76, s76
    s_bitset0_b32 s52, s76
    s_add_u32 s77, s76, s65
    s_and_b32 s77, s77, 15
    s_mul_i32 s77, s77, 32768
    s_add_u32 s33, s77, s80
    s_waitcnt vmcnt(11) lgkmcnt(4)
    v_mfma_f32_32x32x16_bf16 v[16:31], v[120:123], v[160:163], v[16:31]
    ds_read_b64_tr_b16 v[112:113], v80 offset:4096
    ds_read_b64_tr_b16 v[114:115], v80 offset:5120
    buffer_load_dwordx4 v[144:147], v14, s[40:43], s33 offen offset:0 sc1
    s_add_u32 s76, s76, 3
    s_and_b32 s76, s76, 15
    s_lshl_b32 s9, s76, 13
    v_mfma_f32_32x32x16_bf16 v[32:47], v[124:127], v[160:163], v[32:47]
    ds_read_b64_tr_b16 v[116:117], v81 offset:4096
    ds_read_b64_tr_b16 v[118:119], v81 offset:5120
    s_waitcnt vmcnt(11) lgkmcnt(4)
    v_mfma_f32_32x32x16_bf16 v[16:31], v[104:107], v[164:167], v[16:31]
    ds_read_b64_tr_b16 v[120:121], v80 offset:6144
    ds_read_b64_tr_b16 v[122:123], v80 offset:7168
    buffer_load_dwordx4 v[148:151], v14, s[40:43], s33 offen offset:2048 sc1
    v_mfma_f32_32x32x16_bf16 v[32:47], v[108:111], v[164:167], v[32:47]
    ds_read_b64_tr_b16 v[124:125], v81 offset:6144
    ds_read_b64_tr_b16 v[126:127], v81 offset:7168
    v_add_u32 v82, s7, v72
    v_add_u32 v83, s7, v73
    s_waitcnt vmcnt(11) lgkmcnt(4)
    v_mfma_f32_32x32x16_bf16 v[16:31], v[112:115], v[168:171], v[16:31]
    ds_read_b32 v79, v8 offset:25984
    ds_read_b64_tr_b16 v[104:105], v82 offset:0
    ds_read_b64_tr_b16 v[106:107], v82 offset:1024
    buffer_load_dwordx4 v[152:155], v78, s[40:43], s33 offen offset:0 sc1
    v_mfma_f32_32x32x16_bf16 v[32:47], v[116:119], v[168:171], v[32:47]
    ds_read_b64_tr_b16 v[108:109], v83 offset:0
    ds_read_b64_tr_b16 v[110:111], v83 offset:1024
    s_waitcnt vmcnt(11) lgkmcnt(4)
    v_mfma_f32_32x32x16_bf16 v[16:31], v[120:123], v[172:175], v[16:31]
    ds_read_b64_tr_b16 v[112:113], v82 offset:2048
    ds_read_b64_tr_b16 v[114:115], v82 offset:3072
    buffer_load_dwordx4 v[156:159], v78, s[40:43], s33 offen offset:2048 sc1
    v_mfma_f32_32x32x16_bf16 v[32:47], v[124:127], v[172:175], v[32:47]
    ds_read_b64_tr_b16 v[116:117], v83 offset:2048
    ds_read_b64_tr_b16 v[118:119], v83 offset:3072
    v_readfirstlane_b32 s76, v79
    s_nop 0
    s_and_b32 s76, s76, s52
    s_cbranch_scc0 L_tr6
L_bk6:
    s_ff1_i32_b32 s76, s76
    s_bitset0_b32 s52, s76
    s_add_u32 s77, s76, s65
    s_and_b32 s77, s77, 15
    s_mul_i32 s77, s77, 32768
    s_add_u32 s34, s77, s80
    s_waitcnt vmcnt(11) lgkmcnt(4)
    v_mfma_f32_32x32x16_bf16 v[16:31], v[104:107], v[176:179], v[16:31]
    ds_read_b64_tr_b16 v[120:121], v82 offset:4096
    ds_read_b64_tr_b16 v[122:123], v82 offset:5120
    buffer_load_dwordx4 v[160:163], v14, s[40:43], s34 offen offset:0 sc1
    s_add_u32 s76, s76, 3
    s_and_b32 s76, s76, 15
    s_lshl_b32 s10, s76, 13
    v_mfma_f32_32x32x16_bf16 v[32:47], v[108:111], v[176:179], v[32:47]
    ds_read_b64_tr_b16 v[124:125], v83 offset:4096
    ds_read_b64_tr_b16 v[126:127], v83 offset:5120
    s_waitcnt vmcnt(11) lgkmcnt(4)
    v_mfma_f32_32x32x16_bf16 v[16:31], v[112:115], v[180:183], v[16:31]
    ds_read_b64_tr_b16 v[104:105], v82 offset:6144
    ds_read_b64_tr_b16 v[106:107], v82 offset:7168
    buffer_load_dwordx4 v[164:167], v14, s[40:43], s34 offen offset:2048 sc1
    v_mfma_f32_32x32x16_bf16 v[32:47], v[116:119], v[180:183], v[32:47]
    ds_read_b64_tr_b16 v[108:109], v83 offset:6144
    ds_read_b64_tr_b16 v[110:111], v83 offset:7168
    v_add_u32 v80, s8, v72
    v_add_u32 v81, s8, v73
    s_waitcnt vmcnt(11) lgkmcnt(4)
    v_mfma_f32_32x32x16_bf16 v[16:31], v[120:123], v[184:187], v[16:31]
    ds_read_b32 v79, v8 offset:25984
    ds_read_b64_tr_b16 v[112:113], v80 offset:0
    ds_read_b64_tr_b16 v[114:115], v80 offset:1024
    buffer_load_dwordx4 v[168:171], v78, s[40:43], s34 offen offset:0 sc1
    v_mfma_f32_32x32x16_bf16 v[32:47], v[124:127], v[184:187], v[32:47]
    ds_read_b64_tr_b16 v[116:117], v81 offset:0
    ds_read_b64_tr_b16 v[118:119], v81 offset:1024
    s_waitcnt vmcnt(11) lgkmcnt(4)
    v_mfma_f32_32x32x16_bf16 v[16:31], v[104:107], v[188:191], v[16:31]
    ds_read_b64_tr_b16 v[120:121], v80 offset:2048
    ds_read_b64_tr_b16 v[122:123], v80 offset:3072
    buffer_load_dwordx4 v[172:175], v78, s[40:43], s34 offen offset:2048 sc1
    v_mfma_f32_32x32x16_bf16 v[32:47], v[108:111], v[188:191], v[32:47]
    ds_read_b64_tr_b16 v[124:125], v81 offset:2048
    ds_read_b64_tr_b16 v[126:127], v81 offset:3072
    v_readfirstlane_b32 s76, v79
    s_nop 0
    s_and_b32 s76, s76, s52
    s_cbranch_scc0 L_tr7
L_bk7:
    s_ff1_i32_b32 s76, s76
    s_bitset0_b32 s52, s76
    s_add_u32 s77, s76, s65
    s_and_b32 s77, s77, 15
    s_mul_i32 s77, s77, 32768
    s_add_u32 s35, s77, s80
    s_waitcnt vmcnt(11) lgkmcnt(4)
    v_mfma_f32_32x32x16_bf16 v[16:31], v[112:115], v[128:131], v[16:31]
    ds_read_b64_tr_b16 v[104:105], v80 offset:4096
    ds_read_b64_tr_b16 v[106:107], v80 offset:5120
    buffer_load_dwordx4 v[176:179], v14, s[40:43], s35 offen offset:0 sc1
    s_add_u32 s76, s76, 3
    s_and_b32 s76, s76, 15
    s_lshl_b32 s11, s76, 13
    v_mfma_f32_32x32x16_bf16 v[32:47], v[116:119], v[128:131], v[32:47]
    ds_read_b64_tr_b16 v[108:109], v81 offset:4096
    ds_read_b64_tr_b16 v[110:111], v81 offset:5120
    s_waitcnt vmcnt(11) lgkmcnt(4)
    v_mfma_f32_32x32x16_bf16 v[16:31], v[120:123], v[132:135], v[16:31]
    ds_read_b64_tr_b16 v[112:113], v80 offset:6144
    ds_read_b64_tr_b16 v[114:115], v80 offset:7168
    buffer_load_dwordx4 v[180:183], v14, s[40:43], s35 offen offset:2048 sc1
    v_mfma_f32_32x32x16_bf16 v[32:47], v[124:127], v[132:135], v[32:47]
    ds_read_b64_tr_b16 v[116:117], v81 offset:6144
    ds_read_b64_tr_b16 v[118:119], v81 offset:7168
    v_add_u32 v82, s9, v72
    v_add_u32 v83, s9, v73
    s_waitcnt vmcnt(11) lgkmcnt(4)
    v_mfma_f32_32x32x16_bf16 v[16:31], v[104:107], v[136:139], v[16:31]
    ds_read_b32 v79, v8 offset:25984
    ds_read_b64_tr_b16 v[120:121], v82 offset:0
    ds_read_b64_tr_b16 v[122:123], v82 offset:1024
    buffer_load_dwordx4 v[184:187], v78, s[40:43], s35 offen offset:0 sc1
    v_mfma_f32_32x32x16_bf16 v[32:47], v[108:111], v[136:139], v[32:47]
    ds_read_b64_tr_b16 v[124:125], v83 offset:0
    ds_read_b64_tr_b16 v[126:127], v83 offset:1024
    s_waitcnt vmcnt(11) lgkmcnt(4)
    v_mfma_f32_32x32x16_bf16 v[16:31], v[112:115], v[140:143], v[16:31]
    ds_read_b64_tr_b16 v[104:105], v82 offset:2048
    ds_read_b64_tr_b16 v[106:107], v82 offset:3072
    buffer_load_dwordx4 v[188:191], v78, s[40:43], s35 offen offset:2048 sc1
    v_mfma_f32_32x32x16_bf16 v[32:47], v[116:119], v[140:143], v[32:47]
    ds_read_b64_tr_b16 v[108:109], v83 offset:2048
    ds_read_b64_tr_b16 v[110:111], v83 offset:3072
    v_readfirstlane_b32 s76, v79
    s_nop 0
    s_and_b32 s76, s76, s52
    s_cbranch_scc0 L_tr8
L_bk8:
    s_ff1_i32_b32 s76, s76
    s_bitset0_b32 s52, s76
    s_add_u32 s77, s76, s65
    s_and_b32 s77, s77, 15
    s_mul_i32 s77, s77, 32768
    s_add_u32 s36, s77, s80
    s_waitcnt vmcnt(11) lgkmcnt(4)
    v_mfma_f32_32x32x16_bf16 v[16:31], v[120:123], v[144:147], v[16:31]
    ds_read_b64_tr_b16 v[112:113], v82 offset:4096
    ds_read_b64_tr_b16 v[114:115], v82 offset:5120
    buffer_load_dwordx4 v[128:131], v14, s[40:43], s36 offen offset:0 sc1
    s_add_u32 s76, s76, 3
    s_and_b32 s76, s76, 15
    s_lshl_b32 s12, s76, 13
    v_mfma_f32_32x32x16_bf16 v[32:47], v[124:127], v[144:147], v[32:47]
    ds_read_b64_tr_b16 v[116:117], v83 offset:4096
    ds_read_b64_tr_b16 v[118:119], v83 offset:5120
    s_waitcnt vmcnt(11) lgkmcnt(4)
    v_mfma_f32_32x32x16_bf16 v[16:31], v[104:107], v[148:151], v[16:31]
    ds_read_b64_tr_b16 v[120:121], v82 offset:6144
    ds_read_b64_tr_b16 v[122:123], v82 offset:7168
    buffer_load_dwordx4 v[132:135], v14, s[40:43], s36 offen offset:2048 sc1
    v_mfma_f32_32x32x16_bf16 v[32:47], v[108:111], v[148:151], v[32:47]
    ds_read_b64_tr_b16 v[124:125], v83 offset:6144
    ds_read_b64_tr_b16 v[126:127], v83 offset:7168
    v_add_u32 v80, s10, v72
    v_add_u32 v81, s10, v73
    s_waitcnt vmcnt(11) lgkmcnt(4)
    v_mfma_f32_32x32x16_bf16 v[16:31], v[112:115], v[152:155], v[16:31]
    ds_read_b32 v79, v8 offset:25984
    ds_read_b64_tr_b16 v[104:105], v80 offset:0
    ds_read_b64_tr_b16 v[106:107], v80 offset:1024
    buffer_load_dwordx4 v[136:139], v78, s[40:43], s36 offen offset:0 sc1
    v_mfma_f32_32x32x16_bf16 v[32:47], v[116:119], v[152:155], v[32:47]
    ds_read_b64_tr_b16 v[108:109], v81 offset:0
    ds_read_b64_tr_b16 v[110:111], v81 offset:1024
    s_waitcnt vmcnt(11) lgkmcnt(4)
    v_mfma_f32_32x32x16_bf16 v[16:31], v[120:123], v[156:159], v[16:31]
    ds_read_b64_tr_b16 v[112:113], v80 offset:2048
    ds_read_b64_tr_b16 v[114:115], v80 offset:3072
    buffer_load_dwordx4 v[140:143], v78, s[40:43], s36 offen offset:2048 sc1
    v_mfma_f32_32x32x16_bf16 v[32:47], v[124:127], v[156:159], v[32:47]
    ds_read_b64_tr_b16 v[116:117], v81 offset:2048
    ds_read_b64_tr_b16 v[118:119], v81 offset:3072
    v_readfirstlane_b32 s76, v79
    s_nop 0
    s_and_b32 s76, s76, s52
    s_cbranch_scc0 L_tr9
L_bk9:
    s_ff1_i32_b32 s76, s76
    s_bitset0_b32 s52, s76
    s_add_u32 s77, s76, s65
    s_and_b32 s77, s77, 15
    s_mul_i32 s77, s77, 32768
    s_add_u32 s37, s77, s80
    s_waitcnt vmcnt(11) lgkmcnt(4)
    v_mfma_f32_32x32x16_bf16 v[16:31], v[104:107], v[160:163], v[16:31]
    ds_read_b64_tr_b16 v[120:121], v80 offset:4096
    ds_read_b64_tr_b16 v[122:123], v80 offset:5120
    buffer_load_dwordx4 v[144:147], v14, s[40:43], s37 offen offset:0 sc1
    s_add_u32 s76, s76, 3
    s_and_b32 s76, s76, 15
    s_lshl_b32 s13, s76, 13
    v_mfma_f32_32x32x16_bf16 v[32:47], v[108:111], v[160:163], v[32:47]
    ds_read_b64_tr_b16 v[124:125], v81 offset:4096
    ds_read_b64_tr_b16 v[126:127], v81 offset:5120
    s_waitcnt vmcnt(11) lgkmcnt(4)
    v_mfma_f32_32x32x16_bf16 v[16:31], v[112:115], v[164:167], v[16:31]
    ds_read_b64_tr_b16 v[104:105], v80 offset:6144
    ds_read_b64_tr_b16 v[106:107], v80 offset:7168
    buffer_load_dwordx4 v[148:151], v14, s[40:43], s37 offen offset:2048 sc1
    v_mfma_f32_32x32x16_bf16 v[32:47], v[116:119], v[164:167], v[32:47]
    ds_read_b64_tr_b16 v[108:109], v81 offset:6144
    ds_read_b64_tr_b16 v[110:111], v81 offset:7168
    v_add_u32 v82, s11, v72
    v_add_u32 v83, s11, v73
    s_waitcnt vmcnt(11) lgkmcnt(4)
    v_mfma_f32_32x32x16_bf16 v[16:31], v[120:123], v[168:171], v[16:31]
    ds_read_b32 v79, v8 offset:25984
    ds_read_b64_tr_b16 v[112:113], v82 offset:0
    ds_read_b64_tr_b16 v[114:115], v82 offset:1024
    buffer_load_dwordx4 v[152:155], v78, s[40:43], s37 offen offset:0 sc1
    v_mfma_f32_32x32x16_bf16 v[32:47], v[124:127], v[168:171], v[32:47]
    ds_read_b64_tr_b16 v[116:117], v83 offset:0
    ds_read_b64_tr_b16 v[118:119], v83 offset:1024
    s_waitcnt vmcnt(11) lgkmcnt(4)
    v_mfma_f32_32x32x16_bf16 v[16:31], v[104:107], v[172:175], v[16:31]
    ds_read_b64_tr_b16 v[120:121], v82 offset:2048
    ds_read_b64_tr_b16 v[122:123], v82 offset:3072
    buffer_load_dwordx4 v[156:159], v78, s[40:43], s37 offen offset:2048 sc1
    v_mfma_f32_32x32x16_bf16 v[32:47], v[108:111], v[172:175], v[32:47]
    ds_read_b64_tr_b16 v[124:125], v83 offset:2048
    ds_read_b64_tr_b16 v[126:127], v83 offset:3072
    v_readfirstlane_b32 s76, v79
    s_nop 0
    s_and_b32 s76, s76, s52
    s_cbranch_scc0 L_tr10
L_bk10:
    s_ff1_i32_b32 s76, s76
    s_bitset0_b32 s52, s76
    s_add_u32 s77, s76, s65
    s_and_b32 s77, s77, 15
    s_mul_i32 s77, s77, 32768
    s_add_u32 s38, s77, s80
    s_waitcnt vmcnt(11) lgkmcnt(4)
    v_mfma_f32_32x32x16_bf16 v[16:31], v[112:115], v[176:179], v[16:31]
    ds_read_b64_tr_b16 v[104:105], v82 offset:4096
    ds_read_b64_tr_b16 v[106:107], v82 offset:5120
    buffer_load_dwordx4 v[160:163], v14, s[40:43], s38 offen offset:0 sc1
    s_add_u32 s76, s76, 3
    s_and_b32 s76, s76, 15
    s_lshl_b32 s14, s76, 13
    v_mfma_f32_32x32x16_bf16 v[32:47], v[116:119], v[176:179], v[32:47]
    ds_read_b64_tr_b16 v[108:109], v83 offset:4096
    ds_read_b64_tr_b16 v[110:111], v83 offset:5120
    s_waitcnt vmcnt(11) lgkmcnt(4)
    v_mfma_f32_32x32x16_bf16 v[16:31], v[120:123], v[180:183], v[16:31]
    ds_read_b64_tr_b16 v[112:113], v82 offset:6144
    ds_read_b64_tr_b16 v[114:115], v82 offset:7168
    buffer_load_dwordx4 v[164:167], v14, s[40:43], s38 offen offset:2048 sc1
    v_mfma_f32_32x32x16_bf16 v[32:47], v[124:127], v[180:183], v[32:47]
    ds_read_b64_tr_b16 v[116:117], v83 offset:6144
    ds_read_b64_tr_b16 v[118:119], v83 offset:7168
    v_add_u32 v80, s12, v72
    v_add_u32 v81, s12, v73
    s_waitcnt vmcnt(11) lgkmcnt(4)
    v_mfma_f32_32x32x16_bf16 v[16:31], v[104:107], v[184:187], v[16:31]
    ds_read_b32 v79, v8 offset:25984
    ds_read_b64_tr_b16 v[120:121], v80 offset:0
    ds_read_b64_tr_b16 v[122:123], v80 offset:1024
    buffer_load_dwordx4 v[168:171], v78, s[40:43], s38 offen offset:0 sc1
    v_mfma_f32_32x32x16_bf16 v[32:47], v[108:111], v[184:187], v[32:47]
    ds_read_b64_tr_b16 v[124:125], v81 offset:0
    ds_read_b64_tr_b16 v[126:127], v81 offset:1024
    s_waitcnt vmcnt(11) lgkmcnt(4)
    v_mfma_f32_32x32x16_bf16 v[16:31], v[112:115], v[188:191], v[16:31]
    ds_read_b64_tr_b16 v[104:105], v80 offset:2048
    ds_read_b64_tr_b16 v[106:107], v80 offset:3072
    buffer_load_dwordx4 v[172:175], v78, s[40:43], s38 offen offset:2048 sc1
    v_mfma_f32_32x32x16_bf16 v[32:47], v[116:119], v[188:191], v[32:47]
    ds_read_b64_tr_b16 v[108:109], v81 offset:2048
    ds_read_b64_tr_b16 v[110:111], v81 offset:3072
    v_readfirstlane_b32 s76, v79
    s_nop 0
    s_and_b32 s76, s76, s52
    s_cbranch_scc0 L_tr11
L_bk11:
    s_ff1_i32_b32 s76, s76
    s_bitset0_b32 s52, s76
    s_add_u32 s77, s76, s65
    s_and_b32 s77, s77, 15
    s_mul_i32 s77, s77, 32768
    s_add_u32 s39, s77, s80
    s_waitcnt vmcnt(11) lgkmcnt(4)
    v_mfma_f32_32x32x16_bf16 v[16:31], v[120:123], v[128:131], v[16:31]
    ds_read_b64_tr_b16 v[112:113], v80 offset:4096
    ds_read_b64_tr_b16 v[114:115], v80 offset:5120
    buffer_load_dwordx4 v[176:179], v14, s[40:43], s39 offen offset:0 sc1
    s_add_u32 s76, s76, 3
    s_and_b32 s76, s76, 15
    s_lshl_b32 s15, s76, 13
    v_mfma_f32_32x32x16_bf16 v[32:47], v[124:127], v[128:131], v[32:47]
    ds_read_b64_tr_b16 v[116:117], v81 offset:4096
    ds_read_b64_tr_b16 v[118:119], v81 offset:5120
    s_waitcnt vmcnt(11) lgkmcnt(4)
    v_mfma_f32_32x32x16_bf16 v[16:31], v[104:107], v[132:135], v[16:31]
    ds_read_b64_tr_b16 v[120:121], v80 offset:6144
    ds_read_b64_tr_b16 v[122:123], v80 offset:7168
    buffer_load_dwordx4 v[180:183], v14, s[40:43], s39 offen offset:2048 sc1
    v_mfma_f32_32x32x16_bf16 v[32:47], v[108:111], v[132:135], v[32:47]
    ds_read_b64_tr_b16 v[124:125], v81 offset:6144
    ds_read_b64_tr_b16 v[126:127], v81 offset:7168
    v_add_u32 v82, s13, v72
    v_add_u32 v83, s13, v73
    s_waitcnt vmcnt(11) lgkmcnt(4)
    v_mfma_f32_32x32x16_bf16 v[16:31], v[112:115], v[136:139], v[16:31]
    ds_read_b32 v79, v8 offset:25984
    ds_read_b64_tr_b16 v[104:105], v82 offset:0
    ds_read_b64_tr_b16 v[106:107], v82 offset:1024
    buffer_load_dwordx4 v[184:187], v78, s[40:43], s39 offen offset:0 sc1
    v_mfma_f32_32x32x16_bf16 v[32:47], v[116:119], v[136:139], v[32:47]
    ds_read_b64_tr_b16 v[108:109], v83 offset:0
    ds_read_b64_tr_b16 v[110:111], v83 offset:1024
    s_waitcnt vmcnt(11) lgkmcnt(4)
    v_mfma_f32_32x32x16_bf16 v[16:31], v[120:123], v[140:143], v[16:31]
    ds_read_b64_tr_b16 v[112:113], v82 offset:2048
    ds_read_b64_tr_b16 v[114:115], v82 offset:3072
    buffer_load_dwordx4 v[188:191], v78, s[40:43], s39 offen offset:2048 sc1
    v_mfma_f32_32x32x16_bf16 v[32:47], v[124:127], v[140:143], v[32:47]
    ds_read_b64_tr_b16 v[116:117], v83 offset:2048
    ds_read_b64_tr_b16 v[118:119], v83 offset:3072
    v_readfirstlane_b32 s76, v79
    s_nop 0
    s_and_b32 s76, s76, s52
    s_cbranch_scc0 L_tr12
L_bk12:
    s_ff1_i32_b32 s76, s76
    s_bitset0_b32 s52, s76
    s_add_u32 s77, s76, s65
    s_and_b32 s77, s77, 15
    s_mul_i32 s77, s77, 32768
    s_add_u32 s48, s77, s80
    s_waitcnt vmcnt(11) lgkmcnt(4)
    v_mfma_f32_32x32x16_bf16 v[16:31], v[104:107], v[144:147], v[16:31]
    ds_read_b64_tr_b16 v[120:121], v82 offset:4096
    ds_read_b64_tr_b16 v[122:123], v82 offset:5120
    buffer_load_dwordx4 v[128:131], v14, s[40:43], s48 offen offset:0 sc1
    s_add_u32 s76, s76, 3
    s_and_b32 s76, s76, 15
    s_lshl_b32 s16, s76, 13
    v_mfma_f32_32x32x16_bf16 v[32:47], v[108:111], v[144:147], v[32:47]
    ds_read_b64_tr_b16 v[124:125], v83 offset:4096
    ds_read_b64_tr_b16 v[126:127], v83 offset:5120
    s_waitcnt vmcnt(11) lgkmcnt(4)
    v_mfma_f32_32x32x16_bf16 v[16:31], v[112:115], v[148:151], v[16:31]
    ds_read_b64_tr_b16 v[104:105], v82 offset:6144
    ds_read_b64_tr_b16 v[106:107], v82 offset:7168
    buffer_load_dwordx4 v[132:135], v14, s[40:43], s48 offen offset:2048 sc1
    v_mfma_f32_32x32x16_bf16 v[32:47], v[116:119], v[148:151], v[32:47]
    ds_read_b64_tr_b16 v[108:109], v83 offset:6144
    ds_read_b64_tr_b16 v[110:111], v83 offset:7168
    v_add_u32 v80, s14, v72
    v_add_u32 v81, s14, v73
    s_waitcnt vmcnt(11) lgkmcnt(4)
    v_mfma_f32_32x32x16_bf16 v[16:31], v[120:123], v[152:155], v[16:31]
    ds_read_b32 v79, v8 offset:25984
    ds_read_b64_tr_b16 v[112:113], v80 offset:0
    ds_read_b64_tr_b16 v[114:115], v80 offset:1024
    buffer_load_dwordx4 v[136:139], v78, s[40:43], s48 offen offset:0 sc1
    v_mfma_f32_32x32x16_bf16 v[32:47], v[124:127], v[152:155], v[32:47]
    ds_read_b64_tr_b16 v[116:117], v81 offset:0
    ds_read_b64_tr_b16 v[118:119], v81 offset:1024
    s_waitcnt vmcnt(11) lgkmcnt(4)
    v_mfma_f32_32x32x16_bf16 v[16:31], v[104:107], v[156:159], v[16:31]
    ds_read_b64_tr_b16 v[120:121], v80 offset:2048
    ds_read_b64_tr_b16 v[122:123], v80 offset:3072
    buffer_load_dwordx4 v[140:143], v78, s[40:43], s48 offen offset:2048 sc1
    v_mfma_f32_32x32x16_bf16 v[32:47], v[108:111], v[156:159], v[32:47]
    ds_read_b64_tr_b16 v[124:125], v81 offset:2048
    ds_read_b64_tr_b16 v[126:127], v81 offset:3072
    v_readfirstlane_b32 s76, v79
    s_nop 0
    s_and_b32 s76, s76, s52
    s_cbranch_scc0 L_tr13
L_bk13:
    s_ff1_i32_b32 s76, s76
    s_bitset0_b32 s52, s76
    s_add_u32 s77, s76, s65
    s_and_b32 s77, s77, 15
    s_mul_i32 s77, s77, 32768
    s_add_u32 s49, s77, s80
    s_waitcnt vmcnt(11) lgkmcnt(4)
    v_mfma_f32_32x32x16_bf16 v[16:31], v[112:115], v[160:163], v[16:31]
    ds_read_b64_tr_b16 v[104:105], v80 offset:4096
    ds_read_b64_tr_b16 v[106:107], v80 offset:5120
    buffer_load_dwordx4 v[144:147], v14, s[40:43], s49 offen offset:0 sc1
    s_add_u32 s76, s76, 3
    s_and_b32 s76, s76, 15
    s_lshl_b32 s17, s76, 13
    v_mfma_f32_32x32x16_bf16 v[32:47], v[116:119], v[160:163], v[32:47]
    ds_read_b64_tr_b16 v[108:109], v81 offset:4096
    ds_read_b64_tr_b16 v[110:111], v81 offset:5120
    s_waitcnt vmcnt(11) lgkmcnt(4)
    v_mfma_f32_32x32x16_bf16 v[16:31], v[120:123], v[164:167], v[16:31]
    ds_read_b64_tr_b16 v[112:113], v80 offset:6144
    ds_read_b64_tr_b16 v[114:115], v80 offset:7168
    buffer_load_dwordx4 v[148:151], v14, s[40:43], s49 offen offset:2048 sc1
    v_mfma_f32_32x32x16_bf16 v[32:47], v[124:127], v[164:167], v[32:47]
    ds_read_b64_tr_b16 v[116:117], v81 offset:6144
    ds_read_b64_tr_b16 v[118:119], v81 offset:7168
    v_add_u32 v82, s15, v72
    v_add_u32 v83, s15, v73
    s_waitcnt vmcnt(11) lgkmcnt(4)
    v_mfma_f32_32x32x16_bf16 v[16:31], v[104:107], v[168:171], v[16:31]
    ds_read_b32 v79, v8 offset:25984
    ds_read_b64_tr_b16 v[120:121], v82 offset:0
    ds_read_b64_tr_b16 v[122:123], v82 offset:1024
    buffer_load_dwordx4 v[152:155], v78, s[40:43], s49 offen offset:0 sc1
    v_mfma_f32_32x32x16_bf16 v[32:47], v[108:111], v[168:171], v[32:47]
    ds_read_b64_tr_b16 v[124:125], v83 offset:0
    ds_read_b64_tr_b16 v[126:127], v83 offset:1024
    s_waitcnt vmcnt(11) lgkmcnt(4)
    v_mfma_f32_32x32x16_bf16 v[16:31], v[112:115], v[172:175], v[16:31]
    ds_read_b64_tr_b16 v[104:105], v82 offset:2048
    ds_read_b64_tr_b16 v[106:107], v82 offset:3072
    buffer_load_dwordx4 v[156:159], v78, s[40:43], s49 offen offset:2048 sc1
    v_mfma_f32_32x32x16_bf16 v[32:47], v[116:119], v[172:175], v[32:47]
    ds_read_b64_tr_b16 v[108:109], v83 offset:2048
    ds_read_b64_tr_b16 v[110:111], v83 offset:3072
    v_readfirstlane_b32 s76, v79
    s_nop 0
    s_and_b32 s76, s76, s52
    s_cbranch_scc0 L_tr14
L_bk14:
    s_ff1_i32_b32 s76, s76
    s_bitset0_b32 s52, s76
    s_add_u32 s77, s76, s65
    s_and_b32 s77, s77, 15
    s_mul_i32 s77, s77, 32768
    s_add_u32 s50, s77, s80
    s_waitcnt vmcnt(11) lgkmcnt(4)
    v_mfma_f32_32x32x16_bf16 v[16:31], v[120:123], v[176:179], v[16:31]
    ds_read_b64_tr_b16 v[112:113], v82 offset:4096
    ds_read_b64_tr_b16 v[114:115], v82 offset:5120
    buffer_load_dwordx4 v[160:163], v14, s[40:43], s50 offen offset:0 sc1
    s_add_u32 s76, s76, 3
    s_and_b32 s76, s76, 15
    s_lshl_b32 s18, s76, 13
    v_mfma_f32_32x32x16_bf16 v[32:47], v[124:127], v[176:179], v[32:47]
    ds_read_b64_tr_b16 v[116:117], v83 offset:4096
    ds_read_b64_tr_b16 v[118:119], v83 offset:5120
    s_waitcnt vmcnt(11) lgkmcnt(4)
    v_mfma_f32_32x32x16_bf16 v[16:31], v[104:107], v[180:183], v[16:31]
    ds_read_b64_tr_b16 v[120:121], v82 offset:6144
    ds_read_b64_tr_b16 v[122:123], v82 offset:7168
    buffer_load_dwordx4 v[164:167], v14, s[40:43], s50 offen offset:2048 sc1
    v_mfma_f32_32x32x16_bf16 v[32:47], v[108:111], v[180:183], v[32:47]
    ds_read_b64_tr_b16 v[124:125], v83 offset:6144
    ds_read_b64_tr_b16 v[126:127], v83 offset:7168
    v_add_u32 v80, s16, v72
    v_add_u32 v81, s16, v73
    s_waitcnt vmcnt(11) lgkmcnt(4)
    v_mfma_f32_32x32x16_bf16 v[16:31], v[112:115], v[184:187], v[16:31]
    ds_read_b32 v79, v8 offset:25984
    ds_read_b64_tr_b16 v[104:105], v80 offset:0
    ds_read_b64_tr_b16 v[106:107], v80 offset:1024
    buffer_load_dwordx4 v[168:171], v78, s[40:43], s50 offen offset:0 sc1
    v_mfma_f32_32x32x16_bf16 v[32:47], v[116:119], v[184:187], v[32:47]
    ds_read_b64_tr_b16 v[108:109], v81 offset:0
    ds_read_b64_tr_b16 v[110:111], v81 offset:1024
    s_waitcnt vmcnt(11) lgkmcnt(4)
    v_mfma_f32_32x32x16_bf16 v[16:31], v[120:123], v[188:191], v[16:31]
    ds_read_b64_tr_b16 v[112:113], v80 offset:2048
    ds_read_b64_tr_b16 v[114:115], v80 offset:3072
    buffer_load_dwordx4 v[172:175], v78, s[40:43], s50 offen offset:2048 sc1
    v_mfma_f32_32x32x16_bf16 v[32:47], v[124:127], v[188:191], v[32:47]
    ds_read_b64_tr_b16 v[116:117], v81 offset:2048
    ds_read_b64_tr_b16 v[118:119], v81 offset:3072
    v_readfirstlane_b32 s76, v79
    s_nop 0
    s_and_b32 s76, s76, s52
    s_cbranch_scc0 L_tr15
L_bk15:
    s_ff1_i32_b32 s76, s76
    s_bitset0_b32 s52, s76
    s_add_u32 s77, s76, s65
    s_and_b32 s77, s77, 15
    s_mul_i32 s77, s77, 32768
    s_add_u32 s51, s77, s80
    s_waitcnt vmcnt(11) lgkmcnt(4)
    v_mfma_f32_32x32x16_bf16 v[16:31], v[104:107], v[128:131], v[16:31]
    ds_read_b64_tr_b16 v[120:121], v80 offset:4096
    ds_read_b64_tr_b16 v[122:123], v80 offset:5120
    buffer_load_dwordx4 v[176:179], v14, s[40:43], s51 offen offset:0 sc1
    s_add_u32 s76, s76, 3
    s_and_b32 s76, s76, 15
    s_lshl_b32 s19, s76, 13
    v_mfma_f32_32x32x16_bf16 v[32:47], v[108:111], v[128:131], v[32:47]
    ds_read_b64_tr_b16 v[124:125], v81 offset:4096
    ds_read_b64_tr_b16 v[126:127], v81 offset:5120
    s_waitcnt vmcnt(11) lgkmcnt(4)
    v_mfma_f32_32x32x16_bf16 v[16:31], v[112:115], v[132:135], v[16:31]
    ds_read_b64_tr_b16 v[104:105], v80 offset:6144
    ds_read_b64_tr_b16 v[106:107], v80 offset:7168
    buffer_load_dwordx4 v[180:183], v14, s[40:43], s51 offen offset:2048 sc1
    v_mfma_f32_32x32x16_bf16 v[32:47], v[116:119], v[132:135], v[32:47]
    ds_read_b64_tr_b16 v[108:109], v81 offset:6144
    ds_read_b64_tr_b16 v[110:111], v81 offset:7168
    v_add_u32 v82, s17, v72
    v_add_u32 v83, s17, v73
    s_waitcnt vmcnt(11) lgkmcnt(4)
    v_mfma_f32_32x32x16_bf16 v[16:31], v[120:123], v[136:139], v[16:31]
    ds_read_b64 v[192:193], v10 offset:16384
    ds_read_b64_tr_b16 v[112:113], v82 offset:0
    ds_read_b64_tr_b16 v[114:115], v82 offset:1024
    buffer_load_dwordx4 v[184:187], v78, s[40:43], s51 offen offset:0 sc1
    v_mfma_f32_32x32x16_bf16 v[32:47], v[124:127], v[136:139], v[32:47]
    ds_read_b64_tr_b16 v[116:117], v83 offset:0
    ds_read_b64_tr_b16 v[118:119], v83 offset:1024
    s_waitcnt vmcnt(11) lgkmcnt(4)
    v_mfma_f32_32x32x16_bf16 v[16:31], v[104:107], v[140:143], v[16:31]
    ds_read_b64 v[194:195], v10 offset:16400
    ds_read_b64_tr_b16 v[120:121], v82 offset:2048
    ds_read_b64_tr_b16 v[122:123], v82 offset:3072
    buffer_load_dwordx4 v[188:191], v78, s[40:43], s51 offen offset:2048 sc1
    s_barrier
    v_mfma_f32_32x32x16_bf16 v[32:47], v[108:111], v[140:143], v[32:47]
    ds_read_b64_tr_b16 v[124:125], v83 offset:2048
    ds_read_b64_tr_b16 v[126:127], v83 offset:3072
    s_waitcnt vmcnt(11) lgkmcnt(4)
    v_mfma_f32_32x32x16_bf16 v[16:31], v[112:115], v[144:147], v[16:31]
    ds_read_b64 v[196:197], v10 offset:16416
    ds_read_b64_tr_b16 v[104:105], v82 offset:4096
    ds_read_b64_tr_b16 v[106:107], v82 offset:5120
    v_mfma_f32_32x32x16_bf16 v[32:47], v[116:119], v[144:147], v[32:47]
    ds_read_b64_tr_b16 v[108:109], v83 offset:4096
    ds_read_b64_tr_b16 v[110:111], v83 offset:5120
    s_waitcnt vmcnt(10) lgkmcnt(4)
    v_mfma_f32_32x32x16_bf16 v[16:31], v[120:123], v[148:151], v[16:31]
    ds_read_b64 v[198:199], v10 offset:16432
    ds_read_b64_tr_b16 v[112:113], v82 offset:6144
    ds_read_b64_tr_b16 v[114:115], v82 offset:7168
    v_mfma_f32_32x32x16_bf16 v[32:47], v[124:127], v[148:151], v[32:47]
    ds_read_b64_tr_b16 v[116:117], v83 offset:6144
    ds_read_b64_tr_b16 v[118:119], v83 offset:7168
    v_add_u32 v80, s18, v72
    v_add_u32_e64 v81, s18, v73
    s_waitcnt vmcnt(9) lgkmcnt(4)
    v_mfma_f32_32x32x16_bf16 v[16:31], v[104:107], v[152:155], v[16:31]
    ds_read_b64 v[200:201], v10 offset:16448
    ds_read_b64_tr_b16 v[120:121], v80 offset:0
    ds_read_b64_tr_b16 v[122:123], v80 offset:1024
    v_mfma_f32_32x32x16_bf16 v[32:47], v[108:111], v[152:155], v[32:47]
    ds_read_b64_tr_b16 v[124:125], v81 offset:0
    ds_read_b64_tr_b16 v[126:127], v81 offset:1024
    s_waitcnt vmcnt(8) lgkmcnt(4)
    v_mfma_f32_32x32x16_bf16 v[16:31], v[112:115], v[156:159], v[16:31]
    ds_read_b64 v[202:203], v10 offset:16464
    ds_read_b64_tr_b16 v[104:105], v80 offset:2048
    ds_read_b64_tr_b16 v[106:107], v80 offset:3072
    v_mfma_f32_32x32x16_bf16 v[32:47], v[116:119], v[156:159], v[32:47]
    ds_read_b64_tr_b16 v[108:109], v81 offset:2048
    ds_read_b64_tr_b16 v[110:111], v81 offset:3072
    s_waitcnt vmcnt(7) lgkmcnt(4)
    v_mfma_f32_32x32x16_bf16 v[16:31], v[120:123], v[160:163], v[16:31]
    ds_read_b64 v[204:205], v10 offset:16480
    ds_read_b64_tr_b16 v[112:113], v80 offset:4096
    ds_read_b64_tr_b16 v[114:115], v80 offset:5120
    v_mfma_f32_32x32x16_bf16 v[32:47], v[124:127], v[160:163], v[32:47]
    ds_read_b64_tr_b16 v[116:117], v81 offset:4096
    ds_read_b64_tr_b16 v[118:119], v81 offset:5120
    s_waitcnt vmcnt(6) lgkmcnt(4)
    v_mfma_f32_32x32x16_bf16 v[16:31], v[104:107], v[164:167], v[16:31]
    ds_read_b64 v[206:207], v10 offset:16496
    ds_read_b64_tr_b16 v[120:121], v80 offset:6144
    ds_read_b64_tr_b16 v[122:123], v80 offset:7168
    v_mfma_f32_32x32x16_bf16 v[32:47], v[108:111], v[164:167], v[32:47]
    ds_read_b64_tr_b16 v[124:125], v81 offset:6144
    ds_read_b64_tr_b16 v[126:127], v81 offset:7168
    v_add_u32 v82, s19, v72
    v_add_u32 v83, s19, v73
    s_waitcnt vmcnt(5) lgkmcnt(4)
    v_mfma_f32_32x32x16_bf16 v[16:31], v[112:115], v[168:171], v[16:31]
    ds_read_b128 v[208:211], v11 offset:16384
    ds_read_b64_tr_b16 v[104:105], v82 offset:0
    ds_read_b64_tr_b16 v[106:107], v82 offset:1024
    v_mfma_f32_32x32x16_bf16 v[32:47], v[116:119], v[168:171], v[32:47]
    ds_read_b64_tr_b16 v[108:109], v83 offset:0
    ds_read_b64_tr_b16 v[110:111], v83 offset:1024
    s_waitcnt vmcnt(4) lgkmcnt(4)
    v_mfma_f32_32x32x16_bf16 v[16:31], v[120:123], v[172:175], v[16:31]
    ds_read_b128 v[212:215], v11 offset:16400
    ds_read_b64_tr_b16 v[112:113], v82 offset:2048
    ds_read_b64_tr_b16 v[114:115], v82 offset:3072
    v_mfma_f32_32x32x16_bf16 v[32:47], v[124:127], v[172:175], v[32:47]
    ds_read_b64_tr_b16 v[116:117], v83 offset:2048
    ds_read_b64_tr_b16 v[118:119], v83 offset:3072
    s_waitcnt vmcnt(3) lgkmcnt(4)
    v_mfma_f32_32x32x16_bf16 v[16:31], v[104:107], v[176:179], v[16:31]
    ds_read_b64_tr_b16 v[120:121], v82 offset:4096
    ds_read_b64_tr_b16 v[122:123], v82 offset:5120
    v_mfma_f32_32x32x16_bf16 v[32:47], v[108:111], v[176:179], v[32:47]
    ds_read_b64_tr_b16 v[124:125], v83 offset:4096
    ds_read_b64_tr_b16 v[126:127], v83 offset:5120
    s_waitcnt vmcnt(2) lgkmcnt(4)
    v_mfma_f32_32x32x16_bf16 v[16:31], v[112:115], v[180:183], v[16:31]
    ds_read_b64_tr_b16 v[104:105], v82 offset:6144
    ds_read_b64_tr_b16 v[106:107], v82 offset:7168
    v_mfma_f32_32x32x16_bf16 v[32:47], v[116:119], v[180:183], v[32:47]
    ds_read_b64_tr_b16 v[108:109], v83 offset:6144
    ds_read_b64_tr_b16 v[110:111], v83 offset:7168
    s_waitcnt vmcnt(1) lgkmcnt(4)
    v_mfma_f32_32x32x16_bf16 v[16:31], v[120:123], v[184:187], v[16:31]
    v_mfma_f32_32x32x16_bf16 v[32:47], v[124:127], v[184:187], v[32:47]
    s_waitcnt vmcnt(0) lgkmcnt(0)
    v_mfma_f32_32x32x16_bf16 v[16:31], v[104:107], v[188:191], v[16:31]
    v_mfma_f32_32x32x16_bf16 v[32:47], v[108:111], v[188:191], v[32:47]
    s_nop 10
    v_cvt_pk_bf16_f32 v88, v16, v17
    v_cvt_pk_bf16_f32 v89, v18, v19
    v_cvt_pk_bf16_f32 v90, v20, v21
    v_cvt_pk_bf16_f32 v91, v22, v23
    v_cvt_pk_bf16_f32 v92, v24, v25
    v_cvt_pk_bf16_f32 v93, v26, v27
    v_cvt_pk_bf16_f32 v94, v28, v29
    v_cvt_pk_bf16_f32 v95, v30, v31
    v_cvt_pk_bf16_f32 v96, v32, v33
    v_cvt_pk_bf16_f32 v97, v34, v35
    v_cvt_pk_bf16_f32 v98, v36, v37
    v_cvt_pk_bf16_f32 v99, v38, v39
    v_cvt_pk_bf16_f32 v100, v40, v41
    v_cvt_pk_bf16_f32 v101, v42, v43
    v_cvt_pk_bf16_f32 v102, v44, v45
    v_cvt_pk_bf16_f32 v103, v46, v47
    v_dot2_f32_bf16 v104, v88, s89, 0
    v_dot2_f32_bf16 v105, v88, v88, 0
    v_dot2_f32_bf16 v106, v88, v192, 0
    v_dot2_f32_bf16 v104, v89, s89, v104
    v_dot2_f32_bf16 v105, v89, v89, v105
    v_dot2_f32_bf16 v106, v89, v193, v106
    v_dot2_f32_bf16 v104, v90, s89, v104
    v_dot2_f32_bf16 v105, v90, v90, v105
    v_dot2_f32_bf16 v106, v90, v194, v106
    v_dot2_f32_bf16 v104, v91, s89, v104
    v_dot2_f32_bf16 v105, v91, v91, v105
    v_dot2_f32_bf16 v106, v91, v195, v106
    v_dot2_f32_bf16 v104, v92, s89, v104
    v_dot2_f32_bf16 v105, v92, v92, v105
    v_dot2_f32_bf16 v106, v92, v196, v106
    v_dot2_f32_bf16 v104, v93, s89, v104
    v_dot2_f32_bf16 v105, v93, v93, v105
    v_dot2_f32_bf16 v106, v93, v197, v106
    v_dot2_f32_bf16 v104, v94, s89, v104
    v_dot2_f32_bf16 v105, v94, v94, v105
    v_dot2_f32_bf16 v106, v94, v198, v106
    v_dot2_f32_bf16 v104, v95, s89, v104
    v_dot2_f32_bf16 v105, v95, v95, v105
    v_dot2_f32_bf16 v106, v95, v199, v106
    v_dot2_f32_bf16 v104, v96, s89, v104
    v_dot2_f32_bf16 v105, v96, v96, v105
    v_dot2_f32_bf16 v106, v96, v200, v106
    v_dot2_f32_bf16 v104, v97, s89, v104
    v_dot2_f32_bf16 v105, v97, v97, v105
    v_dot2_f32_bf16 v106, v97, v201, v106
    v_dot2_f32_bf16 v104, v98, s89, v104
    v_dot2_f32_bf16 v105, v98, v98, v105
    v_dot2_f32_bf16 v106, v98, v202, v106
    v_dot2_f32_bf16 v104, v99, s89, v104
    v_dot2_f32_bf16 v105, v99, v99, v105
    v_dot2_f32_bf16 v106, v99, v203, v106
    v_dot2_f32_bf16 v104, v100, s89, v104
    v_dot2_f32_bf16 v105, v100, v100, v105
    v_dot2_f32_bf16 v106, v100, v204, v106
    v_dot2_f32_bf16 v104, v101, s89, v104
    v_dot2_f32_bf16 v105, v101, v101, v105
    v_dot2_f32_bf16 v106, v101, v205, v106
    v_dot2_f32_bf16 v104, v102, s89, v104
    v_dot2_f32_bf16 v105, v102, v102, v105
    v_dot2_f32_bf16 v106, v102, v206, v106
    v_dot2_f32_bf16 v104, v103, s89, v104
    v_dot2_f32_bf16 v105, v103, v103, v105
    v_dot2_f32_bf16 v106, v103, v207, v106
    s_lshl_b32 s76, s62, 9
    s_add_u32 s77, s76, s99
    v_mov_b32 v107, 0
    v_mov_b32 v4, v104
    v_mov_b32 v5, v105
    v_mov_b32 v6, v106
    v_permlane32_swap_b32 v104, v4
    v_permlane32_swap_b32 v105, v5
    v_permlane32_swap_b32 v106, v6
    v_add_f32 v104, v104, v4
    v_add_f32 v105, v105, v5
    v_add_f32_e64 v106, v106, v6
    s_mov_b32 exec_hi, 0
    s_bitcmp1_b32 s100, 1
    s_cbranch_scc1 L_loc_70
    buffer_store_dwordx4 v[104:107], v12, s[40:43], s77 offen offset:1024 sc1
    s_branch L_pubd_71
L_loc_70:
    buffer_store_dwordx4 v[104:107], v12, s[40:43], s77 offen offset:1024
L_pubd_71:
    s_mov_b64 exec, -1
    ds_write_b64 v64, v[88:89]
    ds_write_b64 v65, v[90:91]
    ds_write_b64 v66, v[92:93]
    ds_write_b64 v67, v[94:95]
    ds_write_b64 v68, v[96:97]
    ds_write_b64 v69, v[98:99]
    ds_write_b64 v70, v[100:101]
    ds_write_b64 v71, v[102:103]
    v_bfe_u32 v4, v1, 1, 3
    v_bfe_u32 v5, v1, 4, 1
    v_lshlrev_b32_e64 v176, 4, v4
    v_lshl_add_u32 v176, v5, 3, v176
    v_and_b32_e64 v5, 1, v1
    v_lshl_add_u32 v176, v5, 2, v176
    v_lshlrev_b32_e64 v177, 2, v2
    v_lshl_add_u32 v177, v3, 8, v177
    v_and_b32 v4, 15, v1
    v_lshrrev_b32 v5, 4, v1
    v_mul_u32_u24 v179, 149504, v4
    v_lshl_add_u32 v180, v5, 4, v179
    s_lshl_b32 s82, s97, 7
    s_lshl_b32 s79, s62, 5
    s_add_u32 s82, s82, s79
    s_lshl_b32 s79, s62, 2
    v_mov_b32_e64 v7, s79
    v_mul_u32_u24 v178, 9344, v3
    v_lshl_add_u32 v178, v2, 4, v178
    s_mul_i32 s78, s97, 149504
    s_add_u32 s78, s78, s76
    s_add_u32 s78, s78, 8388608
    s_add_u32 s48, s78, 18688
    s_add_u32 s49, s48, 18688
    s_add_u32 s50, s49, 18688
    s_add_u32 s51, s50, 18688
    s_add_u32 s52, s51, 18688
    s_add_u32 s53, s52, 18688
    s_add_u32 s54, s53, 18688
    buffer_load_dwordx4 v[112:115], v178, s[40:43], s78 offen offset:1024 sc1
    buffer_load_dwordx4 v[116:119], v178, s[40:43], s48 offen offset:1024 sc1
    buffer_load_dwordx4 v[120:123], v178, s[40:43], s49 offen offset:1024 sc1
    buffer_load_dwordx4 v[124:127], v178, s[40:43], s50 offen offset:1024 sc1
    buffer_load_dwordx4 v[128:131], v178, s[40:43], s51 offen offset:1024 sc1
    buffer_load_dwordx4 v[132:135], v178, s[40:43], s52 offen offset:1024 sc1
    buffer_load_dwordx4 v[136:139], v178, s[40:43], s53 offen offset:1024 sc1
    buffer_load_dwordx4 v[140:143], v178, s[40:43], s54 offen offset:1024 sc1
    v_dot2_f32_bf16 v76, v208, s89, 0
    v_dot2_f32_bf16 v76, v209, s89, v76
    v_dot2_f32_bf16 v76, v210, s89, v76
    v_dot2_f32_bf16 v76, v211, s89, v76
    v_dot2_f32_bf16 v76, v212, s89, v76
    v_dot2_f32_bf16 v76, v213, s89, v76
    v_dot2_f32_bf16 v76, v214, s89, v76
    v_dot2_f32_bf16 v76, v215, s89, v76
    s_nop 2
    v_add_f32_dpp v76, v76, v76 row_ror:8 row_mask:0xf bank_mask:0xf
    s_nop 1
    v_add_f32_dpp v76, v76, v76 row_ror:4 row_mask:0xf bank_mask:0xf
    s_nop 1
    v_add_f32_dpp v76, v76, v76 row_ror:2 row_mask:0xf bank_mask:0xf
    s_nop 1
    v_add_f32_dpp v76, v76, v76 row_ror:1 row_mask:0xf bank_mask:0xf
    v_mov_b32 v4, v76
    s_nop 1
    v_permlane16_swap_b32 v76, v4
    v_add_f32 v76, v76, v4
    v_mov_b32 v4, v76
    s_nop 1
    v_permlane32_swap_b32 v76, v4
    v_add_f32_e64 v76, v76, v4
    s_mov_b32 s88, 0
    s_waitcnt vmcnt(6)
    v_pk_add_f32 v[108:109], v[112:113], v[116:117]
    v_pk_add_f32 v[110:111], v[114:115], v[118:119]
    s_waitcnt vmcnt(5)
    v_pk_add_f32 v[108:109], v[108:109], v[120:121]
    v_pk_add_f32 v[110:111], v[110:111], v[122:123]
    s_waitcnt vmcnt(4)
    v_pk_add_f32 v[108:109], v[108:109], v[124:125]
    v_pk_add_f32 v[110:111], v[110:111], v[126:127]
    s_waitcnt vmcnt(3)
    v_pk_add_f32 v[108:109], v[108:109], v[128:129]
    v_pk_add_f32 v[110:111], v[110:111], v[130:131]
    s_waitcnt vmcnt(2)
    v_pk_add_f32 v[108:109], v[108:109], v[132:133]
    v_pk_add_f32 v[110:111], v[110:111], v[134:135]
    s_waitcnt vmcnt(1)
    v_pk_add_f32 v[108:109], v[108:109], v[136:137]
    v_pk_add_f32 v[110:111], v[110:111], v[138:139]
    s_waitcnt vmcnt(0)
    v_pk_add_f32 v[108:109], v[108:109], v[140:141]
    v_pk_add_f32 v[110:111], v[110:111], v[142:143]
    v_cmp_u_f32 vcc, v111, v111
    v_mov_b32 v4, v108
    v_mov_b32 v5, v109
    v_mov_b32 v6, v110
    s_cbranch_vccnz L_s3_73
L_s3ok_74:
    v_permlane32_swap_b32 v108, v4
    v_permlane32_swap_b32 v109, v5
    v_permlane32_swap_b32 v110, v6
    s_barrier
    v_add_f32 v108, v108, v4
    v_add_f32 v109, v109, v5
    v_add_f32 v110, v110, v6
    v_mul_f32 v108, 0x3a800000, v108
    v_mul_f32 v109, 0x3a800000, v109
    v_fma_f32 v4, -v108, v108, v109
    v_max_f32_e64 v4, 0, v4
    v_cvt_pk_bf16_f32 v116, v108, v108
    v_and_b32_e64 v116, s90, v116
    v_cvt_pk_bf16_f32 v4, v4, v4
    v_and_b32_e64 v4, s90, v4
    v_add_f32 v4, 0x3727c5ac, v4
    v_cvt_pk_bf16_f32 v4, v4, v4
    v_and_b32 v4, s90, v4
    v_sqrt_f32_e64 v4, v4
    s_nop 0
    v_cvt_pk_bf16_f32 v4, v4, v4
    v_and_b32 v4, s90, v4
    v_rcp_f32 v118, v4
    v_fma_f32 v120, -v116, v76, v110
    v_mul_f32 v119, v116, v118
    v_mul_f32 v120, v120, v118
    v_and_b32 v6, 3, v1
    v_lshlrev_b32 v6, 2, v6
    v_max_f32_dpp v4, v120, v120 row_ror:8 row_mask:0xf bank_mask:0xf
    s_lshl_b32 s83, s62, 12
    v_cmp_gt_u32 s[84:85], 32, v1
    v_max_f32_dpp v4, v4, v4 row_ror:4 row_mask:0xf bank_mask:0xf
    s_lshl_b32 s55, 1, s62
    s_sub_u32 s55, s55, 1
    v_max_f32_dpp v4, v4, v4 row_ror:2 row_mask:0xf bank_mask:0xf
    s_nop 1
    v_max_f32_dpp v4, v4, v4 row_ror:1 row_mask:0xf bank_mask:0xf
    v_mov_b32 v5, v4
    s_nop 1
    v_permlane16_swap_b32 v4, v5
    v_max_f32 v4, v4, v5
    v_cmp_eq_f32_e64 vcc, v4, v120
    ds_write_b32 v7, v4 offset:25600
    s_ff1_i32_b32 s77, vcc_lo
    s_and_b32 s77, s77, 31
    s_bfe_u32 s79, s77, 0x30001
    s_lshl3_add_u32 s79, s77, s79
    s_lshl4_add_u32 s79, s79, s83
    v_xor_b32_e64 v176, s79, v176
    ds_read_b32 v182, v176 offset:0
    s_waitcnt lgkmcnt(1)
    s_barrier
    ds_read_b32 v8, v6 offset:25600
    v_readlane_b32 s80, v118, s77
    v_readlane_b32 s81, v119, s77
    s_add_u32 s79, s82, s77
    v_writelane_b32 v4, s79, 33
    v_mov_b32 v5, s81
    s_waitcnt lgkmcnt(1)
    v_lshlrev_b32 v184, 16, v182
    v_and_b32_e64 v185, s90, v182
    v_fma_f32 v184, v184, s80, -v5
    v_fma_f32 v185, v185, s80, -v5
    v_cvt_pk_bf16_f32 v184, v184, v185
    v_cndmask_b32 v184, v4, v184, s[84:85]
    s_waitcnt lgkmcnt(0)
    v_cmp_eq_f32 s[56:57], v8, v4
    v_cmp_gt_f32 vcc, v8, v4
    s_and_b32 s56, s56, s55
    s_or_b32 s56, s56, vcc_lo
    s_cbranch_scc1 L_nopub_83
    buffer_store_dword v184, v177, s[40:43], s99 offen offset:0 sc1
L_nopub_83:
    v_lshlrev_b32 v16, 16, v88
    v_and_b32_e64 v17, s90, v88
    v_pk_fma_f32 v[144:145], v[16:17], v[118:119], v[118:119] op_sel:[0,0,1] op_sel_hi:[1,0,1] neg_lo:[0,0,1] neg_hi:[0,0,1]
    v_cvt_pk_bf16_f32 v124, v144, v145
    v_lshlrev_b32 v144, 16, v124
    v_and_b32 v145, s90, v124
    v_pk_add_f32 v[144:145], v[144:145], v[16:17]
    v_cvt_pk_bf16_f32 v124, v144, v145
    v_lshlrev_b32 v18, 16, v89
    v_and_b32 v19, s90, v89
    v_pk_fma_f32 v[146:147], v[18:19], v[118:119], v[118:119] op_sel:[0,0,1] op_sel_hi:[1,0,1] neg_lo:[0,0,1] neg_hi:[0,0,1]
    v_cvt_pk_bf16_f32 v125, v146, v147
    v_lshlrev_b32 v146, 16, v125
    v_and_b32 v147, s90, v125
    v_pk_add_f32 v[146:147], v[146:147], v[18:19]
    v_cvt_pk_bf16_f32 v125, v146, v147
    ds_write_b64 v64, v[124:125]
    v_lshlrev_b32 v20, 16, v90
    v_and_b32 v21, s90, v90
    v_pk_fma_f32 v[148:149], v[20:21], v[118:119], v[118:119] op_sel:[0,0,1] op_sel_hi:[1,0,1] neg_lo:[0,0,1] neg_hi:[0,0,1]
    v_cvt_pk_bf16_f32 v126, v148, v149
    v_lshlrev_b32 v148, 16, v126
    v_and_b32 v149, s90, v126
    v_pk_add_f32 v[148:149], v[148:149], v[20:21]
    v_cvt_pk_bf16_f32 v126, v148, v149
    v_lshlrev_b32 v22, 16, v91
    v_and_b32 v23, s90, v91
    v_pk_fma_f32 v[150:151], v[22:23], v[118:119], v[118:119] op_sel:[0,0,1] op_sel_hi:[1,0,1] neg_lo:[0,0,1] neg_hi:[0,0,1]
    v_cvt_pk_bf16_f32 v127, v150, v151
    v_lshlrev_b32 v150, 16, v127
    v_and_b32 v151, s90, v127
    v_pk_add_f32 v[150:151], v[150:151], v[22:23]
    v_cvt_pk_bf16_f32 v127, v150, v151
    ds_write_b64 v65, v[126:127]
    s_cmp_eq_u32 s56, 0
    s_cbranch_scc1 L_stay_84
    s_cmp_gt_u32 s62, 1
    s_cbranch_scc0 L_stay_84
    s_mov_b32 s91, -1
    v_lshlrev_b32 v24, 16, v92
    v_and_b32_e64 v25, s90, v92
    v_pk_fma_f32 v[152:153], v[24:25], v[118:119], v[118:119] op_sel:[0,0,1] op_sel_hi:[1,0,1] neg_lo:[0,0,1] neg_hi:[0,0,1]
    v_cvt_pk_bf16_f32 v128, v152, v153
    v_lshlrev_b32 v152, 16, v128
    v_and_b32 v153, s90, v128
    v_pk_add_f32 v[152:153], v[152:153], v[24:25]
    v_cvt_pk_bf16_f32 v128, v152, v153
    v_lshlrev_b32 v26, 16, v93
    v_and_b32 v27, s90, v93
    v_pk_fma_f32 v[154:155], v[26:27], v[118:119], v[118:119] op_sel:[0,0,1] op_sel_hi:[1,0,1] neg_lo:[0,0,1] neg_hi:[0,0,1]
    v_cvt_pk_bf16_f32 v129, v154, v155
    v_lshlrev_b32 v154, 16, v129
    v_and_b32 v155, s90, v129
    v_pk_add_f32 v[154:155], v[154:155], v[26:27]
    v_cvt_pk_bf16_f32 v129, v154, v155
    ds_write_b64 v66, v[128:129]
    v_lshlrev_b32 v28, 16, v94
    v_and_b32 v29, s90, v94
    v_pk_fma_f32 v[156:157], v[28:29], v[118:119], v[118:119] op_sel:[0,0,1] op_sel_hi:[1,0,1] neg_lo:[0,0,1] neg_hi:[0,0,1]
    v_cvt_pk_bf16_f32 v130, v156, v157
    v_lshlrev_b32 v156, 16, v130
    v_and_b32 v157, s90, v130
    v_pk_add_f32 v[156:157], v[156:157], v[28:29]
    v_cvt_pk_bf16_f32 v130, v156, v157
    v_lshlrev_b32 v30, 16, v95
    v_and_b32 v31, s90, v95
    v_pk_fma_f32 v[158:159], v[30:31], v[118:119], v[118:119] op_sel:[0,0,1] op_sel_hi:[1,0,1] neg_lo:[0,0,1] neg_hi:[0,0,1]
    v_cvt_pk_bf16_f32 v131, v158, v159
    v_lshlrev_b32 v158, 16, v131
    v_and_b32 v159, s90, v131
    v_pk_add_f32 v[158:159], v[158:159], v[30:31]
    v_cvt_pk_bf16_f32 v131, v158, v159
    ds_write_b64 v67, v[130:131]
    v_lshlrev_b32 v32, 16, v96
    v_and_b32 v33, s90, v96
    v_pk_fma_f32 v[160:161], v[32:33], v[118:119], v[118:119] op_sel:[0,0,1] op_sel_hi:[1,0,1] neg_lo:[0,0,1] neg_hi:[0,0,1]
    v_cvt_pk_bf16_f32 v132, v160, v161
    v_lshlrev_b32 v160, 16, v132
    v_and_b32 v161, s90, v132
    v_pk_add_f32 v[160:161], v[160:161], v[32:33]
    v_cvt_pk_bf16_f32 v132, v160, v161
    v_lshlrev_b32 v34, 16, v97
    v_and_b32 v35, s90, v97
    v_pk_fma_f32 v[162:163], v[34:35], v[118:119], v[118:119] op_sel:[0,0,1] op_sel_hi:[1,0,1] neg_lo:[0,0,1] neg_hi:[0,0,1]
    v_cvt_pk_bf16_f32 v133, v162, v163
    v_lshlrev_b32 v162, 16, v133
    v_and_b32 v163, s90, v133
    v_pk_add_f32 v[162:163], v[162:163], v[34:35]
    v_cvt_pk_bf16_f32 v133, v162, v163
    ds_write_b64 v68, v[132:133]
    v_lshlrev_b32 v36, 16, v98
    v_and_b32 v37, s90, v98
    v_pk_fma_f32 v[164:165], v[36:37], v[118:119], v[118:119] op_sel:[0,0,1] op_sel_hi:[1,0,1] neg_lo:[0,0,1] neg_hi:[0,0,1]
    v_cvt_pk_bf16_f32 v134, v164, v165
    v_lshlrev_b32 v164, 16, v134
    v_and_b32 v165, s90, v134
    v_pk_add_f32 v[164:165], v[164:165], v[36:37]
    v_cvt_pk_bf16_f32 v134, v164, v165
    v_lshlrev_b32 v38, 16, v99
    v_and_b32 v39, s90, v99
    v_pk_fma_f32 v[166:167], v[38:39], v[118:119], v[118:119] op_sel:[0,0,1] op_sel_hi:[1,0,1] neg_lo:[0,0,1] neg_hi:[0,0,1]
    v_cvt_pk_bf16_f32 v135, v166, v167
    v_lshlrev_b32 v166, 16, v135
    v_and_b32 v167, s90, v135
    v_pk_add_f32 v[166:167], v[166:167], v[38:39]
    v_cvt_pk_bf16_f32 v135, v166, v167
    ds_write_b64 v69, v[134:135]
    v_lshlrev_b32 v40, 16, v100
    v_and_b32 v41, s90, v100
    v_pk_fma_f32 v[168:169], v[40:41], v[118:119], v[118:119] op_sel:[0,0,1] op_sel_hi:[1,0,1] neg_lo:[0,0,1] neg_hi:[0,0,1]
    v_cvt_pk_bf16_f32 v136, v168, v169
    v_lshlrev_b32 v168, 16, v136
    v_and_b32 v169, s90, v136
    v_pk_add_f32 v[168:169], v[168:169], v[40:41]
    v_cvt_pk_bf16_f32 v136, v168, v169
    v_lshlrev_b32 v42, 16, v101
    v_and_b32 v43, s90, v101
    v_pk_fma_f32 v[170:171], v[42:43], v[118:119], v[118:119] op_sel:[0,0,1] op_sel_hi:[1,0,1] neg_lo:[0,0,1] neg_hi:[0,0,1]
    v_cvt_pk_bf16_f32 v137, v170, v171
    v_lshlrev_b32 v170, 16, v137
    v_and_b32 v171, s90, v137
    v_pk_add_f32 v[170:171], v[170:171], v[42:43]
    v_cvt_pk_bf16_f32 v137, v170, v171
    ds_write_b64 v70, v[136:137]
    v_lshlrev_b32 v44, 16, v102
    v_and_b32 v45, s90, v102
    v_pk_fma_f32 v[172:173], v[44:45], v[118:119], v[118:119] op_sel:[0,0,1] op_sel_hi:[1,0,1] neg_lo:[0,0,1] neg_hi:[0,0,1]
    v_cvt_pk_bf16_f32 v138, v172, v173
    v_lshlrev_b32 v172, 16, v138
    v_and_b32 v173, s90, v138
    v_pk_add_f32 v[172:173], v[172:173], v[44:45]
    v_cvt_pk_bf16_f32 v138, v172, v173
    v_lshlrev_b32 v46, 16, v103
    v_and_b32 v47, s90, v103
    v_pk_fma_f32 v[174:175], v[46:47], v[118:119], v[118:119] op_sel:[0,0,1] op_sel_hi:[1,0,1] neg_lo:[0,0,1] neg_hi:[0,0,1]
    v_cvt_pk_bf16_f32 v139, v174, v175
    v_lshlrev_b32 v174, 16, v139
    v_and_b32 v175, s90, v139
    v_pk_add_f32 v[174:175], v[174:175], v[46:47]
    v_cvt_pk_bf16_f32 v139, v174, v175
    ds_write_b64 v71, v[138:139]
    s_sub_u32 s77, s91, s82
    v_lshrrev_b32 v7, 3, v1
    v_sub_u32_e64 v5, s77, v7
    v_mov_b32 v6, 2146435072
    v_and_b32 v8, 7, v1
    v_lshrrev_b32 v9, 4, v1
    v_xor_b32 v8, v8, v9
    v_lshlrev_b32 v8, 4, v8
    v_lshl_add_u32 v7, v7, 11, v8
    v_xor_b32 v8, 64, v7
    s_lshl_b32 s58, s82, 11
    s_lshl_b32 s59, s98, 7
    s_add_u32 s58, s58, s59
    v_cmp_eq_u32 vcc, 0, v5
    s_nop 1
    v_cndmask_b32 v200, v7, v6, vcc
    v_cmp_eq_u32 vcc, 8, v5
    s_nop 1
    v_cndmask_b32 v201, v8, v6, vcc
    v_cmp_eq_u32 vcc, 16, v5
    s_nop 1
    v_cndmask_b32 v202, v7, v6, vcc
    v_cmp_eq_u32 vcc, 24, v5
    s_nop 1
    v_cndmask_b32 v203, v8, v6, vcc
    s_lshl_b32 s77, s62, 12
    s_add_u32 s77, s77, 0
    v_add_u32 v4, s77, v12
    s_waitcnt lgkmcnt(0)
    ds_read_b128 v[48:51], v4 offset:0
    ds_read_b128 v[52:55], v4 offset:1024
    ds_read_b128 v[56:59], v4 offset:2048
    ds_read_b128 v[60:63], v4 offset:3072
    s_waitcnt lgkmcnt(3)
    buffer_store_dwordx4 v[48:51], v200, s[44:47], s58 offen sc1
    s_add_u32 s58, s58, 16384
    s_waitcnt lgkmcnt(2)
    buffer_store_dwordx4 v[52:55], v201, s[44:47], s58 offen sc1
    s_add_u32 s58, s58, 16384
    s_waitcnt lgkmcnt(1)
    buffer_store_dwordx4 v[56:59], v202, s[44:47], s58 offen sc1
    s_add_u32 s58, s58, 16384
    s_waitcnt lgkmcnt(0)
    buffer_store_dwordx4 v[60:63], v203, s[44:47], s58 offen sc1
    s_barrier
    s_barrier
    s_branch L_cdone
L_stay_84:
    v_and_b32 v7, 15, v1
    v_lshlrev_b32_e64 v7, 3, v7
    s_cmp_eq_u32 s62, 0
    s_cbranch_scc0 L_nos4_85
    s_mul_i32 s76, s98, 9344
    s_add_u32 s76, s76, 8388608
    s_add_u32 s20, s26, s99
    s_addc_u32 s21, s27, 0
    s_mov_b32 s88, 0
L_spin_86:
    s_load_dwordx16 s[4:19], s[20:21], 768 glc
    s_waitcnt lgkmcnt(0)
    s_or_b64 s[4:5], s[4:5], s[6:7]
    s_or_b64 s[4:5], s[4:5], s[8:9]
    s_or_b64 s[4:5], s[4:5], s[10:11]
    s_or_b64 s[4:5], s[4:5], s[12:13]
    s_or_b64 s[4:5], s[4:5], s[14:15]
    s_or_b64 s[4:5], s[4:5], s[16:17]
    s_or_b64 s[4:5], s[4:5], s[18:19]
    s_cbranch_scc0 L_gate_87
    s_add_u32 s88, s88, 1
    s_cmp_lt_u32 s88, 65536
    s_cbranch_scc1 L_spin_86
L_gate_87:
    s_mov_b32 s88, 0
L_poll_88:
    buffer_load_dwordx2 v[196:197], v179, s[40:43], s76 offen offset:256 sc1
    buffer_load_dwordx4 v[188:191], v180, s[40:43], s76 offen offset:0 sc1
    buffer_load_dwordx4 v[192:195], v180, s[40:43], s76 offen offset:64 sc1
    s_waitcnt vmcnt(0)
    v_max3_u32 v4, v196, v197, v188
    v_max3_u32 v4, v4, v189, v190
    v_max3_u32 v4, v4, v191, v192
    v_max3_u32 v4, v4, v193, v194
    v_max_u32 v4, v4, v195
    v_cmp_eq_u32_e64 vcc, -1, v4
    s_nop 0
    s_cbranch_vccz L_ok_89
    s_add_u32 s88, s88, 1
    s_cmp_lt_u32 s88, 65536
    s_cbranch_scc1 L_poll_88
L_ok_89:
    ds_write_b128 v12, v[188:191] offset:28672
    ds_write_b128 v12, v[192:195] offset:29696
    ds_write_b64 v7, v[196:197] offset:25728
L_nos4_85:
    s_waitcnt lgkmcnt(0)
    s_barrier
    ds_read_b64 v[8:9], v7 offset:25728
    s_waitcnt lgkmcnt(0)
    v_max_f32_dpp v4, v8, v8 row_ror:8 row_mask:0xf bank_mask:0xf
    s_nop 1
    v_max_f32_dpp v4, v4, v4 row_ror:4 row_mask:0xf bank_mask:0xf
    s_nop 1
    v_max_f32_dpp v4, v4, v4 row_ror:2 row_mask:0xf bank_mask:0xf
    s_nop 1
    v_max_f32_dpp v4, v4, v4 row_ror:1 row_mask:0xf bank_mask:0xf
    v_cmp_eq_f32 vcc, v4, v8
    s_nop 0
    s_ff1_i32_b32 s92, vcc_lo
    s_and_b32 s92, s92, 15
    s_nop 3
    v_readlane_b32 s91, v9, s92
    s_nop 0
    s_cmp_eq_u32 s91, s79
    s_cbranch_scc0 L_noh_90
    s_mov_b32 exec_hi, 0
    buffer_store_dword v182, v177, s[40:43], s99 offen offset:128 sc1
    s_mov_b64 exec, -1
L_noh_90:
    s_sub_u32 s77, s91, s82
    v_lshrrev_b32 v7, 3, v1
    v_sub_u32 v5, s77, v7
    v_mov_b32 v6, 2146435072
    v_and_b32 v8, 7, v1
    v_lshrrev_b32 v9, 4, v1
    v_xor_b32 v8, v8, v9
    v_lshlrev_b32 v8, 4, v8
    v_lshl_add_u32 v7, v7, 11, v8
    v_xor_b32 v8, 64, v7
    s_lshl_b32 s58, s82, 11
    s_lshl_b32 s59, s98, 7
    s_add_u32 s58, s58, s59
    v_cmp_eq_u32 vcc, 0, v5
    s_nop 1
    v_cndmask_b32 v200, v7, v6, vcc
    v_cmp_eq_u32 vcc, 8, v5
    s_nop 1
    v_cndmask_b32 v201, v8, v6, vcc
    v_cmp_eq_u32 vcc, 16, v5
    s_nop 1
    v_cndmask_b32 v202, v7, v6, vcc
    v_cmp_eq_u32 vcc, 24, v5
    s_nop 1
    v_cndmask_b32 v203, v8, v6, vcc
    s_lshl_b32 s77, s62, 12
    s_add_u32 s77, s77, 0
    v_add_u32 v4, s77, v12
    v_lshlrev_b32 v24, 16, v92
    v_and_b32_e64 v25, s90, v92
    v_pk_fma_f32 v[152:153], v[24:25], v[118:119], v[118:119] op_sel:[0,0,1] op_sel_hi:[1,0,1] neg_lo:[0,0,1] neg_hi:[0,0,1]
    v_cvt_pk_bf16_f32 v128, v152, v153
    v_lshlrev_b32 v152, 16, v128
    v_and_b32 v153, s90, v128
    v_pk_add_f32 v[152:153], v[152:153], v[24:25]
    v_cvt_pk_bf16_f32 v128, v152, v153
    v_lshlrev_b32 v26, 16, v93
    v_and_b32 v27, s90, v93
    v_pk_fma_f32 v[154:155], v[26:27], v[118:119], v[118:119] op_sel:[0,0,1] op_sel_hi:[1,0,1] neg_lo:[0,0,1] neg_hi:[0,0,1]
    v_cvt_pk_bf16_f32 v129, v154, v155
    v_lshlrev_b32 v154, 16, v129
    v_and_b32 v155, s90, v129
    v_pk_add_f32 v[154:155], v[154:155], v[26:27]
    v_cvt_pk_bf16_f32 v129, v154, v155
    ds_write_b64 v66, v[128:129]
    v_lshlrev_b32 v28, 16, v94
    v_and_b32 v29, s90, v94
    v_pk_fma_f32 v[156:157], v[28:29], v[118:119], v[118:119] op_sel:[0,0,1] op_sel_hi:[1,0,1] neg_lo:[0,0,1] neg_hi:[0,0,1]
    v_cvt_pk_bf16_f32 v130, v156, v157
    v_lshlrev_b32 v156, 16, v130
    v_and_b32 v157, s90, v130
    v_pk_add_f32 v[156:157], v[156:157], v[28:29]
    v_cvt_pk_bf16_f32 v130, v156, v157
    v_lshlrev_b32 v30, 16, v95
    v_and_b32 v31, s90, v95
    v_pk_fma_f32 v[158:159], v[30:31], v[118:119], v[118:119] op_sel:[0,0,1] op_sel_hi:[1,0,1] neg_lo:[0,0,1] neg_hi:[0,0,1]
    v_cvt_pk_bf16_f32 v131, v158, v159
    v_lshlrev_b32 v158, 16, v131
    v_and_b32 v159, s90, v131
    v_pk_add_f32 v[158:159], v[158:159], v[30:31]
    v_cvt_pk_bf16_f32 v131, v158, v159
    ds_write_b64 v67, v[130:131]
    v_lshlrev_b32 v32, 16, v96
    v_and_b32 v33, s90, v96
    v_pk_fma_f32 v[160:161], v[32:33], v[118:119], v[118:119] op_sel:[0,0,1] op_sel_hi:[1,0,1] neg_lo:[0,0,1] neg_hi:[0,0,1]
    v_cvt_pk_bf16_f32 v132, v160, v161
    v_lshlrev_b32 v160, 16, v132
    v_and_b32 v161, s90, v132
    v_pk_add_f32 v[160:161], v[160:161], v[32:33]
    v_cvt_pk_bf16_f32 v132, v160, v161
    v_lshlrev_b32 v34, 16, v97
    v_and_b32 v35, s90, v97
    v_pk_fma_f32 v[162:163], v[34:35], v[118:119], v[118:119] op_sel:[0,0,1] op_sel_hi:[1,0,1] neg_lo:[0,0,1] neg_hi:[0,0,1]
    v_cvt_pk_bf16_f32 v133, v162, v163
    v_lshlrev_b32 v162, 16, v133
    v_and_b32 v163, s90, v133
    v_pk_add_f32 v[162:163], v[162:163], v[34:35]
    v_cvt_pk_bf16_f32 v133, v162, v163
    ds_write_b64 v68, v[132:133]
    v_lshlrev_b32 v36, 16, v98
    v_and_b32 v37, s90, v98
    v_pk_fma_f32 v[164:165], v[36:37], v[118:119], v[118:119] op_sel:[0,0,1] op_sel_hi:[1,0,1] neg_lo:[0,0,1] neg_hi:[0,0,1]
    v_cvt_pk_bf16_f32 v134, v164, v165
    v_lshlrev_b32 v164, 16, v134
    v_and_b32 v165, s90, v134
    v_pk_add_f32 v[164:165], v[164:165], v[36:37]
    v_cvt_pk_bf16_f32 v134, v164, v165
    v_lshlrev_b32 v38, 16, v99
    v_and_b32 v39, s90, v99
    v_pk_fma_f32 v[166:167], v[38:39], v[118:119], v[118:119] op_sel:[0,0,1] op_sel_hi:[1,0,1] neg_lo:[0,0,1] neg_hi:[0,0,1]
    v_cvt_pk_bf16_f32 v135, v166, v167
    v_lshlrev_b32 v166, 16, v135
    v_and_b32 v167, s90, v135
    v_pk_add_f32 v[166:167], v[166:167], v[38:39]
    v_cvt_pk_bf16_f32 v135, v166, v167
    ds_write_b64 v69, v[134:135]
    v_lshlrev_b32 v40, 16, v100
    v_and_b32 v41, s90, v100
    v_pk_fma_f32 v[168:169], v[40:41], v[118:119], v[118:119] op_sel:[0,0,1] op_sel_hi:[1,0,1] neg_lo:[0,0,1] neg_hi:[0,0,1]
    v_cvt_pk_bf16_f32 v136, v168, v169
    v_lshlrev_b32 v168, 16, v136
    v_and_b32 v169, s90, v136
    v_pk_add_f32 v[168:169], v[168:169], v[40:41]
    v_cvt_pk_bf16_f32 v136, v168, v169
    v_lshlrev_b32 v42, 16, v101
    v_and_b32 v43, s90, v101
    v_pk_fma_f32 v[170:171], v[42:43], v[118:119], v[118:119] op_sel:[0,0,1] op_sel_hi:[1,0,1] neg_lo:[0,0,1] neg_hi:[0,0,1]
    v_cvt_pk_bf16_f32 v137, v170, v171
    v_lshlrev_b32 v170, 16, v137
    v_and_b32 v171, s90, v137
    v_pk_add_f32 v[170:171], v[170:171], v[42:43]
    v_cvt_pk_bf16_f32 v137, v170, v171
    ds_write_b64 v70, v[136:137]
    v_lshlrev_b32 v44, 16, v102
    v_and_b32 v45, s90, v102
    v_pk_fma_f32 v[172:173], v[44:45], v[118:119], v[118:119] op_sel:[0,0,1] op_sel_hi:[1,0,1] neg_lo:[0,0,1] neg_hi:[0,0,1]
    v_cvt_pk_bf16_f32 v138, v172, v173
    v_lshlrev_b32 v172, 16, v138
    v_and_b32 v173, s90, v138
    v_pk_add_f32 v[172:173], v[172:173], v[44:45]
    v_cvt_pk_bf16_f32 v138, v172, v173
    v_lshlrev_b32 v46, 16, v103
    v_and_b32 v47, s90, v103
    v_pk_fma_f32 v[174:175], v[46:47], v[118:119], v[118:119] op_sel:[0,0,1] op_sel_hi:[1,0,1] neg_lo:[0,0,1] neg_hi:[0,0,1]
    v_cvt_pk_bf16_f32 v139, v174, v175
    v_lshlrev_b32 v174, 16, v139
    v_and_b32 v175, s90, v139
    v_pk_add_f32 v[174:175], v[174:175], v[46:47]
    v_cvt_pk_bf16_f32 v139, v174, v175
    ds_write_b64 v71, v[138:139]
    s_barrier
    s_waitcnt lgkmcnt(0)
    ds_read_b128 v[48:51], v4 offset:0
    ds_read_b128 v[52:55], v4 offset:1024
    ds_read_b128 v[56:59], v4 offset:2048
    ds_read_b128 v[60:63], v4 offset:3072
    s_waitcnt lgkmcnt(3)
    buffer_store_dwordx4 v[48:51], v200, s[44:47], s58 offen sc1
    s_add_u32 s58, s58, 16384
    s_waitcnt lgkmcnt(2)
    buffer_store_dwordx4 v[52:55], v201, s[44:47], s58 offen sc1
    s_add_u32 s58, s58, 16384
    s_waitcnt lgkmcnt(1)
    buffer_store_dwordx4 v[56:59], v202, s[44:47], s58 offen sc1
    s_add_u32 s58, s58, 16384
    s_waitcnt lgkmcnt(0)
    buffer_store_dwordx4 v[60:63], v203, s[44:47], s58 offen sc1
L_cdone:
L_cfin:
L_end:
    s_endpgm
L_tr0:
    s_mov_b32 s88, 0
L_trq:
    ds_read_b32 v79, v8 offset:25984
    s_waitcnt lgkmcnt(0)
    v_readfirstlane_b32 s76, v79
    s_nop 0
    s_and_b32 s76, s76, s52
    s_cbranch_scc1 L_bk0
    s_add_u32 s88, s88, 1
    s_cmp_lt_u32 s88, 5
    s_cbranch_scc1 L_trq
    s_cmp_eq_u32 s53, 0
    s_cbranch_scc0 L_sent_68
    s_waitcnt vmcnt(0)
    s_mov_b64 exec, 1
    ds_add_u32 v8, v74 offset:25988
    s_mov_b64 exec, -1
    s_mov_b32 s53, 1
L_sent_68:
    s_call_b64 s[54:55], L_stall
    s_branch L_bk0
L_tr1:
    s_cmp_eq_u32 s53, 0
    s_cbranch_scc0 L_sent_69
    s_waitcnt vmcnt(4)
    s_mov_b64 exec, 1
    ds_add_u32 v8, v74 offset:25988
    s_mov_b64 exec, -1
    s_mov_b32 s53, 1
L_sent_69:
    s_call_b64 s[54:55], L_stall
    s_branch L_bk1
L_tr2:
    s_call_b64 s[54:55], L_stall
    s_branch L_bk2
L_tr3:
    s_call_b64 s[54:55], L_stall
    s_branch L_bk3
L_tr4:
    s_call_b64 s[54:55], L_stall
    s_branch L_bk4
L_tr5:
    s_call_b64 s[54:55], L_stall
    s_branch L_bk5
L_tr6:
    s_call_b64 s[54:55], L_stall
    s_branch L_bk6
L_tr7:
    s_call_b64 s[54:55], L_stall
    s_branch L_bk7
L_tr8:
    s_call_b64 s[54:55], L_stall
    s_branch L_bk8
L_tr9:
    s_call_b64 s[54:55], L_stall
    s_branch L_bk9
L_tr10:
    s_call_b64 s[54:55], L_stall
    s_branch L_bk10
L_tr11:
    s_call_b64 s[54:55], L_stall
    s_branch L_bk11
L_tr12:
    s_call_b64 s[54:55], L_stall
    s_branch L_bk12
L_tr13:
    s_call_b64 s[54:55], L_stall
    s_branch L_bk13
L_tr14:
    s_call_b64 s[54:55], L_stall
    s_branch L_bk14
L_tr15:
    s_call_b64 s[54:55], L_stall
    s_branch L_bk15
L_stall:
    s_cmp_eq_u32 s53, 0
    s_cbranch_scc0 L_sent_67
    s_waitcnt vmcnt(0)
    s_mov_b64 exec, 1
    ds_add_u32 v8, v74 offset:25988
    s_mov_b64 exec, -1
    s_mov_b32 s53, 1
L_sent_67:
    s_mov_b32 s88, 0
L_stall1:
    ds_read_b32 v79, v8 offset:25984
    s_waitcnt lgkmcnt(0)
    v_readfirstlane_b32 s76, v79
    s_nop 0
    s_and_b32 s76, s76, s52
    s_cbranch_scc1 L_stall2
    s_add_u32 s88, s88, 1
    s_cmp_lt_u32 s88, 1048576
    s_cbranch_scc1 L_stall1
    s_mov_b32 s76, s52
L_stall2:
    s_setpc_b64 s[54:55]
L_s3_73:
    v_cmp_eq_u32_e64 vcc, -1, v115
    s_nop 0
    s_cbranch_vccz L_s3skip_75
    buffer_load_dwordx4 v[112:115], v178, s[40:43], s78 offen offset:1024 sc1
L_s3skip_75:
    v_cmp_eq_u32_e64 vcc, -1, v119
    s_nop 0
    s_cbranch_vccz L_s3skip_76
    buffer_load_dwordx4 v[116:119], v178, s[40:43], s48 offen offset:1024 sc1
L_s3skip_76:
    v_cmp_eq_u32_e64 vcc, -1, v123
    s_nop 0
    s_cbranch_vccz L_s3skip_77
    buffer_load_dwordx4 v[120:123], v178, s[40:43], s49 offen offset:1024 sc1
L_s3skip_77:
    v_cmp_eq_u32_e64 vcc, -1, v127
    s_nop 0
    s_cbranch_vccz L_s3skip_78
    buffer_load_dwordx4 v[124:127], v178, s[40:43], s50 offen offset:1024 sc1
L_s3skip_78:
    v_cmp_eq_u32_e64 vcc, -1, v131
    s_nop 0
    s_cbranch_vccz L_s3skip_79
    buffer_load_dwordx4 v[128:131], v178, s[40:43], s51 offen offset:1024 sc1
L_s3skip_79:
    v_cmp_eq_u32_e64 vcc, -1, v135
    s_nop 0
    s_cbranch_vccz L_s3skip_80
    buffer_load_dwordx4 v[132:135], v178, s[40:43], s52 offen offset:1024 sc1
L_s3skip_80:
    v_cmp_eq_u32_e64 vcc, -1, v139
    s_nop 0
    s_cbranch_vccz L_s3skip_81
    buffer_load_dwordx4 v[136:139], v178, s[40:43], s53 offen offset:1024 sc1
L_s3skip_81:
    v_cmp_eq_u32_e64 vcc, -1, v143
    s_nop 0
    s_cbranch_vccz L_s3skip_82
    buffer_load_dwordx4 v[140:143], v178, s[40:43], s54 offen offset:1024 sc1
L_s3skip_82:
    s_waitcnt vmcnt(0)
    v_pk_add_f32 v[108:109], v[112:113], v[116:117]
    v_pk_add_f32 v[110:111], v[114:115], v[118:119]
    v_pk_add_f32 v[108:109], v[108:109], v[120:121]
    v_pk_add_f32 v[110:111], v[110:111], v[122:123]
    v_pk_add_f32 v[108:109], v[108:109], v[124:125]
    v_pk_add_f32 v[110:111], v[110:111], v[126:127]
    v_pk_add_f32 v[108:109], v[108:109], v[128:129]
    v_pk_add_f32 v[110:111], v[110:111], v[130:131]
    v_pk_add_f32 v[108:109], v[108:109], v[132:133]
    v_pk_add_f32 v[110:111], v[110:111], v[134:135]
    v_pk_add_f32 v[108:109], v[108:109], v[136:137]
    v_pk_add_f32 v[110:111], v[110:111], v[138:139]
    v_pk_add_f32 v[108:109], v[108:109], v[140:141]
    v_pk_add_f32 v[110:111], v[110:111], v[142:143]
    v_cmp_u_f32 vcc, v111, v111
    v_mov_b32 v4, v108
    v_mov_b32 v5, v109
    v_mov_b32_e64 v6, v110
    s_cbranch_vccz L_s3ok_74
    s_add_u32 s88, s88, 1
    s_cmp_lt_u32 s88, 65536
    s_cbranch_scc1 L_s3_73
    s_branch L_s3ok_74
L_code_end:
s_endpgm
.p2align 7
.type L_table,@object
L_table:
.long 0x650c3824, 0xfedba97, 0x50110, 0x3006
.long 0x650c3824, 0xfedba97, 0x520200, 0x3060
.long 0x641d0935, 0xfecba87, 0x5000011, 0x3600
.long 0x76543218, 0xfedcba9, 0x15000010, 0x6300
.long 0x641d0935, 0xfecba87, 0x25200, 0x3006
.long 0x54e2a160, 0xfdcb987, 0x501001, 0x3060
.long 0x54e2a160, 0xfdcb987, 0x5000022, 0x3600
.long 0x54f3b271, 0xedca986, 0x50101000, 0x6300
.long 0x54f3b271, 0xedca986, 0x250020, 0x3006
.long 0x650c3824, 0xfedba97, 0x510001, 0x3060
.long 0x650c3824, 0xfedba97, 0x5000202, 0x3600
.long 0x76543218, 0xfedcba9, 0x50000202, 0x6300
.long 0x641d0935, 0xfecba87, 0x15100, 0x3006
.long 0x641d0935, 0xfecba87, 0x500022, 0x3060
.long 0x54e2a160, 0xfdcb987, 0x5100010, 0x3600
.long 0x54e2a160, 0xfdcb987, 0x50202000, 0x6300
.long 0x641d0935, 0xfecba87, 0x500011, 0x3060
.long 0x641d0935, 0xfecba87, 0x5020020, 0x3600
.long 0x54e2a160, 0xfdcb987, 0x50001010, 0x6300
.long 0x76543209, 0xfedcba8, 0x15010, 0x3006
.long 0x54e2a160, 0xfdcb987, 0x500022, 0x3060
.long 0x54f3b271, 0xedca986, 0x5100001, 0x3600
.long 0x54f3b271, 0xedca986, 0x50002020, 0x6300
.long 0x650c3824, 0xfedba97, 0x15100, 0x3006
.long 0x650c3824, 0xfedba97, 0x520020, 0x3060
.long 0x641d0935, 0xfecba87, 0x5010100, 0x3600
.long 0x641d0935, 0xfecba87, 0x50020200, 0x6300
.long 0x76543209, 0xfedcba8, 0x250002, 0x3006
.long 0x54e2a160, 0xfdcb987, 0x5110000, 0x3060
.long 0x54e2a160, 0xfdcb987, 0x5200002, 0x3600
.long 0x54f3b271, 0xedca986, 0x50001010, 0x6300
.long 0x54f3b271, 0xedca986, 0x52020, 0x3006
.long 0x54e2a160, 0xfdcb987, 0x5100100, 0x3600
.long 0x54e2a160, 0xfdcb987, 0x50002002, 0x6300
.long 0x54f3b271, 0xedca986, 0x150010, 0x3006
.long 0x765431a0, 0xfedcb98, 0x150001, 0x3060
.long 0x54f3b271, 0xedca986, 0x5000022, 0x3600
.long 0x650c3824, 0xfedba97, 0x50000101, 0x6300
.long 0x650c3824, 0xfedba97, 0x50220, 0x3006
.long 0x641d0935, 0xfecba87, 0x510100, 0x3060
.long 0x641d0935, 0xfecba87, 0x5000022, 0x3600
.long 0x54e2a160, 0xfdcb987, 0x50001010, 0x6300
.long 0x54e2a160, 0xfdcb987, 0x250002, 0x3006
.long 0x765431a0, 0xfedcb98, 0x500220, 0x3060
.long 0x54f3b271, 0xedca986, 0x5001100, 0x3600
.long 0x54f3b271, 0xedca986, 0x50000022, 0x6300
.long 0x650c3824, 0xfedba97, 0x511000, 0x3006
.long 0x650c3824, 0xfedba97, 0x520002, 0x3060
.long 0x54f3b271, 0xedca986, 0x50100001, 0x6300
.long 0x54f3b271, 0xedca986, 0x52002, 0x3006
.long 0x650c3824, 0xfedba97, 0x500101, 0x3060
.long 0x765421b0, 0xfedca98, 0x1500001, 0x3600
.long 0x650c3824, 0xfedba97, 0x50000022, 0x6300
.long 0x641d0935, 0xfecba87, 0x15100, 0x3006
.long 0x641d0935, 0xfecba87, 0x520020, 0x3060
.long 0x54e2a160, 0xfdcb987, 0x5101000, 0x3600
.long 0x54e2a160, 0xfdcb987, 0x50002020, 0x6300
.long 0x54f3b271, 0xedca986, 0x51010, 0x3006
.long 0x54f3b271, 0xedca986, 0x250020, 0x3060
.long 0x765421b0, 0xfedca98, 0x5000022, 0x3600
.long 0x650c3824, 0xfedba97, 0x50010010, 0x6300
.long 0x650c3824, 0xfedba97, 0x25200, 0x3006
.long 0x641d0935, 0xfecba87, 0x500011, 0x3060
.long 0x641d0935, 0xfecba87, 0x5020200, 0x3600
.long 0x650c3824, 0xfedba97, 0x51010, 0x3006
.long 0x650c3824, 0xfedba97, 0x500022, 0x3060
.long 0x641d0935, 0xfecba87, 0x5100100, 0x3600
.long 0x76532c10, 0xfedba98, 0x15000100, 0x6300
.long 0x641d0935, 0xfecba87, 0x50022, 0x3006
.long 0x54e2a160, 0xfdcb987, 0x150010, 0x3060
.long 0x54e2a160, 0xfdcb987, 0x5202000, 0x3600
.long 0x54f3b271, 0xedca986, 0x50101000, 0x6300
.long 0x54f3b271, 0xedca986, 0x52002, 0x3006
.long 0x650c3824, 0xfedba97, 0x500101, 0x3060
.long 0x650c3824, 0xfedba97, 0x5020020, 0x3600
.long 0x76532c10, 0xfedba98, 0x52000200, 0x6300
.long 0x641d0935, 0xfecba87, 0x15001, 0x3006
.long 0x641d0935, 0xfecba87, 0x520200, 0x3060
.long 0x54e2a160, 0xfdcb987, 0x5001001, 0x3600
.long 0x54e2a160, 0xfdcb987, 0x50000022, 0x6300
.long 0x641d0935, 0xfecba87, 0x501001, 0x3060
.long 0x641d0935, 0xfecba87, 0x5000202, 0x3600
.long 0x54e2a160, 0xfdcb987, 0x50100100, 0x6300
.long 0x76432d10, 0xfecba98, 0x150100, 0x3006
.long 0x54e2a160, 0xfdcb987, 0x252000, 0x3060
.long 0x54f3b271, 0xedca986, 0x5101000, 0x3600
.long 0x54f3b271, 0xedca986, 0x50200002, 0x6300
.long 0x650c3824, 0xfedba97, 0x15100, 0x3006
.long 0x650c3824, 0xfedba97, 0x500202, 0x3060
.long 0x641d0935, 0xfecba87, 0x5000110, 0x3600
.long 0x641d0935, 0xfecba87, 0x50000022, 0x6300
.long 0x76432d10, 0xfecba98, 0x20050200, 0x3006
.long 0x54e2a160, 0xfdcb987, 0x501010, 0x3060
.long 0x54e2a160, 0xfdcb987, 0x5002020, 0x3600
.long 0x54f3b271, 0xedca986, 0x50000110, 0x6300
.long 0x54f3b271, 0xedca986, 0x250002, 0x3006
.long 0x54e2a160, 0xfdcb987, 0x5000011, 0x3600
.long 0x54e2a160, 0xfdcb987, 0x50200020, 0x6300
.long 0x54f3b271, 0xedca986, 0x115000, 0x3006
.long 0x7543e210, 0xfdcba98, 0x501010, 0x3060
.long 0x54f3b271, 0xedca986, 0x5202000, 0x3600
.long 0x650c3824, 0xfedba97, 0x51000001, 0x6300
.long 0x650c3824, 0xfedba97, 0x25002, 0x3006
.long 0x641d0935, 0xfecba87, 0x510100, 0x3060
.long 0x641d0935, 0xfecba87, 0x5020200, 0x3600
.long 0x54e2a160, 0xfdcb987, 0x50011000, 0x6300
.long 0x54e2a160, 0xfdcb987, 0x52020, 0x3006
.long 0x7543e210, 0xfdcba98, 0x522000, 0x3060
.long 0x54f3b271, 0xedca986, 0x5001010, 0x3600
.long 0x54f3b271, 0xedca986, 0x50202000, 0x6300
.long 0x650c3824, 0xfedba97, 0x15100, 0x3006
.long 0x650c3824, 0xfedba97, 0x500220, 0x3060
.long 0x54f3b271, 0xedca986, 0x50001010, 0x6300
.long 0x54f3b271, 0xedca986, 0x250020, 0x3006
.long 0x650c3824, 0xfedba97, 0x500110, 0x3060
.long 0x6543f210, 0xedcba98, 0x15000001, 0x3600
.long 0x650c3824, 0xfedba97, 0x50020200, 0x6300
.long 0x641d0935, 0xfecba87, 0x15001, 0x3006
.long 0x641d0935, 0xfecba87, 0x500202, 0x3060
.long 0x54e2a160, 0xfdcb987, 0x5101000, 0x3600
.long 0x54e2a160, 0xfdcb987, 0x50200002, 0x6300
.long 0x54f3b271, 0xedca986, 0x150001, 0x3006
.long 0x54f3b271, 0xedca986, 0x502002, 0x3060
.long 0x6543f210, 0xedcba98, 0x5202000, 0x3600
.long 0x650c3824, 0xfedba97, 0x50010001, 0x6300
.long 0x650c3824, 0xfedba97, 0x50022, 0x3006
.long 0x641d0935, 0xfecba87, 0x500110, 0x3060
.long 0x641d0935, 0xfecba87, 0x5000022, 0x3600
.long 0x650c3824, 0xfedba97, 0x25002, 0x3006
.long 0x650c3824, 0xfedba97, 0x510010, 0x3060
.long 0x641d0935, 0xfecba87, 0x5020200, 0x3600
.long 0x76543218, 0xfedcba9, 0x50000022, 0x6300
.long 0x641d0935, 0xfecba87, 0x50110, 0x3006
.long 0x54e2a160, 0xfdcb987, 0x250002, 0x3060
.long 0x54e2a160, 0xfdcb987, 0x5101000, 0x3600
.long 0x54f3b271, 0xedca986, 0x50002002, 0x6300
.long 0x54f3b271, 0xedca986, 0x151000, 0x3006
.long 0x650c3824, 0xfedba97, 0x520020, 0x3060
.long 0x650c3824, 0xfedba97, 0x5000101, 0x3600
.long 0x76543218, 0xfedcba9, 0x15000010, 0x6300
.long 0x641d0935, 0xfecba87, 0x25200, 0x3006
.long 0x641d0935, 0xfecba87, 0x510001, 0x3060
.long 0x54e2a160, 0xfdcb987, 0x5000022, 0x3600
.long 0x54e2a160, 0xfdcb987, 0x50000011, 0x6300
.long 0x641d0935, 0xfecba87, 0x500022, 0x3060
.long 0x641d0935, 0xfecba87, 0x5000011, 0x3600
.long 0x54e2a160, 0xfdcb987, 0x50000022, 0x6300
.long 0x76543209, 0xfedcba8, 0x52002, 0x3006
.long 0x54e2a160, 0xfdcb987, 0x501010, 0x3060
.long 0x54f3b271, 0xedca986, 0x5002020, 0x3600
.long 0x54f3b271, 0xedca986, 0x50000011, 0x6300
.long 0x650c3824, 0xfedba97, 0x25020, 0x3006
.long 0x650c3824, 0xfedba97, 0x510100, 0x3060
.long 0x641d0935, 0xfecba87, 0x5000220, 0x3600
.long 0x641d0935, 0xfecba87, 0x50010100, 0x6300
.long 0x76543209, 0xfedcba8, 0x15100, 0x3006
.long 0x54e2a160, 0xfdcb987, 0x252000, 0x3060
.long 0x54e2a160, 0xfdcb987, 0x5100001, 0x3600
.long 0x54f3b271, 0xedca986, 0x50200020, 0x6300
.long 0x54f3b271, 0xedca986, 0x151000, 0x3006
.long 0x54e2a160, 0xfdcb987, 0x5200002, 0x3600
.long 0x54e2a160, 0xfdcb987, 0x50100100, 0x6300
.long 0x54f3b271, 0xedca986, 0x250002, 0x3006
.long 0x765431a0, 0xfedcb98, 0x520020, 0x3060
.long 0x54f3b271, 0xedca986, 0x5001010, 0x3600
.long 0x650c3824, 0xfedba97, 0x50020200, 0x6300
.long 0x650c3824, 0xfedba97, 0x50101, 0x3006
.long 0x641d0935, 0xfecba87, 0x520200, 0x3060
.long 0x641d0935, 0xfecba87, 0x5010100, 0x3600
.long 0x54e2a160, 0xfdcb987, 0x50202000, 0x6300
.long 0x54e2a160, 0xfdcb987, 0x50011, 0x3006
.long 0x765431a0, 0xfedcb98, 0x150010, 0x3060
.long 0x54f3b271, 0xedca986, 0x5200020, 0x3600
.long 0x54f3b271, 0xedca986, 0x50100100, 0x6300
.long 0x650c3824, 0xfedba97, 0x25002, 0x3006
.long 0x650c3824, 0xfedba97, 0x511000, 0x3060
.long 0x54f3b271, 0xedca986, 0x50002002, 0x6300
.long 0x54f3b271, 0xedca986, 0x150010, 0x3006
.long 0x650c3824, 0xfedba97, 0x520200, 0x3060
.long 0x765421b0, 0xfedca98, 0x25000020, 0x3600
.long 0x650c3824, 0xfedba97, 0x50000101, 0x6300
.long 0x641d0935, 0xfecba87, 0x50022, 0x3006
.long 0x641d0935, 0xfecba87, 0x510001, 0x3060
.long 0x54e2a160, 0xfdcb987, 0x5200020, 0x3600
.long 0x54e2a160, 0xfdcb987, 0x50101000, 0x6300
.long 0x54f3b271, 0xedca986, 0x50022, 0x3006
.long 0x54f3b271, 0xedca986, 0x500101, 0x3060
.long 0x765421b0, 0xfedca98, 0x1500010, 0x3600
.long 0x650c3824, 0xfedba97, 0x50000022, 0x6300
.long 0x650c3824, 0xfedba97, 0x511000, 0x3006
.long 0x641d0935, 0xfecba87, 0x520200, 0x3060
.long 0x641d0935, 0xfecba87, 0x5001100, 0x3600
.long 0x650c3824, 0xfedba97, 0x50220, 0x3006
.long 0x650c3824, 0xfedba97, 0x500101, 0x3060
.long 0x641d0935, 0xfecba87, 0x5000022, 0x3600
.long 0x76532c10, 0xfedba98, 0x50000202, 0x6300
.long 0x641d0935, 0xfecba87, 0x50101, 0x3006
.long 0x54e2a160, 0xfdcb987, 0x502020, 0x3060
.long 0x54e2a160, 0xfdcb987, 0x5101000, 0x3600
.long 0x54f3b271, 0xedca986, 0x50200020, 0x6300
.long 0x54f3b271, 0xedca986, 0x151000, 0x3006
.long 0x650c3824, 0xfedba97, 0x500202, 0x3060
.long 0x650c3824, 0xfedba97, 0x5010010, 0x3600
.long 0x76532c10, 0xfedba98, 0x15000001, 0x6300
.long 0x641d0935, 0xfecba87, 0x50022, 0x3006
.long 0x641d0935, 0xfecba87, 0x510010, 0x3060
.long 0x54e2a160, 0xfdcb987, 0x5202000, 0x3600
.long 0x54e2a160, 0xfdcb987, 0x50000110, 0x6300
.long 0x641d0935, 0xfecba87, 0x520200, 0x3060
.long 0x641d0935, 0xfecba87, 0x5000110, 0x3600
.long 0x54e2a160, 0xfdcb987, 0x50202000, 0x6300
.long 0x76432d10, 0xfecba98, 0x52200, 0x3006
.long 0x54e2a160, 0xfdcb987, 0x151000, 0x3060
.long 0x54f3b271, 0xedca986, 0x5200002, 0x3600
.long 0x54f3b271, 0xedca986, 0x50100100, 0x6300
.long 0x650c3824, 0xfedba97, 0x50202, 0x3006
.long 0x650c3824, 0xfedba97, 0x510100, 0x3060
.long 0x641d0935, 0xfecba87, 0x5020002, 0x3600
.long 0x641d0935, 0xfecba87, 0x50010001, 0x6300
.long 0x76432d10, 0xfecba98, 0x150010, 0x3006
.long 0x54e2a160, 0xfdcb987, 0x500022, 0x3060
.long 0x54e2a160, 0xfdcb987, 0x5000011, 0x3600
.long 0x54f3b271, 0xedca986, 0x50002002, 0x6300
.long 0x54f3b271, 0xedca986, 0x51010, 0x3006
.long 0x54e2a160, 0xfdcb987, 0x5002020, 0x3600
.long 0x54e2a160, 0xfdcb987, 0x50101000, 0x6300
.long 0x54f3b271, 0xedca986, 0x52020, 0x3006
.long 0x7543e210, 0xfdcba98, 0x2502000, 0x3060
.long 0x54f3b271, 0xedca986, 0x5001010, 0x3600
.long 0x650c3824, 0xfedba97, 0x50000022, 0x6300
.long 0x650c3824, 0xfedba97, 0x15100, 0x3006
.long 0x641d0935, 0xfecba87, 0x500022, 0x3060
.long 0x641d0935, 0xfecba87, 0x5010100, 0x3600
.long 0x54e2a160, 0xfdcb987, 0x50000022, 0x6300
.long 0x54e2a160, 0xfdcb987, 0x50011, 0x3006
.long 0x7543e210, 0xfdcba98, 0x1500010, 0x3060
.long 0x54f3b271, 0xedca986, 0x5002002, 0x3600
.long 0x54f3b271, 0xedca986, 0x50110000, 0x6300
.long 0x650c3824, 0xfedba97, 0x50220, 0x3006
.long 0x650c3824, 0xfedba97, 0x500011, 0x3060
.long 0x54f3b271, 0xedca986, 0x50200020, 0x6300
.long 0x54f3b271, 0xedca986, 0x15010, 0x3006
.long 0x650c3824, 0xfedba97, 0x500022, 0x3060
.long 0x6543f210, 0xedcba98, 0x25002000, 0x3600
.long 0x650c3824, 0xfedba97, 0x50000101, 0x6300
.long 0x641d0935, 0xfecba87, 0x25200, 0x3006
.long 0x641d0935, 0xfecba87, 0x511000, 0x3060
.long 0x54e2a160, 0xfdcb987, 0x5002002, 0x3600
.long 0x54e2a160, 0xfdcb987, 0x50101000, 0x6300
.long 0x54f3b271, 0xedca986, 0x252000, 0x3006
.long 0x54f3b271, 0xedca986, 0x501001, 0x3060
.long 0x6543f210, 0xedcba98, 0x15001000, 0x3600
.long 0x650c3824, 0xfedba97, 0x50020200, 0x6300
.long 0x650c3824, 0xfedba97, 0x15010, 0x3006
.long 0x641d0935, 0xfecba87, 0x500022, 0x3060
.long 0x641d0935, 0xfecba87, 0x5000101, 0x3600
.fill 1, 4, 0
.size L_table, .-L_table
.section .rodata,"a"
.p2align 6
.amdhsa_kernel sequential_preLN__linear_kernel_hedgehog__moe_arch_mod__prompt_kernel
  .amdhsa_next_free_vgpr 256
  .amdhsa_next_free_sgpr 102
  .amdhsa_accum_offset 256
  .amdhsa_group_segment_fixed_size 0
  .amdhsa_kernarg_size 96
  .amdhsa_user_sgpr_count 2
  .amdhsa_user_sgpr_kernarg_segment_ptr 1
  .amdhsa_system_sgpr_workgroup_id_x 1
  .amdhsa_float_denorm_mode_32 3
.end_amdhsa_kernel
```

```asm
; @launch grid=(256,1,1) block=(512,1,1) lds=163840
.amdgcn_target "amdgcn-amd-amdhsa--gfx950"
.text
.p2align 10
.fill 64, 4, 0xbf800000
.globl sequential_preLN__linear_kernel_hedgehog__moe_arch_mod__prompt_kernel
.p2align 8
.type sequential_preLN__linear_kernel_hedgehog__moe_arch_mod__prompt_kernel,@function
sequential_preLN__linear_kernel_hedgehog__moe_arch_mod__prompt_kernel:
    s_load_dwordx2 s[28:29], s[0:1], 0
    s_load_dwordx2 s[32:33], s[0:1], 8
    s_getpc_b64 s[66:67]
L_pc:
    v_readfirstlane_b32 s79, v0
    s_lshr_b32 s60, s2, 3
    s_cmp_ge_u32 s60, 32
    s_cbranch_scc1 L_end
    v_and_b32_e64 v1, 63, v0
    s_and_b32 s60, s60, 15
    s_lshr_b32 s62, s79, 6
    s_cmp_ge_u32 s62, 4
    s_cbranch_scc1 L_compute
    s_setprio 3
    s_lshr_b32 s76, s2, 3
    s_lshl2_add_u32 s76, s76, s62
    s_mul_i32 s76, s76, 256
    v_lshl_add_u32 v91, v1, 7, s76
    s_mov_b64 exec, 3
    global_load_dword v27, v91, s[66:67]
    s_mov_b64 exec, -1
    s_add_u32 s84, s60, s2
    s_and_b32 s84, s84, 3
    s_and_b32 s76, s60, 7
    s_and_b32 s77, s2, 7
    s_cselect_b32 s84, s84, s76
    v_lshrrev_b32 v4, 3, v1
    v_and_b32 v5, 7, v1
    v_lshrrev_b32 v6, 4, v1
    s_lshl2_add_u32 s76, s60, s62
    s_lshl_b32 s76, s76, 16
    s_movk_i32 s70, 10240
    s_mul_i32 s70, s70, s62
    v_xor_b32 v7, v5, v6
    v_lshlrev_b32 v7, 4, v7
    v_lshl_add_u32 v78, v4, 11, v7
    v_add_u32_e64 v16, s76, v78
    s_mov_b32 s30, 4194304
    s_mov_b32 s31, 0x20000
    s_and_b32 s72, s84, 15
    s_mov_b32 m0, s70
    s_lshl_b32 s71, s72, 7
    s_waitcnt lgkmcnt(0)
    buffer_load_dwordx4 v16, s[28:31], s71 offen offset:0 lds
    s_mul_i32 s72, s72, 393216
    s_lshr_b64 s[84:85], s[84:85], 4
    s_load_dwordx4 s[8:11], s[0:1], 16
    s_load_dwordx16 s[12:27], s[0:1], 32
    v_xor_b32 v7, 64, v16
    v_add_u32 v17, 15360, v7
    buffer_load_dwordx4 v17, s[28:31], s71 offen offset:1024 lds
    v_add_u32 v18, 30720, v16
    buffer_load_dwordx4 v18, s[28:31], s71 offen offset:2048 lds
    v_add_u32 v19, 46080, v7
    buffer_load_dwordx4 v19, s[28:31], s71 offen offset:3072 lds
    s_and_b32 s76, s2, 7
    s_lshl_b32 s76, s76, 3
    s_lshr_b32 s77, s2, 7
    s_lshl2_add_u32 s76, s77, s76
    s_mov_b32 s80, 0x654210b3
    s_mov_b32 s81, 0xfedca987
    s_lshr_b64 s[80:81], s[80:81], s76
    s_and_b32 s61, s80, 15
    v_and_b32 v6, 1, v6
    v_lshlrev_b32 v6, 2, v6
    v_xor_b32 v8, v5, v6
    v_lshlrev_b32_e64 v8, 4, v8
    s_lshl_b32 s76, s61, 7
    s_mul_i32 s77, s62, 98304
    s_add_u32 s76, s76, s77
    v_mul_u32_u24 v7, 6144, v4
    v_add3_u32 v20, v7, v8, s76
    v_xor_b32 v7, 32, v20
    s_mov_b32 s34, 6291456
    s_mov_b32 s35, 0x20000
    s_add_u32 m0, s70, 4096
    s_nop 0
    buffer_load_dwordx4 v20, s[32:35], s72 offen offset:0 lds
    v_add_u32 v21, 48128, v7
    buffer_load_dwordx4 v21, s[32:35], s72 offen offset:1024 lds
    v_add_u32 v22, 0, v20
    buffer_load_dwordx4 v22, s[32:35], s72 offen offset:2048 lds
    v_add_u32 v23, 48128, v7
    buffer_load_dwordx4 v23, s[32:35], s72 offen offset:3072 lds
    v_add_u32 v24, 4096, v20
    s_add_u32 m0, s70, 8192
    s_nop 0
    buffer_load_dwordx4 v24, s[32:35], s72 offen offset:0 lds
    v_add_u32 v25, 52224, v7
    buffer_load_dwordx4 v25, s[32:35], s72 offen offset:1024 lds
    s_add_u32 s70, s70, 40960
    s_cmp_ge_u32 s70, 122880
    s_cselect_b32 s76, 122880, 0
    s_sub_u32 s70, s70, s76
    s_lshl_b32 s76, s60, 8
    s_lshl_b32 s77, s61, 4
    s_add_u32 s76, s76, s77
    s_add_u32 s76, s76, 30700
    s_load_dwordx4 s[84:87], s[66:67], s76
    v_lshl_add_u32 v26, v4, 11, v8
    v_xor_b32 v79, 64, v78
    s_and_b32 s63, s62, 1
    s_lshr_b32 s64, s62, 1
    s_lshl_b32 s73, s60, 4
    s_add_u32 s73, s73, s61
    s_mul_i32 s73, s73, 28800
    s_add_u32 s76, s2, 7
    s_and_b32 s76, s76, 7
    s_bfe_u32 s77, s2, 0x10003
    s_lshl1_add_u32 s97, s76, s77
    s_lshr_b32 s98, s2, 4
    s_lshl_b32 s99, s97, 4
    s_add_u32 s99, s99, s98
    s_mul_i32 s99, s99, 9344
    s_add_u32 s99, s99, 8388608
    s_lshr_b32 s65, s97, 1
    s_lshl_b32 s76, s97, 3
    s_add_u32 s65, s65, s76
    s_mul_i32 s76, s98, 4
    s_add_u32 s65, s65, s76
    s_and_b32 s65, s65, 15
    s_mov_b32 s89, 0x3f803f80
    s_mov_b32 s90, 0xffff0000
    v_and_b32 v2, 31, v1
    v_lshrrev_b32 v3, 5, v1
    v_lshlrev_b32 v12, 4, v1
    v_lshrrev_b32 v4, 3, v1
    v_mul_u32_u24 v13, 460800, v4
    v_and_b32_e64 v4, 7, v1
    v_lshl_add_u32 v13, v4, 4, v13
    s_lshl_b32 s76, s98, 7
    s_lshl_b32 s77, s62, 15
    s_add_u32 s76, s76, s77
    v_add_u32 v26, s76, v26
    v_mov_b32 v28, -1
    v_mov_b32 v29, -1
    v_mov_b32 v30, -1
    v_mov_b32 v31, -1
    s_waitcnt lgkmcnt(0)
    s_and_b32 s72, s84, 15
    s_mov_b32 m0, s70
    s_lshl_b32 s71, s72, 7
    buffer_load_dwordx4 v16, s[28:31], s71 offen offset:0 lds
    s_mul_i32 s72, s72, 393216
    s_lshr_b64 s[84:85], s[84:85], 4
    buffer_load_dwordx4 v17, s[28:31], s71 offen offset:1024 lds
    s_mov_b32 s40, s26
    s_and_b32 s41, s27, 0xffff
    s_mov_b32 s42, 33554432
    s_mov_b32 s43, 0x20000
    buffer_load_dwordx4 v18, s[28:31], s71 offen offset:2048 lds
    s_mov_b32 s56, s8
    s_and_b32 s57, s9, 0xffff
    s_mov_b32 s58, 65536
    s_mov_b32 s59, 0x20000
    buffer_load_dwordx4 v19, s[28:31], s71 offen offset:3072 lds
    s_add_u32 m0, s70, 4096
    s_nop 0
    buffer_load_dwordx4 v20, s[32:35], s72 offen offset:0 lds
    buffer_load_dwordx4 v21, s[32:35], s72 offen offset:1024 lds
    buffer_load_dwordx4 v22, s[32:35], s72 offen offset:2048 lds
    buffer_load_dwordx4 v23, s[32:35], s72 offen offset:3072 lds
    s_add_u32 m0, s70, 8192
    s_nop 0
    buffer_load_dwordx4 v24, s[32:35], s72 offen offset:0 lds
    buffer_load_dwordx4 v25, s[32:35], s72 offen offset:1024 lds
    s_add_u32 s70, s70, 40960
    s_cmp_ge_u32 s70, 122880
    s_cselect_b32 s76, 122880, 0
    s_sub_u32 s70, s70, s76
    s_lshl_b32 s77, s62, 10
    s_add_u32 s76, s77, s73
    buffer_store_dwordx4 v[28:31], v12, s[40:43], s76 offen sc1
    s_lshl_b32 s76, s61, 12
    s_add_u32 s76, s76, s77
    s_add_u32 m0, s77, 122880
    s_nop 0
    buffer_load_dwordx4 v12, s[56:59], s76 offen lds
    v_mov_b32 v4, 13631488
    buffer_load_dwordx2 v[88:89], v4, s[40:43], 0 offen
    s_setprio 0
    s_waitcnt vmcnt(13)
    s_barrier
    s_and_b32 s72, s84, 15
    s_mov_b32 m0, s70
    s_lshl_b32 s71, s72, 7
    buffer_load_dwordx4 v16, s[28:31], s71 offen offset:0 lds
    s_mul_i32 s72, s72, 393216
    s_lshr_b64 s[84:85], s[84:85], 4
    buffer_load_dwordx4 v17, s[28:31], s71 offen offset:1024 lds
    buffer_load_dwordx4 v18, s[28:31], s71 offen offset:2048 lds
    buffer_load_dwordx4 v19, s[28:31], s71 offen offset:3072 lds
    s_add_u32 m0, s70, 4096
    s_nop 0
    buffer_load_dwordx4 v20, s[32:35], s72 offen offset:0 lds
    buffer_load_dwordx4 v21, s[32:35], s72 offen offset:1024 lds
    buffer_load_dwordx4 v22, s[32:35], s72 offen offset:2048 lds
    buffer_load_dwordx4 v23, s[32:35], s72 offen offset:3072 lds
    s_add_u32 m0, s70, 8192
    s_nop 0
    buffer_load_dwordx4 v24, s[32:35], s72 offen offset:0 lds
    buffer_load_dwordx4 v25, s[32:35], s72 offen offset:1024 lds
    s_add_u32 s70, s70, 40960
    s_cmp_ge_u32 s70, 122880
    s_cselect_b32 s76, 122880, 0
    s_sub_u32 s70, s70, s76
    s_mov_b32 s36, s10
    s_and_b32 s37, s11, 0xffff
    s_mov_b32 s38, 2097152
    s_mov_b32 s39, 0x20000
    s_mov_b32 s44, s22
    s_and_b32 s45, s23, 0xffff
    s_mov_b32 s46, 4194304
    s_mov_b32 s47, 0x20000
    s_mov_b32 s52, s20
    s_and_b32 s53, s21, 0xffff
    s_mov_b32 s54, 7340032
    s_mov_b32 s55, 0x20000
    s_cmp_eq_u32 s64, 0
    s_cselect_b32 s48, s16, s18
    s_cselect_b32 s49, s17, s19
    s_and_b32 s49, s49, 0xffff
    s_mov_b32 s51, 0x20000
    s_cmp_lt_u32 s97, 14
    s_cselect_b32 s50, 7340032, 0
    s_cselect_b32 s54, 7340032, 0
    v_bfe_u32 v4, v2, 1, 3
    v_xor_b32 v4, v4, v3
    v_lshlrev_b32 v4, 4, v4
    v_lshl_add_u32 v72, v2, 7, v4
    v_bfe_u32 v4, v1, 2, 2
    v_lshl_add_u32 v5, v3, 3, v4
    v_lshlrev_b32 v5, 7, v5
    v_lshrrev_b32 v4, 1, v4
    v_xor_b32_e64 v4, s64, v4
    v_lshl_add_u32 v5, v4, 6, v5
    v_bfe_u32 v4, v1, 4, 1
    v_xor_b32_e64 v4, v4, v3
    v_lshl_add_u32 v5, v4, 5, v5
    v_and_b32_e64 v4, 3, v1
    v_lshl_add_u32 v5, v4, 3, v5
    s_mul_i32 s76, s62, 10240
    s_sub_u32 s76, 4096, s76
    v_add_u32 v73, s76, v5
    v_lshlrev_b32 v74, 3, v2
    v_lshrrev_b32 v4, 4, v1
    v_and_b32 v5, 15, v1
    v_mul_u32_u24 v66, 28800, v4
    v_lshl_add_u32 v66, v5, 4, v66
    v_mul_u32_u24 v75, 460800, v4
    v_lshl_add_u32 v75, v5, 4, v75
    s_lshr_b32 s76, s60, 3
    s_lshl_b32 s76, s76, 2
    v_lshl_add_u32 v6, v4, 3, s76
    s_mov_b32 s69, 0
    v_mov_b32 v7, 0x654210b3
    v_bfe_u32 v7, v7, v6, 4
    v_mul_u32_u24 v7, 28800, v7
    v_lshl_add_u32 v66, v5, 4, v7
    v_mov_b32 v7, 0xfedca987
    v_bfe_u32 v7, v7, v6, 4
    v_mul_u32_u24 v7, 28800, v7
    v_lshl_add_u32 v67, v5, 4, v7
    v_mov_b32 v80, 0
    v_mov_b32 v81, 0
    v_mov_b32 v82, 0
    v_mov_b32 v83, 0
    v_lshrrev_b32 v4, 4, v1
    v_and_b32_e64 v5, 15, v1
    v_mul_u32_u24 v76, 114688, v4
    v_lshl_add_u32 v76, v5, 4, v76
    v_lshlrev_b32_e64 v77, 4, v2
    v_lshl_add_u32 v77, v3, 11, v77
    s_mul_i32 s75, s98, 458752
    s_lshl_b32 s77, s97, 9
    s_add_u32 s75, s75, s77
    s_lshl_b32 s77, s63, 8
    s_add_u32 s75, s75, s77
    s_lshl_b32 s96, s97, 19
    s_lshl_b32 s77, s98, 15
    s_add_u32 s96, s96, s77
    s_lshl_b32 s77, s62, 9
    s_add_u32 s96, s96, s77
    s_mov_b32 s68, 1
    s_getreg_b32 s101, hwreg(HW_REG_XCC_ID, 0, 4)
    s_lshl_b32 s76, s61, 8
    s_add_u32 s76, s76, 12582912
    s_lshl_b32 s77, s60, 8
    s_add_u32 s77, s77, 12586752
    s_lshr_b32 s78, s97, 1
    s_lshl_b32 s78, s78, 9
    s_add_u32 s78, s78, 12590592
    v_mov_b32 v4, s76
    v_mov_b32 v5, s77
    v_mov_b32 v6, s78
    v_cmp_gt_u32 vcc, 16, v1
    s_nop 1
    v_cndmask_b32 v4, v5, v4, vcc
    v_cmp_gt_u32 vcc, 32, v1
    s_nop 1
    v_cndmask_b32 v4, v6, v4, vcc
    v_add_u32 v90, v4, v12
    s_waitcnt vmcnt(10)
    s_barrier
L_hloop:
    s_and_b32 s77, s86, 15
    s_cbranch_scc1 L_event
L_evret:
    s_and_b32 s72, s84, 15
    s_mov_b32 m0, s70
    s_lshl_b32 s71, s72, 7
    buffer_load_dwordx4 v16, s[28:31], s71 offen offset:0 lds
    s_mul_i32 s72, s72, 393216
    s_lshr_b64 s[84:85], s[84:85], 4
    buffer_load_dwordx4 v17, s[28:31], s71 offen offset:1024 lds
    buffer_load_dwordx4 v18, s[28:31], s71 offen offset:2048 lds
    buffer_load_dwordx4 v19, s[28:31], s71 offen offset:3072 lds
    s_add_u32 m0, s70, 4096
    s_nop 0
    buffer_load_dwordx4 v20, s[32:35], s72 offen offset:0 lds
    buffer_load_dwordx4 v21, s[32:35], s72 offen offset:1024 lds
    buffer_load_dwordx4 v22, s[32:35], s72 offen offset:2048 lds
    buffer_load_dwordx4 v23, s[32:35], s72 offen offset:3072 lds
    s_add_u32 m0, s70, 8192
    s_nop 0
    buffer_load_dwordx4 v24, s[32:35], s72 offen offset:0 lds
    buffer_load_dwordx4 v25, s[32:35], s72 offen offset:1024 lds
    s_add_u32 s70, s70, 40960
    s_cmp_ge_u32 s70, 122880
    s_cselect_b32 s76, 122880, 0
    s_sub_u32 s70, s70, s76
L_hw10:
    s_waitcnt vmcnt(10)
L_hbar:
    s_lshr_b64 s[86:87], s[86:87], 4
    s_add_u32 s68, s68, 1
    s_cmp_lt_u32 s68, 14
    s_barrier
    s_cbranch_scc1 L_hloop
L_hdone:
    v_add_co_u32 v88, vcc, 1, v88
    s_nop 1
    v_addc_co_u32 v89, vcc, 0, v89, vcc
    v_cmp_ne_u64 vcc, v[92:93], v[88:89]
    s_nop 0
    s_cbranch_vccz L_hello_ok_1
    s_mov_b32 s88, 0
L_spin_2:
    buffer_load_dwordx4 v[92:95], v90, s[40:43], 0 offen sc1
    s_waitcnt vmcnt(0)
    v_cmp_ne_u64 vcc, v[92:93], v[88:89]
    s_nop 0
    s_cbranch_vccz L_hello_ok_1
    s_add_u32 s88, s88, 1
    s_cmp_lt_u32 s88, 65536
    s_cbranch_scc1 L_spin_2
L_hello_ok_1:
    v_cmp_ne_u32_e64 vcc, s101, v94
    s_nop 0
    s_and_b32 s76, vcc_lo, 0xffff
    s_cselect_b32 s100, 0, 1
    s_cmp_eq_u32 vcc_hi, 0
    s_cselect_b32 s76, 2, 0
    s_or_b32 s100, s100, s76
    v_mov_b32 v4, s100
    v_mov_b32 v5, 0
    ds_write_b32 v5, v4 offset:53248
    s_lshl_b32 s81, s62, 8
    s_mul_i32 s80, s60, 460800
    s_add_u32 s80, s80, s81
    buffer_load_dwordx4 v[32:35], v66, s[40:43], s80 offen offset:0 sc1
    buffer_load_dwordx4 v[36:39], v67, s[40:43], s80 offen offset:0 sc1
    s_mul_i32 s80, s61, 28800
    s_add_u32 s80, s80, s81
    s_bitcmp1_b32 s2, 7
    s_cselect_b32 s79, 0, 3686400
    s_add_u32 s80, s80, s79
    buffer_load_dwordx4 v[48:51], v75, s[40:43], s80 offen offset:1024 sc1
    s_add_u32 s80, s80, 1843200
    buffer_load_dwordx4 v[52:55], v75, s[40:43], s80 offen offset:1024 sc1
    v_bfe_u32 v10, v1, 4, 1
    v_lshl_add_u32 v10, v10, 1, v3
    v_min_u32 v10, 2, v10
    v_and_b32 v7, 15, v1
    v_lshlrev_b32_e64 v7, 3, v7
    s_lshl_b32 s76, s62, 7
    v_lshl_add_u32 v10, v10, 9, v7
    v_add_u32_e64 v64, s76, v10
    v_lshl_add_u32 v65, v7, 1, s81
    v_bfe_u32 v10, v1, 4, 1
    v_lshl_add_u32 v65, v10, 3, v65
    s_mul_i32 s78, s62, 2048
    s_add_u32 s78, s78, s99
    s_add_u32 s78, s78, 1024
    v_lshlrev_b32 v11, 7, v1
    s_mov_b64 exec, 65535
    buffer_load_dword v27, v11, s[40:43], s78 offen sc1
    s_mov_b64 exec, -1
    s_add_u32 s78, s65, 0
    s_and_b32 s78, s78, 15
    s_lshl_b32 s78, s78, 17
    s_lshl_b32 s79, s62, 11
    s_add_u32 m0, s79, 57344
    s_add_u32 s79, s78, 15360
    buffer_load_dwordx4 v26, s[36:39], s78 offen lds
    buffer_load_dwordx4 v26, s[36:39], s79 offen offset:1024 lds
    s_waitcnt vmcnt(7)
    s_barrier
    s_add_u32 s78, s65, 1
    s_and_b32 s78, s78, 15
    s_lshl_b32 s78, s78, 17
    s_lshl_b32 s79, s62, 11
    s_add_u32 m0, s79, 65536
    s_add_u32 s79, s78, 15360
    buffer_load_dwordx4 v26, s[36:39], s78 offen lds
    buffer_load_dwordx4 v26, s[36:39], s79 offen offset:1024 lds
    s_setprio 3
    s_mov_b32 s88, 0
    s_waitcnt vmcnt(7)
    s_branch L_g1first_3
L_g1_4:
    s_mul_i32 s80, s60, 460800
    s_add_u32 s80, s80, s81
    buffer_load_dwordx4 v[32:35], v66, s[40:43], s80 offen offset:0 sc1
    buffer_load_dwordx4 v[36:39], v67, s[40:43], s80 offen offset:0 sc1
    s_waitcnt vmcnt(0)
L_g1first_3:
    v_max3_u32 v4, v32, v34, v36
    v_max_u32 v4, v4, v38
    v_cmp_eq_u32 vcc, -1, v4
    s_nop 0
    s_cbranch_vccz L_ok_5
    s_add_u32 s88, s88, 1
    s_cmp_lt_u32 s88, 65536
    s_cbranch_scc1 L_g1_4
L_ok_5:
    v_add_f32 v32, v32, v36
    v_add_f32 v33, v33, v37
    v_add_f32 v34, v34, v38
    v_add_f32_e64 v35, v35, v39
    s_add_u32 s78, s65, 2
    s_and_b32 s78, s78, 15
    s_lshl_b32 s78, s78, 17
    s_lshl_b32 s79, s62, 11
    s_add_u32 m0, s79, 73728
    s_add_u32 s79, s78, 15360
    buffer_load_dwordx4 v26, s[36:39], s78 offen lds
    buffer_load_dwordx4 v26, s[36:39], s79 offen offset:1024 lds
    v_permlane32_swap_b32 v32, v33
    v_permlane32_swap_b32 v34, v35
    v_add_f32 v32, v32, v33
    v_add_f32 v34, v34, v35
    s_nop 1
    v_permlane16_swap_b32 v32, v34
    v_add_f32 v32, v32, v34
    v_mov_b32 v33, v32
    s_nop 1
    v_permlane32_swap_b32 v32, v33
    v_mul_f32 v32, 0x3a800000, v32
    v_mul_f32 v33, 0x3a800000, v33
    v_fma_f32 v7, -v32, v32, v33
    v_max_f32_e64 v7, 0, v7
    v_cvt_pk_bf16_f32 v5, v32, v32
    v_and_b32_e64 v5, s90, v5
    v_cvt_pk_bf16_f32 v7, v7, v7
    v_and_b32_e64 v7, s90, v7
    v_add_f32 v7, 0x3727c5ac, v7
    v_cvt_pk_bf16_f32 v7, v7, v7
    v_and_b32 v7, s90, v7
    v_sqrt_f32_e64 v7, v7
    s_nop 0
    v_cvt_pk_bf16_f32 v7, v7, v7
    v_and_b32 v7, s90, v7
    v_rcp_f32 v9, v7
    v_xor_b32 v5, 0x80000000, v5
    v_cvt_pk_bf16_f32 v8, v5, v5
    ds_write_b64 v65, v[8:9] offset:49152
    s_mov_b32 s88, 0
    s_waitcnt vmcnt(7)
    s_branch L_g1first_6
L_g1_7:
    s_mul_i32 s80, s61, 28800
    s_add_u32 s80, s80, s81
    s_bitcmp1_b32 s2, 7
    s_cselect_b32 s79, 0, 3686400
    s_add_u32 s80, s80, s79
    buffer_load_dwordx4 v[48:51], v75, s[40:43], s80 offen offset:1024 sc1
    s_add_u32 s80, s80, 1843200
    buffer_load_dwordx4 v[52:55], v75, s[40:43], s80 offen offset:1024 sc1
    s_waitcnt vmcnt(0)
L_g1first_6:
    v_max3_u32 v4, v48, v50, v52
    v_max_u32 v4, v4, v54
    v_cmp_eq_u32 vcc, -1, v4
    s_nop 0
    s_cbranch_vccz L_ok_8
    s_add_u32 s88, s88, 1
    s_cmp_lt_u32 s88, 65536
    s_cbranch_scc1 L_g1_7
L_ok_8:
    v_add_f32 v48, v48, v52
    v_add_f32 v49, v49, v53
    v_add_f32 v50, v50, v54
    v_add_f32 v51, v51, v55
    v_add_f32 v49, v49, v51
    v_mov_b32 v51, v49
    v_permlane32_swap_b32 v48, v50
    s_nop 0
    v_permlane32_swap_b32 v49, v51
    v_add_f32 v48, v48, v50
    v_add_f32 v49, v49, v51
    s_nop 1
    v_permlane16_swap_b32 v48, v49
    v_add_f32_e64 v48, v48, v49
    v_cvt_pk_bf16_f32 v49, v48, v48
    v_and_b32 v49, s90, v49
    v_sub_f32 v49, v48, v49
    v_cvt_pk_bf16_f32 v50, v48, v49
    v_and_b32 v51, s90, v50
    v_sub_f32 v49, v49, v51
    v_cvt_pk_bf16_f32 v51, v49, 0
    ds_write_b64 v64, v[50:51] offset:50176
    s_setprio 0
    s_waitcnt lgkmcnt(0)
    s_barrier
    s_add_u32 s78, s65, 3
    s_and_b32 s78, s78, 15
    s_lshl_b32 s78, s78, 17
    s_lshl_b32 s79, s62, 11
    s_add_u32 m0, s79, 81920
    s_add_u32 s79, s78, 15360
    buffer_load_dwordx4 v26, s[36:39], s78 offen lds
    buffer_load_dwordx4 v26, s[36:39], s79 offen offset:1024 lds
    s_add_u32 s78, s65, 4
    s_and_b32 s78, s78, 15
    s_lshl_b32 s78, s78, 17
    s_lshl_b32 s79, s62, 11
    s_add_u32 m0, s79, 90112
    s_add_u32 s79, s78, 15360
    buffer_load_dwordx4 v26, s[36:39], s78 offen lds
    buffer_load_dwordx4 v26, s[36:39], s79 offen offset:1024 lds
    s_lshl_b32 s78, s62, 11
    s_add_u32 s79, s78, s99
    s_bitcmp1_b32 s100, 0
    s_cbranch_scc1 L_loc_9
    buffer_store_dwordx4 v[28:31], v12, s[40:43], s79 offen offset:1024 sc1
    buffer_store_dwordx4 v[28:31], v12, s[40:43], s79 offen offset:2048 sc1
    s_branch L_pubd_10
L_loc_9:
    buffer_store_dwordx4 v[28:31], v12, s[40:43], s79 offen offset:1024
    buffer_store_dwordx4 v[28:31], v12, s[40:43], s79 offen offset:2048
L_pubd_10:
    s_lshl_b32 s79, s62, 8
    s_add_u32 s79, s79, s99
    s_mov_b64 exec, 0xffff
    buffer_store_dwordx4 v[28:31], v12, s[40:43], s79 offen sc1
    s_mov_b64 exec, -1
    s_add_u32 s78, s65, 5
    s_and_b32 s78, s78, 15
    s_lshl_b32 s78, s78, 17
    s_lshl_b32 s79, s62, 11
    s_add_u32 m0, s79, 98304
    s_add_u32 s79, s78, 15360
    buffer_load_dwordx4 v26, s[36:39], s78 offen lds
    buffer_load_dwordx4 v26, s[36:39], s79 offen offset:1024 lds
    s_add_u32 s78, s65, 6
    s_and_b32 s78, s78, 15
    s_lshl_b32 s78, s78, 17
    s_lshl_b32 s79, s62, 11
    s_add_u32 m0, s79, 106496
    s_add_u32 s79, s78, 15360
    buffer_load_dwordx4 v26, s[36:39], s78 offen lds
    buffer_load_dwordx4 v26, s[36:39], s79 offen offset:1024 lds
    s_add_u32 s78, s65, 7
    s_and_b32 s78, s78, 15
    s_lshl_b32 s78, s78, 17
    s_lshl_b32 s79, s62, 11
    s_add_u32 m0, s79, 114688
    s_add_u32 s79, s78, 15360
    buffer_load_dwordx4 v26, s[36:39], s78 offen lds
    buffer_load_dwordx4 v26, s[36:39], s79 offen offset:1024 lds
    s_mul_i32 s78, s62, 384
    s_add_u32 s78, s78, s73
    s_add_u32 s78, s78, 2048
    v_lshlrev_b32 v11, 7, v1
    s_mov_b64 exec, 7
    buffer_load_dword v27, v11, s[40:43], s78 offen sc1
    s_mov_b64 exec, -1
    s_waitcnt vmcnt(7)
    s_lshl_b32 s76, s62, 2
    s_add_u32 s76, s76, s73
    v_mov_b32 v4, 0
    s_mov_b64 exec, 1
    s_bitcmp1_b32 s100, 0
    s_cbranch_scc1 L_loc_11
    buffer_store_dword v4, v4, s[40:43], s76 offen offset:2560 sc1
    s_branch L_pubd_12
L_loc_11:
    buffer_store_dword v4, v4, s[40:43], s76 offen offset:2560
L_pubd_12:
    s_mov_b64 exec, -1
    s_add_u32 s78, s65, 8
    s_and_b32 s78, s78, 15
    s_lshl_b32 s78, s78, 17
    s_lshl_b32 s79, s62, 11
    s_add_u32 m0, s79, 122880
    s_add_u32 s79, s78, 15360
    buffer_load_dwordx4 v26, s[36:39], s78 offen lds
    buffer_load_dwordx4 v26, s[36:39], s79 offen offset:1024 lds
    s_add_u32 s78, s65, 9
    s_and_b32 s78, s78, 15
    s_lshl_b32 s78, s78, 17
    s_lshl_b32 s79, s62, 11
    s_add_u32 m0, s79, 131072
    s_add_u32 s79, s78, 15360
    buffer_load_dwordx4 v26, s[36:39], s78 offen lds
    buffer_load_dwordx4 v26, s[36:39], s79 offen offset:1024 lds
    s_add_u32 s78, s65, 10
    s_and_b32 s78, s78, 15
    s_lshl_b32 s78, s78, 17
    s_lshl_b32 s79, s62, 11
    s_add_u32 m0, s79, 139264
    s_add_u32 s79, s78, 15360
    buffer_load_dwordx4 v26, s[36:39], s78 offen lds
    buffer_load_dwordx4 v26, s[36:39], s79 offen offset:1024 lds
    v_and_b32_e64 v65, 15, v1
    v_mul_u32_u24 v65, 460800, v65
    s_mul_i32 s80, s61, 28800
    s_lshl_b32 s82, s62, 2
    s_add_u32 s82, s82, s80
    v_bfe_u32 v4, v1, 4, 1
    v_lshl_add_u32 v4, v4, 1, v3
    s_lshl_b32 s77, s62, 6
    v_lshl_add_u32 v66, v4, 1, s77
    v_bfe_u32 v4, v1, 2, 1
    v_lshl_add_u32 v66, v4, 5, v66
    v_bfe_u32 v4, v1, 0, 1
    v_lshl_add_u32 v66, v4, 4, v66
    v_bfe_u32 v4, v1, 1, 1
    v_lshl_add_u32 v66, v4, 3, v66
    s_lshl_b32 s83, s62, 7
    s_add_u32 s81, s83, s80
    s_add_u32 s68, s81, 3686400
    s_add_u32 s83, s83, s73
    v_and_b32 v4, 7, v1
    v_lshrrev_b32 v5, 4, v1
    v_lshlrev_b32_e64 v5, 2, v5
    v_lshl_add_u32 v67, v4, 4, v5
    v_bfe_u32 v5, v1, 3, 1
    v_lshrrev_b32_e64 v6, 4, v1
    v_lshl_add_u32 v5, v5, 4, v6
    v_mul_u32_u24 v5, 9344, v5
    v_lshl_add_u32 v61, v4, 4, v5
    s_lshr_b32 s69, s97, 1
    s_lshr_b32 s76, s2, 7
    s_lshl2_add_u32 s69, s69, s76
    s_mul_i32 s69, s69, 74752
    s_add_u32 s69, s69, 8389632
    s_barrier
    s_add_u32 s78, s65, 11
    s_and_b32 s78, s78, 15
    s_lshl_b32 s78, s78, 17
    s_lshl_b32 s79, s62, 11
    s_add_u32 m0, s79, 147456
    s_add_u32 s79, s78, 15360
    buffer_load_dwordx4 v26, s[36:39], s78 offen lds
    buffer_load_dwordx4 v26, s[36:39], s79 offen offset:1024 lds
    s_add_u32 s78, s65, 12
    s_and_b32 s78, s78, 15
    s_lshl_b32 s78, s78, 17
    s_lshl_b32 s79, s62, 11
    s_add_u32 m0, s79, 155648
    s_add_u32 s79, s78, 15360
    buffer_load_dwordx4 v26, s[36:39], s78 offen lds
    buffer_load_dwordx4 v26, s[36:39], s79 offen offset:1024 lds
    buffer_load_dword v64, v65, s[40:43], s82 offen offset:2560 sc1
    s_barrier
    s_setprio 3
    v_mov_b32 v4, s89
    v_lshlrev_b32 v5, 2, v1
    ds_write_b32 v5, v4 offset:24832
    v_mov_b32 v70, 0
    v_mov_b32 v71, 0
    ds_write_b64 v70, v[70:71] offset:25984
    s_mov_b32 s88, 0
    s_branch L_p2first_13
L_p2_14:
    buffer_load_dword v64, v65, s[40:43], s82 offen offset:2560 sc1
L_p2first_13:
    s_waitcnt vmcnt(0)
    v_cmp_eq_u32_e64 vcc, -1, v64
    s_nop 0
    s_cbranch_vccz L_ok_15
    s_add_u32 s88, s88, 1
    s_cmp_lt_u32 s88, 65536
    s_cbranch_scc1 L_p2_14
L_ok_15:
    s_add_u32 s78, s65, 13
    s_and_b32 s78, s78, 15
    s_lshl_b32 s78, s78, 17
    s_lshl_b32 s79, s62, 11
    s_add_u32 m0, s79, 32768
    s_add_u32 s79, s78, 15360
    buffer_load_dwordx4 v26, s[36:39], s78 offen lds
    buffer_load_dwordx4 v26, s[36:39], s79 offen offset:1024 lds
    s_add_u32 s78, s65, 14
    s_and_b32 s78, s78, 15
    s_lshl_b32 s78, s78, 17
    s_lshl_b32 s79, s62, 11
    s_add_u32 m0, s79, 40960
    s_add_u32 s79, s78, 15360
    buffer_load_dwordx4 v26, s[36:39], s78 offen lds
    buffer_load_dwordx4 v26, s[36:39], s79 offen offset:1024 lds
    s_add_u32 s78, s65, 15
    s_and_b32 s78, s78, 15
    s_lshl_b32 s78, s78, 17
    s_lshl_b32 s79, s62, 11
    s_add_u32 m0, s79, 49152
    s_add_u32 s79, s78, 15360
    buffer_load_dwordx4 v26, s[36:39], s78 offen lds
    buffer_load_dwordx4 v26, s[36:39], s79 offen offset:1024 lds
    s_lshl_b32 s76, s62, 11
    s_lshl_b32 s77, s60, 7
    s_add_u32 s76, s76, s77
    s_add_u32 s76, s76, s69
    s_add_u32 s77, s76, 37376
    s_mov_b32 s78, 0x00003f80
    s_mov_b32 s79, 0x3f800000
    s_mov_b32 s88, 0
L_poll_16:
    buffer_load_dwordx4 v[32:35], v61, s[40:43], s76 offen sc1
    buffer_load_dwordx4 v[36:39], v61, s[40:43], s77 offen sc1
    s_waitcnt vmcnt(0)
    v_max_u32 v4, v32, v36
    v_cmp_eq_u32_e64 vcc, -1, v4
    s_nop 0
    s_cbranch_vccz L_ok_17
    s_add_u32 s88, s88, 1
    s_cmp_lt_u32 s88, 65536
    s_cbranch_scc1 L_poll_16
L_ok_17:
    v_dot2_f32_bf16 v48, v32, s78, 0
    v_dot2_f32_bf16 v49, v32, s79, 0
    v_dot2_f32_bf16 v50, v33, s78, 0
    v_dot2_f32_bf16 v51, v33, s79, 0
    v_dot2_f32_bf16 v52, v34, s78, 0
    v_dot2_f32_bf16 v53, v34, s79, 0
    v_dot2_f32_bf16 v54, v35, s78, 0
    v_dot2_f32_bf16 v55, v35, s79, 0
    v_dot2_f32_bf16 v48, v36, s78, v48
    v_dot2_f32_bf16 v49, v36, s79, v49
    v_dot2_f32_bf16 v50, v37, s78, v50
    v_dot2_f32_bf16 v51, v37, s79, v51
    v_dot2_f32_bf16 v52, v38, s78, v52
    v_dot2_f32_bf16 v53, v38, s79, v53
    v_dot2_f32_bf16 v54, v39, s78, v54
    v_dot2_f32_bf16 v55, v39, s79, v55
    buffer_load_dwordx4 v[40:43], v13, s[40:43], s81 offen offset:2048 sc1
    buffer_load_dwordx4 v[44:47], v13, s[40:43], s68 offen offset:2048 sc1
    v_permlane32_swap_b32 v48, v52
    v_permlane32_swap_b32 v49, v53
    v_permlane32_swap_b32 v50, v54
    v_permlane32_swap_b32 v51, v55
    v_add_f32 v48, v48, v52
    v_add_f32 v49, v49, v53
    v_add_f32 v50, v50, v54
    v_add_f32 v51, v51, v55
    s_nop 0
    v_permlane16_swap_b32 v48, v50
    v_permlane16_swap_b32 v49, v51
    v_add_f32 v48, v48, v50
    v_add_f32_e64 v49, v49, v51
    s_nop 0
    v_add_f32_dpp v48, v48, v48 row_ror:8 row_mask:0xf bank_mask:0xf
    v_add_f32_dpp v49, v49, v49 row_ror:8 row_mask:0xf bank_mask:0xf
    v_cvt_pk_bf16_f32 v48, v48, v49
    s_bitcmp1_b32 s100, 0
    s_cbranch_scc1 L_loc_18
    buffer_store_dword v48, v67, s[40:43], s83 offen offset:3072 sc1
    s_branch L_pubd_19
L_loc_18:
    buffer_store_dword v48, v67, s[40:43], s83 offen offset:3072
L_pubd_19:
    s_mov_b32 s88, 0
    s_waitcnt vmcnt(1)
    s_branch L_zfirst_20
L_z_21:
    buffer_load_dwordx4 v[40:43], v13, s[40:43], s81 offen offset:2048 sc1
    buffer_load_dwordx4 v[44:47], v13, s[40:43], s68 offen offset:2048 sc1
    s_waitcnt vmcnt(0)
L_zfirst_20:
    v_max3_u32 v4, v40, v41, v42
    v_max3_u32 v4, v4, v43, v44
    v_max3_u32 v4, v4, v45, v46
    v_max_u32 v4, v4, v47
    v_cmp_eq_u32 vcc, -1, v4
    s_nop 0
    s_cbranch_vccz L_ok_22
    s_add_u32 s88, s88, 1
    s_cmp_lt_u32 s88, 65536
    s_cbranch_scc1 L_z_21
L_ok_22:
    v_add_f32 v40, v40, v44
    v_add_f32 v41, v41, v45
    v_add_f32 v42, v42, v46
    v_add_f32 v43, v43, v47
    v_permlane32_swap_b32 v40, v41
    s_nop 0
    v_permlane32_swap_b32 v42, v43
    v_add_f32 v40, v40, v41
    v_add_f32 v42, v42, v43
    s_nop 1
    v_permlane16_swap_b32 v40, v42
    v_add_f32 v40, v40, v42
    s_nop 1
    v_add_f32_dpp v40, v40, v40 row_ror:8 row_mask:0xf bank_mask:0xf
    v_cvt_pk_bf16_f32 v40, v40, v40
    ds_write_b16 v66, v40 offset:24576
    s_waitcnt lgkmcnt(0)
    s_barrier
    s_setprio 0
    s_mov_b64 exec, 3
    global_load_dword v27, v91, s[66:67]
    s_mov_b64 exec, -1
    s_lshl_b32 s78, s97, 18
    s_lshl_b32 s79, s62, 16
    s_add_u32 s78, s78, s79
    s_lshl_b32 s79, s98, 7
    s_add_u32 s78, s78, s79
    s_lshl_b32 s79, s62, 12
    s_add_u32 m0, s79, 0
    s_nop 0
    buffer_load_dwordx4 v78, s[28:31], s78 offen offset:0 lds
    s_add_u32 s78, s78, 15360
    buffer_load_dwordx4 v79, s[28:31], s78 offen offset:1024 lds
    s_add_u32 s78, s78, 15360
    buffer_load_dwordx4 v78, s[28:31], s78 offen offset:2048 lds
    s_add_u32 s78, s78, 15360
    buffer_load_dwordx4 v79, s[28:31], s78 offen offset:3072 lds
    s_mov_b32 s56, s14
    s_and_b32 s57, s15, 0xffff
    s_mov_b32 s58, 2048
    s_mov_b32 s59, 0x20000
    s_lshl_b32 s78, s62, 9
    s_add_u32 m0, s78, 16384
    s_mov_b32 exec_hi, 0
    buffer_load_dwordx4 v12, s[56:59], s78 offen lds
    s_mov_b64 exec, -1
    s_barrier
    s_lshl4_add_u32 s76, s97, s98
    s_mul_i32 s76, s76, 28800
    s_add_u32 s20, s26, s76
    s_addc_u32 s21, s27, 0
    s_cmp_eq_u32 s62, 0
    s_cbranch_scc0 L_now0_25
    s_load_dwordx16 s[4:19], s[20:21], 3584 glc
    s_waitcnt lgkmcnt(0)
    s_and_b64 s[4:5], s[4:5], s[6:7]
    s_and_b64 s[4:5], s[4:5], s[8:9]
    s_and_b64 s[4:5], s[4:5], s[10:11]
    s_and_b64 s[4:5], s[4:5], s[12:13]
    s_and_b64 s[4:5], s[4:5], s[14:15]
    s_and_b64 s[4:5], s[4:5], s[16:17]
    s_and_b64 s[4:5], s[4:5], s[18:19]
    s_nand_b32 s4, s4, s5
    s_and_b32 s4, s4, 0xffff
    s_mul_i32 s4, s4, 0x10001
    s_lshr_b32 s4, s4, s65
    s_and_b32 s77, s4, 0xffff
    v_mov_b32_e64 v69, s77
    s_mov_b64 exec, 1
    ds_or_b32 v70, v69 offset:25984
    s_mov_b64 exec, -1
    s_waitcnt vmcnt(0) lgkmcnt(0)
    s_load_dwordx16 s[4:19], s[20:21], 3584 glc
    s_barrier
    s_mov_b32 s88, 0
    s_branch L_fo2
L_now0_25:
    s_waitcnt vmcnt(0) lgkmcnt(0)
    s_barrier
    s_cmp_eq_u32 s62, 0
    s_cbranch_scc0 L_now1_23
    s_mov_b32 s88, 0
L_spin_26:
    s_load_dwordx16 s[4:19], s[20:21], 3584 glc
L_fo2:
    s_waitcnt lgkmcnt(0)
    s_and_b64 s[4:5], s[4:5], s[6:7]
    s_and_b64 s[4:5], s[4:5], s[8:9]
    s_and_b64 s[4:5], s[4:5], s[10:11]
    s_and_b64 s[4:5], s[4:5], s[12:13]
    s_and_b64 s[4:5], s[4:5], s[14:15]
    s_and_b64 s[4:5], s[4:5], s[16:17]
    s_and_b64 s[4:5], s[4:5], s[18:19]
    s_nand_b32 s4, s4, s5
    s_and_b32 s4, s4, 0xffff
    s_mul_i32 s4, s4, 0x10001
    s_lshr_b32 s4, s4, s65
    s_and_b32 s77, s4, 0xffff
    v_mov_b32 v69, s77
    s_mov_b64 exec, 1
    ds_or_b32 v70, v69 offset:25984
    s_mov_b64 exec, -1
    s_cmp_eq_u32 s77, 0xffff
    s_cbranch_scc1 L_s2done_24
    s_add_u32 s88, s88, 1
    s_cmp_lt_u32 s88, 65536
    s_cbranch_scc1 L_spin_26
    s_branch L_s2done_24
L_now1_23:
    s_cmp_eq_u32 s62, 1
    s_cbranch_scc0 L_s2done_24
    s_lshl_b32 s77, 1, s61
    s_not_b32 s77, s77
    v_mov_b32 v4, s77
    v_mul_u32_u24 v5, 28800, v1
    s_mul_i32 s76, s60, 460800
    s_lshl2_add_u32 s76, s61, s76
    s_mov_b32 s88, 0
L_spin_27:
    ds_read_b32 v69, v70 offset:25988
    s_waitcnt lgkmcnt(0)
    v_cmp_eq_u32_e64 vcc, 4, v69
    s_nop 0
    s_cbranch_vccnz L_drained_28
    s_add_u32 s88, s88, 1
    s_cmp_lt_u32 s88, 1048576
    s_cbranch_scc1 L_spin_27
L_drained_28:
    s_mov_b64 exec, 0xffff
    buffer_store_dword v4, v5, s[40:43], s76 offen offset:3584 sc1
    s_mov_b64 exec, -1
L_s2done_24:
    s_waitcnt vmcnt(0)
    s_mov_b32 s78, 0x05040100
    s_mov_b32 s79, 0x07060302
    v_perm_b32 v160, v100, v96, s78
    v_perm_b32 v164, v100, v96, s79
    v_perm_b32 v168, v101, v97, s78
    v_perm_b32 v172, v101, v97, s79
    v_perm_b32 v176, v102, v98, s78
    v_perm_b32 v180, v102, v98, s79
    v_perm_b32 v184, v103, v99, s78
    v_perm_b32 v188, v103, v99, s79
    v_perm_b32 v161, v108, v104, s78
    v_perm_b32 v165, v108, v104, s79
    v_perm_b32 v169, v109, v105, s78
    v_perm_b32 v173, v109, v105, s79
    v_perm_b32 v177, v110, v106, s78
    v_perm_b32 v181, v110, v106, s79
    v_perm_b32 v185, v111, v107, s78
    v_perm_b32 v189, v111, v107, s79
    v_perm_b32 v162, v116, v112, s78
    v_perm_b32 v166, v116, v112, s79
    v_perm_b32 v170, v117, v113, s78
    v_perm_b32 v174, v117, v113, s79
    v_perm_b32 v178, v118, v114, s78
    v_perm_b32 v182, v118, v114, s79
    v_perm_b32 v186, v119, v115, s78
    v_perm_b32 v190, v119, v115, s79
    v_perm_b32 v163, v124, v120, s78
    v_perm_b32 v167, v124, v120, s79
    v_perm_b32 v171, v125, v121, s78
    v_perm_b32 v175, v125, v121, s79
    v_perm_b32 v179, v126, v122, s78
    v_perm_b32 v183, v126, v122, s79
    v_perm_b32 v187, v127, v123, s78
    v_perm_b32 v191, v127, v123, s79
    v_perm_b32 v192, v132, v128, s78
    v_perm_b32 v196, v132, v128, s79
    v_perm_b32 v200, v133, v129, s78
    v_perm_b32 v204, v133, v129, s79
    v_perm_b32 v208, v134, v130, s78
    v_perm_b32 v212, v134, v130, s79
    v_perm_b32 v216, v135, v131, s78
    v_perm_b32 v220, v135, v131, s79
    v_perm_b32 v193, v140, v136, s78
    v_perm_b32 v197, v140, v136, s79
    v_perm_b32 v201, v141, v137, s78
    v_perm_b32 v205, v141, v137, s79
    v_perm_b32 v209, v142, v138, s78
    v_perm_b32 v213, v142, v138, s79
    v_perm_b32 v217, v143, v139, s78
    v_perm_b32 v221, v143, v139, s79
    v_perm_b32 v194, v148, v144, s78
    v_perm_b32 v198, v148, v144, s79
    v_perm_b32 v202, v149, v145, s78
    v_perm_b32 v206, v149, v145, s79
    v_perm_b32 v210, v150, v146, s78
    v_perm_b32 v214, v150, v146, s79
    v_perm_b32 v218, v151, v147, s78
    v_perm_b32 v222, v151, v147, s79
    v_perm_b32 v195, v156, v152, s78
    v_perm_b32 v199, v156, v152, s79
    v_perm_b32 v203, v157, v153, s78
    v_perm_b32 v207, v157, v153, s79
    v_perm_b32 v211, v158, v154, s78
    v_perm_b32 v215, v158, v154, s79
    v_perm_b32 v219, v159, v155, s78
    v_perm_b32 v223, v159, v155, s79
    v_lshlrev_b32 v17, 5, v2
    v_lshl_add_u32 v17, v3, 4, v17
    v_and_b32 v4, 15, v1
    v_lshrrev_b32 v5, 1, v4
    v_and_b32 v4, 1, v4
    v_lshlrev_b32 v4, 5, v4
    v_lshl_add_u32 v16, v5, 7, v4
    v_lshrrev_b32 v4, 3, v1
    v_and_b32 v5, 7, v1
    v_lshlrev_b32_e64 v5, 4, v5
    v_mul_u32_u24 v18, 9344, v4
    v_add_u32_e64 v18, v18, v5
    v_bfe_u32 v6, v1, 4, 1
    v_lshl_add_u32 v6, v6, 1, v3
    v_lshl_add_u32 v19, v6, 2, v5
    s_mul_i32 s84, s97, 149504
    s_lshl_b32 s77, s98, 7
    s_add_u32 s84, s84, s77
    s_add_u32 s84, s84, 8388608
    s_lshl_b32 s85, s62, 10
    s_add_u32 s85, s85, s99
    s_add_u32 s85, s85, 5120
    s_and_b32 s87, s97, 1
    s_lshl_b32 s87, s87, 4
    s_add_u32 s87, s87, s98
    s_lshr_b32 s86, s97, 1
    s_mul_i32 s86, s86, 299008
    s_lshl_b32 s77, s87, 7
    s_add_u32 s86, s86, s77
    s_add_u32 s86, s86, 8393728
    s_lshl_b32 s78, s62, 11
    s_add_u32 s79, s78, s99
    s_bitcmp1_b32 s100, 1
    s_cbranch_scc1 L_loc_29
    buffer_store_dwordx4 v[28:31], v12, s[40:43], s79 offen offset:1024 sc1
    buffer_store_dwordx4 v[28:31], v12, s[40:43], s79 offen offset:2048 sc1
    s_branch L_pubd_30
L_loc_29:
    buffer_store_dwordx4 v[28:31], v12, s[40:43], s79 offen offset:1024
    buffer_store_dwordx4 v[28:31], v12, s[40:43], s79 offen offset:2048
L_pubd_30:
    s_lshl4_add_u32 s78, s97, s98
    s_lshl4_add_u32 s78, s78, s62
    s_add_u32 s78, s78, 12591116
    s_waitcnt vmcnt(0)
    s_mov_b64 exec, 1
    s_bitcmp1_b32 s100, 1
    s_cbranch_scc1 L_loc_31
    buffer_store_byte v28, v70, s[40:43], s78 offen sc1
    s_branch L_pubd_32
L_loc_31:
    buffer_store_byte v28, v70, s[40:43], s78 offen
L_pubd_32:
    s_mov_b64 exec, -1
    s_cmp_eq_u32 s62, 0
    s_cbranch_scc0 L_nop3c_33
    s_mov_b32 exec_lo, 0
    s_mov_b32 s88, 0
L_spin_34:
    buffer_load_dword v4, v90, s[40:43], 0 offen offset:12 sc1
    s_waitcnt vmcnt(0)
    v_cmp_ne_u32 vcc, -1, v4
    s_nop 0
    s_cbranch_vccz L_p3ok_35
    s_add_u32 s88, s88, 1
    s_cmp_lt_u32 s88, 65536
    s_cbranch_scc1 L_spin_34
L_p3ok_35:
    s_mov_b64 exec, -1
L_nop3c_33:
    s_barrier
    buffer_load_dwordx4 v[224:227], v77, s[52:55], s96 offen nt
    s_add_u32 s96, s96, 4096
    buffer_load_dwordx4 v[228:231], v77, s[52:55], s96 offen nt
    s_add_u32 s96, s96, 4096
    buffer_load_dwordx4 v[232:235], v77, s[52:55], s96 offen nt
    s_add_u32 s96, s96, 4096
    buffer_load_dwordx4 v[236:239], v77, s[52:55], s96 offen nt
    s_add_u32 s96, s96, 4096
    buffer_load_dwordx4 v[240:243], v77, s[52:55], s96 offen nt
    s_add_u32 s96, s96, 4096
    v_mul_u32_u24 v20, 149504, v1
    s_mul_i32 s72, s98, 9344
    s_lshl2_add_u32 s72, s97, s72
    s_add_u32 s72, s72, 8388608
    s_barrier
    s_cmp_eq_u32 s62, 1
    s_cbranch_scc0 L_nopre_36
    s_mov_b64 exec, 0xffff
    buffer_store_dword v70, v20, s[40:43], s72 offen offset:768 sc1
    s_mov_b64 exec, -1
L_nopre_36:
    buffer_load_dwordx4 v[244:247], v77, s[52:55], s96 offen nt
    s_add_u32 s96, s96, 4096
    buffer_load_dwordx4 v[248:251], v77, s[52:55], s96 offen nt
    s_add_u32 s96, s96, 4096
    buffer_load_dwordx4 v[252:255], v77, s[52:55], s96 offen nt
    s_add_u32 s96, s96, 4096
    s_barrier
    s_waitcnt vmcnt(7)
    s_mov_b32 s78, 0x05040100
    s_mov_b32 s79, 0x07060302
    v_permlane32_swap_b32 v224, v226
    v_permlane32_swap_b32 v225, v227
    v_perm_b32 v32, v226, v224, s78
    v_perm_b32 v33, v226, v224, s79
    v_perm_b32 v34, v227, v225, s78
    v_perm_b32 v35, v227, v225, s79
    s_waitcnt vmcnt(6)
    s_mov_b32 s78, 0x05040100
    s_mov_b32 s79, 0x07060302
    v_permlane32_swap_b32 v228, v230
    v_permlane32_swap_b32_e64 v229, v231
    v_perm_b32 v36, v230, v228, s78
    v_perm_b32 v37, v230, v228, s79
    v_perm_b32 v38, v231, v229, s78
    v_perm_b32 v39, v231, v229, s79
    s_waitcnt vmcnt(5)
    s_mov_b32 s78, 0x05040100
    s_mov_b32 s79, 0x07060302
    v_permlane32_swap_b32 v232, v234
    v_permlane32_swap_b32_e64 v233, v235
    v_perm_b32 v40, v234, v232, s78
    v_perm_b32 v41, v234, v232, s79
    v_perm_b32 v42, v235, v233, s78
    v_perm_b32 v43, v235, v233, s79
    s_waitcnt vmcnt(4)
    s_mov_b32 s78, 0x05040100
    s_mov_b32 s79, 0x07060302
    v_permlane32_swap_b32 v236, v238
    v_permlane32_swap_b32_e64 v237, v239
    v_perm_b32 v44, v238, v236, s78
    v_perm_b32 v45, v238, v236, s79
    v_perm_b32 v46, v239, v237, s78
    v_perm_b32 v47, v239, v237, s79
    s_waitcnt vmcnt(3)
    s_mov_b32 s78, 0x05040100
    s_mov_b32 s79, 0x07060302
    v_permlane32_swap_b32 v240, v242
    v_permlane32_swap_b32_e64 v241, v243
    v_perm_b32 v48, v242, v240, s78
    v_perm_b32 v49, v242, v240, s79
    v_perm_b32 v50, v243, v241, s78
    v_perm_b32 v51, v243, v241, s79
    s_waitcnt vmcnt(2)
    s_mov_b32 s78, 0x05040100
    s_mov_b32 s79, 0x07060302
    v_permlane32_swap_b32 v244, v246
    v_permlane32_swap_b32_e64 v245, v247
    v_perm_b32 v52, v246, v244, s78
    v_perm_b32 v53, v246, v244, s79
    v_perm_b32 v54, v247, v245, s78
    v_perm_b32 v55, v247, v245, s79
    s_waitcnt vmcnt(1)
    s_mov_b32 s78, 0x05040100
    s_mov_b32 s79, 0x07060302
    v_permlane32_swap_b32 v248, v250
    v_permlane32_swap_b32_e64 v249, v251
    v_perm_b32 v56, v250, v248, s78
    v_perm_b32 v57, v250, v248, s79
    v_perm_b32 v58, v251, v249, s78
    v_perm_b32 v59, v251, v249, s79
    s_waitcnt vmcnt(0)
    s_mov_b32 s78, 0x05040100
    s_mov_b32 s79, 0x07060302
    v_permlane32_swap_b32 v252, v254
    v_permlane32_swap_b32_e64 v253, v255
    v_perm_b32 v60, v254, v252, s78
    v_perm_b32 v61, v254, v252, s79
    v_perm_b32 v62, v255, v253, s78
    v_perm_b32 v63, v255, v253, s79
    v_and_b32 v5, 15, v1
    v_lshlrev_b32 v5, 3, v5
    s_lshl_b32 s76, s63, 10
    s_lshl_b32 s77, s64, 6
    s_add_u32 s76, s76, s77
    s_add_u32 s76, s76, s99
    s_mov_b64 s[80:81], 0xffff
    s_add_u32 s68, s84, 74752
    s_add_u32 s69, s86, 74752
    s_add_u32 s70, s86, 149504
    s_add_u32 s71, s86, 224256
    s_setprio 3
    s_barrier
    ds_read_b128 v[64:67], v12 offset:28672
    ds_read_b128 v[68:71], v12 offset:29696
    ds_read_b64 v[8:9], v5 offset:25728
    s_waitcnt lgkmcnt(2)
    v_mfma_f32_16x16x32_bf16 v[96:99], v[64:67], v[160:163], 0
    v_mfma_f32_16x16x32_bf16 v[100:103], v[64:67], v[164:167], 0
    s_waitcnt lgkmcnt(0)
    v_max_f32_dpp v4, v8, v8 row_ror:8 row_mask:0xf bank_mask:0xf
    v_mfma_f32_16x16x32_bf16 v[104:107], v[64:67], v[168:171], 0
    v_mfma_f32_16x16x32_bf16 v[108:111], v[64:67], v[172:175], 0
    v_max_f32_dpp v4, v4, v4 row_ror:4 row_mask:0xf bank_mask:0xf
    v_mfma_f32_16x16x32_bf16 v[112:115], v[64:67], v[176:179], 0
    v_mfma_f32_16x16x32_bf16 v[116:119], v[64:67], v[180:183], 0
    v_max_f32_dpp v4, v4, v4 row_ror:2 row_mask:0xf bank_mask:0xf
    v_mfma_f32_16x16x32_bf16 v[120:123], v[64:67], v[184:187], 0
    v_mfma_f32_16x16x32_bf16 v[124:127], v[64:67], v[188:191], 0
    v_max_f32_dpp v4, v4, v4 row_ror:1 row_mask:0xf bank_mask:0xf
    v_mfma_f32_16x16x32_bf16 v[96:99], v[68:71], v[192:195], v[96:99]
    v_cmp_eq_f32_e64 vcc, v4, v8
    v_mfma_f32_16x16x32_bf16 v[100:103], v[68:71], v[196:199], v[100:103]
    s_ff1_i32_b32 s92, vcc_lo
    s_and_b32 s92, s92, 15
    v_mfma_f32_16x16x32_bf16 v[104:107], v[68:71], v[200:203], v[104:107]
    s_lshr_b32 s78, s92, 2
    s_lshl_b32 s78, s78, 4
    v_mfma_f32_16x16x32_bf16 v[108:111], v[68:71], v[204:207], v[108:111]
    s_and_b32 s77, s92, 3
    v_mfma_f32_16x16x32_bf16 v[112:115], v[68:71], v[208:211], v[112:115]
    v_readlane_b32 s91, v9, s92
    v_readlane_b32 s93, v8, s92
    v_mfma_f32_16x16x32_bf16 v[116:119], v[68:71], v[212:215], v[116:119]
    v_mfma_f32_16x16x32_bf16 v[120:123], v[68:71], v[216:219], v[120:123]
    v_mfma_f32_16x16x32_bf16 v[124:127], v[68:71], v[220:223], v[124:127]
    s_cmp_ge_u32 s97, 14
    s_cbranch_scc1 L_final
    s_cmp_eq_u32 s77, 0
    s_cbranch_scc0 L_sel_38
    v_mov_b32 v64, v96
    v_mov_b32 v65, v100
    v_mov_b32 v66, v104
    v_mov_b32 v67, v108
    v_mov_b32 v68, v112
    v_mov_b32 v69, v116
    v_mov_b32 v70, v120
    v_mov_b32 v71, v124
    s_branch L_seldone_37
L_sel_38:
    s_cmp_eq_u32 s77, 1
    s_cbranch_scc0 L_sel_39
    v_mov_b32 v64, v97
    v_mov_b32 v65, v101
    v_mov_b32 v66, v105
    v_mov_b32 v67, v109
    v_mov_b32 v68, v113
    v_mov_b32 v69, v117
    v_mov_b32 v70, v121
    v_mov_b32 v71, v125
    s_branch L_seldone_37
L_sel_39:
    s_cmp_eq_u32 s77, 2
    s_cbranch_scc0 L_sel_40
    v_mov_b32 v64, v98
    v_mov_b32 v65, v102
    v_mov_b32 v66, v106
    v_mov_b32 v67, v110
    v_mov_b32 v68, v114
    v_mov_b32 v69, v118
    v_mov_b32 v70, v122
    v_mov_b32 v71, v126
    s_branch L_seldone_37
L_sel_40:
    v_mov_b32 v64, v99
    v_mov_b32 v65, v103
    v_mov_b32 v66, v107
    v_mov_b32 v67, v111
    v_mov_b32 v68, v115
    v_mov_b32 v69, v119
    v_mov_b32 v70, v123
    v_mov_b32_e64 v71, v127
L_seldone_37:
    s_lshl_b64 exec, s[80:81], s78
    s_bitcmp1_b32 s100, 1
    s_cbranch_scc1 L_loc_42
    buffer_store_dwordx4 v[64:67], v16, s[40:43], s76 offen offset:3072 sc1
    buffer_store_dwordx4 v[68:71], v16, s[40:43], s76 offen offset:3088 sc1
    s_branch L_pubd_43
L_loc_42:
    buffer_store_dwordx4 v[64:67], v16, s[40:43], s76 offen offset:3072
    buffer_store_dwordx4 v[68:71], v16, s[40:43], s76 offen offset:3088
L_pubd_43:
    s_mov_b64 exec, -1
    s_mov_b32 s88, 0
L_poll_44:
    buffer_load_dwordx4 v[128:131], v18, s[40:43], s84 offen offset:3072 sc1
    buffer_load_dwordx4 v[132:135], v18, s[40:43], s68 offen offset:3072 sc1
    s_waitcnt vmcnt(0)
    v_max_u32 v4, v128, v132
    v_cmp_eq_u32_e64 vcc, -1, v4
    s_nop 0
    s_cbranch_vccz L_ok_45
    s_add_u32 s88, s88, 1
    s_cmp_lt_u32 s88, 65536
    s_cbranch_scc1 L_poll_44
L_ok_45:
    v_pk_add_f32 v[152:153], v[128:129], v[132:133]
    v_pk_add_f32 v[154:155], v[130:131], v[134:135]
    s_nop 0
    v_permlane32_swap_b32 v152, v153
    v_permlane32_swap_b32 v154, v155
    v_add_f32 v152, v152, v153
    v_add_f32 v154, v154, v155
    s_nop 1
    v_permlane16_swap_b32 v152, v154
    v_add_f32 v152, v152, v154
    s_nop 1
    v_add_f32_dpp v152, v152, v152 row_ror:8 row_mask:0xf bank_mask:0xf
    v_cvt_pk_bf16_f32 v152, v152, v152
    v_and_b32_e64 v152, s90, v152
    v_mul_f32 v4, 0xbfb8aa3b, v152
    v_exp_f32_e64 v4, v4
    v_mov_b32_dpp v153, v152 row_ror:12 row_mask:0xf bank_mask:0xf
    v_add_f32 v4, 1.0, v4
    v_rcp_f32 v4, v4
    s_nop 0
    v_mul_f32 v4, v4, v152
    v_cvt_pk_bf16_f32 v4, v4, v4
    v_and_b32 v4, s90, v4
    v_mul_f32 v4, v4, v153
    v_mov_b32 v5, v4
    s_nop 1
    v_permlane32_swap_b32_e64 v4, v5
    v_cvt_pk_bf16_f32 v4, v4, v5
    s_nop 0
    v_readlane_b32 s76, v4, 0
    v_readlane_b32 s77, v4, 16
    v_readlane_b32 s78, v4, 1
    v_readlane_b32 s79, v4, 17
    v_readlane_b32 s80, v4, 2
    v_readlane_b32 s81, v4, 18
    v_readlane_b32 s82, v4, 3
    v_readlane_b32 s83, v4, 19
    v_dot2_f32_bf16 v20, v32, s76, 0
    v_dot2_f32_bf16 v21, v33, s76, 0
    v_dot2_f32_bf16 v22, v34, s76, 0
    v_dot2_f32_bf16 v23, v35, s76, 0
    v_dot2_f32_bf16 v20, v36, s77, v20
    v_dot2_f32_bf16 v21, v37, s77, v21
    v_dot2_f32_bf16 v22, v38, s77, v22
    v_dot2_f32_bf16 v23, v39, s77, v23
    v_dot2_f32_bf16 v20, v40, s78, v20
    v_dot2_f32_bf16 v21, v41, s78, v21
    v_dot2_f32_bf16 v22, v42, s78, v22
    v_dot2_f32_bf16 v23, v43, s78, v23
    v_dot2_f32_bf16 v20, v44, s79, v20
    v_dot2_f32_bf16 v21, v45, s79, v21
    v_dot2_f32_bf16 v22, v46, s79, v22
    v_dot2_f32_bf16 v23, v47, s79, v23
    v_dot2_f32_bf16 v20, v48, s80, v20
    v_dot2_f32_bf16 v21, v49, s80, v21
    v_dot2_f32_bf16 v22, v50, s80, v22
    v_dot2_f32_bf16 v23, v51, s80, v23
    v_dot2_f32_bf16 v20, v52, s81, v20
    v_dot2_f32_bf16 v21, v53, s81, v21
    v_dot2_f32_bf16 v22, v54, s81, v22
    v_dot2_f32_bf16 v23, v55, s81, v23
    v_dot2_f32_bf16 v20, v56, s82, v20
    v_dot2_f32_bf16 v21, v57, s82, v21
    v_dot2_f32_bf16 v22, v58, s82, v22
    v_dot2_f32_bf16 v23, v59, s82, v23
    v_dot2_f32_bf16 v20, v60, s83, v20
    v_dot2_f32_bf16 v21, v61, s83, v21
    v_dot2_f32_bf16 v22, v62, s83, v22
    v_dot2_f32_bf16 v23, v63, s83, v23
    s_bitcmp1_b32 s100, 1
    s_cbranch_scc1 L_loc_46
    s_nop 0
    buffer_store_dwordx4 v[20:23], v17, s[40:43], s85 offen sc1
    s_branch L_pubd_47
L_loc_46:
    s_nop 0
    buffer_store_dwordx4 v[20:23], v17, s[40:43], s85 offen
L_pubd_47:
    s_cmp_eq_u32 s62, 0
    s_cbranch_scc0 L_hby
    s_mov_b32 s88, 0
L_poll_48:
    buffer_load_dwordx4 v[136:139], v18, s[40:43], s86 offen sc1
    buffer_load_dwordx4 v[140:143], v18, s[40:43], s69 offen sc1
    buffer_load_dwordx4 v[144:147], v18, s[40:43], s70 offen sc1
    buffer_load_dwordx4 v[148:151], v18, s[40:43], s71 offen sc1
    s_waitcnt vmcnt(0)
    v_max3_u32 v4, v136, v140, v144
    v_max_u32 v4, v4, v148
    v_cmp_eq_u32_e64 vcc, -1, v4
    s_nop 0
    s_cbranch_vccz L_ok_49
    s_add_u32 s88, s88, 1
    s_cmp_lt_u32 s88, 65536
    s_cbranch_scc1 L_poll_48
L_ok_49:
    v_pk_add_f32 v[152:153], v[136:137], v[144:145]
    v_pk_add_f32 v[154:155], v[138:139], v[146:147]
    v_pk_add_f32 v[156:157], v[140:141], v[148:149]
    v_pk_add_f32 v[158:159], v[142:143], v[150:151]
    v_pk_add_f32 v[152:153], v[152:153], v[156:157]
    v_pk_add_f32 v[154:155], v[154:155], v[158:159]
    s_nop 0
    v_permlane32_swap_b32 v152, v153
    v_permlane32_swap_b32 v154, v155
    v_add_f32 v152, v152, v153
    v_add_f32 v154, v154, v155
    s_nop 1
    v_permlane16_swap_b32 v152, v154
    v_add_f32 v152, v152, v154
    s_nop 1
    v_add_f32_dpp v152, v152, v152 row_ror:8 row_mask:0xf bank_mask:0xf
    buffer_store_dword v152, v19, s[40:43], s99 offen offset:512 sc1
L_hby:
    s_barrier
    s_lshl2_add_u32 s72, s87, s62
    s_cmp_eq_u32 s72, 0
    s_cbranch_scc0 L_nowb_50
    s_waitcnt vmcnt(0)
    buffer_wbl2 sc1
L_nowb_50:
    s_branch L_hfin
L_final:
    s_barrier
    s_lshl2_add_u32 s72, s87, s62
    s_cmp_eq_u32 s72, 3
    s_cbranch_scc0 L_nowb_51
    s_waitcnt vmcnt(0)
    buffer_wbl2 sc1
L_nowb_51:
    s_cmp_eq_u32 s62, 1
    s_cbranch_scc0 L_noep_52
    s_cmp_eq_u32 s87, 0
    s_cbranch_scc0 L_noep_52
    v_mov_b32 v4, 13631488
    s_mov_b64 exec, 1
    buffer_store_dwordx2 v[88:89], v4, s[40:43], 0 offen sc1
    s_mov_b64 exec, -1
L_noep_52:
    s_cmp_eq_u32 s62, 0
    s_cbranch_scc0 L_hfin
    v_mov_b32 v8, s93
    v_cvt_pk_bf16_f32 v8, v8, v8
    v_and_b32_e64 v8, s90, v8
    v_mul_f32 v8, 0xbfb8aa3b, v8
    v_exp_f32 v8, v8
    s_nop 0
    v_add_f32 v8, 1.0, v8
    v_rcp_f32_e64 v8, v8
    s_nop 0
    v_cvt_pk_bf16_f32 v8, v8, v8
    v_and_b32 v8, s90, v8
    s_lshl_b32 s76, s92, 4
    s_lshr_b32 s77, s87, 1
    s_add_u32 s76, s76, s77
    s_mul_i32 s76, s76, 9344
    s_add_u32 s76, s76, 8388608
    s_and_b32 s77, s87, 1
    s_lshl_b32 s77, s77, 5
    s_add_u32 s76, s76, s77
    v_and_b32 v10, 1, v1
    v_lshlrev_b32_e64 v10, 6, v10
    v_bfe_u32 v4, v1, 1, 2
    v_lshl_add_u32 v10, v4, 3, v10
    v_bfe_u32 v4, v1, 4, 1
    v_lshl_add_u32 v10, v4, 2, v10
    v_lshrrev_b32_e64 v4, 3, v1
    v_mul_u32_u24 v6, 299008, v4
    v_and_b32_e64 v5, 7, v1
    v_lshl_add_u32 v6, v5, 4, v6
    v_mov_b32 v7, 2146435072
    v_cmp_gt_u32 vcc, 56, v1
    s_nop 1
    v_cndmask_b32_e64 v6, v7, v6, vcc
    s_mul_i32 s79, s87, 9344
    s_add_u32 s79, s79, 8388608
    s_lshl_b32 s80, s91, 11
    s_lshl_b32 s77, s87, 6
    s_add_u32 s80, s80, s77
    s_mov_b32 s88, 0
L_spin_53:
    buffer_load_dword v64, v10, s[40:43], s76 offen offset:0 sc1
    buffer_load_dword v65, v10, s[40:43], s76 offen offset:128 sc1
    s_waitcnt vmcnt(0)
    v_max_u32 v4, v64, v65
    v_cmp_eq_u32 vcc, -1, v4
    s_nop 0
    s_cbranch_vccz L_ok_54
    s_add_u32 s88, s88, 1
    s_cmp_lt_u32 s88, 65536
    s_cbranch_scc1 L_spin_53
L_ok_54:
    v_lshlrev_b32 v4, 4, v3
    v_lshrrev_b32 v64, v4, v64
    v_lshrrev_b32 v65, v4, v65
    v_lshlrev_b32 v64, 16, v64
    v_lshlrev_b32 v65, 16, v65
    v_lshrrev_b32 v9, 1, v19
    s_mov_b32 s88, 0
    buffer_load_dwordx4 v[128:131], v6, s[40:43], s79 offen offset:512 sc1
    buffer_load_dwordx4 v[128:131], v6, s[40:43], s79 offen offset:512 sc1
L_poll_55:
    buffer_load_dwordx4 v[128:131], v6, s[40:43], s79 offen offset:512 sc1
    s_waitcnt vmcnt(2)
    v_max3_u32 v4, v128, v129, v130
    v_max_u32 v4, v4, v131
    v_cmp_eq_u32 vcc, -1, v4
    s_nop 0
    s_cbranch_vccz L_ok_56
    s_add_u32 s88, s88, 1
    s_cmp_lt_u32 s88, 65536
    s_cbranch_scc1 L_poll_55
L_ok_56:
    v_mov_b32 v152, v128
    v_mov_b32 v153, v129
    v_mov_b32 v154, v130
    v_mov_b32 v155, v131
    v_permlane32_swap_b32 v152, v153
    s_nop 0
    v_permlane32_swap_b32 v154, v155
    v_add_f32 v152, v152, v153
    v_add_f32 v154, v154, v155
    s_nop 1
    v_permlane16_swap_b32 v152, v154
    v_add_f32 v152, v152, v154
    s_nop 1
    v_add_f32_dpp v152, v152, v152 row_ror:8 row_mask:0xf bank_mask:0xf
    v_cvt_pk_bf16_f32 v152, v152, v152
    v_and_b32 v152, s90, v152
    v_mul_f32 v152, v152, v8
    v_cvt_pk_bf16_f32 v152, v152, v152
    v_and_b32 v152, s90, v152
    v_add_f32 v152, v152, v64
    v_cvt_pk_bf16_f32 v152, v152, v152
    v_and_b32 v152, s90, v152
    v_add_f32 v152, v152, v65
    v_cvt_pk_bf16_f32 v152, v152, v152
    s_mov_b32 exec_lo, 0x00ff00ff
    s_mov_b32 exec_hi, 0x00ff00ff
    buffer_store_short v152, v9, s[44:47], s80 offen sc1
    s_mov_b64 exec, -1
L_hfin:
    s_endpgm
L_event:
    s_cmp_eq_u32 s77, 3
    s_cbranch_scc0 L_ev1
    buffer_load_dwordx4 v[92:95], v90, s[40:43], 0 offen sc1
    s_mov_b64 exec, 3
    global_load_dword v27, v91, s[66:67]
    s_mov_b64 exec, -1
    s_branch L_evret
L_ev1:
    s_cmp_eq_u32 s77, 5
    s_cbranch_scc0 L_ev_57
    s_and_b32 s72, s84, 15
    s_mov_b32 m0, s70
    s_lshl_b32 s71, s72, 7
    buffer_load_dwordx4 v16, s[28:31], s71 offen offset:0 lds
    s_mul_i32 s72, s72, 393216
    s_lshr_b64 s[84:85], s[84:85], 4
    buffer_load_dwordx4 v17, s[28:31], s71 offen offset:1024 lds
    buffer_load_dwordx4 v18, s[28:31], s71 offen offset:2048 lds
    buffer_load_dwordx4 v19, s[28:31], s71 offen offset:3072 lds
    s_add_u32 m0, s70, 4096
    s_nop 0
    buffer_load_dwordx4 v20, s[32:35], s72 offen offset:0 lds
    buffer_load_dwordx4 v21, s[32:35], s72 offen offset:1024 lds
    buffer_load_dwordx4 v22, s[32:35], s72 offen offset:2048 lds
    buffer_load_dwordx4 v23, s[32:35], s72 offen offset:3072 lds
    s_add_u32 m0, s70, 8192
    s_nop 0
    buffer_load_dwordx4 v24, s[32:35], s72 offen offset:0 lds
    buffer_load_dwordx4 v25, s[32:35], s72 offen offset:1024 lds
    s_add_u32 s70, s70, 40960
    s_cmp_ge_u32 s70, 122880
    s_cselect_b32 s76, 122880, 0
    s_sub_u32 s70, s70, s76
    buffer_load_dwordx4 v[96:99], v76, s[48:51], s75 offen nt
    s_add_u32 s75, s75, 7168
    buffer_load_dwordx4 v[100:103], v76, s[48:51], s75 offen nt
    s_add_u32 s75, s75, 7168
    buffer_load_dwordx4 v[104:107], v76, s[48:51], s75 offen nt
    s_add_u32 s75, s75, 7168
    buffer_load_dwordx4 v[108:111], v76, s[48:51], s75 offen nt
    s_add_u32 s75, s75, 7168
    buffer_load_dwordx4 v[128:131], v76, s[48:51], s75 offen nt
    s_add_u32 s75, s75, 7168
    buffer_load_dwordx4 v[132:135], v76, s[48:51], s75 offen nt
    s_add_u32 s75, s75, 7168
    buffer_load_dwordx4 v[136:139], v76, s[48:51], s75 offen nt
    s_add_u32 s75, s75, 7168
    buffer_load_dwordx4 v[140:143], v76, s[48:51], s75 offen nt
    s_add_u32 s75, s75, 7168
    s_waitcnt vmcnt(18)
    s_branch L_hbar
L_ev_57:
    s_cmp_eq_u32 s77, 6
    s_cbranch_scc0 L_ev_58
    s_and_b32 s72, s84, 15
    s_mov_b32 m0, s70
    s_lshl_b32 s71, s72, 7
    buffer_load_dwordx4 v16, s[28:31], s71 offen offset:0 lds
    s_mul_i32 s72, s72, 393216
    s_lshr_b64 s[84:85], s[84:85], 4
    buffer_load_dwordx4 v17, s[28:31], s71 offen offset:1024 lds
    buffer_load_dwordx4 v18, s[28:31], s71 offen offset:2048 lds
    buffer_load_dwordx4 v19, s[28:31], s71 offen offset:3072 lds
    s_add_u32 m0, s70, 4096
    s_nop 0
    buffer_load_dwordx4 v20, s[32:35], s72 offen offset:0 lds
    buffer_load_dwordx4 v21, s[32:35], s72 offen offset:1024 lds
    buffer_load_dwordx4 v22, s[32:35], s72 offen offset:2048 lds
    buffer_load_dwordx4 v23, s[32:35], s72 offen offset:3072 lds
    s_add_u32 m0, s70, 8192
    s_nop 0
    buffer_load_dwordx4 v24, s[32:35], s72 offen offset:0 lds
    buffer_load_dwordx4 v25, s[32:35], s72 offen offset:1024 lds
    s_add_u32 s70, s70, 40960
    s_cmp_ge_u32 s70, 122880
    s_cselect_b32 s76, 122880, 0
    s_sub_u32 s70, s70, s76
    s_lshl_b32 s78, s62, 9
    v_lshl_add_u32 v11, v1, 7, s78
    s_mov_b64 exec, 15
    global_load_dword v27, v11, s[14:15]
    s_mov_b64 exec, -1
    buffer_load_dwordx4 v[112:115], v76, s[48:51], s75 offen nt
    s_add_u32 s75, s75, 7168
    buffer_load_dwordx4 v[116:119], v76, s[48:51], s75 offen nt
    s_add_u32 s75, s75, 7168
    buffer_load_dwordx4 v[120:123], v76, s[48:51], s75 offen nt
    s_add_u32 s75, s75, 7168
    buffer_load_dwordx4 v[124:127], v76, s[48:51], s75 offen nt
    s_add_u32 s75, s75, 7168
    buffer_load_dwordx4 v[144:147], v76, s[48:51], s75 offen nt
    s_add_u32 s75, s75, 7168
    buffer_load_dwordx4 v[148:151], v76, s[48:51], s75 offen nt
    s_add_u32 s75, s75, 7168
    buffer_load_dwordx4 v[152:155], v76, s[48:51], s75 offen nt
    s_add_u32 s75, s75, 7168
    buffer_load_dwordx4 v[156:159], v76, s[48:51], s75 offen nt
    s_add_u32 s75, s75, 7168
    s_waitcnt vmcnt(19)
    s_branch L_hbar
L_ev_58:
    s_add_u32 s78, s70, 40960
    s_cmp_ge_u32 s78, 122880
    s_cselect_b32 s76, 122880, 0
    s_sub_u32 s78, s78, s76
    s_cmp_eq_u32 s77, 2
    s_cbranch_scc1 L_evw
    v_add_u32 v4, s78, v72
    v_xor_b32 v5, 32, v4
    v_xor_b32 v6, 64, v4
    v_xor_b32 v7, 96, v4
    s_and_b32 s72, s84, 15
    s_mov_b32 m0, s70
    s_lshl_b32 s71, s72, 7
    buffer_load_dwordx4 v16, s[28:31], s71 offen offset:0 lds
    s_mul_i32 s72, s72, 393216
    s_lshr_b64 s[84:85], s[84:85], 4
    ds_read_b128 v[32:35], v4
    ds_read_b128 v[36:39], v5
    ds_read_b128 v[40:43], v6
    ds_read_b128 v[44:47], v7
    buffer_load_dwordx4 v17, s[28:31], s71 offen offset:1024 lds
    s_lshl_b32 s79, s62, 8
    s_add_u32 s79, s79, s73
    s_waitcnt lgkmcnt(0)
    v_lshlrev_b32 v8, 16, v32
    v_and_b32 v9, s90, v32
    v_add_f32 v80, v80, v8
    v_add_f32 v82, v82, v9
    v_fmac_f32 v81, v8, v8
    v_fmac_f32 v83, v9, v9
    v_lshlrev_b32 v10, 16, v33
    v_and_b32 v11, s90, v33
    v_add_f32 v80, v80, v10
    v_add_f32 v82, v82, v11
    v_fmac_f32 v81, v10, v10
    v_fmac_f32_e64 v83, v11, v11
    buffer_load_dwordx4 v18, s[28:31], s71 offen offset:2048 lds
    v_lshlrev_b32 v8, 16, v34
    v_and_b32 v9, s90, v34
    v_add_f32 v80, v80, v8
    v_add_f32 v82, v82, v9
    v_fmac_f32 v81, v8, v8
    v_fmac_f32 v83, v9, v9
    v_lshlrev_b32 v10, 16, v35
    v_and_b32 v11, s90, v35
    v_add_f32 v80, v80, v10
    v_add_f32 v82, v82, v11
    v_fmac_f32 v81, v10, v10
    v_fmac_f32 v83, v11, v11
    buffer_load_dwordx4 v19, s[28:31], s71 offen offset:3072 lds
    v_lshlrev_b32 v8, 16, v36
    v_and_b32 v9, s90, v36
    v_add_f32 v80, v80, v8
    v_add_f32 v82, v82, v9
    v_fmac_f32 v81, v8, v8
    v_fmac_f32 v83, v9, v9
    v_lshlrev_b32 v10, 16, v37
    v_and_b32 v11, s90, v37
    v_add_f32 v80, v80, v10
    v_add_f32 v82, v82, v11
    v_fmac_f32 v81, v10, v10
    v_fmac_f32 v83, v11, v11
    s_add_u32 m0, s70, 4096
    s_nop 0
    buffer_load_dwordx4 v20, s[32:35], s72 offen offset:0 lds
    v_lshlrev_b32 v8, 16, v38
    v_and_b32 v9, s90, v38
    v_add_f32 v80, v80, v8
    v_add_f32 v82, v82, v9
    v_fmac_f32 v81, v8, v8
    v_fmac_f32 v83, v9, v9
    v_lshlrev_b32 v10, 16, v39
    v_and_b32 v11, s90, v39
    v_add_f32 v80, v80, v10
    v_add_f32 v82, v82, v11
    v_fmac_f32 v81, v10, v10
    v_fmac_f32_e64 v83, v11, v11
    buffer_load_dwordx4 v21, s[32:35], s72 offen offset:1024 lds
    v_lshlrev_b32 v8, 16, v40
    v_and_b32 v9, s90, v40
    v_add_f32 v80, v80, v8
    v_add_f32 v82, v82, v9
    v_fmac_f32 v81, v8, v8
    v_fmac_f32 v83, v9, v9
    v_lshlrev_b32 v10, 16, v41
    v_and_b32 v11, s90, v41
    v_add_f32 v80, v80, v10
    v_add_f32 v82, v82, v11
    v_fmac_f32 v81, v10, v10
    v_fmac_f32 v83, v11, v11
    buffer_load_dwordx4 v22, s[32:35], s72 offen offset:2048 lds
    v_lshlrev_b32 v8, 16, v42
    v_and_b32 v9, s90, v42
    v_add_f32 v80, v80, v8
    v_add_f32 v82, v82, v9
    v_fmac_f32 v81, v8, v8
    v_fmac_f32 v83, v9, v9
    v_lshlrev_b32 v10, 16, v43
    v_and_b32 v11, s90, v43
    v_add_f32 v80, v80, v10
    v_add_f32 v82, v82, v11
    v_fmac_f32 v81, v10, v10
    v_fmac_f32 v83, v11, v11
    buffer_load_dwordx4 v23, s[32:35], s72 offen offset:3072 lds
    v_lshlrev_b32 v8, 16, v44
    v_and_b32 v9, s90, v44
    v_add_f32 v80, v80, v8
    v_add_f32 v82, v82, v9
    v_fmac_f32 v81, v8, v8
    v_fmac_f32 v83, v9, v9
    v_lshlrev_b32 v10, 16, v45
    v_and_b32 v11, s90, v45
    v_add_f32 v80, v80, v10
    v_add_f32 v82, v82, v11
    v_fmac_f32 v81, v10, v10
    v_fmac_f32 v83, v11, v11
    s_add_u32 m0, s70, 8192
    s_nop 0
    buffer_load_dwordx4 v24, s[32:35], s72 offen offset:0 lds
    v_lshlrev_b32 v8, 16, v46
    v_and_b32 v9, s90, v46
    v_add_f32 v80, v80, v8
    v_add_f32 v82, v82, v9
    v_fmac_f32 v81, v8, v8
    v_fmac_f32 v83, v9, v9
    v_lshlrev_b32 v10, 16, v47
    v_and_b32 v11, s90, v47
    v_add_f32 v80, v80, v10
    v_add_f32 v82, v82, v11
    v_fmac_f32 v81, v10, v10
    v_fmac_f32_e64 v83, v11, v11
    buffer_load_dwordx4 v25, s[32:35], s72 offen offset:1024 lds
    s_add_u32 s70, s70, 40960
    s_cmp_ge_u32 s70, 122880
    s_cselect_b32 s76, 122880, 0
    s_sub_u32 s70, s70, s76
    s_xor_b32 s69, s69, 1
    s_cbranch_scc1 L_hw10
    v_add_f32 v80, v80, v82
    v_add_f32 v81, v81, v83
    v_mov_b32 v82, v80
    v_mov_b32 v83, v81
    s_nop 0
    v_permlane32_swap_b32 v80, v82
    v_permlane32_swap_b32 v81, v83
    v_add_f32 v80, v80, v82
    v_add_f32_e64 v81, v81, v83
    s_mov_b32 exec_hi, 0
    buffer_store_dwordx2 v[80:81], v74, s[40:43], s79 offen offset:0 sc1
    s_mov_b64 exec, -1
    s_waitcnt vmcnt(11)
    s_branch L_hbar
L_evw:
    s_mul_i32 s79, s63, 2048
    s_add_u32 s79, s79, s78
    v_add_u32_e64 v4, s79, v73
    s_mul_i32 s79, s63, 20480
    s_add_u32 s79, s79, s78
    v_add_u32_e64 v5, s79, v73
    s_and_b32 s72, s84, 15
    s_mov_b32 m0, s70
    s_lshl_b32 s71, s72, 7
    buffer_load_dwordx4 v16, s[28:31], s71 offen offset:0 lds
    s_mul_i32 s72, s72, 393216
    s_lshr_b64 s[84:85], s[84:85], 4
    ds_read_b64_tr_b16 v[32:33], v4 offset:0
    ds_read_b64_tr_b16 v[34:35], v4 offset:512
    ds_read_b64_tr_b16 v[36:37], v4 offset:10240
    ds_read_b64_tr_b16 v[38:39], v4 offset:10752
    ds_read_b64_tr_b16 v[40:41], v4 offset:20480
    ds_read_b64_tr_b16 v[42:43], v4 offset:20992
    ds_read_b64_tr_b16 v[44:45], v4 offset:30720
    ds_read_b64_tr_b16 v[46:47], v4 offset:31232
    ds_read_b64_tr_b16 v[48:49], v5 offset:4096
    ds_read_b64_tr_b16 v[50:51], v5 offset:4608
    ds_read_b64_tr_b16 v[52:53], v5 offset:14336
    ds_read_b64_tr_b16 v[54:55], v5 offset:14848
    buffer_load_dwordx4 v17, s[28:31], s71 offen offset:1024 lds
    s_lshl_b32 s79, s64, 9
    s_lshl_b32 s80, s63, 3
    s_add_u32 s79, s79, s80
    s_add_u32 s79, s79, s73
    s_waitcnt lgkmcnt(0)
    v_lshlrev_b32 v8, 16, v32
    v_and_b32 v9, s90, v32
    v_add_f32 v80, v80, v8
    v_add_f32 v82, v82, v9
    v_lshlrev_b32 v10, 16, v33
    v_and_b32 v11, s90, v33
    v_add_f32 v80, v80, v10
    v_add_f32 v82, v82, v11
    v_lshlrev_b32 v8, 16, v34
    v_and_b32 v9, s90, v34
    v_add_f32 v80, v80, v8
    v_add_f32 v82, v82, v9
    buffer_load_dwordx4 v18, s[28:31], s71 offen offset:2048 lds
    v_lshlrev_b32 v10, 16, v35
    v_and_b32 v11, s90, v35
    v_add_f32 v80, v80, v10
    v_add_f32 v82, v82, v11
    v_lshlrev_b32 v8, 16, v36
    v_and_b32 v9, s90, v36
    v_add_f32 v80, v80, v8
    v_add_f32 v82, v82, v9
    v_lshlrev_b32 v10, 16, v37
    v_and_b32 v11, s90, v37
    v_add_f32 v80, v80, v10
    v_add_f32 v82, v82, v11
    buffer_load_dwordx4 v19, s[28:31], s71 offen offset:3072 lds
    v_lshlrev_b32 v8, 16, v38
    v_and_b32 v9, s90, v38
    v_add_f32 v80, v80, v8
    v_add_f32 v82, v82, v9
    v_lshlrev_b32 v10, 16, v39
    v_and_b32 v11, s90, v39
    v_add_f32 v80, v80, v10
    v_add_f32 v82, v82, v11
    v_lshlrev_b32 v8, 16, v40
    v_and_b32 v9, s90, v40
    v_add_f32 v80, v80, v8
    v_add_f32 v82, v82, v9
    s_add_u32 m0, s70, 4096
    s_nop 0
    buffer_load_dwordx4 v20, s[32:35], s72 offen offset:0 lds
    v_lshlrev_b32 v10, 16, v41
    v_and_b32 v11, s90, v41
    v_add_f32 v80, v80, v10
    v_add_f32 v82, v82, v11
    v_lshlrev_b32 v8, 16, v42
    v_and_b32 v9, s90, v42
    v_add_f32 v80, v80, v8
    v_add_f32 v82, v82, v9
    v_lshlrev_b32 v10, 16, v43
    v_and_b32 v11, s90, v43
    v_add_f32 v80, v80, v10
    v_add_f32_e64 v82, v82, v11
    buffer_load_dwordx4 v21, s[32:35], s72 offen offset:1024 lds
    v_lshlrev_b32 v8, 16, v44
    v_and_b32 v9, s90, v44
    v_add_f32 v80, v80, v8
    v_add_f32 v82, v82, v9
    v_lshlrev_b32 v10, 16, v45
    v_and_b32 v11, s90, v45
    v_add_f32 v80, v80, v10
    v_add_f32 v82, v82, v11
    v_lshlrev_b32 v8, 16, v46
    v_and_b32 v9, s90, v46
    v_add_f32 v80, v80, v8
    v_add_f32 v82, v82, v9
    buffer_load_dwordx4 v22, s[32:35], s72 offen offset:2048 lds
    v_lshlrev_b32 v10, 16, v47
    v_and_b32 v11, s90, v47
    v_add_f32 v80, v80, v10
    v_add_f32 v82, v82, v11
    v_lshlrev_b32 v8, 16, v48
    v_and_b32 v9, s90, v48
    v_add_f32 v81, v81, v8
    v_add_f32 v83, v83, v9
    v_lshlrev_b32 v10, 16, v49
    v_and_b32 v11, s90, v49
    v_add_f32 v81, v81, v10
    v_add_f32 v83, v83, v11
    buffer_load_dwordx4 v23, s[32:35], s72 offen offset:3072 lds
    v_lshlrev_b32 v8, 16, v50
    v_and_b32 v9, s90, v50
    v_add_f32 v81, v81, v8
    v_add_f32 v83, v83, v9
    v_lshlrev_b32 v10, 16, v51
    v_and_b32 v11, s90, v51
    v_add_f32 v81, v81, v10
    v_add_f32 v83, v83, v11
    v_lshlrev_b32 v8, 16, v52
    v_and_b32 v9, s90, v52
    v_add_f32 v81, v81, v8
    v_add_f32 v83, v83, v9
    s_add_u32 m0, s70, 8192
    s_nop 0
    buffer_load_dwordx4 v24, s[32:35], s72 offen offset:0 lds
    v_lshlrev_b32 v10, 16, v53
    v_and_b32 v11, s90, v53
    v_add_f32 v81, v81, v10
    v_add_f32 v83, v83, v11
    v_lshlrev_b32 v8, 16, v54
    v_and_b32 v9, s90, v54
    v_add_f32 v81, v81, v8
    v_add_f32 v83, v83, v9
    v_lshlrev_b32 v10, 16, v55
    v_and_b32 v11, s90, v55
    v_add_f32 v81, v81, v10
    v_add_f32_e64 v83, v83, v11
    buffer_load_dwordx4 v25, s[32:35], s72 offen offset:1024 lds
    s_add_u32 s70, s70, 40960
    s_cmp_ge_u32 s70, 122880
    s_cselect_b32 s76, 122880, 0
    s_sub_u32 s70, s70, s76
    s_xor_b32 s69, s69, 1
    s_cbranch_scc1 L_hw10
    v_add_f32 v80, v80, v82
    v_add_f32 v81, v81, v83
    v_mov_b32 v82, v80
    v_mov_b32 v83, v81
    s_nop 0
    v_permlane32_swap_b32 v80, v82
    v_permlane32_swap_b32 v81, v83
    v_add_f32 v80, v80, v82
    v_add_f32_e64 v81, v81, v83
    s_mov_b32 exec_hi, 0
    buffer_store_dwordx2 v[80:81], v12, s[40:43], s79 offen offset:1024 sc1
    s_mov_b64 exec, -1
    s_waitcnt vmcnt(11)
    s_branch L_hbar
L_compute:
    s_load_dwordx4 s[8:11], s[0:1], 16
    s_load_dwordx16 s[12:27], s[0:1], 32
    s_and_b32 s62, s62, 3
    s_and_b32 s76, s2, 7
    s_lshl_b32 s76, s76, 3
    s_lshr_b32 s77, s2, 7
    s_lshl2_add_u32 s76, s77, s76
    s_mov_b32 s80, 0x654210b3
    s_mov_b32 s81, 0xfedca987
    s_lshr_b64 s[80:81], s[80:81], s76
    s_and_b32 s61, s80, 15
    s_setprio 2
    s_and_b32 s63, s62, 1
    s_lshr_b32 s64, s62, 1
    s_lshl_b32 s73, s60, 4
    s_add_u32 s73, s73, s61
    s_mul_i32 s73, s73, 28800
    s_add_u32 s76, s2, 7
    s_and_b32 s76, s76, 7
    s_bfe_u32 s77, s2, 0x10003
    s_lshl1_add_u32 s97, s76, s77
    s_lshr_b32 s98, s2, 4
    s_lshl_b32 s99, s97, 4
    s_add_u32 s99, s99, s98
    s_mul_i32 s99, s99, 9344
    s_add_u32 s99, s99, 8388608
    s_lshr_b32 s65, s97, 1
    s_lshl_b32 s76, s97, 3
    s_add_u32 s65, s65, s76
    s_mul_i32 s76, s98, 4
    s_add_u32 s65, s65, s76
    s_and_b32 s65, s65, 15
    s_mov_b32 s89, 0x3f803f80
    s_mov_b32 s90, 0xffff0000
    v_and_b32 v2, 31, v1
    v_lshrrev_b32 v3, 5, v1
    v_lshlrev_b32 v12, 4, v1
    v_lshrrev_b32_e64 v4, 3, v1
    v_mul_u32_u24 v13, 460800, v4
    v_and_b32_e64 v4, 7, v1
    v_lshl_add_u32 v13, v4, 4, v13
    v_and_b32 v10, 15, v1
    v_lshrrev_b32 v11, 4, v1
    s_mul_i32 s76, s63, 20480
    v_lshrrev_b32 v4, 1, v10
    v_xor_b32 v4, v4, v11
    v_lshlrev_b32_e64 v4, 4, v4
    v_lshl_add_u32 v4, v10, 7, v4
    v_add_u32 v192, s76, v4
    v_xor_b32 v193, 64, v192
    v_bfe_u32 v4, v1, 2, 2
    v_and_b32_e64 v6, 1, v11
    v_lshl_add_u32 v5, v6, 3, v4
    v_lshlrev_b32 v5, 7, v5
    v_lshrrev_b32 v4, 1, v4
    v_xor_b32_e64 v4, s64, v4
    v_lshl_add_u32 v5, v4, 6, v5
    v_lshl_add_u32 v5, v6, 5, v5
    v_and_b32_e64 v4, 3, v1
    v_lshl_add_u32 v5, v4, 3, v5
    v_mul_u32_u24 v4, 10240, v3
    v_add_u32_e64 v5, v5, v4
    v_add_u32 v194, 4096, v5
    v_xor_b32_e64 v195, 32, v194
    v_add_u32 v196, 40960, v192
    v_add_u32 v197, 40960, v193
    v_add_u32 v198, 40960, v194
    v_add_u32 v199, 40960, v195
    v_add_u32 v200, 81920, v192
    v_add_u32 v201, 81920, v193
    v_add_u32 v202, 81920, v194
    v_add_u32 v203, 81920, v195
    v_bfe_u32 v4, v1, 2, 2
    v_lshl_add_u32 v4, v3, 3, v4
    v_lshlrev_b32 v4, 6, v4
    v_and_b32 v5, 1, v11
    v_lshl_add_u32 v4, v5, 5, v4
    v_and_b32_e64 v5, 3, v1
    v_lshl_add_u32 v4, v5, 3, v4
    s_lshl_b32 s76, s64, 11
    s_add_u32 s76, s76, 122880
    v_add_u32_e64 v212, s76, v4
    s_lshl_b32 s76, s63, 9
    v_lshl_add_u32 v213, v10, 3, s76
    v_lshl_add_u32 v214, v2, 3, s76
    s_lshl_b32 s76, s64, 8
    v_lshl_add_u32 v215, v10, 3, s76
    v_bfe_u32 v4, v10, 1, 1
    v_xor_b32 v4, s64, v4
    v_lshrrev_b32 v5, 2, v10
    v_xor_b32 v5, v5, v3
    v_xor_b32 v6, v10, v11
    v_and_b32 v6, 1, v6
    v_lshlrev_b32_e64 v4, 6, v4
    v_lshl_add_u32 v4, v5, 4, v4
    v_lshl_add_u32 v4, v6, 3, v4
    v_lshl_add_u32 v4, v10, 7, v4
    s_lshl_b32 s76, s63, 13
    v_add_u32 v216, s76, v4
    v_bfe_u32 v4, v2, 1, 1
    v_bfe_u32 v5, v2, 2, 2
    v_and_b32 v6, 1, v2
    v_xor_b32 v6, v6, v3
    v_lshlrev_b32_e64 v4, 6, v4
    v_lshl_add_u32 v4, v5, 4, v4
    v_lshl_add_u32 v4, v6, 3, v4
    v_lshl_add_u32 v4, v2, 7, v4
    s_lshl_b32 s77, s64, 14
    s_add_u32 s76, s76, s77
    v_add_u32_e64 v217, s76, v4
    v_bfe_u32 v4, v1, 2, 2
    v_lshl_add_u32 v5, v3, 3, v4
    v_lshlrev_b32 v5, 7, v5
    v_lshrrev_b32 v6, 1, v4
    v_lshl_add_u32 v5, v6, 6, v5
    v_bfe_u32 v6, v1, 4, 1
    v_xor_b32_e64 v6, v6, v3
    v_lshl_add_u32 v5, v6, 5, v5
    v_bfe_u32 v6, v1, 1, 1
    v_lshl_add_u32 v5, v6, 4, v5
    v_xor_b32 v6, v1, v4
    v_and_b32 v6, 1, v6
    v_lshl_add_u32 v5, v6, 3, v5
    s_lshl_b32 s76, s63, 13
    v_xor_b32 v5, s76, v5
    s_lshl_b32 s76, s63, 6
    s_or_b32 s76, s76, s77
    v_xor_b32 v218, s76, v5
    s_lshl_b32 s76, s64, 6
    v_xor_b32_e64 v220, s76, v5
    v_xor_b32 v219, 528, v218
    v_xor_b32 v221, 528, v220
    v_cmp_gt_u32 s[86:87], 16, v1
    s_waitcnt lgkmcnt(0)
    s_mov_b32 s40, s26
    s_and_b32 s41, s27, 0xffff
    s_mov_b32 s42, 33554432
    s_mov_b32 s43, 0x20000
    s_mov_b32 s44, s22
    s_and_b32 s45, s23, 0xffff
    s_mov_b32 s46, 4194304
    s_mov_b32 s47, 0x20000
    s_mov_b32 s68, 0
    s_getreg_b32 s101, hwreg(HW_REG_XCC_ID, 0, 4)
    v_mov_b32 v9, 13631488
    s_lshl_b32 s76, s61, 8
    s_lshl4_add_u32 s76, s60, s76
    s_add_u32 s76, s76, 12582912
    v_mov_b32 v8, s76
    s_lshl_b32 s76, s60, 8
    s_lshl4_add_u32 s76, s61, s76
    s_add_u32 s76, s76, 12587008
    v_writelane_b32 v8, s76, 1
    s_lshl_b32 s76, s97, 8
    s_lshl4_add_u32 s76, s98, s76
    s_add_u32 s76, s76, 12591104
    v_writelane_b32 v8, s76, 2
    v_mov_b32 v6, s101
    v_mov_b32 v7, 0
    v_mov_b32_e64 v10, 0
    s_cmp_eq_u32 s62, 0
    s_cbranch_scc0 L_noep
    buffer_load_dwordx2 v[4:5], v9, s[40:43], 0 offen
L_noep:
    s_barrier
    ds_read_b128 v[112:115], v192 offset:0
    ds_read_b64_tr_b16 v[128:129], v194 offset:0
    ds_read_b64_tr_b16 v[130:131], v194 offset:512
    ds_read_b128 v[116:119], v192 offset:2048
    ds_read_b128 v[120:123], v192 offset:10240
    ds_read_b128 v[124:127], v192 offset:12288
    ds_read_b64_tr_b16 v[132:133], v195 offset:0
    ds_read_b64_tr_b16 v[134:135], v195 offset:512
    ds_read_b64_tr_b16 v[136:137], v194 offset:2048
    ds_read_b64_tr_b16 v[138:139], v194 offset:2560
    ds_read_b64_tr_b16 v[140:141], v195 offset:2048
    ds_read_b64_tr_b16 v[142:143], v195 offset:2560
    ds_read_b64_tr_b16 v[144:145], v194 offset:4096
    ds_read_b64_tr_b16 v[146:147], v194 offset:4608
    s_waitcnt lgkmcnt(8)
    ds_read_b64_tr_b16 v[148:149], v195 offset:4096
    ds_read_b64_tr_b16 v[150:151], v195 offset:4608
    v_mfma_f32_16x16x32_bf16 v[16:19], v[128:131], v[112:115], 0
    ds_read_b128 v[152:155], v193 offset:0
    v_mfma_f32_16x16x32_bf16 v[20:23], v[128:131], v[116:119], 0
    ds_read_b64_tr_b16 v[168:169], v194 offset:20480
    v_mfma_f32_16x16x32_bf16 v[24:27], v[128:131], v[120:123], 0
    ds_read_b64_tr_b16 v[170:171], v194 offset:20992
    v_mfma_f32_16x16x32_bf16 v[28:31], v[128:131], v[124:127], 0
    ds_read_b128 v[156:159], v193 offset:2048
    s_waitcnt lgkmcnt(4)
    v_mfma_f32_16x16x32_bf16 v[44:47], v[132:135], v[124:127], 0
    ds_read_b128 v[160:163], v193 offset:10240
    v_mfma_f32_16x16x32_bf16 v[40:43], v[132:135], v[120:123], 0
    ds_read_b128 v[164:167], v193 offset:12288
    v_mfma_f32_16x16x32_bf16 v[36:39], v[132:135], v[116:119], 0
    ds_read_b64_tr_b16 v[172:173], v195 offset:20480
    v_mfma_f32_16x16x32_bf16 v[32:35], v[132:135], v[112:115], 0
    ds_read_b64_tr_b16 v[174:175], v195 offset:20992
    v_mfma_f32_16x16x32_bf16 v[48:51], v[136:139], v[112:115], 0
    ds_read_b64_tr_b16 v[176:177], v194 offset:22528
    v_mfma_f32_16x16x32_bf16 v[52:55], v[136:139], v[116:119], 0
    ds_read_b64_tr_b16 v[178:179], v194 offset:23040
    v_mfma_f32_16x16x32_bf16 v[56:59], v[136:139], v[120:123], 0
    ds_read_b64_tr_b16 v[180:181], v195 offset:22528
    v_mfma_f32_16x16x32_bf16 v[60:63], v[136:139], v[124:127], 0
    ds_read_b64_tr_b16 v[182:183], v195 offset:23040
    v_mfma_f32_16x16x32_bf16 v[76:79], v[140:143], v[124:127], 0
    ds_read_b64_tr_b16 v[184:185], v194 offset:24576
    v_mfma_f32_16x16x32_bf16 v[72:75], v[140:143], v[120:123], 0
    ds_read_b64_tr_b16 v[186:187], v194 offset:25088
    v_mfma_f32_16x16x32_bf16 v[68:71], v[140:143], v[116:119], 0
    ds_read_b64_tr_b16 v[188:189], v195 offset:24576
    v_mfma_f32_16x16x32_bf16 v[64:67], v[140:143], v[112:115], 0
    ds_read_b64_tr_b16 v[190:191], v195 offset:25088
    v_mfma_f32_16x16x32_bf16 v[80:83], v[144:147], v[112:115], 0
    v_mfma_f32_16x16x32_bf16 v[84:87], v[144:147], v[116:119], 0
    v_mfma_f32_16x16x32_bf16 v[88:91], v[144:147], v[120:123], 0
    v_mfma_f32_16x16x32_bf16 v[92:95], v[144:147], v[124:127], 0
    v_mfma_f32_16x16x32_bf16 v[108:111], v[148:151], v[124:127], 0
    v_mfma_f32_16x16x32_bf16 v[104:107], v[148:151], v[120:123], 0
    v_mfma_f32_16x16x32_bf16 v[100:103], v[148:151], v[116:119], 0
    v_mfma_f32_16x16x32_bf16 v[96:99], v[148:151], v[112:115], 0
    s_waitcnt lgkmcnt(0)
    v_mfma_f32_16x16x32_bf16 v[16:19], v[168:171], v[152:155], v[16:19]
    s_barrier
    v_mfma_f32_16x16x32_bf16 v[20:23], v[168:171], v[156:159], v[20:23]
    ds_read_b128 v[112:115], v196 offset:0
    ds_read_b64_tr_b16 v[204:205], v212 offset:0
    ds_read_b64_tr_b16 v[206:207], v212 offset:256
    ds_read_b64_tr_b16 v[208:209], v212 offset:1024
    ds_read_b64_tr_b16 v[210:211], v212 offset:1280
    v_mfma_f32_16x16x32_bf16 v[24:27], v[168:171], v[160:163], v[24:27]
    ds_read_b64_tr_b16 v[128:129], v198 offset:0
    s_cmp_eq_u32 s62, 0
    s_cbranch_scc0 L_cloop
    s_waitcnt vmcnt(0)
    v_add_co_u32 v4, vcc, 1, v4
    s_nop 1
    v_addc_co_u32 v5, vcc, 0, v5, vcc
    s_mov_b64 exec, 7
    buffer_store_dwordx4 v[4:7], v8, s[40:43], 0 offen sc1
    s_mov_b64 exec, -1
.p2align 3
L_cloop:
    v_mfma_f32_16x16x32_bf16 v[28:31], v[168:171], v[164:167], v[28:31]
    ds_read_b64_tr_b16 v[130:131], v198 offset:512
    v_mfma_f32_16x16x32_bf16 v[44:47], v[172:175], v[164:167], v[44:47]
    ds_read_b128 v[116:119], v196 offset:2048
    v_mfma_f32_16x16x32_bf16 v[40:43], v[172:175], v[160:163], v[40:43]
    ds_read_b128 v[120:123], v196 offset:10240
    v_mfma_f32_16x16x32_bf16 v[36:39], v[172:175], v[156:159], v[36:39]
    ds_read_b128 v[124:127], v196 offset:12288
    v_mfma_f32_16x16x32_bf16 v[32:35], v[172:175], v[152:155], v[32:35]
    ds_read_b64_tr_b16 v[132:133], v199 offset:0
    v_mfma_f32_16x16x32_bf16 v[48:51], v[176:179], v[152:155], v[48:51]
    ds_read_b64_tr_b16 v[134:135], v199 offset:512
    v_mfma_f32_16x16x32_bf16 v[52:55], v[176:179], v[156:159], v[52:55]
    ds_read_b64_tr_b16 v[136:137], v198 offset:2048
    v_mfma_f32_16x16x32_bf16 v[56:59], v[176:179], v[160:163], v[56:59]
    ds_read_b64_tr_b16 v[138:139], v198 offset:2560
    v_mfma_f32_16x16x32_bf16 v[60:63], v[176:179], v[164:167], v[60:63]
    ds_read_b64_tr_b16 v[140:141], v199 offset:2048
    v_mfma_f32_16x16x32_bf16 v[76:79], v[180:183], v[164:167], v[76:79]
    ds_read_b64_tr_b16 v[142:143], v199 offset:2560
    v_mfma_f32_16x16x32_bf16 v[72:75], v[180:183], v[160:163], v[72:75]
    ds_read_b64_tr_b16 v[144:145], v198 offset:4096
    v_mfma_f32_16x16x32_bf16 v[68:71], v[180:183], v[156:159], v[68:71]
    ds_read_b64_tr_b16 v[146:147], v198 offset:4608
    v_mfma_f32_16x16x32_bf16 v[64:67], v[180:183], v[152:155], v[64:67]
    ds_read_b64_tr_b16 v[148:149], v199 offset:4096
    v_mfma_f32_16x16x32_bf16 v[80:83], v[184:187], v[152:155], v[80:83]
    ds_read_b64_tr_b16 v[150:151], v199 offset:4608
    v_mfma_f32_16x16x32_bf16 v[84:87], v[184:187], v[156:159], v[84:87]
    v_mfma_f32_16x16x32_bf16 v[88:91], v[184:187], v[160:163], v[88:91]
    v_mfma_f32_16x16x32_bf16 v[92:95], v[184:187], v[164:167], v[92:95]
    v_mfma_f32_16x16x32_bf16 v[108:111], v[188:191], v[164:167], v[108:111]
    v_mfma_f32_16x16x32_bf16 v[104:107], v[188:191], v[160:163], v[104:107]
    v_mfma_f32_16x16x32_bf16 v[100:103], v[188:191], v[156:159], v[100:103]
    v_mfma_f32_16x16x32_bf16 v[96:99], v[188:191], v[152:155], v[96:99]
    s_waitcnt lgkmcnt(0)
    v_mfma_f32_16x16x32_bf16 v[16:19], v[128:131], v[112:115], v[16:19]
    ds_read_b128 v[152:155], v197 offset:0
    v_mfma_f32_16x16x32_bf16 v[20:23], v[128:131], v[116:119], v[20:23]
    ds_read_b64_tr_b16 v[168:169], v198 offset:20480
    v_mfma_f32_16x16x32_bf16 v[24:27], v[128:131], v[120:123], v[24:27]
    ds_read_b64_tr_b16 v[170:171], v198 offset:20992
    v_mfma_f32_16x16x32_bf16 v[28:31], v[128:131], v[124:127], v[28:31]
    ds_read_b128 v[156:159], v197 offset:2048
    v_mfma_f32_16x16x32_bf16 v[44:47], v[132:135], v[124:127], v[44:47]
    ds_read_b128 v[160:163], v197 offset:10240
    v_mfma_f32_16x16x32_bf16 v[40:43], v[132:135], v[120:123], v[40:43]
    ds_read_b128 v[164:167], v197 offset:12288
    v_mfma_f32_16x16x32_bf16 v[36:39], v[132:135], v[116:119], v[36:39]
    ds_read_b64_tr_b16 v[172:173], v199 offset:20480
    v_mfma_f32_16x16x32_bf16 v[32:35], v[132:135], v[112:115], v[32:35]
    ds_read_b64_tr_b16 v[174:175], v199 offset:20992
    v_mfma_f32_16x16x32_bf16 v[48:51], v[136:139], v[112:115], v[48:51]
    ds_read_b64_tr_b16 v[176:177], v198 offset:22528
    v_mfma_f32_16x16x32_bf16 v[52:55], v[136:139], v[116:119], v[52:55]
    ds_read_b64_tr_b16 v[178:179], v198 offset:23040
    v_mfma_f32_16x16x32_bf16 v[56:59], v[136:139], v[120:123], v[56:59]
    ds_read_b64_tr_b16 v[180:181], v199 offset:22528
    v_mfma_f32_16x16x32_bf16 v[60:63], v[136:139], v[124:127], v[60:63]
    ds_read_b64_tr_b16 v[182:183], v199 offset:23040
    v_mfma_f32_16x16x32_bf16 v[76:79], v[140:143], v[124:127], v[76:79]
    ds_read_b64_tr_b16 v[184:185], v198 offset:24576
    v_mfma_f32_16x16x32_bf16 v[72:75], v[140:143], v[120:123], v[72:75]
    ds_read_b64_tr_b16 v[186:187], v198 offset:25088
    v_mfma_f32_16x16x32_bf16 v[68:71], v[140:143], v[116:119], v[68:71]
    ds_read_b64_tr_b16 v[188:189], v199 offset:24576
    v_mfma_f32_16x16x32_bf16 v[64:67], v[140:143], v[112:115], v[64:67]
    ds_read_b64_tr_b16 v[190:191], v199 offset:25088
    v_mfma_f32_16x16x32_bf16 v[80:83], v[144:147], v[112:115], v[80:83]
    v_mfma_f32_16x16x32_bf16 v[84:87], v[144:147], v[116:119], v[84:87]
    v_mfma_f32_16x16x32_bf16 v[88:91], v[144:147], v[120:123], v[88:91]
    v_mfma_f32_16x16x32_bf16 v[92:95], v[144:147], v[124:127], v[92:95]
    v_mfma_f32_16x16x32_bf16 v[108:111], v[148:151], v[124:127], v[108:111]
    v_mfma_f32_16x16x32_bf16 v[104:107], v[148:151], v[120:123], v[104:107]
    v_mfma_f32_16x16x32_bf16 v[100:103], v[148:151], v[116:119], v[100:103]
    v_mfma_f32_16x16x32_bf16 v[96:99], v[148:151], v[112:115], v[96:99]
    s_waitcnt lgkmcnt(0)
    v_mfma_f32_16x16x32_bf16 v[16:19], v[168:171], v[152:155], v[16:19]
    s_barrier
    v_mfma_f32_16x16x32_bf16 v[20:23], v[168:171], v[156:159], v[20:23]
    ds_read_b128 v[112:115], v200 offset:0
    v_mfma_f32_16x16x32_bf16 v[24:27], v[168:171], v[160:163], v[24:27]
    ds_read_b64_tr_b16 v[128:129], v202 offset:0
    v_mfma_f32_16x16x32_bf16 v[28:31], v[168:171], v[164:167], v[28:31]
    ds_read_b64_tr_b16 v[130:131], v202 offset:512
    v_mfma_f32_16x16x32_bf16 v[44:47], v[172:175], v[164:167], v[44:47]
    ds_read_b128 v[116:119], v200 offset:2048
    v_mfma_f32_16x16x32_bf16 v[40:43], v[172:175], v[160:163], v[40:43]
    ds_read_b128 v[120:123], v200 offset:10240
    v_mfma_f32_16x16x32_bf16 v[36:39], v[172:175], v[156:159], v[36:39]
    ds_read_b128 v[124:127], v200 offset:12288
    v_mfma_f32_16x16x32_bf16 v[32:35], v[172:175], v[152:155], v[32:35]
    ds_read_b64_tr_b16 v[132:133], v203 offset:0
    v_mfma_f32_16x16x32_bf16 v[48:51], v[176:179], v[152:155], v[48:51]
    ds_read_b64_tr_b16 v[134:135], v203 offset:512
    v_mfma_f32_16x16x32_bf16 v[52:55], v[176:179], v[156:159], v[52:55]
    ds_read_b64_tr_b16 v[136:137], v202 offset:2048
    v_mfma_f32_16x16x32_bf16 v[56:59], v[176:179], v[160:163], v[56:59]
    ds_read_b64_tr_b16 v[138:139], v202 offset:2560
    v_mfma_f32_16x16x32_bf16 v[60:63], v[176:179], v[164:167], v[60:63]
    ds_read_b64_tr_b16 v[140:141], v203 offset:2048
    v_mfma_f32_16x16x32_bf16 v[76:79], v[180:183], v[164:167], v[76:79]
    ds_read_b64_tr_b16 v[142:143], v203 offset:2560
    v_mfma_f32_16x16x32_bf16 v[72:75], v[180:183], v[160:163], v[72:75]
    ds_read_b64_tr_b16 v[144:145], v202 offset:4096
    v_mfma_f32_16x16x32_bf16 v[68:71], v[180:183], v[156:159], v[68:71]
    ds_read_b64_tr_b16 v[146:147], v202 offset:4608
    v_mfma_f32_16x16x32_bf16 v[64:67], v[180:183], v[152:155], v[64:67]
    ds_read_b64_tr_b16 v[148:149], v203 offset:4096
    v_mfma_f32_16x16x32_bf16 v[80:83], v[184:187], v[152:155], v[80:83]
    ds_read_b64_tr_b16 v[150:151], v203 offset:4608
    v_mfma_f32_16x16x32_bf16 v[84:87], v[184:187], v[156:159], v[84:87]
    v_mfma_f32_16x16x32_bf16 v[88:91], v[184:187], v[160:163], v[88:91]
    v_mfma_f32_16x16x32_bf16 v[92:95], v[184:187], v[164:167], v[92:95]
    v_mfma_f32_16x16x32_bf16 v[108:111], v[188:191], v[164:167], v[108:111]
    v_mfma_f32_16x16x32_bf16 v[104:107], v[188:191], v[160:163], v[104:107]
    v_mfma_f32_16x16x32_bf16 v[100:103], v[188:191], v[156:159], v[100:103]
    v_mfma_f32_16x16x32_bf16 v[96:99], v[188:191], v[152:155], v[96:99]
    s_waitcnt lgkmcnt(0)
    v_mfma_f32_16x16x32_bf16 v[16:19], v[128:131], v[112:115], v[16:19]
    ds_read_b128 v[152:155], v201 offset:0
    v_mfma_f32_16x16x32_bf16 v[20:23], v[128:131], v[116:119], v[20:23]
    ds_read_b64_tr_b16 v[168:169], v202 offset:20480
    v_mfma_f32_16x16x32_bf16 v[24:27], v[128:131], v[120:123], v[24:27]
    ds_read_b64_tr_b16 v[170:171], v202 offset:20992
    v_mfma_f32_16x16x32_bf16 v[28:31], v[128:131], v[124:127], v[28:31]
    ds_read_b128 v[156:159], v201 offset:2048
    v_mfma_f32_16x16x32_bf16 v[44:47], v[132:135], v[124:127], v[44:47]
    ds_read_b128 v[160:163], v201 offset:10240
    v_mfma_f32_16x16x32_bf16 v[40:43], v[132:135], v[120:123], v[40:43]
    ds_read_b128 v[164:167], v201 offset:12288
    v_mfma_f32_16x16x32_bf16 v[36:39], v[132:135], v[116:119], v[36:39]
    ds_read_b64_tr_b16 v[172:173], v203 offset:20480
    v_mfma_f32_16x16x32_bf16 v[32:35], v[132:135], v[112:115], v[32:35]
    ds_read_b64_tr_b16 v[174:175], v203 offset:20992
    v_mfma_f32_16x16x32_bf16 v[48:51], v[136:139], v[112:115], v[48:51]
    ds_read_b64_tr_b16 v[176:177], v202 offset:22528
    v_mfma_f32_16x16x32_bf16 v[52:55], v[136:139], v[116:119], v[52:55]
    ds_read_b64_tr_b16 v[178:179], v202 offset:23040
    v_mfma_f32_16x16x32_bf16 v[56:59], v[136:139], v[120:123], v[56:59]
    ds_read_b64_tr_b16 v[180:181], v203 offset:22528
    v_mfma_f32_16x16x32_bf16 v[60:63], v[136:139], v[124:127], v[60:63]
    ds_read_b64_tr_b16 v[182:183], v203 offset:23040
    v_mfma_f32_16x16x32_bf16 v[76:79], v[140:143], v[124:127], v[76:79]
    ds_read_b64_tr_b16 v[184:185], v202 offset:24576
    v_mfma_f32_16x16x32_bf16 v[72:75], v[140:143], v[120:123], v[72:75]
    ds_read_b64_tr_b16 v[186:187], v202 offset:25088
    v_mfma_f32_16x16x32_bf16 v[68:71], v[140:143], v[116:119], v[68:71]
    ds_read_b64_tr_b16 v[188:189], v203 offset:24576
    v_mfma_f32_16x16x32_bf16 v[64:67], v[140:143], v[112:115], v[64:67]
    ds_read_b64_tr_b16 v[190:191], v203 offset:25088
    v_mfma_f32_16x16x32_bf16 v[80:83], v[144:147], v[112:115], v[80:83]
    v_mfma_f32_16x16x32_bf16 v[84:87], v[144:147], v[116:119], v[84:87]
    v_mfma_f32_16x16x32_bf16 v[88:91], v[144:147], v[120:123], v[88:91]
    v_mfma_f32_16x16x32_bf16 v[92:95], v[144:147], v[124:127], v[92:95]
    v_mfma_f32_16x16x32_bf16 v[108:111], v[148:151], v[124:127], v[108:111]
    v_mfma_f32_16x16x32_bf16 v[104:107], v[148:151], v[120:123], v[104:107]
    v_mfma_f32_16x16x32_bf16 v[100:103], v[148:151], v[116:119], v[100:103]
    v_mfma_f32_16x16x32_bf16 v[96:99], v[148:151], v[112:115], v[96:99]
    s_waitcnt lgkmcnt(0)
    v_mfma_f32_16x16x32_bf16 v[16:19], v[168:171], v[152:155], v[16:19]
    s_barrier
    v_mfma_f32_16x16x32_bf16 v[20:23], v[168:171], v[156:159], v[20:23]
    ds_read_b128 v[112:115], v192 offset:0
    v_mfma_f32_16x16x32_bf16 v[24:27], v[168:171], v[160:163], v[24:27]
    ds_read_b64_tr_b16 v[128:129], v194 offset:0
    v_mfma_f32_16x16x32_bf16 v[28:31], v[168:171], v[164:167], v[28:31]
    ds_read_b64_tr_b16 v[130:131], v194 offset:512
    v_mfma_f32_16x16x32_bf16 v[44:47], v[172:175], v[164:167], v[44:47]
    ds_read_b128 v[116:119], v192 offset:2048
    v_mfma_f32_16x16x32_bf16 v[40:43], v[172:175], v[160:163], v[40:43]
    ds_read_b128 v[120:123], v192 offset:10240
    v_mfma_f32_16x16x32_bf16 v[36:39], v[172:175], v[156:159], v[36:39]
    ds_read_b128 v[124:127], v192 offset:12288
    v_mfma_f32_16x16x32_bf16 v[32:35], v[172:175], v[152:155], v[32:35]
    ds_read_b64_tr_b16 v[132:133], v195 offset:0
    v_mfma_f32_16x16x32_bf16 v[48:51], v[176:179], v[152:155], v[48:51]
    ds_read_b64_tr_b16 v[134:135], v195 offset:512
    v_mfma_f32_16x16x32_bf16 v[52:55], v[176:179], v[156:159], v[52:55]
    ds_read_b64_tr_b16 v[136:137], v194 offset:2048
    v_mfma_f32_16x16x32_bf16 v[56:59], v[176:179], v[160:163], v[56:59]
    ds_read_b64_tr_b16 v[138:139], v194 offset:2560
    v_mfma_f32_16x16x32_bf16 v[60:63], v[176:179], v[164:167], v[60:63]
    ds_read_b64_tr_b16 v[140:141], v195 offset:2048
    v_mfma_f32_16x16x32_bf16 v[76:79], v[180:183], v[164:167], v[76:79]
    ds_read_b64_tr_b16 v[142:143], v195 offset:2560
    v_mfma_f32_16x16x32_bf16 v[72:75], v[180:183], v[160:163], v[72:75]
    ds_read_b64_tr_b16 v[144:145], v194 offset:4096
    v_mfma_f32_16x16x32_bf16 v[68:71], v[180:183], v[156:159], v[68:71]
    ds_read_b64_tr_b16 v[146:147], v194 offset:4608
    v_mfma_f32_16x16x32_bf16 v[64:67], v[180:183], v[152:155], v[64:67]
    ds_read_b64_tr_b16 v[148:149], v195 offset:4096
    v_mfma_f32_16x16x32_bf16 v[80:83], v[184:187], v[152:155], v[80:83]
    ds_read_b64_tr_b16 v[150:151], v195 offset:4608
    v_mfma_f32_16x16x32_bf16 v[84:87], v[184:187], v[156:159], v[84:87]
    v_mfma_f32_16x16x32_bf16 v[88:91], v[184:187], v[160:163], v[88:91]
    v_mfma_f32_16x16x32_bf16 v[92:95], v[184:187], v[164:167], v[92:95]
    v_mfma_f32_16x16x32_bf16 v[108:111], v[188:191], v[164:167], v[108:111]
    v_mfma_f32_16x16x32_bf16 v[104:107], v[188:191], v[160:163], v[104:107]
    v_mfma_f32_16x16x32_bf16 v[100:103], v[188:191], v[156:159], v[100:103]
    v_mfma_f32_16x16x32_bf16 v[96:99], v[188:191], v[152:155], v[96:99]
    s_waitcnt lgkmcnt(0)
    v_mfma_f32_16x16x32_bf16 v[16:19], v[128:131], v[112:115], v[16:19]
    ds_read_b128 v[152:155], v193 offset:0
    v_mfma_f32_16x16x32_bf16 v[20:23], v[128:131], v[116:119], v[20:23]
    ds_read_b64_tr_b16 v[168:169], v194 offset:20480
    v_mfma_f32_16x16x32_bf16 v[24:27], v[128:131], v[120:123], v[24:27]
    ds_read_b64_tr_b16 v[170:171], v194 offset:20992
    v_mfma_f32_16x16x32_bf16 v[28:31], v[128:131], v[124:127], v[28:31]
    ds_read_b128 v[156:159], v193 offset:2048
    v_mfma_f32_16x16x32_bf16 v[44:47], v[132:135], v[124:127], v[44:47]
    ds_read_b128 v[160:163], v193 offset:10240
    v_mfma_f32_16x16x32_bf16 v[40:43], v[132:135], v[120:123], v[40:43]
    ds_read_b128 v[164:167], v193 offset:12288
    v_mfma_f32_16x16x32_bf16 v[36:39], v[132:135], v[116:119], v[36:39]
    ds_read_b64_tr_b16 v[172:173], v195 offset:20480
    v_mfma_f32_16x16x32_bf16 v[32:35], v[132:135], v[112:115], v[32:35]
    ds_read_b64_tr_b16 v[174:175], v195 offset:20992
    v_mfma_f32_16x16x32_bf16 v[48:51], v[136:139], v[112:115], v[48:51]
    ds_read_b64_tr_b16 v[176:177], v194 offset:22528
    v_mfma_f32_16x16x32_bf16 v[52:55], v[136:139], v[116:119], v[52:55]
    ds_read_b64_tr_b16 v[178:179], v194 offset:23040
    v_mfma_f32_16x16x32_bf16 v[56:59], v[136:139], v[120:123], v[56:59]
    ds_read_b64_tr_b16 v[180:181], v195 offset:22528
    v_mfma_f32_16x16x32_bf16 v[60:63], v[136:139], v[124:127], v[60:63]
    ds_read_b64_tr_b16 v[182:183], v195 offset:23040
    v_mfma_f32_16x16x32_bf16 v[76:79], v[140:143], v[124:127], v[76:79]
    ds_read_b64_tr_b16 v[184:185], v194 offset:24576
    v_mfma_f32_16x16x32_bf16 v[72:75], v[140:143], v[120:123], v[72:75]
    ds_read_b64_tr_b16 v[186:187], v194 offset:25088
    v_mfma_f32_16x16x32_bf16 v[68:71], v[140:143], v[116:119], v[68:71]
    ds_read_b64_tr_b16 v[188:189], v195 offset:24576
    v_mfma_f32_16x16x32_bf16 v[64:67], v[140:143], v[112:115], v[64:67]
    ds_read_b64_tr_b16 v[190:191], v195 offset:25088
    v_mfma_f32_16x16x32_bf16 v[80:83], v[144:147], v[112:115], v[80:83]
    v_mfma_f32_16x16x32_bf16 v[84:87], v[144:147], v[116:119], v[84:87]
    v_mfma_f32_16x16x32_bf16 v[88:91], v[144:147], v[120:123], v[88:91]
    v_mfma_f32_16x16x32_bf16 v[92:95], v[144:147], v[124:127], v[92:95]
    v_mfma_f32_16x16x32_bf16 v[108:111], v[148:151], v[124:127], v[108:111]
    s_add_u32 s68, s68, 1
    s_cmp_lt_u32 s68, 5
    v_mfma_f32_16x16x32_bf16 v[104:107], v[148:151], v[120:123], v[104:107]
    v_mfma_f32_16x16x32_bf16 v[100:103], v[148:151], v[116:119], v[100:103]
    v_mfma_f32_16x16x32_bf16 v[96:99], v[148:151], v[112:115], v[96:99]
    s_waitcnt lgkmcnt(0)
    v_mfma_f32_16x16x32_bf16 v[16:19], v[168:171], v[152:155], v[16:19]
    s_cbranch_scc0 L_cexit
    s_barrier
    v_mfma_f32_16x16x32_bf16 v[20:23], v[168:171], v[156:159], v[20:23]
    ds_read_b128 v[112:115], v196 offset:0
    v_mfma_f32_16x16x32_bf16 v[24:27], v[168:171], v[160:163], v[24:27]
    ds_read_b64_tr_b16 v[128:129], v198 offset:0
    s_branch L_cloop
L_cexit:
    v_mfma_f32_16x16x32_bf16 v[20:23], v[168:171], v[156:159], v[20:23]
    v_mfma_f32_16x16x32_bf16 v[24:27], v[168:171], v[160:163], v[24:27]
    v_mfma_f32_16x16x32_bf16 v[28:31], v[168:171], v[164:167], v[28:31]
    v_mfma_f32_16x16x32_bf16 v[44:47], v[172:175], v[164:167], v[44:47]
    v_mfma_f32_16x16x32_bf16 v[40:43], v[172:175], v[160:163], v[40:43]
    v_mfma_f32_16x16x32_bf16 v[36:39], v[172:175], v[156:159], v[36:39]
    v_mfma_f32_16x16x32_bf16 v[32:35], v[172:175], v[152:155], v[32:35]
    v_mfma_f32_16x16x32_bf16 v[48:51], v[176:179], v[152:155], v[48:51]
    v_mfma_f32_16x16x32_bf16 v[52:55], v[176:179], v[156:159], v[52:55]
    v_mfma_f32_16x16x32_bf16 v[56:59], v[176:179], v[160:163], v[56:59]
    s_barrier
    ds_read_b32 v11, v10 offset:53248
    ds_read_b64 v[222:223], v213 offset:49152
    ds_read_b64 v[224:225], v213 offset:49280
    v_mfma_f32_16x16x32_bf16 v[60:63], v[176:179], v[164:167], v[60:63]
    ds_read_b64 v[226:227], v213 offset:49408
    ds_read_b64 v[228:229], v213 offset:49536
    v_mfma_f32_16x16x32_bf16 v[76:79], v[180:183], v[164:167], v[76:79]
    ds_read_b64 v[238:239], v215 offset:50176
    ds_read_b64 v[240:241], v215 offset:50304
    v_mfma_f32_16x16x32_bf16 v[72:75], v[180:183], v[160:163], v[72:75]
    ds_read_b64 v[242:243], v215 offset:50688
    ds_read_b64 v[244:245], v215 offset:50816
    v_mfma_f32_16x16x32_bf16 v[68:71], v[180:183], v[156:159], v[68:71]
    ds_read_b64 v[246:247], v215 offset:51200
    ds_read_b64 v[248:249], v215 offset:51328
    v_mfma_f32_16x16x32_bf16 v[64:67], v[180:183], v[152:155], v[64:67]
    ds_read_b32 v250, v214 offset:49156
    ds_read_b32 v252, v214 offset:49412
    v_mfma_f32_16x16x32_bf16 v[80:83], v[184:187], v[152:155], v[80:83]
    s_waitcnt lgkmcnt(8)
    v_readfirstlane_b32 s100, v11
    v_mov_b32_e64 v230, v223
    v_cndmask_b32 v222, 0, v222, s[86:87]
    v_mfma_f32_16x16x32_bf16 v[84:87], v[184:187], v[156:159], v[84:87]
    v_mov_b32_e64 v232, v225
    v_cndmask_b32 v224, 0, v224, s[86:87]
    v_mov_b32_e64 v234, v227
    v_cndmask_b32 v226, 0, v226, s[86:87]
    v_mfma_f32_16x16x32_bf16 v[88:91], v[184:187], v[160:163], v[88:91]
    v_mov_b32_e64 v236, v229
    v_cndmask_b32 v228, 0, v228, s[86:87]
    v_mov_b32 v223, v222
    v_mov_b32 v225, v224
    v_mfma_f32_16x16x32_bf16 v[92:95], v[184:187], v[164:167], v[92:95]
    v_mov_b32 v227, v226
    v_mov_b32_e64 v229, v228
    s_waitcnt lgkmcnt(0)
    v_mul_f32 v251, 0x3fb8aa3b, v250
    v_mfma_f32_16x16x32_bf16 v[108:111], v[188:191], v[164:167], v[108:111]
    v_mul_f32 v253, 0x3fb8aa3b, v252
    v_mfma_f32_16x16x32_bf16 v[104:107], v[188:191], v[160:163], v[104:107]
    v_mfma_f32_16x16x32_bf16 v[100:103], v[188:191], v[156:159], v[100:103]
    v_mfma_f32_16x16x32_bf16 v[96:99], v[188:191], v[152:155], v[96:99]
    v_mfma_f32_16x16x16_bf16 v[48:51], v[242:243], v[222:223], v[48:51]
    v_xor_b32 v168, 0, v217
    v_xor_b32 v169, 16, v217
    v_mfma_f32_16x16x16_bf16 v[52:55], v[242:243], v[224:225], v[52:55]
    v_xor_b32 v170, 32, v217
    v_xor_b32 v171, 48, v217
    v_mfma_f32_16x16x16_bf16 v[64:67], v[244:245], v[222:223], v[64:67]
    v_xor_b32_e64 v172, 64, v217
    v_xor_b32 v173, 80, v217
    v_mfma_f32_16x16x16_bf16 v[68:71], v[244:245], v[224:225], v[68:71]
    v_xor_b32 v174, 96, v217
    v_xor_b32 v175, 112, v217
    v_mfma_f32_16x16x16_bf16 v[56:59], v[242:243], v[226:227], v[56:59]
    v_xor_b32_e64 v4, 32, v216
    v_mfma_f32_16x16x16_bf16 v[60:63], v[242:243], v[228:229], v[60:63]
    v_mfma_f32_16x16x16_bf16 v[72:75], v[244:245], v[226:227], v[72:75]
    v_mfma_f32_16x16x16_bf16 v[76:79], v[244:245], v[228:229], v[76:79]
    v_mfma_f32_16x16x16_bf16 v[80:83], v[246:247], v[222:223], v[80:83]
    v_cvt_pk_bf16_f32 v112, v48, v49
    v_cvt_pk_bf16_f32 v113, v50, v51
    v_mfma_f32_16x16x16_bf16 v[84:87], v[246:247], v[224:225], v[84:87]
    v_cvt_pk_bf16_f32 v114, v52, v53
    v_cvt_pk_bf16_f32 v115, v54, v55
    v_mfma_f32_16x16x16_bf16 v[88:91], v[246:247], v[226:227], v[88:91]
    v_cvt_pk_bf16_f32 v116, v64, v65
    v_cvt_pk_bf16_f32 v117, v66, v67
    v_mfma_f32_16x16x16_bf16 v[92:95], v[246:247], v[228:229], v[92:95]
    v_cvt_pk_bf16_f32 v118, v68, v69
    v_cvt_pk_bf16_f32 v119, v70, v71
    v_mfma_f32_16x16x16_bf16 v[96:99], v[248:249], v[222:223], v[96:99]
    v_cvt_pk_bf16_f32 v120, v56, v57
    v_cvt_pk_bf16_f32 v121, v58, v59
    v_mfma_f32_16x16x16_bf16 v[100:103], v[248:249], v[224:225], v[100:103]
    v_cvt_pk_bf16_f32 v122, v60, v61
    v_cvt_pk_bf16_f32 v123, v62, v63
    v_mfma_f32_16x16x16_bf16 v[104:107], v[248:249], v[226:227], v[104:107]
    v_permlane16_swap_b32 v112, v114
    v_permlane16_swap_b32 v113, v115
    v_mfma_f32_16x16x16_bf16 v[108:111], v[248:249], v[228:229], v[108:111]
    v_permlane16_swap_b32 v116, v118
    v_permlane16_swap_b32 v117, v119
    v_cvt_pk_bf16_f32 v124, v72, v73
    v_cvt_pk_bf16_f32 v125, v74, v75
    v_cvt_pk_bf16_f32 v126, v76, v77
    v_cvt_pk_bf16_f32 v127, v78, v79
    v_permlane16_swap_b32 v120, v122
    v_permlane16_swap_b32 v121, v123
    v_permlane16_swap_b32 v124, v126
    v_permlane16_swap_b32 v125, v127
    v_mfma_f32_32x32x16_bf16 v[48:63], v[204:207], v[112:115], 0
    v_mul_f32 v80, v80, v230
    v_mul_f32 v81, v81, v230
    v_mul_f32 v82, v82, v230
    v_mul_f32 v83, v83, v230
    v_cvt_pk_bf16_f32 v80, v80, v81
    v_cvt_pk_bf16_f32 v81, v82, v83
    v_mfma_f32_32x32x16_bf16 v[64:79], v[204:207], v[120:123], 0
    v_mul_f32 v96, v96, v230
    v_mul_f32 v97, v97, v230
    v_mul_f32 v98, v98, v230
    v_mul_f32 v99, v99, v230
    v_cvt_pk_bf16_f32 v96, v96, v97
    v_cvt_pk_bf16_f32 v97, v98, v99
    v_mfma_f32_32x32x16_bf16 v[48:63], v[208:211], v[116:119], v[48:63]
    v_mul_f32 v84, v84, v232
    v_mul_f32 v85, v85, v232
    v_mul_f32 v86, v86, v232
    v_mul_f32 v87, v87, v232
    v_cvt_pk_bf16_f32 v84, v84, v85
    v_cvt_pk_bf16_f32 v85, v86, v87
    v_mfma_f32_32x32x16_bf16 v[64:79], v[208:211], v[124:127], v[64:79]
    v_mul_f32 v100, v100, v232
    v_mul_f32 v101, v101, v232
    v_mul_f32 v102, v102, v232
    v_mul_f32 v103, v103, v232
    v_cvt_pk_bf16_f32 v100, v100, v101
    v_cvt_pk_bf16_f32 v101, v102, v103
    v_mul_f32 v88, v88, v234
    v_mul_f32 v89, v89, v234
    v_mul_f32 v90, v90, v234
    v_mul_f32 v91, v91, v234
    v_cvt_pk_bf16_f32 v88, v88, v89
    v_cvt_pk_bf16_f32 v89, v90, v91
    v_mul_f32 v104, v104, v234
    v_mul_f32 v105, v105, v234
    v_mul_f32 v106, v106, v234
    v_mul_f32 v107, v107, v234
    v_cvt_pk_bf16_f32 v104, v104, v105
    v_cvt_pk_bf16_f32 v105, v106, v107
    v_mul_f32 v92, v92, v236
    v_mul_f32 v93, v93, v236
    v_mul_f32 v94, v94, v236
    v_mul_f32 v95, v95, v236
    v_cvt_pk_bf16_f32 v92, v92, v93
    v_cvt_pk_bf16_f32 v93, v94, v95
    v_mul_f32 v108, v108, v236
    v_mul_f32 v109, v109, v236
    v_mul_f32 v110, v110, v236
    v_mul_f32 v111, v111, v236
    v_cvt_pk_bf16_f32 v108, v108, v109
    v_cvt_pk_bf16_f32 v109, v110, v111
    v_max3_f32 v160, v48, v49, v50
    v_min3_f32 v162, v48, v49, v50
    v_max3_f32 v160, v160, v51, v52
    v_min3_f32 v162, v162, v51, v52
    v_max3_f32 v160, v160, v53, v54
    v_min3_f32 v162, v162, v53, v54
    v_max3_f32 v160, v160, v55, v56
    v_min3_f32 v162, v162, v55, v56
    v_max3_f32 v160, v160, v57, v58
    v_min3_f32 v162, v162, v57, v58
    v_max3_f32 v160, v160, v59, v60
    v_min3_f32 v162, v162, v59, v60
    v_max3_f32 v160, v160, v61, v62
    v_min3_f32 v162, v162, v61, v62
    v_max_f32 v160, v160, v63
    v_min_f32 v162, v162, v63
    v_max3_f32 v164, v64, v65, v66
    v_min3_f32 v166, v64, v65, v66
    v_max3_f32 v164, v164, v67, v68
    v_min3_f32 v166, v166, v67, v68
    v_max3_f32 v164, v164, v69, v70
    v_min3_f32 v166, v166, v69, v70
    v_max3_f32 v164, v164, v71, v72
    v_min3_f32 v166, v166, v71, v72
    v_max3_f32 v164, v164, v73, v74
    v_min3_f32 v166, v166, v73, v74
    v_max3_f32 v164, v164, v75, v76
    v_min3_f32 v166, v166, v75, v76
    v_max3_f32 v164, v164, v77, v78
    v_min3_f32 v166, v166, v77, v78
    v_max_f32 v164, v164, v79
    v_min_f32 v166, v166, v79
    v_mov_b32 v161, v160
    v_mov_b32 v163, v162
    v_mov_b32 v165, v164
    v_mov_b32 v167, v166
    v_permlane32_swap_b32 v160, v161
    v_permlane32_swap_b32 v162, v163
    v_permlane32_swap_b32 v164, v165
    v_permlane32_swap_b32 v166, v167
    v_max_f32 v160, v160, v161
    v_min_f32 v162, v162, v163
    v_max_f32 v164, v164, v165
    v_min_f32 v166, v166, v167
    v_mul_f32 v160, v160, v251
    v_mul_f32 v162, v162, v251
    v_mul_f32 v164, v164, v253
    v_mul_f32 v166, v166, v253
    v_pk_fma_f32 v[128:129], v[48:49], v[250:251], v[160:161] op_sel:[0,1,0] op_sel_hi:[1,1,0] neg_lo:[0,0,1] neg_hi:[0,0,1]
    v_pk_fma_f32 v[48:49], v[48:49], v[250:251], v[162:163] op_sel:[0,1,0] op_sel_hi:[1,1,0] neg_lo:[0,1,0] neg_hi:[0,1,0]
    v_pk_fma_f32 v[130:131], v[50:51], v[250:251], v[160:161] op_sel:[0,1,0] op_sel_hi:[1,1,0] neg_lo:[0,0,1] neg_hi:[0,0,1]
    v_pk_fma_f32 v[50:51], v[50:51], v[250:251], v[162:163] op_sel:[0,1,0] op_sel_hi:[1,1,0] neg_lo:[0,1,0] neg_hi:[0,1,0]
    v_pk_fma_f32 v[132:133], v[52:53], v[250:251], v[160:161] op_sel:[0,1,0] op_sel_hi:[1,1,0] neg_lo:[0,0,1] neg_hi:[0,0,1]
    v_pk_fma_f32 v[52:53], v[52:53], v[250:251], v[162:163] op_sel:[0,1,0] op_sel_hi:[1,1,0] neg_lo:[0,1,0] neg_hi:[0,1,0]
    v_pk_fma_f32 v[134:135], v[54:55], v[250:251], v[160:161] op_sel:[0,1,0] op_sel_hi:[1,1,0] neg_lo:[0,0,1] neg_hi:[0,0,1]
    v_pk_fma_f32 v[54:55], v[54:55], v[250:251], v[162:163] op_sel:[0,1,0] op_sel_hi:[1,1,0] neg_lo:[0,1,0] neg_hi:[0,1,0]
    v_pk_fma_f32 v[136:137], v[56:57], v[250:251], v[160:161] op_sel:[0,1,0] op_sel_hi:[1,1,0] neg_lo:[0,0,1] neg_hi:[0,0,1]
    v_pk_fma_f32 v[56:57], v[56:57], v[250:251], v[162:163] op_sel:[0,1,0] op_sel_hi:[1,1,0] neg_lo:[0,1,0] neg_hi:[0,1,0]
    v_pk_fma_f32 v[138:139], v[58:59], v[250:251], v[160:161] op_sel:[0,1,0] op_sel_hi:[1,1,0] neg_lo:[0,0,1] neg_hi:[0,0,1]
    v_pk_fma_f32 v[58:59], v[58:59], v[250:251], v[162:163] op_sel:[0,1,0] op_sel_hi:[1,1,0] neg_lo:[0,1,0] neg_hi:[0,1,0]
    v_pk_fma_f32 v[140:141], v[60:61], v[250:251], v[160:161] op_sel:[0,1,0] op_sel_hi:[1,1,0] neg_lo:[0,0,1] neg_hi:[0,0,1]
    v_pk_fma_f32 v[60:61], v[60:61], v[250:251], v[162:163] op_sel:[0,1,0] op_sel_hi:[1,1,0] neg_lo:[0,1,0] neg_hi:[0,1,0]
    v_pk_fma_f32 v[142:143], v[62:63], v[250:251], v[160:161] op_sel:[0,1,0] op_sel_hi:[1,1,0] neg_lo:[0,0,1] neg_hi:[0,0,1]
    v_pk_fma_f32 v[62:63], v[62:63], v[250:251], v[162:163] op_sel:[0,1,0] op_sel_hi:[1,1,0] neg_lo:[0,1,0] neg_hi:[0,1,0]
    v_pk_fma_f32 v[144:145], v[64:65], v[252:253], v[164:165] op_sel:[0,1,0] op_sel_hi:[1,1,0] neg_lo:[0,0,1] neg_hi:[0,0,1]
    v_pk_fma_f32 v[64:65], v[64:65], v[252:253], v[166:167] op_sel:[0,1,0] op_sel_hi:[1,1,0] neg_lo:[0,1,0] neg_hi:[0,1,0]
    v_pk_fma_f32 v[146:147], v[66:67], v[252:253], v[164:165] op_sel:[0,1,0] op_sel_hi:[1,1,0] neg_lo:[0,0,1] neg_hi:[0,0,1]
    v_pk_fma_f32 v[66:67], v[66:67], v[252:253], v[166:167] op_sel:[0,1,0] op_sel_hi:[1,1,0] neg_lo:[0,1,0] neg_hi:[0,1,0]
    v_pk_fma_f32 v[148:149], v[68:69], v[252:253], v[164:165] op_sel:[0,1,0] op_sel_hi:[1,1,0] neg_lo:[0,0,1] neg_hi:[0,0,1]
    v_pk_fma_f32 v[68:69], v[68:69], v[252:253], v[166:167] op_sel:[0,1,0] op_sel_hi:[1,1,0] neg_lo:[0,1,0] neg_hi:[0,1,0]
    v_pk_fma_f32 v[150:151], v[70:71], v[252:253], v[164:165] op_sel:[0,1,0] op_sel_hi:[1,1,0] neg_lo:[0,0,1] neg_hi:[0,0,1]
    v_pk_fma_f32 v[70:71], v[70:71], v[252:253], v[166:167] op_sel:[0,1,0] op_sel_hi:[1,1,0] neg_lo:[0,1,0] neg_hi:[0,1,0]
    v_pk_fma_f32 v[152:153], v[72:73], v[252:253], v[164:165] op_sel:[0,1,0] op_sel_hi:[1,1,0] neg_lo:[0,0,1] neg_hi:[0,0,1]
    v_pk_fma_f32 v[72:73], v[72:73], v[252:253], v[166:167] op_sel:[0,1,0] op_sel_hi:[1,1,0] neg_lo:[0,1,0] neg_hi:[0,1,0]
    v_pk_fma_f32 v[154:155], v[74:75], v[252:253], v[164:165] op_sel:[0,1,0] op_sel_hi:[1,1,0] neg_lo:[0,0,1] neg_hi:[0,0,1]
    v_pk_fma_f32 v[74:75], v[74:75], v[252:253], v[166:167] op_sel:[0,1,0] op_sel_hi:[1,1,0] neg_lo:[0,1,0] neg_hi:[0,1,0]
    v_pk_fma_f32 v[156:157], v[76:77], v[252:253], v[164:165] op_sel:[0,1,0] op_sel_hi:[1,1,0] neg_lo:[0,0,1] neg_hi:[0,0,1]
    v_pk_fma_f32 v[76:77], v[76:77], v[252:253], v[166:167] op_sel:[0,1,0] op_sel_hi:[1,1,0] neg_lo:[0,1,0] neg_hi:[0,1,0]
    v_pk_fma_f32 v[158:159], v[78:79], v[252:253], v[164:165] op_sel:[0,1,0] op_sel_hi:[1,1,0] neg_lo:[0,0,1] neg_hi:[0,0,1]
    v_pk_fma_f32 v[78:79], v[78:79], v[252:253], v[166:167] op_sel:[0,1,0] op_sel_hi:[1,1,0] neg_lo:[0,1,0] neg_hi:[0,1,0]
    v_exp_f32_e64 v128, v128
    v_mfma_f32_16x16x16_bf16 v[16:19], v[238:239], v[222:223], v[16:19]
    v_exp_f32 v144, v144
    v_exp_f32 v129, v129
    v_exp_f32_e64 v145, v145
    v_mfma_f32_16x16x16_bf16 v[20:23], v[238:239], v[224:225], v[20:23]
    ds_write2st64_b64 v216, v[80:81], v[84:85] offset0:64 offset1:68
    v_exp_f32 v130, v130
    v_exp_f32 v146, v146
    v_exp_f32_e64 v131, v131
    v_mfma_f32_16x16x16_bf16 v[24:27], v[238:239], v[226:227], v[24:27]
    v_exp_f32 v147, v147
    v_exp_f32 v132, v132
    v_exp_f32_e64 v148, v148
    v_mfma_f32_16x16x16_bf16 v[28:31], v[238:239], v[228:229], v[28:31]
    ds_write2st64_b64 v4, v[96:97], v[100:101] offset0:64 offset1:68
    v_exp_f32 v133, v133
    v_exp_f32 v149, v149
    v_exp_f32_e64 v134, v134
    v_mfma_f32_16x16x16_bf16 v[32:35], v[240:241], v[222:223], v[32:35]
    v_exp_f32 v150, v150
    v_exp_f32 v135, v135
    v_exp_f32_e64 v151, v151
    v_mfma_f32_16x16x16_bf16 v[36:39], v[240:241], v[224:225], v[36:39]
    ds_write2st64_b64 v216, v[88:89], v[92:93] offset0:72 offset1:76
    v_exp_f32 v136, v136
    v_exp_f32 v152, v152
    v_exp_f32_e64 v137, v137
    v_mfma_f32_16x16x16_bf16 v[40:43], v[240:241], v[226:227], v[40:43]
    v_exp_f32 v153, v153
    v_exp_f32 v138, v138
    v_exp_f32_e64 v154, v154
    v_mfma_f32_16x16x16_bf16 v[44:47], v[240:241], v[228:229], v[44:47]
    ds_write2st64_b64 v4, v[104:105], v[108:109] offset0:72 offset1:76
    v_exp_f32 v139, v139
    v_exp_f32 v155, v155
    v_exp_f32 v140, v140
    v_exp_f32 v156, v156
    v_exp_f32 v141, v141
    v_exp_f32 v157, v157
    v_exp_f32 v142, v142
    v_exp_f32 v158, v158
    v_exp_f32 v143, v143
    v_exp_f32 v159, v159
    v_pk_add_f32 v[176:177], v[128:129], v[130:131]
    v_pk_add_f32 v[178:179], v[144:145], v[146:147]
    v_pk_add_f32 v[176:177], v[176:177], v[132:133]
    v_pk_add_f32 v[178:179], v[178:179], v[148:149]
    v_pk_add_f32 v[176:177], v[176:177], v[134:135]
    v_pk_add_f32 v[178:179], v[178:179], v[150:151]
    v_pk_add_f32 v[176:177], v[176:177], v[136:137]
    v_pk_add_f32 v[178:179], v[178:179], v[152:153]
    v_pk_add_f32 v[176:177], v[176:177], v[138:139]
    v_pk_add_f32 v[178:179], v[178:179], v[154:155]
    v_pk_add_f32 v[176:177], v[176:177], v[140:141]
    v_pk_add_f32 v[178:179], v[178:179], v[156:157]
    v_pk_add_f32 v[176:177], v[176:177], v[142:143]
    v_pk_add_f32 v[178:179], v[178:179], v[158:159]
    v_exp_f32 v48, v48
    v_add_f32 v176, v176, v177
    v_add_f32 v178, v178, v179
    v_exp_f32 v64, v64
    v_mov_b32 v177, v176
    v_mov_b32 v179, v178
    v_exp_f32 v49, v49
    v_permlane32_swap_b32 v176, v177
    v_permlane32_swap_b32 v178, v179
    v_exp_f32 v65, v65
    v_add_f32 v176, v176, v177
    v_add_f32 v178, v178, v179
    v_exp_f32 v50, v50
    v_rcp_f32 v176, v176
    v_rcp_f32 v178, v178
    v_exp_f32 v66, v66
    v_exp_f32 v51, v51
    v_exp_f32 v67, v67
    v_exp_f32 v52, v52
    v_exp_f32 v68, v68
    v_exp_f32 v53, v53
    v_exp_f32 v69, v69
    v_exp_f32 v54, v54
    v_exp_f32 v70, v70
    v_exp_f32 v55, v55
    v_exp_f32 v71, v71
    v_exp_f32 v56, v56
    v_exp_f32 v72, v72
    v_exp_f32 v57, v57
    v_exp_f32 v73, v73
    v_exp_f32 v58, v58
    v_exp_f32 v74, v74
    v_exp_f32 v59, v59
    v_exp_f32 v75, v75
    v_exp_f32 v60, v60
    v_exp_f32 v76, v76
    v_exp_f32 v61, v61
    v_exp_f32 v77, v77
    v_exp_f32 v62, v62
    v_exp_f32 v78, v78
    v_exp_f32 v63, v63
    v_exp_f32 v79, v79
    v_pk_add_f32 v[180:181], v[48:49], v[50:51]
    v_pk_add_f32 v[182:183], v[64:65], v[66:67]
    v_pk_add_f32 v[180:181], v[180:181], v[52:53]
    v_pk_add_f32 v[182:183], v[182:183], v[68:69]
    v_pk_add_f32 v[180:181], v[180:181], v[54:55]
    v_pk_add_f32 v[182:183], v[182:183], v[70:71]
    v_pk_add_f32 v[180:181], v[180:181], v[56:57]
    v_pk_add_f32 v[182:183], v[182:183], v[72:73]
    v_pk_add_f32 v[180:181], v[180:181], v[58:59]
    v_pk_add_f32 v[182:183], v[182:183], v[74:75]
    v_pk_add_f32 v[180:181], v[180:181], v[60:61]
    v_pk_add_f32 v[182:183], v[182:183], v[76:77]
    v_pk_add_f32 v[180:181], v[180:181], v[62:63]
    v_pk_add_f32 v[182:183], v[182:183], v[78:79]
    v_add_f32 v180, v180, v181
    v_add_f32 v182, v182, v183
    v_mov_b32 v181, v180
    v_mov_b32 v183, v182
    v_pk_mul_f32 v[128:129], v[128:129], v[176:177] op_sel_hi:[1,0]
    v_pk_mul_f32 v[130:131], v[130:131], v[176:177] op_sel_hi:[1,0]
    v_cvt_pk_bf16_f32 v128, v128, v129
    v_permlane32_swap_b32 v180, v181
    v_permlane32_swap_b32 v182, v183
    v_cvt_pk_bf16_f32 v129, v130, v131
    v_pk_mul_f32 v[144:145], v[144:145], v[178:179] op_sel_hi:[1,0]
    v_pk_mul_f32 v[146:147], v[146:147], v[178:179] op_sel_hi:[1,0]
    v_cvt_pk_bf16_f32 v144, v144, v145
    v_cvt_pk_bf16_f32 v145, v146, v147
    v_add_f32 v180, v180, v181
    v_add_f32 v182, v182, v183
    ds_write2st64_b64 v168, v[128:129], v[144:145] offset0:0 offset1:8
    v_pk_mul_f32 v[132:133], v[132:133], v[176:177] op_sel_hi:[1,0]
    v_pk_mul_f32 v[134:135], v[134:135], v[176:177] op_sel_hi:[1,0]
    v_cvt_pk_bf16_f32 v132, v132, v133
    v_cvt_pk_bf16_f32 v133, v134, v135
    v_pk_mul_f32 v[148:149], v[148:149], v[178:179] op_sel_hi:[1,0]
    v_rcp_f32 v180, v180
    v_rcp_f32 v182, v182
    v_pk_mul_f32 v[150:151], v[150:151], v[178:179] op_sel_hi:[1,0]
    v_cvt_pk_bf16_f32 v148, v148, v149
    v_cvt_pk_bf16_f32 v149, v150, v151
    ds_write2st64_b64 v169, v[132:133], v[148:149] offset0:0 offset1:8
    v_pk_mul_f32 v[136:137], v[136:137], v[176:177] op_sel_hi:[1,0]
    v_pk_mul_f32 v[138:139], v[138:139], v[176:177] op_sel_hi:[1,0]
    v_cvt_pk_bf16_f32 v136, v136, v137
    v_cvt_pk_bf16_f32 v137, v138, v139
    v_pk_mul_f32 v[152:153], v[152:153], v[178:179] op_sel_hi:[1,0]
    v_pk_mul_f32 v[154:155], v[154:155], v[178:179] op_sel_hi:[1,0]
    v_cvt_pk_bf16_f32 v152, v152, v153
    v_cvt_pk_bf16_f32 v153, v154, v155
    ds_write2st64_b64 v170, v[136:137], v[152:153] offset0:0 offset1:8
    v_pk_mul_f32 v[140:141], v[140:141], v[176:177] op_sel_hi:[1,0]
    v_pk_mul_f32 v[142:143], v[142:143], v[176:177] op_sel_hi:[1,0]
    v_cvt_pk_bf16_f32 v140, v140, v141
    v_cvt_pk_bf16_f32 v141, v142, v143
    v_pk_mul_f32 v[156:157], v[156:157], v[178:179] op_sel_hi:[1,0]
    v_pk_mul_f32 v[158:159], v[158:159], v[178:179] op_sel_hi:[1,0]
    v_cvt_pk_bf16_f32 v156, v156, v157
    v_cvt_pk_bf16_f32 v157, v158, v159
    ds_write2st64_b64 v171, v[140:141], v[156:157] offset0:0 offset1:8
    v_pk_mul_f32 v[48:49], v[48:49], v[180:181] op_sel_hi:[1,0]
    v_pk_mul_f32 v[50:51], v[50:51], v[180:181] op_sel_hi:[1,0]
    v_cvt_pk_bf16_f32 v48, v48, v49
    v_cvt_pk_bf16_f32 v49, v50, v51
    v_pk_mul_f32 v[64:65], v[64:65], v[182:183] op_sel_hi:[1,0]
    v_pk_mul_f32 v[66:67], v[66:67], v[182:183] op_sel_hi:[1,0]
    v_cvt_pk_bf16_f32 v64, v64, v65
    v_cvt_pk_bf16_f32 v65, v66, v67
    ds_write2st64_b64 v172, v[48:49], v[64:65] offset0:0 offset1:8
    v_pk_mul_f32 v[52:53], v[52:53], v[180:181] op_sel_hi:[1,0]
    v_pk_mul_f32 v[54:55], v[54:55], v[180:181] op_sel_hi:[1,0]
    v_cvt_pk_bf16_f32 v52, v52, v53
    v_cvt_pk_bf16_f32 v53, v54, v55
    v_pk_mul_f32 v[68:69], v[68:69], v[182:183] op_sel_hi:[1,0]
    v_pk_mul_f32 v[70:71], v[70:71], v[182:183] op_sel_hi:[1,0]
    v_cvt_pk_bf16_f32 v68, v68, v69
    v_cvt_pk_bf16_f32 v69, v70, v71
    ds_write2st64_b64 v173, v[52:53], v[68:69] offset0:0 offset1:8
    v_pk_mul_f32 v[56:57], v[56:57], v[180:181] op_sel_hi:[1,0]
    v_pk_mul_f32 v[58:59], v[58:59], v[180:181] op_sel_hi:[1,0]
    v_cvt_pk_bf16_f32 v56, v56, v57
    v_cvt_pk_bf16_f32 v57, v58, v59
    v_pk_mul_f32 v[72:73], v[72:73], v[182:183] op_sel_hi:[1,0]
    v_pk_mul_f32 v[74:75], v[74:75], v[182:183] op_sel_hi:[1,0]
    v_cvt_pk_bf16_f32 v72, v72, v73
    v_cvt_pk_bf16_f32 v73, v74, v75
    ds_write2st64_b64 v174, v[56:57], v[72:73] offset0:0 offset1:8
    v_pk_mul_f32 v[60:61], v[60:61], v[180:181] op_sel_hi:[1,0]
    v_pk_mul_f32 v[62:63], v[62:63], v[180:181] op_sel_hi:[1,0]
    v_cvt_pk_bf16_f32 v60, v60, v61
    v_cvt_pk_bf16_f32 v61, v62, v63
    v_pk_mul_f32 v[76:77], v[76:77], v[182:183] op_sel_hi:[1,0]
    v_pk_mul_f32 v[78:79], v[78:79], v[182:183] op_sel_hi:[1,0]
    v_cvt_pk_bf16_f32 v76, v76, v77
    v_cvt_pk_bf16_f32 v77, v78, v79
    ds_write2st64_b64 v175, v[60:61], v[76:77] offset0:0 offset1:8
    ds_read_b64_tr_b16 v[112:113], v218 offset:0
    ds_read_b64_tr_b16 v[114:115], v219 offset:0
    ds_read_b64_tr_b16 v[144:145], v220 offset:32768
    ds_read_b64_tr_b16 v[146:147], v221 offset:32768
    ds_read_b64_tr_b16 v[116:117], v218 offset:2048
    ds_read_b64_tr_b16 v[118:119], v219 offset:2048
    ds_read_b64_tr_b16 v[148:149], v220 offset:34816
    ds_read_b64_tr_b16 v[150:151], v221 offset:34816
    ds_read_b64_tr_b16 v[120:121], v218 offset:4096
    ds_read_b64_tr_b16 v[122:123], v219 offset:4096
    ds_read_b64_tr_b16 v[152:153], v220 offset:36864
    ds_read_b64_tr_b16 v[154:155], v221 offset:36864
    v_cvt_pk_bf16_f32 v176, v16, v17
    v_cvt_pk_bf16_f32 v177, v18, v19
    v_cvt_pk_bf16_f32 v178, v20, v21
    v_cvt_pk_bf16_f32 v179, v22, v23
    v_cvt_pk_bf16_f32 v180, v32, v33
    v_cvt_pk_bf16_f32 v181, v34, v35
    v_cvt_pk_bf16_f32 v182, v36, v37
    v_cvt_pk_bf16_f32 v183, v38, v39
    v_cvt_pk_bf16_f32 v184, v24, v25
    v_cvt_pk_bf16_f32 v185, v26, v27
    v_cvt_pk_bf16_f32 v186, v28, v29
    v_cvt_pk_bf16_f32 v187, v30, v31
    v_cvt_pk_bf16_f32 v188, v40, v41
    v_cvt_pk_bf16_f32 v189, v42, v43
    v_cvt_pk_bf16_f32 v190, v44, v45
    v_cvt_pk_bf16_f32 v191, v46, v47
    s_waitcnt lgkmcnt(8)
    v_mfma_f32_32x32x16_bf16 v[48:63], v[112:115], v[144:147], 0
    ds_read_b64_tr_b16 v[124:125], v218 offset:6144
    ds_read_b64_tr_b16 v[126:127], v219 offset:6144
    ds_read_b64_tr_b16 v[156:157], v220 offset:38912
    ds_read_b64_tr_b16 v[158:159], v221 offset:38912
    s_waitcnt lgkmcnt(8)
    v_mfma_f32_32x32x16_bf16 v[48:63], v[116:119], v[148:151], v[48:63]
    v_xor_b32 v218, 8192, v218
    v_xor_b32 v219, 8192, v219
    v_xor_b32 v220, 8192, v220
    v_xor_b32 v221, 8192, v221
    s_barrier
    ds_read_b64_tr_b16 v[128:129], v218 offset:0
    ds_read_b64_tr_b16 v[130:131], v219 offset:0
    ds_read_b64_tr_b16 v[160:161], v220 offset:32768
    ds_read_b64_tr_b16 v[162:163], v221 offset:32768
    s_waitcnt lgkmcnt(8)
    v_mfma_f32_32x32x16_bf16 v[48:63], v[120:123], v[152:155], v[48:63]
    ds_read_b64_tr_b16 v[132:133], v218 offset:2048
    ds_read_b64_tr_b16 v[134:135], v219 offset:2048
    ds_read_b64_tr_b16 v[164:165], v220 offset:34816
    ds_read_b64_tr_b16 v[166:167], v221 offset:34816
    s_waitcnt lgkmcnt(8)
    v_mfma_f32_32x32x16_bf16 v[48:63], v[124:127], v[156:159], v[48:63]
    ds_read_b64_tr_b16 v[136:137], v218 offset:4096
    ds_read_b64_tr_b16 v[138:139], v219 offset:4096
    ds_read_b64_tr_b16 v[168:169], v220 offset:36864
    ds_read_b64_tr_b16 v[170:171], v221 offset:36864
    s_waitcnt lgkmcnt(8)
    v_mfma_f32_32x32x16_bf16 v[48:63], v[128:131], v[160:163], v[48:63]
    ds_read_b64_tr_b16 v[140:141], v218 offset:6144
    ds_read_b64_tr_b16 v[142:143], v219 offset:6144
    ds_read_b64_tr_b16 v[172:173], v220 offset:38912
    ds_read_b64_tr_b16 v[174:175], v221 offset:38912
    s_waitcnt lgkmcnt(8)
    v_mfma_f32_32x32x16_bf16 v[48:63], v[132:135], v[164:167], v[48:63]
    v_permlane16_swap_b32 v176, v178
    v_permlane16_swap_b32 v177, v179
    s_waitcnt lgkmcnt(4)
    v_mfma_f32_32x32x16_bf16 v[48:63], v[136:139], v[168:171], v[48:63]
    v_permlane16_swap_b32 v180, v182
    v_permlane16_swap_b32 v181, v183
    v_permlane16_swap_b32 v184, v186
    s_waitcnt lgkmcnt(0)
    v_mfma_f32_32x32x16_bf16 v[48:63], v[140:143], v[172:175], v[48:63]
    s_barrier
    v_permlane16_swap_b32 v185, v187
    v_permlane16_swap_b32 v188, v190
    v_permlane16_swap_b32 v189, v191
    s_lshl_b32 s76, s62, 11
    s_add_u32 s76, s76, s99
    v_mfma_f32_32x32x16_bf16 v[16:31], v[204:207], v[176:179], 0
    s_add_u32 s76, s76, 1024
    s_lshl_b32 s77, s62, 7
    s_add_u32 s77, s77, s73
    v_lshlrev_b32_e64 v4, 2, v2
    v_mfma_f32_32x32x16_bf16 v[32:47], v[204:207], v[184:187], 0
    v_cvt_pk_bf16_f32 v64, v48, v49
    v_cvt_pk_bf16_f32 v65, v50, v51
    v_cvt_pk_bf16_f32 v66, v52, v53
    v_cvt_pk_bf16_f32 v67, v54, v55
    v_cvt_pk_bf16_f32 v68, v56, v57
    v_mfma_f32_32x32x16_bf16 v[16:31], v[208:211], v[180:183], v[16:31]
    v_cvt_pk_bf16_f32 v69, v58, v59
    v_cvt_pk_bf16_f32 v70, v60, v61
    v_cvt_pk_bf16_f32 v71, v62, v63
    s_bitcmp1_b32 s100, 0
    s_cbranch_scc1 L_loc_59
    buffer_store_dwordx4 v[64:67], v12, s[40:43], s76 offen offset:0 sc1
    buffer_store_dwordx4 v[68:71], v12, s[40:43], s76 offen offset:1024 sc1
    s_branch L_pubd_60
L_loc_59:
    buffer_store_dwordx4 v[64:67], v12, s[40:43], s76 offen offset:0
    buffer_store_dwordx4 v[68:71], v12, s[40:43], s76 offen offset:1024
L_pubd_60:
    v_mfma_f32_32x32x16_bf16 v[32:47], v[208:211], v[188:191], v[32:47]
    v_and_b32 v216, 1, v1
    v_lshlrev_b32_e64 v216, 8, v216
    v_lshl_add_u32 v216, v3, 4, v216
    s_lshl_b32 s76, s64, 7
    v_add_u32 v216, s76, v216
    s_mul_i32 s78, s61, 28800
    s_lshl_b32 s79, s64, 8
    s_add_u32 s78, s78, s79
    s_add_u32 s79, s78, 3686400
    v_dot2_f32_bf16 v72, v112, s89, 0
    v_dot2_f32_bf16 v73, v113, s89, 0
    v_dot2_f32_bf16 v72, v114, s89, v72
    v_dot2_f32_bf16 v73, v115, s89, v73
    v_dot2_f32_bf16 v72, v116, s89, v72
    v_dot2_f32_bf16 v73, v117, s89, v73
    v_dot2_f32_bf16 v72, v118, s89, v72
    v_dot2_f32_bf16 v73, v119, s89, v73
    v_dot2_f32_bf16 v72, v120, s89, v72
    v_dot2_f32_bf16 v73, v121, s89, v73
    v_dot2_f32_bf16 v72, v122, s89, v72
    v_dot2_f32_bf16 v73, v123, s89, v73
    v_dot2_f32_bf16 v72, v124, s89, v72
    v_dot2_f32_bf16 v73, v125, s89, v73
    v_dot2_f32_bf16 v72, v126, s89, v72
    v_dot2_f32_bf16 v73, v127, s89, v73
    v_dot2_f32_bf16 v72, v128, s89, v72
    v_dot2_f32_bf16 v73, v129, s89, v73
    v_dot2_f32_bf16 v72, v130, s89, v72
    v_dot2_f32_bf16 v73, v131, s89, v73
    v_dot2_f32_bf16 v72, v132, s89, v72
    v_dot2_f32_bf16 v73, v133, s89, v73
    v_dot2_f32_bf16 v72, v134, s89, v72
    v_dot2_f32_bf16 v73, v135, s89, v73
    v_dot2_f32_bf16 v72, v136, s89, v72
    v_dot2_f32_bf16 v73, v137, s89, v73
    v_dot2_f32_bf16 v72, v138, s89, v72
    v_dot2_f32_bf16 v73, v139, s89, v73
    v_dot2_f32_bf16 v72, v140, s89, v72
    v_dot2_f32_bf16 v73, v141, s89, v73
    v_dot2_f32_bf16 v72, v142, s89, v72
    v_dot2_f32_bf16 v73, v143, s89, v73
    s_lshl_b32 s76, s98, 7
    v_lshl_add_u32 v10, v3, 3, s76
    v_lshlrev_b32 v11, 5, v1
    v_add_f32 v72, v72, v73
    v_mov_b32 v73, v72
    s_nop 1
    v_permlane32_swap_b32 v72, v73
    v_add_f32 v72, v72, v73
    s_mov_b32 exec_hi, 0
    s_bitcmp1_b32 s100, 0
    s_cbranch_scc1 L_loc_61
    buffer_store_dword v72, v4, s[40:43], s77 offen offset:2048 sc1
    s_branch L_pubd_62
L_loc_61:
    buffer_store_dword v72, v4, s[40:43], s77 offen offset:2048
L_pubd_62:
    s_mov_b64 exec, -1
    v_max3_f32 v160, v16, v17, v18
    v_min3_f32 v162, v16, v17, v18
    v_max3_f32 v160, v160, v19, v20
    v_min3_f32 v162, v162, v19, v20
    v_max3_f32 v160, v160, v21, v22
    v_min3_f32 v162, v162, v21, v22
    v_max3_f32 v160, v160, v23, v24
    v_min3_f32 v162, v162, v23, v24
    v_max3_f32 v160, v160, v25, v26
    v_min3_f32 v162, v162, v25, v26
    v_max3_f32 v160, v160, v27, v28
    v_min3_f32 v162, v162, v27, v28
    v_max3_f32 v160, v160, v29, v30
    v_min3_f32 v162, v162, v29, v30
    v_max_f32 v160, v160, v31
    v_min_f32 v162, v162, v31
    v_max3_f32 v164, v32, v33, v34
    v_min3_f32 v166, v32, v33, v34
    v_max3_f32 v164, v164, v35, v36
    v_min3_f32 v166, v166, v35, v36
    v_max3_f32 v164, v164, v37, v38
    v_min3_f32 v166, v166, v37, v38
    v_max3_f32 v164, v164, v39, v40
    v_min3_f32 v166, v166, v39, v40
    v_max3_f32 v164, v164, v41, v42
    v_min3_f32 v166, v166, v41, v42
    v_max3_f32 v164, v164, v43, v44
    v_min3_f32 v166, v166, v43, v44
    v_max3_f32 v164, v164, v45, v46
    v_min3_f32 v166, v166, v45, v46
    v_max_f32 v164, v164, v47
    v_min_f32 v166, v166, v47
    v_mov_b32 v161, v160
    v_mov_b32 v163, v162
    v_mov_b32 v165, v164
    v_mov_b32 v167, v166
    v_permlane32_swap_b32 v160, v161
    v_permlane32_swap_b32 v162, v163
    v_permlane32_swap_b32 v164, v165
    v_permlane32_swap_b32 v166, v167
    v_max_f32 v160, v160, v161
    v_min_f32 v162, v162, v163
    v_max_f32 v164, v164, v165
    v_min_f32 v166, v166, v167
    v_mul_f32 v160, v160, v251
    v_mul_f32 v162, v162, v251
    v_mul_f32 v164, v164, v253
    v_mul_f32 v166, v166, v253
    v_pk_fma_f32 v[128:129], v[16:17], v[250:251], v[160:161] op_sel:[0,1,0] op_sel_hi:[1,1,0] neg_lo:[0,0,1] neg_hi:[0,0,1]
    v_pk_fma_f32 v[16:17], v[16:17], v[250:251], v[162:163] op_sel:[0,1,0] op_sel_hi:[1,1,0] neg_lo:[0,1,0] neg_hi:[0,1,0]
    v_pk_fma_f32 v[130:131], v[18:19], v[250:251], v[160:161] op_sel:[0,1,0] op_sel_hi:[1,1,0] neg_lo:[0,0,1] neg_hi:[0,0,1]
    v_pk_fma_f32 v[18:19], v[18:19], v[250:251], v[162:163] op_sel:[0,1,0] op_sel_hi:[1,1,0] neg_lo:[0,1,0] neg_hi:[0,1,0]
    v_pk_fma_f32 v[132:133], v[20:21], v[250:251], v[160:161] op_sel:[0,1,0] op_sel_hi:[1,1,0] neg_lo:[0,0,1] neg_hi:[0,0,1]
    v_pk_fma_f32 v[20:21], v[20:21], v[250:251], v[162:163] op_sel:[0,1,0] op_sel_hi:[1,1,0] neg_lo:[0,1,0] neg_hi:[0,1,0]
    v_pk_fma_f32 v[134:135], v[22:23], v[250:251], v[160:161] op_sel:[0,1,0] op_sel_hi:[1,1,0] neg_lo:[0,0,1] neg_hi:[0,0,1]
    v_pk_fma_f32 v[22:23], v[22:23], v[250:251], v[162:163] op_sel:[0,1,0] op_sel_hi:[1,1,0] neg_lo:[0,1,0] neg_hi:[0,1,0]
    v_pk_fma_f32 v[136:137], v[24:25], v[250:251], v[160:161] op_sel:[0,1,0] op_sel_hi:[1,1,0] neg_lo:[0,0,1] neg_hi:[0,0,1]
    v_pk_fma_f32 v[24:25], v[24:25], v[250:251], v[162:163] op_sel:[0,1,0] op_sel_hi:[1,1,0] neg_lo:[0,1,0] neg_hi:[0,1,0]
    v_pk_fma_f32 v[138:139], v[26:27], v[250:251], v[160:161] op_sel:[0,1,0] op_sel_hi:[1,1,0] neg_lo:[0,0,1] neg_hi:[0,0,1]
    v_pk_fma_f32 v[26:27], v[26:27], v[250:251], v[162:163] op_sel:[0,1,0] op_sel_hi:[1,1,0] neg_lo:[0,1,0] neg_hi:[0,1,0]
    v_pk_fma_f32 v[140:141], v[28:29], v[250:251], v[160:161] op_sel:[0,1,0] op_sel_hi:[1,1,0] neg_lo:[0,0,1] neg_hi:[0,0,1]
    v_pk_fma_f32 v[28:29], v[28:29], v[250:251], v[162:163] op_sel:[0,1,0] op_sel_hi:[1,1,0] neg_lo:[0,1,0] neg_hi:[0,1,0]
    v_pk_fma_f32 v[142:143], v[30:31], v[250:251], v[160:161] op_sel:[0,1,0] op_sel_hi:[1,1,0] neg_lo:[0,0,1] neg_hi:[0,0,1]
    v_pk_fma_f32 v[30:31], v[30:31], v[250:251], v[162:163] op_sel:[0,1,0] op_sel_hi:[1,1,0] neg_lo:[0,1,0] neg_hi:[0,1,0]
    v_pk_fma_f32 v[144:145], v[32:33], v[252:253], v[164:165] op_sel:[0,1,0] op_sel_hi:[1,1,0] neg_lo:[0,0,1] neg_hi:[0,0,1]
    v_pk_fma_f32 v[32:33], v[32:33], v[252:253], v[166:167] op_sel:[0,1,0] op_sel_hi:[1,1,0] neg_lo:[0,1,0] neg_hi:[0,1,0]
    v_pk_fma_f32 v[146:147], v[34:35], v[252:253], v[164:165] op_sel:[0,1,0] op_sel_hi:[1,1,0] neg_lo:[0,0,1] neg_hi:[0,0,1]
    v_pk_fma_f32 v[34:35], v[34:35], v[252:253], v[166:167] op_sel:[0,1,0] op_sel_hi:[1,1,0] neg_lo:[0,1,0] neg_hi:[0,1,0]
    v_pk_fma_f32 v[148:149], v[36:37], v[252:253], v[164:165] op_sel:[0,1,0] op_sel_hi:[1,1,0] neg_lo:[0,0,1] neg_hi:[0,0,1]
    v_pk_fma_f32 v[36:37], v[36:37], v[252:253], v[166:167] op_sel:[0,1,0] op_sel_hi:[1,1,0] neg_lo:[0,1,0] neg_hi:[0,1,0]
    v_pk_fma_f32 v[150:151], v[38:39], v[252:253], v[164:165] op_sel:[0,1,0] op_sel_hi:[1,1,0] neg_lo:[0,0,1] neg_hi:[0,0,1]
    v_pk_fma_f32 v[38:39], v[38:39], v[252:253], v[166:167] op_sel:[0,1,0] op_sel_hi:[1,1,0] neg_lo:[0,1,0] neg_hi:[0,1,0]
    v_pk_fma_f32 v[152:153], v[40:41], v[252:253], v[164:165] op_sel:[0,1,0] op_sel_hi:[1,1,0] neg_lo:[0,0,1] neg_hi:[0,0,1]
    v_pk_fma_f32 v[40:41], v[40:41], v[252:253], v[166:167] op_sel:[0,1,0] op_sel_hi:[1,1,0] neg_lo:[0,1,0] neg_hi:[0,1,0]
    v_pk_fma_f32 v[154:155], v[42:43], v[252:253], v[164:165] op_sel:[0,1,0] op_sel_hi:[1,1,0] neg_lo:[0,0,1] neg_hi:[0,0,1]
    v_pk_fma_f32 v[42:43], v[42:43], v[252:253], v[166:167] op_sel:[0,1,0] op_sel_hi:[1,1,0] neg_lo:[0,1,0] neg_hi:[0,1,0]
    v_pk_fma_f32 v[156:157], v[44:45], v[252:253], v[164:165] op_sel:[0,1,0] op_sel_hi:[1,1,0] neg_lo:[0,0,1] neg_hi:[0,0,1]
    v_pk_fma_f32 v[44:45], v[44:45], v[252:253], v[166:167] op_sel:[0,1,0] op_sel_hi:[1,1,0] neg_lo:[0,1,0] neg_hi:[0,1,0]
    v_pk_fma_f32 v[158:159], v[46:47], v[252:253], v[164:165] op_sel:[0,1,0] op_sel_hi:[1,1,0] neg_lo:[0,0,1] neg_hi:[0,0,1]
    v_pk_fma_f32 v[46:47], v[46:47], v[252:253], v[166:167] op_sel:[0,1,0] op_sel_hi:[1,1,0] neg_lo:[0,1,0] neg_hi:[0,1,0]
    v_exp_f32 v128, v128
    v_exp_f32 v16, v16
    v_exp_f32 v129, v129
    v_exp_f32 v17, v17
    v_exp_f32 v130, v130
    v_exp_f32 v18, v18
    v_exp_f32 v131, v131
    v_exp_f32 v19, v19
    v_exp_f32 v132, v132
    v_exp_f32 v20, v20
    v_exp_f32 v133, v133
    v_exp_f32 v21, v21
    v_exp_f32 v134, v134
    v_exp_f32 v22, v22
    v_exp_f32 v135, v135
    v_exp_f32 v23, v23
    v_exp_f32 v136, v136
    v_exp_f32 v24, v24
    v_exp_f32 v137, v137
    v_exp_f32 v25, v25
    v_exp_f32 v138, v138
    v_exp_f32 v26, v26
    v_exp_f32 v139, v139
    v_exp_f32 v27, v27
    v_exp_f32 v140, v140
    v_exp_f32 v28, v28
    v_exp_f32 v141, v141
    v_exp_f32 v29, v29
    v_exp_f32 v142, v142
    v_exp_f32 v30, v30
    v_exp_f32 v143, v143
    v_exp_f32 v31, v31
    v_cvt_pk_bf16_f32 v218, v128, v129
    v_cvt_pk_bf16_f32 v219, v130, v131
    v_cvt_pk_bf16_f32 v220, v132, v133
    v_cvt_pk_bf16_f32 v221, v134, v135
    v_cvt_pk_bf16_f32 v222, v136, v137
    v_cvt_pk_bf16_f32 v223, v138, v139
    v_cvt_pk_bf16_f32 v224, v140, v141
    v_cvt_pk_bf16_f32 v225, v142, v143
    v_cvt_pk_bf16_f32 v226, v16, v17
    v_cvt_pk_bf16_f32 v227, v18, v19
    v_cvt_pk_bf16_f32 v228, v20, v21
    v_cvt_pk_bf16_f32 v229, v22, v23
    v_cvt_pk_bf16_f32 v230, v24, v25
    v_cvt_pk_bf16_f32 v231, v26, v27
    v_cvt_pk_bf16_f32 v232, v28, v29
    v_cvt_pk_bf16_f32 v233, v30, v31
    v_exp_f32 v144, v144
    v_exp_f32 v32, v32
    v_exp_f32 v145, v145
    v_exp_f32 v33, v33
    v_exp_f32 v146, v146
    v_exp_f32 v34, v34
    v_exp_f32 v147, v147
    v_exp_f32 v35, v35
    v_exp_f32 v148, v148
    v_exp_f32 v36, v36
    v_exp_f32 v149, v149
    v_exp_f32 v37, v37
    v_exp_f32 v150, v150
    v_exp_f32 v38, v38
    v_exp_f32 v151, v151
    v_exp_f32_e64 v39, v39
    s_barrier
    buffer_load_dwordx4 v[48:51], v13, s[40:43], s78 offen offset:3072 sc1
    buffer_load_dwordx4 v[52:55], v13, s[40:43], s79 offen offset:3072 sc1
    buffer_load_dwordx4 v[56:59], v13, s[40:43], s78 offen offset:3200 sc1
    buffer_load_dwordx4 v[60:63], v13, s[40:43], s79 offen offset:3200 sc1
    ds_read_b128 v[168:171], v216 offset:24576
    ds_read_b128 v[172:175], v216 offset:24608
    ds_read_b128 v[176:179], v216 offset:24640
    ds_read_b128 v[180:183], v216 offset:24672
    v_exp_f32 v152, v152
    v_exp_f32 v40, v40
    v_exp_f32 v153, v153
    v_exp_f32 v41, v41
    v_exp_f32 v154, v154
    v_exp_f32 v42, v42
    v_exp_f32 v155, v155
    v_exp_f32 v43, v43
    v_exp_f32 v156, v156
    v_exp_f32_e64 v44, v44
    s_waitcnt lgkmcnt(0)
    v_mfma_f32_32x32x16_bf16 v[64:79], v[168:171], v[218:221], 0
    v_exp_f32 v157, v157
    v_exp_f32 v45, v45
    v_exp_f32_e64 v158, v158
    v_mfma_f32_32x32x16_bf16 v[80:95], v[176:179], v[226:229], 0
    v_exp_f32 v46, v46
    v_exp_f32 v159, v159
    v_exp_f32_e64 v47, v47
    v_mfma_f32_32x32x16_bf16 v[64:79], v[172:175], v[222:225], v[64:79]
    v_cvt_pk_bf16_f32 v234, v144, v145
    v_cvt_pk_bf16_f32 v235, v146, v147
    v_cvt_pk_bf16_f32 v236, v148, v149
    v_cvt_pk_bf16_f32 v237, v150, v151
    v_cvt_pk_bf16_f32 v238, v152, v153
    v_cvt_pk_bf16_f32 v239, v154, v155
    v_mfma_f32_32x32x16_bf16 v[80:95], v[180:183], v[230:233], v[80:95]
    v_cvt_pk_bf16_f32 v240, v156, v157
    v_cvt_pk_bf16_f32 v241, v158, v159
    v_cvt_pk_bf16_f32 v242, v32, v33
    v_cvt_pk_bf16_f32 v243, v34, v35
    v_cvt_pk_bf16_f32 v244, v36, v37
    v_cvt_pk_bf16_f32 v245, v38, v39
    v_cvt_pk_bf16_f32 v246, v40, v41
    v_cvt_pk_bf16_f32 v247, v42, v43
    v_cvt_pk_bf16_f32 v248, v44, v45
    v_cvt_pk_bf16_f32 v249, v46, v47
    v_mfma_f32_32x32x16_bf16 v[96:111], v[168:171], v[234:237], 0
    v_rcp_f32 v184, v65
    v_rcp_f32 v185, v81
    v_mul_f32 v6, v64, v184
    v_fmac_f32 v6, v80, v185
    v_add_f32 v6, 0x358637bd, v6
    v_mfma_f32_32x32x16_bf16 v[112:127], v[176:179], v[242:245], 0
    v_rcp_f32 v6, v6
    v_mov_b32 v8, 0
    v_mul_f32 v184, v184, v6
    v_mul_f32_e64 v185, v185, v6
    s_lshl4_add_u32 s76, s60, s61
    v_mfma_f32_32x32x16_bf16 v[96:111], v[172:175], v[238:241], v[96:111]
    s_mul_i32 s76, s76, 32768
    s_lshl2_add_u32 s77, s63, s64
    s_lshl_b32 s77, s77, 12
    s_add_u32 s76, s76, s77
    s_add_u32 s76, s76, 16777216
    v_mfma_f32_32x32x16_bf16 v[112:127], v[180:183], v[246:249], v[112:127]
    s_add_u32 s77, s76, 8192
    v_add_u32 v14, 128, v12
    v_cmp_gt_u32 vcc, 24, v1
    s_nop 0
    s_nop 0
    v_cndmask_b32_e64 v14, v14, v12, vcc
    s_mov_b32 s88, 0
    s_branch L_pfirst_64
L_poll_63:
    buffer_load_dwordx4 v[48:51], v13, s[40:43], s78 offen offset:3072 sc1
    buffer_load_dwordx4 v[52:55], v13, s[40:43], s79 offen offset:3072 sc1
    buffer_load_dwordx4 v[56:59], v13, s[40:43], s78 offen offset:3200 sc1
    buffer_load_dwordx4 v[60:63], v13, s[40:43], s79 offen offset:3200 sc1
L_pfirst_64:
    s_waitcnt vmcnt(0)
    v_max3_u32 v9, v48, v49, v50
    v_max3_u32 v9, v9, v51, v52
    v_max3_u32 v9, v9, v53, v54
    v_max3_u32 v9, v9, v55, v56
    v_max3_u32 v9, v9, v57, v58
    v_max3_u32 v9, v9, v59, v60
    v_max3_u32 v9, v9, v61, v62
    v_max_u32 v9, v9, v63
    v_cmp_eq_u32 vcc, -1, v9
    s_nop 0
    s_cbranch_vccz L_ok_65
    s_add_u32 s88, s88, 1
    s_cmp_lt_u32 s88, 65536
    s_cbranch_scc1 L_poll_63
L_ok_65:
    v_mfma_f32_32x32x16_bf16 v[16:31], v[48:51], v[218:221], 0
    s_barrier
    v_rcp_f32 v186, v97
    v_rcp_f32 v187, v113
    v_mul_f32_e64 v7, v96, v186
    v_mfma_f32_32x32x16_bf16 v[128:143], v[56:59], v[226:229], 0
    v_fmac_f32_e64 v7, v112, v187
    v_add_f32 v7, 0x358637bd, v7
    v_rcp_f32_e64 v7, v7
    v_bfe_u32 v4, v2, 1, 3
    v_lshlrev_b32_e64 v4, 4, v4
    v_mfma_f32_32x32x16_bf16 v[16:31], v[52:55], v[222:225], v[16:31]
    v_mov_b32 v8, 0
    v_mul_f32 v186, v186, v7
    v_mul_f32_e64 v187, v187, v7
    v_lshl_add_u32 v4, v3, 3, v4
    v_lshl_add_u32 v4, v2, 7, v4
    s_lshl_b32 s56, s62, 12
    v_mfma_f32_32x32x16_bf16 v[128:143], v[60:63], v[230:233], v[128:143]
    s_add_u32 s57, s56, 0
    v_add_u32 v64, s57, v4
    v_xor_b32 v65, 16, v64
    v_xor_b32 v66, 32, v64
    v_xor_b32 v67, 48, v64
    v_xor_b32_e64 v68, 64, v64
    v_mfma_f32_32x32x16_bf16 v[32:47], v[48:51], v[234:237], 0
    v_xor_b32 v69, 80, v64
    v_xor_b32 v70, 96, v64
    v_xor_b32 v71, 112, v64
    v_bfe_u32 v4, v1, 2, 2
    v_lshl_add_u32 v5, v3, 2, v4
    v_lshlrev_b32 v5, 7, v5
    s_bitcmp1_b32 s100, 2
    v_mfma_f32_32x32x16_bf16 v[144:159], v[56:59], v[242:245], 0
    v_mul_f32 v16, v16, v184
    v_mul_f32 v17, v17, v184
    v_mul_f32 v18, v18, v184
    v_mul_f32 v19, v19, v184
    v_mul_f32 v20, v20, v184
    v_mul_f32 v21, v21, v184
    v_mfma_f32_32x32x16_bf16 v[32:47], v[52:55], v[238:241], v[32:47]
    v_mul_f32 v22, v22, v184
    v_mul_f32 v23, v23, v184
    v_mul_f32 v24, v24, v184
    v_mul_f32 v25, v25, v184
    v_mul_f32 v26, v26, v184
    v_mul_f32 v27, v27, v184
    v_mfma_f32_32x32x16_bf16 v[144:159], v[60:63], v[246:249], v[144:159]
    v_mul_f32 v28, v28, v184
    v_mul_f32 v29, v29, v184
    v_mul_f32 v30, v30, v184
    v_mul_f32 v31, v31, v184
    v_fmac_f32 v16, v128, v185
    v_fmac_f32 v17, v129, v185
    v_cvt_pk_bf16_f32 v96, v16, v17
    v_fmac_f32 v18, v130, v185
    v_fmac_f32 v19, v131, v185
    v_cvt_pk_bf16_f32 v97, v18, v19
    v_fmac_f32 v20, v132, v185
    v_fmac_f32 v21, v133, v185
    v_cvt_pk_bf16_f32 v98, v20, v21
    v_fmac_f32 v22, v134, v185
    v_fmac_f32 v23, v135, v185
    v_cvt_pk_bf16_f32 v99, v22, v23
    buffer_store_dwordx4 v[96:99], v14, s[40:43], s76 offen offset:0 sc1
    v_fmac_f32 v24, v136, v185
    v_fmac_f32 v25, v137, v185
    v_cvt_pk_bf16_f32 v100, v24, v25
    v_fmac_f32 v26, v138, v185
    v_fmac_f32 v27, v139, v185
    v_cvt_pk_bf16_f32 v101, v26, v27
    v_fmac_f32 v28, v140, v185
    v_fmac_f32 v29, v141, v185
    v_cvt_pk_bf16_f32 v102, v28, v29
    v_fmac_f32 v30, v142, v185
    v_fmac_f32 v31, v143, v185
    v_cvt_pk_bf16_f32 v103, v30, v31
    buffer_store_dwordx4 v[100:103], v14, s[40:43], s76 offen offset:2048 sc1
    v_pk_mul_f32 v[32:33], v[32:33], v[186:187] op_sel_hi:[1,0]
    v_pk_fma_f32 v[32:33], v[144:145], v[186:187], v[32:33] op_sel:[0,1,0] op_sel_hi:[1,1,1]
    v_cvt_pk_bf16_f32 v104, v32, v33
    v_pk_mul_f32 v[34:35], v[34:35], v[186:187] op_sel_hi:[1,0]
    v_pk_fma_f32 v[34:35], v[146:147], v[186:187], v[34:35] op_sel:[0,1,0] op_sel_hi:[1,1,1]
    v_cvt_pk_bf16_f32 v105, v34, v35
    v_pk_mul_f32 v[36:37], v[36:37], v[186:187] op_sel_hi:[1,0]
    v_pk_fma_f32 v[36:37], v[148:149], v[186:187], v[36:37] op_sel:[0,1,0] op_sel_hi:[1,1,1]
    v_cvt_pk_bf16_f32 v106, v36, v37
    v_pk_mul_f32 v[38:39], v[38:39], v[186:187] op_sel_hi:[1,0]
    v_pk_fma_f32 v[38:39], v[150:151], v[186:187], v[38:39] op_sel:[0,1,0] op_sel_hi:[1,1,1]
    v_cvt_pk_bf16_f32 v107, v38, v39
    buffer_store_dwordx4 v[104:107], v14, s[40:43], s77 offen offset:0 sc1
    v_pk_mul_f32 v[40:41], v[40:41], v[186:187] op_sel_hi:[1,0]
    v_pk_fma_f32 v[40:41], v[152:153], v[186:187], v[40:41] op_sel:[0,1,0] op_sel_hi:[1,1,1]
    v_cvt_pk_bf16_f32 v108, v40, v41
    v_pk_mul_f32 v[42:43], v[42:43], v[186:187] op_sel_hi:[1,0]
    v_pk_fma_f32 v[42:43], v[154:155], v[186:187], v[42:43] op_sel:[0,1,0] op_sel_hi:[1,1,1]
    v_cvt_pk_bf16_f32 v109, v42, v43
    v_pk_mul_f32 v[44:45], v[44:45], v[186:187] op_sel_hi:[1,0]
    v_pk_fma_f32 v[44:45], v[156:157], v[186:187], v[44:45] op_sel:[0,1,0] op_sel_hi:[1,1,1]
    v_cvt_pk_bf16_f32 v110, v44, v45
    v_pk_mul_f32 v[46:47], v[46:47], v[186:187] op_sel_hi:[1,0]
    v_pk_fma_f32 v[46:47], v[158:159], v[186:187], v[46:47] op_sel:[0,1,0] op_sel_hi:[1,1,1]
    v_cvt_pk_bf16_f32 v111, v46, v47
    buffer_store_dwordx4 v[108:111], v14, s[40:43], s77 offen offset:2048 sc1
    v_lshrrev_b32_e64 v4, 1, v4
    v_lshl_add_u32 v5, v4, 6, v5
    v_bfe_u32 v4, v1, 4, 1
    v_lshl_add_u32 v5, v4, 5, v5
    v_and_b32_e64 v4, 3, v1
    v_lshl_add_u32 v5, v4, 3, v5
    v_add_u32 v72, 32768, v5
    v_xor_b32_e64 v73, 64, v72
    s_mul_i32 s80, s97, 524288
    s_mul_i32 s56, s62, 8192
    s_add_u32 s80, s80, s56
    s_add_u32 s80, s80, 16777216
    v_add_u32 v78, 4096, v14
    v_mov_b32 v74, 1
    s_mov_b32 s52, 0xffff
    s_mov_b32 s53, 0
    s_barrier
    ds_read_b32 v79, v8 offset:25984
    ds_read_b64 v[88:89], v64
    ds_read_b64 v[90:91], v65
    ds_read_b64 v[92:93], v66
    ds_read_b64 v[94:95], v67
    ds_read_b64 v[96:97], v68
    ds_read_b64 v[98:99], v69
    ds_read_b64 v[100:101], v70
    ds_read_b64 v[102:103], v71
    s_waitcnt lgkmcnt(8)
    v_readfirstlane_b32 s76, v79
    s_nop 0
    s_and_b32 s76, s76, s52
    s_cbranch_scc0 L_tr0
L_bk0:
    s_ff1_i32_b32 s76, s76
    s_bitset0_b32 s52, s76
    s_add_u32 s77, s76, s65
    s_and_b32 s77, s77, 15
    s_mul_i32 s77, s77, 32768
    s_add_u32 s28, s77, s80
    s_add_u32 s76, s76, 3
    s_and_b32 s76, s76, 15
    s_lshl_b32 s4, s76, 13
    buffer_load_dwordx4 v[128:131], v14, s[40:43], s28 offen offset:0 sc1
    buffer_load_dwordx4 v[132:135], v14, s[40:43], s28 offen offset:2048 sc1
    buffer_load_dwordx4 v[136:139], v78, s[40:43], s28 offen offset:0 sc1
    buffer_load_dwordx4 v[140:143], v78, s[40:43], s28 offen offset:2048 sc1
    v_readfirstlane_b32 s76, v79
    s_nop 0
    s_and_b32 s76, s76, s52
    s_cbranch_scc0 L_tr1
L_bk1:
    s_ff1_i32_b32 s76, s76
    s_bitset0_b32 s52, s76
    s_add_u32 s77, s76, s65
    s_and_b32 s77, s77, 15
    s_mul_i32 s77, s77, 32768
    s_add_u32 s29, s77, s80
    s_add_u32 s76, s76, 3
    s_and_b32 s76, s76, 15
    s_lshl_b32 s5, s76, 13
    buffer_load_dwordx4 v[144:147], v14, s[40:43], s29 offen offset:0 sc1
    buffer_load_dwordx4 v[148:151], v14, s[40:43], s29 offen offset:2048 sc1
    v_add_u32 v80, s4, v72
    v_add_u32 v81, s4, v73
    s_waitcnt lgkmcnt(0)
    v_lshlrev_b32 v16, 16, v88
    v_and_b32 v17, s90, v88
    v_lshlrev_b32 v18, 16, v89
    v_and_b32 v19, s90, v89
    v_lshlrev_b32 v20, 16, v90
    v_and_b32 v21, s90, v90
    v_lshlrev_b32 v22, 16, v91
    v_and_b32 v23, s90, v91
    v_lshlrev_b32 v24, 16, v92
    v_and_b32 v25, s90, v92
    v_lshlrev_b32 v26, 16, v93
    v_and_b32 v27, s90, v93
    v_lshlrev_b32 v28, 16, v94
    v_and_b32 v29, s90, v94
    v_lshlrev_b32 v30, 16, v95
    v_and_b32 v31, s90, v95
    v_lshlrev_b32 v32, 16, v96
    v_and_b32 v33, s90, v96
    v_lshlrev_b32 v34, 16, v97
    v_and_b32 v35, s90, v97
    v_lshlrev_b32 v36, 16, v98
    v_and_b32 v37, s90, v98
    v_lshlrev_b32 v38, 16, v99
    v_and_b32 v39, s90, v99
    v_lshlrev_b32 v40, 16, v100
    v_and_b32 v41, s90, v100
    v_lshlrev_b32 v42, 16, v101
    v_and_b32 v43, s90, v101
    v_lshlrev_b32 v44, 16, v102
    v_and_b32 v45, s90, v102
    v_lshlrev_b32 v46, 16, v103
    v_and_b32 v47, s90, v103
    s_cmp_eq_u32 s53, 0
    s_cbranch_scc0 L_sent_66
    s_waitcnt vmcnt(6)
    s_mov_b64 exec, 1
    ds_add_u32 v8, v74 offset:25988
    s_mov_b64 exec, -1
    s_mov_b32 s53, 1
L_sent_66:
    ds_read_b32 v79, v8 offset:25984
    ds_read_b64_tr_b16 v[104:105], v80 offset:0
    ds_read_b64_tr_b16 v[106:107], v80 offset:1024
    ds_read_b64_tr_b16 v[108:109], v81 offset:0
    ds_read_b64_tr_b16 v[110:111], v81 offset:1024
    ds_read_b64_tr_b16 v[112:113], v80 offset:2048
    ds_read_b64_tr_b16 v[114:115], v80 offset:3072
    ds_read_b64_tr_b16 v[116:117], v81 offset:2048
    ds_read_b64_tr_b16 v[118:119], v81 offset:3072
    s_waitcnt vmcnt(5) lgkmcnt(4)
    v_mfma_f32_32x32x16_bf16 v[16:31], v[104:107], v[128:131], v[16:31]
    ds_read_b64_tr_b16 v[120:121], v80 offset:4096
    ds_read_b64_tr_b16 v[122:123], v80 offset:5120
    buffer_load_dwordx4 v[152:155], v78, s[40:43], s29 offen offset:0 sc1
    v_mfma_f32_32x32x16_bf16 v[32:47], v[108:111], v[128:131], v[32:47]
    ds_read_b64_tr_b16 v[124:125], v81 offset:4096
    ds_read_b64_tr_b16 v[126:127], v81 offset:5120
    buffer_load_dwordx4 v[156:159], v78, s[40:43], s29 offen offset:2048 sc1
    v_readfirstlane_b32 s76, v79
    s_nop 0
    s_and_b32 s76, s76, s52
    s_cbranch_scc0 L_tr2
L_bk2:
    s_ff1_i32_b32 s76, s76
    s_bitset0_b32 s52, s76
    s_add_u32 s77, s76, s65
    s_and_b32 s77, s77, 15
    s_mul_i32 s77, s77, 32768
    s_add_u32 s30, s77, s80
    s_waitcnt vmcnt(6) lgkmcnt(4)
    v_mfma_f32_32x32x16_bf16 v[16:31], v[112:115], v[132:135], v[16:31]
    ds_read_b32 v79, v8 offset:25984
    ds_read_b64_tr_b16 v[104:105], v80 offset:6144
    ds_read_b64_tr_b16 v[106:107], v80 offset:7168
    buffer_load_dwordx4 v[160:163], v14, s[40:43], s30 offen offset:0 sc1
    s_add_u32 s76, s76, 3
    s_and_b32 s76, s76, 15
    s_lshl_b32 s6, s76, 13
    v_mfma_f32_32x32x16_bf16 v[32:47], v[116:119], v[132:135], v[32:47]
    ds_read_b64_tr_b16 v[108:109], v81 offset:6144
    ds_read_b64_tr_b16 v[110:111], v81 offset:7168
    buffer_load_dwordx4 v[164:167], v14, s[40:43], s30 offen offset:2048 sc1
    v_add_u32 v82, s5, v72
    v_add_u32_e64 v83, s5, v73
    s_waitcnt vmcnt(7) lgkmcnt(4)
    v_mfma_f32_32x32x16_bf16 v[16:31], v[120:123], v[136:139], v[16:31]
    ds_read_b64_tr_b16 v[112:113], v82 offset:0
    ds_read_b64_tr_b16 v[114:115], v82 offset:1024
    buffer_load_dwordx4 v[168:171], v78, s[40:43], s30 offen offset:0 sc1
    v_mfma_f32_32x32x16_bf16 v[32:47], v[124:127], v[136:139], v[32:47]
    ds_read_b64_tr_b16 v[116:117], v83 offset:0
    ds_read_b64_tr_b16 v[118:119], v83 offset:1024
    buffer_load_dwordx4 v[172:175], v78, s[40:43], s30 offen offset:2048 sc1
    v_readfirstlane_b32 s76, v79
    s_nop 0
    s_and_b32 s76, s76, s52
    s_cbranch_scc0 L_tr3
L_bk3:
    s_ff1_i32_b32 s76, s76
    s_bitset0_b32 s52, s76
    s_add_u32 s77, s76, s65
    s_and_b32 s77, s77, 15
    s_mul_i32 s77, s77, 32768
    s_add_u32 s31, s77, s80
    s_waitcnt vmcnt(8) lgkmcnt(4)
    v_mfma_f32_32x32x16_bf16 v[16:31], v[104:107], v[140:143], v[16:31]
    ds_read_b32 v79, v8 offset:25984
    ds_read_b64_tr_b16 v[120:121], v82 offset:2048
    ds_read_b64_tr_b16 v[122:123], v82 offset:3072
    buffer_load_dwordx4 v[176:179], v14, s[40:43], s31 offen offset:0 sc1
    s_add_u32 s76, s76, 3
    s_and_b32 s76, s76, 15
    s_lshl_b32 s7, s76, 13
    v_mfma_f32_32x32x16_bf16 v[32:47], v[108:111], v[140:143], v[32:47]
    ds_read_b64_tr_b16 v[124:125], v83 offset:2048
    ds_read_b64_tr_b16 v[126:127], v83 offset:3072
    buffer_load_dwordx4 v[180:183], v14, s[40:43], s31 offen offset:2048 sc1
    s_waitcnt vmcnt(9) lgkmcnt(4)
    v_mfma_f32_32x32x16_bf16 v[16:31], v[112:115], v[144:147], v[16:31]
    ds_read_b64_tr_b16 v[104:105], v82 offset:4096
    ds_read_b64_tr_b16 v[106:107], v82 offset:5120
    buffer_load_dwordx4 v[184:187], v78, s[40:43], s31 offen offset:0 sc1
    v_mfma_f32_32x32x16_bf16 v[32:47], v[116:119], v[144:147], v[32:47]
    ds_read_b64_tr_b16 v[108:109], v83 offset:4096
    ds_read_b64_tr_b16 v[110:111], v83 offset:5120
    buffer_load_dwordx4 v[188:191], v78, s[40:43], s31 offen offset:2048 sc1
    v_readfirstlane_b32 s76, v79
    s_nop 0
    s_and_b32 s76, s76, s52
    s_cbranch_scc0 L_tr4
L_bk4:
    s_ff1_i32_b32 s76, s76
    s_bitset0_b32 s52, s76
    s_add_u32 s77, s76, s65
    s_and_b32 s77, s77, 15
    s_mul_i32 s77, s77, 32768
    s_add_u32 s32, s77, s80
    s_waitcnt vmcnt(10) lgkmcnt(4)
    v_mfma_f32_32x32x16_bf16 v[16:31], v[120:123], v[148:151], v[16:31]
    ds_read_b64_tr_b16 v[112:113], v82 offset:6144
    ds_read_b64_tr_b16 v[114:115], v82 offset:7168
    buffer_load_dwordx4 v[128:131], v14, s[40:43], s32 offen offset:0 sc1
    s_add_u32 s76, s76, 3
    s_and_b32 s76, s76, 15
    s_lshl_b32 s8, s76, 13
    v_mfma_f32_32x32x16_bf16 v[32:47], v[124:127], v[148:151], v[32:47]
    ds_read_b64_tr_b16 v[116:117], v83 offset:6144
    ds_read_b64_tr_b16 v[118:119], v83 offset:7168
    buffer_load_dwordx4 v[132:135], v14, s[40:43], s32 offen offset:2048 sc1
    v_add_u32 v80, s6, v72
    v_add_u32 v81, s6, v73
    s_waitcnt vmcnt(11) lgkmcnt(4)
    v_mfma_f32_32x32x16_bf16 v[16:31], v[104:107], v[152:155], v[16:31]
    ds_read_b32 v79, v8 offset:25984
    ds_read_b64_tr_b16 v[120:121], v80 offset:0
    ds_read_b64_tr_b16 v[122:123], v80 offset:1024
    buffer_load_dwordx4 v[136:139], v78, s[40:43], s32 offen offset:0 sc1
    v_mfma_f32_32x32x16_bf16 v[32:47], v[108:111], v[152:155], v[32:47]
    ds_read_b64_tr_b16 v[124:125], v81 offset:0
    ds_read_b64_tr_b16 v[126:127], v81 offset:1024
    s_waitcnt vmcnt(11) lgkmcnt(4)
    v_mfma_f32_32x32x16_bf16 v[16:31], v[112:115], v[156:159], v[16:31]
    ds_read_b64_tr_b16 v[104:105], v80 offset:2048
    ds_read_b64_tr_b16 v[106:107], v80 offset:3072
    buffer_load_dwordx4 v[140:143], v78, s[40:43], s32 offen offset:2048 sc1
    v_mfma_f32_32x32x16_bf16 v[32:47], v[116:119], v[156:159], v[32:47]
    ds_read_b64_tr_b16 v[108:109], v81 offset:2048
    ds_read_b64_tr_b16 v[110:111], v81 offset:3072
    v_readfirstlane_b32 s76, v79
    s_nop 0
    s_and_b32 s76, s76, s52
    s_cbranch_scc0 L_tr5
L_bk5:
    s_ff1_i32_b32 s76, s76
    s_bitset0_b32 s52, s76
    s_add_u32 s77, s76, s65
    s_and_b32 s77, s77, 15
    s_mul_i32 s77, s77, 32768
    s_add_u32 s33, s77, s80
    s_waitcnt vmcnt(11) lgkmcnt(4)
    v_mfma_f32_32x32x16_bf16 v[16:31], v[120:123], v[160:163], v[16:31]
    ds_read_b64_tr_b16 v[112:113], v80 offset:4096
    ds_read_b64_tr_b16 v[114:115], v80 offset:5120
    buffer_load_dwordx4 v[144:147], v14, s[40:43], s33 offen offset:0 sc1
    s_add_u32 s76, s76, 3
    s_and_b32 s76, s76, 15
    s_lshl_b32 s9, s76, 13
    v_mfma_f32_32x32x16_bf16 v[32:47], v[124:127], v[160:163], v[32:47]
    ds_read_b64_tr_b16 v[116:117], v81 offset:4096
    ds_read_b64_tr_b16 v[118:119], v81 offset:5120
    s_waitcnt vmcnt(11) lgkmcnt(4)
    v_mfma_f32_32x32x16_bf16 v[16:31], v[104:107], v[164:167], v[16:31]
    ds_read_b64_tr_b16 v[120:121], v80 offset:6144
    ds_read_b64_tr_b16 v[122:123], v80 offset:7168
    buffer_load_dwordx4 v[148:151], v14, s[40:43], s33 offen offset:2048 sc1
    v_mfma_f32_32x32x16_bf16 v[32:47], v[108:111], v[164:167], v[32:47]
    ds_read_b64_tr_b16 v[124:125], v81 offset:6144
    ds_read_b64_tr_b16 v[126:127], v81 offset:7168
    v_add_u32 v82, s7, v72
    v_add_u32 v83, s7, v73
    s_waitcnt vmcnt(11) lgkmcnt(4)
    v_mfma_f32_32x32x16_bf16 v[16:31], v[112:115], v[168:171], v[16:31]
    ds_read_b32 v79, v8 offset:25984
    ds_read_b64_tr_b16 v[104:105], v82 offset:0
    ds_read_b64_tr_b16 v[106:107], v82 offset:1024
    buffer_load_dwordx4 v[152:155], v78, s[40:43], s33 offen offset:0 sc1
    v_mfma_f32_32x32x16_bf16 v[32:47], v[116:119], v[168:171], v[32:47]
    ds_read_b64_tr_b16 v[108:109], v83 offset:0
    ds_read_b64_tr_b16 v[110:111], v83 offset:1024
    s_waitcnt vmcnt(11) lgkmcnt(4)
    v_mfma_f32_32x32x16_bf16 v[16:31], v[120:123], v[172:175], v[16:31]
    ds_read_b64_tr_b16 v[112:113], v82 offset:2048
    ds_read_b64_tr_b16 v[114:115], v82 offset:3072
    buffer_load_dwordx4 v[156:159], v78, s[40:43], s33 offen offset:2048 sc1
    v_mfma_f32_32x32x16_bf16 v[32:47], v[124:127], v[172:175], v[32:47]
    ds_read_b64_tr_b16 v[116:117], v83 offset:2048
    ds_read_b64_tr_b16 v[118:119], v83 offset:3072
    v_readfirstlane_b32 s76, v79
    s_nop 0
    s_and_b32 s76, s76, s52
    s_cbranch_scc0 L_tr6
L_bk6:
    s_ff1_i32_b32 s76, s76
    s_bitset0_b32 s52, s76
    s_add_u32 s77, s76, s65
    s_and_b32 s77, s77, 15
    s_mul_i32 s77, s77, 32768
    s_add_u32 s34, s77, s80
    s_waitcnt vmcnt(11) lgkmcnt(4)
    v_mfma_f32_32x32x16_bf16 v[16:31], v[104:107], v[176:179], v[16:31]
    ds_read_b64_tr_b16 v[120:121], v82 offset:4096
    ds_read_b64_tr_b16 v[122:123], v82 offset:5120
    buffer_load_dwordx4 v[160:163], v14, s[40:43], s34 offen offset:0 sc1
    s_add_u32 s76, s76, 3
    s_and_b32 s76, s76, 15
    s_lshl_b32 s10, s76, 13
    v_mfma_f32_32x32x16_bf16 v[32:47], v[108:111], v[176:179], v[32:47]
    ds_read_b64_tr_b16 v[124:125], v83 offset:4096
    ds_read_b64_tr_b16 v[126:127], v83 offset:5120
    s_waitcnt vmcnt(11) lgkmcnt(4)
    v_mfma_f32_32x32x16_bf16 v[16:31], v[112:115], v[180:183], v[16:31]
    ds_read_b64_tr_b16 v[104:105], v82 offset:6144
    ds_read_b64_tr_b16 v[106:107], v82 offset:7168
    buffer_load_dwordx4 v[164:167], v14, s[40:43], s34 offen offset:2048 sc1
    v_mfma_f32_32x32x16_bf16 v[32:47], v[116:119], v[180:183], v[32:47]
    ds_read_b64_tr_b16 v[108:109], v83 offset:6144
    ds_read_b64_tr_b16 v[110:111], v83 offset:7168
    v_add_u32 v80, s8, v72
    v_add_u32 v81, s8, v73
    s_waitcnt vmcnt(11) lgkmcnt(4)
    v_mfma_f32_32x32x16_bf16 v[16:31], v[120:123], v[184:187], v[16:31]
    ds_read_b32 v79, v8 offset:25984
    ds_read_b64_tr_b16 v[112:113], v80 offset:0
    ds_read_b64_tr_b16 v[114:115], v80 offset:1024
    buffer_load_dwordx4 v[168:171], v78, s[40:43], s34 offen offset:0 sc1
    v_mfma_f32_32x32x16_bf16 v[32:47], v[124:127], v[184:187], v[32:47]
    ds_read_b64_tr_b16 v[116:117], v81 offset:0
    ds_read_b64_tr_b16 v[118:119], v81 offset:1024
    s_waitcnt vmcnt(11) lgkmcnt(4)
    v_mfma_f32_32x32x16_bf16 v[16:31], v[104:107], v[188:191], v[16:31]
    ds_read_b64_tr_b16 v[120:121], v80 offset:2048
    ds_read_b64_tr_b16 v[122:123], v80 offset:3072
    buffer_load_dwordx4 v[172:175], v78, s[40:43], s34 offen offset:2048 sc1
    v_mfma_f32_32x32x16_bf16 v[32:47], v[108:111], v[188:191], v[32:47]
    ds_read_b64_tr_b16 v[124:125], v81 offset:2048
    ds_read_b64_tr_b16 v[126:127], v81 offset:3072
    v_readfirstlane_b32 s76, v79
    s_nop 0
    s_and_b32 s76, s76, s52
    s_cbranch_scc0 L_tr7
L_bk7:
    s_ff1_i32_b32 s76, s76
    s_bitset0_b32 s52, s76
    s_add_u32 s77, s76, s65
    s_and_b32 s77, s77, 15
    s_mul_i32 s77, s77, 32768
    s_add_u32 s35, s77, s80
    s_waitcnt vmcnt(11) lgkmcnt(4)
    v_mfma_f32_32x32x16_bf16 v[16:31], v[112:115], v[128:131], v[16:31]
    ds_read_b64_tr_b16 v[104:105], v80 offset:4096
    ds_read_b64_tr_b16 v[106:107], v80 offset:5120
    buffer_load_dwordx4 v[176:179], v14, s[40:43], s35 offen offset:0 sc1
    s_add_u32 s76, s76, 3
    s_and_b32 s76, s76, 15
    s_lshl_b32 s11, s76, 13
    v_mfma_f32_32x32x16_bf16 v[32:47], v[116:119], v[128:131], v[32:47]
    ds_read_b64_tr_b16 v[108:109], v81 offset:4096
    ds_read_b64_tr_b16 v[110:111], v81 offset:5120
    s_waitcnt vmcnt(11) lgkmcnt(4)
    v_mfma_f32_32x32x16_bf16 v[16:31], v[120:123], v[132:135], v[16:31]
    ds_read_b64_tr_b16 v[112:113], v80 offset:6144
    ds_read_b64_tr_b16 v[114:115], v80 offset:7168
    buffer_load_dwordx4 v[180:183], v14, s[40:43], s35 offen offset:2048 sc1
    v_mfma_f32_32x32x16_bf16 v[32:47], v[124:127], v[132:135], v[32:47]
    ds_read_b64_tr_b16 v[116:117], v81 offset:6144
    ds_read_b64_tr_b16 v[118:119], v81 offset:7168
    v_add_u32 v82, s9, v72
    v_add_u32 v83, s9, v73
    s_waitcnt vmcnt(11) lgkmcnt(4)
    v_mfma_f32_32x32x16_bf16 v[16:31], v[104:107], v[136:139], v[16:31]
    ds_read_b32 v79, v8 offset:25984
    ds_read_b64_tr_b16 v[120:121], v82 offset:0
    ds_read_b64_tr_b16 v[122:123], v82 offset:1024
    buffer_load_dwordx4 v[184:187], v78, s[40:43], s35 offen offset:0 sc1
    v_mfma_f32_32x32x16_bf16 v[32:47], v[108:111], v[136:139], v[32:47]
    ds_read_b64_tr_b16 v[124:125], v83 offset:0
    ds_read_b64_tr_b16 v[126:127], v83 offset:1024
    s_waitcnt vmcnt(11) lgkmcnt(4)
    v_mfma_f32_32x32x16_bf16 v[16:31], v[112:115], v[140:143], v[16:31]
    ds_read_b64_tr_b16 v[104:105], v82 offset:2048
    ds_read_b64_tr_b16 v[106:107], v82 offset:3072
    buffer_load_dwordx4 v[188:191], v78, s[40:43], s35 offen offset:2048 sc1
    v_mfma_f32_32x32x16_bf16 v[32:47], v[116:119], v[140:143], v[32:47]
    ds_read_b64_tr_b16 v[108:109], v83 offset:2048
    ds_read_b64_tr_b16 v[110:111], v83 offset:3072
    v_readfirstlane_b32 s76, v79
    s_nop 0
    s_and_b32 s76, s76, s52
    s_cbranch_scc0 L_tr8
L_bk8:
    s_ff1_i32_b32 s76, s76
    s_bitset0_b32 s52, s76
    s_add_u32 s77, s76, s65
    s_and_b32 s77, s77, 15
    s_mul_i32 s77, s77, 32768
    s_add_u32 s36, s77, s80
    s_waitcnt vmcnt(11) lgkmcnt(4)
    v_mfma_f32_32x32x16_bf16 v[16:31], v[120:123], v[144:147], v[16:31]
    ds_read_b64_tr_b16 v[112:113], v82 offset:4096
    ds_read_b64_tr_b16 v[114:115], v82 offset:5120
    buffer_load_dwordx4 v[128:131], v14, s[40:43], s36 offen offset:0 sc1
    s_add_u32 s76, s76, 3
    s_and_b32 s76, s76, 15
    s_lshl_b32 s12, s76, 13
    v_mfma_f32_32x32x16_bf16 v[32:47], v[124:127], v[144:147], v[32:47]
    ds_read_b64_tr_b16 v[116:117], v83 offset:4096
    ds_read_b64_tr_b16 v[118:119], v83 offset:5120
    s_waitcnt vmcnt(11) lgkmcnt(4)
    v_mfma_f32_32x32x16_bf16 v[16:31], v[104:107], v[148:151], v[16:31]
    ds_read_b64_tr_b16 v[120:121], v82 offset:6144
    ds_read_b64_tr_b16 v[122:123], v82 offset:7168
    buffer_load_dwordx4 v[132:135], v14, s[40:43], s36 offen offset:2048 sc1
    v_mfma_f32_32x32x16_bf16 v[32:47], v[108:111], v[148:151], v[32:47]
    ds_read_b64_tr_b16 v[124:125], v83 offset:6144
    ds_read_b64_tr_b16 v[126:127], v83 offset:7168
    v_add_u32 v80, s10, v72
    v_add_u32 v81, s10, v73
    s_waitcnt vmcnt(11) lgkmcnt(4)
    v_mfma_f32_32x32x16_bf16 v[16:31], v[112:115], v[152:155], v[16:31]
    ds_read_b32 v79, v8 offset:25984
    ds_read_b64_tr_b16 v[104:105], v80 offset:0
    ds_read_b64_tr_b16 v[106:107], v80 offset:1024
    buffer_load_dwordx4 v[136:139], v78, s[40:43], s36 offen offset:0 sc1
    v_mfma_f32_32x32x16_bf16 v[32:47], v[116:119], v[152:155], v[32:47]
    ds_read_b64_tr_b16 v[108:109], v81 offset:0
    ds_read_b64_tr_b16 v[110:111], v81 offset:1024
    s_waitcnt vmcnt(11) lgkmcnt(4)
    v_mfma_f32_32x32x16_bf16 v[16:31], v[120:123], v[156:159], v[16:31]
    ds_read_b64_tr_b16 v[112:113], v80 offset:2048
    ds_read_b64_tr_b16 v[114:115], v80 offset:3072
    buffer_load_dwordx4 v[140:143], v78, s[40:43], s36 offen offset:2048 sc1
    v_mfma_f32_32x32x16_bf16 v[32:47], v[124:127], v[156:159], v[32:47]
    ds_read_b64_tr_b16 v[116:117], v81 offset:2048
    ds_read_b64_tr_b16 v[118:119], v81 offset:3072
    v_readfirstlane_b32 s76, v79
    s_nop 0
    s_and_b32 s76, s76, s52
    s_cbranch_scc0 L_tr9
L_bk9:
    s_ff1_i32_b32 s76, s76
    s_bitset0_b32 s52, s76
    s_add_u32 s77, s76, s65
    s_and_b32 s77, s77, 15
    s_mul_i32 s77, s77, 32768
    s_add_u32 s37, s77, s80
    s_waitcnt vmcnt(11) lgkmcnt(4)
    v_mfma_f32_32x32x16_bf16 v[16:31], v[104:107], v[160:163], v[16:31]
    ds_read_b64_tr_b16 v[120:121], v80 offset:4096
    ds_read_b64_tr_b16 v[122:123], v80 offset:5120
    buffer_load_dwordx4 v[144:147], v14, s[40:43], s37 offen offset:0 sc1
    s_add_u32 s76, s76, 3
    s_and_b32 s76, s76, 15
    s_lshl_b32 s13, s76, 13
    v_mfma_f32_32x32x16_bf16 v[32:47], v[108:111], v[160:163], v[32:47]
    ds_read_b64_tr_b16 v[124:125], v81 offset:4096
    ds_read_b64_tr_b16 v[126:127], v81 offset:5120
    s_waitcnt vmcnt(11) lgkmcnt(4)
    v_mfma_f32_32x32x16_bf16 v[16:31], v[112:115], v[164:167], v[16:31]
    ds_read_b64_tr_b16 v[104:105], v80 offset:6144
    ds_read_b64_tr_b16 v[106:107], v80 offset:7168
    buffer_load_dwordx4 v[148:151], v14, s[40:43], s37 offen offset:2048 sc1
    v_mfma_f32_32x32x16_bf16 v[32:47], v[116:119], v[164:167], v[32:47]
    ds_read_b64_tr_b16 v[108:109], v81 offset:6144
    ds_read_b64_tr_b16 v[110:111], v81 offset:7168
    v_add_u32 v82, s11, v72
    v_add_u32 v83, s11, v73
    s_waitcnt vmcnt(11) lgkmcnt(4)
    v_mfma_f32_32x32x16_bf16 v[16:31], v[120:123], v[168:171], v[16:31]
    ds_read_b32 v79, v8 offset:25984
    ds_read_b64_tr_b16 v[112:113], v82 offset:0
    ds_read_b64_tr_b16 v[114:115], v82 offset:1024
    buffer_load_dwordx4 v[152:155], v78, s[40:43], s37 offen offset:0 sc1
    v_mfma_f32_32x32x16_bf16 v[32:47], v[124:127], v[168:171], v[32:47]
    ds_read_b64_tr_b16 v[116:117], v83 offset:0
    ds_read_b64_tr_b16 v[118:119], v83 offset:1024
    s_waitcnt vmcnt(11) lgkmcnt(4)
    v_mfma_f32_32x32x16_bf16 v[16:31], v[104:107], v[172:175], v[16:31]
    ds_read_b64_tr_b16 v[120:121], v82 offset:2048
    ds_read_b64_tr_b16 v[122:123], v82 offset:3072
    buffer_load_dwordx4 v[156:159], v78, s[40:43], s37 offen offset:2048 sc1
    v_mfma_f32_32x32x16_bf16 v[32:47], v[108:111], v[172:175], v[32:47]
    ds_read_b64_tr_b16 v[124:125], v83 offset:2048
    ds_read_b64_tr_b16 v[126:127], v83 offset:3072
    v_readfirstlane_b32 s76, v79
    s_nop 0
    s_and_b32 s76, s76, s52
    s_cbranch_scc0 L_tr10
L_bk10:
    s_ff1_i32_b32 s76, s76
    s_bitset0_b32 s52, s76
    s_add_u32 s77, s76, s65
    s_and_b32 s77, s77, 15
    s_mul_i32 s77, s77, 32768
    s_add_u32 s38, s77, s80
    s_waitcnt vmcnt(11) lgkmcnt(4)
    v_mfma_f32_32x32x16_bf16 v[16:31], v[112:115], v[176:179], v[16:31]
    ds_read_b64_tr_b16 v[104:105], v82 offset:4096
    ds_read_b64_tr_b16 v[106:107], v82 offset:5120
    buffer_load_dwordx4 v[160:163], v14, s[40:43], s38 offen offset:0 sc1
    s_add_u32 s76, s76, 3
    s_and_b32 s76, s76, 15
    s_lshl_b32 s14, s76, 13
    v_mfma_f32_32x32x16_bf16 v[32:47], v[116:119], v[176:179], v[32:47]
    ds_read_b64_tr_b16 v[108:109], v83 offset:4096
    ds_read_b64_tr_b16 v[110:111], v83 offset:5120
    s_waitcnt vmcnt(11) lgkmcnt(4)
    v_mfma_f32_32x32x16_bf16 v[16:31], v[120:123], v[180:183], v[16:31]
    ds_read_b64_tr_b16 v[112:113], v82 offset:6144
    ds_read_b64_tr_b16 v[114:115], v82 offset:7168
    buffer_load_dwordx4 v[164:167], v14, s[40:43], s38 offen offset:2048 sc1
    v_mfma_f32_32x32x16_bf16 v[32:47], v[124:127], v[180:183], v[32:47]
    ds_read_b64_tr_b16 v[116:117], v83 offset:6144
    ds_read_b64_tr_b16 v[118:119], v83 offset:7168
    v_add_u32 v80, s12, v72
    v_add_u32 v81, s12, v73
    s_waitcnt vmcnt(11) lgkmcnt(4)
    v_mfma_f32_32x32x16_bf16 v[16:31], v[104:107], v[184:187], v[16:31]
    ds_read_b32 v79, v8 offset:25984
    ds_read_b64_tr_b16 v[120:121], v80 offset:0
    ds_read_b64_tr_b16 v[122:123], v80 offset:1024
    buffer_load_dwordx4 v[168:171], v78, s[40:43], s38 offen offset:0 sc1
    v_mfma_f32_32x32x16_bf16 v[32:47], v[108:111], v[184:187], v[32:47]
    ds_read_b64_tr_b16 v[124:125], v81 offset:0
    ds_read_b64_tr_b16 v[126:127], v81 offset:1024
    s_waitcnt vmcnt(11) lgkmcnt(4)
    v_mfma_f32_32x32x16_bf16 v[16:31], v[112:115], v[188:191], v[16:31]
    ds_read_b64_tr_b16 v[104:105], v80 offset:2048
    ds_read_b64_tr_b16 v[106:107], v80 offset:3072
    buffer_load_dwordx4 v[172:175], v78, s[40:43], s38 offen offset:2048 sc1
    v_mfma_f32_32x32x16_bf16 v[32:47], v[116:119], v[188:191], v[32:47]
    ds_read_b64_tr_b16 v[108:109], v81 offset:2048
    ds_read_b64_tr_b16 v[110:111], v81 offset:3072
    v_readfirstlane_b32 s76, v79
    s_nop 0
    s_and_b32 s76, s76, s52
    s_cbranch_scc0 L_tr11
L_bk11:
    s_ff1_i32_b32 s76, s76
    s_bitset0_b32 s52, s76
    s_add_u32 s77, s76, s65
    s_and_b32 s77, s77, 15
    s_mul_i32 s77, s77, 32768
    s_add_u32 s39, s77, s80
    s_waitcnt vmcnt(11) lgkmcnt(4)
    v_mfma_f32_32x32x16_bf16 v[16:31], v[120:123], v[128:131], v[16:31]
    ds_read_b64_tr_b16 v[112:113], v80 offset:4096
    ds_read_b64_tr_b16 v[114:115], v80 offset:5120
    buffer_load_dwordx4 v[176:179], v14, s[40:43], s39 offen offset:0 sc1
    s_add_u32 s76, s76, 3
    s_and_b32 s76, s76, 15
    s_lshl_b32 s15, s76, 13
    v_mfma_f32_32x32x16_bf16 v[32:47], v[124:127], v[128:131], v[32:47]
    ds_read_b64_tr_b16 v[116:117], v81 offset:4096
    ds_read_b64_tr_b16 v[118:119], v81 offset:5120
    s_waitcnt vmcnt(11) lgkmcnt(4)
    v_mfma_f32_32x32x16_bf16 v[16:31], v[104:107], v[132:135], v[16:31]
    ds_read_b64_tr_b16 v[120:121], v80 offset:6144
    ds_read_b64_tr_b16 v[122:123], v80 offset:7168
    buffer_load_dwordx4 v[180:183], v14, s[40:43], s39 offen offset:2048 sc1
    v_mfma_f32_32x32x16_bf16 v[32:47], v[108:111], v[132:135], v[32:47]
    ds_read_b64_tr_b16 v[124:125], v81 offset:6144
    ds_read_b64_tr_b16 v[126:127], v81 offset:7168
    v_add_u32 v82, s13, v72
    v_add_u32 v83, s13, v73
    s_waitcnt vmcnt(11) lgkmcnt(4)
    v_mfma_f32_32x32x16_bf16 v[16:31], v[112:115], v[136:139], v[16:31]
    ds_read_b32 v79, v8 offset:25984
    ds_read_b64_tr_b16 v[104:105], v82 offset:0
    ds_read_b64_tr_b16 v[106:107], v82 offset:1024
    buffer_load_dwordx4 v[184:187], v78, s[40:43], s39 offen offset:0 sc1
    v_mfma_f32_32x32x16_bf16 v[32:47], v[116:119], v[136:139], v[32:47]
    ds_read_b64_tr_b16 v[108:109], v83 offset:0
    ds_read_b64_tr_b16 v[110:111], v83 offset:1024
    s_waitcnt vmcnt(11) lgkmcnt(4)
    v_mfma_f32_32x32x16_bf16 v[16:31], v[120:123], v[140:143], v[16:31]
    ds_read_b64_tr_b16 v[112:113], v82 offset:2048
    ds_read_b64_tr_b16 v[114:115], v82 offset:3072
    buffer_load_dwordx4 v[188:191], v78, s[40:43], s39 offen offset:2048 sc1
    v_mfma_f32_32x32x16_bf16 v[32:47], v[124:127], v[140:143], v[32:47]
    ds_read_b64_tr_b16 v[116:117], v83 offset:2048
    ds_read_b64_tr_b16 v[118:119], v83 offset:3072
    v_readfirstlane_b32 s76, v79
    s_nop 0
    s_and_b32 s76, s76, s52
    s_cbranch_scc0 L_tr12
L_bk12:
    s_ff1_i32_b32 s76, s76
    s_bitset0_b32 s52, s76
    s_add_u32 s77, s76, s65
    s_and_b32 s77, s77, 15
    s_mul_i32 s77, s77, 32768
    s_add_u32 s48, s77, s80
    s_waitcnt vmcnt(11) lgkmcnt(4)
    v_mfma_f32_32x32x16_bf16 v[16:31], v[104:107], v[144:147], v[16:31]
    ds_read_b64_tr_b16 v[120:121], v82 offset:4096
    ds_read_b64_tr_b16 v[122:123], v82 offset:5120
    buffer_load_dwordx4 v[128:131], v14, s[40:43], s48 offen offset:0 sc1
    s_add_u32 s76, s76, 3
    s_and_b32 s76, s76, 15
    s_lshl_b32 s16, s76, 13
    v_mfma_f32_32x32x16_bf16 v[32:47], v[108:111], v[144:147], v[32:47]
    ds_read_b64_tr_b16 v[124:125], v83 offset:4096
    ds_read_b64_tr_b16 v[126:127], v83 offset:5120
    s_waitcnt vmcnt(11) lgkmcnt(4)
    v_mfma_f32_32x32x16_bf16 v[16:31], v[112:115], v[148:151], v[16:31]
    ds_read_b64_tr_b16 v[104:105], v82 offset:6144
    ds_read_b64_tr_b16 v[106:107], v82 offset:7168
    buffer_load_dwordx4 v[132:135], v14, s[40:43], s48 offen offset:2048 sc1
    v_mfma_f32_32x32x16_bf16 v[32:47], v[116:119], v[148:151], v[32:47]
    ds_read_b64_tr_b16 v[108:109], v83 offset:6144
    ds_read_b64_tr_b16 v[110:111], v83 offset:7168
    v_add_u32 v80, s14, v72
    v_add_u32 v81, s14, v73
    s_waitcnt vmcnt(11) lgkmcnt(4)
    v_mfma_f32_32x32x16_bf16 v[16:31], v[120:123], v[152:155], v[16:31]
    ds_read_b32 v79, v8 offset:25984
    ds_read_b64_tr_b16 v[112:113], v80 offset:0
    ds_read_b64_tr_b16 v[114:115], v80 offset:1024
    buffer_load_dwordx4 v[136:139], v78, s[40:43], s48 offen offset:0 sc1
    v_mfma_f32_32x32x16_bf16 v[32:47], v[124:127], v[152:155], v[32:47]
    ds_read_b64_tr_b16 v[116:117], v81 offset:0
    ds_read_b64_tr_b16 v[118:119], v81 offset:1024
    s_waitcnt vmcnt(11) lgkmcnt(4)
    v_mfma_f32_32x32x16_bf16 v[16:31], v[104:107], v[156:159], v[16:31]
    ds_read_b64_tr_b16 v[120:121], v80 offset:2048
    ds_read_b64_tr_b16 v[122:123], v80 offset:3072
    buffer_load_dwordx4 v[140:143], v78, s[40:43], s48 offen offset:2048 sc1
    v_mfma_f32_32x32x16_bf16 v[32:47], v[108:111], v[156:159], v[32:47]
    ds_read_b64_tr_b16 v[124:125], v81 offset:2048
    ds_read_b64_tr_b16 v[126:127], v81 offset:3072
    v_readfirstlane_b32 s76, v79
    s_nop 0
    s_and_b32 s76, s76, s52
    s_cbranch_scc0 L_tr13
L_bk13:
    s_ff1_i32_b32 s76, s76
    s_bitset0_b32 s52, s76
    s_add_u32 s77, s76, s65
    s_and_b32 s77, s77, 15
    s_mul_i32 s77, s77, 32768
    s_add_u32 s49, s77, s80
    s_waitcnt vmcnt(11) lgkmcnt(4)
    v_mfma_f32_32x32x16_bf16 v[16:31], v[112:115], v[160:163], v[16:31]
    ds_read_b64_tr_b16 v[104:105], v80 offset:4096
    ds_read_b64_tr_b16 v[106:107], v80 offset:5120
    buffer_load_dwordx4 v[144:147], v14, s[40:43], s49 offen offset:0 sc1
    s_add_u32 s76, s76, 3
    s_and_b32 s76, s76, 15
    s_lshl_b32 s17, s76, 13
    v_mfma_f32_32x32x16_bf16 v[32:47], v[116:119], v[160:163], v[32:47]
    ds_read_b64_tr_b16 v[108:109], v81 offset:4096
    ds_read_b64_tr_b16 v[110:111], v81 offset:5120
    s_waitcnt vmcnt(11) lgkmcnt(4)
    v_mfma_f32_32x32x16_bf16 v[16:31], v[120:123], v[164:167], v[16:31]
    ds_read_b64_tr_b16 v[112:113], v80 offset:6144
    ds_read_b64_tr_b16 v[114:115], v80 offset:7168
    buffer_load_dwordx4 v[148:151], v14, s[40:43], s49 offen offset:2048 sc1
    v_mfma_f32_32x32x16_bf16 v[32:47], v[124:127], v[164:167], v[32:47]
    ds_read_b64_tr_b16 v[116:117], v81 offset:6144
    ds_read_b64_tr_b16 v[118:119], v81 offset:7168
    v_add_u32 v82, s15, v72
    v_add_u32 v83, s15, v73
    s_waitcnt vmcnt(11) lgkmcnt(4)
    v_mfma_f32_32x32x16_bf16 v[16:31], v[104:107], v[168:171], v[16:31]
    ds_read_b32 v79, v8 offset:25984
    ds_read_b64_tr_b16 v[120:121], v82 offset:0
    ds_read_b64_tr_b16 v[122:123], v82 offset:1024
    buffer_load_dwordx4 v[152:155], v78, s[40:43], s49 offen offset:0 sc1
    v_mfma_f32_32x32x16_bf16 v[32:47], v[108:111], v[168:171], v[32:47]
    ds_read_b64_tr_b16 v[124:125], v83 offset:0
    ds_read_b64_tr_b16 v[126:127], v83 offset:1024
    s_waitcnt vmcnt(11) lgkmcnt(4)
    v_mfma_f32_32x32x16_bf16 v[16:31], v[112:115], v[172:175], v[16:31]
    ds_read_b64_tr_b16 v[104:105], v82 offset:2048
    ds_read_b64_tr_b16 v[106:107], v82 offset:3072
    buffer_load_dwordx4 v[156:159], v78, s[40:43], s49 offen offset:2048 sc1
    v_mfma_f32_32x32x16_bf16 v[32:47], v[116:119], v[172:175], v[32:47]
    ds_read_b64_tr_b16 v[108:109], v83 offset:2048
    ds_read_b64_tr_b16 v[110:111], v83 offset:3072
    v_readfirstlane_b32 s76, v79
    s_nop 0
    s_and_b32 s76, s76, s52
    s_cbranch_scc0 L_tr14
L_bk14:
    s_ff1_i32_b32 s76, s76
    s_bitset0_b32 s52, s76
    s_add_u32 s77, s76, s65
    s_and_b32 s77, s77, 15
    s_mul_i32 s77, s77, 32768
    s_add_u32 s50, s77, s80
    s_waitcnt vmcnt(11) lgkmcnt(4)
    v_mfma_f32_32x32x16_bf16 v[16:31], v[120:123], v[176:179], v[16:31]
    ds_read_b64_tr_b16 v[112:113], v82 offset:4096
    ds_read_b64_tr_b16 v[114:115], v82 offset:5120
    buffer_load_dwordx4 v[160:163], v14, s[40:43], s50 offen offset:0 sc1
    s_add_u32 s76, s76, 3
    s_and_b32 s76, s76, 15
    s_lshl_b32 s18, s76, 13
    v_mfma_f32_32x32x16_bf16 v[32:47], v[124:127], v[176:179], v[32:47]
    ds_read_b64_tr_b16 v[116:117], v83 offset:4096
    ds_read_b64_tr_b16 v[118:119], v83 offset:5120
    s_waitcnt vmcnt(11) lgkmcnt(4)
    v_mfma_f32_32x32x16_bf16 v[16:31], v[104:107], v[180:183], v[16:31]
    ds_read_b64_tr_b16 v[120:121], v82 offset:6144
    ds_read_b64_tr_b16 v[122:123], v82 offset:7168
    buffer_load_dwordx4 v[164:167], v14, s[40:43], s50 offen offset:2048 sc1
    v_mfma_f32_32x32x16_bf16 v[32:47], v[108:111], v[180:183], v[32:47]
    ds_read_b64_tr_b16 v[124:125], v83 offset:6144
    ds_read_b64_tr_b16 v[126:127], v83 offset:7168
    v_add_u32 v80, s16, v72
    v_add_u32 v81, s16, v73
    s_waitcnt vmcnt(11) lgkmcnt(4)
    v_mfma_f32_32x32x16_bf16 v[16:31], v[112:115], v[184:187], v[16:31]
    ds_read_b32 v79, v8 offset:25984
    ds_read_b64_tr_b16 v[104:105], v80 offset:0
    ds_read_b64_tr_b16 v[106:107], v80 offset:1024
    buffer_load_dwordx4 v[168:171], v78, s[40:43], s50 offen offset:0 sc1
    v_mfma_f32_32x32x16_bf16 v[32:47], v[116:119], v[184:187], v[32:47]
    ds_read_b64_tr_b16 v[108:109], v81 offset:0
    ds_read_b64_tr_b16 v[110:111], v81 offset:1024
    s_waitcnt vmcnt(11) lgkmcnt(4)
    v_mfma_f32_32x32x16_bf16 v[16:31], v[120:123], v[188:191], v[16:31]
    ds_read_b64_tr_b16 v[112:113], v80 offset:2048
    ds_read_b64_tr_b16 v[114:115], v80 offset:3072
    buffer_load_dwordx4 v[172:175], v78, s[40:43], s50 offen offset:2048 sc1
    v_mfma_f32_32x32x16_bf16 v[32:47], v[124:127], v[188:191], v[32:47]
    ds_read_b64_tr_b16 v[116:117], v81 offset:2048
    ds_read_b64_tr_b16 v[118:119], v81 offset:3072
    v_readfirstlane_b32 s76, v79
    s_nop 0
    s_and_b32 s76, s76, s52
    s_cbranch_scc0 L_tr15
L_bk15:
    s_ff1_i32_b32 s76, s76
    s_bitset0_b32 s52, s76
    s_add_u32 s77, s76, s65
    s_and_b32 s77, s77, 15
    s_mul_i32 s77, s77, 32768
    s_add_u32 s51, s77, s80
    s_waitcnt vmcnt(11) lgkmcnt(4)
    v_mfma_f32_32x32x16_bf16 v[16:31], v[104:107], v[128:131], v[16:31]
    ds_read_b64_tr_b16 v[120:121], v80 offset:4096
    ds_read_b64_tr_b16 v[122:123], v80 offset:5120
    buffer_load_dwordx4 v[176:179], v14, s[40:43], s51 offen offset:0 sc1
    s_add_u32 s76, s76, 3
    s_and_b32 s76, s76, 15
    s_lshl_b32 s19, s76, 13
    v_mfma_f32_32x32x16_bf16 v[32:47], v[108:111], v[128:131], v[32:47]
    ds_read_b64_tr_b16 v[124:125], v81 offset:4096
    ds_read_b64_tr_b16 v[126:127], v81 offset:5120
    s_waitcnt vmcnt(11) lgkmcnt(4)
    v_mfma_f32_32x32x16_bf16 v[16:31], v[112:115], v[132:135], v[16:31]
    ds_read_b64_tr_b16 v[104:105], v80 offset:6144
    ds_read_b64_tr_b16 v[106:107], v80 offset:7168
    buffer_load_dwordx4 v[180:183], v14, s[40:43], s51 offen offset:2048 sc1
    v_mfma_f32_32x32x16_bf16 v[32:47], v[116:119], v[132:135], v[32:47]
    ds_read_b64_tr_b16 v[108:109], v81 offset:6144
    ds_read_b64_tr_b16 v[110:111], v81 offset:7168
    v_add_u32 v82, s17, v72
    v_add_u32 v83, s17, v73
    s_waitcnt vmcnt(11) lgkmcnt(4)
    v_mfma_f32_32x32x16_bf16 v[16:31], v[120:123], v[136:139], v[16:31]
    ds_read_b64 v[192:193], v10 offset:16384
    ds_read_b64_tr_b16 v[112:113], v82 offset:0
    ds_read_b64_tr_b16 v[114:115], v82 offset:1024
    buffer_load_dwordx4 v[184:187], v78, s[40:43], s51 offen offset:0 sc1
    v_mfma_f32_32x32x16_bf16 v[32:47], v[124:127], v[136:139], v[32:47]
    ds_read_b64_tr_b16 v[116:117], v83 offset:0
    ds_read_b64_tr_b16 v[118:119], v83 offset:1024
    s_waitcnt vmcnt(11) lgkmcnt(4)
    v_mfma_f32_32x32x16_bf16 v[16:31], v[104:107], v[140:143], v[16:31]
    ds_read_b64 v[194:195], v10 offset:16400
    ds_read_b64_tr_b16 v[120:121], v82 offset:2048
    ds_read_b64_tr_b16 v[122:123], v82 offset:3072
    buffer_load_dwordx4 v[188:191], v78, s[40:43], s51 offen offset:2048 sc1
    s_barrier
    v_mfma_f32_32x32x16_bf16 v[32:47], v[108:111], v[140:143], v[32:47]
    ds_read_b64_tr_b16 v[124:125], v83 offset:2048
    ds_read_b64_tr_b16 v[126:127], v83 offset:3072
    s_waitcnt vmcnt(11) lgkmcnt(4)
    v_mfma_f32_32x32x16_bf16 v[16:31], v[112:115], v[144:147], v[16:31]
    ds_read_b64 v[196:197], v10 offset:16416
    ds_read_b64_tr_b16 v[104:105], v82 offset:4096
    ds_read_b64_tr_b16 v[106:107], v82 offset:5120
    v_mfma_f32_32x32x16_bf16 v[32:47], v[116:119], v[144:147], v[32:47]
    ds_read_b64_tr_b16 v[108:109], v83 offset:4096
    ds_read_b64_tr_b16 v[110:111], v83 offset:5120
    s_waitcnt vmcnt(10) lgkmcnt(4)
    v_mfma_f32_32x32x16_bf16 v[16:31], v[120:123], v[148:151], v[16:31]
    ds_read_b64 v[198:199], v10 offset:16432
    ds_read_b64_tr_b16 v[112:113], v82 offset:6144
    ds_read_b64_tr_b16 v[114:115], v82 offset:7168
    v_mfma_f32_32x32x16_bf16 v[32:47], v[124:127], v[148:151], v[32:47]
    ds_read_b64_tr_b16 v[116:117], v83 offset:6144
    ds_read_b64_tr_b16 v[118:119], v83 offset:7168
    v_add_u32 v80, s18, v72
    v_add_u32_e64 v81, s18, v73
    s_waitcnt vmcnt(9) lgkmcnt(4)
    v_mfma_f32_32x32x16_bf16 v[16:31], v[104:107], v[152:155], v[16:31]
    ds_read_b64 v[200:201], v10 offset:16448
    ds_read_b64_tr_b16 v[120:121], v80 offset:0
    ds_read_b64_tr_b16 v[122:123], v80 offset:1024
    v_mfma_f32_32x32x16_bf16 v[32:47], v[108:111], v[152:155], v[32:47]
    ds_read_b64_tr_b16 v[124:125], v81 offset:0
    ds_read_b64_tr_b16 v[126:127], v81 offset:1024
    s_waitcnt vmcnt(8) lgkmcnt(4)
    v_mfma_f32_32x32x16_bf16 v[16:31], v[112:115], v[156:159], v[16:31]
    ds_read_b64 v[202:203], v10 offset:16464
    ds_read_b64_tr_b16 v[104:105], v80 offset:2048
    ds_read_b64_tr_b16 v[106:107], v80 offset:3072
    v_mfma_f32_32x32x16_bf16 v[32:47], v[116:119], v[156:159], v[32:47]
    ds_read_b64_tr_b16 v[108:109], v81 offset:2048
    ds_read_b64_tr_b16 v[110:111], v81 offset:3072
    s_waitcnt vmcnt(7) lgkmcnt(4)
    v_mfma_f32_32x32x16_bf16 v[16:31], v[120:123], v[160:163], v[16:31]
    ds_read_b64 v[204:205], v10 offset:16480
    ds_read_b64_tr_b16 v[112:113], v80 offset:4096
    ds_read_b64_tr_b16 v[114:115], v80 offset:5120
    v_mfma_f32_32x32x16_bf16 v[32:47], v[124:127], v[160:163], v[32:47]
    ds_read_b64_tr_b16 v[116:117], v81 offset:4096
    ds_read_b64_tr_b16 v[118:119], v81 offset:5120
    s_waitcnt vmcnt(6) lgkmcnt(4)
    v_mfma_f32_32x32x16_bf16 v[16:31], v[104:107], v[164:167], v[16:31]
    ds_read_b64 v[206:207], v10 offset:16496
    ds_read_b64_tr_b16 v[120:121], v80 offset:6144
    ds_read_b64_tr_b16 v[122:123], v80 offset:7168
    v_mfma_f32_32x32x16_bf16 v[32:47], v[108:111], v[164:167], v[32:47]
    ds_read_b64_tr_b16 v[124:125], v81 offset:6144
    ds_read_b64_tr_b16 v[126:127], v81 offset:7168
    v_add_u32 v82, s19, v72
    v_add_u32 v83, s19, v73
    s_waitcnt vmcnt(5) lgkmcnt(4)
    v_mfma_f32_32x32x16_bf16 v[16:31], v[112:115], v[168:171], v[16:31]
    ds_read_b128 v[208:211], v11 offset:16384
    ds_read_b64_tr_b16 v[104:105], v82 offset:0
    ds_read_b64_tr_b16 v[106:107], v82 offset:1024
    v_mfma_f32_32x32x16_bf16 v[32:47], v[116:119], v[168:171], v[32:47]
    ds_read_b64_tr_b16 v[108:109], v83 offset:0
    ds_read_b64_tr_b16 v[110:111], v83 offset:1024
    s_waitcnt vmcnt(4) lgkmcnt(4)
    v_mfma_f32_32x32x16_bf16 v[16:31], v[120:123], v[172:175], v[16:31]
    ds_read_b128 v[212:215], v11 offset:16400
    ds_read_b64_tr_b16 v[112:113], v82 offset:2048
    ds_read_b64_tr_b16 v[114:115], v82 offset:3072
    v_mfma_f32_32x32x16_bf16 v[32:47], v[124:127], v[172:175], v[32:47]
    ds_read_b64_tr_b16 v[116:117], v83 offset:2048
    ds_read_b64_tr_b16 v[118:119], v83 offset:3072
    s_waitcnt vmcnt(3) lgkmcnt(4)
    v_mfma_f32_32x32x16_bf16 v[16:31], v[104:107], v[176:179], v[16:31]
    ds_read_b64_tr_b16 v[120:121], v82 offset:4096
    ds_read_b64_tr_b16 v[122:123], v82 offset:5120
    v_mfma_f32_32x32x16_bf16 v[32:47], v[108:111], v[176:179], v[32:47]
    ds_read_b64_tr_b16 v[124:125], v83 offset:4096
    ds_read_b64_tr_b16 v[126:127], v83 offset:5120
    s_waitcnt vmcnt(2) lgkmcnt(4)
    v_mfma_f32_32x32x16_bf16 v[16:31], v[112:115], v[180:183], v[16:31]
    ds_read_b64_tr_b16 v[104:105], v82 offset:6144
    ds_read_b64_tr_b16 v[106:107], v82 offset:7168
    v_mfma_f32_32x32x16_bf16 v[32:47], v[116:119], v[180:183], v[32:47]
    ds_read_b64_tr_b16 v[108:109], v83 offset:6144
    ds_read_b64_tr_b16 v[110:111], v83 offset:7168
    s_waitcnt vmcnt(1) lgkmcnt(4)
    v_mfma_f32_32x32x16_bf16 v[16:31], v[120:123], v[184:187], v[16:31]
    v_mfma_f32_32x32x16_bf16 v[32:47], v[124:127], v[184:187], v[32:47]
    s_waitcnt vmcnt(0) lgkmcnt(0)
    v_mfma_f32_32x32x16_bf16 v[16:31], v[104:107], v[188:191], v[16:31]
    v_mfma_f32_32x32x16_bf16 v[32:47], v[108:111], v[188:191], v[32:47]
    s_nop 10
    v_cvt_pk_bf16_f32 v88, v16, v17
    v_cvt_pk_bf16_f32 v89, v18, v19
    v_cvt_pk_bf16_f32 v90, v20, v21
    v_cvt_pk_bf16_f32 v91, v22, v23
    v_cvt_pk_bf16_f32 v92, v24, v25
    v_cvt_pk_bf16_f32 v93, v26, v27
    v_cvt_pk_bf16_f32 v94, v28, v29
    v_cvt_pk_bf16_f32 v95, v30, v31
    v_cvt_pk_bf16_f32 v96, v32, v33
    v_cvt_pk_bf16_f32 v97, v34, v35
    v_cvt_pk_bf16_f32 v98, v36, v37
    v_cvt_pk_bf16_f32 v99, v38, v39
    v_cvt_pk_bf16_f32 v100, v40, v41
    v_cvt_pk_bf16_f32 v101, v42, v43
    v_cvt_pk_bf16_f32 v102, v44, v45
    v_cvt_pk_bf16_f32 v103, v46, v47
    v_dot2_f32_bf16 v104, v88, s89, 0
    v_dot2_f32_bf16 v105, v88, v88, 0
    v_dot2_f32_bf16 v106, v88, v192, 0
    v_dot2_f32_bf16 v104, v89, s89, v104
    v_dot2_f32_bf16 v105, v89, v89, v105
    v_dot2_f32_bf16 v106, v89, v193, v106
    v_dot2_f32_bf16 v104, v90, s89, v104
    v_dot2_f32_bf16 v105, v90, v90, v105
    v_dot2_f32_bf16 v106, v90, v194, v106
    v_dot2_f32_bf16 v104, v91, s89, v104
    v_dot2_f32_bf16 v105, v91, v91, v105
    v_dot2_f32_bf16 v106, v91, v195, v106
    v_dot2_f32_bf16 v104, v92, s89, v104
    v_dot2_f32_bf16 v105, v92, v92, v105
    v_dot2_f32_bf16 v106, v92, v196, v106
    v_dot2_f32_bf16 v104, v93, s89, v104
    v_dot2_f32_bf16 v105, v93, v93, v105
    v_dot2_f32_bf16 v106, v93, v197, v106
    v_dot2_f32_bf16 v104, v94, s89, v104
    v_dot2_f32_bf16 v105, v94, v94, v105
    v_dot2_f32_bf16 v106, v94, v198, v106
    v_dot2_f32_bf16 v104, v95, s89, v104
    v_dot2_f32_bf16 v105, v95, v95, v105
    v_dot2_f32_bf16 v106, v95, v199, v106
    v_dot2_f32_bf16 v104, v96, s89, v104
    v_dot2_f32_bf16 v105, v96, v96, v105
    v_dot2_f32_bf16 v106, v96, v200, v106
    v_dot2_f32_bf16 v104, v97, s89, v104
    v_dot2_f32_bf16 v105, v97, v97, v105
    v_dot2_f32_bf16 v106, v97, v201, v106
    v_dot2_f32_bf16 v104, v98, s89, v104
    v_dot2_f32_bf16 v105, v98, v98, v105
    v_dot2_f32_bf16 v106, v98, v202, v106
    v_dot2_f32_bf16 v104, v99, s89, v104
    v_dot2_f32_bf16 v105, v99, v99, v105
    v_dot2_f32_bf16 v106, v99, v203, v106
    v_dot2_f32_bf16 v104, v100, s89, v104
    v_dot2_f32_bf16 v105, v100, v100, v105
    v_dot2_f32_bf16 v106, v100, v204, v106
    v_dot2_f32_bf16 v104, v101, s89, v104
    v_dot2_f32_bf16 v105, v101, v101, v105
    v_dot2_f32_bf16 v106, v101, v205, v106
    v_dot2_f32_bf16 v104, v102, s89, v104
    v_dot2_f32_bf16 v105, v102, v102, v105
    v_dot2_f32_bf16 v106, v102, v206, v106
    v_dot2_f32_bf16 v104, v103, s89, v104
    v_dot2_f32_bf16 v105, v103, v103, v105
    v_dot2_f32_bf16 v106, v103, v207, v106
    s_lshl_b32 s76, s62, 9
    s_add_u32 s77, s76, s99
    v_mov_b32 v107, 0
    v_mov_b32 v4, v104
    v_mov_b32 v5, v105
    v_mov_b32 v6, v106
    v_permlane32_swap_b32 v104, v4
    v_permlane32_swap_b32 v105, v5
    v_permlane32_swap_b32 v106, v6
    v_add_f32 v104, v104, v4
    v_add_f32 v105, v105, v5
    v_add_f32_e64 v106, v106, v6
    s_mov_b32 exec_hi, 0
    s_bitcmp1_b32 s100, 1
    s_cbranch_scc1 L_loc_70
    buffer_store_dwordx4 v[104:107], v12, s[40:43], s77 offen offset:1024 sc1
    s_branch L_pubd_71
L_loc_70:
    buffer_store_dwordx4 v[104:107], v12, s[40:43], s77 offen offset:1024
L_pubd_71:
    s_mov_b64 exec, -1
    ds_write_b64 v64, v[88:89]
    ds_write_b64 v65, v[90:91]
    ds_write_b64 v66, v[92:93]
    ds_write_b64 v67, v[94:95]
    ds_write_b64 v68, v[96:97]
    ds_write_b64 v69, v[98:99]
    ds_write_b64 v70, v[100:101]
    ds_write_b64 v71, v[102:103]
    v_bfe_u32 v4, v1, 1, 3
    v_bfe_u32 v5, v1, 4, 1
    v_lshlrev_b32_e64 v176, 4, v4
    v_lshl_add_u32 v176, v5, 3, v176
    v_and_b32_e64 v5, 1, v1
    v_lshl_add_u32 v176, v5, 2, v176
    v_lshlrev_b32_e64 v177, 2, v2
    v_lshl_add_u32 v177, v3, 8, v177
    v_and_b32 v4, 15, v1
    v_lshrrev_b32 v5, 4, v1
    v_mul_u32_u24 v179, 149504, v4
    v_lshl_add_u32 v180, v5, 4, v179
    s_lshl_b32 s82, s97, 7
    s_lshl_b32 s79, s62, 5
    s_add_u32 s82, s82, s79
    s_lshl_b32 s79, s62, 2
    v_mov_b32_e64 v7, s79
    v_mul_u32_u24 v178, 9344, v3
    v_lshl_add_u32 v178, v2, 4, v178
    s_mul_i32 s78, s97, 149504
    s_add_u32 s78, s78, s76
    s_add_u32 s78, s78, 8388608
    s_add_u32 s48, s78, 18688
    s_add_u32 s49, s48, 18688
    s_add_u32 s50, s49, 18688
    s_add_u32 s51, s50, 18688
    s_add_u32 s52, s51, 18688
    s_add_u32 s53, s52, 18688
    s_add_u32 s54, s53, 18688
    buffer_load_dwordx4 v[112:115], v178, s[40:43], s78 offen offset:1024 sc1
    buffer_load_dwordx4 v[116:119], v178, s[40:43], s48 offen offset:1024 sc1
    buffer_load_dwordx4 v[120:123], v178, s[40:43], s49 offen offset:1024 sc1
    buffer_load_dwordx4 v[124:127], v178, s[40:43], s50 offen offset:1024 sc1
    buffer_load_dwordx4 v[128:131], v178, s[40:43], s51 offen offset:1024 sc1
    buffer_load_dwordx4 v[132:135], v178, s[40:43], s52 offen offset:1024 sc1
    buffer_load_dwordx4 v[136:139], v178, s[40:43], s53 offen offset:1024 sc1
    buffer_load_dwordx4 v[140:143], v178, s[40:43], s54 offen offset:1024 sc1
    v_dot2_f32_bf16 v76, v208, s89, 0
    v_dot2_f32_bf16 v76, v209, s89, v76
    v_dot2_f32_bf16 v76, v210, s89, v76
    v_dot2_f32_bf16 v76, v211, s89, v76
    v_dot2_f32_bf16 v76, v212, s89, v76
    v_dot2_f32_bf16 v76, v213, s89, v76
    v_dot2_f32_bf16 v76, v214, s89, v76
    v_dot2_f32_bf16 v76, v215, s89, v76
    s_nop 2
    v_add_f32_dpp v76, v76, v76 row_ror:8 row_mask:0xf bank_mask:0xf
    s_nop 1
    v_add_f32_dpp v76, v76, v76 row_ror:4 row_mask:0xf bank_mask:0xf
    s_nop 1
    v_add_f32_dpp v76, v76, v76 row_ror:2 row_mask:0xf bank_mask:0xf
    s_nop 1
    v_add_f32_dpp v76, v76, v76 row_ror:1 row_mask:0xf bank_mask:0xf
    v_mov_b32 v4, v76
    s_nop 1
    v_permlane16_swap_b32 v76, v4
    v_add_f32 v76, v76, v4
    v_mov_b32 v4, v76
    s_nop 1
    v_permlane32_swap_b32 v76, v4
    v_add_f32_e64 v76, v76, v4
    s_mov_b32 s88, 0
    s_waitcnt vmcnt(6)
    v_pk_add_f32 v[108:109], v[112:113], v[116:117]
    v_pk_add_f32 v[110:111], v[114:115], v[118:119]
    s_waitcnt vmcnt(5)
    v_pk_add_f32 v[108:109], v[108:109], v[120:121]
    v_pk_add_f32 v[110:111], v[110:111], v[122:123]
    s_waitcnt vmcnt(4)
    v_pk_add_f32 v[108:109], v[108:109], v[124:125]
    v_pk_add_f32 v[110:111], v[110:111], v[126:127]
    s_waitcnt vmcnt(3)
    v_pk_add_f32 v[108:109], v[108:109], v[128:129]
    v_pk_add_f32 v[110:111], v[110:111], v[130:131]
    s_waitcnt vmcnt(2)
    v_pk_add_f32 v[108:109], v[108:109], v[132:133]
    v_pk_add_f32 v[110:111], v[110:111], v[134:135]
    s_waitcnt vmcnt(1)
    v_pk_add_f32 v[108:109], v[108:109], v[136:137]
    v_pk_add_f32 v[110:111], v[110:111], v[138:139]
    s_waitcnt vmcnt(0)
    v_pk_add_f32 v[108:109], v[108:109], v[140:141]
    v_pk_add_f32 v[110:111], v[110:111], v[142:143]
    v_cmp_u_f32 vcc, v111, v111
    v_mov_b32 v4, v108
    v_mov_b32 v5, v109
    v_mov_b32 v6, v110
    s_cbranch_vccnz L_s3_73
L_s3ok_74:
    v_permlane32_swap_b32 v108, v4
    v_permlane32_swap_b32 v109, v5
    v_permlane32_swap_b32 v110, v6
    s_barrier
    v_add_f32 v108, v108, v4
    v_add_f32 v109, v109, v5
    v_add_f32 v110, v110, v6
    v_mul_f32 v108, 0x3a800000, v108
    v_mul_f32 v109, 0x3a800000, v109
    v_fma_f32 v4, -v108, v108, v109
    v_max_f32_e64 v4, 0, v4
    v_cvt_pk_bf16_f32 v116, v108, v108
    v_and_b32_e64 v116, s90, v116
    v_cvt_pk_bf16_f32 v4, v4, v4
    v_and_b32_e64 v4, s90, v4
    v_add_f32 v4, 0x3727c5ac, v4
    v_cvt_pk_bf16_f32 v4, v4, v4
    v_and_b32 v4, s90, v4
    v_sqrt_f32_e64 v4, v4
    s_nop 0
    v_cvt_pk_bf16_f32 v4, v4, v4
    v_and_b32 v4, s90, v4
    v_rcp_f32 v118, v4
    v_fma_f32 v120, -v116, v76, v110
    v_mul_f32 v119, v116, v118
    v_mul_f32 v120, v120, v118
    v_and_b32 v6, 3, v1
    v_lshlrev_b32 v6, 2, v6
    v_max_f32_dpp v4, v120, v120 row_ror:8 row_mask:0xf bank_mask:0xf
    s_lshl_b32 s83, s62, 12
    v_cmp_gt_u32 s[84:85], 32, v1
    v_max_f32_dpp v4, v4, v4 row_ror:4 row_mask:0xf bank_mask:0xf
    s_lshl_b32 s55, 1, s62
    s_sub_u32 s55, s55, 1
    v_max_f32_dpp v4, v4, v4 row_ror:2 row_mask:0xf bank_mask:0xf
    s_nop 1
    v_max_f32_dpp v4, v4, v4 row_ror:1 row_mask:0xf bank_mask:0xf
    v_mov_b32 v5, v4
    s_nop 1
    v_permlane16_swap_b32 v4, v5
    v_max_f32 v4, v4, v5
    v_cmp_eq_f32_e64 vcc, v4, v120
    ds_write_b32 v7, v4 offset:25600
    s_ff1_i32_b32 s77, vcc_lo
    s_and_b32 s77, s77, 31
    s_bfe_u32 s79, s77, 0x30001
    s_lshl3_add_u32 s79, s77, s79
    s_lshl4_add_u32 s79, s79, s83
    v_xor_b32_e64 v176, s79, v176
    ds_read_b32 v182, v176 offset:0
    s_waitcnt lgkmcnt(1)
    s_barrier
    ds_read_b32 v8, v6 offset:25600
    v_readlane_b32 s80, v118, s77
    v_readlane_b32 s81, v119, s77
    s_add_u32 s79, s82, s77
    v_writelane_b32 v4, s79, 33
    v_mov_b32 v5, s81
    s_waitcnt lgkmcnt(1)
    v_lshlrev_b32 v184, 16, v182
    v_and_b32_e64 v185, s90, v182
    v_fma_f32 v184, v184, s80, -v5
    v_fma_f32 v185, v185, s80, -v5
    v_cvt_pk_bf16_f32 v184, v184, v185
    v_cndmask_b32 v184, v4, v184, s[84:85]
    s_waitcnt lgkmcnt(0)
    v_cmp_eq_f32 s[56:57], v8, v4
    v_cmp_gt_f32 vcc, v8, v4
    s_and_b32 s56, s56, s55
    s_or_b32 s56, s56, vcc_lo
    s_cbranch_scc1 L_nopub_83
    buffer_store_dword v184, v177, s[40:43], s99 offen offset:0 sc1
L_nopub_83:
    v_lshlrev_b32 v16, 16, v88
    v_and_b32_e64 v17, s90, v88
    v_pk_fma_f32 v[144:145], v[16:17], v[118:119], v[118:119] op_sel:[0,0,1] op_sel_hi:[1,0,1] neg_lo:[0,0,1] neg_hi:[0,0,1]
    v_cvt_pk_bf16_f32 v124, v144, v145
    v_lshlrev_b32 v144, 16, v124
    v_and_b32 v145, s90, v124
    v_pk_add_f32 v[144:145], v[144:145], v[16:17]
    v_cvt_pk_bf16_f32 v124, v144, v145
    v_lshlrev_b32 v18, 16, v89
    v_and_b32 v19, s90, v89
    v_pk_fma_f32 v[146:147], v[18:19], v[118:119], v[118:119] op_sel:[0,0,1] op_sel_hi:[1,0,1] neg_lo:[0,0,1] neg_hi:[0,0,1]
    v_cvt_pk_bf16_f32 v125, v146, v147
    v_lshlrev_b32 v146, 16, v125
    v_and_b32 v147, s90, v125
    v_pk_add_f32 v[146:147], v[146:147], v[18:19]
    v_cvt_pk_bf16_f32 v125, v146, v147
    ds_write_b64 v64, v[124:125]
    v_lshlrev_b32 v20, 16, v90
    v_and_b32 v21, s90, v90
    v_pk_fma_f32 v[148:149], v[20:21], v[118:119], v[118:119] op_sel:[0,0,1] op_sel_hi:[1,0,1] neg_lo:[0,0,1] neg_hi:[0,0,1]
    v_cvt_pk_bf16_f32 v126, v148, v149
    v_lshlrev_b32 v148, 16, v126
    v_and_b32 v149, s90, v126
    v_pk_add_f32 v[148:149], v[148:149], v[20:21]
    v_cvt_pk_bf16_f32 v126, v148, v149
    v_lshlrev_b32 v22, 16, v91
    v_and_b32 v23, s90, v91
    v_pk_fma_f32 v[150:151], v[22:23], v[118:119], v[118:119] op_sel:[0,0,1] op_sel_hi:[1,0,1] neg_lo:[0,0,1] neg_hi:[0,0,1]
    v_cvt_pk_bf16_f32 v127, v150, v151
    v_lshlrev_b32 v150, 16, v127
    v_and_b32 v151, s90, v127
    v_pk_add_f32 v[150:151], v[150:151], v[22:23]
    v_cvt_pk_bf16_f32 v127, v150, v151
    ds_write_b64 v65, v[126:127]
    s_cmp_eq_u32 s56, 0
    s_cbranch_scc1 L_stay_84
    s_cmp_gt_u32 s62, 1
    s_cbranch_scc0 L_stay_84
    s_mov_b32 s91, -1
    v_lshlrev_b32 v24, 16, v92
    v_and_b32_e64 v25, s90, v92
    v_pk_fma_f32 v[152:153], v[24:25], v[118:119], v[118:119] op_sel:[0,0,1] op_sel_hi:[1,0,1] neg_lo:[0,0,1] neg_hi:[0,0,1]
    v_cvt_pk_bf16_f32 v128, v152, v153
    v_lshlrev_b32 v152, 16, v128
    v_and_b32 v153, s90, v128
    v_pk_add_f32 v[152:153], v[152:153], v[24:25]
    v_cvt_pk_bf16_f32 v128, v152, v153
    v_lshlrev_b32 v26, 16, v93
    v_and_b32 v27, s90, v93
    v_pk_fma_f32 v[154:155], v[26:27], v[118:119], v[118:119] op_sel:[0,0,1] op_sel_hi:[1,0,1] neg_lo:[0,0,1] neg_hi:[0,0,1]
    v_cvt_pk_bf16_f32 v129, v154, v155
    v_lshlrev_b32 v154, 16, v129
    v_and_b32 v155, s90, v129
    v_pk_add_f32 v[154:155], v[154:155], v[26:27]
    v_cvt_pk_bf16_f32 v129, v154, v155
    ds_write_b64 v66, v[128:129]
    v_lshlrev_b32 v28, 16, v94
    v_and_b32 v29, s90, v94
    v_pk_fma_f32 v[156:157], v[28:29], v[118:119], v[118:119] op_sel:[0,0,1] op_sel_hi:[1,0,1] neg_lo:[0,0,1] neg_hi:[0,0,1]
    v_cvt_pk_bf16_f32 v130, v156, v157
    v_lshlrev_b32 v156, 16, v130
    v_and_b32 v157, s90, v130
    v_pk_add_f32 v[156:157], v[156:157], v[28:29]
    v_cvt_pk_bf16_f32 v130, v156, v157
    v_lshlrev_b32 v30, 16, v95
    v_and_b32 v31, s90, v95
    v_pk_fma_f32 v[158:159], v[30:31], v[118:119], v[118:119] op_sel:[0,0,1] op_sel_hi:[1,0,1] neg_lo:[0,0,1] neg_hi:[0,0,1]
    v_cvt_pk_bf16_f32 v131, v158, v159
    v_lshlrev_b32 v158, 16, v131
    v_and_b32 v159, s90, v131
    v_pk_add_f32 v[158:159], v[158:159], v[30:31]
    v_cvt_pk_bf16_f32 v131, v158, v159
    ds_write_b64 v67, v[130:131]
    v_lshlrev_b32 v32, 16, v96
    v_and_b32 v33, s90, v96
    v_pk_fma_f32 v[160:161], v[32:33], v[118:119], v[118:119] op_sel:[0,0,1] op_sel_hi:[1,0,1] neg_lo:[0,0,1] neg_hi:[0,0,1]
    v_cvt_pk_bf16_f32 v132, v160, v161
    v_lshlrev_b32 v160, 16, v132
    v_and_b32 v161, s90, v132
    v_pk_add_f32 v[160:161], v[160:161], v[32:33]
    v_cvt_pk_bf16_f32 v132, v160, v161
    v_lshlrev_b32 v34, 16, v97
    v_and_b32 v35, s90, v97
    v_pk_fma_f32 v[162:163], v[34:35], v[118:119], v[118:119] op_sel:[0,0,1] op_sel_hi:[1,0,1] neg_lo:[0,0,1] neg_hi:[0,0,1]
    v_cvt_pk_bf16_f32 v133, v162, v163
    v_lshlrev_b32 v162, 16, v133
    v_and_b32 v163, s90, v133
    v_pk_add_f32 v[162:163], v[162:163], v[34:35]
    v_cvt_pk_bf16_f32 v133, v162, v163
    ds_write_b64 v68, v[132:133]
    v_lshlrev_b32 v36, 16, v98
    v_and_b32 v37, s90, v98
    v_pk_fma_f32 v[164:165], v[36:37], v[118:119], v[118:119] op_sel:[0,0,1] op_sel_hi:[1,0,1] neg_lo:[0,0,1] neg_hi:[0,0,1]
    v_cvt_pk_bf16_f32 v134, v164, v165
    v_lshlrev_b32 v164, 16, v134
    v_and_b32 v165, s90, v134
    v_pk_add_f32 v[164:165], v[164:165], v[36:37]
    v_cvt_pk_bf16_f32 v134, v164, v165
    v_lshlrev_b32 v38, 16, v99
    v_and_b32 v39, s90, v99
    v_pk_fma_f32 v[166:167], v[38:39], v[118:119], v[118:119] op_sel:[0,0,1] op_sel_hi:[1,0,1] neg_lo:[0,0,1] neg_hi:[0,0,1]
    v_cvt_pk_bf16_f32 v135, v166, v167
    v_lshlrev_b32 v166, 16, v135
    v_and_b32 v167, s90, v135
    v_pk_add_f32 v[166:167], v[166:167], v[38:39]
    v_cvt_pk_bf16_f32 v135, v166, v167
    ds_write_b64 v69, v[134:135]
    v_lshlrev_b32 v40, 16, v100
    v_and_b32 v41, s90, v100
    v_pk_fma_f32 v[168:169], v[40:41], v[118:119], v[118:119] op_sel:[0,0,1] op_sel_hi:[1,0,1] neg_lo:[0,0,1] neg_hi:[0,0,1]
    v_cvt_pk_bf16_f32 v136, v168, v169
    v_lshlrev_b32 v168, 16, v136
    v_and_b32 v169, s90, v136
    v_pk_add_f32 v[168:169], v[168:169], v[40:41]
    v_cvt_pk_bf16_f32 v136, v168, v169
    v_lshlrev_b32 v42, 16, v101
    v_and_b32 v43, s90, v101
    v_pk_fma_f32 v[170:171], v[42:43], v[118:119], v[118:119] op_sel:[0,0,1] op_sel_hi:[1,0,1] neg_lo:[0,0,1] neg_hi:[0,0,1]
    v_cvt_pk_bf16_f32 v137, v170, v171
    v_lshlrev_b32 v170, 16, v137
    v_and_b32 v171, s90, v137
    v_pk_add_f32 v[170:171], v[170:171], v[42:43]
    v_cvt_pk_bf16_f32 v137, v170, v171
    ds_write_b64 v70, v[136:137]
    v_lshlrev_b32 v44, 16, v102
    v_and_b32 v45, s90, v102
    v_pk_fma_f32 v[172:173], v[44:45], v[118:119], v[118:119] op_sel:[0,0,1] op_sel_hi:[1,0,1] neg_lo:[0,0,1] neg_hi:[0,0,1]
    v_cvt_pk_bf16_f32 v138, v172, v173
    v_lshlrev_b32 v172, 16, v138
    v_and_b32 v173, s90, v138
    v_pk_add_f32 v[172:173], v[172:173], v[44:45]
    v_cvt_pk_bf16_f32 v138, v172, v173
    v_lshlrev_b32 v46, 16, v103
    v_and_b32 v47, s90, v103
    v_pk_fma_f32 v[174:175], v[46:47], v[118:119], v[118:119] op_sel:[0,0,1] op_sel_hi:[1,0,1] neg_lo:[0,0,1] neg_hi:[0,0,1]
    v_cvt_pk_bf16_f32 v139, v174, v175
    v_lshlrev_b32 v174, 16, v139
    v_and_b32 v175, s90, v139
    v_pk_add_f32 v[174:175], v[174:175], v[46:47]
    v_cvt_pk_bf16_f32 v139, v174, v175
    ds_write_b64 v71, v[138:139]
    s_sub_u32 s77, s91, s82
    v_lshrrev_b32 v7, 3, v1
    v_sub_u32_e64 v5, s77, v7
    v_mov_b32 v6, 2146435072
    v_and_b32 v8, 7, v1
    v_lshrrev_b32 v9, 4, v1
    v_xor_b32 v8, v8, v9
    v_lshlrev_b32 v8, 4, v8
    v_lshl_add_u32 v7, v7, 11, v8
    v_xor_b32 v8, 64, v7
    s_lshl_b32 s58, s82, 11
    s_lshl_b32 s59, s98, 7
    s_add_u32 s58, s58, s59
    v_cmp_eq_u32 vcc, 0, v5
    s_nop 1
    v_cndmask_b32 v200, v7, v6, vcc
    v_cmp_eq_u32 vcc, 8, v5
    s_nop 1
    v_cndmask_b32 v201, v8, v6, vcc
    v_cmp_eq_u32 vcc, 16, v5
    s_nop 1
    v_cndmask_b32 v202, v7, v6, vcc
    v_cmp_eq_u32 vcc, 24, v5
    s_nop 1
    v_cndmask_b32 v203, v8, v6, vcc
    s_lshl_b32 s77, s62, 12
    s_add_u32 s77, s77, 0
    v_add_u32 v4, s77, v12
    s_waitcnt lgkmcnt(0)
    ds_read_b128 v[48:51], v4 offset:0
    ds_read_b128 v[52:55], v4 offset:1024
    ds_read_b128 v[56:59], v4 offset:2048
    ds_read_b128 v[60:63], v4 offset:3072
    s_waitcnt lgkmcnt(3)
    buffer_store_dwordx4 v[48:51], v200, s[44:47], s58 offen sc1
    s_add_u32 s58, s58, 16384
    s_waitcnt lgkmcnt(2)
    buffer_store_dwordx4 v[52:55], v201, s[44:47], s58 offen sc1
    s_add_u32 s58, s58, 16384
    s_waitcnt lgkmcnt(1)
    buffer_store_dwordx4 v[56:59], v202, s[44:47], s58 offen sc1
    s_add_u32 s58, s58, 16384
    s_waitcnt lgkmcnt(0)
    buffer_store_dwordx4 v[60:63], v203, s[44:47], s58 offen sc1
    s_barrier
    s_barrier
    s_branch L_cdone
L_stay_84:
    v_and_b32 v7, 15, v1
    v_lshlrev_b32_e64 v7, 3, v7
    s_cmp_eq_u32 s62, 0
    s_cbranch_scc0 L_nos4_85
    s_mul_i32 s76, s98, 9344
    s_add_u32 s76, s76, 8388608
    s_add_u32 s20, s26, s99
    s_addc_u32 s21, s27, 0
    s_mov_b32 s88, 0
L_spin_86:
    s_load_dwordx16 s[4:19], s[20:21], 768 glc
    s_waitcnt lgkmcnt(0)
    s_or_b64 s[4:5], s[4:5], s[6:7]
    s_or_b64 s[4:5], s[4:5], s[8:9]
    s_or_b64 s[4:5], s[4:5], s[10:11]
    s_or_b64 s[4:5], s[4:5], s[12:13]
    s_or_b64 s[4:5], s[4:5], s[14:15]
    s_or_b64 s[4:5], s[4:5], s[16:17]
    s_or_b64 s[4:5], s[4:5], s[18:19]
    s_cbranch_scc0 L_gate_87
    s_add_u32 s88, s88, 1
    s_cmp_lt_u32 s88, 65536
    s_cbranch_scc1 L_spin_86
L_gate_87:
    s_mov_b32 s88, 0
L_poll_88:
    buffer_load_dwordx2 v[196:197], v179, s[40:43], s76 offen offset:256 sc1
    buffer_load_dwordx4 v[188:191], v180, s[40:43], s76 offen offset:0 sc1
    buffer_load_dwordx4 v[192:195], v180, s[40:43], s76 offen offset:64 sc1
    s_waitcnt vmcnt(0)
    v_max3_u32 v4, v196, v197, v188
    v_max3_u32 v4, v4, v189, v190
    v_max3_u32 v4, v4, v191, v192
    v_max3_u32 v4, v4, v193, v194
    v_max_u32 v4, v4, v195
    v_cmp_eq_u32_e64 vcc, -1, v4
    s_nop 0
    s_cbranch_vccz L_ok_89
    s_add_u32 s88, s88, 1
    s_cmp_lt_u32 s88, 65536
    s_cbranch_scc1 L_poll_88
L_ok_89:
    ds_write_b128 v12, v[188:191] offset:28672
    ds_write_b128 v12, v[192:195] offset:29696
    ds_write_b64 v7, v[196:197] offset:25728
L_nos4_85:
    s_waitcnt lgkmcnt(0)
    s_barrier
    ds_read_b64 v[8:9], v7 offset:25728
    s_waitcnt lgkmcnt(0)
    v_max_f32_dpp v4, v8, v8 row_ror:8 row_mask:0xf bank_mask:0xf
    s_nop 1
    v_max_f32_dpp v4, v4, v4 row_ror:4 row_mask:0xf bank_mask:0xf
    s_nop 1
    v_max_f32_dpp v4, v4, v4 row_ror:2 row_mask:0xf bank_mask:0xf
    s_nop 1
    v_max_f32_dpp v4, v4, v4 row_ror:1 row_mask:0xf bank_mask:0xf
    v_cmp_eq_f32 vcc, v4, v8
    s_nop 0
    s_ff1_i32_b32 s92, vcc_lo
    s_and_b32 s92, s92, 15
    s_nop 3
    v_readlane_b32 s91, v9, s92
    s_nop 0
    s_cmp_eq_u32 s91, s79
    s_cbranch_scc0 L_noh_90
    s_mov_b32 exec_hi, 0
    buffer_store_dword v182, v177, s[40:43], s99 offen offset:128 sc1
    s_mov_b64 exec, -1
L_noh_90:
    s_sub_u32 s77, s91, s82
    v_lshrrev_b32 v7, 3, v1
    v_sub_u32 v5, s77, v7
    v_mov_b32 v6, 2146435072
    v_and_b32 v8, 7, v1
    v_lshrrev_b32 v9, 4, v1
    v_xor_b32 v8, v8, v9
    v_lshlrev_b32 v8, 4, v8
    v_lshl_add_u32 v7, v7, 11, v8
    v_xor_b32 v8, 64, v7
    s_lshl_b32 s58, s82, 11
    s_lshl_b32 s59, s98, 7
    s_add_u32 s58, s58, s59
    v_cmp_eq_u32 vcc, 0, v5
    s_nop 1
    v_cndmask_b32 v200, v7, v6, vcc
    v_cmp_eq_u32 vcc, 8, v5
    s_nop 1
    v_cndmask_b32 v201, v8, v6, vcc
    v_cmp_eq_u32 vcc, 16, v5
    s_nop 1
    v_cndmask_b32 v202, v7, v6, vcc
    v_cmp_eq_u32 vcc, 24, v5
    s_nop 1
    v_cndmask_b32 v203, v8, v6, vcc
    s_lshl_b32 s77, s62, 12
    s_add_u32 s77, s77, 0
    v_add_u32 v4, s77, v12
    v_lshlrev_b32 v24, 16, v92
    v_and_b32_e64 v25, s90, v92
    v_pk_fma_f32 v[152:153], v[24:25], v[118:119], v[118:119] op_sel:[0,0,1] op_sel_hi:[1,0,1] neg_lo:[0,0,1] neg_hi:[0,0,1]
    v_cvt_pk_bf16_f32 v128, v152, v153
    v_lshlrev_b32 v152, 16, v128
    v_and_b32 v153, s90, v128
    v_pk_add_f32 v[152:153], v[152:153], v[24:25]
    v_cvt_pk_bf16_f32 v128, v152, v153
    v_lshlrev_b32 v26, 16, v93
    v_and_b32 v27, s90, v93
    v_pk_fma_f32 v[154:155], v[26:27], v[118:119], v[118:119] op_sel:[0,0,1] op_sel_hi:[1,0,1] neg_lo:[0,0,1] neg_hi:[0,0,1]
    v_cvt_pk_bf16_f32 v129, v154, v155
    v_lshlrev_b32 v154, 16, v129
    v_and_b32 v155, s90, v129
    v_pk_add_f32 v[154:155], v[154:155], v[26:27]
    v_cvt_pk_bf16_f32 v129, v154, v155
    ds_write_b64 v66, v[128:129]
    v_lshlrev_b32 v28, 16, v94
    v_and_b32 v29, s90, v94
    v_pk_fma_f32 v[156:157], v[28:29], v[118:119], v[118:119] op_sel:[0,0,1] op_sel_hi:[1,0,1] neg_lo:[0,0,1] neg_hi:[0,0,1]
    v_cvt_pk_bf16_f32 v130, v156, v157
    v_lshlrev_b32 v156, 16, v130
    v_and_b32 v157, s90, v130
    v_pk_add_f32 v[156:157], v[156:157], v[28:29]
    v_cvt_pk_bf16_f32 v130, v156, v157
    v_lshlrev_b32 v30, 16, v95
    v_and_b32 v31, s90, v95
    v_pk_fma_f32 v[158:159], v[30:31], v[118:119], v[118:119] op_sel:[0,0,1] op_sel_hi:[1,0,1] neg_lo:[0,0,1] neg_hi:[0,0,1]
    v_cvt_pk_bf16_f32 v131, v158, v159
    v_lshlrev_b32 v158, 16, v131
    v_and_b32 v159, s90, v131
    v_pk_add_f32 v[158:159], v[158:159], v[30:31]
    v_cvt_pk_bf16_f32 v131, v158, v159
    ds_write_b64 v67, v[130:131]
    v_lshlrev_b32 v32, 16, v96
    v_and_b32 v33, s90, v96
    v_pk_fma_f32 v[160:161], v[32:33], v[118:119], v[118:119] op_sel:[0,0,1] op_sel_hi:[1,0,1] neg_lo:[0,0,1] neg_hi:[0,0,1]
    v_cvt_pk_bf16_f32 v132, v160, v161
    v_lshlrev_b32 v160, 16, v132
    v_and_b32 v161, s90, v132
    v_pk_add_f32 v[160:161], v[160:161], v[32:33]
    v_cvt_pk_bf16_f32 v132, v160, v161
    v_lshlrev_b32 v34, 16, v97
    v_and_b32 v35, s90, v97
    v_pk_fma_f32 v[162:163], v[34:35], v[118:119], v[118:119] op_sel:[0,0,1] op_sel_hi:[1,0,1] neg_lo:[0,0,1] neg_hi:[0,0,1]
    v_cvt_pk_bf16_f32 v133, v162, v163
    v_lshlrev_b32 v162, 16, v133
    v_and_b32 v163, s90, v133
    v_pk_add_f32 v[162:163], v[162:163], v[34:35]
    v_cvt_pk_bf16_f32 v133, v162, v163
    ds_write_b64 v68, v[132:133]
    v_lshlrev_b32 v36, 16, v98
    v_and_b32 v37, s90, v98
    v_pk_fma_f32 v[164:165], v[36:37], v[118:119], v[118:119] op_sel:[0,0,1] op_sel_hi:[1,0,1] neg_lo:[0,0,1] neg_hi:[0,0,1]
    v_cvt_pk_bf16_f32 v134, v164, v165
    v_lshlrev_b32 v164, 16, v134
    v_and_b32 v165, s90, v134
    v_pk_add_f32 v[164:165], v[164:165], v[36:37]
    v_cvt_pk_bf16_f32 v134, v164, v165
    v_lshlrev_b32 v38, 16, v99
    v_and_b32 v39, s90, v99
    v_pk_fma_f32 v[166:167], v[38:39], v[118:119], v[118:119] op_sel:[0,0,1] op_sel_hi:[1,0,1] neg_lo:[0,0,1] neg_hi:[0,0,1]
    v_cvt_pk_bf16_f32 v135, v166, v167
    v_lshlrev_b32 v166, 16, v135
    v_and_b32 v167, s90, v135
    v_pk_add_f32 v[166:167], v[166:167], v[38:39]
    v_cvt_pk_bf16_f32 v135, v166, v167
    ds_write_b64 v69, v[134:135]
    v_lshlrev_b32 v40, 16, v100
    v_and_b32 v41, s90, v100
    v_pk_fma_f32 v[168:169], v[40:41], v[118:119], v[118:119] op_sel:[0,0,1] op_sel_hi:[1,0,1] neg_lo:[0,0,1] neg_hi:[0,0,1]
    v_cvt_pk_bf16_f32 v136, v168, v169
    v_lshlrev_b32 v168, 16, v136
    v_and_b32 v169, s90, v136
    v_pk_add_f32 v[168:169], v[168:169], v[40:41]
    v_cvt_pk_bf16_f32 v136, v168, v169
    v_lshlrev_b32 v42, 16, v101
    v_and_b32 v43, s90, v101
    v_pk_fma_f32 v[170:171], v[42:43], v[118:119], v[118:119] op_sel:[0,0,1] op_sel_hi:[1,0,1] neg_lo:[0,0,1] neg_hi:[0,0,1]
    v_cvt_pk_bf16_f32 v137, v170, v171
    v_lshlrev_b32 v170, 16, v137
    v_and_b32 v171, s90, v137
    v_pk_add_f32 v[170:171], v[170:171], v[42:43]
    v_cvt_pk_bf16_f32 v137, v170, v171
    ds_write_b64 v70, v[136:137]
    v_lshlrev_b32 v44, 16, v102
    v_and_b32 v45, s90, v102
    v_pk_fma_f32 v[172:173], v[44:45], v[118:119], v[118:119] op_sel:[0,0,1] op_sel_hi:[1,0,1] neg_lo:[0,0,1] neg_hi:[0,0,1]
    v_cvt_pk_bf16_f32 v138, v172, v173
    v_lshlrev_b32 v172, 16, v138
    v_and_b32 v173, s90, v138
    v_pk_add_f32 v[172:173], v[172:173], v[44:45]
    v_cvt_pk_bf16_f32 v138, v172, v173
    v_lshlrev_b32 v46, 16, v103
    v_and_b32 v47, s90, v103
    v_pk_fma_f32 v[174:175], v[46:47], v[118:119], v[118:119] op_sel:[0,0,1] op_sel_hi:[1,0,1] neg_lo:[0,0,1] neg_hi:[0,0,1]
    v_cvt_pk_bf16_f32 v139, v174, v175
    v_lshlrev_b32 v174, 16, v139
    v_and_b32 v175, s90, v139
    v_pk_add_f32 v[174:175], v[174:175], v[46:47]
    v_cvt_pk_bf16_f32 v139, v174, v175
    ds_write_b64 v71, v[138:139]
    s_barrier
    s_waitcnt lgkmcnt(0)
    ds_read_b128 v[48:51], v4 offset:0
    ds_read_b128 v[52:55], v4 offset:1024
    ds_read_b128 v[56:59], v4 offset:2048
    ds_read_b128 v[60:63], v4 offset:3072
    s_waitcnt lgkmcnt(3)
    buffer_store_dwordx4 v[48:51], v200, s[44:47], s58 offen sc1
    s_add_u32 s58, s58, 16384
    s_waitcnt lgkmcnt(2)
    buffer_store_dwordx4 v[52:55], v201, s[44:47], s58 offen sc1
    s_add_u32 s58, s58, 16384
    s_waitcnt lgkmcnt(1)
    buffer_store_dwordx4 v[56:59], v202, s[44:47], s58 offen sc1
    s_add_u32 s58, s58, 16384
    s_waitcnt lgkmcnt(0)
    buffer_store_dwordx4 v[60:63], v203, s[44:47], s58 offen sc1
L_cdone:
L_cfin:
L_end:
    s_endpgm
L_tr0:
    s_mov_b32 s88, 0
L_trq:
    ds_read_b32 v79, v8 offset:25984
    s_waitcnt lgkmcnt(0)
    v_readfirstlane_b32 s76, v79
    s_nop 0
    s_and_b32 s76, s76, s52
    s_cbranch_scc1 L_bk0
    s_add_u32 s88, s88, 1
    s_cmp_lt_u32 s88, 5
    s_cbranch_scc1 L_trq
    s_cmp_eq_u32 s53, 0
    s_cbranch_scc0 L_sent_68
    s_waitcnt vmcnt(0)
    s_mov_b64 exec, 1
    ds_add_u32 v8, v74 offset:25988
    s_mov_b64 exec, -1
    s_mov_b32 s53, 1
L_sent_68:
    s_call_b64 s[54:55], L_stall
    s_branch L_bk0
L_tr1:
    s_cmp_eq_u32 s53, 0
    s_cbranch_scc0 L_sent_69
    s_waitcnt vmcnt(4)
    s_mov_b64 exec, 1
    ds_add_u32 v8, v74 offset:25988
    s_mov_b64 exec, -1
    s_mov_b32 s53, 1
L_sent_69:
    s_call_b64 s[54:55], L_stall
    s_branch L_bk1
L_tr2:
    s_call_b64 s[54:55], L_stall
    s_branch L_bk2
L_tr3:
    s_call_b64 s[54:55], L_stall
    s_branch L_bk3
L_tr4:
    s_call_b64 s[54:55], L_stall
    s_branch L_bk4
L_tr5:
    s_call_b64 s[54:55], L_stall
    s_branch L_bk5
L_tr6:
    s_call_b64 s[54:55], L_stall
    s_branch L_bk6
L_tr7:
    s_call_b64 s[54:55], L_stall
    s_branch L_bk7
L_tr8:
    s_call_b64 s[54:55], L_stall
    s_branch L_bk8
L_tr9:
    s_call_b64 s[54:55], L_stall
    s_branch L_bk9
L_tr10:
    s_call_b64 s[54:55], L_stall
    s_branch L_bk10
L_tr11:
    s_call_b64 s[54:55], L_stall
    s_branch L_bk11
L_tr12:
    s_call_b64 s[54:55], L_stall
    s_branch L_bk12
L_tr13:
    s_call_b64 s[54:55], L_stall
    s_branch L_bk13
L_tr14:
    s_call_b64 s[54:55], L_stall
    s_branch L_bk14
L_tr15:
    s_call_b64 s[54:55], L_stall
    s_branch L_bk15
L_stall:
    s_cmp_eq_u32 s53, 0
    s_cbranch_scc0 L_sent_67
    s_waitcnt vmcnt(0)
    s_mov_b64 exec, 1
    ds_add_u32 v8, v74 offset:25988
    s_mov_b64 exec, -1
    s_mov_b32 s53, 1
L_sent_67:
    s_mov_b32 s88, 0
L_stall1:
    ds_read_b32 v79, v8 offset:25984
    s_waitcnt lgkmcnt(0)
    v_readfirstlane_b32 s76, v79
    s_nop 0
    s_and_b32 s76, s76, s52
    s_cbranch_scc1 L_stall2
    s_add_u32 s88, s88, 1
    s_cmp_lt_u32 s88, 1048576
    s_cbranch_scc1 L_stall1
    s_mov_b32 s76, s52
L_stall2:
    s_setpc_b64 s[54:55]
L_s3_73:
    v_cmp_eq_u32_e64 vcc, -1, v115
    s_nop 0
    s_cbranch_vccz L_s3skip_75
    buffer_load_dwordx4 v[112:115], v178, s[40:43], s78 offen offset:1024 sc1
L_s3skip_75:
    v_cmp_eq_u32_e64 vcc, -1, v119
    s_nop 0
    s_cbranch_vccz L_s3skip_76
    buffer_load_dwordx4 v[116:119], v178, s[40:43], s48 offen offset:1024 sc1
L_s3skip_76:
    v_cmp_eq_u32_e64 vcc, -1, v123
    s_nop 0
    s_cbranch_vccz L_s3skip_77
    buffer_load_dwordx4 v[120:123], v178, s[40:43], s49 offen offset:1024 sc1
L_s3skip_77:
    v_cmp_eq_u32_e64 vcc, -1, v127
    s_nop 0
    s_cbranch_vccz L_s3skip_78
    buffer_load_dwordx4 v[124:127], v178, s[40:43], s50 offen offset:1024 sc1
L_s3skip_78:
    v_cmp_eq_u32_e64 vcc, -1, v131
    s_nop 0
    s_cbranch_vccz L_s3skip_79
    buffer_load_dwordx4 v[128:131], v178, s[40:43], s51 offen offset:1024 sc1
L_s3skip_79:
    v_cmp_eq_u32_e64 vcc, -1, v135
    s_nop 0
    s_cbranch_vccz L_s3skip_80
    buffer_load_dwordx4 v[132:135], v178, s[40:43], s52 offen offset:1024 sc1
L_s3skip_80:
    v_cmp_eq_u32_e64 vcc, -1, v139
    s_nop 0
    s_cbranch_vccz L_s3skip_81
    buffer_load_dwordx4 v[136:139], v178, s[40:43], s53 offen offset:1024 sc1
L_s3skip_81:
    v_cmp_eq_u32_e64 vcc, -1, v143
    s_nop 0
    s_cbranch_vccz L_s3skip_82
    buffer_load_dwordx4 v[140:143], v178, s[40:43], s54 offen offset:1024 sc1
L_s3skip_82:
    s_waitcnt vmcnt(0)
    v_pk_add_f32 v[108:109], v[112:113], v[116:117]
    v_pk_add_f32 v[110:111], v[114:115], v[118:119]
    v_pk_add_f32 v[108:109], v[108:109], v[120:121]
    v_pk_add_f32 v[110:111], v[110:111], v[122:123]
    v_pk_add_f32 v[108:109], v[108:109], v[124:125]
    v_pk_add_f32 v[110:111], v[110:111], v[126:127]
    v_pk_add_f32 v[108:109], v[108:109], v[128:129]
    v_pk_add_f32 v[110:111], v[110:111], v[130:131]
    v_pk_add_f32 v[108:109], v[108:109], v[132:133]
    v_pk_add_f32 v[110:111], v[110:111], v[134:135]
    v_pk_add_f32 v[108:109], v[108:109], v[136:137]
    v_pk_add_f32 v[110:111], v[110:111], v[138:139]
    v_pk_add_f32 v[108:109], v[108:109], v[140:141]
    v_pk_add_f32 v[110:111], v[110:111], v[142:143]
    v_cmp_u_f32 vcc, v111, v111
    v_mov_b32 v4, v108
    v_mov_b32 v5, v109
    v_mov_b32_e64 v6, v110
    s_cbranch_vccz L_s3ok_74
    s_add_u32 s88, s88, 1
    s_cmp_lt_u32 s88, 65536
    s_cbranch_scc1 L_s3_73
    s_branch L_s3ok_74
L_code_end:
s_endpgm
.p2align 7
.type L_table,@object
L_table:
.long 0x650c3824, 0xfedba97, 0x50110, 0x3006
.long 0x650c3824, 0xfedba97, 0x520200, 0x3060
.long 0x641d0935, 0xfecba87, 0x5000011, 0x3600
.long 0x76543218, 0xfedcba9, 0x15000010, 0x6300
.long 0x641d0935, 0xfecba87, 0x25200, 0x3006
.long 0x54e2a160, 0xfdcb987, 0x501001, 0x3060
.long 0x54e2a160, 0xfdcb987, 0x5000022, 0x3600
.long 0x54f3b271, 0xedca986, 0x50101000, 0x6300
.long 0x54f3b271, 0xedca986, 0x250020, 0x3006
.long 0x650c3824, 0xfedba97, 0x510001, 0x3060
.long 0x650c3824, 0xfedba97, 0x5000202, 0x3600
.long 0x76543218, 0xfedcba9, 0x50000202, 0x6300
.long 0x641d0935, 0xfecba87, 0x15100, 0x3006
.long 0x641d0935, 0xfecba87, 0x500022, 0x3060
.long 0x54e2a160, 0xfdcb987, 0x5100010, 0x3600
.long 0x54e2a160, 0xfdcb987, 0x50202000, 0x6300
.long 0x641d0935, 0xfecba87, 0x500011, 0x3060
.long 0x641d0935, 0xfecba87, 0x5020020, 0x3600
.long 0x54e2a160, 0xfdcb987, 0x50001010, 0x6300
.long 0x76543209, 0xfedcba8, 0x15010, 0x3006
.long 0x54e2a160, 0xfdcb987, 0x500022, 0x3060
.long 0x54f3b271, 0xedca986, 0x5100001, 0x3600
.long 0x54f3b271, 0xedca986, 0x50002020, 0x6300
.long 0x650c3824, 0xfedba97, 0x15100, 0x3006
.long 0x650c3824, 0xfedba97, 0x520020, 0x3060
.long 0x641d0935, 0xfecba87, 0x5010100, 0x3600
.long 0x641d0935, 0xfecba87, 0x50020200, 0x6300
.long 0x76543209, 0xfedcba8, 0x250002, 0x3006
.long 0x54e2a160, 0xfdcb987, 0x5110000, 0x3060
.long 0x54e2a160, 0xfdcb987, 0x5200002, 0x3600
.long 0x54f3b271, 0xedca986, 0x50001010, 0x6300
.long 0x54f3b271, 0xedca986, 0x52020, 0x3006
.long 0x54e2a160, 0xfdcb987, 0x5100100, 0x3600
.long 0x54e2a160, 0xfdcb987, 0x50002002, 0x6300
.long 0x54f3b271, 0xedca986, 0x150010, 0x3006
.long 0x765431a0, 0xfedcb98, 0x150001, 0x3060
.long 0x54f3b271, 0xedca986, 0x5000022, 0x3600
.long 0x650c3824, 0xfedba97, 0x50000101, 0x6300
.long 0x650c3824, 0xfedba97, 0x50220, 0x3006
.long 0x641d0935, 0xfecba87, 0x510100, 0x3060
.long 0x641d0935, 0xfecba87, 0x5000022, 0x3600
.long 0x54e2a160, 0xfdcb987, 0x50001010, 0x6300
.long 0x54e2a160, 0xfdcb987, 0x250002, 0x3006
.long 0x765431a0, 0xfedcb98, 0x500220, 0x3060
.long 0x54f3b271, 0xedca986, 0x5001100, 0x3600
.long 0x54f3b271, 0xedca986, 0x50000022, 0x6300
.long 0x650c3824, 0xfedba97, 0x511000, 0x3006
.long 0x650c3824, 0xfedba97, 0x520002, 0x3060
.long 0x54f3b271, 0xedca986, 0x50100001, 0x6300
.long 0x54f3b271, 0xedca986, 0x52002, 0x3006
.long 0x650c3824, 0xfedba97, 0x500101, 0x3060
.long 0x765421b0, 0xfedca98, 0x1500001, 0x3600
.long 0x650c3824, 0xfedba97, 0x50000022, 0x6300
.long 0x641d0935, 0xfecba87, 0x15100, 0x3006
.long 0x641d0935, 0xfecba87, 0x520020, 0x3060
.long 0x54e2a160, 0xfdcb987, 0x5101000, 0x3600
.long 0x54e2a160, 0xfdcb987, 0x50002020, 0x6300
.long 0x54f3b271, 0xedca986, 0x51010, 0x3006
.long 0x54f3b271, 0xedca986, 0x250020, 0x3060
.long 0x765421b0, 0xfedca98, 0x5000022, 0x3600
.long 0x650c3824, 0xfedba97, 0x50010010, 0x6300
.long 0x650c3824, 0xfedba97, 0x25200, 0x3006
.long 0x641d0935, 0xfecba87, 0x500011, 0x3060
.long 0x641d0935, 0xfecba87, 0x5020200, 0x3600
.long 0x650c3824, 0xfedba97, 0x51010, 0x3006
.long 0x650c3824, 0xfedba97, 0x500022, 0x3060
.long 0x641d0935, 0xfecba87, 0x5100100, 0x3600
.long 0x76532c10, 0xfedba98, 0x15000100, 0x6300
.long 0x641d0935, 0xfecba87, 0x50022, 0x3006
.long 0x54e2a160, 0xfdcb987, 0x150010, 0x3060
.long 0x54e2a160, 0xfdcb987, 0x5202000, 0x3600
.long 0x54f3b271, 0xedca986, 0x50101000, 0x6300
.long 0x54f3b271, 0xedca986, 0x52002, 0x3006
.long 0x650c3824, 0xfedba97, 0x500101, 0x3060
.long 0x650c3824, 0xfedba97, 0x5020020, 0x3600
.long 0x76532c10, 0xfedba98, 0x52000200, 0x6300
.long 0x641d0935, 0xfecba87, 0x15001, 0x3006
.long 0x641d0935, 0xfecba87, 0x520200, 0x3060
.long 0x54e2a160, 0xfdcb987, 0x5001001, 0x3600
.long 0x54e2a160, 0xfdcb987, 0x50000022, 0x6300
.long 0x641d0935, 0xfecba87, 0x501001, 0x3060
.long 0x641d0935, 0xfecba87, 0x5000202, 0x3600
.long 0x54e2a160, 0xfdcb987, 0x50100100, 0x6300
.long 0x76432d10, 0xfecba98, 0x150100, 0x3006
.long 0x54e2a160, 0xfdcb987, 0x252000, 0x3060
.long 0x54f3b271, 0xedca986, 0x5101000, 0x3600
.long 0x54f3b271, 0xedca986, 0x50200002, 0x6300
.long 0x650c3824, 0xfedba97, 0x15100, 0x3006
.long 0x650c3824, 0xfedba97, 0x500202, 0x3060
.long 0x641d0935, 0xfecba87, 0x5000110, 0x3600
.long 0x641d0935, 0xfecba87, 0x50000022, 0x6300
.long 0x76432d10, 0xfecba98, 0x20050200, 0x3006
.long 0x54e2a160, 0xfdcb987, 0x501010, 0x3060
.long 0x54e2a160, 0xfdcb987, 0x5002020, 0x3600
.long 0x54f3b271, 0xedca986, 0x50000110, 0x6300
.long 0x54f3b271, 0xedca986, 0x250002, 0x3006
.long 0x54e2a160, 0xfdcb987, 0x5000011, 0x3600
.long 0x54e2a160, 0xfdcb987, 0x50200020, 0x6300
.long 0x54f3b271, 0xedca986, 0x115000, 0x3006
.long 0x7543e210, 0xfdcba98, 0x501010, 0x3060
.long 0x54f3b271, 0xedca986, 0x5202000, 0x3600
.long 0x650c3824, 0xfedba97, 0x51000001, 0x6300
.long 0x650c3824, 0xfedba97, 0x25002, 0x3006
.long 0x641d0935, 0xfecba87, 0x510100, 0x3060
.long 0x641d0935, 0xfecba87, 0x5020200, 0x3600
.long 0x54e2a160, 0xfdcb987, 0x50011000, 0x6300
.long 0x54e2a160, 0xfdcb987, 0x52020, 0x3006
.long 0x7543e210, 0xfdcba98, 0x522000, 0x3060
.long 0x54f3b271, 0xedca986, 0x5001010, 0x3600
.long 0x54f3b271, 0xedca986, 0x50202000, 0x6300
.long 0x650c3824, 0xfedba97, 0x15100, 0x3006
.long 0x650c3824, 0xfedba97, 0x500220, 0x3060
.long 0x54f3b271, 0xedca986, 0x50001010, 0x6300
.long 0x54f3b271, 0xedca986, 0x250020, 0x3006
.long 0x650c3824, 0xfedba97, 0x500110, 0x3060
.long 0x6543f210, 0xedcba98, 0x15000001, 0x3600
.long 0x650c3824, 0xfedba97, 0x50020200, 0x6300
.long 0x641d0935, 0xfecba87, 0x15001, 0x3006
.long 0x641d0935, 0xfecba87, 0x500202, 0x3060
.long 0x54e2a160, 0xfdcb987, 0x5101000, 0x3600
.long 0x54e2a160, 0xfdcb987, 0x50200002, 0x6300
.long 0x54f3b271, 0xedca986, 0x150001, 0x3006
.long 0x54f3b271, 0xedca986, 0x502002, 0x3060
.long 0x6543f210, 0xedcba98, 0x5202000, 0x3600
.long 0x650c3824, 0xfedba97, 0x50010001, 0x6300
.long 0x650c3824, 0xfedba97, 0x50022, 0x3006
.long 0x641d0935, 0xfecba87, 0x500110, 0x3060
.long 0x641d0935, 0xfecba87, 0x5000022, 0x3600
.long 0x650c3824, 0xfedba97, 0x25002, 0x3006
.long 0x650c3824, 0xfedba97, 0x510010, 0x3060
.long 0x641d0935, 0xfecba87, 0x5020200, 0x3600
.long 0x76543218, 0xfedcba9, 0x50000022, 0x6300
.long 0x641d0935, 0xfecba87, 0x50110, 0x3006
.long 0x54e2a160, 0xfdcb987, 0x250002, 0x3060
.long 0x54e2a160, 0xfdcb987, 0x5101000, 0x3600
.long 0x54f3b271, 0xedca986, 0x50002002, 0x6300
.long 0x54f3b271, 0xedca986, 0x151000, 0x3006
.long 0x650c3824, 0xfedba97, 0x520020, 0x3060
.long 0x650c3824, 0xfedba97, 0x5000101, 0x3600
.long 0x76543218, 0xfedcba9, 0x15000010, 0x6300
.long 0x641d0935, 0xfecba87, 0x25200, 0x3006
.long 0x641d0935, 0xfecba87, 0x510001, 0x3060
.long 0x54e2a160, 0xfdcb987, 0x5000022, 0x3600
.long 0x54e2a160, 0xfdcb987, 0x50000011, 0x6300
.long 0x641d0935, 0xfecba87, 0x500022, 0x3060
.long 0x641d0935, 0xfecba87, 0x5000011, 0x3600
.long 0x54e2a160, 0xfdcb987, 0x50000022, 0x6300
.long 0x76543209, 0xfedcba8, 0x52002, 0x3006
.long 0x54e2a160, 0xfdcb987, 0x501010, 0x3060
.long 0x54f3b271, 0xedca986, 0x5002020, 0x3600
.long 0x54f3b271, 0xedca986, 0x50000011, 0x6300
.long 0x650c3824, 0xfedba97, 0x25020, 0x3006
.long 0x650c3824, 0xfedba97, 0x510100, 0x3060
.long 0x641d0935, 0xfecba87, 0x5000220, 0x3600
.long 0x641d0935, 0xfecba87, 0x50010100, 0x6300
.long 0x76543209, 0xfedcba8, 0x15100, 0x3006
.long 0x54e2a160, 0xfdcb987, 0x252000, 0x3060
.long 0x54e2a160, 0xfdcb987, 0x5100001, 0x3600
.long 0x54f3b271, 0xedca986, 0x50200020, 0x6300
.long 0x54f3b271, 0xedca986, 0x151000, 0x3006
.long 0x54e2a160, 0xfdcb987, 0x5200002, 0x3600
.long 0x54e2a160, 0xfdcb987, 0x50100100, 0x6300
.long 0x54f3b271, 0xedca986, 0x250002, 0x3006
.long 0x765431a0, 0xfedcb98, 0x520020, 0x3060
.long 0x54f3b271, 0xedca986, 0x5001010, 0x3600
.long 0x650c3824, 0xfedba97, 0x50020200, 0x6300
.long 0x650c3824, 0xfedba97, 0x50101, 0x3006
.long 0x641d0935, 0xfecba87, 0x520200, 0x3060
.long 0x641d0935, 0xfecba87, 0x5010100, 0x3600
.long 0x54e2a160, 0xfdcb987, 0x50202000, 0x6300
.long 0x54e2a160, 0xfdcb987, 0x50011, 0x3006
.long 0x765431a0, 0xfedcb98, 0x150010, 0x3060
.long 0x54f3b271, 0xedca986, 0x5200020, 0x3600
.long 0x54f3b271, 0xedca986, 0x50100100, 0x6300
.long 0x650c3824, 0xfedba97, 0x25002, 0x3006
.long 0x650c3824, 0xfedba97, 0x511000, 0x3060
.long 0x54f3b271, 0xedca986, 0x50002002, 0x6300
.long 0x54f3b271, 0xedca986, 0x150010, 0x3006
.long 0x650c3824, 0xfedba97, 0x520200, 0x3060
.long 0x765421b0, 0xfedca98, 0x25000020, 0x3600
.long 0x650c3824, 0xfedba97, 0x50000101, 0x6300
.long 0x641d0935, 0xfecba87, 0x50022, 0x3006
.long 0x641d0935, 0xfecba87, 0x510001, 0x3060
.long 0x54e2a160, 0xfdcb987, 0x5200020, 0x3600
.long 0x54e2a160, 0xfdcb987, 0x50101000, 0x6300
.long 0x54f3b271, 0xedca986, 0x50022, 0x3006
.long 0x54f3b271, 0xedca986, 0x500101, 0x3060
.long 0x765421b0, 0xfedca98, 0x1500010, 0x3600
.long 0x650c3824, 0xfedba97, 0x50000022, 0x6300
.long 0x650c3824, 0xfedba97, 0x511000, 0x3006
.long 0x641d0935, 0xfecba87, 0x520200, 0x3060
.long 0x641d0935, 0xfecba87, 0x5001100, 0x3600
.long 0x650c3824, 0xfedba97, 0x50220, 0x3006
.long 0x650c3824, 0xfedba97, 0x500101, 0x3060
.long 0x641d0935, 0xfecba87, 0x5000022, 0x3600
.long 0x76532c10, 0xfedba98, 0x50000202, 0x6300
.long 0x641d0935, 0xfecba87, 0x50101, 0x3006
.long 0x54e2a160, 0xfdcb987, 0x502020, 0x3060
.long 0x54e2a160, 0xfdcb987, 0x5101000, 0x3600
.long 0x54f3b271, 0xedca986, 0x50200020, 0x6300
.long 0x54f3b271, 0xedca986, 0x151000, 0x3006
.long 0x650c3824, 0xfedba97, 0x500202, 0x3060
.long 0x650c3824, 0xfedba97, 0x5010010, 0x3600
.long 0x76532c10, 0xfedba98, 0x15000001, 0x6300
.long 0x641d0935, 0xfecba87, 0x50022, 0x3006
.long 0x641d0935, 0xfecba87, 0x510010, 0x3060
.long 0x54e2a160, 0xfdcb987, 0x5202000, 0x3600
.long 0x54e2a160, 0xfdcb987, 0x50000110, 0x6300
.long 0x641d0935, 0xfecba87, 0x520200, 0x3060
.long 0x641d0935, 0xfecba87, 0x5000110, 0x3600
.long 0x54e2a160, 0xfdcb987, 0x50202000, 0x6300
.long 0x76432d10, 0xfecba98, 0x52200, 0x3006
.long 0x54e2a160, 0xfdcb987, 0x151000, 0x3060
.long 0x54f3b271, 0xedca986, 0x5200002, 0x3600
.long 0x54f3b271, 0xedca986, 0x50100100, 0x6300
.long 0x650c3824, 0xfedba97, 0x50202, 0x3006
.long 0x650c3824, 0xfedba97, 0x510100, 0x3060
.long 0x641d0935, 0xfecba87, 0x5020002, 0x3600
.long 0x641d0935, 0xfecba87, 0x50010001, 0x6300
.long 0x76432d10, 0xfecba98, 0x150010, 0x3006
.long 0x54e2a160, 0xfdcb987, 0x500022, 0x3060
.long 0x54e2a160, 0xfdcb987, 0x5000011, 0x3600
.long 0x54f3b271, 0xedca986, 0x50002002, 0x6300
.long 0x54f3b271, 0xedca986, 0x51010, 0x3006
.long 0x54e2a160, 0xfdcb987, 0x5002020, 0x3600
.long 0x54e2a160, 0xfdcb987, 0x50101000, 0x6300
.long 0x54f3b271, 0xedca986, 0x52020, 0x3006
.long 0x7543e210, 0xfdcba98, 0x2502000, 0x3060
.long 0x54f3b271, 0xedca986, 0x5001010, 0x3600
.long 0x650c3824, 0xfedba97, 0x50000022, 0x6300
.long 0x650c3824, 0xfedba97, 0x15100, 0x3006
.long 0x641d0935, 0xfecba87, 0x500022, 0x3060
.long 0x641d0935, 0xfecba87, 0x5010100, 0x3600
.long 0x54e2a160, 0xfdcb987, 0x50000022, 0x6300
.long 0x54e2a160, 0xfdcb987, 0x50011, 0x3006
.long 0x7543e210, 0xfdcba98, 0x1500010, 0x3060
.long 0x54f3b271, 0xedca986, 0x5002002, 0x3600
.long 0x54f3b271, 0xedca986, 0x50110000, 0x6300
.long 0x650c3824, 0xfedba97, 0x50220, 0x3006
.long 0x650c3824, 0xfedba97, 0x500011, 0x3060
.long 0x54f3b271, 0xedca986, 0x50200020, 0x6300
.long 0x54f3b271, 0xedca986, 0x15010, 0x3006
.long 0x650c3824, 0xfedba97, 0x500022, 0x3060
.long 0x6543f210, 0xedcba98, 0x25002000, 0x3600
.long 0x650c3824, 0xfedba97, 0x50000101, 0x6300
.long 0x641d0935, 0xfecba87, 0x25200, 0x3006
.long 0x641d0935, 0xfecba87, 0x511000, 0x3060
.long 0x54e2a160, 0xfdcb987, 0x5002002, 0x3600
.long 0x54e2a160, 0xfdcb987, 0x50101000, 0x6300
.long 0x54f3b271, 0xedca986, 0x252000, 0x3006
.long 0x54f3b271, 0xedca986, 0x501001, 0x3060
.long 0x6543f210, 0xedcba98, 0x15001000, 0x3600
.long 0x650c3824, 0xfedba97, 0x50020200, 0x6300
.long 0x650c3824, 0xfedba97, 0x15010, 0x3006
.long 0x641d0935, 0xfecba87, 0x500022, 0x3060
.long 0x641d0935, 0xfecba87, 0x5000101, 0x3600
.fill 1, 4, 0
.size L_table, .-L_table
.section .rodata,"a"
.p2align 6
.amdhsa_kernel sequential_preLN__linear_kernel_hedgehog__moe_arch_mod__prompt_kernel
  .amdhsa_next_free_vgpr 256
  .amdhsa_next_free_sgpr 102
  .amdhsa_accum_offset 256
  .amdhsa_group_segment_fixed_size 0
  .amdhsa_kernarg_size 96
  .amdhsa_user_sgpr_count 2
  .amdhsa_user_sgpr_kernarg_segment_ptr 1
  .amdhsa_system_sgpr_workgroup_id_x 1
  .amdhsa_float_denorm_mode_32 3
.end_amdhsa_kernel
```

```asm
; @launch grid=(256,1,1) block=(512,1,1) lds=163840
.amdgcn_target "amdgcn-amd-amdhsa--gfx950"
.text
.p2align 10
.fill 64, 4, 0xbf800000
.globl sequential_preLN__linear_kernel_hedgehog__moe_arch_mod__prompt_kernel
.p2align 8
.type sequential_preLN__linear_kernel_hedgehog__moe_arch_mod__prompt_kernel,@function
sequential_preLN__linear_kernel_hedgehog__moe_arch_mod__prompt_kernel:
    s_load_dwordx2 s[28:29], s[0:1], 0
    s_load_dwordx2 s[32:33], s[0:1], 8
    s_getpc_b64 s[66:67]
L_pc:
    v_readfirstlane_b32 s79, v0
    s_lshr_b32 s60, s2, 3
    s_cmp_ge_u32 s60, 32
    s_cbranch_scc1 L_end
    v_and_b32_e64 v1, 63, v0
    s_and_b32 s60, s60, 15
    s_lshr_b32 s62, s79, 6
    s_cmp_ge_u32 s62, 4
    s_cbranch_scc1 L_compute
    s_setprio 3
    s_lshr_b32 s76, s2, 3
    s_lshl2_add_u32 s76, s76, s62
    s_mul_i32 s76, s76, 256
    v_lshl_add_u32 v91, v1, 7, s76
    s_mov_b64 exec, 3
    global_load_dword v27, v91, s[66:67]
    s_mov_b64 exec, -1
    s_add_u32 s84, s60, s2
    s_and_b32 s84, s84, 3
    s_and_b32 s76, s60, 7
    s_and_b32 s77, s2, 7
    s_cselect_b32 s84, s84, s76
    v_lshrrev_b32 v4, 3, v1
    v_and_b32 v5, 7, v1
    v_lshrrev_b32 v6, 4, v1
    s_lshl2_add_u32 s76, s60, s62
    s_lshl_b32 s76, s76, 16
    s_movk_i32 s70, 10240
    s_mul_i32 s70, s70, s62
    v_xor_b32 v7, v5, v6
    v_lshlrev_b32 v7, 4, v7
    v_lshl_add_u32 v78, v4, 11, v7
    v_add_u32_e64 v16, s76, v78
    s_mov_b32 s30, 4194304
    s_mov_b32 s31, 0x20000
    s_and_b32 s72, s84, 15
    s_mov_b32 m0, s70
    s_lshl_b32 s71, s72, 7
    s_waitcnt lgkmcnt(0)
    buffer_load_dwordx4 v16, s[28:31], s71 offen offset:0 lds
    s_mul_i32 s72, s72, 393216
    s_lshr_b64 s[84:85], s[84:85], 4
    s_load_dwordx4 s[8:11], s[0:1], 16
    s_load_dwordx16 s[12:27], s[0:1], 32
    v_xor_b32 v7, 64, v16
    v_add_u32 v17, 15360, v7
    buffer_load_dwordx4 v17, s[28:31], s71 offen offset:1024 lds
    v_add_u32 v18, 30720, v16
    buffer_load_dwordx4 v18, s[28:31], s71 offen offset:2048 lds
    v_add_u32 v19, 46080, v7
    buffer_load_dwordx4 v19, s[28:31], s71 offen offset:3072 lds
    s_and_b32 s76, s2, 7
    s_lshl_b32 s76, s76, 3
    s_lshr_b32 s77, s2, 7
    s_lshl2_add_u32 s76, s77, s76
    s_mov_b32 s80, 0x654210b3
    s_mov_b32 s81, 0xfedca987
    s_lshr_b64 s[80:81], s[80:81], s76
    s_and_b32 s61, s80, 15
    v_and_b32 v6, 1, v6
    v_lshlrev_b32 v6, 2, v6
    v_xor_b32 v8, v5, v6
    v_lshlrev_b32_e64 v8, 4, v8
    s_lshl_b32 s76, s61, 7
    s_mul_i32 s77, s62, 98304
    s_add_u32 s76, s76, s77
    v_mul_u32_u24 v7, 6144, v4
    v_add3_u32 v20, v7, v8, s76
    v_xor_b32 v7, 32, v20
    s_mov_b32 s34, 6291456
    s_mov_b32 s35, 0x20000
    s_add_u32 m0, s70, 4096
    s_nop 0
    buffer_load_dwordx4 v20, s[32:35], s72 offen offset:0 lds
    v_add_u32 v21, 48128, v7
    buffer_load_dwordx4 v21, s[32:35], s72 offen offset:1024 lds
    v_add_u32 v22, 0, v20
    buffer_load_dwordx4 v22, s[32:35], s72 offen offset:2048 lds
    v_add_u32 v23, 48128, v7
    buffer_load_dwordx4 v23, s[32:35], s72 offen offset:3072 lds
    v_add_u32 v24, 4096, v20
    s_add_u32 m0, s70, 8192
    s_nop 0
    buffer_load_dwordx4 v24, s[32:35], s72 offen offset:0 lds
    v_add_u32 v25, 52224, v7
    buffer_load_dwordx4 v25, s[32:35], s72 offen offset:1024 lds
    s_add_u32 s70, s70, 40960
    s_cmp_ge_u32 s70, 122880
    s_cselect_b32 s76, 122880, 0
    s_sub_u32 s70, s70, s76
    s_lshl_b32 s76, s60, 8
    s_lshl_b32 s77, s61, 4
    s_add_u32 s76, s76, s77
    s_add_u32 s76, s76, 31596
    s_load_dwordx4 s[84:87], s[66:67], s76
    v_lshl_add_u32 v26, v4, 11, v8
    v_xor_b32 v79, 64, v78
    s_and_b32 s63, s62, 1
    s_lshr_b32 s64, s62, 1
    s_lshl_b32 s73, s60, 4
    s_add_u32 s73, s73, s61
    s_mul_i32 s73, s73, 28800
    s_add_u32 s76, s2, 7
    s_and_b32 s76, s76, 7
    s_bfe_u32 s77, s2, 0x10003
    s_lshl1_add_u32 s97, s76, s77
    s_lshr_b32 s98, s2, 4
    s_lshl_b32 s99, s97, 4
    s_add_u32 s99, s99, s98
    s_mul_i32 s99, s99, 9344
    s_add_u32 s99, s99, 8388608
    s_lshr_b32 s65, s97, 1
    s_lshl_b32 s76, s97, 3
    s_add_u32 s65, s65, s76
    s_mul_i32 s76, s98, 4
    s_add_u32 s65, s65, s76
    s_and_b32 s65, s65, 15
    s_mov_b32 s89, 0x3f803f80
    s_mov_b32 s90, 0xffff0000
    v_and_b32 v2, 31, v1
    v_lshrrev_b32 v3, 5, v1
    v_lshlrev_b32 v12, 4, v1
    v_lshrrev_b32 v4, 3, v1
    v_mul_u32_u24 v13, 460800, v4
    v_and_b32_e64 v4, 7, v1
    v_lshl_add_u32 v13, v4, 4, v13
    s_lshl_b32 s76, s98, 7
    s_lshl_b32 s77, s62, 15
    s_add_u32 s76, s76, s77
    v_add_u32 v26, s76, v26
    v_mov_b32 v28, -1
    v_mov_b32 v29, -1
    v_mov_b32 v30, -1
    v_mov_b32 v31, -1
    s_waitcnt lgkmcnt(0)
    s_and_b32 s72, s84, 15
    s_mov_b32 m0, s70
    s_lshl_b32 s71, s72, 7
    buffer_load_dwordx4 v16, s[28:31], s71 offen offset:0 lds
    s_mul_i32 s72, s72, 393216
    s_lshr_b64 s[84:85], s[84:85], 4
    buffer_load_dwordx4 v17, s[28:31], s71 offen offset:1024 lds
    s_mov_b32 s40, s26
    s_and_b32 s41, s27, 0xffff
    s_mov_b32 s42, 33554432
    s_mov_b32 s43, 0x20000
    buffer_load_dwordx4 v18, s[28:31], s71 offen offset:2048 lds
    s_mov_b32 s56, s8
    s_and_b32 s57, s9, 0xffff
    s_mov_b32 s58, 65536
    s_mov_b32 s59, 0x20000
    buffer_load_dwordx4 v19, s[28:31], s71 offen offset:3072 lds
    s_add_u32 m0, s70, 4096
    s_nop 0
    buffer_load_dwordx4 v20, s[32:35], s72 offen offset:0 lds
    buffer_load_dwordx4 v21, s[32:35], s72 offen offset:1024 lds
    buffer_load_dwordx4 v22, s[32:35], s72 offen offset:2048 lds
    buffer_load_dwordx4 v23, s[32:35], s72 offen offset:3072 lds
    s_add_u32 m0, s70, 8192
    s_nop 0
    buffer_load_dwordx4 v24, s[32:35], s72 offen offset:0 lds
    buffer_load_dwordx4 v25, s[32:35], s72 offen offset:1024 lds
    s_add_u32 s70, s70, 40960
    s_cmp_ge_u32 s70, 122880
    s_cselect_b32 s76, 122880, 0
    s_sub_u32 s70, s70, s76
    s_lshl_b32 s77, s62, 10
    s_add_u32 s76, s77, s73
    buffer_store_dwordx4 v[28:31], v12, s[40:43], s76 offen sc1
    s_lshl_b32 s76, s61, 12
    s_add_u32 s76, s76, s77
    s_add_u32 m0, s77, 122880
    s_nop 0
    buffer_load_dwordx4 v12, s[56:59], s76 offen lds
    v_mov_b32 v4, 13631488
    buffer_load_dwordx2 v[88:89], v4, s[40:43], 0 offen
    s_setprio 0
    s_waitcnt vmcnt(13)
    s_barrier
    s_and_b32 s72, s84, 15
    s_mov_b32 m0, s70
    s_lshl_b32 s71, s72, 7
    buffer_load_dwordx4 v16, s[28:31], s71 offen offset:0 lds
    s_mul_i32 s72, s72, 393216
    s_lshr_b64 s[84:85], s[84:85], 4
    buffer_load_dwordx4 v17, s[28:31], s71 offen offset:1024 lds
    buffer_load_dwordx4 v18, s[28:31], s71 offen offset:2048 lds
    buffer_load_dwordx4 v19, s[28:31], s71 offen offset:3072 lds
    s_add_u32 m0, s70, 4096
    s_nop 0
    buffer_load_dwordx4 v20, s[32:35], s72 offen offset:0 lds
    buffer_load_dwordx4 v21, s[32:35], s72 offen offset:1024 lds
    buffer_load_dwordx4 v22, s[32:35], s72 offen offset:2048 lds
    buffer_load_dwordx4 v23, s[32:35], s72 offen offset:3072 lds
    s_add_u32 m0, s70, 8192
    s_nop 0
    buffer_load_dwordx4 v24, s[32:35], s72 offen offset:0 lds
    buffer_load_dwordx4 v25, s[32:35], s72 offen offset:1024 lds
    s_add_u32 s70, s70, 40960
    s_cmp_ge_u32 s70, 122880
    s_cselect_b32 s76, 122880, 0
    s_sub_u32 s70, s70, s76
    s_mov_b32 s36, s10
    s_and_b32 s37, s11, 0xffff
    s_mov_b32 s38, 2097152
    s_mov_b32 s39, 0x20000
    s_mov_b32 s44, s22
    s_and_b32 s45, s23, 0xffff
    s_mov_b32 s46, 4194304
    s_mov_b32 s47, 0x20000
    s_mov_b32 s52, s20
    s_and_b32 s53, s21, 0xffff
    s_mov_b32 s54, 7340032
    s_mov_b32 s55, 0x20000
    s_cmp_eq_u32 s64, 0
    s_cselect_b32 s48, s16, s18
    s_cselect_b32 s49, s17, s19
    s_and_b32 s49, s49, 0xffff
    s_mov_b32 s51, 0x20000
    s_cmp_lt_u32 s97, 14
    s_cselect_b32 s50, 7340032, 0
    s_cselect_b32 s54, 7340032, 0
    v_bfe_u32 v4, v2, 1, 3
    v_xor_b32 v4, v4, v3
    v_lshlrev_b32 v4, 4, v4
    v_lshl_add_u32 v72, v2, 7, v4
    v_bfe_u32 v4, v1, 2, 2
    v_lshl_add_u32 v5, v3, 3, v4
    v_lshlrev_b32 v5, 7, v5
    v_lshrrev_b32 v4, 1, v4
    v_xor_b32_e64 v4, s64, v4
    v_lshl_add_u32 v5, v4, 6, v5
    v_bfe_u32 v4, v1, 4, 1
    v_xor_b32_e64 v4, v4, v3
    v_lshl_add_u32 v5, v4, 5, v5
    v_and_b32_e64 v4, 3, v1
    v_lshl_add_u32 v5, v4, 3, v5
    s_mul_i32 s76, s62, 10240
    s_sub_u32 s76, 4096, s76
    v_add_u32 v73, s76, v5
    v_lshlrev_b32 v74, 3, v2
    v_lshrrev_b32 v4, 4, v1
    v_and_b32 v5, 15, v1
    v_mul_u32_u24 v66, 28800, v4
    v_lshl_add_u32 v66, v5, 4, v66
    v_mul_u32_u24 v75, 460800, v4
    v_lshl_add_u32 v75, v5, 4, v75
    s_lshr_b32 s76, s60, 3
    s_lshl_b32 s76, s76, 2
    v_lshl_add_u32 v6, v4, 3, s76
    s_mov_b32 s69, 0
    v_mov_b32 v7, 0x654210b3
    v_bfe_u32 v7, v7, v6, 4
    v_mul_u32_u24 v7, 28800, v7
    v_lshl_add_u32 v66, v5, 4, v7
    v_mov_b32 v7, 0xfedca987
    v_bfe_u32 v7, v7, v6, 4
    v_mul_u32_u24 v7, 28800, v7
    v_lshl_add_u32 v67, v5, 4, v7
    v_mov_b32 v80, 0
    v_mov_b32 v81, 0
    v_mov_b32 v82, 0
    v_mov_b32 v83, 0
    v_lshrrev_b32 v4, 4, v1
    v_and_b32_e64 v5, 15, v1
    v_mul_u32_u24 v76, 114688, v4
    v_lshl_add_u32 v76, v5, 4, v76
    v_lshlrev_b32_e64 v77, 4, v2
    v_lshl_add_u32 v77, v3, 11, v77
    s_mul_i32 s75, s98, 458752
    s_lshl_b32 s77, s97, 9
    s_add_u32 s75, s75, s77
    s_lshl_b32 s77, s63, 8
    s_add_u32 s75, s75, s77
    s_lshl_b32 s96, s97, 19
    s_lshl_b32 s77, s98, 15
    s_add_u32 s96, s96, s77
    s_lshl_b32 s77, s62, 9
    s_add_u32 s96, s96, s77
    s_mov_b32 s68, 1
    s_getreg_b32 s101, hwreg(HW_REG_XCC_ID, 0, 4)
    s_lshl_b32 s76, s61, 8
    s_add_u32 s76, s76, 12582912
    s_lshl_b32 s77, s60, 8
    s_add_u32 s77, s77, 12586752
    s_lshr_b32 s78, s97, 1
    s_lshl_b32 s78, s78, 9
    s_add_u32 s78, s78, 12590592
    v_mov_b32 v4, s76
    v_mov_b32 v5, s77
    v_mov_b32 v6, s78
    v_cmp_gt_u32 vcc, 16, v1
    s_nop 1
    v_cndmask_b32 v4, v5, v4, vcc
    v_cmp_gt_u32 vcc, 32, v1
    s_nop 1
    v_cndmask_b32 v4, v6, v4, vcc
    v_add_u32 v90, v4, v12
    s_waitcnt vmcnt(10)
    s_barrier
L_hloop:
    s_and_b32 s77, s86, 15
    s_cbranch_scc1 L_event
L_evret:
    s_and_b32 s72, s84, 15
    s_mov_b32 m0, s70
    s_lshl_b32 s71, s72, 7
    buffer_load_dwordx4 v16, s[28:31], s71 offen offset:0 lds
    s_mul_i32 s72, s72, 393216
    s_lshr_b64 s[84:85], s[84:85], 4
    buffer_load_dwordx4 v17, s[28:31], s71 offen offset:1024 lds
    buffer_load_dwordx4 v18, s[28:31], s71 offen offset:2048 lds
    buffer_load_dwordx4 v19, s[28:31], s71 offen offset:3072 lds
    s_add_u32 m0, s70, 4096
    s_nop 0
    buffer_load_dwordx4 v20, s[32:35], s72 offen offset:0 lds
    buffer_load_dwordx4 v21, s[32:35], s72 offen offset:1024 lds
    buffer_load_dwordx4 v22, s[32:35], s72 offen offset:2048 lds
    buffer_load_dwordx4 v23, s[32:35], s72 offen offset:3072 lds
    s_add_u32 m0, s70, 8192
    s_nop 0
    buffer_load_dwordx4 v24, s[32:35], s72 offen offset:0 lds
    buffer_load_dwordx4 v25, s[32:35], s72 offen offset:1024 lds
    s_add_u32 s70, s70, 40960
    s_cmp_ge_u32 s70, 122880
    s_cselect_b32 s76, 122880, 0
    s_sub_u32 s70, s70, s76
L_hw10:
    s_waitcnt vmcnt(10)
L_hbar:
    s_lshr_b64 s[86:87], s[86:87], 4
    s_add_u32 s68, s68, 1
    s_cmp_lt_u32 s68, 14
    s_barrier
    s_cbranch_scc1 L_hloop
L_hdone:
    v_add_co_u32 v88, vcc, 1, v88
    s_nop 1
    v_addc_co_u32 v89, vcc, 0, v89, vcc
    v_cmp_ne_u64 vcc, v[92:93], v[88:89]
    s_nop 0
    s_cbranch_vccz L_hello_ok_1
    s_mov_b32 s88, 0
L_spin_2:
    buffer_load_dwordx4 v[92:95], v90, s[40:43], 0 offen sc1
    s_waitcnt vmcnt(0)
    v_cmp_ne_u64 vcc, v[92:93], v[88:89]
    s_nop 0
    s_cbranch_vccz L_hello_ok_1
    s_add_u32 s88, s88, 1
    s_cmp_lt_u32 s88, 65536
    s_cbranch_scc1 L_spin_2
L_hello_ok_1:
    v_cmp_ne_u32_e64 vcc, s101, v94
    s_nop 0
    s_and_b32 s76, vcc_lo, 0xffff
    s_cselect_b32 s100, 0, 1
    s_cmp_eq_u32 vcc_hi, 0
    s_cselect_b32 s76, 2, 0
    s_or_b32 s100, s100, s76
    v_mov_b32 v4, s100
    v_mov_b32 v5, 0
    ds_write_b32 v5, v4 offset:53248
    s_lshl_b32 s81, s62, 8
    s_mul_i32 s80, s60, 460800
    s_add_u32 s80, s80, s81
    buffer_load_dwordx4 v[32:35], v66, s[40:43], s80 offen offset:0 sc1
    buffer_load_dwordx4 v[36:39], v67, s[40:43], s80 offen offset:0 sc1
    s_mul_i32 s80, s61, 28800
    s_add_u32 s80, s80, s81
    s_bitcmp1_b32 s2, 7
    s_cselect_b32 s79, 0, 3686400
    s_add_u32 s80, s80, s79
    buffer_load_dwordx4 v[48:51], v75, s[40:43], s80 offen offset:1024 sc1
    s_add_u32 s80, s80, 1843200
    buffer_load_dwordx4 v[52:55], v75, s[40:43], s80 offen offset:1024 sc1
    v_bfe_u32 v10, v1, 4, 1
    v_lshl_add_u32 v10, v10, 1, v3
    v_min_u32 v10, 2, v10
    v_and_b32 v7, 15, v1
    v_lshlrev_b32_e64 v7, 3, v7
    s_lshl_b32 s76, s62, 7
    v_lshl_add_u32 v10, v10, 9, v7
    v_add_u32_e64 v64, s76, v10
    v_lshl_add_u32 v65, v7, 1, s81
    v_bfe_u32 v10, v1, 4, 1
    v_lshl_add_u32 v65, v10, 3, v65
    s_mul_i32 s78, s62, 2048
    s_add_u32 s78, s78, s99
    s_add_u32 s78, s78, 1024
    v_lshlrev_b32 v11, 7, v1
    s_mov_b64 exec, 65535
    buffer_load_dword v27, v11, s[40:43], s78 offen sc1
    s_mov_b64 exec, -1
    s_add_u32 s78, s65, 0
    s_and_b32 s78, s78, 15
    s_lshl_b32 s78, s78, 17
    s_lshl_b32 s79, s62, 11
    s_add_u32 m0, s79, 57344
    s_add_u32 s79, s78, 15360
    buffer_load_dwordx4 v26, s[36:39], s78 offen lds
    buffer_load_dwordx4 v26, s[36:39], s79 offen offset:1024 lds
    s_waitcnt vmcnt(7)
    s_barrier
    s_add_u32 s78, s65, 1
    s_and_b32 s78, s78, 15
    s_lshl_b32 s78, s78, 17
    s_lshl_b32 s79, s62, 11
    s_add_u32 m0, s79, 65536
    s_add_u32 s79, s78, 15360
    buffer_load_dwordx4 v26, s[36:39], s78 offen lds
    buffer_load_dwordx4 v26, s[36:39], s79 offen offset:1024 lds
    s_setprio 3
    s_mov_b32 s88, 0
    s_waitcnt vmcnt(7)
    s_branch L_g1first_3
L_g1_4:
    s_mul_i32 s80, s60, 460800
    s_add_u32 s80, s80, s81
    buffer_load_dwordx4 v[32:35], v66, s[40:43], s80 offen offset:0 sc1
    buffer_load_dwordx4 v[36:39], v67, s[40:43], s80 offen offset:0 sc1
    s_waitcnt vmcnt(0)
L_g1first_3:
    v_max3_u32 v4, v32, v34, v36
    v_max_u32 v4, v4, v38
    v_cmp_eq_u32 vcc, -1, v4
    s_nop 0
    s_cbranch_vccz L_ok_5
    s_add_u32 s88, s88, 1
    s_cmp_lt_u32 s88, 65536
    s_cbranch_scc1 L_g1_4
L_ok_5:
    v_add_f32 v32, v32, v36
    v_add_f32 v33, v33, v37
    v_add_f32 v34, v34, v38
    v_add_f32_e64 v35, v35, v39
    s_add_u32 s78, s65, 2
    s_and_b32 s78, s78, 15
    s_lshl_b32 s78, s78, 17
    s_lshl_b32 s79, s62, 11
    s_add_u32 m0, s79, 73728
    s_add_u32 s79, s78, 15360
    buffer_load_dwordx4 v26, s[36:39], s78 offen lds
    buffer_load_dwordx4 v26, s[36:39], s79 offen offset:1024 lds
    v_permlane32_swap_b32 v32, v33
    v_permlane32_swap_b32 v34, v35
    v_add_f32 v32, v32, v33
    v_add_f32 v34, v34, v35
    s_nop 1
    v_permlane16_swap_b32 v32, v34
    v_add_f32 v32, v32, v34
    v_mov_b32 v33, v32
    s_nop 1
    v_permlane32_swap_b32 v32, v33
    v_mul_f32 v32, 0x3a800000, v32
    v_mul_f32 v33, 0x3a800000, v33
    v_fma_f32 v7, -v32, v32, v33
    v_max_f32_e64 v7, 0, v7
    v_cvt_pk_bf16_f32 v5, v32, v32
    v_and_b32_e64 v5, s90, v5
    v_cvt_pk_bf16_f32 v7, v7, v7
    v_and_b32_e64 v7, s90, v7
    v_add_f32 v7, 0x3727c5ac, v7
    v_cvt_pk_bf16_f32 v7, v7, v7
    v_and_b32 v7, s90, v7
    v_sqrt_f32_e64 v7, v7
    s_nop 0
    v_cvt_pk_bf16_f32 v7, v7, v7
    v_and_b32 v7, s90, v7
    v_rcp_f32 v9, v7
    v_xor_b32 v5, 0x80000000, v5
    v_cvt_pk_bf16_f32 v8, v5, v5
    ds_write_b64 v65, v[8:9] offset:49152
    s_mov_b32 s88, 0
    s_waitcnt vmcnt(7)
    s_branch L_g1first_6
L_g1_7:
    s_mul_i32 s80, s61, 28800
    s_add_u32 s80, s80, s81
    s_bitcmp1_b32 s2, 7
    s_cselect_b32 s79, 0, 3686400
    s_add_u32 s80, s80, s79
    buffer_load_dwordx4 v[48:51], v75, s[40:43], s80 offen offset:1024 sc1
    s_add_u32 s80, s80, 1843200
    buffer_load_dwordx4 v[52:55], v75, s[40:43], s80 offen offset:1024 sc1
    s_waitcnt vmcnt(0)
L_g1first_6:
    v_max3_u32 v4, v48, v50, v52
    v_max_u32 v4, v4, v54
    v_cmp_eq_u32 vcc, -1, v4
    s_nop 0
    s_cbranch_vccz L_ok_8
    s_add_u32 s88, s88, 1
    s_cmp_lt_u32 s88, 65536
    s_cbranch_scc1 L_g1_7
L_ok_8:
    v_add_f32 v48, v48, v52
    v_add_f32 v49, v49, v53
    v_add_f32 v50, v50, v54
    v_add_f32 v51, v51, v55
    v_add_f32 v49, v49, v51
    v_mov_b32 v51, v49
    v_permlane32_swap_b32 v48, v50
    s_nop 0
    v_permlane32_swap_b32 v49, v51
    v_add_f32 v48, v48, v50
    v_add_f32 v49, v49, v51
    s_nop 1
    v_permlane16_swap_b32 v48, v49
    v_add_f32_e64 v48, v48, v49
    v_cvt_pk_bf16_f32 v49, v48, v48
    v_and_b32 v49, s90, v49
    v_sub_f32 v49, v48, v49
    v_cvt_pk_bf16_f32 v50, v48, v49
    v_and_b32 v51, s90, v50
    v_sub_f32 v49, v49, v51
    v_cvt_pk_bf16_f32 v51, v49, 0
    ds_write_b64 v64, v[50:51] offset:50176
    s_setprio 0
    s_waitcnt lgkmcnt(0)
    s_barrier
    s_add_u32 s78, s65, 3
    s_and_b32 s78, s78, 15
    s_lshl_b32 s78, s78, 17
    s_lshl_b32 s79, s62, 11
    s_add_u32 m0, s79, 81920
    s_add_u32 s79, s78, 15360
    buffer_load_dwordx4 v26, s[36:39], s78 offen lds
    buffer_load_dwordx4 v26, s[36:39], s79 offen offset:1024 lds
    s_add_u32 s78, s65, 4
    s_and_b32 s78, s78, 15
    s_lshl_b32 s78, s78, 17
    s_lshl_b32 s79, s62, 11
    s_add_u32 m0, s79, 90112
    s_add_u32 s79, s78, 15360
    buffer_load_dwordx4 v26, s[36:39], s78 offen lds
    buffer_load_dwordx4 v26, s[36:39], s79 offen offset:1024 lds
    s_lshl_b32 s78, s62, 11
    s_add_u32 s79, s78, s99
    s_bitcmp1_b32 s100, 0
    s_cbranch_scc1 L_loc_9
    buffer_store_dwordx4 v[28:31], v12, s[40:43], s79 offen offset:1024 sc1
    buffer_store_dwordx4 v[28:31], v12, s[40:43], s79 offen offset:2048 sc1
    s_branch L_pubd_10
L_loc_9:
    buffer_store_dwordx4 v[28:31], v12, s[40:43], s79 offen offset:1024
    buffer_store_dwordx4 v[28:31], v12, s[40:43], s79 offen offset:2048
L_pubd_10:
    s_lshl_b32 s79, s62, 8
    s_add_u32 s79, s79, s99
    s_mov_b64 exec, 0xffff
    buffer_store_dwordx4 v[28:31], v12, s[40:43], s79 offen sc1
    s_mov_b64 exec, -1
    s_add_u32 s78, s65, 5
    s_and_b32 s78, s78, 15
    s_lshl_b32 s78, s78, 17
    s_lshl_b32 s79, s62, 11
    s_add_u32 m0, s79, 98304
    s_add_u32 s79, s78, 15360
    buffer_load_dwordx4 v26, s[36:39], s78 offen lds
    buffer_load_dwordx4 v26, s[36:39], s79 offen offset:1024 lds
    s_add_u32 s78, s65, 6
    s_and_b32 s78, s78, 15
    s_lshl_b32 s78, s78, 17
    s_lshl_b32 s79, s62, 11
    s_add_u32 m0, s79, 106496
    s_add_u32 s79, s78, 15360
    buffer_load_dwordx4 v26, s[36:39], s78 offen lds
    buffer_load_dwordx4 v26, s[36:39], s79 offen offset:1024 lds
    s_add_u32 s78, s65, 7
    s_and_b32 s78, s78, 15
    s_lshl_b32 s78, s78, 17
    s_lshl_b32 s79, s62, 11
    s_add_u32 m0, s79, 114688
    s_add_u32 s79, s78, 15360
    buffer_load_dwordx4 v26, s[36:39], s78 offen lds
    buffer_load_dwordx4 v26, s[36:39], s79 offen offset:1024 lds
    s_mul_i32 s78, s62, 384
    s_add_u32 s78, s78, s73
    s_add_u32 s78, s78, 2048
    v_lshlrev_b32 v11, 7, v1
    s_mov_b64 exec, 7
    buffer_load_dword v27, v11, s[40:43], s78 offen sc1
    s_mov_b64 exec, -1
    s_waitcnt vmcnt(7)
    s_lshl_b32 s76, s62, 2
    s_add_u32 s76, s76, s73
    v_mov_b32 v4, 0
    s_mov_b64 exec, 1
    s_bitcmp1_b32 s100, 0
    s_cbranch_scc1 L_loc_11
    buffer_store_dword v4, v4, s[40:43], s76 offen offset:2560 sc1
    s_branch L_pubd_12
L_loc_11:
    buffer_store_dword v4, v4, s[40:43], s76 offen offset:2560
L_pubd_12:
    s_mov_b64 exec, -1
    s_add_u32 s78, s65, 8
    s_and_b32 s78, s78, 15
    s_lshl_b32 s78, s78, 17
    s_lshl_b32 s79, s62, 11
    s_add_u32 m0, s79, 122880
    s_add_u32 s79, s78, 15360
    buffer_load_dwordx4 v26, s[36:39], s78 offen lds
    buffer_load_dwordx4 v26, s[36:39], s79 offen offset:1024 lds
    s_add_u32 s78, s65, 9
    s_and_b32 s78, s78, 15
    s_lshl_b32 s78, s78, 17
    s_lshl_b32 s79, s62, 11
    s_add_u32 m0, s79, 131072
    s_add_u32 s79, s78, 15360
    buffer_load_dwordx4 v26, s[36:39], s78 offen lds
    buffer_load_dwordx4 v26, s[36:39], s79 offen offset:1024 lds
    s_add_u32 s78, s65, 10
    s_and_b32 s78, s78, 15
    s_lshl_b32 s78, s78, 17
    s_lshl_b32 s79, s62, 11
    s_add_u32 m0, s79, 139264
    s_add_u32 s79, s78, 15360
    buffer_load_dwordx4 v26, s[36:39], s78 offen lds
    buffer_load_dwordx4 v26, s[36:39], s79 offen offset:1024 lds
    v_and_b32_e64 v65, 15, v1
    v_mul_u32_u24 v65, 460800, v65
    s_mul_i32 s80, s61, 28800
    s_lshl_b32 s82, s62, 2
    s_add_u32 s82, s82, s80
    v_bfe_u32 v4, v1, 4, 1
    v_lshl_add_u32 v4, v4, 1, v3
    s_lshl_b32 s77, s62, 6
    v_lshl_add_u32 v66, v4, 1, s77
    v_bfe_u32 v4, v1, 2, 1
    v_lshl_add_u32 v66, v4, 5, v66
    v_bfe_u32 v4, v1, 0, 1
    v_lshl_add_u32 v66, v4, 4, v66
    v_bfe_u32 v4, v1, 1, 1
    v_lshl_add_u32 v66, v4, 3, v66
    s_lshl_b32 s83, s62, 7
    s_add_u32 s81, s83, s80
    s_add_u32 s68, s81, 3686400
    s_add_u32 s83, s83, s73
    v_and_b32 v4, 7, v1
    v_lshrrev_b32 v5, 4, v1
    v_lshlrev_b32_e64 v5, 2, v5
    v_lshl_add_u32 v67, v4, 4, v5
    v_bfe_u32 v5, v1, 3, 1
    v_lshrrev_b32_e64 v6, 4, v1
    v_lshl_add_u32 v5, v5, 4, v6
    v_mul_u32_u24 v5, 9344, v5
    v_lshl_add_u32 v61, v4, 4, v5
    s_lshr_b32 s69, s97, 1
    s_lshr_b32 s76, s2, 7
    s_lshl2_add_u32 s69, s69, s76
    s_mul_i32 s69, s69, 74752
    s_add_u32 s69, s69, 8389632
    s_barrier
    s_add_u32 s78, s65, 11
    s_and_b32 s78, s78, 15
    s_lshl_b32 s78, s78, 17
    s_lshl_b32 s79, s62, 11
    s_add_u32 m0, s79, 147456
    s_add_u32 s79, s78, 15360
    buffer_load_dwordx4 v26, s[36:39], s78 offen lds
    buffer_load_dwordx4 v26, s[36:39], s79 offen offset:1024 lds
    s_add_u32 s78, s65, 12
    s_and_b32 s78, s78, 15
    s_lshl_b32 s78, s78, 17
    s_lshl_b32 s79, s62, 11
    s_add_u32 m0, s79, 155648
    s_add_u32 s79, s78, 15360
    buffer_load_dwordx4 v26, s[36:39], s78 offen lds
    buffer_load_dwordx4 v26, s[36:39], s79 offen offset:1024 lds
    buffer_load_dword v64, v65, s[40:43], s82 offen offset:2560 sc1
    s_barrier
    s_setprio 3
    v_mov_b32 v4, s89
    v_lshlrev_b32 v5, 2, v1
    ds_write_b32 v5, v4 offset:24832
    v_mov_b32 v70, 0
    v_mov_b32 v71, 0
    ds_write_b64 v70, v[70:71] offset:25984
    s_mov_b32 s88, 0
    s_branch L_p2first_13
L_p2_14:
    buffer_load_dword v64, v65, s[40:43], s82 offen offset:2560 sc1
L_p2first_13:
    s_waitcnt vmcnt(0)
    v_cmp_eq_u32_e64 vcc, -1, v64
    s_nop 0
    s_cbranch_vccz L_ok_15
    s_add_u32 s88, s88, 1
    s_cmp_lt_u32 s88, 65536
    s_cbranch_scc1 L_p2_14
L_ok_15:
    s_add_u32 s78, s65, 13
    s_and_b32 s78, s78, 15
    s_lshl_b32 s78, s78, 17
    s_lshl_b32 s79, s62, 11
    s_add_u32 m0, s79, 32768
    s_add_u32 s79, s78, 15360
    buffer_load_dwordx4 v26, s[36:39], s78 offen lds
    buffer_load_dwordx4 v26, s[36:39], s79 offen offset:1024 lds
    s_add_u32 s78, s65, 14
    s_and_b32 s78, s78, 15
    s_lshl_b32 s78, s78, 17
    s_lshl_b32 s79, s62, 11
    s_add_u32 m0, s79, 40960
    s_add_u32 s79, s78, 15360
    buffer_load_dwordx4 v26, s[36:39], s78 offen lds
    buffer_load_dwordx4 v26, s[36:39], s79 offen offset:1024 lds
    s_add_u32 s78, s65, 15
    s_and_b32 s78, s78, 15
    s_lshl_b32 s78, s78, 17
    s_lshl_b32 s79, s62, 11
    s_add_u32 m0, s79, 49152
    s_add_u32 s79, s78, 15360
    buffer_load_dwordx4 v26, s[36:39], s78 offen lds
    buffer_load_dwordx4 v26, s[36:39], s79 offen offset:1024 lds
    s_lshl_b32 s76, s62, 11
    s_lshl_b32 s77, s60, 7
    s_add_u32 s76, s76, s77
    s_add_u32 s76, s76, s69
    s_add_u32 s77, s76, 37376
    s_mov_b32 s78, 0x00003f80
    s_mov_b32 s79, 0x3f800000
    s_mov_b32 s88, 0
L_poll_16:
    buffer_load_dwordx4 v[32:35], v61, s[40:43], s76 offen sc1
    buffer_load_dwordx4 v[36:39], v61, s[40:43], s77 offen sc1
    s_waitcnt vmcnt(0)
    v_max_u32 v4, v32, v36
    v_cmp_eq_u32_e64 vcc, -1, v4
    s_nop 0
    s_cbranch_vccz L_ok_17
    s_add_u32 s88, s88, 1
    s_cmp_lt_u32 s88, 65536
    s_cbranch_scc1 L_poll_16
L_ok_17:
    v_dot2_f32_bf16 v48, v32, s78, 0
    v_dot2_f32_bf16 v49, v32, s79, 0
    v_dot2_f32_bf16 v50, v33, s78, 0
    v_dot2_f32_bf16 v51, v33, s79, 0
    v_dot2_f32_bf16 v52, v34, s78, 0
    v_dot2_f32_bf16 v53, v34, s79, 0
    v_dot2_f32_bf16 v54, v35, s78, 0
    v_dot2_f32_bf16 v55, v35, s79, 0
    v_dot2_f32_bf16 v48, v36, s78, v48
    v_dot2_f32_bf16 v49, v36, s79, v49
    v_dot2_f32_bf16 v50, v37, s78, v50
    v_dot2_f32_bf16 v51, v37, s79, v51
    v_dot2_f32_bf16 v52, v38, s78, v52
    v_dot2_f32_bf16 v53, v38, s79, v53
    v_dot2_f32_bf16 v54, v39, s78, v54
    v_dot2_f32_bf16 v55, v39, s79, v55
    buffer_load_dwordx4 v[40:43], v13, s[40:43], s81 offen offset:2048 sc1
    buffer_load_dwordx4 v[44:47], v13, s[40:43], s68 offen offset:2048 sc1
    v_permlane32_swap_b32 v48, v52
    v_permlane32_swap_b32 v49, v53
    v_permlane32_swap_b32 v50, v54
    v_permlane32_swap_b32 v51, v55
    v_add_f32 v48, v48, v52
    v_add_f32 v49, v49, v53
    v_add_f32 v50, v50, v54
    v_add_f32 v51, v51, v55
    s_nop 0
    v_permlane16_swap_b32 v48, v50
    v_permlane16_swap_b32 v49, v51
    v_add_f32 v48, v48, v50
    v_add_f32_e64 v49, v49, v51
    s_nop 0
    v_add_f32_dpp v48, v48, v48 row_ror:8 row_mask:0xf bank_mask:0xf
    v_add_f32_dpp v49, v49, v49 row_ror:8 row_mask:0xf bank_mask:0xf
    v_cvt_pk_bf16_f32 v48, v48, v49
    s_bitcmp1_b32 s100, 0
    s_cbranch_scc1 L_loc_18
    buffer_store_dword v48, v67, s[40:43], s83 offen offset:3072 sc1
    s_branch L_pubd_19
L_loc_18:
    buffer_store_dword v48, v67, s[40:43], s83 offen offset:3072
L_pubd_19:
    s_mov_b32 s88, 0
    s_waitcnt vmcnt(1)
    s_branch L_zfirst_20
L_z_21:
    buffer_load_dwordx4 v[40:43], v13, s[40:43], s81 offen offset:2048 sc1
    buffer_load_dwordx4 v[44:47], v13, s[40:43], s68 offen offset:2048 sc1
    s_waitcnt vmcnt(0)
L_zfirst_20:
    v_max3_u32 v4, v40, v41, v42
    v_max3_u32 v4, v4, v43, v44
    v_max3_u32 v4, v4, v45, v46
    v_max_u32 v4, v4, v47
    v_cmp_eq_u32 vcc, -1, v4
    s_nop 0
    s_cbranch_vccz L_ok_22
    s_add_u32 s88, s88, 1
    s_cmp_lt_u32 s88, 65536
    s_cbranch_scc1 L_z_21
L_ok_22:
    v_add_f32 v40, v40, v44
    v_add_f32 v41, v41, v45
    v_add_f32 v42, v42, v46
    v_add_f32 v43, v43, v47
    v_permlane32_swap_b32 v40, v41
    s_nop 0
    v_permlane32_swap_b32 v42, v43
    v_add_f32 v40, v40, v41
    v_add_f32 v42, v42, v43
    s_nop 1
    v_permlane16_swap_b32 v40, v42
    v_add_f32 v40, v40, v42
    s_nop 1
    v_add_f32_dpp v40, v40, v40 row_ror:8 row_mask:0xf bank_mask:0xf
    v_cvt_pk_bf16_f32 v40, v40, v40
    ds_write_b16 v66, v40 offset:24576
    s_waitcnt lgkmcnt(0)
    s_barrier
    s_setprio 0
    s_mov_b64 exec, 3
    global_load_dword v27, v91, s[66:67]
    s_mov_b64 exec, -1
    s_lshl_b32 s78, s97, 18
    s_lshl_b32 s79, s62, 16
    s_add_u32 s78, s78, s79
    s_lshl_b32 s79, s98, 7
    s_add_u32 s78, s78, s79
    s_lshl_b32 s79, s62, 12
    s_add_u32 m0, s79, 0
    s_nop 0
    buffer_load_dwordx4 v78, s[28:31], s78 offen offset:0 lds
    s_add_u32 s78, s78, 15360
    buffer_load_dwordx4 v79, s[28:31], s78 offen offset:1024 lds
    s_add_u32 s78, s78, 15360
    buffer_load_dwordx4 v78, s[28:31], s78 offen offset:2048 lds
    s_add_u32 s78, s78, 15360
    buffer_load_dwordx4 v79, s[28:31], s78 offen offset:3072 lds
    s_mov_b32 s56, s14
    s_and_b32 s57, s15, 0xffff
    s_mov_b32 s58, 2048
    s_mov_b32 s59, 0x20000
    s_lshl_b32 s78, s62, 9
    s_add_u32 m0, s78, 16384
    s_mov_b32 exec_hi, 0
    buffer_load_dwordx4 v12, s[56:59], s78 offen lds
    s_mov_b64 exec, -1
    s_barrier
    s_lshl4_add_u32 s76, s97, s98
    s_mul_i32 s76, s76, 28800
    s_add_u32 s20, s26, s76
    s_addc_u32 s21, s27, 0
    s_cmp_eq_u32 s62, 0
    s_cbranch_scc0 L_now0_25
    s_load_dwordx16 s[4:19], s[20:21], 3584 glc
    s_waitcnt lgkmcnt(0)
    s_and_b64 s[4:5], s[4:5], s[6:7]
    s_and_b64 s[4:5], s[4:5], s[8:9]
    s_and_b64 s[4:5], s[4:5], s[10:11]
    s_and_b64 s[4:5], s[4:5], s[12:13]
    s_and_b64 s[4:5], s[4:5], s[14:15]
    s_and_b64 s[4:5], s[4:5], s[16:17]
    s_and_b64 s[4:5], s[4:5], s[18:19]
    s_nand_b32 s4, s4, s5
    s_and_b32 s4, s4, 0xffff
    s_mul_i32 s4, s4, 0x10001
    s_lshr_b32 s4, s4, s65
    s_and_b32 s77, s4, 0xffff
    v_mov_b32_e64 v69, s77
    s_mov_b64 exec, 1
    ds_or_b32 v70, v69 offset:25984
    s_mov_b64 exec, -1
    s_waitcnt vmcnt(0) lgkmcnt(0)
    s_load_dwordx16 s[4:19], s[20:21], 3584 glc
    s_barrier
    s_mov_b32 s88, 0
    s_branch L_fo2
L_now0_25:
    s_waitcnt vmcnt(0) lgkmcnt(0)
    s_barrier
    s_cmp_eq_u32 s62, 0
    s_cbranch_scc0 L_now1_23
    s_mov_b32 s88, 0
L_spin_26:
    s_load_dwordx16 s[4:19], s[20:21], 3584 glc
L_fo2:
    s_waitcnt lgkmcnt(0)
    s_and_b64 s[4:5], s[4:5], s[6:7]
    s_and_b64 s[4:5], s[4:5], s[8:9]
    s_and_b64 s[4:5], s[4:5], s[10:11]
    s_and_b64 s[4:5], s[4:5], s[12:13]
    s_and_b64 s[4:5], s[4:5], s[14:15]
    s_and_b64 s[4:5], s[4:5], s[16:17]
    s_and_b64 s[4:5], s[4:5], s[18:19]
    s_nand_b32 s4, s4, s5
    s_and_b32 s4, s4, 0xffff
    s_mul_i32 s4, s4, 0x10001
    s_lshr_b32 s4, s4, s65
    s_and_b32 s77, s4, 0xffff
    v_mov_b32 v69, s77
    s_mov_b64 exec, 1
    ds_or_b32 v70, v69 offset:25984
    s_mov_b64 exec, -1
    s_cmp_eq_u32 s77, 0xffff
    s_cbranch_scc1 L_s2done_24
    s_add_u32 s88, s88, 1
    s_cmp_lt_u32 s88, 65536
    s_cbranch_scc1 L_spin_26
    s_branch L_s2done_24
L_now1_23:
    s_cmp_eq_u32 s62, 1
    s_cbranch_scc0 L_s2done_24
    s_lshl_b32 s77, 1, s61
    s_not_b32 s77, s77
    v_mov_b32 v4, s77
    v_mul_u32_u24 v5, 28800, v1
    s_mul_i32 s76, s60, 460800
    s_lshl2_add_u32 s76, s61, s76
    s_mov_b32 s88, 0
L_spin_27:
    ds_read_b32 v69, v70 offset:25988
    s_waitcnt lgkmcnt(0)
    v_cmp_eq_u32_e64 vcc, 4, v69
    s_nop 0
    s_cbranch_vccnz L_drained_28
    s_add_u32 s88, s88, 1
    s_cmp_lt_u32 s88, 1048576
    s_cbranch_scc1 L_spin_27
L_drained_28:
    s_mov_b64 exec, 0xffff
    buffer_store_dword v4, v5, s[40:43], s76 offen offset:3584 sc1
    s_mov_b64 exec, -1
L_s2done_24:
    s_waitcnt vmcnt(0)
    s_mov_b32 s78, 0x05040100
    s_mov_b32 s79, 0x07060302
    v_perm_b32 v160, v100, v96, s78
    v_perm_b32 v164, v100, v96, s79
    v_perm_b32 v168, v101, v97, s78
    v_perm_b32 v172, v101, v97, s79
    v_perm_b32 v176, v102, v98, s78
    v_perm_b32 v180, v102, v98, s79
    v_perm_b32 v184, v103, v99, s78
    v_perm_b32 v188, v103, v99, s79
    v_perm_b32 v161, v108, v104, s78
    v_perm_b32 v165, v108, v104, s79
    v_perm_b32 v169, v109, v105, s78
    v_perm_b32 v173, v109, v105, s79
    v_perm_b32 v177, v110, v106, s78
    v_perm_b32 v181, v110, v106, s79
    v_perm_b32 v185, v111, v107, s78
    v_perm_b32 v189, v111, v107, s79
    v_perm_b32 v162, v116, v112, s78
    v_perm_b32 v166, v116, v112, s79
    v_perm_b32 v170, v117, v113, s78
    v_perm_b32 v174, v117, v113, s79
    v_perm_b32 v178, v118, v114, s78
    v_perm_b32 v182, v118, v114, s79
    v_perm_b32 v186, v119, v115, s78
    v_perm_b32 v190, v119, v115, s79
    v_perm_b32 v163, v124, v120, s78
    v_perm_b32 v167, v124, v120, s79
    v_perm_b32 v171, v125, v121, s78
    v_perm_b32 v175, v125, v121, s79
    v_perm_b32 v179, v126, v122, s78
    v_perm_b32 v183, v126, v122, s79
    v_perm_b32 v187, v127, v123, s78
    v_perm_b32 v191, v127, v123, s79
    v_perm_b32 v192, v132, v128, s78
    v_perm_b32 v196, v132, v128, s79
    v_perm_b32 v200, v133, v129, s78
    v_perm_b32 v204, v133, v129, s79
    v_perm_b32 v208, v134, v130, s78
    v_perm_b32 v212, v134, v130, s79
    v_perm_b32 v216, v135, v131, s78
    v_perm_b32 v220, v135, v131, s79
    v_perm_b32 v193, v140, v136, s78
    v_perm_b32 v197, v140, v136, s79
    v_perm_b32 v201, v141, v137, s78
    v_perm_b32 v205, v141, v137, s79
    v_perm_b32 v209, v142, v138, s78
    v_perm_b32 v213, v142, v138, s79
    v_perm_b32 v217, v143, v139, s78
    v_perm_b32 v221, v143, v139, s79
    v_perm_b32 v194, v148, v144, s78
    v_perm_b32 v198, v148, v144, s79
    v_perm_b32 v202, v149, v145, s78
    v_perm_b32 v206, v149, v145, s79
    v_perm_b32 v210, v150, v146, s78
    v_perm_b32 v214, v150, v146, s79
    v_perm_b32 v218, v151, v147, s78
    v_perm_b32 v222, v151, v147, s79
    v_perm_b32 v195, v156, v152, s78
    v_perm_b32 v199, v156, v152, s79
    v_perm_b32 v203, v157, v153, s78
    v_perm_b32 v207, v157, v153, s79
    v_perm_b32 v211, v158, v154, s78
    v_perm_b32 v215, v158, v154, s79
    v_perm_b32 v219, v159, v155, s78
    v_perm_b32 v223, v159, v155, s79
    v_lshlrev_b32 v17, 5, v2
    v_lshl_add_u32 v17, v3, 4, v17
    v_and_b32 v4, 15, v1
    v_lshrrev_b32 v5, 1, v4
    v_and_b32 v4, 1, v4
    v_lshlrev_b32 v4, 5, v4
    v_lshl_add_u32 v16, v5, 7, v4
    v_lshrrev_b32 v4, 3, v1
    v_and_b32 v5, 7, v1
    v_lshlrev_b32_e64 v5, 4, v5
    v_mul_u32_u24 v18, 9344, v4
    v_add_u32_e64 v18, v18, v5
    v_bfe_u32 v6, v1, 4, 1
    v_lshl_add_u32 v6, v6, 1, v3
    v_lshl_add_u32 v19, v6, 2, v5
    s_mul_i32 s84, s97, 149504
    s_lshl_b32 s77, s98, 7
    s_add_u32 s84, s84, s77
    s_add_u32 s84, s84, 8388608
    s_lshl_b32 s85, s62, 10
    s_add_u32 s85, s85, s99
    s_add_u32 s85, s85, 5120
    s_and_b32 s87, s97, 1
    s_lshl_b32 s87, s87, 4
    s_add_u32 s87, s87, s98
    s_lshr_b32 s86, s97, 1
    s_mul_i32 s86, s86, 299008
    s_lshl_b32 s77, s87, 7
    s_add_u32 s86, s86, s77
    s_add_u32 s86, s86, 8393728
    s_lshl_b32 s78, s62, 11
    s_add_u32 s79, s78, s99
    s_bitcmp1_b32 s100, 1
    s_cbranch_scc1 L_loc_29
    buffer_store_dwordx4 v[28:31], v12, s[40:43], s79 offen offset:1024 sc1
    buffer_store_dwordx4 v[28:31], v12, s[40:43], s79 offen offset:2048 sc1
    s_branch L_pubd_30
L_loc_29:
    buffer_store_dwordx4 v[28:31], v12, s[40:43], s79 offen offset:1024
    buffer_store_dwordx4 v[28:31], v12, s[40:43], s79 offen offset:2048
L_pubd_30:
    s_lshl4_add_u32 s78, s97, s98
    s_lshl4_add_u32 s78, s78, s62
    s_add_u32 s78, s78, 12591116
    s_waitcnt vmcnt(0)
    s_mov_b64 exec, 1
    s_bitcmp1_b32 s100, 1
    s_cbranch_scc1 L_loc_31
    buffer_store_byte v28, v70, s[40:43], s78 offen sc1
    s_branch L_pubd_32
L_loc_31:
    buffer_store_byte v28, v70, s[40:43], s78 offen
L_pubd_32:
    s_mov_b64 exec, -1
    s_cmp_eq_u32 s62, 0
    s_cbranch_scc0 L_nop3c_33
    s_mov_b32 exec_lo, 0
    s_mov_b32 s88, 0
L_spin_34:
    buffer_load_dword v4, v90, s[40:43], 0 offen offset:12 sc1
    s_waitcnt vmcnt(0)
    v_cmp_ne_u32 vcc, -1, v4
    s_nop 0
    s_cbranch_vccz L_p3ok_35
    s_add_u32 s88, s88, 1
    s_cmp_lt_u32 s88, 65536
    s_cbranch_scc1 L_spin_34
L_p3ok_35:
    s_mov_b64 exec, -1
L_nop3c_33:
    s_barrier
    buffer_load_dwordx4 v[224:227], v77, s[52:55], s96 offen nt
    s_add_u32 s96, s96, 4096
    buffer_load_dwordx4 v[228:231], v77, s[52:55], s96 offen nt
    s_add_u32 s96, s96, 4096
    buffer_load_dwordx4 v[232:235], v77, s[52:55], s96 offen nt
    s_add_u32 s96, s96, 4096
    buffer_load_dwordx4 v[236:239], v77, s[52:55], s96 offen nt
    s_add_u32 s96, s96, 4096
    buffer_load_dwordx4 v[240:243], v77, s[52:55], s96 offen nt
    s_add_u32 s96, s96, 4096
    v_mul_u32_u24 v20, 149504, v1
    s_mul_i32 s72, s98, 9344
    s_lshl2_add_u32 s72, s97, s72
    s_add_u32 s72, s72, 8388608
    s_barrier
    s_cmp_eq_u32 s62, 1
    s_cbranch_scc0 L_nopre_36
    s_mov_b64 exec, 0xffff
    buffer_store_dword v70, v20, s[40:43], s72 offen offset:768 sc1
    s_mov_b64 exec, -1
L_nopre_36:
    buffer_load_dwordx4 v[244:247], v77, s[52:55], s96 offen nt
    s_add_u32 s96, s96, 4096
    buffer_load_dwordx4 v[248:251], v77, s[52:55], s96 offen nt
    s_add_u32 s96, s96, 4096
    buffer_load_dwordx4 v[252:255], v77, s[52:55], s96 offen nt
    s_add_u32 s96, s96, 4096
    s_barrier
    s_waitcnt vmcnt(7)
    s_mov_b32 s78, 0x05040100
    s_mov_b32 s79, 0x07060302
    v_permlane32_swap_b32 v224, v226
    v_permlane32_swap_b32 v225, v227
    v_perm_b32 v32, v226, v224, s78
    v_perm_b32 v33, v226, v224, s79
    v_perm_b32 v34, v227, v225, s78
    v_perm_b32 v35, v227, v225, s79
    s_waitcnt vmcnt(6)
    s_mov_b32 s78, 0x05040100
    s_mov_b32 s79, 0x07060302
    v_permlane32_swap_b32 v228, v230
    v_permlane32_swap_b32_e64 v229, v231
    v_perm_b32 v36, v230, v228, s78
    v_perm_b32 v37, v230, v228, s79
    v_perm_b32 v38, v231, v229, s78
    v_perm_b32 v39, v231, v229, s79
    s_waitcnt vmcnt(5)
    s_mov_b32 s78, 0x05040100
    s_mov_b32 s79, 0x07060302
    v_permlane32_swap_b32 v232, v234
    v_permlane32_swap_b32_e64 v233, v235
    v_perm_b32 v40, v234, v232, s78
    v_perm_b32 v41, v234, v232, s79
    v_perm_b32 v42, v235, v233, s78
    v_perm_b32 v43, v235, v233, s79
    s_waitcnt vmcnt(4)
    s_mov_b32 s78, 0x05040100
    s_mov_b32 s79, 0x07060302
    v_permlane32_swap_b32 v236, v238
    v_permlane32_swap_b32_e64 v237, v239
    v_perm_b32 v44, v238, v236, s78
    v_perm_b32 v45, v238, v236, s79
    v_perm_b32 v46, v239, v237, s78
    v_perm_b32 v47, v239, v237, s79
    s_waitcnt vmcnt(3)
    s_mov_b32 s78, 0x05040100
    s_mov_b32 s79, 0x07060302
    v_permlane32_swap_b32 v240, v242
    v_permlane32_swap_b32_e64 v241, v243
    v_perm_b32 v48, v242, v240, s78
    v_perm_b32 v49, v242, v240, s79
    v_perm_b32 v50, v243, v241, s78
    v_perm_b32 v51, v243, v241, s79
    s_waitcnt vmcnt(2)
    s_mov_b32 s78, 0x05040100
    s_mov_b32 s79, 0x07060302
    v_permlane32_swap_b32 v244, v246
    v_permlane32_swap_b32_e64 v245, v247
    v_perm_b32 v52, v246, v244, s78
    v_perm_b32 v53, v246, v244, s79
    v_perm_b32 v54, v247, v245, s78
    v_perm_b32 v55, v247, v245, s79
    s_waitcnt vmcnt(1)
    s_mov_b32 s78, 0x05040100
    s_mov_b32 s79, 0x07060302
    v_permlane32_swap_b32 v248, v250
    v_permlane32_swap_b32_e64 v249, v251
    v_perm_b32 v56, v250, v248, s78
    v_perm_b32 v57, v250, v248, s79
    v_perm_b32 v58, v251, v249, s78
    v_perm_b32 v59, v251, v249, s79
    s_waitcnt vmcnt(0)
    s_mov_b32 s78, 0x05040100
    s_mov_b32 s79, 0x07060302
    v_permlane32_swap_b32 v252, v254
    v_permlane32_swap_b32_e64 v253, v255
    v_perm_b32 v60, v254, v252, s78
    v_perm_b32 v61, v254, v252, s79
    v_perm_b32 v62, v255, v253, s78
    v_perm_b32 v63, v255, v253, s79
    v_and_b32 v5, 15, v1
    v_lshlrev_b32 v5, 3, v5
    s_lshl_b32 s76, s63, 10
    s_lshl_b32 s77, s64, 6
    s_add_u32 s76, s76, s77
    s_add_u32 s76, s76, s99
    s_mov_b64 s[80:81], 0xffff
    s_add_u32 s68, s84, 74752
    s_add_u32 s69, s86, 74752
    s_add_u32 s70, s86, 149504
    s_add_u32 s71, s86, 224256
    s_branch L_fit_ffn1
.fill 85, 4, 0xbf800000
L_fit_ffn1:
    s_setprio 3
    s_barrier
    ds_read_b128 v[64:67], v12 offset:28672
    ds_read_b128 v[68:71], v12 offset:29696
    ds_read_b64 v[8:9], v5 offset:25728
    s_waitcnt lgkmcnt(2)
    v_mfma_f32_16x16x32_bf16 v[96:99], v[64:67], v[160:163], 0
    v_mfma_f32_16x16x32_bf16 v[100:103], v[64:67], v[164:167], 0
    s_waitcnt lgkmcnt(0)
    v_max_f32_dpp v4, v8, v8 row_ror:8 row_mask:0xf bank_mask:0xf
    v_mfma_f32_16x16x32_bf16 v[104:107], v[64:67], v[168:171], 0
    v_mfma_f32_16x16x32_bf16 v[108:111], v[64:67], v[172:175], 0
    v_max_f32_dpp v4, v4, v4 row_ror:4 row_mask:0xf bank_mask:0xf
    v_mfma_f32_16x16x32_bf16 v[112:115], v[64:67], v[176:179], 0
    v_mfma_f32_16x16x32_bf16 v[116:119], v[64:67], v[180:183], 0
    v_max_f32_dpp v4, v4, v4 row_ror:2 row_mask:0xf bank_mask:0xf
    v_mfma_f32_16x16x32_bf16 v[120:123], v[64:67], v[184:187], 0
    v_mfma_f32_16x16x32_bf16 v[124:127], v[64:67], v[188:191], 0
    v_max_f32_dpp v4, v4, v4 row_ror:1 row_mask:0xf bank_mask:0xf
    v_mfma_f32_16x16x32_bf16 v[96:99], v[68:71], v[192:195], v[96:99]
    v_cmp_eq_f32_e64 vcc, v4, v8
    v_mfma_f32_16x16x32_bf16 v[100:103], v[68:71], v[196:199], v[100:103]
    s_ff1_i32_b32 s92, vcc_lo
    s_and_b32 s92, s92, 15
    v_mfma_f32_16x16x32_bf16 v[104:107], v[68:71], v[200:203], v[104:107]
    s_lshr_b32 s78, s92, 2
    s_lshl_b32 s78, s78, 4
    v_mfma_f32_16x16x32_bf16 v[108:111], v[68:71], v[204:207], v[108:111]
    s_and_b32 s77, s92, 3
    v_mfma_f32_16x16x32_bf16 v[112:115], v[68:71], v[208:211], v[112:115]
    v_readlane_b32 s91, v9, s92
    v_readlane_b32 s93, v8, s92
    v_mfma_f32_16x16x32_bf16 v[116:119], v[68:71], v[212:215], v[116:119]
    v_mfma_f32_16x16x32_bf16 v[120:123], v[68:71], v[216:219], v[120:123]
    v_mfma_f32_16x16x32_bf16 v[124:127], v[68:71], v[220:223], v[124:127]
    s_cmp_ge_u32 s97, 14
    s_cbranch_scc1 L_final
    s_cmp_eq_u32 s77, 0
    s_cbranch_scc0 L_sel_38
    v_mov_b32 v64, v96
    v_mov_b32 v65, v100
    v_mov_b32 v66, v104
    v_mov_b32 v67, v108
    v_mov_b32 v68, v112
    v_mov_b32 v69, v116
    v_mov_b32 v70, v120
    v_mov_b32 v71, v124
    s_branch L_seldone_37
L_sel_38:
    s_cmp_eq_u32 s77, 1
    s_cbranch_scc0 L_sel_39
    v_mov_b32 v64, v97
    v_mov_b32 v65, v101
    v_mov_b32 v66, v105
    v_mov_b32 v67, v109
    v_mov_b32 v68, v113
    v_mov_b32 v69, v117
    v_mov_b32 v70, v121
    v_mov_b32 v71, v125
    s_branch L_seldone_37
L_sel_39:
    s_cmp_eq_u32 s77, 2
    s_cbranch_scc0 L_sel_40
    v_mov_b32 v64, v98
    v_mov_b32 v65, v102
    v_mov_b32 v66, v106
    v_mov_b32 v67, v110
    v_mov_b32 v68, v114
    v_mov_b32 v69, v118
    v_mov_b32 v70, v122
    v_mov_b32 v71, v126
    s_branch L_seldone_37
L_sel_40:
    v_mov_b32 v64, v99
    v_mov_b32 v65, v103
    v_mov_b32 v66, v107
    v_mov_b32 v67, v111
    v_mov_b32 v68, v115
    v_mov_b32 v69, v119
    v_mov_b32 v70, v123
    v_mov_b32_e64 v71, v127
L_seldone_37:
    s_lshl_b64 exec, s[80:81], s78
    s_bitcmp1_b32 s100, 1
    s_cbranch_scc1 L_loc_42
    buffer_store_dwordx4 v[64:67], v16, s[40:43], s76 offen offset:3072 sc1
    buffer_store_dwordx4 v[68:71], v16, s[40:43], s76 offen offset:3088 sc1
    s_branch L_pubd_43
L_loc_42:
    buffer_store_dwordx4 v[64:67], v16, s[40:43], s76 offen offset:3072
    buffer_store_dwordx4 v[68:71], v16, s[40:43], s76 offen offset:3088
L_pubd_43:
    s_mov_b64 exec, -1
    s_branch L_fit_ffn2
.fill 137, 4, 0xbf800000
L_fit_ffn2:
    s_mov_b32 s88, 0
L_poll_44:
    buffer_load_dwordx4 v[128:131], v18, s[40:43], s84 offen offset:3072 sc1
    buffer_load_dwordx4 v[132:135], v18, s[40:43], s68 offen offset:3072 sc1
    s_waitcnt vmcnt(0)
    v_max_u32 v4, v128, v132
    v_cmp_eq_u32_e64 vcc, -1, v4
    s_nop 0
    s_cbranch_vccz L_ok_45
    s_add_u32 s88, s88, 1
    s_cmp_lt_u32 s88, 65536
    s_cbranch_scc1 L_poll_44
L_ok_45:
    v_pk_add_f32 v[152:153], v[128:129], v[132:133]
    v_pk_add_f32 v[154:155], v[130:131], v[134:135]
    s_nop 0
    v_permlane32_swap_b32 v152, v153
    v_permlane32_swap_b32 v154, v155
    v_add_f32 v152, v152, v153
    v_add_f32 v154, v154, v155
    s_nop 1
    v_permlane16_swap_b32 v152, v154
    v_add_f32 v152, v152, v154
    s_nop 1
    v_add_f32_dpp v152, v152, v152 row_ror:8 row_mask:0xf bank_mask:0xf
    v_cvt_pk_bf16_f32 v152, v152, v152
    v_and_b32_e64 v152, s90, v152
    v_mul_f32 v4, 0xbfb8aa3b, v152
    v_exp_f32_e64 v4, v4
    v_mov_b32_dpp v153, v152 row_ror:12 row_mask:0xf bank_mask:0xf
    v_add_f32 v4, 1.0, v4
    v_rcp_f32 v4, v4
    s_nop 0
    v_mul_f32 v4, v4, v152
    v_cvt_pk_bf16_f32 v4, v4, v4
    v_and_b32 v4, s90, v4
    v_mul_f32 v4, v4, v153
    v_mov_b32 v5, v4
    s_nop 1
    v_permlane32_swap_b32_e64 v4, v5
    v_cvt_pk_bf16_f32 v4, v4, v5
    s_nop 0
    v_readlane_b32 s76, v4, 0
    v_readlane_b32 s77, v4, 16
    v_readlane_b32 s78, v4, 1
    v_readlane_b32 s79, v4, 17
    v_readlane_b32 s80, v4, 2
    v_readlane_b32 s81, v4, 18
    v_readlane_b32 s82, v4, 3
    v_readlane_b32 s83, v4, 19
    v_dot2_f32_bf16 v20, v32, s76, 0
    v_dot2_f32_bf16 v21, v33, s76, 0
    v_dot2_f32_bf16 v22, v34, s76, 0
    v_dot2_f32_bf16 v23, v35, s76, 0
    v_dot2_f32_bf16 v20, v36, s77, v20
    v_dot2_f32_bf16 v21, v37, s77, v21
    v_dot2_f32_bf16 v22, v38, s77, v22
    v_dot2_f32_bf16 v23, v39, s77, v23
    v_dot2_f32_bf16 v20, v40, s78, v20
    v_dot2_f32_bf16 v21, v41, s78, v21
    v_dot2_f32_bf16 v22, v42, s78, v22
    v_dot2_f32_bf16 v23, v43, s78, v23
    v_dot2_f32_bf16 v20, v44, s79, v20
    v_dot2_f32_bf16 v21, v45, s79, v21
    v_dot2_f32_bf16 v22, v46, s79, v22
    v_dot2_f32_bf16 v23, v47, s79, v23
    v_dot2_f32_bf16 v20, v48, s80, v20
    v_dot2_f32_bf16 v21, v49, s80, v21
    v_dot2_f32_bf16 v22, v50, s80, v22
    v_dot2_f32_bf16 v23, v51, s80, v23
    v_dot2_f32_bf16 v20, v52, s81, v20
    v_dot2_f32_bf16 v21, v53, s81, v21
    v_dot2_f32_bf16 v22, v54, s81, v22
    v_dot2_f32_bf16 v23, v55, s81, v23
    v_dot2_f32_bf16 v20, v56, s82, v20
    v_dot2_f32_bf16 v21, v57, s82, v21
    v_dot2_f32_bf16 v22, v58, s82, v22
    v_dot2_f32_bf16 v23, v59, s82, v23
    v_dot2_f32_bf16 v20, v60, s83, v20
    v_dot2_f32_bf16 v21, v61, s83, v21
    v_dot2_f32_bf16 v22, v62, s83, v22
    v_dot2_f32_bf16 v23, v63, s83, v23
    s_bitcmp1_b32 s100, 1
    s_cbranch_scc1 L_loc_46
    s_nop 0
    buffer_store_dwordx4 v[20:23], v17, s[40:43], s85 offen sc1
    s_branch L_pubd_47
L_loc_46:
    s_nop 0
    buffer_store_dwordx4 v[20:23], v17, s[40:43], s85 offen
L_pubd_47:
    s_cmp_eq_u32 s62, 0
    s_cbranch_scc0 L_hby
    s_mov_b32 s88, 0
L_poll_48:
    buffer_load_dwordx4 v[136:139], v18, s[40:43], s86 offen sc1
    buffer_load_dwordx4 v[140:143], v18, s[40:43], s69 offen sc1
    buffer_load_dwordx4 v[144:147], v18, s[40:43], s70 offen sc1
    buffer_load_dwordx4 v[148:151], v18, s[40:43], s71 offen sc1
    s_waitcnt vmcnt(0)
    v_max3_u32 v4, v136, v140, v144
    v_max_u32 v4, v4, v148
    v_cmp_eq_u32_e64 vcc, -1, v4
    s_nop 0
    s_cbranch_vccz L_ok_49
    s_add_u32 s88, s88, 1
    s_cmp_lt_u32 s88, 65536
    s_cbranch_scc1 L_poll_48
L_ok_49:
    v_pk_add_f32 v[152:153], v[136:137], v[144:145]
    v_pk_add_f32 v[154:155], v[138:139], v[146:147]
    v_pk_add_f32 v[156:157], v[140:141], v[148:149]
    v_pk_add_f32 v[158:159], v[142:143], v[150:151]
    v_pk_add_f32 v[152:153], v[152:153], v[156:157]
    v_pk_add_f32 v[154:155], v[154:155], v[158:159]
    s_nop 0
    v_permlane32_swap_b32 v152, v153
    v_permlane32_swap_b32 v154, v155
    v_add_f32 v152, v152, v153
    v_add_f32 v154, v154, v155
    s_nop 1
    v_permlane16_swap_b32 v152, v154
    v_add_f32 v152, v152, v154
    s_nop 1
    v_add_f32_dpp v152, v152, v152 row_ror:8 row_mask:0xf bank_mask:0xf
    buffer_store_dword v152, v19, s[40:43], s99 offen offset:512 sc1
L_hby:
    s_barrier
    s_lshl2_add_u32 s72, s87, s62
    s_cmp_eq_u32 s72, 0
    s_cbranch_scc0 L_nowb_50
    s_waitcnt vmcnt(0)
    buffer_wbl2 sc1
L_nowb_50:
    s_branch L_hfin
L_final:
    s_barrier
    s_lshl2_add_u32 s72, s87, s62
    s_cmp_eq_u32 s72, 3
    s_cbranch_scc0 L_nowb_51
    s_waitcnt vmcnt(0)
    buffer_wbl2 sc1
L_nowb_51:
    s_cmp_eq_u32 s62, 1
    s_cbranch_scc0 L_noep_52
    s_cmp_eq_u32 s87, 0
    s_cbranch_scc0 L_noep_52
    v_mov_b32 v4, 13631488
    s_mov_b64 exec, 1
    buffer_store_dwordx2 v[88:89], v4, s[40:43], 0 offen sc1
    s_mov_b64 exec, -1
L_noep_52:
    s_cmp_eq_u32 s62, 0
    s_cbranch_scc0 L_hfin
    v_mov_b32 v8, s93
    v_cvt_pk_bf16_f32 v8, v8, v8
    v_and_b32_e64 v8, s90, v8
    v_mul_f32 v8, 0xbfb8aa3b, v8
    v_exp_f32 v8, v8
    s_nop 0
    v_add_f32 v8, 1.0, v8
    v_rcp_f32_e64 v8, v8
    s_nop 0
    v_cvt_pk_bf16_f32 v8, v8, v8
    v_and_b32 v8, s90, v8
    s_lshl_b32 s76, s92, 4
    s_lshr_b32 s77, s87, 1
    s_add_u32 s76, s76, s77
    s_mul_i32 s76, s76, 9344
    s_add_u32 s76, s76, 8388608
    s_and_b32 s77, s87, 1
    s_lshl_b32 s77, s77, 5
    s_add_u32 s76, s76, s77
    v_and_b32 v10, 1, v1
    v_lshlrev_b32_e64 v10, 6, v10
    v_bfe_u32 v4, v1, 1, 2
    v_lshl_add_u32 v10, v4, 3, v10
    v_bfe_u32 v4, v1, 4, 1
    v_lshl_add_u32 v10, v4, 2, v10
    v_lshrrev_b32_e64 v4, 3, v1
    v_mul_u32_u24 v6, 299008, v4
    v_and_b32_e64 v5, 7, v1
    v_lshl_add_u32 v6, v5, 4, v6
    v_mov_b32 v7, 2146435072
    v_cmp_gt_u32 vcc, 56, v1
    s_nop 1
    v_cndmask_b32_e64 v6, v7, v6, vcc
    s_mul_i32 s79, s87, 9344
    s_add_u32 s79, s79, 8388608
    s_lshl_b32 s80, s91, 11
    s_lshl_b32 s77, s87, 6
    s_add_u32 s80, s80, s77
    s_mov_b32 s88, 0
L_spin_53:
    buffer_load_dword v64, v10, s[40:43], s76 offen offset:0 sc1
    buffer_load_dword v65, v10, s[40:43], s76 offen offset:128 sc1
    s_waitcnt vmcnt(0)
    v_max_u32 v4, v64, v65
    v_cmp_eq_u32 vcc, -1, v4
    s_nop 0
    s_cbranch_vccz L_ok_54
    s_add_u32 s88, s88, 1
    s_cmp_lt_u32 s88, 65536
    s_cbranch_scc1 L_spin_53
L_ok_54:
    v_lshlrev_b32 v4, 4, v3
    v_lshrrev_b32 v64, v4, v64
    v_lshrrev_b32 v65, v4, v65
    v_lshlrev_b32 v64, 16, v64
    v_lshlrev_b32 v65, 16, v65
    v_lshrrev_b32 v9, 1, v19
    s_mov_b32 s88, 0
    buffer_load_dwordx4 v[128:131], v6, s[40:43], s79 offen offset:512 sc1
    buffer_load_dwordx4 v[128:131], v6, s[40:43], s79 offen offset:512 sc1
L_poll_55:
    buffer_load_dwordx4 v[128:131], v6, s[40:43], s79 offen offset:512 sc1
    s_waitcnt vmcnt(2)
    v_max3_u32 v4, v128, v129, v130
    v_max_u32 v4, v4, v131
    v_cmp_eq_u32 vcc, -1, v4
    s_nop 0
    s_cbranch_vccz L_ok_56
    s_add_u32 s88, s88, 1
    s_cmp_lt_u32 s88, 65536
    s_cbranch_scc1 L_poll_55
L_ok_56:
    v_mov_b32 v152, v128
    v_mov_b32 v153, v129
    v_mov_b32 v154, v130
    v_mov_b32 v155, v131
    v_permlane32_swap_b32 v152, v153
    s_nop 0
    v_permlane32_swap_b32 v154, v155
    v_add_f32 v152, v152, v153
    v_add_f32 v154, v154, v155
    s_nop 1
    v_permlane16_swap_b32 v152, v154
    v_add_f32 v152, v152, v154
    s_nop 1
    v_add_f32_dpp v152, v152, v152 row_ror:8 row_mask:0xf bank_mask:0xf
    v_cvt_pk_bf16_f32 v152, v152, v152
    v_and_b32 v152, s90, v152
    v_mul_f32 v152, v152, v8
    v_cvt_pk_bf16_f32 v152, v152, v152
    v_and_b32 v152, s90, v152
    v_add_f32 v152, v152, v64
    v_cvt_pk_bf16_f32 v152, v152, v152
    v_and_b32 v152, s90, v152
    v_add_f32 v152, v152, v65
    v_cvt_pk_bf16_f32 v152, v152, v152
    s_mov_b32 exec_lo, 0x00ff00ff
    s_mov_b32 exec_hi, 0x00ff00ff
    buffer_store_short v152, v9, s[44:47], s80 offen sc1
    s_mov_b64 exec, -1
L_hfin:
    s_endpgm
L_event:
    s_cmp_eq_u32 s77, 3
    s_cbranch_scc0 L_ev1
    buffer_load_dwordx4 v[92:95], v90, s[40:43], 0 offen sc1
    s_mov_b64 exec, 3
    global_load_dword v27, v91, s[66:67]
    s_mov_b64 exec, -1
    s_branch L_evret
L_ev1:
    s_cmp_eq_u32 s77, 5
    s_cbranch_scc0 L_ev_57
    s_and_b32 s72, s84, 15
    s_mov_b32 m0, s70
    s_lshl_b32 s71, s72, 7
    buffer_load_dwordx4 v16, s[28:31], s71 offen offset:0 lds
    s_mul_i32 s72, s72, 393216
    s_lshr_b64 s[84:85], s[84:85], 4
    buffer_load_dwordx4 v17, s[28:31], s71 offen offset:1024 lds
    buffer_load_dwordx4 v18, s[28:31], s71 offen offset:2048 lds
    buffer_load_dwordx4 v19, s[28:31], s71 offen offset:3072 lds
    s_add_u32 m0, s70, 4096
    s_nop 0
    buffer_load_dwordx4 v20, s[32:35], s72 offen offset:0 lds
    buffer_load_dwordx4 v21, s[32:35], s72 offen offset:1024 lds
    buffer_load_dwordx4 v22, s[32:35], s72 offen offset:2048 lds
    buffer_load_dwordx4 v23, s[32:35], s72 offen offset:3072 lds
    s_add_u32 m0, s70, 8192
    s_nop 0
    buffer_load_dwordx4 v24, s[32:35], s72 offen offset:0 lds
    buffer_load_dwordx4 v25, s[32:35], s72 offen offset:1024 lds
    s_add_u32 s70, s70, 40960
    s_cmp_ge_u32 s70, 122880
    s_cselect_b32 s76, 122880, 0
    s_sub_u32 s70, s70, s76
    buffer_load_dwordx4 v[96:99], v76, s[48:51], s75 offen nt
    s_add_u32 s75, s75, 7168
    buffer_load_dwordx4 v[100:103], v76, s[48:51], s75 offen nt
    s_add_u32 s75, s75, 7168
    buffer_load_dwordx4 v[104:107], v76, s[48:51], s75 offen nt
    s_add_u32 s75, s75, 7168
    buffer_load_dwordx4 v[108:111], v76, s[48:51], s75 offen nt
    s_add_u32 s75, s75, 7168
    buffer_load_dwordx4 v[128:131], v76, s[48:51], s75 offen nt
    s_add_u32 s75, s75, 7168
    buffer_load_dwordx4 v[132:135], v76, s[48:51], s75 offen nt
    s_add_u32 s75, s75, 7168
    buffer_load_dwordx4 v[136:139], v76, s[48:51], s75 offen nt
    s_add_u32 s75, s75, 7168
    buffer_load_dwordx4 v[140:143], v76, s[48:51], s75 offen nt
    s_add_u32 s75, s75, 7168
    s_waitcnt vmcnt(18)
    s_branch L_hbar
L_ev_57:
    s_cmp_eq_u32 s77, 6
    s_cbranch_scc0 L_ev_58
    s_and_b32 s72, s84, 15
    s_mov_b32 m0, s70
    s_lshl_b32 s71, s72, 7
    buffer_load_dwordx4 v16, s[28:31], s71 offen offset:0 lds
    s_mul_i32 s72, s72, 393216
    s_lshr_b64 s[84:85], s[84:85], 4
    buffer_load_dwordx4 v17, s[28:31], s71 offen offset:1024 lds
    buffer_load_dwordx4 v18, s[28:31], s71 offen offset:2048 lds
    buffer_load_dwordx4 v19, s[28:31], s71 offen offset:3072 lds
    s_add_u32 m0, s70, 4096
    s_nop 0
    buffer_load_dwordx4 v20, s[32:35], s72 offen offset:0 lds
    buffer_load_dwordx4 v21, s[32:35], s72 offen offset:1024 lds
    buffer_load_dwordx4 v22, s[32:35], s72 offen offset:2048 lds
    buffer_load_dwordx4 v23, s[32:35], s72 offen offset:3072 lds
    s_add_u32 m0, s70, 8192
    s_nop 0
    buffer_load_dwordx4 v24, s[32:35], s72 offen offset:0 lds
    buffer_load_dwordx4 v25, s[32:35], s72 offen offset:1024 lds
    s_add_u32 s70, s70, 40960
    s_cmp_ge_u32 s70, 122880
    s_cselect_b32 s76, 122880, 0
    s_sub_u32 s70, s70, s76
    s_lshl_b32 s78, s62, 9
    v_lshl_add_u32 v11, v1, 7, s78
    s_mov_b64 exec, 15
    global_load_dword v27, v11, s[14:15]
    s_mov_b64 exec, -1
    buffer_load_dwordx4 v[112:115], v76, s[48:51], s75 offen nt
    s_add_u32 s75, s75, 7168
    buffer_load_dwordx4 v[116:119], v76, s[48:51], s75 offen nt
    s_add_u32 s75, s75, 7168
    buffer_load_dwordx4 v[120:123], v76, s[48:51], s75 offen nt
    s_add_u32 s75, s75, 7168
    buffer_load_dwordx4 v[124:127], v76, s[48:51], s75 offen nt
    s_add_u32 s75, s75, 7168
    buffer_load_dwordx4 v[144:147], v76, s[48:51], s75 offen nt
    s_add_u32 s75, s75, 7168
    buffer_load_dwordx4 v[148:151], v76, s[48:51], s75 offen nt
    s_add_u32 s75, s75, 7168
    buffer_load_dwordx4 v[152:155], v76, s[48:51], s75 offen nt
    s_add_u32 s75, s75, 7168
    buffer_load_dwordx4 v[156:159], v76, s[48:51], s75 offen nt
    s_add_u32 s75, s75, 7168
    s_waitcnt vmcnt(19)
    s_branch L_hbar
L_ev_58:
    s_add_u32 s78, s70, 40960
    s_cmp_ge_u32 s78, 122880
    s_cselect_b32 s76, 122880, 0
    s_sub_u32 s78, s78, s76
    s_cmp_eq_u32 s77, 2
    s_cbranch_scc1 L_evw
    v_add_u32 v4, s78, v72
    v_xor_b32 v5, 32, v4
    v_xor_b32 v6, 64, v4
    v_xor_b32 v7, 96, v4
    s_and_b32 s72, s84, 15
    s_mov_b32 m0, s70
    s_lshl_b32 s71, s72, 7
    buffer_load_dwordx4 v16, s[28:31], s71 offen offset:0 lds
    s_mul_i32 s72, s72, 393216
    s_lshr_b64 s[84:85], s[84:85], 4
    ds_read_b128 v[32:35], v4
    ds_read_b128 v[36:39], v5
    ds_read_b128 v[40:43], v6
    ds_read_b128 v[44:47], v7
    buffer_load_dwordx4 v17, s[28:31], s71 offen offset:1024 lds
    s_lshl_b32 s79, s62, 8
    s_add_u32 s79, s79, s73
    s_waitcnt lgkmcnt(0)
    v_lshlrev_b32 v8, 16, v32
    v_and_b32 v9, s90, v32
    v_add_f32 v80, v80, v8
    v_add_f32 v82, v82, v9
    v_fmac_f32 v81, v8, v8
    v_fmac_f32 v83, v9, v9
    v_lshlrev_b32 v10, 16, v33
    v_and_b32 v11, s90, v33
    v_add_f32 v80, v80, v10
    v_add_f32 v82, v82, v11
    v_fmac_f32 v81, v10, v10
    v_fmac_f32_e64 v83, v11, v11
    buffer_load_dwordx4 v18, s[28:31], s71 offen offset:2048 lds
    v_lshlrev_b32 v8, 16, v34
    v_and_b32 v9, s90, v34
    v_add_f32 v80, v80, v8
    v_add_f32 v82, v82, v9
    v_fmac_f32 v81, v8, v8
    v_fmac_f32 v83, v9, v9
    v_lshlrev_b32 v10, 16, v35
    v_and_b32 v11, s90, v35
    v_add_f32 v80, v80, v10
    v_add_f32 v82, v82, v11
    v_fmac_f32 v81, v10, v10
    v_fmac_f32 v83, v11, v11
    buffer_load_dwordx4 v19, s[28:31], s71 offen offset:3072 lds
    v_lshlrev_b32 v8, 16, v36
    v_and_b32 v9, s90, v36
    v_add_f32 v80, v80, v8
    v_add_f32 v82, v82, v9
    v_fmac_f32 v81, v8, v8
    v_fmac_f32 v83, v9, v9
    v_lshlrev_b32 v10, 16, v37
    v_and_b32 v11, s90, v37
    v_add_f32 v80, v80, v10
    v_add_f32 v82, v82, v11
    v_fmac_f32 v81, v10, v10
    v_fmac_f32 v83, v11, v11
    s_add_u32 m0, s70, 4096
    s_nop 0
    buffer_load_dwordx4 v20, s[32:35], s72 offen offset:0 lds
    v_lshlrev_b32 v8, 16, v38
    v_and_b32 v9, s90, v38
    v_add_f32 v80, v80, v8
    v_add_f32 v82, v82, v9
    v_fmac_f32 v81, v8, v8
    v_fmac_f32 v83, v9, v9
    v_lshlrev_b32 v10, 16, v39
    v_and_b32 v11, s90, v39
    v_add_f32 v80, v80, v10
    v_add_f32 v82, v82, v11
    v_fmac_f32 v81, v10, v10
    v_fmac_f32_e64 v83, v11, v11
    buffer_load_dwordx4 v21, s[32:35], s72 offen offset:1024 lds
    v_lshlrev_b32 v8, 16, v40
    v_and_b32 v9, s90, v40
    v_add_f32 v80, v80, v8
    v_add_f32 v82, v82, v9
    v_fmac_f32 v81, v8, v8
    v_fmac_f32 v83, v9, v9
    v_lshlrev_b32 v10, 16, v41
    v_and_b32 v11, s90, v41
    v_add_f32 v80, v80, v10
    v_add_f32 v82, v82, v11
    v_fmac_f32 v81, v10, v10
    v_fmac_f32 v83, v11, v11
    buffer_load_dwordx4 v22, s[32:35], s72 offen offset:2048 lds
    v_lshlrev_b32 v8, 16, v42
    v_and_b32 v9, s90, v42
    v_add_f32 v80, v80, v8
    v_add_f32 v82, v82, v9
    v_fmac_f32 v81, v8, v8
    v_fmac_f32 v83, v9, v9
    v_lshlrev_b32 v10, 16, v43
    v_and_b32 v11, s90, v43
    v_add_f32 v80, v80, v10
    v_add_f32 v82, v82, v11
    v_fmac_f32 v81, v10, v10
    v_fmac_f32 v83, v11, v11
    buffer_load_dwordx4 v23, s[32:35], s72 offen offset:3072 lds
    v_lshlrev_b32 v8, 16, v44
    v_and_b32 v9, s90, v44
    v_add_f32 v80, v80, v8
    v_add_f32 v82, v82, v9
    v_fmac_f32 v81, v8, v8
    v_fmac_f32 v83, v9, v9
    v_lshlrev_b32 v10, 16, v45
    v_and_b32 v11, s90, v45
    v_add_f32 v80, v80, v10
    v_add_f32 v82, v82, v11
    v_fmac_f32 v81, v10, v10
    v_fmac_f32 v83, v11, v11
    s_add_u32 m0, s70, 8192
    s_nop 0
    buffer_load_dwordx4 v24, s[32:35], s72 offen offset:0 lds
    v_lshlrev_b32 v8, 16, v46
    v_and_b32 v9, s90, v46
    v_add_f32 v80, v80, v8
    v_add_f32 v82, v82, v9
    v_fmac_f32 v81, v8, v8
    v_fmac_f32 v83, v9, v9
    v_lshlrev_b32 v10, 16, v47
    v_and_b32 v11, s90, v47
    v_add_f32 v80, v80, v10
    v_add_f32 v82, v82, v11
    v_fmac_f32 v81, v10, v10
    v_fmac_f32_e64 v83, v11, v11
    buffer_load_dwordx4 v25, s[32:35], s72 offen offset:1024 lds
    s_add_u32 s70, s70, 40960
    s_cmp_ge_u32 s70, 122880
    s_cselect_b32 s76, 122880, 0
    s_sub_u32 s70, s70, s76
    s_xor_b32 s69, s69, 1
    s_cbranch_scc1 L_hw10
    v_add_f32 v80, v80, v82
    v_add_f32 v81, v81, v83
    v_mov_b32 v82, v80
    v_mov_b32 v83, v81
    s_nop 0
    v_permlane32_swap_b32 v80, v82
    v_permlane32_swap_b32 v81, v83
    v_add_f32 v80, v80, v82
    v_add_f32_e64 v81, v81, v83
    s_mov_b32 exec_hi, 0
    buffer_store_dwordx2 v[80:81], v74, s[40:43], s79 offen offset:0 sc1
    s_mov_b64 exec, -1
    s_waitcnt vmcnt(11)
    s_branch L_hbar
L_evw:
    s_mul_i32 s79, s63, 2048
    s_add_u32 s79, s79, s78
    v_add_u32_e64 v4, s79, v73
    s_mul_i32 s79, s63, 20480
    s_add_u32 s79, s79, s78
    v_add_u32_e64 v5, s79, v73
    s_and_b32 s72, s84, 15
    s_mov_b32 m0, s70
    s_lshl_b32 s71, s72, 7
    buffer_load_dwordx4 v16, s[28:31], s71 offen offset:0 lds
    s_mul_i32 s72, s72, 393216
    s_lshr_b64 s[84:85], s[84:85], 4
    ds_read_b64_tr_b16 v[32:33], v4 offset:0
    ds_read_b64_tr_b16 v[34:35], v4 offset:512
    ds_read_b64_tr_b16 v[36:37], v4 offset:10240
    ds_read_b64_tr_b16 v[38:39], v4 offset:10752
    ds_read_b64_tr_b16 v[40:41], v4 offset:20480
    ds_read_b64_tr_b16 v[42:43], v4 offset:20992
    ds_read_b64_tr_b16 v[44:45], v4 offset:30720
    ds_read_b64_tr_b16 v[46:47], v4 offset:31232
    ds_read_b64_tr_b16 v[48:49], v5 offset:4096
    ds_read_b64_tr_b16 v[50:51], v5 offset:4608
    ds_read_b64_tr_b16 v[52:53], v5 offset:14336
    ds_read_b64_tr_b16 v[54:55], v5 offset:14848
    buffer_load_dwordx4 v17, s[28:31], s71 offen offset:1024 lds
    s_lshl_b32 s79, s64, 9
    s_lshl_b32 s80, s63, 3
    s_add_u32 s79, s79, s80
    s_add_u32 s79, s79, s73
    s_waitcnt lgkmcnt(0)
    v_lshlrev_b32 v8, 16, v32
    v_and_b32 v9, s90, v32
    v_add_f32 v80, v80, v8
    v_add_f32 v82, v82, v9
    v_lshlrev_b32 v10, 16, v33
    v_and_b32 v11, s90, v33
    v_add_f32 v80, v80, v10
    v_add_f32 v82, v82, v11
    v_lshlrev_b32 v8, 16, v34
    v_and_b32 v9, s90, v34
    v_add_f32 v80, v80, v8
    v_add_f32 v82, v82, v9
    buffer_load_dwordx4 v18, s[28:31], s71 offen offset:2048 lds
    v_lshlrev_b32 v10, 16, v35
    v_and_b32 v11, s90, v35
    v_add_f32 v80, v80, v10
    v_add_f32 v82, v82, v11
    v_lshlrev_b32 v8, 16, v36
    v_and_b32 v9, s90, v36
    v_add_f32 v80, v80, v8
    v_add_f32 v82, v82, v9
    v_lshlrev_b32 v10, 16, v37
    v_and_b32 v11, s90, v37
    v_add_f32 v80, v80, v10
    v_add_f32 v82, v82, v11
    buffer_load_dwordx4 v19, s[28:31], s71 offen offset:3072 lds
    v_lshlrev_b32 v8, 16, v38
    v_and_b32 v9, s90, v38
    v_add_f32 v80, v80, v8
    v_add_f32 v82, v82, v9
    v_lshlrev_b32 v10, 16, v39
    v_and_b32 v11, s90, v39
    v_add_f32 v80, v80, v10
    v_add_f32 v82, v82, v11
    v_lshlrev_b32 v8, 16, v40
    v_and_b32 v9, s90, v40
    v_add_f32 v80, v80, v8
    v_add_f32 v82, v82, v9
    s_add_u32 m0, s70, 4096
    s_nop 0
    buffer_load_dwordx4 v20, s[32:35], s72 offen offset:0 lds
    v_lshlrev_b32 v10, 16, v41
    v_and_b32 v11, s90, v41
    v_add_f32 v80, v80, v10
    v_add_f32 v82, v82, v11
    v_lshlrev_b32 v8, 16, v42
    v_and_b32 v9, s90, v42
    v_add_f32 v80, v80, v8
    v_add_f32 v82, v82, v9
    v_lshlrev_b32 v10, 16, v43
    v_and_b32 v11, s90, v43
    v_add_f32 v80, v80, v10
    v_add_f32_e64 v82, v82, v11
    buffer_load_dwordx4 v21, s[32:35], s72 offen offset:1024 lds
    v_lshlrev_b32 v8, 16, v44
    v_and_b32 v9, s90, v44
    v_add_f32 v80, v80, v8
    v_add_f32 v82, v82, v9
    v_lshlrev_b32 v10, 16, v45
    v_and_b32 v11, s90, v45
    v_add_f32 v80, v80, v10
    v_add_f32 v82, v82, v11
    v_lshlrev_b32 v8, 16, v46
    v_and_b32 v9, s90, v46
    v_add_f32 v80, v80, v8
    v_add_f32 v82, v82, v9
    buffer_load_dwordx4 v22, s[32:35], s72 offen offset:2048 lds
    v_lshlrev_b32 v10, 16, v47
    v_and_b32 v11, s90, v47
    v_add_f32 v80, v80, v10
    v_add_f32 v82, v82, v11
    v_lshlrev_b32 v8, 16, v48
    v_and_b32 v9, s90, v48
    v_add_f32 v81, v81, v8
    v_add_f32 v83, v83, v9
    v_lshlrev_b32 v10, 16, v49
    v_and_b32 v11, s90, v49
    v_add_f32 v81, v81, v10
    v_add_f32 v83, v83, v11
    buffer_load_dwordx4 v23, s[32:35], s72 offen offset:3072 lds
    v_lshlrev_b32 v8, 16, v50
    v_and_b32 v9, s90, v50
    v_add_f32 v81, v81, v8
    v_add_f32 v83, v83, v9
    v_lshlrev_b32 v10, 16, v51
    v_and_b32 v11, s90, v51
    v_add_f32 v81, v81, v10
    v_add_f32 v83, v83, v11
    v_lshlrev_b32 v8, 16, v52
    v_and_b32 v9, s90, v52
    v_add_f32 v81, v81, v8
    v_add_f32 v83, v83, v9
    s_add_u32 m0, s70, 8192
    s_nop 0
    buffer_load_dwordx4 v24, s[32:35], s72 offen offset:0 lds
    v_lshlrev_b32 v10, 16, v53
    v_and_b32 v11, s90, v53
    v_add_f32 v81, v81, v10
    v_add_f32 v83, v83, v11
    v_lshlrev_b32 v8, 16, v54
    v_and_b32 v9, s90, v54
    v_add_f32 v81, v81, v8
    v_add_f32 v83, v83, v9
    v_lshlrev_b32 v10, 16, v55
    v_and_b32 v11, s90, v55
    v_add_f32 v81, v81, v10
    v_add_f32_e64 v83, v83, v11
    buffer_load_dwordx4 v25, s[32:35], s72 offen offset:1024 lds
    s_add_u32 s70, s70, 40960
    s_cmp_ge_u32 s70, 122880
    s_cselect_b32 s76, 122880, 0
    s_sub_u32 s70, s70, s76
    s_xor_b32 s69, s69, 1
    s_cbranch_scc1 L_hw10
    v_add_f32 v80, v80, v82
    v_add_f32 v81, v81, v83
    v_mov_b32 v82, v80
    v_mov_b32 v83, v81
    s_nop 0
    v_permlane32_swap_b32 v80, v82
    v_permlane32_swap_b32 v81, v83
    v_add_f32 v80, v80, v82
    v_add_f32_e64 v81, v81, v83
    s_mov_b32 exec_hi, 0
    buffer_store_dwordx2 v[80:81], v12, s[40:43], s79 offen offset:1024 sc1
    s_mov_b64 exec, -1
    s_waitcnt vmcnt(11)
    s_branch L_hbar
L_compute:
    s_load_dwordx4 s[8:11], s[0:1], 16
    s_load_dwordx16 s[12:27], s[0:1], 32
    s_and_b32 s62, s62, 3
    s_and_b32 s76, s2, 7
    s_lshl_b32 s76, s76, 3
    s_lshr_b32 s77, s2, 7
    s_lshl2_add_u32 s76, s77, s76
    s_mov_b32 s80, 0x654210b3
    s_mov_b32 s81, 0xfedca987
    s_lshr_b64 s[80:81], s[80:81], s76
    s_and_b32 s61, s80, 15
    s_setprio 2
    s_and_b32 s63, s62, 1
    s_lshr_b32 s64, s62, 1
    s_lshl_b32 s73, s60, 4
    s_add_u32 s73, s73, s61
    s_mul_i32 s73, s73, 28800
    s_add_u32 s76, s2, 7
    s_and_b32 s76, s76, 7
    s_bfe_u32 s77, s2, 0x10003
    s_lshl1_add_u32 s97, s76, s77
    s_lshr_b32 s98, s2, 4
    s_lshl_b32 s99, s97, 4
    s_add_u32 s99, s99, s98
    s_mul_i32 s99, s99, 9344
    s_add_u32 s99, s99, 8388608
    s_lshr_b32 s65, s97, 1
    s_lshl_b32 s76, s97, 3
    s_add_u32 s65, s65, s76
    s_mul_i32 s76, s98, 4
    s_add_u32 s65, s65, s76
    s_and_b32 s65, s65, 15
    s_mov_b32 s89, 0x3f803f80
    s_mov_b32 s90, 0xffff0000
    v_and_b32 v2, 31, v1
    v_lshrrev_b32 v3, 5, v1
    v_lshlrev_b32 v12, 4, v1
    v_lshrrev_b32_e64 v4, 3, v1
    v_mul_u32_u24 v13, 460800, v4
    v_and_b32_e64 v4, 7, v1
    v_lshl_add_u32 v13, v4, 4, v13
    v_and_b32 v10, 15, v1
    v_lshrrev_b32 v11, 4, v1
    s_mul_i32 s76, s63, 20480
    v_lshrrev_b32 v4, 1, v10
    v_xor_b32 v4, v4, v11
    v_lshlrev_b32_e64 v4, 4, v4
    v_lshl_add_u32 v4, v10, 7, v4
    v_add_u32 v192, s76, v4
    v_xor_b32 v193, 64, v192
    v_bfe_u32 v4, v1, 2, 2
    v_and_b32_e64 v6, 1, v11
    v_lshl_add_u32 v5, v6, 3, v4
    v_lshlrev_b32 v5, 7, v5
    v_lshrrev_b32 v4, 1, v4
    v_xor_b32_e64 v4, s64, v4
    v_lshl_add_u32 v5, v4, 6, v5
    v_lshl_add_u32 v5, v6, 5, v5
    v_and_b32_e64 v4, 3, v1
    v_lshl_add_u32 v5, v4, 3, v5
    v_mul_u32_u24 v4, 10240, v3
    v_add_u32_e64 v5, v5, v4
    v_add_u32 v194, 4096, v5
    v_xor_b32_e64 v195, 32, v194
    v_add_u32 v196, 40960, v192
    v_add_u32 v197, 40960, v193
    v_add_u32 v198, 40960, v194
    v_add_u32 v199, 40960, v195
    v_add_u32 v200, 81920, v192
    v_add_u32 v201, 81920, v193
    v_add_u32 v202, 81920, v194
    v_add_u32 v203, 81920, v195
    v_bfe_u32 v4, v1, 2, 2
    v_lshl_add_u32 v4, v3, 3, v4
    v_lshlrev_b32 v4, 6, v4
    v_and_b32 v5, 1, v11
    v_lshl_add_u32 v4, v5, 5, v4
    v_and_b32_e64 v5, 3, v1
    v_lshl_add_u32 v4, v5, 3, v4
    s_lshl_b32 s76, s64, 11
    s_add_u32 s76, s76, 122880
    v_add_u32_e64 v212, s76, v4
    s_lshl_b32 s76, s63, 9
    v_lshl_add_u32 v213, v10, 3, s76
    v_lshl_add_u32 v214, v2, 3, s76
    s_lshl_b32 s76, s64, 8
    v_lshl_add_u32 v215, v10, 3, s76
    v_bfe_u32 v4, v10, 1, 1
    v_xor_b32 v4, s64, v4
    v_lshrrev_b32 v5, 2, v10
    v_xor_b32 v5, v5, v3
    v_xor_b32 v6, v10, v11
    v_and_b32 v6, 1, v6
    v_lshlrev_b32_e64 v4, 6, v4
    v_lshl_add_u32 v4, v5, 4, v4
    v_lshl_add_u32 v4, v6, 3, v4
    v_lshl_add_u32 v4, v10, 7, v4
    s_lshl_b32 s76, s63, 13
    v_add_u32 v216, s76, v4
    v_bfe_u32 v4, v2, 1, 1
    v_bfe_u32 v5, v2, 2, 2
    v_and_b32 v6, 1, v2
    v_xor_b32 v6, v6, v3
    v_lshlrev_b32_e64 v4, 6, v4
    v_lshl_add_u32 v4, v5, 4, v4
    v_lshl_add_u32 v4, v6, 3, v4
    v_lshl_add_u32 v4, v2, 7, v4
    s_lshl_b32 s77, s64, 14
    s_add_u32 s76, s76, s77
    v_add_u32_e64 v217, s76, v4
    v_bfe_u32 v4, v1, 2, 2
    v_lshl_add_u32 v5, v3, 3, v4
    v_lshlrev_b32 v5, 7, v5
    v_lshrrev_b32 v6, 1, v4
    v_lshl_add_u32 v5, v6, 6, v5
    v_bfe_u32 v6, v1, 4, 1
    v_xor_b32_e64 v6, v6, v3
    v_lshl_add_u32 v5, v6, 5, v5
    v_bfe_u32 v6, v1, 1, 1
    v_lshl_add_u32 v5, v6, 4, v5
    v_xor_b32 v6, v1, v4
    v_and_b32 v6, 1, v6
    v_lshl_add_u32 v5, v6, 3, v5
    s_lshl_b32 s76, s63, 13
    v_xor_b32 v5, s76, v5
    s_lshl_b32 s76, s63, 6
    s_or_b32 s76, s76, s77
    v_xor_b32 v218, s76, v5
    s_lshl_b32 s76, s64, 6
    v_xor_b32_e64 v220, s76, v5
    v_xor_b32 v219, 528, v218
    v_xor_b32 v221, 528, v220
    v_cmp_gt_u32 s[86:87], 16, v1
    s_waitcnt lgkmcnt(0)
    s_mov_b32 s40, s26
    s_and_b32 s41, s27, 0xffff
    s_mov_b32 s42, 33554432
    s_mov_b32 s43, 0x20000
    s_mov_b32 s44, s22
    s_and_b32 s45, s23, 0xffff
    s_mov_b32 s46, 4194304
    s_mov_b32 s47, 0x20000
    s_mov_b32 s68, 0
    s_getreg_b32 s101, hwreg(HW_REG_XCC_ID, 0, 4)
    v_mov_b32 v9, 13631488
    s_lshl_b32 s76, s61, 8
    s_lshl4_add_u32 s76, s60, s76
    s_add_u32 s76, s76, 12582912
    v_mov_b32 v8, s76
    s_lshl_b32 s76, s60, 8
    s_lshl4_add_u32 s76, s61, s76
    s_add_u32 s76, s76, 12587008
    v_writelane_b32 v8, s76, 1
    s_lshl_b32 s76, s97, 8
    s_lshl4_add_u32 s76, s98, s76
    s_add_u32 s76, s76, 12591104
    v_writelane_b32 v8, s76, 2
    v_mov_b32 v6, s101
    v_mov_b32 v7, 0
    v_mov_b32_e64 v10, 0
    s_cmp_eq_u32 s62, 0
    s_cbranch_scc0 L_noep
    buffer_load_dwordx2 v[4:5], v9, s[40:43], 0 offen
L_noep:
    s_barrier
    ds_read_b128 v[112:115], v192 offset:0
    ds_read_b64_tr_b16 v[128:129], v194 offset:0
    ds_read_b64_tr_b16 v[130:131], v194 offset:512
    ds_read_b128 v[116:119], v192 offset:2048
    ds_read_b128 v[120:123], v192 offset:10240
    ds_read_b128 v[124:127], v192 offset:12288
    ds_read_b64_tr_b16 v[132:133], v195 offset:0
    ds_read_b64_tr_b16 v[134:135], v195 offset:512
    ds_read_b64_tr_b16 v[136:137], v194 offset:2048
    ds_read_b64_tr_b16 v[138:139], v194 offset:2560
    ds_read_b64_tr_b16 v[140:141], v195 offset:2048
    ds_read_b64_tr_b16 v[142:143], v195 offset:2560
    ds_read_b64_tr_b16 v[144:145], v194 offset:4096
    ds_read_b64_tr_b16 v[146:147], v194 offset:4608
    s_waitcnt lgkmcnt(8)
    ds_read_b64_tr_b16 v[148:149], v195 offset:4096
    ds_read_b64_tr_b16 v[150:151], v195 offset:4608
    v_mfma_f32_16x16x32_bf16 v[16:19], v[128:131], v[112:115], 0
    ds_read_b128 v[152:155], v193 offset:0
    v_mfma_f32_16x16x32_bf16 v[20:23], v[128:131], v[116:119], 0
    ds_read_b64_tr_b16 v[168:169], v194 offset:20480
    v_mfma_f32_16x16x32_bf16 v[24:27], v[128:131], v[120:123], 0
    ds_read_b64_tr_b16 v[170:171], v194 offset:20992
    v_mfma_f32_16x16x32_bf16 v[28:31], v[128:131], v[124:127], 0
    ds_read_b128 v[156:159], v193 offset:2048
    s_waitcnt lgkmcnt(4)
    v_mfma_f32_16x16x32_bf16 v[44:47], v[132:135], v[124:127], 0
    ds_read_b128 v[160:163], v193 offset:10240
    v_mfma_f32_16x16x32_bf16 v[40:43], v[132:135], v[120:123], 0
    ds_read_b128 v[164:167], v193 offset:12288
    v_mfma_f32_16x16x32_bf16 v[36:39], v[132:135], v[116:119], 0
    ds_read_b64_tr_b16 v[172:173], v195 offset:20480
    v_mfma_f32_16x16x32_bf16 v[32:35], v[132:135], v[112:115], 0
    ds_read_b64_tr_b16 v[174:175], v195 offset:20992
    v_mfma_f32_16x16x32_bf16 v[48:51], v[136:139], v[112:115], 0
    ds_read_b64_tr_b16 v[176:177], v194 offset:22528
    v_mfma_f32_16x16x32_bf16 v[52:55], v[136:139], v[116:119], 0
    ds_read_b64_tr_b16 v[178:179], v194 offset:23040
    v_mfma_f32_16x16x32_bf16 v[56:59], v[136:139], v[120:123], 0
    ds_read_b64_tr_b16 v[180:181], v195 offset:22528
    v_mfma_f32_16x16x32_bf16 v[60:63], v[136:139], v[124:127], 0
    ds_read_b64_tr_b16 v[182:183], v195 offset:23040
    v_mfma_f32_16x16x32_bf16 v[76:79], v[140:143], v[124:127], 0
    ds_read_b64_tr_b16 v[184:185], v194 offset:24576
    v_mfma_f32_16x16x32_bf16 v[72:75], v[140:143], v[120:123], 0
    ds_read_b64_tr_b16 v[186:187], v194 offset:25088
    v_mfma_f32_16x16x32_bf16 v[68:71], v[140:143], v[116:119], 0
    ds_read_b64_tr_b16 v[188:189], v195 offset:24576
    v_mfma_f32_16x16x32_bf16 v[64:67], v[140:143], v[112:115], 0
    ds_read_b64_tr_b16 v[190:191], v195 offset:25088
    v_mfma_f32_16x16x32_bf16 v[80:83], v[144:147], v[112:115], 0
    v_mfma_f32_16x16x32_bf16 v[84:87], v[144:147], v[116:119], 0
    v_mfma_f32_16x16x32_bf16 v[88:91], v[144:147], v[120:123], 0
    v_mfma_f32_16x16x32_bf16 v[92:95], v[144:147], v[124:127], 0
    v_mfma_f32_16x16x32_bf16 v[108:111], v[148:151], v[124:127], 0
    v_mfma_f32_16x16x32_bf16 v[104:107], v[148:151], v[120:123], 0
    v_mfma_f32_16x16x32_bf16 v[100:103], v[148:151], v[116:119], 0
    v_mfma_f32_16x16x32_bf16 v[96:99], v[148:151], v[112:115], 0
    s_waitcnt lgkmcnt(0)
    v_mfma_f32_16x16x32_bf16 v[16:19], v[168:171], v[152:155], v[16:19]
    s_barrier
    v_mfma_f32_16x16x32_bf16 v[20:23], v[168:171], v[156:159], v[20:23]
    ds_read_b128 v[112:115], v196 offset:0
    ds_read_b64_tr_b16 v[204:205], v212 offset:0
    ds_read_b64_tr_b16 v[206:207], v212 offset:256
    ds_read_b64_tr_b16 v[208:209], v212 offset:1024
    ds_read_b64_tr_b16 v[210:211], v212 offset:1280
    v_mfma_f32_16x16x32_bf16 v[24:27], v[168:171], v[160:163], v[24:27]
    ds_read_b64_tr_b16 v[128:129], v198 offset:0
    s_cmp_eq_u32 s62, 0
    s_cbranch_scc0 L_cloop
    s_waitcnt vmcnt(0)
    v_add_co_u32 v4, vcc, 1, v4
    s_nop 1
    v_addc_co_u32 v5, vcc, 0, v5, vcc
    s_mov_b64 exec, 7
    buffer_store_dwordx4 v[4:7], v8, s[40:43], 0 offen sc1
    s_mov_b64 exec, -1
.p2align 3
L_cloop:
    v_mfma_f32_16x16x32_bf16 v[28:31], v[168:171], v[164:167], v[28:31]
    ds_read_b64_tr_b16 v[130:131], v198 offset:512
    v_mfma_f32_16x16x32_bf16 v[44:47], v[172:175], v[164:167], v[44:47]
    ds_read_b128 v[116:119], v196 offset:2048
    v_mfma_f32_16x16x32_bf16 v[40:43], v[172:175], v[160:163], v[40:43]
    ds_read_b128 v[120:123], v196 offset:10240
    v_mfma_f32_16x16x32_bf16 v[36:39], v[172:175], v[156:159], v[36:39]
    ds_read_b128 v[124:127], v196 offset:12288
    v_mfma_f32_16x16x32_bf16 v[32:35], v[172:175], v[152:155], v[32:35]
    ds_read_b64_tr_b16 v[132:133], v199 offset:0
    v_mfma_f32_16x16x32_bf16 v[48:51], v[176:179], v[152:155], v[48:51]
    ds_read_b64_tr_b16 v[134:135], v199 offset:512
    v_mfma_f32_16x16x32_bf16 v[52:55], v[176:179], v[156:159], v[52:55]
    ds_read_b64_tr_b16 v[136:137], v198 offset:2048
    v_mfma_f32_16x16x32_bf16 v[56:59], v[176:179], v[160:163], v[56:59]
    ds_read_b64_tr_b16 v[138:139], v198 offset:2560
    v_mfma_f32_16x16x32_bf16 v[60:63], v[176:179], v[164:167], v[60:63]
    ds_read_b64_tr_b16 v[140:141], v199 offset:2048
    v_mfma_f32_16x16x32_bf16 v[76:79], v[180:183], v[164:167], v[76:79]
    ds_read_b64_tr_b16 v[142:143], v199 offset:2560
    v_mfma_f32_16x16x32_bf16 v[72:75], v[180:183], v[160:163], v[72:75]
    ds_read_b64_tr_b16 v[144:145], v198 offset:4096
    v_mfma_f32_16x16x32_bf16 v[68:71], v[180:183], v[156:159], v[68:71]
    ds_read_b64_tr_b16 v[146:147], v198 offset:4608
    v_mfma_f32_16x16x32_bf16 v[64:67], v[180:183], v[152:155], v[64:67]
    ds_read_b64_tr_b16 v[148:149], v199 offset:4096
    v_mfma_f32_16x16x32_bf16 v[80:83], v[184:187], v[152:155], v[80:83]
    ds_read_b64_tr_b16 v[150:151], v199 offset:4608
    v_mfma_f32_16x16x32_bf16 v[84:87], v[184:187], v[156:159], v[84:87]
    v_mfma_f32_16x16x32_bf16 v[88:91], v[184:187], v[160:163], v[88:91]
    v_mfma_f32_16x16x32_bf16 v[92:95], v[184:187], v[164:167], v[92:95]
    v_mfma_f32_16x16x32_bf16 v[108:111], v[188:191], v[164:167], v[108:111]
    v_mfma_f32_16x16x32_bf16 v[104:107], v[188:191], v[160:163], v[104:107]
    v_mfma_f32_16x16x32_bf16 v[100:103], v[188:191], v[156:159], v[100:103]
    v_mfma_f32_16x16x32_bf16 v[96:99], v[188:191], v[152:155], v[96:99]
    s_waitcnt lgkmcnt(0)
    v_mfma_f32_16x16x32_bf16 v[16:19], v[128:131], v[112:115], v[16:19]
    ds_read_b128 v[152:155], v197 offset:0
    v_mfma_f32_16x16x32_bf16 v[20:23], v[128:131], v[116:119], v[20:23]
    ds_read_b64_tr_b16 v[168:169], v198 offset:20480
    v_mfma_f32_16x16x32_bf16 v[24:27], v[128:131], v[120:123], v[24:27]
    ds_read_b64_tr_b16 v[170:171], v198 offset:20992
    v_mfma_f32_16x16x32_bf16 v[28:31], v[128:131], v[124:127], v[28:31]
    ds_read_b128 v[156:159], v197 offset:2048
    v_mfma_f32_16x16x32_bf16 v[44:47], v[132:135], v[124:127], v[44:47]
    ds_read_b128 v[160:163], v197 offset:10240
    v_mfma_f32_16x16x32_bf16 v[40:43], v[132:135], v[120:123], v[40:43]
    ds_read_b128 v[164:167], v197 offset:12288
    v_mfma_f32_16x16x32_bf16 v[36:39], v[132:135], v[116:119], v[36:39]
    ds_read_b64_tr_b16 v[172:173], v199 offset:20480
    v_mfma_f32_16x16x32_bf16 v[32:35], v[132:135], v[112:115], v[32:35]
    ds_read_b64_tr_b16 v[174:175], v199 offset:20992
    v_mfma_f32_16x16x32_bf16 v[48:51], v[136:139], v[112:115], v[48:51]
    ds_read_b64_tr_b16 v[176:177], v198 offset:22528
    v_mfma_f32_16x16x32_bf16 v[52:55], v[136:139], v[116:119], v[52:55]
    ds_read_b64_tr_b16 v[178:179], v198 offset:23040
    v_mfma_f32_16x16x32_bf16 v[56:59], v[136:139], v[120:123], v[56:59]
    ds_read_b64_tr_b16 v[180:181], v199 offset:22528
    v_mfma_f32_16x16x32_bf16 v[60:63], v[136:139], v[124:127], v[60:63]
    ds_read_b64_tr_b16 v[182:183], v199 offset:23040
    v_mfma_f32_16x16x32_bf16 v[76:79], v[140:143], v[124:127], v[76:79]
    ds_read_b64_tr_b16 v[184:185], v198 offset:24576
    v_mfma_f32_16x16x32_bf16 v[72:75], v[140:143], v[120:123], v[72:75]
    ds_read_b64_tr_b16 v[186:187], v198 offset:25088
    v_mfma_f32_16x16x32_bf16 v[68:71], v[140:143], v[116:119], v[68:71]
    ds_read_b64_tr_b16 v[188:189], v199 offset:24576
    v_mfma_f32_16x16x32_bf16 v[64:67], v[140:143], v[112:115], v[64:67]
    ds_read_b64_tr_b16 v[190:191], v199 offset:25088
    v_mfma_f32_16x16x32_bf16 v[80:83], v[144:147], v[112:115], v[80:83]
    v_mfma_f32_16x16x32_bf16 v[84:87], v[144:147], v[116:119], v[84:87]
    v_mfma_f32_16x16x32_bf16 v[88:91], v[144:147], v[120:123], v[88:91]
    v_mfma_f32_16x16x32_bf16 v[92:95], v[144:147], v[124:127], v[92:95]
    v_mfma_f32_16x16x32_bf16 v[108:111], v[148:151], v[124:127], v[108:111]
    v_mfma_f32_16x16x32_bf16 v[104:107], v[148:151], v[120:123], v[104:107]
    v_mfma_f32_16x16x32_bf16 v[100:103], v[148:151], v[116:119], v[100:103]
    v_mfma_f32_16x16x32_bf16 v[96:99], v[148:151], v[112:115], v[96:99]
    s_waitcnt lgkmcnt(0)
    v_mfma_f32_16x16x32_bf16 v[16:19], v[168:171], v[152:155], v[16:19]
    s_barrier
    v_mfma_f32_16x16x32_bf16 v[20:23], v[168:171], v[156:159], v[20:23]
    ds_read_b128 v[112:115], v200 offset:0
    v_mfma_f32_16x16x32_bf16 v[24:27], v[168:171], v[160:163], v[24:27]
    ds_read_b64_tr_b16 v[128:129], v202 offset:0
    v_mfma_f32_16x16x32_bf16 v[28:31], v[168:171], v[164:167], v[28:31]
    ds_read_b64_tr_b16 v[130:131], v202 offset:512
    v_mfma_f32_16x16x32_bf16 v[44:47], v[172:175], v[164:167], v[44:47]
    ds_read_b128 v[116:119], v200 offset:2048
    v_mfma_f32_16x16x32_bf16 v[40:43], v[172:175], v[160:163], v[40:43]
    ds_read_b128 v[120:123], v200 offset:10240
    v_mfma_f32_16x16x32_bf16 v[36:39], v[172:175], v[156:159], v[36:39]
    ds_read_b128 v[124:127], v200 offset:12288
    v_mfma_f32_16x16x32_bf16 v[32:35], v[172:175], v[152:155], v[32:35]
    ds_read_b64_tr_b16 v[132:133], v203 offset:0
    v_mfma_f32_16x16x32_bf16 v[48:51], v[176:179], v[152:155], v[48:51]
    ds_read_b64_tr_b16 v[134:135], v203 offset:512
    v_mfma_f32_16x16x32_bf16 v[52:55], v[176:179], v[156:159], v[52:55]
    ds_read_b64_tr_b16 v[136:137], v202 offset:2048
    v_mfma_f32_16x16x32_bf16 v[56:59], v[176:179], v[160:163], v[56:59]
    ds_read_b64_tr_b16 v[138:139], v202 offset:2560
    v_mfma_f32_16x16x32_bf16 v[60:63], v[176:179], v[164:167], v[60:63]
    ds_read_b64_tr_b16 v[140:141], v203 offset:2048
    v_mfma_f32_16x16x32_bf16 v[76:79], v[180:183], v[164:167], v[76:79]
    ds_read_b64_tr_b16 v[142:143], v203 offset:2560
    v_mfma_f32_16x16x32_bf16 v[72:75], v[180:183], v[160:163], v[72:75]
    ds_read_b64_tr_b16 v[144:145], v202 offset:4096
    v_mfma_f32_16x16x32_bf16 v[68:71], v[180:183], v[156:159], v[68:71]
    ds_read_b64_tr_b16 v[146:147], v202 offset:4608
    v_mfma_f32_16x16x32_bf16 v[64:67], v[180:183], v[152:155], v[64:67]
    ds_read_b64_tr_b16 v[148:149], v203 offset:4096
    v_mfma_f32_16x16x32_bf16 v[80:83], v[184:187], v[152:155], v[80:83]
    ds_read_b64_tr_b16 v[150:151], v203 offset:4608
    v_mfma_f32_16x16x32_bf16 v[84:87], v[184:187], v[156:159], v[84:87]
    v_mfma_f32_16x16x32_bf16 v[88:91], v[184:187], v[160:163], v[88:91]
    v_mfma_f32_16x16x32_bf16 v[92:95], v[184:187], v[164:167], v[92:95]
    v_mfma_f32_16x16x32_bf16 v[108:111], v[188:191], v[164:167], v[108:111]
    v_mfma_f32_16x16x32_bf16 v[104:107], v[188:191], v[160:163], v[104:107]
    v_mfma_f32_16x16x32_bf16 v[100:103], v[188:191], v[156:159], v[100:103]
    v_mfma_f32_16x16x32_bf16 v[96:99], v[188:191], v[152:155], v[96:99]
    s_waitcnt lgkmcnt(0)
    v_mfma_f32_16x16x32_bf16 v[16:19], v[128:131], v[112:115], v[16:19]
    ds_read_b128 v[152:155], v201 offset:0
    v_mfma_f32_16x16x32_bf16 v[20:23], v[128:131], v[116:119], v[20:23]
    ds_read_b64_tr_b16 v[168:169], v202 offset:20480
    v_mfma_f32_16x16x32_bf16 v[24:27], v[128:131], v[120:123], v[24:27]
    ds_read_b64_tr_b16 v[170:171], v202 offset:20992
    v_mfma_f32_16x16x32_bf16 v[28:31], v[128:131], v[124:127], v[28:31]
    ds_read_b128 v[156:159], v201 offset:2048
    v_mfma_f32_16x16x32_bf16 v[44:47], v[132:135], v[124:127], v[44:47]
    ds_read_b128 v[160:163], v201 offset:10240
    v_mfma_f32_16x16x32_bf16 v[40:43], v[132:135], v[120:123], v[40:43]
    ds_read_b128 v[164:167], v201 offset:12288
    v_mfma_f32_16x16x32_bf16 v[36:39], v[132:135], v[116:119], v[36:39]
    ds_read_b64_tr_b16 v[172:173], v203 offset:20480
    v_mfma_f32_16x16x32_bf16 v[32:35], v[132:135], v[112:115], v[32:35]
    ds_read_b64_tr_b16 v[174:175], v203 offset:20992
    v_mfma_f32_16x16x32_bf16 v[48:51], v[136:139], v[112:115], v[48:51]
    ds_read_b64_tr_b16 v[176:177], v202 offset:22528
    v_mfma_f32_16x16x32_bf16 v[52:55], v[136:139], v[116:119], v[52:55]
    ds_read_b64_tr_b16 v[178:179], v202 offset:23040
    v_mfma_f32_16x16x32_bf16 v[56:59], v[136:139], v[120:123], v[56:59]
    ds_read_b64_tr_b16 v[180:181], v203 offset:22528
    v_mfma_f32_16x16x32_bf16 v[60:63], v[136:139], v[124:127], v[60:63]
    ds_read_b64_tr_b16 v[182:183], v203 offset:23040
    v_mfma_f32_16x16x32_bf16 v[76:79], v[140:143], v[124:127], v[76:79]
    ds_read_b64_tr_b16 v[184:185], v202 offset:24576
    v_mfma_f32_16x16x32_bf16 v[72:75], v[140:143], v[120:123], v[72:75]
    ds_read_b64_tr_b16 v[186:187], v202 offset:25088
    v_mfma_f32_16x16x32_bf16 v[68:71], v[140:143], v[116:119], v[68:71]
    ds_read_b64_tr_b16 v[188:189], v203 offset:24576
    v_mfma_f32_16x16x32_bf16 v[64:67], v[140:143], v[112:115], v[64:67]
    ds_read_b64_tr_b16 v[190:191], v203 offset:25088
    v_mfma_f32_16x16x32_bf16 v[80:83], v[144:147], v[112:115], v[80:83]
    v_mfma_f32_16x16x32_bf16 v[84:87], v[144:147], v[116:119], v[84:87]
    v_mfma_f32_16x16x32_bf16 v[88:91], v[144:147], v[120:123], v[88:91]
    v_mfma_f32_16x16x32_bf16 v[92:95], v[144:147], v[124:127], v[92:95]
    v_mfma_f32_16x16x32_bf16 v[108:111], v[148:151], v[124:127], v[108:111]
    v_mfma_f32_16x16x32_bf16 v[104:107], v[148:151], v[120:123], v[104:107]
    v_mfma_f32_16x16x32_bf16 v[100:103], v[148:151], v[116:119], v[100:103]
    v_mfma_f32_16x16x32_bf16 v[96:99], v[148:151], v[112:115], v[96:99]
    s_waitcnt lgkmcnt(0)
    v_mfma_f32_16x16x32_bf16 v[16:19], v[168:171], v[152:155], v[16:19]
    s_barrier
    v_mfma_f32_16x16x32_bf16 v[20:23], v[168:171], v[156:159], v[20:23]
    ds_read_b128 v[112:115], v192 offset:0
    v_mfma_f32_16x16x32_bf16 v[24:27], v[168:171], v[160:163], v[24:27]
    ds_read_b64_tr_b16 v[128:129], v194 offset:0
    v_mfma_f32_16x16x32_bf16 v[28:31], v[168:171], v[164:167], v[28:31]
    ds_read_b64_tr_b16 v[130:131], v194 offset:512
    v_mfma_f32_16x16x32_bf16 v[44:47], v[172:175], v[164:167], v[44:47]
    ds_read_b128 v[116:119], v192 offset:2048
    v_mfma_f32_16x16x32_bf16 v[40:43], v[172:175], v[160:163], v[40:43]
    ds_read_b128 v[120:123], v192 offset:10240
    v_mfma_f32_16x16x32_bf16 v[36:39], v[172:175], v[156:159], v[36:39]
    ds_read_b128 v[124:127], v192 offset:12288
    v_mfma_f32_16x16x32_bf16 v[32:35], v[172:175], v[152:155], v[32:35]
    ds_read_b64_tr_b16 v[132:133], v195 offset:0
    v_mfma_f32_16x16x32_bf16 v[48:51], v[176:179], v[152:155], v[48:51]
    ds_read_b64_tr_b16 v[134:135], v195 offset:512
    v_mfma_f32_16x16x32_bf16 v[52:55], v[176:179], v[156:159], v[52:55]
    ds_read_b64_tr_b16 v[136:137], v194 offset:2048
    v_mfma_f32_16x16x32_bf16 v[56:59], v[176:179], v[160:163], v[56:59]
    ds_read_b64_tr_b16 v[138:139], v194 offset:2560
    v_mfma_f32_16x16x32_bf16 v[60:63], v[176:179], v[164:167], v[60:63]
    ds_read_b64_tr_b16 v[140:141], v195 offset:2048
    v_mfma_f32_16x16x32_bf16 v[76:79], v[180:183], v[164:167], v[76:79]
    ds_read_b64_tr_b16 v[142:143], v195 offset:2560
    v_mfma_f32_16x16x32_bf16 v[72:75], v[180:183], v[160:163], v[72:75]
    ds_read_b64_tr_b16 v[144:145], v194 offset:4096
    v_mfma_f32_16x16x32_bf16 v[68:71], v[180:183], v[156:159], v[68:71]
    ds_read_b64_tr_b16 v[146:147], v194 offset:4608
    v_mfma_f32_16x16x32_bf16 v[64:67], v[180:183], v[152:155], v[64:67]
    ds_read_b64_tr_b16 v[148:149], v195 offset:4096
    v_mfma_f32_16x16x32_bf16 v[80:83], v[184:187], v[152:155], v[80:83]
    ds_read_b64_tr_b16 v[150:151], v195 offset:4608
    v_mfma_f32_16x16x32_bf16 v[84:87], v[184:187], v[156:159], v[84:87]
    v_mfma_f32_16x16x32_bf16 v[88:91], v[184:187], v[160:163], v[88:91]
    v_mfma_f32_16x16x32_bf16 v[92:95], v[184:187], v[164:167], v[92:95]
    v_mfma_f32_16x16x32_bf16 v[108:111], v[188:191], v[164:167], v[108:111]
    v_mfma_f32_16x16x32_bf16 v[104:107], v[188:191], v[160:163], v[104:107]
    v_mfma_f32_16x16x32_bf16 v[100:103], v[188:191], v[156:159], v[100:103]
    v_mfma_f32_16x16x32_bf16 v[96:99], v[188:191], v[152:155], v[96:99]
    s_waitcnt lgkmcnt(0)
    v_mfma_f32_16x16x32_bf16 v[16:19], v[128:131], v[112:115], v[16:19]
    ds_read_b128 v[152:155], v193 offset:0
    v_mfma_f32_16x16x32_bf16 v[20:23], v[128:131], v[116:119], v[20:23]
    ds_read_b64_tr_b16 v[168:169], v194 offset:20480
    v_mfma_f32_16x16x32_bf16 v[24:27], v[128:131], v[120:123], v[24:27]
    ds_read_b64_tr_b16 v[170:171], v194 offset:20992
    v_mfma_f32_16x16x32_bf16 v[28:31], v[128:131], v[124:127], v[28:31]
    ds_read_b128 v[156:159], v193 offset:2048
    v_mfma_f32_16x16x32_bf16 v[44:47], v[132:135], v[124:127], v[44:47]
    ds_read_b128 v[160:163], v193 offset:10240
    v_mfma_f32_16x16x32_bf16 v[40:43], v[132:135], v[120:123], v[40:43]
    ds_read_b128 v[164:167], v193 offset:12288
    v_mfma_f32_16x16x32_bf16 v[36:39], v[132:135], v[116:119], v[36:39]
    ds_read_b64_tr_b16 v[172:173], v195 offset:20480
    v_mfma_f32_16x16x32_bf16 v[32:35], v[132:135], v[112:115], v[32:35]
    ds_read_b64_tr_b16 v[174:175], v195 offset:20992
    v_mfma_f32_16x16x32_bf16 v[48:51], v[136:139], v[112:115], v[48:51]
    ds_read_b64_tr_b16 v[176:177], v194 offset:22528
    v_mfma_f32_16x16x32_bf16 v[52:55], v[136:139], v[116:119], v[52:55]
    ds_read_b64_tr_b16 v[178:179], v194 offset:23040
    v_mfma_f32_16x16x32_bf16 v[56:59], v[136:139], v[120:123], v[56:59]
    ds_read_b64_tr_b16 v[180:181], v195 offset:22528
    v_mfma_f32_16x16x32_bf16 v[60:63], v[136:139], v[124:127], v[60:63]
    ds_read_b64_tr_b16 v[182:183], v195 offset:23040
    v_mfma_f32_16x16x32_bf16 v[76:79], v[140:143], v[124:127], v[76:79]
    ds_read_b64_tr_b16 v[184:185], v194 offset:24576
    v_mfma_f32_16x16x32_bf16 v[72:75], v[140:143], v[120:123], v[72:75]
    ds_read_b64_tr_b16 v[186:187], v194 offset:25088
    v_mfma_f32_16x16x32_bf16 v[68:71], v[140:143], v[116:119], v[68:71]
    ds_read_b64_tr_b16 v[188:189], v195 offset:24576
    v_mfma_f32_16x16x32_bf16 v[64:67], v[140:143], v[112:115], v[64:67]
    ds_read_b64_tr_b16 v[190:191], v195 offset:25088
    v_mfma_f32_16x16x32_bf16 v[80:83], v[144:147], v[112:115], v[80:83]
    v_mfma_f32_16x16x32_bf16 v[84:87], v[144:147], v[116:119], v[84:87]
    v_mfma_f32_16x16x32_bf16 v[88:91], v[144:147], v[120:123], v[88:91]
    v_mfma_f32_16x16x32_bf16 v[92:95], v[144:147], v[124:127], v[92:95]
    v_mfma_f32_16x16x32_bf16 v[108:111], v[148:151], v[124:127], v[108:111]
    s_add_u32 s68, s68, 1
    s_cmp_lt_u32 s68, 5
    v_mfma_f32_16x16x32_bf16 v[104:107], v[148:151], v[120:123], v[104:107]
    v_mfma_f32_16x16x32_bf16 v[100:103], v[148:151], v[116:119], v[100:103]
    v_mfma_f32_16x16x32_bf16 v[96:99], v[148:151], v[112:115], v[96:99]
    s_waitcnt lgkmcnt(0)
    v_mfma_f32_16x16x32_bf16 v[16:19], v[168:171], v[152:155], v[16:19]
    s_cbranch_scc0 L_cexit
    s_barrier
    v_mfma_f32_16x16x32_bf16 v[20:23], v[168:171], v[156:159], v[20:23]
    ds_read_b128 v[112:115], v196 offset:0
    v_mfma_f32_16x16x32_bf16 v[24:27], v[168:171], v[160:163], v[24:27]
    ds_read_b64_tr_b16 v[128:129], v198 offset:0
    s_branch L_cloop
L_cexit:
    v_mfma_f32_16x16x32_bf16 v[20:23], v[168:171], v[156:159], v[20:23]
    v_mfma_f32_16x16x32_bf16 v[24:27], v[168:171], v[160:163], v[24:27]
    v_mfma_f32_16x16x32_bf16 v[28:31], v[168:171], v[164:167], v[28:31]
    v_mfma_f32_16x16x32_bf16 v[44:47], v[172:175], v[164:167], v[44:47]
    v_mfma_f32_16x16x32_bf16 v[40:43], v[172:175], v[160:163], v[40:43]
    v_mfma_f32_16x16x32_bf16 v[36:39], v[172:175], v[156:159], v[36:39]
    v_mfma_f32_16x16x32_bf16 v[32:35], v[172:175], v[152:155], v[32:35]
    v_mfma_f32_16x16x32_bf16 v[48:51], v[176:179], v[152:155], v[48:51]
    v_mfma_f32_16x16x32_bf16 v[52:55], v[176:179], v[156:159], v[52:55]
    v_mfma_f32_16x16x32_bf16 v[56:59], v[176:179], v[160:163], v[56:59]
    s_barrier
    ds_read_b32 v11, v10 offset:53248
    ds_read_b64 v[222:223], v213 offset:49152
    ds_read_b64 v[224:225], v213 offset:49280
    v_mfma_f32_16x16x32_bf16 v[60:63], v[176:179], v[164:167], v[60:63]
    ds_read_b64 v[226:227], v213 offset:49408
    ds_read_b64 v[228:229], v213 offset:49536
    v_mfma_f32_16x16x32_bf16 v[76:79], v[180:183], v[164:167], v[76:79]
    ds_read_b64 v[238:239], v215 offset:50176
    ds_read_b64 v[240:241], v215 offset:50304
    v_mfma_f32_16x16x32_bf16 v[72:75], v[180:183], v[160:163], v[72:75]
    ds_read_b64 v[242:243], v215 offset:50688
    ds_read_b64 v[244:245], v215 offset:50816
    v_mfma_f32_16x16x32_bf16 v[68:71], v[180:183], v[156:159], v[68:71]
    ds_read_b64 v[246:247], v215 offset:51200
    ds_read_b64 v[248:249], v215 offset:51328
    v_mfma_f32_16x16x32_bf16 v[64:67], v[180:183], v[152:155], v[64:67]
    ds_read_b32 v250, v214 offset:49156
    ds_read_b32 v252, v214 offset:49412
    v_mfma_f32_16x16x32_bf16 v[80:83], v[184:187], v[152:155], v[80:83]
    s_waitcnt lgkmcnt(8)
    v_readfirstlane_b32 s100, v11
    v_mov_b32_e64 v230, v223
    v_cndmask_b32 v222, 0, v222, s[86:87]
    v_mfma_f32_16x16x32_bf16 v[84:87], v[184:187], v[156:159], v[84:87]
    v_mov_b32_e64 v232, v225
    v_cndmask_b32 v224, 0, v224, s[86:87]
    v_mov_b32_e64 v234, v227
    v_cndmask_b32 v226, 0, v226, s[86:87]
    v_mfma_f32_16x16x32_bf16 v[88:91], v[184:187], v[160:163], v[88:91]
    v_mov_b32_e64 v236, v229
    v_cndmask_b32 v228, 0, v228, s[86:87]
    v_mov_b32 v223, v222
    v_mov_b32 v225, v224
    v_mfma_f32_16x16x32_bf16 v[92:95], v[184:187], v[164:167], v[92:95]
    v_mov_b32 v227, v226
    v_mov_b32_e64 v229, v228
    s_waitcnt lgkmcnt(0)
    v_mul_f32 v251, 0x3fb8aa3b, v250
    v_mfma_f32_16x16x32_bf16 v[108:111], v[188:191], v[164:167], v[108:111]
    v_mul_f32 v253, 0x3fb8aa3b, v252
    v_mfma_f32_16x16x32_bf16 v[104:107], v[188:191], v[160:163], v[104:107]
    v_mfma_f32_16x16x32_bf16 v[100:103], v[188:191], v[156:159], v[100:103]
    v_mfma_f32_16x16x32_bf16 v[96:99], v[188:191], v[152:155], v[96:99]
    v_mfma_f32_16x16x16_bf16 v[48:51], v[242:243], v[222:223], v[48:51]
    v_xor_b32 v168, 0, v217
    v_xor_b32 v169, 16, v217
    v_mfma_f32_16x16x16_bf16 v[52:55], v[242:243], v[224:225], v[52:55]
    v_xor_b32 v170, 32, v217
    v_xor_b32 v171, 48, v217
    v_mfma_f32_16x16x16_bf16 v[64:67], v[244:245], v[222:223], v[64:67]
    v_xor_b32_e64 v172, 64, v217
    v_xor_b32 v173, 80, v217
    v_mfma_f32_16x16x16_bf16 v[68:71], v[244:245], v[224:225], v[68:71]
    v_xor_b32 v174, 96, v217
    v_xor_b32 v175, 112, v217
    v_mfma_f32_16x16x16_bf16 v[56:59], v[242:243], v[226:227], v[56:59]
    v_xor_b32_e64 v4, 32, v216
    v_mfma_f32_16x16x16_bf16 v[60:63], v[242:243], v[228:229], v[60:63]
    v_mfma_f32_16x16x16_bf16 v[72:75], v[244:245], v[226:227], v[72:75]
    v_mfma_f32_16x16x16_bf16 v[76:79], v[244:245], v[228:229], v[76:79]
    v_mfma_f32_16x16x16_bf16 v[80:83], v[246:247], v[222:223], v[80:83]
    v_cvt_pk_bf16_f32 v112, v48, v49
    v_cvt_pk_bf16_f32 v113, v50, v51
    v_mfma_f32_16x16x16_bf16 v[84:87], v[246:247], v[224:225], v[84:87]
    v_cvt_pk_bf16_f32 v114, v52, v53
    v_cvt_pk_bf16_f32 v115, v54, v55
    v_mfma_f32_16x16x16_bf16 v[88:91], v[246:247], v[226:227], v[88:91]
    v_cvt_pk_bf16_f32 v116, v64, v65
    v_cvt_pk_bf16_f32 v117, v66, v67
    v_mfma_f32_16x16x16_bf16 v[92:95], v[246:247], v[228:229], v[92:95]
    v_cvt_pk_bf16_f32 v118, v68, v69
    v_cvt_pk_bf16_f32 v119, v70, v71
    v_mfma_f32_16x16x16_bf16 v[96:99], v[248:249], v[222:223], v[96:99]
    v_cvt_pk_bf16_f32 v120, v56, v57
    v_cvt_pk_bf16_f32 v121, v58, v59
    v_mfma_f32_16x16x16_bf16 v[100:103], v[248:249], v[224:225], v[100:103]
    v_cvt_pk_bf16_f32 v122, v60, v61
    v_cvt_pk_bf16_f32 v123, v62, v63
    v_mfma_f32_16x16x16_bf16 v[104:107], v[248:249], v[226:227], v[104:107]
    v_permlane16_swap_b32 v112, v114
    v_permlane16_swap_b32 v113, v115
    v_mfma_f32_16x16x16_bf16 v[108:111], v[248:249], v[228:229], v[108:111]
    v_permlane16_swap_b32 v116, v118
    v_permlane16_swap_b32 v117, v119
    v_cvt_pk_bf16_f32 v124, v72, v73
    v_cvt_pk_bf16_f32 v125, v74, v75
    v_cvt_pk_bf16_f32 v126, v76, v77
    v_cvt_pk_bf16_f32 v127, v78, v79
    v_permlane16_swap_b32 v120, v122
    v_permlane16_swap_b32 v121, v123
    v_permlane16_swap_b32 v124, v126
    v_permlane16_swap_b32 v125, v127
    v_mfma_f32_32x32x16_bf16 v[48:63], v[204:207], v[112:115], 0
    v_mul_f32 v80, v80, v230
    v_mul_f32 v81, v81, v230
    v_mul_f32 v82, v82, v230
    v_mul_f32 v83, v83, v230
    v_cvt_pk_bf16_f32 v80, v80, v81
    v_cvt_pk_bf16_f32 v81, v82, v83
    v_mfma_f32_32x32x16_bf16 v[64:79], v[204:207], v[120:123], 0
    v_mul_f32 v96, v96, v230
    v_mul_f32 v97, v97, v230
    v_mul_f32 v98, v98, v230
    v_mul_f32 v99, v99, v230
    v_cvt_pk_bf16_f32 v96, v96, v97
    v_cvt_pk_bf16_f32 v97, v98, v99
    v_mfma_f32_32x32x16_bf16 v[48:63], v[208:211], v[116:119], v[48:63]
    v_mul_f32 v84, v84, v232
    v_mul_f32 v85, v85, v232
    v_mul_f32 v86, v86, v232
    v_mul_f32 v87, v87, v232
    v_cvt_pk_bf16_f32 v84, v84, v85
    v_cvt_pk_bf16_f32 v85, v86, v87
    v_mfma_f32_32x32x16_bf16 v[64:79], v[208:211], v[124:127], v[64:79]
    v_mul_f32 v100, v100, v232
    v_mul_f32 v101, v101, v232
    v_mul_f32 v102, v102, v232
    v_mul_f32 v103, v103, v232
    v_cvt_pk_bf16_f32 v100, v100, v101
    v_cvt_pk_bf16_f32 v101, v102, v103
    v_mul_f32 v88, v88, v234
    v_mul_f32 v89, v89, v234
    v_mul_f32 v90, v90, v234
    v_mul_f32 v91, v91, v234
    v_cvt_pk_bf16_f32 v88, v88, v89
    v_cvt_pk_bf16_f32 v89, v90, v91
    v_mul_f32 v104, v104, v234
    v_mul_f32 v105, v105, v234
    v_mul_f32 v106, v106, v234
    v_mul_f32 v107, v107, v234
    v_cvt_pk_bf16_f32 v104, v104, v105
    v_cvt_pk_bf16_f32 v105, v106, v107
    v_mul_f32 v92, v92, v236
    v_mul_f32 v93, v93, v236
    v_mul_f32 v94, v94, v236
    v_mul_f32 v95, v95, v236
    v_cvt_pk_bf16_f32 v92, v92, v93
    v_cvt_pk_bf16_f32 v93, v94, v95
    v_mul_f32 v108, v108, v236
    v_mul_f32 v109, v109, v236
    v_mul_f32 v110, v110, v236
    v_mul_f32 v111, v111, v236
    v_cvt_pk_bf16_f32 v108, v108, v109
    v_cvt_pk_bf16_f32 v109, v110, v111
    v_max3_f32 v160, v48, v49, v50
    v_min3_f32 v162, v48, v49, v50
    v_max3_f32 v160, v160, v51, v52
    v_min3_f32 v162, v162, v51, v52
    v_max3_f32 v160, v160, v53, v54
    v_min3_f32 v162, v162, v53, v54
    v_max3_f32 v160, v160, v55, v56
    v_min3_f32 v162, v162, v55, v56
    v_max3_f32 v160, v160, v57, v58
    v_min3_f32 v162, v162, v57, v58
    v_max3_f32 v160, v160, v59, v60
    v_min3_f32 v162, v162, v59, v60
    v_max3_f32 v160, v160, v61, v62
    v_min3_f32 v162, v162, v61, v62
    v_max_f32 v160, v160, v63
    v_min_f32 v162, v162, v63
    v_max3_f32 v164, v64, v65, v66
    v_min3_f32 v166, v64, v65, v66
    v_max3_f32 v164, v164, v67, v68
    v_min3_f32 v166, v166, v67, v68
    v_max3_f32 v164, v164, v69, v70
    v_min3_f32 v166, v166, v69, v70
    v_max3_f32 v164, v164, v71, v72
    v_min3_f32 v166, v166, v71, v72
    v_max3_f32 v164, v164, v73, v74
    v_min3_f32 v166, v166, v73, v74
    v_max3_f32 v164, v164, v75, v76
    v_min3_f32 v166, v166, v75, v76
    v_max3_f32 v164, v164, v77, v78
    v_min3_f32 v166, v166, v77, v78
    v_max_f32 v164, v164, v79
    v_min_f32 v166, v166, v79
    v_mov_b32 v161, v160
    v_mov_b32 v163, v162
    v_mov_b32 v165, v164
    v_mov_b32 v167, v166
    v_permlane32_swap_b32 v160, v161
    v_permlane32_swap_b32 v162, v163
    v_permlane32_swap_b32 v164, v165
    v_permlane32_swap_b32 v166, v167
    v_max_f32 v160, v160, v161
    v_min_f32 v162, v162, v163
    v_max_f32 v164, v164, v165
    v_min_f32 v166, v166, v167
    v_mul_f32 v160, v160, v251
    v_mul_f32 v162, v162, v251
    v_mul_f32 v164, v164, v253
    v_mul_f32 v166, v166, v253
    v_pk_fma_f32 v[128:129], v[48:49], v[250:251], v[160:161] op_sel:[0,1,0] op_sel_hi:[1,1,0] neg_lo:[0,0,1] neg_hi:[0,0,1]
    v_pk_fma_f32 v[48:49], v[48:49], v[250:251], v[162:163] op_sel:[0,1,0] op_sel_hi:[1,1,0] neg_lo:[0,1,0] neg_hi:[0,1,0]
    v_pk_fma_f32 v[130:131], v[50:51], v[250:251], v[160:161] op_sel:[0,1,0] op_sel_hi:[1,1,0] neg_lo:[0,0,1] neg_hi:[0,0,1]
    v_pk_fma_f32 v[50:51], v[50:51], v[250:251], v[162:163] op_sel:[0,1,0] op_sel_hi:[1,1,0] neg_lo:[0,1,0] neg_hi:[0,1,0]
    v_pk_fma_f32 v[132:133], v[52:53], v[250:251], v[160:161] op_sel:[0,1,0] op_sel_hi:[1,1,0] neg_lo:[0,0,1] neg_hi:[0,0,1]
    v_pk_fma_f32 v[52:53], v[52:53], v[250:251], v[162:163] op_sel:[0,1,0] op_sel_hi:[1,1,0] neg_lo:[0,1,0] neg_hi:[0,1,0]
    v_pk_fma_f32 v[134:135], v[54:55], v[250:251], v[160:161] op_sel:[0,1,0] op_sel_hi:[1,1,0] neg_lo:[0,0,1] neg_hi:[0,0,1]
    v_pk_fma_f32 v[54:55], v[54:55], v[250:251], v[162:163] op_sel:[0,1,0] op_sel_hi:[1,1,0] neg_lo:[0,1,0] neg_hi:[0,1,0]
    v_pk_fma_f32 v[136:137], v[56:57], v[250:251], v[160:161] op_sel:[0,1,0] op_sel_hi:[1,1,0] neg_lo:[0,0,1] neg_hi:[0,0,1]
    v_pk_fma_f32 v[56:57], v[56:57], v[250:251], v[162:163] op_sel:[0,1,0] op_sel_hi:[1,1,0] neg_lo:[0,1,0] neg_hi:[0,1,0]
    v_pk_fma_f32 v[138:139], v[58:59], v[250:251], v[160:161] op_sel:[0,1,0] op_sel_hi:[1,1,0] neg_lo:[0,0,1] neg_hi:[0,0,1]
    v_pk_fma_f32 v[58:59], v[58:59], v[250:251], v[162:163] op_sel:[0,1,0] op_sel_hi:[1,1,0] neg_lo:[0,1,0] neg_hi:[0,1,0]
    v_pk_fma_f32 v[140:141], v[60:61], v[250:251], v[160:161] op_sel:[0,1,0] op_sel_hi:[1,1,0] neg_lo:[0,0,1] neg_hi:[0,0,1]
    v_pk_fma_f32 v[60:61], v[60:61], v[250:251], v[162:163] op_sel:[0,1,0] op_sel_hi:[1,1,0] neg_lo:[0,1,0] neg_hi:[0,1,0]
    v_pk_fma_f32 v[142:143], v[62:63], v[250:251], v[160:161] op_sel:[0,1,0] op_sel_hi:[1,1,0] neg_lo:[0,0,1] neg_hi:[0,0,1]
    v_pk_fma_f32 v[62:63], v[62:63], v[250:251], v[162:163] op_sel:[0,1,0] op_sel_hi:[1,1,0] neg_lo:[0,1,0] neg_hi:[0,1,0]
    v_pk_fma_f32 v[144:145], v[64:65], v[252:253], v[164:165] op_sel:[0,1,0] op_sel_hi:[1,1,0] neg_lo:[0,0,1] neg_hi:[0,0,1]
    v_pk_fma_f32 v[64:65], v[64:65], v[252:253], v[166:167] op_sel:[0,1,0] op_sel_hi:[1,1,0] neg_lo:[0,1,0] neg_hi:[0,1,0]
    v_pk_fma_f32 v[146:147], v[66:67], v[252:253], v[164:165] op_sel:[0,1,0] op_sel_hi:[1,1,0] neg_lo:[0,0,1] neg_hi:[0,0,1]
    v_pk_fma_f32 v[66:67], v[66:67], v[252:253], v[166:167] op_sel:[0,1,0] op_sel_hi:[1,1,0] neg_lo:[0,1,0] neg_hi:[0,1,0]
    v_pk_fma_f32 v[148:149], v[68:69], v[252:253], v[164:165] op_sel:[0,1,0] op_sel_hi:[1,1,0] neg_lo:[0,0,1] neg_hi:[0,0,1]
    v_pk_fma_f32 v[68:69], v[68:69], v[252:253], v[166:167] op_sel:[0,1,0] op_sel_hi:[1,1,0] neg_lo:[0,1,0] neg_hi:[0,1,0]
    v_pk_fma_f32 v[150:151], v[70:71], v[252:253], v[164:165] op_sel:[0,1,0] op_sel_hi:[1,1,0] neg_lo:[0,0,1] neg_hi:[0,0,1]
    v_pk_fma_f32 v[70:71], v[70:71], v[252:253], v[166:167] op_sel:[0,1,0] op_sel_hi:[1,1,0] neg_lo:[0,1,0] neg_hi:[0,1,0]
    v_pk_fma_f32 v[152:153], v[72:73], v[252:253], v[164:165] op_sel:[0,1,0] op_sel_hi:[1,1,0] neg_lo:[0,0,1] neg_hi:[0,0,1]
    v_pk_fma_f32 v[72:73], v[72:73], v[252:253], v[166:167] op_sel:[0,1,0] op_sel_hi:[1,1,0] neg_lo:[0,1,0] neg_hi:[0,1,0]
    v_pk_fma_f32 v[154:155], v[74:75], v[252:253], v[164:165] op_sel:[0,1,0] op_sel_hi:[1,1,0] neg_lo:[0,0,1] neg_hi:[0,0,1]
    v_pk_fma_f32 v[74:75], v[74:75], v[252:253], v[166:167] op_sel:[0,1,0] op_sel_hi:[1,1,0] neg_lo:[0,1,0] neg_hi:[0,1,0]
    v_pk_fma_f32 v[156:157], v[76:77], v[252:253], v[164:165] op_sel:[0,1,0] op_sel_hi:[1,1,0] neg_lo:[0,0,1] neg_hi:[0,0,1]
    v_pk_fma_f32 v[76:77], v[76:77], v[252:253], v[166:167] op_sel:[0,1,0] op_sel_hi:[1,1,0] neg_lo:[0,1,0] neg_hi:[0,1,0]
    v_pk_fma_f32 v[158:159], v[78:79], v[252:253], v[164:165] op_sel:[0,1,0] op_sel_hi:[1,1,0] neg_lo:[0,0,1] neg_hi:[0,0,1]
    v_pk_fma_f32 v[78:79], v[78:79], v[252:253], v[166:167] op_sel:[0,1,0] op_sel_hi:[1,1,0] neg_lo:[0,1,0] neg_hi:[0,1,0]
    v_exp_f32_e64 v128, v128
    v_mfma_f32_16x16x16_bf16 v[16:19], v[238:239], v[222:223], v[16:19]
    v_exp_f32 v144, v144
    v_exp_f32 v129, v129
    v_exp_f32_e64 v145, v145
    v_mfma_f32_16x16x16_bf16 v[20:23], v[238:239], v[224:225], v[20:23]
    ds_write2st64_b64 v216, v[80:81], v[84:85] offset0:64 offset1:68
    v_exp_f32 v130, v130
    v_exp_f32 v146, v146
    v_exp_f32_e64 v131, v131
    v_mfma_f32_16x16x16_bf16 v[24:27], v[238:239], v[226:227], v[24:27]
    v_exp_f32 v147, v147
    v_exp_f32 v132, v132
    v_exp_f32_e64 v148, v148
    v_mfma_f32_16x16x16_bf16 v[28:31], v[238:239], v[228:229], v[28:31]
    ds_write2st64_b64 v4, v[96:97], v[100:101] offset0:64 offset1:68
    v_exp_f32 v133, v133
    v_exp_f32 v149, v149
    v_exp_f32_e64 v134, v134
    v_mfma_f32_16x16x16_bf16 v[32:35], v[240:241], v[222:223], v[32:35]
    v_exp_f32 v150, v150
    v_exp_f32 v135, v135
    v_exp_f32_e64 v151, v151
    v_mfma_f32_16x16x16_bf16 v[36:39], v[240:241], v[224:225], v[36:39]
    ds_write2st64_b64 v216, v[88:89], v[92:93] offset0:72 offset1:76
    v_exp_f32 v136, v136
    v_exp_f32 v152, v152
    v_exp_f32_e64 v137, v137
    v_mfma_f32_16x16x16_bf16 v[40:43], v[240:241], v[226:227], v[40:43]
    v_exp_f32 v153, v153
    v_exp_f32 v138, v138
    v_exp_f32_e64 v154, v154
    v_mfma_f32_16x16x16_bf16 v[44:47], v[240:241], v[228:229], v[44:47]
    ds_write2st64_b64 v4, v[104:105], v[108:109] offset0:72 offset1:76
    v_exp_f32 v139, v139
    v_exp_f32 v155, v155
    v_exp_f32 v140, v140
    v_exp_f32 v156, v156
    v_exp_f32 v141, v141
    v_exp_f32 v157, v157
    v_exp_f32 v142, v142
    v_exp_f32 v158, v158
    v_exp_f32 v143, v143
    v_exp_f32 v159, v159
    v_pk_add_f32 v[176:177], v[128:129], v[130:131]
    v_pk_add_f32 v[178:179], v[144:145], v[146:147]
    v_pk_add_f32 v[176:177], v[176:177], v[132:133]
    v_pk_add_f32 v[178:179], v[178:179], v[148:149]
    v_pk_add_f32 v[176:177], v[176:177], v[134:135]
    v_pk_add_f32 v[178:179], v[178:179], v[150:151]
    v_pk_add_f32 v[176:177], v[176:177], v[136:137]
    v_pk_add_f32 v[178:179], v[178:179], v[152:153]
    v_pk_add_f32 v[176:177], v[176:177], v[138:139]
    v_pk_add_f32 v[178:179], v[178:179], v[154:155]
    v_pk_add_f32 v[176:177], v[176:177], v[140:141]
    v_pk_add_f32 v[178:179], v[178:179], v[156:157]
    v_pk_add_f32 v[176:177], v[176:177], v[142:143]
    v_pk_add_f32 v[178:179], v[178:179], v[158:159]
    v_exp_f32 v48, v48
    v_add_f32 v176, v176, v177
    v_add_f32 v178, v178, v179
    v_exp_f32 v64, v64
    v_mov_b32 v177, v176
    v_mov_b32 v179, v178
    v_exp_f32 v49, v49
    v_permlane32_swap_b32 v176, v177
    v_permlane32_swap_b32 v178, v179
    v_exp_f32 v65, v65
    v_add_f32 v176, v176, v177
    v_add_f32 v178, v178, v179
    v_exp_f32 v50, v50
    v_rcp_f32 v176, v176
    v_rcp_f32 v178, v178
    v_exp_f32 v66, v66
    v_exp_f32 v51, v51
    v_exp_f32 v67, v67
    v_exp_f32 v52, v52
    v_exp_f32 v68, v68
    v_exp_f32 v53, v53
    v_exp_f32 v69, v69
    v_exp_f32 v54, v54
    v_exp_f32 v70, v70
    v_exp_f32 v55, v55
    v_exp_f32 v71, v71
    v_exp_f32 v56, v56
    v_exp_f32 v72, v72
    v_exp_f32 v57, v57
    v_exp_f32 v73, v73
    v_exp_f32 v58, v58
    v_exp_f32 v74, v74
    v_exp_f32 v59, v59
    v_exp_f32 v75, v75
    v_exp_f32 v60, v60
    v_exp_f32 v76, v76
    v_exp_f32 v61, v61
    v_exp_f32 v77, v77
    v_exp_f32 v62, v62
    v_exp_f32 v78, v78
    v_exp_f32 v63, v63
    v_exp_f32 v79, v79
    v_pk_add_f32 v[180:181], v[48:49], v[50:51]
    v_pk_add_f32 v[182:183], v[64:65], v[66:67]
    v_pk_add_f32 v[180:181], v[180:181], v[52:53]
    v_pk_add_f32 v[182:183], v[182:183], v[68:69]
    v_pk_add_f32 v[180:181], v[180:181], v[54:55]
    v_pk_add_f32 v[182:183], v[182:183], v[70:71]
    v_pk_add_f32 v[180:181], v[180:181], v[56:57]
    v_pk_add_f32 v[182:183], v[182:183], v[72:73]
    v_pk_add_f32 v[180:181], v[180:181], v[58:59]
    v_pk_add_f32 v[182:183], v[182:183], v[74:75]
    v_pk_add_f32 v[180:181], v[180:181], v[60:61]
    v_pk_add_f32 v[182:183], v[182:183], v[76:77]
    v_pk_add_f32 v[180:181], v[180:181], v[62:63]
    v_pk_add_f32 v[182:183], v[182:183], v[78:79]
    v_add_f32 v180, v180, v181
    v_add_f32 v182, v182, v183
    v_mov_b32 v181, v180
    v_mov_b32 v183, v182
    v_pk_mul_f32 v[128:129], v[128:129], v[176:177] op_sel_hi:[1,0]
    v_pk_mul_f32 v[130:131], v[130:131], v[176:177] op_sel_hi:[1,0]
    v_cvt_pk_bf16_f32 v128, v128, v129
    v_permlane32_swap_b32 v180, v181
    v_permlane32_swap_b32 v182, v183
    v_cvt_pk_bf16_f32 v129, v130, v131
    v_pk_mul_f32 v[144:145], v[144:145], v[178:179] op_sel_hi:[1,0]
    v_pk_mul_f32 v[146:147], v[146:147], v[178:179] op_sel_hi:[1,0]
    v_cvt_pk_bf16_f32 v144, v144, v145
    v_cvt_pk_bf16_f32 v145, v146, v147
    v_add_f32 v180, v180, v181
    v_add_f32 v182, v182, v183
    ds_write2st64_b64 v168, v[128:129], v[144:145] offset0:0 offset1:8
    v_pk_mul_f32 v[132:133], v[132:133], v[176:177] op_sel_hi:[1,0]
    v_pk_mul_f32 v[134:135], v[134:135], v[176:177] op_sel_hi:[1,0]
    v_cvt_pk_bf16_f32 v132, v132, v133
    v_cvt_pk_bf16_f32 v133, v134, v135
    v_pk_mul_f32 v[148:149], v[148:149], v[178:179] op_sel_hi:[1,0]
    v_rcp_f32 v180, v180
    v_rcp_f32 v182, v182
    v_pk_mul_f32 v[150:151], v[150:151], v[178:179] op_sel_hi:[1,0]
    v_cvt_pk_bf16_f32 v148, v148, v149
    v_cvt_pk_bf16_f32 v149, v150, v151
    ds_write2st64_b64 v169, v[132:133], v[148:149] offset0:0 offset1:8
    v_pk_mul_f32 v[136:137], v[136:137], v[176:177] op_sel_hi:[1,0]
    v_pk_mul_f32 v[138:139], v[138:139], v[176:177] op_sel_hi:[1,0]
    v_cvt_pk_bf16_f32 v136, v136, v137
    v_cvt_pk_bf16_f32 v137, v138, v139
    v_pk_mul_f32 v[152:153], v[152:153], v[178:179] op_sel_hi:[1,0]
    v_pk_mul_f32 v[154:155], v[154:155], v[178:179] op_sel_hi:[1,0]
    v_cvt_pk_bf16_f32 v152, v152, v153
    v_cvt_pk_bf16_f32 v153, v154, v155
    ds_write2st64_b64 v170, v[136:137], v[152:153] offset0:0 offset1:8
    v_pk_mul_f32 v[140:141], v[140:141], v[176:177] op_sel_hi:[1,0]
    v_pk_mul_f32 v[142:143], v[142:143], v[176:177] op_sel_hi:[1,0]
    v_cvt_pk_bf16_f32 v140, v140, v141
    v_cvt_pk_bf16_f32 v141, v142, v143
    v_pk_mul_f32 v[156:157], v[156:157], v[178:179] op_sel_hi:[1,0]
    v_pk_mul_f32 v[158:159], v[158:159], v[178:179] op_sel_hi:[1,0]
    v_cvt_pk_bf16_f32 v156, v156, v157
    v_cvt_pk_bf16_f32 v157, v158, v159
    ds_write2st64_b64 v171, v[140:141], v[156:157] offset0:0 offset1:8
    v_pk_mul_f32 v[48:49], v[48:49], v[180:181] op_sel_hi:[1,0]
    v_pk_mul_f32 v[50:51], v[50:51], v[180:181] op_sel_hi:[1,0]
    v_cvt_pk_bf16_f32 v48, v48, v49
    v_cvt_pk_bf16_f32 v49, v50, v51
    v_pk_mul_f32 v[64:65], v[64:65], v[182:183] op_sel_hi:[1,0]
    v_pk_mul_f32 v[66:67], v[66:67], v[182:183] op_sel_hi:[1,0]
    v_cvt_pk_bf16_f32 v64, v64, v65
    v_cvt_pk_bf16_f32 v65, v66, v67
    ds_write2st64_b64 v172, v[48:49], v[64:65] offset0:0 offset1:8
    v_pk_mul_f32 v[52:53], v[52:53], v[180:181] op_sel_hi:[1,0]
    v_pk_mul_f32 v[54:55], v[54:55], v[180:181] op_sel_hi:[1,0]
    v_cvt_pk_bf16_f32 v52, v52, v53
    v_cvt_pk_bf16_f32 v53, v54, v55
    v_pk_mul_f32 v[68:69], v[68:69], v[182:183] op_sel_hi:[1,0]
    v_pk_mul_f32 v[70:71], v[70:71], v[182:183] op_sel_hi:[1,0]
    v_cvt_pk_bf16_f32 v68, v68, v69
    v_cvt_pk_bf16_f32 v69, v70, v71
    ds_write2st64_b64 v173, v[52:53], v[68:69] offset0:0 offset1:8
    v_pk_mul_f32 v[56:57], v[56:57], v[180:181] op_sel_hi:[1,0]
    v_pk_mul_f32 v[58:59], v[58:59], v[180:181] op_sel_hi:[1,0]
    v_cvt_pk_bf16_f32 v56, v56, v57
    v_cvt_pk_bf16_f32 v57, v58, v59
    v_pk_mul_f32 v[72:73], v[72:73], v[182:183] op_sel_hi:[1,0]
    v_pk_mul_f32 v[74:75], v[74:75], v[182:183] op_sel_hi:[1,0]
    v_cvt_pk_bf16_f32 v72, v72, v73
    v_cvt_pk_bf16_f32 v73, v74, v75
    ds_write2st64_b64 v174, v[56:57], v[72:73] offset0:0 offset1:8
    v_pk_mul_f32 v[60:61], v[60:61], v[180:181] op_sel_hi:[1,0]
    v_pk_mul_f32 v[62:63], v[62:63], v[180:181] op_sel_hi:[1,0]
    v_cvt_pk_bf16_f32 v60, v60, v61
    v_cvt_pk_bf16_f32 v61, v62, v63
    v_pk_mul_f32 v[76:77], v[76:77], v[182:183] op_sel_hi:[1,0]
    v_pk_mul_f32 v[78:79], v[78:79], v[182:183] op_sel_hi:[1,0]
    v_cvt_pk_bf16_f32 v76, v76, v77
    v_cvt_pk_bf16_f32 v77, v78, v79
    ds_write2st64_b64 v175, v[60:61], v[76:77] offset0:0 offset1:8
    ds_read_b64_tr_b16 v[112:113], v218 offset:0
    ds_read_b64_tr_b16 v[114:115], v219 offset:0
    ds_read_b64_tr_b16 v[144:145], v220 offset:32768
    ds_read_b64_tr_b16 v[146:147], v221 offset:32768
    ds_read_b64_tr_b16 v[116:117], v218 offset:2048
    ds_read_b64_tr_b16 v[118:119], v219 offset:2048
    ds_read_b64_tr_b16 v[148:149], v220 offset:34816
    ds_read_b64_tr_b16 v[150:151], v221 offset:34816
    ds_read_b64_tr_b16 v[120:121], v218 offset:4096
    ds_read_b64_tr_b16 v[122:123], v219 offset:4096
    ds_read_b64_tr_b16 v[152:153], v220 offset:36864
    ds_read_b64_tr_b16 v[154:155], v221 offset:36864
    v_cvt_pk_bf16_f32 v176, v16, v17
    v_cvt_pk_bf16_f32 v177, v18, v19
    v_cvt_pk_bf16_f32 v178, v20, v21
    v_cvt_pk_bf16_f32 v179, v22, v23
    v_cvt_pk_bf16_f32 v180, v32, v33
    v_cvt_pk_bf16_f32 v181, v34, v35
    v_cvt_pk_bf16_f32 v182, v36, v37
    v_cvt_pk_bf16_f32 v183, v38, v39
    v_cvt_pk_bf16_f32 v184, v24, v25
    v_cvt_pk_bf16_f32 v185, v26, v27
    v_cvt_pk_bf16_f32 v186, v28, v29
    v_cvt_pk_bf16_f32 v187, v30, v31
    v_cvt_pk_bf16_f32 v188, v40, v41
    v_cvt_pk_bf16_f32 v189, v42, v43
    v_cvt_pk_bf16_f32 v190, v44, v45
    v_cvt_pk_bf16_f32 v191, v46, v47
    s_waitcnt lgkmcnt(8)
    v_mfma_f32_32x32x16_bf16 v[48:63], v[112:115], v[144:147], 0
    ds_read_b64_tr_b16 v[124:125], v218 offset:6144
    ds_read_b64_tr_b16 v[126:127], v219 offset:6144
    ds_read_b64_tr_b16 v[156:157], v220 offset:38912
    ds_read_b64_tr_b16 v[158:159], v221 offset:38912
    s_waitcnt lgkmcnt(8)
    v_mfma_f32_32x32x16_bf16 v[48:63], v[116:119], v[148:151], v[48:63]
    v_xor_b32 v218, 8192, v218
    v_xor_b32 v219, 8192, v219
    v_xor_b32 v220, 8192, v220
    v_xor_b32 v221, 8192, v221
    s_barrier
    ds_read_b64_tr_b16 v[128:129], v218 offset:0
    ds_read_b64_tr_b16 v[130:131], v219 offset:0
    ds_read_b64_tr_b16 v[160:161], v220 offset:32768
    ds_read_b64_tr_b16 v[162:163], v221 offset:32768
    s_waitcnt lgkmcnt(8)
    v_mfma_f32_32x32x16_bf16 v[48:63], v[120:123], v[152:155], v[48:63]
    ds_read_b64_tr_b16 v[132:133], v218 offset:2048
    ds_read_b64_tr_b16 v[134:135], v219 offset:2048
    ds_read_b64_tr_b16 v[164:165], v220 offset:34816
    ds_read_b64_tr_b16 v[166:167], v221 offset:34816
    s_waitcnt lgkmcnt(8)
    v_mfma_f32_32x32x16_bf16 v[48:63], v[124:127], v[156:159], v[48:63]
    ds_read_b64_tr_b16 v[136:137], v218 offset:4096
    ds_read_b64_tr_b16 v[138:139], v219 offset:4096
    ds_read_b64_tr_b16 v[168:169], v220 offset:36864
    ds_read_b64_tr_b16 v[170:171], v221 offset:36864
    s_waitcnt lgkmcnt(8)
    v_mfma_f32_32x32x16_bf16 v[48:63], v[128:131], v[160:163], v[48:63]
    ds_read_b64_tr_b16 v[140:141], v218 offset:6144
    ds_read_b64_tr_b16 v[142:143], v219 offset:6144
    ds_read_b64_tr_b16 v[172:173], v220 offset:38912
    ds_read_b64_tr_b16 v[174:175], v221 offset:38912
    s_waitcnt lgkmcnt(8)
    v_mfma_f32_32x32x16_bf16 v[48:63], v[132:135], v[164:167], v[48:63]
    v_permlane16_swap_b32 v176, v178
    v_permlane16_swap_b32 v177, v179
    s_waitcnt lgkmcnt(4)
    v_mfma_f32_32x32x16_bf16 v[48:63], v[136:139], v[168:171], v[48:63]
    v_permlane16_swap_b32 v180, v182
    v_permlane16_swap_b32 v181, v183
    v_permlane16_swap_b32 v184, v186
    s_waitcnt lgkmcnt(0)
    v_mfma_f32_32x32x16_bf16 v[48:63], v[140:143], v[172:175], v[48:63]
    s_barrier
    v_permlane16_swap_b32 v185, v187
    v_permlane16_swap_b32 v188, v190
    v_permlane16_swap_b32 v189, v191
    s_lshl_b32 s76, s62, 11
    s_add_u32 s76, s76, s99
    v_mfma_f32_32x32x16_bf16 v[16:31], v[204:207], v[176:179], 0
    s_add_u32 s76, s76, 1024
    s_lshl_b32 s77, s62, 7
    s_add_u32 s77, s77, s73
    v_lshlrev_b32_e64 v4, 2, v2
    v_mfma_f32_32x32x16_bf16 v[32:47], v[204:207], v[184:187], 0
    v_cvt_pk_bf16_f32 v64, v48, v49
    v_cvt_pk_bf16_f32 v65, v50, v51
    v_cvt_pk_bf16_f32 v66, v52, v53
    v_cvt_pk_bf16_f32 v67, v54, v55
    v_cvt_pk_bf16_f32 v68, v56, v57
    v_mfma_f32_32x32x16_bf16 v[16:31], v[208:211], v[180:183], v[16:31]
    v_cvt_pk_bf16_f32 v69, v58, v59
    v_cvt_pk_bf16_f32 v70, v60, v61
    v_cvt_pk_bf16_f32 v71, v62, v63
    s_bitcmp1_b32 s100, 0
    s_cbranch_scc1 L_loc_59
    buffer_store_dwordx4 v[64:67], v12, s[40:43], s76 offen offset:0 sc1
    buffer_store_dwordx4 v[68:71], v12, s[40:43], s76 offen offset:1024 sc1
    s_branch L_pubd_60
L_loc_59:
    buffer_store_dwordx4 v[64:67], v12, s[40:43], s76 offen offset:0
    buffer_store_dwordx4 v[68:71], v12, s[40:43], s76 offen offset:1024
L_pubd_60:
    v_mfma_f32_32x32x16_bf16 v[32:47], v[208:211], v[188:191], v[32:47]
    v_and_b32 v216, 1, v1
    v_lshlrev_b32_e64 v216, 8, v216
    v_lshl_add_u32 v216, v3, 4, v216
    s_lshl_b32 s76, s64, 7
    v_add_u32 v216, s76, v216
    s_mul_i32 s78, s61, 28800
    s_lshl_b32 s79, s64, 8
    s_add_u32 s78, s78, s79
    s_add_u32 s79, s78, 3686400
    v_dot2_f32_bf16 v72, v112, s89, 0
    v_dot2_f32_bf16 v73, v113, s89, 0
    v_dot2_f32_bf16 v72, v114, s89, v72
    v_dot2_f32_bf16 v73, v115, s89, v73
    v_dot2_f32_bf16 v72, v116, s89, v72
    v_dot2_f32_bf16 v73, v117, s89, v73
    v_dot2_f32_bf16 v72, v118, s89, v72
    v_dot2_f32_bf16 v73, v119, s89, v73
    v_dot2_f32_bf16 v72, v120, s89, v72
    v_dot2_f32_bf16 v73, v121, s89, v73
    v_dot2_f32_bf16 v72, v122, s89, v72
    v_dot2_f32_bf16 v73, v123, s89, v73
    v_dot2_f32_bf16 v72, v124, s89, v72
    v_dot2_f32_bf16 v73, v125, s89, v73
    v_dot2_f32_bf16 v72, v126, s89, v72
    v_dot2_f32_bf16 v73, v127, s89, v73
    v_dot2_f32_bf16 v72, v128, s89, v72
    v_dot2_f32_bf16 v73, v129, s89, v73
    v_dot2_f32_bf16 v72, v130, s89, v72
    v_dot2_f32_bf16 v73, v131, s89, v73
    v_dot2_f32_bf16 v72, v132, s89, v72
    v_dot2_f32_bf16 v73, v133, s89, v73
    v_dot2_f32_bf16 v72, v134, s89, v72
    v_dot2_f32_bf16 v73, v135, s89, v73
    v_dot2_f32_bf16 v72, v136, s89, v72
    v_dot2_f32_bf16 v73, v137, s89, v73
    v_dot2_f32_bf16 v72, v138, s89, v72
    v_dot2_f32_bf16 v73, v139, s89, v73
    v_dot2_f32_bf16 v72, v140, s89, v72
    v_dot2_f32_bf16 v73, v141, s89, v73
    v_dot2_f32_bf16 v72, v142, s89, v72
    v_dot2_f32_bf16 v73, v143, s89, v73
    s_lshl_b32 s76, s98, 7
    v_lshl_add_u32 v10, v3, 3, s76
    v_lshlrev_b32 v11, 5, v1
    v_add_f32 v72, v72, v73
    v_mov_b32 v73, v72
    s_nop 1
    v_permlane32_swap_b32 v72, v73
    v_add_f32 v72, v72, v73
    s_mov_b32 exec_hi, 0
    s_bitcmp1_b32 s100, 0
    s_cbranch_scc1 L_loc_61
    buffer_store_dword v72, v4, s[40:43], s77 offen offset:2048 sc1
    s_branch L_pubd_62
L_loc_61:
    buffer_store_dword v72, v4, s[40:43], s77 offen offset:2048
L_pubd_62:
    s_mov_b64 exec, -1
    v_max3_f32 v160, v16, v17, v18
    v_min3_f32 v162, v16, v17, v18
    v_max3_f32 v160, v160, v19, v20
    v_min3_f32 v162, v162, v19, v20
    v_max3_f32 v160, v160, v21, v22
    v_min3_f32 v162, v162, v21, v22
    v_max3_f32 v160, v160, v23, v24
    v_min3_f32 v162, v162, v23, v24
    v_max3_f32 v160, v160, v25, v26
    v_min3_f32 v162, v162, v25, v26
    v_max3_f32 v160, v160, v27, v28
    v_min3_f32 v162, v162, v27, v28
    v_max3_f32 v160, v160, v29, v30
    v_min3_f32 v162, v162, v29, v30
    v_max_f32 v160, v160, v31
    v_min_f32 v162, v162, v31
    v_max3_f32 v164, v32, v33, v34
    v_min3_f32 v166, v32, v33, v34
    v_max3_f32 v164, v164, v35, v36
    v_min3_f32 v166, v166, v35, v36
    v_max3_f32 v164, v164, v37, v38
    v_min3_f32 v166, v166, v37, v38
    v_max3_f32 v164, v164, v39, v40
    v_min3_f32 v166, v166, v39, v40
    v_max3_f32 v164, v164, v41, v42
    v_min3_f32 v166, v166, v41, v42
    v_max3_f32 v164, v164, v43, v44
    v_min3_f32 v166, v166, v43, v44
    v_max3_f32 v164, v164, v45, v46
    v_min3_f32 v166, v166, v45, v46
    v_max_f32 v164, v164, v47
    v_min_f32 v166, v166, v47
    v_mov_b32 v161, v160
    v_mov_b32 v163, v162
    v_mov_b32 v165, v164
    v_mov_b32 v167, v166
    v_permlane32_swap_b32 v160, v161
    v_permlane32_swap_b32 v162, v163
    v_permlane32_swap_b32 v164, v165
    v_permlane32_swap_b32 v166, v167
    v_max_f32 v160, v160, v161
    v_min_f32 v162, v162, v163
    v_max_f32 v164, v164, v165
    v_min_f32 v166, v166, v167
    v_mul_f32 v160, v160, v251
    v_mul_f32 v162, v162, v251
    v_mul_f32 v164, v164, v253
    v_mul_f32 v166, v166, v253
    v_pk_fma_f32 v[128:129], v[16:17], v[250:251], v[160:161] op_sel:[0,1,0] op_sel_hi:[1,1,0] neg_lo:[0,0,1] neg_hi:[0,0,1]
    v_pk_fma_f32 v[16:17], v[16:17], v[250:251], v[162:163] op_sel:[0,1,0] op_sel_hi:[1,1,0] neg_lo:[0,1,0] neg_hi:[0,1,0]
    v_pk_fma_f32 v[130:131], v[18:19], v[250:251], v[160:161] op_sel:[0,1,0] op_sel_hi:[1,1,0] neg_lo:[0,0,1] neg_hi:[0,0,1]
    v_pk_fma_f32 v[18:19], v[18:19], v[250:251], v[162:163] op_sel:[0,1,0] op_sel_hi:[1,1,0] neg_lo:[0,1,0] neg_hi:[0,1,0]
    v_pk_fma_f32 v[132:133], v[20:21], v[250:251], v[160:161] op_sel:[0,1,0] op_sel_hi:[1,1,0] neg_lo:[0,0,1] neg_hi:[0,0,1]
    v_pk_fma_f32 v[20:21], v[20:21], v[250:251], v[162:163] op_sel:[0,1,0] op_sel_hi:[1,1,0] neg_lo:[0,1,0] neg_hi:[0,1,0]
    v_pk_fma_f32 v[134:135], v[22:23], v[250:251], v[160:161] op_sel:[0,1,0] op_sel_hi:[1,1,0] neg_lo:[0,0,1] neg_hi:[0,0,1]
    v_pk_fma_f32 v[22:23], v[22:23], v[250:251], v[162:163] op_sel:[0,1,0] op_sel_hi:[1,1,0] neg_lo:[0,1,0] neg_hi:[0,1,0]
    v_pk_fma_f32 v[136:137], v[24:25], v[250:251], v[160:161] op_sel:[0,1,0] op_sel_hi:[1,1,0] neg_lo:[0,0,1] neg_hi:[0,0,1]
    v_pk_fma_f32 v[24:25], v[24:25], v[250:251], v[162:163] op_sel:[0,1,0] op_sel_hi:[1,1,0] neg_lo:[0,1,0] neg_hi:[0,1,0]
    v_pk_fma_f32 v[138:139], v[26:27], v[250:251], v[160:161] op_sel:[0,1,0] op_sel_hi:[1,1,0] neg_lo:[0,0,1] neg_hi:[0,0,1]
    v_pk_fma_f32 v[26:27], v[26:27], v[250:251], v[162:163] op_sel:[0,1,0] op_sel_hi:[1,1,0] neg_lo:[0,1,0] neg_hi:[0,1,0]
    v_pk_fma_f32 v[140:141], v[28:29], v[250:251], v[160:161] op_sel:[0,1,0] op_sel_hi:[1,1,0] neg_lo:[0,0,1] neg_hi:[0,0,1]
    v_pk_fma_f32 v[28:29], v[28:29], v[250:251], v[162:163] op_sel:[0,1,0] op_sel_hi:[1,1,0] neg_lo:[0,1,0] neg_hi:[0,1,0]
    v_pk_fma_f32 v[142:143], v[30:31], v[250:251], v[160:161] op_sel:[0,1,0] op_sel_hi:[1,1,0] neg_lo:[0,0,1] neg_hi:[0,0,1]
    v_pk_fma_f32 v[30:31], v[30:31], v[250:251], v[162:163] op_sel:[0,1,0] op_sel_hi:[1,1,0] neg_lo:[0,1,0] neg_hi:[0,1,0]
    v_pk_fma_f32 v[144:145], v[32:33], v[252:253], v[164:165] op_sel:[0,1,0] op_sel_hi:[1,1,0] neg_lo:[0,0,1] neg_hi:[0,0,1]
    v_pk_fma_f32 v[32:33], v[32:33], v[252:253], v[166:167] op_sel:[0,1,0] op_sel_hi:[1,1,0] neg_lo:[0,1,0] neg_hi:[0,1,0]
    v_pk_fma_f32 v[146:147], v[34:35], v[252:253], v[164:165] op_sel:[0,1,0] op_sel_hi:[1,1,0] neg_lo:[0,0,1] neg_hi:[0,0,1]
    v_pk_fma_f32 v[34:35], v[34:35], v[252:253], v[166:167] op_sel:[0,1,0] op_sel_hi:[1,1,0] neg_lo:[0,1,0] neg_hi:[0,1,0]
    v_pk_fma_f32 v[148:149], v[36:37], v[252:253], v[164:165] op_sel:[0,1,0] op_sel_hi:[1,1,0] neg_lo:[0,0,1] neg_hi:[0,0,1]
    v_pk_fma_f32 v[36:37], v[36:37], v[252:253], v[166:167] op_sel:[0,1,0] op_sel_hi:[1,1,0] neg_lo:[0,1,0] neg_hi:[0,1,0]
    v_pk_fma_f32 v[150:151], v[38:39], v[252:253], v[164:165] op_sel:[0,1,0] op_sel_hi:[1,1,0] neg_lo:[0,0,1] neg_hi:[0,0,1]
    v_pk_fma_f32 v[38:39], v[38:39], v[252:253], v[166:167] op_sel:[0,1,0] op_sel_hi:[1,1,0] neg_lo:[0,1,0] neg_hi:[0,1,0]
    v_pk_fma_f32 v[152:153], v[40:41], v[252:253], v[164:165] op_sel:[0,1,0] op_sel_hi:[1,1,0] neg_lo:[0,0,1] neg_hi:[0,0,1]
    v_pk_fma_f32 v[40:41], v[40:41], v[252:253], v[166:167] op_sel:[0,1,0] op_sel_hi:[1,1,0] neg_lo:[0,1,0] neg_hi:[0,1,0]
    v_pk_fma_f32 v[154:155], v[42:43], v[252:253], v[164:165] op_sel:[0,1,0] op_sel_hi:[1,1,0] neg_lo:[0,0,1] neg_hi:[0,0,1]
    v_pk_fma_f32 v[42:43], v[42:43], v[252:253], v[166:167] op_sel:[0,1,0] op_sel_hi:[1,1,0] neg_lo:[0,1,0] neg_hi:[0,1,0]
    v_pk_fma_f32 v[156:157], v[44:45], v[252:253], v[164:165] op_sel:[0,1,0] op_sel_hi:[1,1,0] neg_lo:[0,0,1] neg_hi:[0,0,1]
    v_pk_fma_f32 v[44:45], v[44:45], v[252:253], v[166:167] op_sel:[0,1,0] op_sel_hi:[1,1,0] neg_lo:[0,1,0] neg_hi:[0,1,0]
    v_pk_fma_f32 v[158:159], v[46:47], v[252:253], v[164:165] op_sel:[0,1,0] op_sel_hi:[1,1,0] neg_lo:[0,0,1] neg_hi:[0,0,1]
    v_pk_fma_f32 v[46:47], v[46:47], v[252:253], v[166:167] op_sel:[0,1,0] op_sel_hi:[1,1,0] neg_lo:[0,1,0] neg_hi:[0,1,0]
    v_exp_f32 v128, v128
    v_exp_f32 v16, v16
    v_exp_f32 v129, v129
    v_exp_f32 v17, v17
    v_exp_f32 v130, v130
    v_exp_f32 v18, v18
    v_exp_f32 v131, v131
    v_exp_f32 v19, v19
    v_exp_f32 v132, v132
    v_exp_f32 v20, v20
    v_exp_f32 v133, v133
    v_exp_f32 v21, v21
    v_exp_f32 v134, v134
    v_exp_f32 v22, v22
    v_exp_f32 v135, v135
    v_exp_f32 v23, v23
    v_exp_f32 v136, v136
    v_exp_f32 v24, v24
    v_exp_f32 v137, v137
    v_exp_f32 v25, v25
    v_exp_f32 v138, v138
    v_exp_f32 v26, v26
    v_exp_f32 v139, v139
    v_exp_f32 v27, v27
    v_exp_f32 v140, v140
    v_exp_f32 v28, v28
    v_exp_f32 v141, v141
    v_exp_f32 v29, v29
    v_exp_f32 v142, v142
    v_exp_f32 v30, v30
    v_exp_f32 v143, v143
    v_exp_f32 v31, v31
    v_cvt_pk_bf16_f32 v218, v128, v129
    v_cvt_pk_bf16_f32 v219, v130, v131
    v_cvt_pk_bf16_f32 v220, v132, v133
    v_cvt_pk_bf16_f32 v221, v134, v135
    v_cvt_pk_bf16_f32 v222, v136, v137
    v_cvt_pk_bf16_f32 v223, v138, v139
    v_cvt_pk_bf16_f32 v224, v140, v141
    v_cvt_pk_bf16_f32 v225, v142, v143
    v_cvt_pk_bf16_f32 v226, v16, v17
    v_cvt_pk_bf16_f32 v227, v18, v19
    v_cvt_pk_bf16_f32 v228, v20, v21
    v_cvt_pk_bf16_f32 v229, v22, v23
    v_cvt_pk_bf16_f32 v230, v24, v25
    v_cvt_pk_bf16_f32 v231, v26, v27
    v_cvt_pk_bf16_f32 v232, v28, v29
    v_cvt_pk_bf16_f32 v233, v30, v31
    v_exp_f32 v144, v144
    v_exp_f32 v32, v32
    v_exp_f32 v145, v145
    v_exp_f32 v33, v33
    v_exp_f32 v146, v146
    v_exp_f32 v34, v34
    v_exp_f32 v147, v147
    v_exp_f32 v35, v35
    v_exp_f32 v148, v148
    v_exp_f32 v36, v36
    v_exp_f32 v149, v149
    v_exp_f32 v37, v37
    v_exp_f32 v150, v150
    v_exp_f32 v38, v38
    v_exp_f32 v151, v151
    v_exp_f32_e64 v39, v39
    s_barrier
    buffer_load_dwordx4 v[48:51], v13, s[40:43], s78 offen offset:3072 sc1
    buffer_load_dwordx4 v[52:55], v13, s[40:43], s79 offen offset:3072 sc1
    buffer_load_dwordx4 v[56:59], v13, s[40:43], s78 offen offset:3200 sc1
    buffer_load_dwordx4 v[60:63], v13, s[40:43], s79 offen offset:3200 sc1
    ds_read_b128 v[168:171], v216 offset:24576
    ds_read_b128 v[172:175], v216 offset:24608
    ds_read_b128 v[176:179], v216 offset:24640
    ds_read_b128 v[180:183], v216 offset:24672
    v_exp_f32 v152, v152
    v_exp_f32 v40, v40
    v_exp_f32 v153, v153
    v_exp_f32 v41, v41
    v_exp_f32 v154, v154
    v_exp_f32 v42, v42
    v_exp_f32 v155, v155
    v_exp_f32 v43, v43
    v_exp_f32 v156, v156
    v_exp_f32_e64 v44, v44
    s_waitcnt lgkmcnt(0)
    v_mfma_f32_32x32x16_bf16 v[64:79], v[168:171], v[218:221], 0
    v_exp_f32 v157, v157
    v_exp_f32 v45, v45
    v_exp_f32_e64 v158, v158
    v_mfma_f32_32x32x16_bf16 v[80:95], v[176:179], v[226:229], 0
    v_exp_f32 v46, v46
    v_exp_f32 v159, v159
    v_exp_f32_e64 v47, v47
    v_mfma_f32_32x32x16_bf16 v[64:79], v[172:175], v[222:225], v[64:79]
    v_cvt_pk_bf16_f32 v234, v144, v145
    v_cvt_pk_bf16_f32 v235, v146, v147
    v_cvt_pk_bf16_f32 v236, v148, v149
    v_cvt_pk_bf16_f32 v237, v150, v151
    v_cvt_pk_bf16_f32 v238, v152, v153
    v_cvt_pk_bf16_f32 v239, v154, v155
    v_mfma_f32_32x32x16_bf16 v[80:95], v[180:183], v[230:233], v[80:95]
    v_cvt_pk_bf16_f32 v240, v156, v157
    v_cvt_pk_bf16_f32 v241, v158, v159
    v_cvt_pk_bf16_f32 v242, v32, v33
    v_cvt_pk_bf16_f32 v243, v34, v35
    v_cvt_pk_bf16_f32 v244, v36, v37
    v_cvt_pk_bf16_f32 v245, v38, v39
    v_cvt_pk_bf16_f32 v246, v40, v41
    v_cvt_pk_bf16_f32 v247, v42, v43
    v_cvt_pk_bf16_f32 v248, v44, v45
    v_cvt_pk_bf16_f32 v249, v46, v47
    v_mfma_f32_32x32x16_bf16 v[96:111], v[168:171], v[234:237], 0
    v_rcp_f32 v184, v65
    v_rcp_f32 v185, v81
    v_mul_f32 v6, v64, v184
    v_fmac_f32 v6, v80, v185
    v_add_f32 v6, 0x358637bd, v6
    v_mfma_f32_32x32x16_bf16 v[112:127], v[176:179], v[242:245], 0
    v_rcp_f32 v6, v6
    v_mov_b32 v8, 0
    v_mul_f32 v184, v184, v6
    v_mul_f32_e64 v185, v185, v6
    s_lshl4_add_u32 s76, s60, s61
    v_mfma_f32_32x32x16_bf16 v[96:111], v[172:175], v[238:241], v[96:111]
    s_mul_i32 s76, s76, 32768
    s_lshl2_add_u32 s77, s63, s64
    s_lshl_b32 s77, s77, 12
    s_add_u32 s76, s76, s77
    s_add_u32 s76, s76, 16777216
    v_mfma_f32_32x32x16_bf16 v[112:127], v[180:183], v[246:249], v[112:127]
    s_add_u32 s77, s76, 8192
    v_add_u32 v14, 128, v12
    v_cmp_gt_u32 vcc, 24, v1
    s_nop 0
    s_nop 0
    v_cndmask_b32_e64 v14, v14, v12, vcc
    s_mov_b32 s88, 0
    s_branch L_pfirst_64
L_poll_63:
    buffer_load_dwordx4 v[48:51], v13, s[40:43], s78 offen offset:3072 sc1
    buffer_load_dwordx4 v[52:55], v13, s[40:43], s79 offen offset:3072 sc1
    buffer_load_dwordx4 v[56:59], v13, s[40:43], s78 offen offset:3200 sc1
    buffer_load_dwordx4 v[60:63], v13, s[40:43], s79 offen offset:3200 sc1
L_pfirst_64:
    s_waitcnt vmcnt(0)
    v_max3_u32 v9, v48, v49, v50
    v_max3_u32 v9, v9, v51, v52
    v_max3_u32 v9, v9, v53, v54
    v_max3_u32 v9, v9, v55, v56
    v_max3_u32 v9, v9, v57, v58
    v_max3_u32 v9, v9, v59, v60
    v_max3_u32 v9, v9, v61, v62
    v_max_u32 v9, v9, v63
    v_cmp_eq_u32 vcc, -1, v9
    s_nop 0
    s_cbranch_vccz L_ok_65
    s_add_u32 s88, s88, 1
    s_cmp_lt_u32 s88, 65536
    s_cbranch_scc1 L_poll_63
L_ok_65:
    v_mfma_f32_32x32x16_bf16 v[16:31], v[48:51], v[218:221], 0
    s_barrier
    v_rcp_f32 v186, v97
    v_rcp_f32 v187, v113
    v_mul_f32_e64 v7, v96, v186
    v_mfma_f32_32x32x16_bf16 v[128:143], v[56:59], v[226:229], 0
    v_fmac_f32_e64 v7, v112, v187
    v_add_f32 v7, 0x358637bd, v7
    v_rcp_f32_e64 v7, v7
    v_bfe_u32 v4, v2, 1, 3
    v_lshlrev_b32_e64 v4, 4, v4
    v_mfma_f32_32x32x16_bf16 v[16:31], v[52:55], v[222:225], v[16:31]
    v_mov_b32 v8, 0
    v_mul_f32 v186, v186, v7
    v_mul_f32_e64 v187, v187, v7
    v_lshl_add_u32 v4, v3, 3, v4
    v_lshl_add_u32 v4, v2, 7, v4
    s_lshl_b32 s56, s62, 12
    v_mfma_f32_32x32x16_bf16 v[128:143], v[60:63], v[230:233], v[128:143]
    s_add_u32 s57, s56, 0
    v_add_u32 v64, s57, v4
    v_xor_b32 v65, 16, v64
    v_xor_b32 v66, 32, v64
    v_xor_b32 v67, 48, v64
    v_xor_b32_e64 v68, 64, v64
    v_mfma_f32_32x32x16_bf16 v[32:47], v[48:51], v[234:237], 0
    v_xor_b32 v69, 80, v64
    v_xor_b32 v70, 96, v64
    v_xor_b32 v71, 112, v64
    v_bfe_u32 v4, v1, 2, 2
    v_lshl_add_u32 v5, v3, 2, v4
    v_lshlrev_b32 v5, 7, v5
    s_bitcmp1_b32 s100, 2
    v_mfma_f32_32x32x16_bf16 v[144:159], v[56:59], v[242:245], 0
    v_mul_f32 v16, v16, v184
    v_mul_f32 v17, v17, v184
    v_mul_f32 v18, v18, v184
    v_mul_f32 v19, v19, v184
    v_mul_f32 v20, v20, v184
    v_mul_f32 v21, v21, v184
    v_mfma_f32_32x32x16_bf16 v[32:47], v[52:55], v[238:241], v[32:47]
    v_mul_f32 v22, v22, v184
    v_mul_f32 v23, v23, v184
    v_mul_f32 v24, v24, v184
    v_mul_f32 v25, v25, v184
    v_mul_f32 v26, v26, v184
    v_mul_f32 v27, v27, v184
    v_mfma_f32_32x32x16_bf16 v[144:159], v[60:63], v[246:249], v[144:159]
    v_mul_f32 v28, v28, v184
    v_mul_f32 v29, v29, v184
    v_mul_f32 v30, v30, v184
    v_mul_f32 v31, v31, v184
    v_fmac_f32 v16, v128, v185
    v_fmac_f32 v17, v129, v185
    v_cvt_pk_bf16_f32 v96, v16, v17
    v_fmac_f32 v18, v130, v185
    v_fmac_f32 v19, v131, v185
    v_cvt_pk_bf16_f32 v97, v18, v19
    v_fmac_f32 v20, v132, v185
    v_fmac_f32 v21, v133, v185
    v_cvt_pk_bf16_f32 v98, v20, v21
    v_fmac_f32 v22, v134, v185
    v_fmac_f32 v23, v135, v185
    v_cvt_pk_bf16_f32 v99, v22, v23
    buffer_store_dwordx4 v[96:99], v14, s[40:43], s76 offen offset:0 sc1
    v_fmac_f32 v24, v136, v185
    v_fmac_f32 v25, v137, v185
    v_cvt_pk_bf16_f32 v100, v24, v25
    v_fmac_f32 v26, v138, v185
    v_fmac_f32 v27, v139, v185
    v_cvt_pk_bf16_f32 v101, v26, v27
    v_fmac_f32 v28, v140, v185
    v_fmac_f32 v29, v141, v185
    v_cvt_pk_bf16_f32 v102, v28, v29
    v_fmac_f32 v30, v142, v185
    v_fmac_f32 v31, v143, v185
    v_cvt_pk_bf16_f32 v103, v30, v31
    buffer_store_dwordx4 v[100:103], v14, s[40:43], s76 offen offset:2048 sc1
    v_pk_mul_f32 v[32:33], v[32:33], v[186:187] op_sel_hi:[1,0]
    v_pk_fma_f32 v[32:33], v[144:145], v[186:187], v[32:33] op_sel:[0,1,0] op_sel_hi:[1,1,1]
    v_cvt_pk_bf16_f32 v104, v32, v33
    v_pk_mul_f32 v[34:35], v[34:35], v[186:187] op_sel_hi:[1,0]
    v_pk_fma_f32 v[34:35], v[146:147], v[186:187], v[34:35] op_sel:[0,1,0] op_sel_hi:[1,1,1]
    v_cvt_pk_bf16_f32 v105, v34, v35
    v_pk_mul_f32 v[36:37], v[36:37], v[186:187] op_sel_hi:[1,0]
    v_pk_fma_f32 v[36:37], v[148:149], v[186:187], v[36:37] op_sel:[0,1,0] op_sel_hi:[1,1,1]
    v_cvt_pk_bf16_f32 v106, v36, v37
    v_pk_mul_f32 v[38:39], v[38:39], v[186:187] op_sel_hi:[1,0]
    v_pk_fma_f32 v[38:39], v[150:151], v[186:187], v[38:39] op_sel:[0,1,0] op_sel_hi:[1,1,1]
    v_cvt_pk_bf16_f32 v107, v38, v39
    buffer_store_dwordx4 v[104:107], v14, s[40:43], s77 offen offset:0 sc1
    v_pk_mul_f32 v[40:41], v[40:41], v[186:187] op_sel_hi:[1,0]
    v_pk_fma_f32 v[40:41], v[152:153], v[186:187], v[40:41] op_sel:[0,1,0] op_sel_hi:[1,1,1]
    v_cvt_pk_bf16_f32 v108, v40, v41
    v_pk_mul_f32 v[42:43], v[42:43], v[186:187] op_sel_hi:[1,0]
    v_pk_fma_f32 v[42:43], v[154:155], v[186:187], v[42:43] op_sel:[0,1,0] op_sel_hi:[1,1,1]
    v_cvt_pk_bf16_f32 v109, v42, v43
    v_pk_mul_f32 v[44:45], v[44:45], v[186:187] op_sel_hi:[1,0]
    v_pk_fma_f32 v[44:45], v[156:157], v[186:187], v[44:45] op_sel:[0,1,0] op_sel_hi:[1,1,1]
    v_cvt_pk_bf16_f32 v110, v44, v45
    v_pk_mul_f32 v[46:47], v[46:47], v[186:187] op_sel_hi:[1,0]
    v_pk_fma_f32 v[46:47], v[158:159], v[186:187], v[46:47] op_sel:[0,1,0] op_sel_hi:[1,1,1]
    v_cvt_pk_bf16_f32 v111, v46, v47
    buffer_store_dwordx4 v[108:111], v14, s[40:43], s77 offen offset:2048 sc1
    v_lshrrev_b32_e64 v4, 1, v4
    v_lshl_add_u32 v5, v4, 6, v5
    v_bfe_u32 v4, v1, 4, 1
    v_lshl_add_u32 v5, v4, 5, v5
    v_and_b32_e64 v4, 3, v1
    v_lshl_add_u32 v5, v4, 3, v5
    v_add_u32 v72, 32768, v5
    v_xor_b32_e64 v73, 64, v72
    s_mul_i32 s80, s97, 524288
    s_mul_i32 s56, s62, 8192
    s_add_u32 s80, s80, s56
    s_add_u32 s80, s80, 16777216
    v_add_u32 v78, 4096, v14
    v_mov_b32 v74, 1
    s_mov_b32 s52, 0xffff
    s_mov_b32 s53, 0
    s_barrier
    ds_read_b32 v79, v8 offset:25984
    ds_read_b64 v[88:89], v64
    ds_read_b64 v[90:91], v65
    ds_read_b64 v[92:93], v66
    ds_read_b64 v[94:95], v67
    ds_read_b64 v[96:97], v68
    ds_read_b64 v[98:99], v69
    ds_read_b64 v[100:101], v70
    ds_read_b64 v[102:103], v71
    s_waitcnt lgkmcnt(8)
    v_readfirstlane_b32 s76, v79
    s_nop 0
    s_and_b32 s76, s76, s52
    s_cbranch_scc0 L_tr0
L_bk0:
    s_ff1_i32_b32 s76, s76
    s_bitset0_b32 s52, s76
    s_add_u32 s77, s76, s65
    s_and_b32 s77, s77, 15
    s_mul_i32 s77, s77, 32768
    s_add_u32 s28, s77, s80
    s_add_u32 s76, s76, 3
    s_and_b32 s76, s76, 15
    s_lshl_b32 s4, s76, 13
    buffer_load_dwordx4 v[128:131], v14, s[40:43], s28 offen offset:0 sc1
    buffer_load_dwordx4 v[132:135], v14, s[40:43], s28 offen offset:2048 sc1
    buffer_load_dwordx4 v[136:139], v78, s[40:43], s28 offen offset:0 sc1
    buffer_load_dwordx4 v[140:143], v78, s[40:43], s28 offen offset:2048 sc1
    v_readfirstlane_b32 s76, v79
    s_nop 0
    s_and_b32 s76, s76, s52
    s_cbranch_scc0 L_tr1
L_bk1:
    s_ff1_i32_b32 s76, s76
    s_bitset0_b32 s52, s76
    s_add_u32 s77, s76, s65
    s_and_b32 s77, s77, 15
    s_mul_i32 s77, s77, 32768
    s_add_u32 s29, s77, s80
    s_add_u32 s76, s76, 3
    s_and_b32 s76, s76, 15
    s_lshl_b32 s5, s76, 13
    buffer_load_dwordx4 v[144:147], v14, s[40:43], s29 offen offset:0 sc1
    buffer_load_dwordx4 v[148:151], v14, s[40:43], s29 offen offset:2048 sc1
    v_add_u32 v80, s4, v72
    v_add_u32 v81, s4, v73
    s_waitcnt lgkmcnt(0)
    v_lshlrev_b32 v16, 16, v88
    v_and_b32 v17, s90, v88
    v_lshlrev_b32 v18, 16, v89
    v_and_b32 v19, s90, v89
    v_lshlrev_b32 v20, 16, v90
    v_and_b32 v21, s90, v90
    v_lshlrev_b32 v22, 16, v91
    v_and_b32 v23, s90, v91
    v_lshlrev_b32 v24, 16, v92
    v_and_b32 v25, s90, v92
    v_lshlrev_b32 v26, 16, v93
    v_and_b32 v27, s90, v93
    v_lshlrev_b32 v28, 16, v94
    v_and_b32 v29, s90, v94
    v_lshlrev_b32 v30, 16, v95
    v_and_b32 v31, s90, v95
    v_lshlrev_b32 v32, 16, v96
    v_and_b32 v33, s90, v96
    v_lshlrev_b32 v34, 16, v97
    v_and_b32 v35, s90, v97
    v_lshlrev_b32 v36, 16, v98
    v_and_b32 v37, s90, v98
    v_lshlrev_b32 v38, 16, v99
    v_and_b32 v39, s90, v99
    v_lshlrev_b32 v40, 16, v100
    v_and_b32 v41, s90, v100
    v_lshlrev_b32 v42, 16, v101
    v_and_b32 v43, s90, v101
    v_lshlrev_b32 v44, 16, v102
    v_and_b32 v45, s90, v102
    v_lshlrev_b32 v46, 16, v103
    v_and_b32 v47, s90, v103
    s_cmp_eq_u32 s53, 0
    s_cbranch_scc0 L_sent_66
    s_waitcnt vmcnt(6)
    s_mov_b64 exec, 1
    ds_add_u32 v8, v74 offset:25988
    s_mov_b64 exec, -1
    s_mov_b32 s53, 1
L_sent_66:
    ds_read_b32 v79, v8 offset:25984
    ds_read_b64_tr_b16 v[104:105], v80 offset:0
    ds_read_b64_tr_b16 v[106:107], v80 offset:1024
    ds_read_b64_tr_b16 v[108:109], v81 offset:0
    ds_read_b64_tr_b16 v[110:111], v81 offset:1024
    ds_read_b64_tr_b16 v[112:113], v80 offset:2048
    ds_read_b64_tr_b16 v[114:115], v80 offset:3072
    ds_read_b64_tr_b16 v[116:117], v81 offset:2048
    ds_read_b64_tr_b16 v[118:119], v81 offset:3072
    s_waitcnt vmcnt(5) lgkmcnt(4)
    v_mfma_f32_32x32x16_bf16 v[16:31], v[104:107], v[128:131], v[16:31]
    ds_read_b64_tr_b16 v[120:121], v80 offset:4096
    ds_read_b64_tr_b16 v[122:123], v80 offset:5120
    buffer_load_dwordx4 v[152:155], v78, s[40:43], s29 offen offset:0 sc1
    v_mfma_f32_32x32x16_bf16 v[32:47], v[108:111], v[128:131], v[32:47]
    ds_read_b64_tr_b16 v[124:125], v81 offset:4096
    ds_read_b64_tr_b16 v[126:127], v81 offset:5120
    buffer_load_dwordx4 v[156:159], v78, s[40:43], s29 offen offset:2048 sc1
    v_readfirstlane_b32 s76, v79
    s_nop 0
    s_and_b32 s76, s76, s52
    s_cbranch_scc0 L_tr2
L_bk2:
    s_ff1_i32_b32 s76, s76
    s_bitset0_b32 s52, s76
    s_add_u32 s77, s76, s65
    s_and_b32 s77, s77, 15
    s_mul_i32 s77, s77, 32768
    s_add_u32 s30, s77, s80
    s_waitcnt vmcnt(6) lgkmcnt(4)
    v_mfma_f32_32x32x16_bf16 v[16:31], v[112:115], v[132:135], v[16:31]
    ds_read_b32 v79, v8 offset:25984
    ds_read_b64_tr_b16 v[104:105], v80 offset:6144
    ds_read_b64_tr_b16 v[106:107], v80 offset:7168
    buffer_load_dwordx4 v[160:163], v14, s[40:43], s30 offen offset:0 sc1
    s_add_u32 s76, s76, 3
    s_and_b32 s76, s76, 15
    s_lshl_b32 s6, s76, 13
    v_mfma_f32_32x32x16_bf16 v[32:47], v[116:119], v[132:135], v[32:47]
    ds_read_b64_tr_b16 v[108:109], v81 offset:6144
    ds_read_b64_tr_b16 v[110:111], v81 offset:7168
    buffer_load_dwordx4 v[164:167], v14, s[40:43], s30 offen offset:2048 sc1
    v_add_u32 v82, s5, v72
    v_add_u32_e64 v83, s5, v73
    s_waitcnt vmcnt(7) lgkmcnt(4)
    v_mfma_f32_32x32x16_bf16 v[16:31], v[120:123], v[136:139], v[16:31]
    ds_read_b64_tr_b16 v[112:113], v82 offset:0
    ds_read_b64_tr_b16 v[114:115], v82 offset:1024
    buffer_load_dwordx4 v[168:171], v78, s[40:43], s30 offen offset:0 sc1
    v_mfma_f32_32x32x16_bf16 v[32:47], v[124:127], v[136:139], v[32:47]
    ds_read_b64_tr_b16 v[116:117], v83 offset:0
    ds_read_b64_tr_b16 v[118:119], v83 offset:1024
    buffer_load_dwordx4 v[172:175], v78, s[40:43], s30 offen offset:2048 sc1
    v_readfirstlane_b32 s76, v79
    s_nop 0
    s_and_b32 s76, s76, s52
    s_cbranch_scc0 L_tr3
L_bk3:
    s_ff1_i32_b32 s76, s76
    s_bitset0_b32 s52, s76
    s_add_u32 s77, s76, s65
    s_and_b32 s77, s77, 15
    s_mul_i32 s77, s77, 32768
    s_add_u32 s31, s77, s80
    s_waitcnt vmcnt(8) lgkmcnt(4)
    v_mfma_f32_32x32x16_bf16 v[16:31], v[104:107], v[140:143], v[16:31]
    ds_read_b32 v79, v8 offset:25984
    ds_read_b64_tr_b16 v[120:121], v82 offset:2048
    ds_read_b64_tr_b16 v[122:123], v82 offset:3072
    buffer_load_dwordx4 v[176:179], v14, s[40:43], s31 offen offset:0 sc1
    s_add_u32 s76, s76, 3
    s_and_b32 s76, s76, 15
    s_lshl_b32 s7, s76, 13
    v_mfma_f32_32x32x16_bf16 v[32:47], v[108:111], v[140:143], v[32:47]
    ds_read_b64_tr_b16 v[124:125], v83 offset:2048
    ds_read_b64_tr_b16 v[126:127], v83 offset:3072
    buffer_load_dwordx4 v[180:183], v14, s[40:43], s31 offen offset:2048 sc1
    s_waitcnt vmcnt(9) lgkmcnt(4)
    v_mfma_f32_32x32x16_bf16 v[16:31], v[112:115], v[144:147], v[16:31]
    ds_read_b64_tr_b16 v[104:105], v82 offset:4096
    ds_read_b64_tr_b16 v[106:107], v82 offset:5120
    buffer_load_dwordx4 v[184:187], v78, s[40:43], s31 offen offset:0 sc1
    v_mfma_f32_32x32x16_bf16 v[32:47], v[116:119], v[144:147], v[32:47]
    ds_read_b64_tr_b16 v[108:109], v83 offset:4096
    ds_read_b64_tr_b16 v[110:111], v83 offset:5120
    buffer_load_dwordx4 v[188:191], v78, s[40:43], s31 offen offset:2048 sc1
    v_readfirstlane_b32 s76, v79
    s_nop 0
    s_and_b32 s76, s76, s52
    s_cbranch_scc0 L_tr4
L_bk4:
    s_ff1_i32_b32 s76, s76
    s_bitset0_b32 s52, s76
    s_add_u32 s77, s76, s65
    s_and_b32 s77, s77, 15
    s_mul_i32 s77, s77, 32768
    s_add_u32 s32, s77, s80
    s_waitcnt vmcnt(10) lgkmcnt(4)
    v_mfma_f32_32x32x16_bf16 v[16:31], v[120:123], v[148:151], v[16:31]
    ds_read_b64_tr_b16 v[112:113], v82 offset:6144
    ds_read_b64_tr_b16 v[114:115], v82 offset:7168
    buffer_load_dwordx4 v[128:131], v14, s[40:43], s32 offen offset:0 sc1
    s_add_u32 s76, s76, 3
    s_and_b32 s76, s76, 15
    s_lshl_b32 s8, s76, 13
    v_mfma_f32_32x32x16_bf16 v[32:47], v[124:127], v[148:151], v[32:47]
    ds_read_b64_tr_b16 v[116:117], v83 offset:6144
    ds_read_b64_tr_b16 v[118:119], v83 offset:7168
    buffer_load_dwordx4 v[132:135], v14, s[40:43], s32 offen offset:2048 sc1
    v_add_u32 v80, s6, v72
    v_add_u32 v81, s6, v73
    s_waitcnt vmcnt(11) lgkmcnt(4)
    v_mfma_f32_32x32x16_bf16 v[16:31], v[104:107], v[152:155], v[16:31]
    ds_read_b32 v79, v8 offset:25984
    ds_read_b64_tr_b16 v[120:121], v80 offset:0
    ds_read_b64_tr_b16 v[122:123], v80 offset:1024
    buffer_load_dwordx4 v[136:139], v78, s[40:43], s32 offen offset:0 sc1
    v_mfma_f32_32x32x16_bf16 v[32:47], v[108:111], v[152:155], v[32:47]
    ds_read_b64_tr_b16 v[124:125], v81 offset:0
    ds_read_b64_tr_b16 v[126:127], v81 offset:1024
    s_waitcnt vmcnt(11) lgkmcnt(4)
    v_mfma_f32_32x32x16_bf16 v[16:31], v[112:115], v[156:159], v[16:31]
    ds_read_b64_tr_b16 v[104:105], v80 offset:2048
    ds_read_b64_tr_b16 v[106:107], v80 offset:3072
    buffer_load_dwordx4 v[140:143], v78, s[40:43], s32 offen offset:2048 sc1
    v_mfma_f32_32x32x16_bf16 v[32:47], v[116:119], v[156:159], v[32:47]
    ds_read_b64_tr_b16 v[108:109], v81 offset:2048
    ds_read_b64_tr_b16 v[110:111], v81 offset:3072
    v_readfirstlane_b32 s76, v79
    s_nop 0
    s_and_b32 s76, s76, s52
    s_cbranch_scc0 L_tr5
L_bk5:
    s_ff1_i32_b32 s76, s76
    s_bitset0_b32 s52, s76
    s_add_u32 s77, s76, s65
    s_and_b32 s77, s77, 15
    s_mul_i32 s77, s77, 32768
    s_add_u32 s33, s77, s80
    s_waitcnt vmcnt(11) lgkmcnt(4)
    v_mfma_f32_32x32x16_bf16 v[16:31], v[120:123], v[160:163], v[16:31]
    ds_read_b64_tr_b16 v[112:113], v80 offset:4096
    ds_read_b64_tr_b16 v[114:115], v80 offset:5120
    buffer_load_dwordx4 v[144:147], v14, s[40:43], s33 offen offset:0 sc1
    s_add_u32 s76, s76, 3
    s_and_b32 s76, s76, 15
    s_lshl_b32 s9, s76, 13
    v_mfma_f32_32x32x16_bf16 v[32:47], v[124:127], v[160:163], v[32:47]
    ds_read_b64_tr_b16 v[116:117], v81 offset:4096
    ds_read_b64_tr_b16 v[118:119], v81 offset:5120
    s_waitcnt vmcnt(11) lgkmcnt(4)
    v_mfma_f32_32x32x16_bf16 v[16:31], v[104:107], v[164:167], v[16:31]
    ds_read_b64_tr_b16 v[120:121], v80 offset:6144
    ds_read_b64_tr_b16 v[122:123], v80 offset:7168
    buffer_load_dwordx4 v[148:151], v14, s[40:43], s33 offen offset:2048 sc1
    v_mfma_f32_32x32x16_bf16 v[32:47], v[108:111], v[164:167], v[32:47]
    ds_read_b64_tr_b16 v[124:125], v81 offset:6144
    ds_read_b64_tr_b16 v[126:127], v81 offset:7168
    v_add_u32 v82, s7, v72
    v_add_u32 v83, s7, v73
    s_waitcnt vmcnt(11) lgkmcnt(4)
    v_mfma_f32_32x32x16_bf16 v[16:31], v[112:115], v[168:171], v[16:31]
    ds_read_b32 v79, v8 offset:25984
    ds_read_b64_tr_b16 v[104:105], v82 offset:0
    ds_read_b64_tr_b16 v[106:107], v82 offset:1024
    buffer_load_dwordx4 v[152:155], v78, s[40:43], s33 offen offset:0 sc1
    v_mfma_f32_32x32x16_bf16 v[32:47], v[116:119], v[168:171], v[32:47]
    ds_read_b64_tr_b16 v[108:109], v83 offset:0
    ds_read_b64_tr_b16 v[110:111], v83 offset:1024
    s_waitcnt vmcnt(11) lgkmcnt(4)
    v_mfma_f32_32x32x16_bf16 v[16:31], v[120:123], v[172:175], v[16:31]
    ds_read_b64_tr_b16 v[112:113], v82 offset:2048
    ds_read_b64_tr_b16 v[114:115], v82 offset:3072
    buffer_load_dwordx4 v[156:159], v78, s[40:43], s33 offen offset:2048 sc1
    v_mfma_f32_32x32x16_bf16 v[32:47], v[124:127], v[172:175], v[32:47]
    ds_read_b64_tr_b16 v[116:117], v83 offset:2048
    ds_read_b64_tr_b16 v[118:119], v83 offset:3072
    v_readfirstlane_b32 s76, v79
    s_nop 0
    s_and_b32 s76, s76, s52
    s_cbranch_scc0 L_tr6
L_bk6:
    s_ff1_i32_b32 s76, s76
    s_bitset0_b32 s52, s76
    s_add_u32 s77, s76, s65
    s_and_b32 s77, s77, 15
    s_mul_i32 s77, s77, 32768
    s_add_u32 s34, s77, s80
    s_waitcnt vmcnt(11) lgkmcnt(4)
    v_mfma_f32_32x32x16_bf16 v[16:31], v[104:107], v[176:179], v[16:31]
    ds_read_b64_tr_b16 v[120:121], v82 offset:4096
    ds_read_b64_tr_b16 v[122:123], v82 offset:5120
    buffer_load_dwordx4 v[160:163], v14, s[40:43], s34 offen offset:0 sc1
    s_add_u32 s76, s76, 3
    s_and_b32 s76, s76, 15
    s_lshl_b32 s10, s76, 13
    v_mfma_f32_32x32x16_bf16 v[32:47], v[108:111], v[176:179], v[32:47]
    ds_read_b64_tr_b16 v[124:125], v83 offset:4096
    ds_read_b64_tr_b16 v[126:127], v83 offset:5120
    s_waitcnt vmcnt(11) lgkmcnt(4)
    v_mfma_f32_32x32x16_bf16 v[16:31], v[112:115], v[180:183], v[16:31]
    ds_read_b64_tr_b16 v[104:105], v82 offset:6144
    ds_read_b64_tr_b16 v[106:107], v82 offset:7168
    buffer_load_dwordx4 v[164:167], v14, s[40:43], s34 offen offset:2048 sc1
    v_mfma_f32_32x32x16_bf16 v[32:47], v[116:119], v[180:183], v[32:47]
    ds_read_b64_tr_b16 v[108:109], v83 offset:6144
    ds_read_b64_tr_b16 v[110:111], v83 offset:7168
    v_add_u32 v80, s8, v72
    v_add_u32 v81, s8, v73
    s_waitcnt vmcnt(11) lgkmcnt(4)
    v_mfma_f32_32x32x16_bf16 v[16:31], v[120:123], v[184:187], v[16:31]
    ds_read_b32 v79, v8 offset:25984
    ds_read_b64_tr_b16 v[112:113], v80 offset:0
    ds_read_b64_tr_b16 v[114:115], v80 offset:1024
    buffer_load_dwordx4 v[168:171], v78, s[40:43], s34 offen offset:0 sc1
    v_mfma_f32_32x32x16_bf16 v[32:47], v[124:127], v[184:187], v[32:47]
    ds_read_b64_tr_b16 v[116:117], v81 offset:0
    ds_read_b64_tr_b16 v[118:119], v81 offset:1024
    s_waitcnt vmcnt(11) lgkmcnt(4)
    v_mfma_f32_32x32x16_bf16 v[16:31], v[104:107], v[188:191], v[16:31]
    ds_read_b64_tr_b16 v[120:121], v80 offset:2048
    ds_read_b64_tr_b16 v[122:123], v80 offset:3072
    buffer_load_dwordx4 v[172:175], v78, s[40:43], s34 offen offset:2048 sc1
    v_mfma_f32_32x32x16_bf16 v[32:47], v[108:111], v[188:191], v[32:47]
    ds_read_b64_tr_b16 v[124:125], v81 offset:2048
    ds_read_b64_tr_b16 v[126:127], v81 offset:3072
    v_readfirstlane_b32 s76, v79
    s_nop 0
    s_and_b32 s76, s76, s52
    s_cbranch_scc0 L_tr7
L_bk7:
    s_ff1_i32_b32 s76, s76
    s_bitset0_b32 s52, s76
    s_add_u32 s77, s76, s65
    s_and_b32 s77, s77, 15
    s_mul_i32 s77, s77, 32768
    s_add_u32 s35, s77, s80
    s_waitcnt vmcnt(11) lgkmcnt(4)
    v_mfma_f32_32x32x16_bf16 v[16:31], v[112:115], v[128:131], v[16:31]
    ds_read_b64_tr_b16 v[104:105], v80 offset:4096
    ds_read_b64_tr_b16 v[106:107], v80 offset:5120
    buffer_load_dwordx4 v[176:179], v14, s[40:43], s35 offen offset:0 sc1
    s_add_u32 s76, s76, 3
    s_and_b32 s76, s76, 15
    s_lshl_b32 s11, s76, 13
    v_mfma_f32_32x32x16_bf16 v[32:47], v[116:119], v[128:131], v[32:47]
    ds_read_b64_tr_b16 v[108:109], v81 offset:4096
    ds_read_b64_tr_b16 v[110:111], v81 offset:5120
    s_waitcnt vmcnt(11) lgkmcnt(4)
    v_mfma_f32_32x32x16_bf16 v[16:31], v[120:123], v[132:135], v[16:31]
    ds_read_b64_tr_b16 v[112:113], v80 offset:6144
    ds_read_b64_tr_b16 v[114:115], v80 offset:7168
    buffer_load_dwordx4 v[180:183], v14, s[40:43], s35 offen offset:2048 sc1
    v_mfma_f32_32x32x16_bf16 v[32:47], v[124:127], v[132:135], v[32:47]
    ds_read_b64_tr_b16 v[116:117], v81 offset:6144
    ds_read_b64_tr_b16 v[118:119], v81 offset:7168
    v_add_u32 v82, s9, v72
    v_add_u32 v83, s9, v73
    s_waitcnt vmcnt(11) lgkmcnt(4)
    v_mfma_f32_32x32x16_bf16 v[16:31], v[104:107], v[136:139], v[16:31]
    ds_read_b32 v79, v8 offset:25984
    ds_read_b64_tr_b16 v[120:121], v82 offset:0
    ds_read_b64_tr_b16 v[122:123], v82 offset:1024
    buffer_load_dwordx4 v[184:187], v78, s[40:43], s35 offen offset:0 sc1
    v_mfma_f32_32x32x16_bf16 v[32:47], v[108:111], v[136:139], v[32:47]
    ds_read_b64_tr_b16 v[124:125], v83 offset:0
    ds_read_b64_tr_b16 v[126:127], v83 offset:1024
    s_waitcnt vmcnt(11) lgkmcnt(4)
    v_mfma_f32_32x32x16_bf16 v[16:31], v[112:115], v[140:143], v[16:31]
    ds_read_b64_tr_b16 v[104:105], v82 offset:2048
    ds_read_b64_tr_b16 v[106:107], v82 offset:3072
    buffer_load_dwordx4 v[188:191], v78, s[40:43], s35 offen offset:2048 sc1
    v_mfma_f32_32x32x16_bf16 v[32:47], v[116:119], v[140:143], v[32:47]
    ds_read_b64_tr_b16 v[108:109], v83 offset:2048
    ds_read_b64_tr_b16 v[110:111], v83 offset:3072
    v_readfirstlane_b32 s76, v79
    s_nop 0
    s_and_b32 s76, s76, s52
    s_cbranch_scc0 L_tr8
L_bk8:
    s_ff1_i32_b32 s76, s76
    s_bitset0_b32 s52, s76
    s_add_u32 s77, s76, s65
    s_and_b32 s77, s77, 15
    s_mul_i32 s77, s77, 32768
    s_add_u32 s36, s77, s80
    s_waitcnt vmcnt(11) lgkmcnt(4)
    v_mfma_f32_32x32x16_bf16 v[16:31], v[120:123], v[144:147], v[16:31]
    ds_read_b64_tr_b16 v[112:113], v82 offset:4096
    ds_read_b64_tr_b16 v[114:115], v82 offset:5120
    buffer_load_dwordx4 v[128:131], v14, s[40:43], s36 offen offset:0 sc1
    s_add_u32 s76, s76, 3
    s_and_b32 s76, s76, 15
    s_lshl_b32 s12, s76, 13
    v_mfma_f32_32x32x16_bf16 v[32:47], v[124:127], v[144:147], v[32:47]
    ds_read_b64_tr_b16 v[116:117], v83 offset:4096
    ds_read_b64_tr_b16 v[118:119], v83 offset:5120
    s_waitcnt vmcnt(11) lgkmcnt(4)
    v_mfma_f32_32x32x16_bf16 v[16:31], v[104:107], v[148:151], v[16:31]
    ds_read_b64_tr_b16 v[120:121], v82 offset:6144
    ds_read_b64_tr_b16 v[122:123], v82 offset:7168
    buffer_load_dwordx4 v[132:135], v14, s[40:43], s36 offen offset:2048 sc1
    v_mfma_f32_32x32x16_bf16 v[32:47], v[108:111], v[148:151], v[32:47]
    ds_read_b64_tr_b16 v[124:125], v83 offset:6144
    ds_read_b64_tr_b16 v[126:127], v83 offset:7168
    v_add_u32 v80, s10, v72
    v_add_u32 v81, s10, v73
    s_waitcnt vmcnt(11) lgkmcnt(4)
    v_mfma_f32_32x32x16_bf16 v[16:31], v[112:115], v[152:155], v[16:31]
    ds_read_b32 v79, v8 offset:25984
    ds_read_b64_tr_b16 v[104:105], v80 offset:0
    ds_read_b64_tr_b16 v[106:107], v80 offset:1024
    buffer_load_dwordx4 v[136:139], v78, s[40:43], s36 offen offset:0 sc1
    v_mfma_f32_32x32x16_bf16 v[32:47], v[116:119], v[152:155], v[32:47]
    ds_read_b64_tr_b16 v[108:109], v81 offset:0
    ds_read_b64_tr_b16 v[110:111], v81 offset:1024
    s_waitcnt vmcnt(11) lgkmcnt(4)
    v_mfma_f32_32x32x16_bf16 v[16:31], v[120:123], v[156:159], v[16:31]
    ds_read_b64_tr_b16 v[112:113], v80 offset:2048
    ds_read_b64_tr_b16 v[114:115], v80 offset:3072
    buffer_load_dwordx4 v[140:143], v78, s[40:43], s36 offen offset:2048 sc1
    v_mfma_f32_32x32x16_bf16 v[32:47], v[124:127], v[156:159], v[32:47]
    ds_read_b64_tr_b16 v[116:117], v81 offset:2048
    ds_read_b64_tr_b16 v[118:119], v81 offset:3072
    v_readfirstlane_b32 s76, v79
    s_nop 0
    s_and_b32 s76, s76, s52
    s_cbranch_scc0 L_tr9
L_bk9:
    s_ff1_i32_b32 s76, s76
    s_bitset0_b32 s52, s76
    s_add_u32 s77, s76, s65
    s_and_b32 s77, s77, 15
    s_mul_i32 s77, s77, 32768
    s_add_u32 s37, s77, s80
    s_waitcnt vmcnt(11) lgkmcnt(4)
    v_mfma_f32_32x32x16_bf16 v[16:31], v[104:107], v[160:163], v[16:31]
    ds_read_b64_tr_b16 v[120:121], v80 offset:4096
    ds_read_b64_tr_b16 v[122:123], v80 offset:5120
    buffer_load_dwordx4 v[144:147], v14, s[40:43], s37 offen offset:0 sc1
    s_add_u32 s76, s76, 3
    s_and_b32 s76, s76, 15
    s_lshl_b32 s13, s76, 13
    v_mfma_f32_32x32x16_bf16 v[32:47], v[108:111], v[160:163], v[32:47]
    ds_read_b64_tr_b16 v[124:125], v81 offset:4096
    ds_read_b64_tr_b16 v[126:127], v81 offset:5120
    s_waitcnt vmcnt(11) lgkmcnt(4)
    v_mfma_f32_32x32x16_bf16 v[16:31], v[112:115], v[164:167], v[16:31]
    ds_read_b64_tr_b16 v[104:105], v80 offset:6144
    ds_read_b64_tr_b16 v[106:107], v80 offset:7168
    buffer_load_dwordx4 v[148:151], v14, s[40:43], s37 offen offset:2048 sc1
    v_mfma_f32_32x32x16_bf16 v[32:47], v[116:119], v[164:167], v[32:47]
    ds_read_b64_tr_b16 v[108:109], v81 offset:6144
    ds_read_b64_tr_b16 v[110:111], v81 offset:7168
    v_add_u32 v82, s11, v72
    v_add_u32 v83, s11, v73
    s_waitcnt vmcnt(11) lgkmcnt(4)
    v_mfma_f32_32x32x16_bf16 v[16:31], v[120:123], v[168:171], v[16:31]
    ds_read_b32 v79, v8 offset:25984
    ds_read_b64_tr_b16 v[112:113], v82 offset:0
    ds_read_b64_tr_b16 v[114:115], v82 offset:1024
    buffer_load_dwordx4 v[152:155], v78, s[40:43], s37 offen offset:0 sc1
    v_mfma_f32_32x32x16_bf16 v[32:47], v[124:127], v[168:171], v[32:47]
    ds_read_b64_tr_b16 v[116:117], v83 offset:0
    ds_read_b64_tr_b16 v[118:119], v83 offset:1024
    s_waitcnt vmcnt(11) lgkmcnt(4)
    v_mfma_f32_32x32x16_bf16 v[16:31], v[104:107], v[172:175], v[16:31]
    ds_read_b64_tr_b16 v[120:121], v82 offset:2048
    ds_read_b64_tr_b16 v[122:123], v82 offset:3072
    buffer_load_dwordx4 v[156:159], v78, s[40:43], s37 offen offset:2048 sc1
    v_mfma_f32_32x32x16_bf16 v[32:47], v[108:111], v[172:175], v[32:47]
    ds_read_b64_tr_b16 v[124:125], v83 offset:2048
    ds_read_b64_tr_b16 v[126:127], v83 offset:3072
    v_readfirstlane_b32 s76, v79
    s_nop 0
    s_and_b32 s76, s76, s52
    s_cbranch_scc0 L_tr10
L_bk10:
    s_ff1_i32_b32 s76, s76
    s_bitset0_b32 s52, s76
    s_add_u32 s77, s76, s65
    s_and_b32 s77, s77, 15
    s_mul_i32 s77, s77, 32768
    s_add_u32 s38, s77, s80
    s_waitcnt vmcnt(11) lgkmcnt(4)
    v_mfma_f32_32x32x16_bf16 v[16:31], v[112:115], v[176:179], v[16:31]
    ds_read_b64_tr_b16 v[104:105], v82 offset:4096
    ds_read_b64_tr_b16 v[106:107], v82 offset:5120
    buffer_load_dwordx4 v[160:163], v14, s[40:43], s38 offen offset:0 sc1
    s_add_u32 s76, s76, 3
    s_and_b32 s76, s76, 15
    s_lshl_b32 s14, s76, 13
    v_mfma_f32_32x32x16_bf16 v[32:47], v[116:119], v[176:179], v[32:47]
    ds_read_b64_tr_b16 v[108:109], v83 offset:4096
    ds_read_b64_tr_b16 v[110:111], v83 offset:5120
    s_waitcnt vmcnt(11) lgkmcnt(4)
    v_mfma_f32_32x32x16_bf16 v[16:31], v[120:123], v[180:183], v[16:31]
    ds_read_b64_tr_b16 v[112:113], v82 offset:6144
    ds_read_b64_tr_b16 v[114:115], v82 offset:7168
    buffer_load_dwordx4 v[164:167], v14, s[40:43], s38 offen offset:2048 sc1
    v_mfma_f32_32x32x16_bf16 v[32:47], v[124:127], v[180:183], v[32:47]
    ds_read_b64_tr_b16 v[116:117], v83 offset:6144
    ds_read_b64_tr_b16 v[118:119], v83 offset:7168
    v_add_u32 v80, s12, v72
    v_add_u32 v81, s12, v73
    s_waitcnt vmcnt(11) lgkmcnt(4)
    v_mfma_f32_32x32x16_bf16 v[16:31], v[104:107], v[184:187], v[16:31]
    ds_read_b32 v79, v8 offset:25984
    ds_read_b64_tr_b16 v[120:121], v80 offset:0
    ds_read_b64_tr_b16 v[122:123], v80 offset:1024
    buffer_load_dwordx4 v[168:171], v78, s[40:43], s38 offen offset:0 sc1
    v_mfma_f32_32x32x16_bf16 v[32:47], v[108:111], v[184:187], v[32:47]
    ds_read_b64_tr_b16 v[124:125], v81 offset:0
    ds_read_b64_tr_b16 v[126:127], v81 offset:1024
    s_waitcnt vmcnt(11) lgkmcnt(4)
    v_mfma_f32_32x32x16_bf16 v[16:31], v[112:115], v[188:191], v[16:31]
    ds_read_b64_tr_b16 v[104:105], v80 offset:2048
    ds_read_b64_tr_b16 v[106:107], v80 offset:3072
    buffer_load_dwordx4 v[172:175], v78, s[40:43], s38 offen offset:2048 sc1
    v_mfma_f32_32x32x16_bf16 v[32:47], v[116:119], v[188:191], v[32:47]
    ds_read_b64_tr_b16 v[108:109], v81 offset:2048
    ds_read_b64_tr_b16 v[110:111], v81 offset:3072
    v_readfirstlane_b32 s76, v79
    s_nop 0
    s_and_b32 s76, s76, s52
    s_cbranch_scc0 L_tr11
L_bk11:
    s_ff1_i32_b32 s76, s76
    s_bitset0_b32 s52, s76
    s_add_u32 s77, s76, s65
    s_and_b32 s77, s77, 15
    s_mul_i32 s77, s77, 32768
    s_add_u32 s39, s77, s80
    s_waitcnt vmcnt(11) lgkmcnt(4)
    v_mfma_f32_32x32x16_bf16 v[16:31], v[120:123], v[128:131], v[16:31]
    ds_read_b64_tr_b16 v[112:113], v80 offset:4096
    ds_read_b64_tr_b16 v[114:115], v80 offset:5120
    buffer_load_dwordx4 v[176:179], v14, s[40:43], s39 offen offset:0 sc1
    s_add_u32 s76, s76, 3
    s_and_b32 s76, s76, 15
    s_lshl_b32 s15, s76, 13
    v_mfma_f32_32x32x16_bf16 v[32:47], v[124:127], v[128:131], v[32:47]
    ds_read_b64_tr_b16 v[116:117], v81 offset:4096
    ds_read_b64_tr_b16 v[118:119], v81 offset:5120
    s_waitcnt vmcnt(11) lgkmcnt(4)
    v_mfma_f32_32x32x16_bf16 v[16:31], v[104:107], v[132:135], v[16:31]
    ds_read_b64_tr_b16 v[120:121], v80 offset:6144
    ds_read_b64_tr_b16 v[122:123], v80 offset:7168
    buffer_load_dwordx4 v[180:183], v14, s[40:43], s39 offen offset:2048 sc1
    v_mfma_f32_32x32x16_bf16 v[32:47], v[108:111], v[132:135], v[32:47]
    ds_read_b64_tr_b16 v[124:125], v81 offset:6144
    ds_read_b64_tr_b16 v[126:127], v81 offset:7168
    v_add_u32 v82, s13, v72
    v_add_u32 v83, s13, v73
    s_waitcnt vmcnt(11) lgkmcnt(4)
    v_mfma_f32_32x32x16_bf16 v[16:31], v[112:115], v[136:139], v[16:31]
    ds_read_b32 v79, v8 offset:25984
    ds_read_b64_tr_b16 v[104:105], v82 offset:0
    ds_read_b64_tr_b16 v[106:107], v82 offset:1024
    buffer_load_dwordx4 v[184:187], v78, s[40:43], s39 offen offset:0 sc1
    v_mfma_f32_32x32x16_bf16 v[32:47], v[116:119], v[136:139], v[32:47]
    ds_read_b64_tr_b16 v[108:109], v83 offset:0
    ds_read_b64_tr_b16 v[110:111], v83 offset:1024
    s_waitcnt vmcnt(11) lgkmcnt(4)
    v_mfma_f32_32x32x16_bf16 v[16:31], v[120:123], v[140:143], v[16:31]
    ds_read_b64_tr_b16 v[112:113], v82 offset:2048
    ds_read_b64_tr_b16 v[114:115], v82 offset:3072
    buffer_load_dwordx4 v[188:191], v78, s[40:43], s39 offen offset:2048 sc1
    v_mfma_f32_32x32x16_bf16 v[32:47], v[124:127], v[140:143], v[32:47]
    ds_read_b64_tr_b16 v[116:117], v83 offset:2048
    ds_read_b64_tr_b16 v[118:119], v83 offset:3072
    v_readfirstlane_b32 s76, v79
    s_nop 0
    s_and_b32 s76, s76, s52
    s_cbranch_scc0 L_tr12
L_bk12:
    s_ff1_i32_b32 s76, s76
    s_bitset0_b32 s52, s76
    s_add_u32 s77, s76, s65
    s_and_b32 s77, s77, 15
    s_mul_i32 s77, s77, 32768
    s_add_u32 s48, s77, s80
    s_waitcnt vmcnt(11) lgkmcnt(4)
    v_mfma_f32_32x32x16_bf16 v[16:31], v[104:107], v[144:147], v[16:31]
    ds_read_b64_tr_b16 v[120:121], v82 offset:4096
    ds_read_b64_tr_b16 v[122:123], v82 offset:5120
    buffer_load_dwordx4 v[128:131], v14, s[40:43], s48 offen offset:0 sc1
    s_add_u32 s76, s76, 3
    s_and_b32 s76, s76, 15
    s_lshl_b32 s16, s76, 13
    v_mfma_f32_32x32x16_bf16 v[32:47], v[108:111], v[144:147], v[32:47]
    ds_read_b64_tr_b16 v[124:125], v83 offset:4096
    ds_read_b64_tr_b16 v[126:127], v83 offset:5120
    s_waitcnt vmcnt(11) lgkmcnt(4)
    v_mfma_f32_32x32x16_bf16 v[16:31], v[112:115], v[148:151], v[16:31]
    ds_read_b64_tr_b16 v[104:105], v82 offset:6144
    ds_read_b64_tr_b16 v[106:107], v82 offset:7168
    buffer_load_dwordx4 v[132:135], v14, s[40:43], s48 offen offset:2048 sc1
    v_mfma_f32_32x32x16_bf16 v[32:47], v[116:119], v[148:151], v[32:47]
    ds_read_b64_tr_b16 v[108:109], v83 offset:6144
    ds_read_b64_tr_b16 v[110:111], v83 offset:7168
    v_add_u32 v80, s14, v72
    v_add_u32 v81, s14, v73
    s_waitcnt vmcnt(11) lgkmcnt(4)
    v_mfma_f32_32x32x16_bf16 v[16:31], v[120:123], v[152:155], v[16:31]
    ds_read_b32 v79, v8 offset:25984
    ds_read_b64_tr_b16 v[112:113], v80 offset:0
    ds_read_b64_tr_b16 v[114:115], v80 offset:1024
    buffer_load_dwordx4 v[136:139], v78, s[40:43], s48 offen offset:0 sc1
    v_mfma_f32_32x32x16_bf16 v[32:47], v[124:127], v[152:155], v[32:47]
    ds_read_b64_tr_b16 v[116:117], v81 offset:0
    ds_read_b64_tr_b16 v[118:119], v81 offset:1024
    s_waitcnt vmcnt(11) lgkmcnt(4)
    v_mfma_f32_32x32x16_bf16 v[16:31], v[104:107], v[156:159], v[16:31]
    ds_read_b64_tr_b16 v[120:121], v80 offset:2048
    ds_read_b64_tr_b16 v[122:123], v80 offset:3072
    buffer_load_dwordx4 v[140:143], v78, s[40:43], s48 offen offset:2048 sc1
    v_mfma_f32_32x32x16_bf16 v[32:47], v[108:111], v[156:159], v[32:47]
    ds_read_b64_tr_b16 v[124:125], v81 offset:2048
    ds_read_b64_tr_b16 v[126:127], v81 offset:3072
    v_readfirstlane_b32 s76, v79
    s_nop 0
    s_and_b32 s76, s76, s52
    s_cbranch_scc0 L_tr13
L_bk13:
    s_ff1_i32_b32 s76, s76
    s_bitset0_b32 s52, s76
    s_add_u32 s77, s76, s65
    s_and_b32 s77, s77, 15
    s_mul_i32 s77, s77, 32768
    s_add_u32 s49, s77, s80
    s_waitcnt vmcnt(11) lgkmcnt(4)
    v_mfma_f32_32x32x16_bf16 v[16:31], v[112:115], v[160:163], v[16:31]
    ds_read_b64_tr_b16 v[104:105], v80 offset:4096
    ds_read_b64_tr_b16 v[106:107], v80 offset:5120
    buffer_load_dwordx4 v[144:147], v14, s[40:43], s49 offen offset:0 sc1
    s_add_u32 s76, s76, 3
    s_and_b32 s76, s76, 15
    s_lshl_b32 s17, s76, 13
    v_mfma_f32_32x32x16_bf16 v[32:47], v[116:119], v[160:163], v[32:47]
    ds_read_b64_tr_b16 v[108:109], v81 offset:4096
    ds_read_b64_tr_b16 v[110:111], v81 offset:5120
    s_waitcnt vmcnt(11) lgkmcnt(4)
    v_mfma_f32_32x32x16_bf16 v[16:31], v[120:123], v[164:167], v[16:31]
    ds_read_b64_tr_b16 v[112:113], v80 offset:6144
    ds_read_b64_tr_b16 v[114:115], v80 offset:7168
    buffer_load_dwordx4 v[148:151], v14, s[40:43], s49 offen offset:2048 sc1
    v_mfma_f32_32x32x16_bf16 v[32:47], v[124:127], v[164:167], v[32:47]
    ds_read_b64_tr_b16 v[116:117], v81 offset:6144
    ds_read_b64_tr_b16 v[118:119], v81 offset:7168
    v_add_u32 v82, s15, v72
    v_add_u32 v83, s15, v73
    s_waitcnt vmcnt(11) lgkmcnt(4)
    v_mfma_f32_32x32x16_bf16 v[16:31], v[104:107], v[168:171], v[16:31]
    ds_read_b32 v79, v8 offset:25984
    ds_read_b64_tr_b16 v[120:121], v82 offset:0
    ds_read_b64_tr_b16 v[122:123], v82 offset:1024
    buffer_load_dwordx4 v[152:155], v78, s[40:43], s49 offen offset:0 sc1
    v_mfma_f32_32x32x16_bf16 v[32:47], v[108:111], v[168:171], v[32:47]
    ds_read_b64_tr_b16 v[124:125], v83 offset:0
    ds_read_b64_tr_b16 v[126:127], v83 offset:1024
    s_waitcnt vmcnt(11) lgkmcnt(4)
    v_mfma_f32_32x32x16_bf16 v[16:31], v[112:115], v[172:175], v[16:31]
    ds_read_b64_tr_b16 v[104:105], v82 offset:2048
    ds_read_b64_tr_b16 v[106:107], v82 offset:3072
    buffer_load_dwordx4 v[156:159], v78, s[40:43], s49 offen offset:2048 sc1
    v_mfma_f32_32x32x16_bf16 v[32:47], v[116:119], v[172:175], v[32:47]
    ds_read_b64_tr_b16 v[108:109], v83 offset:2048
    ds_read_b64_tr_b16 v[110:111], v83 offset:3072
    v_readfirstlane_b32 s76, v79
    s_nop 0
    s_and_b32 s76, s76, s52
    s_cbranch_scc0 L_tr14
L_bk14:
    s_ff1_i32_b32 s76, s76
    s_bitset0_b32 s52, s76
    s_add_u32 s77, s76, s65
    s_and_b32 s77, s77, 15
    s_mul_i32 s77, s77, 32768
    s_add_u32 s50, s77, s80
    s_waitcnt vmcnt(11) lgkmcnt(4)
    v_mfma_f32_32x32x16_bf16 v[16:31], v[120:123], v[176:179], v[16:31]
    ds_read_b64_tr_b16 v[112:113], v82 offset:4096
    ds_read_b64_tr_b16 v[114:115], v82 offset:5120
    buffer_load_dwordx4 v[160:163], v14, s[40:43], s50 offen offset:0 sc1
    s_add_u32 s76, s76, 3
    s_and_b32 s76, s76, 15
    s_lshl_b32 s18, s76, 13
    v_mfma_f32_32x32x16_bf16 v[32:47], v[124:127], v[176:179], v[32:47]
    ds_read_b64_tr_b16 v[116:117], v83 offset:4096
    ds_read_b64_tr_b16 v[118:119], v83 offset:5120
    s_waitcnt vmcnt(11) lgkmcnt(4)
    v_mfma_f32_32x32x16_bf16 v[16:31], v[104:107], v[180:183], v[16:31]
    ds_read_b64_tr_b16 v[120:121], v82 offset:6144
    ds_read_b64_tr_b16 v[122:123], v82 offset:7168
    buffer_load_dwordx4 v[164:167], v14, s[40:43], s50 offen offset:2048 sc1
    v_mfma_f32_32x32x16_bf16 v[32:47], v[108:111], v[180:183], v[32:47]
    ds_read_b64_tr_b16 v[124:125], v83 offset:6144
    ds_read_b64_tr_b16 v[126:127], v83 offset:7168
    v_add_u32 v80, s16, v72
    v_add_u32 v81, s16, v73
    s_waitcnt vmcnt(11) lgkmcnt(4)
    v_mfma_f32_32x32x16_bf16 v[16:31], v[112:115], v[184:187], v[16:31]
    ds_read_b32 v79, v8 offset:25984
    ds_read_b64_tr_b16 v[104:105], v80 offset:0
    ds_read_b64_tr_b16 v[106:107], v80 offset:1024
    buffer_load_dwordx4 v[168:171], v78, s[40:43], s50 offen offset:0 sc1
    v_mfma_f32_32x32x16_bf16 v[32:47], v[116:119], v[184:187], v[32:47]
    ds_read_b64_tr_b16 v[108:109], v81 offset:0
    ds_read_b64_tr_b16 v[110:111], v81 offset:1024
    s_waitcnt vmcnt(11) lgkmcnt(4)
    v_mfma_f32_32x32x16_bf16 v[16:31], v[120:123], v[188:191], v[16:31]
    ds_read_b64_tr_b16 v[112:113], v80 offset:2048
    ds_read_b64_tr_b16 v[114:115], v80 offset:3072
    buffer_load_dwordx4 v[172:175], v78, s[40:43], s50 offen offset:2048 sc1
    v_mfma_f32_32x32x16_bf16 v[32:47], v[124:127], v[188:191], v[32:47]
    ds_read_b64_tr_b16 v[116:117], v81 offset:2048
    ds_read_b64_tr_b16 v[118:119], v81 offset:3072
    v_readfirstlane_b32 s76, v79
    s_nop 0
    s_and_b32 s76, s76, s52
    s_cbranch_scc0 L_tr15
L_bk15:
    s_ff1_i32_b32 s76, s76
    s_bitset0_b32 s52, s76
    s_add_u32 s77, s76, s65
    s_and_b32 s77, s77, 15
    s_mul_i32 s77, s77, 32768
    s_add_u32 s51, s77, s80
    s_waitcnt vmcnt(11) lgkmcnt(4)
    v_mfma_f32_32x32x16_bf16 v[16:31], v[104:107], v[128:131], v[16:31]
    ds_read_b64_tr_b16 v[120:121], v80 offset:4096
    ds_read_b64_tr_b16 v[122:123], v80 offset:5120
    buffer_load_dwordx4 v[176:179], v14, s[40:43], s51 offen offset:0 sc1
    s_add_u32 s76, s76, 3
    s_and_b32 s76, s76, 15
    s_lshl_b32 s19, s76, 13
    v_mfma_f32_32x32x16_bf16 v[32:47], v[108:111], v[128:131], v[32:47]
    ds_read_b64_tr_b16 v[124:125], v81 offset:4096
    ds_read_b64_tr_b16 v[126:127], v81 offset:5120
    s_waitcnt vmcnt(11) lgkmcnt(4)
    v_mfma_f32_32x32x16_bf16 v[16:31], v[112:115], v[132:135], v[16:31]
    ds_read_b64_tr_b16 v[104:105], v80 offset:6144
    ds_read_b64_tr_b16 v[106:107], v80 offset:7168
    buffer_load_dwordx4 v[180:183], v14, s[40:43], s51 offen offset:2048 sc1
    v_mfma_f32_32x32x16_bf16 v[32:47], v[116:119], v[132:135], v[32:47]
    ds_read_b64_tr_b16 v[108:109], v81 offset:6144
    ds_read_b64_tr_b16 v[110:111], v81 offset:7168
    v_add_u32 v82, s17, v72
    v_add_u32 v83, s17, v73
    s_waitcnt vmcnt(11) lgkmcnt(4)
    v_mfma_f32_32x32x16_bf16 v[16:31], v[120:123], v[136:139], v[16:31]
    ds_read_b64 v[192:193], v10 offset:16384
    ds_read_b64_tr_b16 v[112:113], v82 offset:0
    ds_read_b64_tr_b16 v[114:115], v82 offset:1024
    buffer_load_dwordx4 v[184:187], v78, s[40:43], s51 offen offset:0 sc1
    v_mfma_f32_32x32x16_bf16 v[32:47], v[124:127], v[136:139], v[32:47]
    ds_read_b64_tr_b16 v[116:117], v83 offset:0
    ds_read_b64_tr_b16 v[118:119], v83 offset:1024
    s_waitcnt vmcnt(11) lgkmcnt(4)
    v_mfma_f32_32x32x16_bf16 v[16:31], v[104:107], v[140:143], v[16:31]
    ds_read_b64 v[194:195], v10 offset:16400
    ds_read_b64_tr_b16 v[120:121], v82 offset:2048
    ds_read_b64_tr_b16 v[122:123], v82 offset:3072
    buffer_load_dwordx4 v[188:191], v78, s[40:43], s51 offen offset:2048 sc1
    s_barrier
    v_mfma_f32_32x32x16_bf16 v[32:47], v[108:111], v[140:143], v[32:47]
    ds_read_b64_tr_b16 v[124:125], v83 offset:2048
    ds_read_b64_tr_b16 v[126:127], v83 offset:3072
    s_waitcnt vmcnt(11) lgkmcnt(4)
    v_mfma_f32_32x32x16_bf16 v[16:31], v[112:115], v[144:147], v[16:31]
    ds_read_b64 v[196:197], v10 offset:16416
    ds_read_b64_tr_b16 v[104:105], v82 offset:4096
    ds_read_b64_tr_b16 v[106:107], v82 offset:5120
    v_mfma_f32_32x32x16_bf16 v[32:47], v[116:119], v[144:147], v[32:47]
    ds_read_b64_tr_b16 v[108:109], v83 offset:4096
    ds_read_b64_tr_b16 v[110:111], v83 offset:5120
    s_waitcnt vmcnt(10) lgkmcnt(4)
    v_mfma_f32_32x32x16_bf16 v[16:31], v[120:123], v[148:151], v[16:31]
    ds_read_b64 v[198:199], v10 offset:16432
    ds_read_b64_tr_b16 v[112:113], v82 offset:6144
    ds_read_b64_tr_b16 v[114:115], v82 offset:7168
    v_mfma_f32_32x32x16_bf16 v[32:47], v[124:127], v[148:151], v[32:47]
    ds_read_b64_tr_b16 v[116:117], v83 offset:6144
    ds_read_b64_tr_b16 v[118:119], v83 offset:7168
    v_add_u32 v80, s18, v72
    v_add_u32_e64 v81, s18, v73
    s_waitcnt vmcnt(9) lgkmcnt(4)
    v_mfma_f32_32x32x16_bf16 v[16:31], v[104:107], v[152:155], v[16:31]
    ds_read_b64 v[200:201], v10 offset:16448
    ds_read_b64_tr_b16 v[120:121], v80 offset:0
    ds_read_b64_tr_b16 v[122:123], v80 offset:1024
    v_mfma_f32_32x32x16_bf16 v[32:47], v[108:111], v[152:155], v[32:47]
    ds_read_b64_tr_b16 v[124:125], v81 offset:0
    ds_read_b64_tr_b16 v[126:127], v81 offset:1024
    s_waitcnt vmcnt(8) lgkmcnt(4)
    v_mfma_f32_32x32x16_bf16 v[16:31], v[112:115], v[156:159], v[16:31]
    ds_read_b64 v[202:203], v10 offset:16464
    ds_read_b64_tr_b16 v[104:105], v80 offset:2048
    ds_read_b64_tr_b16 v[106:107], v80 offset:3072
    v_mfma_f32_32x32x16_bf16 v[32:47], v[116:119], v[156:159], v[32:47]
    ds_read_b64_tr_b16 v[108:109], v81 offset:2048
    ds_read_b64_tr_b16 v[110:111], v81 offset:3072
    s_waitcnt vmcnt(7) lgkmcnt(4)
    v_mfma_f32_32x32x16_bf16 v[16:31], v[120:123], v[160:163], v[16:31]
    ds_read_b64 v[204:205], v10 offset:16480
    ds_read_b64_tr_b16 v[112:113], v80 offset:4096
    ds_read_b64_tr_b16 v[114:115], v80 offset:5120
    v_mfma_f32_32x32x16_bf16 v[32:47], v[124:127], v[160:163], v[32:47]
    ds_read_b64_tr_b16 v[116:117], v81 offset:4096
    ds_read_b64_tr_b16 v[118:119], v81 offset:5120
    s_waitcnt vmcnt(6) lgkmcnt(4)
    v_mfma_f32_32x32x16_bf16 v[16:31], v[104:107], v[164:167], v[16:31]
    ds_read_b64 v[206:207], v10 offset:16496
    ds_read_b64_tr_b16 v[120:121], v80 offset:6144
    ds_read_b64_tr_b16 v[122:123], v80 offset:7168
    v_mfma_f32_32x32x16_bf16 v[32:47], v[108:111], v[164:167], v[32:47]
    ds_read_b64_tr_b16 v[124:125], v81 offset:6144
    ds_read_b64_tr_b16 v[126:127], v81 offset:7168
    v_add_u32 v82, s19, v72
    v_add_u32 v83, s19, v73
    s_waitcnt vmcnt(5) lgkmcnt(4)
    v_mfma_f32_32x32x16_bf16 v[16:31], v[112:115], v[168:171], v[16:31]
    ds_read_b128 v[208:211], v11 offset:16384
    ds_read_b64_tr_b16 v[104:105], v82 offset:0
    ds_read_b64_tr_b16 v[106:107], v82 offset:1024
    v_mfma_f32_32x32x16_bf16 v[32:47], v[116:119], v[168:171], v[32:47]
    ds_read_b64_tr_b16 v[108:109], v83 offset:0
    ds_read_b64_tr_b16 v[110:111], v83 offset:1024
    s_waitcnt vmcnt(4) lgkmcnt(4)
    v_mfma_f32_32x32x16_bf16 v[16:31], v[120:123], v[172:175], v[16:31]
    ds_read_b128 v[212:215], v11 offset:16400
    ds_read_b64_tr_b16 v[112:113], v82 offset:2048
    ds_read_b64_tr_b16 v[114:115], v82 offset:3072
    v_mfma_f32_32x32x16_bf16 v[32:47], v[124:127], v[172:175], v[32:47]
    ds_read_b64_tr_b16 v[116:117], v83 offset:2048
    ds_read_b64_tr_b16 v[118:119], v83 offset:3072
    s_waitcnt vmcnt(3) lgkmcnt(4)
    v_mfma_f32_32x32x16_bf16 v[16:31], v[104:107], v[176:179], v[16:31]
    ds_read_b64_tr_b16 v[120:121], v82 offset:4096
    ds_read_b64_tr_b16 v[122:123], v82 offset:5120
    v_mfma_f32_32x32x16_bf16 v[32:47], v[108:111], v[176:179], v[32:47]
    ds_read_b64_tr_b16 v[124:125], v83 offset:4096
    ds_read_b64_tr_b16 v[126:127], v83 offset:5120
    s_waitcnt vmcnt(2) lgkmcnt(4)
    v_mfma_f32_32x32x16_bf16 v[16:31], v[112:115], v[180:183], v[16:31]
    ds_read_b64_tr_b16 v[104:105], v82 offset:6144
    ds_read_b64_tr_b16 v[106:107], v82 offset:7168
    v_mfma_f32_32x32x16_bf16 v[32:47], v[116:119], v[180:183], v[32:47]
    ds_read_b64_tr_b16 v[108:109], v83 offset:6144
    ds_read_b64_tr_b16 v[110:111], v83 offset:7168
    s_waitcnt vmcnt(1) lgkmcnt(4)
    v_mfma_f32_32x32x16_bf16 v[16:31], v[120:123], v[184:187], v[16:31]
    v_mfma_f32_32x32x16_bf16 v[32:47], v[124:127], v[184:187], v[32:47]
    s_waitcnt vmcnt(0) lgkmcnt(0)
    v_mfma_f32_32x32x16_bf16 v[16:31], v[104:107], v[188:191], v[16:31]
    v_mfma_f32_32x32x16_bf16 v[32:47], v[108:111], v[188:191], v[32:47]
    s_nop 10
    v_cvt_pk_bf16_f32 v88, v16, v17
    v_cvt_pk_bf16_f32 v89, v18, v19
    v_cvt_pk_bf16_f32 v90, v20, v21
    v_cvt_pk_bf16_f32 v91, v22, v23
    v_cvt_pk_bf16_f32 v92, v24, v25
    v_cvt_pk_bf16_f32 v93, v26, v27
    v_cvt_pk_bf16_f32 v94, v28, v29
    v_cvt_pk_bf16_f32 v95, v30, v31
    v_cvt_pk_bf16_f32 v96, v32, v33
    v_cvt_pk_bf16_f32 v97, v34, v35
    v_cvt_pk_bf16_f32 v98, v36, v37
    v_cvt_pk_bf16_f32 v99, v38, v39
    v_cvt_pk_bf16_f32 v100, v40, v41
    v_cvt_pk_bf16_f32 v101, v42, v43
    v_cvt_pk_bf16_f32 v102, v44, v45
    v_cvt_pk_bf16_f32 v103, v46, v47
    v_dot2_f32_bf16 v104, v88, s89, 0
    v_dot2_f32_bf16 v105, v88, v88, 0
    v_dot2_f32_bf16 v106, v88, v192, 0
    v_dot2_f32_bf16 v104, v89, s89, v104
    v_dot2_f32_bf16 v105, v89, v89, v105
    v_dot2_f32_bf16 v106, v89, v193, v106
    v_dot2_f32_bf16 v104, v90, s89, v104
    v_dot2_f32_bf16 v105, v90, v90, v105
    v_dot2_f32_bf16 v106, v90, v194, v106
    v_dot2_f32_bf16 v104, v91, s89, v104
    v_dot2_f32_bf16 v105, v91, v91, v105
    v_dot2_f32_bf16 v106, v91, v195, v106
    v_dot2_f32_bf16 v104, v92, s89, v104
    v_dot2_f32_bf16 v105, v92, v92, v105
    v_dot2_f32_bf16 v106, v92, v196, v106
    v_dot2_f32_bf16 v104, v93, s89, v104
    v_dot2_f32_bf16 v105, v93, v93, v105
    v_dot2_f32_bf16 v106, v93, v197, v106
    v_dot2_f32_bf16 v104, v94, s89, v104
    v_dot2_f32_bf16 v105, v94, v94, v105
    v_dot2_f32_bf16 v106, v94, v198, v106
    v_dot2_f32_bf16 v104, v95, s89, v104
    v_dot2_f32_bf16 v105, v95, v95, v105
    v_dot2_f32_bf16 v106, v95, v199, v106
    v_dot2_f32_bf16 v104, v96, s89, v104
    v_dot2_f32_bf16 v105, v96, v96, v105
    v_dot2_f32_bf16 v106, v96, v200, v106
    v_dot2_f32_bf16 v104, v97, s89, v104
    v_dot2_f32_bf16 v105, v97, v97, v105
    v_dot2_f32_bf16 v106, v97, v201, v106
    v_dot2_f32_bf16 v104, v98, s89, v104
    v_dot2_f32_bf16 v105, v98, v98, v105
    v_dot2_f32_bf16 v106, v98, v202, v106
    v_dot2_f32_bf16 v104, v99, s89, v104
    v_dot2_f32_bf16 v105, v99, v99, v105
    v_dot2_f32_bf16 v106, v99, v203, v106
    v_dot2_f32_bf16 v104, v100, s89, v104
    v_dot2_f32_bf16 v105, v100, v100, v105
    v_dot2_f32_bf16 v106, v100, v204, v106
    v_dot2_f32_bf16 v104, v101, s89, v104
    v_dot2_f32_bf16 v105, v101, v101, v105
    v_dot2_f32_bf16 v106, v101, v205, v106
    v_dot2_f32_bf16 v104, v102, s89, v104
    v_dot2_f32_bf16 v105, v102, v102, v105
    v_dot2_f32_bf16 v106, v102, v206, v106
    v_dot2_f32_bf16 v104, v103, s89, v104
    v_dot2_f32_bf16 v105, v103, v103, v105
    v_dot2_f32_bf16 v106, v103, v207, v106
    s_lshl_b32 s76, s62, 9
    s_add_u32 s77, s76, s99
    v_mov_b32 v107, 0
    v_mov_b32 v4, v104
    v_mov_b32 v5, v105
    v_mov_b32 v6, v106
    v_permlane32_swap_b32 v104, v4
    v_permlane32_swap_b32 v105, v5
    v_permlane32_swap_b32 v106, v6
    v_add_f32 v104, v104, v4
    v_add_f32 v105, v105, v5
    v_add_f32_e64 v106, v106, v6
    s_mov_b32 exec_hi, 0
    s_bitcmp1_b32 s100, 1
    s_cbranch_scc1 L_loc_70
    buffer_store_dwordx4 v[104:107], v12, s[40:43], s77 offen offset:1024 sc1
    s_branch L_pubd_71
L_loc_70:
    buffer_store_dwordx4 v[104:107], v12, s[40:43], s77 offen offset:1024
L_pubd_71:
    s_mov_b64 exec, -1
    ds_write_b64 v64, v[88:89]
    ds_write_b64 v65, v[90:91]
    ds_write_b64 v66, v[92:93]
    ds_write_b64 v67, v[94:95]
    ds_write_b64 v68, v[96:97]
    ds_write_b64 v69, v[98:99]
    ds_write_b64 v70, v[100:101]
    ds_write_b64 v71, v[102:103]
    v_bfe_u32 v4, v1, 1, 3
    v_bfe_u32 v5, v1, 4, 1
    v_lshlrev_b32_e64 v176, 4, v4
    v_lshl_add_u32 v176, v5, 3, v176
    v_and_b32_e64 v5, 1, v1
    v_lshl_add_u32 v176, v5, 2, v176
    v_lshlrev_b32_e64 v177, 2, v2
    v_lshl_add_u32 v177, v3, 8, v177
    v_and_b32 v4, 15, v1
    v_lshrrev_b32 v5, 4, v1
    v_mul_u32_u24 v179, 149504, v4
    v_lshl_add_u32 v180, v5, 4, v179
    s_lshl_b32 s82, s97, 7
    s_lshl_b32 s79, s62, 5
    s_add_u32 s82, s82, s79
    s_lshl_b32 s79, s62, 2
    v_mov_b32_e64 v7, s79
    v_mul_u32_u24 v178, 9344, v3
    v_lshl_add_u32 v178, v2, 4, v178
    s_mul_i32 s78, s97, 149504
    s_add_u32 s78, s78, s76
    s_add_u32 s78, s78, 8388608
    s_add_u32 s48, s78, 18688
    s_add_u32 s49, s48, 18688
    s_add_u32 s50, s49, 18688
    s_add_u32 s51, s50, 18688
    s_add_u32 s52, s51, 18688
    s_add_u32 s53, s52, 18688
    s_add_u32 s54, s53, 18688
    buffer_load_dwordx4 v[112:115], v178, s[40:43], s78 offen offset:1024 sc1
    buffer_load_dwordx4 v[116:119], v178, s[40:43], s48 offen offset:1024 sc1
    buffer_load_dwordx4 v[120:123], v178, s[40:43], s49 offen offset:1024 sc1
    buffer_load_dwordx4 v[124:127], v178, s[40:43], s50 offen offset:1024 sc1
    buffer_load_dwordx4 v[128:131], v178, s[40:43], s51 offen offset:1024 sc1
    buffer_load_dwordx4 v[132:135], v178, s[40:43], s52 offen offset:1024 sc1
    buffer_load_dwordx4 v[136:139], v178, s[40:43], s53 offen offset:1024 sc1
    buffer_load_dwordx4 v[140:143], v178, s[40:43], s54 offen offset:1024 sc1
    v_dot2_f32_bf16 v76, v208, s89, 0
    v_dot2_f32_bf16 v76, v209, s89, v76
    v_dot2_f32_bf16 v76, v210, s89, v76
    v_dot2_f32_bf16 v76, v211, s89, v76
    v_dot2_f32_bf16 v76, v212, s89, v76
    v_dot2_f32_bf16 v76, v213, s89, v76
    v_dot2_f32_bf16 v76, v214, s89, v76
    v_dot2_f32_bf16 v76, v215, s89, v76
    s_nop 2
    v_add_f32_dpp v76, v76, v76 row_ror:8 row_mask:0xf bank_mask:0xf
    s_nop 1
    v_add_f32_dpp v76, v76, v76 row_ror:4 row_mask:0xf bank_mask:0xf
    s_nop 1
    v_add_f32_dpp v76, v76, v76 row_ror:2 row_mask:0xf bank_mask:0xf
    s_nop 1
    v_add_f32_dpp v76, v76, v76 row_ror:1 row_mask:0xf bank_mask:0xf
    v_mov_b32 v4, v76
    s_nop 1
    v_permlane16_swap_b32 v76, v4
    v_add_f32 v76, v76, v4
    v_mov_b32 v4, v76
    s_nop 1
    v_permlane32_swap_b32 v76, v4
    v_add_f32_e64 v76, v76, v4
    s_mov_b32 s88, 0
    s_waitcnt vmcnt(6)
    v_pk_add_f32 v[108:109], v[112:113], v[116:117]
    v_pk_add_f32 v[110:111], v[114:115], v[118:119]
    s_waitcnt vmcnt(5)
    v_pk_add_f32 v[108:109], v[108:109], v[120:121]
    v_pk_add_f32 v[110:111], v[110:111], v[122:123]
    s_waitcnt vmcnt(4)
    v_pk_add_f32 v[108:109], v[108:109], v[124:125]
    v_pk_add_f32 v[110:111], v[110:111], v[126:127]
    s_waitcnt vmcnt(3)
    v_pk_add_f32 v[108:109], v[108:109], v[128:129]
    v_pk_add_f32 v[110:111], v[110:111], v[130:131]
    s_waitcnt vmcnt(2)
    v_pk_add_f32 v[108:109], v[108:109], v[132:133]
    v_pk_add_f32 v[110:111], v[110:111], v[134:135]
    s_waitcnt vmcnt(1)
    v_pk_add_f32 v[108:109], v[108:109], v[136:137]
    v_pk_add_f32 v[110:111], v[110:111], v[138:139]
    s_waitcnt vmcnt(0)
    v_pk_add_f32 v[108:109], v[108:109], v[140:141]
    v_pk_add_f32 v[110:111], v[110:111], v[142:143]
    v_cmp_u_f32 vcc, v111, v111
    v_mov_b32 v4, v108
    v_mov_b32 v5, v109
    v_mov_b32 v6, v110
    s_cbranch_vccnz L_s3_73
L_s3ok_74:
    v_permlane32_swap_b32 v108, v4
    v_permlane32_swap_b32 v109, v5
    v_permlane32_swap_b32 v110, v6
    s_barrier
    v_add_f32 v108, v108, v4
    v_add_f32 v109, v109, v5
    v_add_f32 v110, v110, v6
    v_mul_f32 v108, 0x3a800000, v108
    v_mul_f32 v109, 0x3a800000, v109
    v_fma_f32 v4, -v108, v108, v109
    v_max_f32_e64 v4, 0, v4
    v_cvt_pk_bf16_f32 v116, v108, v108
    v_and_b32_e64 v116, s90, v116
    v_cvt_pk_bf16_f32 v4, v4, v4
    v_and_b32_e64 v4, s90, v4
    v_add_f32 v4, 0x3727c5ac, v4
    v_cvt_pk_bf16_f32 v4, v4, v4
    v_and_b32 v4, s90, v4
    v_sqrt_f32_e64 v4, v4
    s_nop 0
    v_cvt_pk_bf16_f32 v4, v4, v4
    v_and_b32 v4, s90, v4
    v_rcp_f32 v118, v4
    v_fma_f32 v120, -v116, v76, v110
    v_mul_f32 v119, v116, v118
    v_mul_f32 v120, v120, v118
    v_and_b32 v6, 3, v1
    v_lshlrev_b32 v6, 2, v6
    v_max_f32_dpp v4, v120, v120 row_ror:8 row_mask:0xf bank_mask:0xf
    s_lshl_b32 s83, s62, 12
    v_cmp_gt_u32 s[84:85], 32, v1
    v_max_f32_dpp v4, v4, v4 row_ror:4 row_mask:0xf bank_mask:0xf
    s_lshl_b32 s55, 1, s62
    s_sub_u32 s55, s55, 1
    v_max_f32_dpp v4, v4, v4 row_ror:2 row_mask:0xf bank_mask:0xf
    s_nop 1
    v_max_f32_dpp v4, v4, v4 row_ror:1 row_mask:0xf bank_mask:0xf
    v_mov_b32 v5, v4
    s_nop 1
    v_permlane16_swap_b32 v4, v5
    v_max_f32 v4, v4, v5
    v_cmp_eq_f32_e64 vcc, v4, v120
    ds_write_b32 v7, v4 offset:25600
    s_ff1_i32_b32 s77, vcc_lo
    s_and_b32 s77, s77, 31
    s_bfe_u32 s79, s77, 0x30001
    s_lshl3_add_u32 s79, s77, s79
    s_lshl4_add_u32 s79, s79, s83
    v_xor_b32_e64 v176, s79, v176
    ds_read_b32 v182, v176 offset:0
    s_waitcnt lgkmcnt(1)
    s_barrier
    ds_read_b32 v8, v6 offset:25600
    v_readlane_b32 s80, v118, s77
    v_readlane_b32 s81, v119, s77
    s_add_u32 s79, s82, s77
    v_writelane_b32 v4, s79, 33
    v_mov_b32 v5, s81
    s_waitcnt lgkmcnt(1)
    v_lshlrev_b32 v184, 16, v182
    v_and_b32_e64 v185, s90, v182
    v_fma_f32 v184, v184, s80, -v5
    v_fma_f32 v185, v185, s80, -v5
    v_cvt_pk_bf16_f32 v184, v184, v185
    v_cndmask_b32 v184, v4, v184, s[84:85]
    s_waitcnt lgkmcnt(0)
    v_cmp_eq_f32 s[56:57], v8, v4
    v_cmp_gt_f32 vcc, v8, v4
    s_and_b32 s56, s56, s55
    s_or_b32 s56, s56, vcc_lo
    s_cbranch_scc1 L_nopub_83
    buffer_store_dword v184, v177, s[40:43], s99 offen offset:0 sc1
L_nopub_83:
    v_lshlrev_b32 v16, 16, v88
    v_and_b32_e64 v17, s90, v88
    v_pk_fma_f32 v[144:145], v[16:17], v[118:119], v[118:119] op_sel:[0,0,1] op_sel_hi:[1,0,1] neg_lo:[0,0,1] neg_hi:[0,0,1]
    v_cvt_pk_bf16_f32 v124, v144, v145
    v_lshlrev_b32 v144, 16, v124
    v_and_b32 v145, s90, v124
    v_pk_add_f32 v[144:145], v[144:145], v[16:17]
    v_cvt_pk_bf16_f32 v124, v144, v145
    v_lshlrev_b32 v18, 16, v89
    v_and_b32 v19, s90, v89
    v_pk_fma_f32 v[146:147], v[18:19], v[118:119], v[118:119] op_sel:[0,0,1] op_sel_hi:[1,0,1] neg_lo:[0,0,1] neg_hi:[0,0,1]
    v_cvt_pk_bf16_f32 v125, v146, v147
    v_lshlrev_b32 v146, 16, v125
    v_and_b32 v147, s90, v125
    v_pk_add_f32 v[146:147], v[146:147], v[18:19]
    v_cvt_pk_bf16_f32 v125, v146, v147
    ds_write_b64 v64, v[124:125]
    v_lshlrev_b32 v20, 16, v90
    v_and_b32 v21, s90, v90
    v_pk_fma_f32 v[148:149], v[20:21], v[118:119], v[118:119] op_sel:[0,0,1] op_sel_hi:[1,0,1] neg_lo:[0,0,1] neg_hi:[0,0,1]
    v_cvt_pk_bf16_f32 v126, v148, v149
    v_lshlrev_b32 v148, 16, v126
    v_and_b32 v149, s90, v126
    v_pk_add_f32 v[148:149], v[148:149], v[20:21]
    v_cvt_pk_bf16_f32 v126, v148, v149
    v_lshlrev_b32 v22, 16, v91
    v_and_b32 v23, s90, v91
    v_pk_fma_f32 v[150:151], v[22:23], v[118:119], v[118:119] op_sel:[0,0,1] op_sel_hi:[1,0,1] neg_lo:[0,0,1] neg_hi:[0,0,1]
    v_cvt_pk_bf16_f32 v127, v150, v151
    v_lshlrev_b32 v150, 16, v127
    v_and_b32 v151, s90, v127
    v_pk_add_f32 v[150:151], v[150:151], v[22:23]
    v_cvt_pk_bf16_f32 v127, v150, v151
    ds_write_b64 v65, v[126:127]
    s_cmp_eq_u32 s56, 0
    s_cbranch_scc1 L_stay_84
    s_cmp_gt_u32 s62, 1
    s_cbranch_scc0 L_stay_84
    s_mov_b32 s91, -1
    v_lshlrev_b32 v24, 16, v92
    v_and_b32_e64 v25, s90, v92
    v_pk_fma_f32 v[152:153], v[24:25], v[118:119], v[118:119] op_sel:[0,0,1] op_sel_hi:[1,0,1] neg_lo:[0,0,1] neg_hi:[0,0,1]
    v_cvt_pk_bf16_f32 v128, v152, v153
    v_lshlrev_b32 v152, 16, v128
    v_and_b32 v153, s90, v128
    v_pk_add_f32 v[152:153], v[152:153], v[24:25]
    v_cvt_pk_bf16_f32 v128, v152, v153
    v_lshlrev_b32 v26, 16, v93
    v_and_b32 v27, s90, v93
    v_pk_fma_f32 v[154:155], v[26:27], v[118:119], v[118:119] op_sel:[0,0,1] op_sel_hi:[1,0,1] neg_lo:[0,0,1] neg_hi:[0,0,1]
    v_cvt_pk_bf16_f32 v129, v154, v155
    v_lshlrev_b32 v154, 16, v129
    v_and_b32 v155, s90, v129
    v_pk_add_f32 v[154:155], v[154:155], v[26:27]
    v_cvt_pk_bf16_f32 v129, v154, v155
    ds_write_b64 v66, v[128:129]
    v_lshlrev_b32 v28, 16, v94
    v_and_b32 v29, s90, v94
    v_pk_fma_f32 v[156:157], v[28:29], v[118:119], v[118:119] op_sel:[0,0,1] op_sel_hi:[1,0,1] neg_lo:[0,0,1] neg_hi:[0,0,1]
    v_cvt_pk_bf16_f32 v130, v156, v157
    v_lshlrev_b32 v156, 16, v130
    v_and_b32 v157, s90, v130
    v_pk_add_f32 v[156:157], v[156:157], v[28:29]
    v_cvt_pk_bf16_f32 v130, v156, v157
    v_lshlrev_b32 v30, 16, v95
    v_and_b32 v31, s90, v95
    v_pk_fma_f32 v[158:159], v[30:31], v[118:119], v[118:119] op_sel:[0,0,1] op_sel_hi:[1,0,1] neg_lo:[0,0,1] neg_hi:[0,0,1]
    v_cvt_pk_bf16_f32 v131, v158, v159
    v_lshlrev_b32 v158, 16, v131
    v_and_b32 v159, s90, v131
    v_pk_add_f32 v[158:159], v[158:159], v[30:31]
    v_cvt_pk_bf16_f32 v131, v158, v159
    ds_write_b64 v67, v[130:131]
    v_lshlrev_b32 v32, 16, v96
    v_and_b32 v33, s90, v96
    v_pk_fma_f32 v[160:161], v[32:33], v[118:119], v[118:119] op_sel:[0,0,1] op_sel_hi:[1,0,1] neg_lo:[0,0,1] neg_hi:[0,0,1]
    v_cvt_pk_bf16_f32 v132, v160, v161
    v_lshlrev_b32 v160, 16, v132
    v_and_b32 v161, s90, v132
    v_pk_add_f32 v[160:161], v[160:161], v[32:33]
    v_cvt_pk_bf16_f32 v132, v160, v161
    v_lshlrev_b32 v34, 16, v97
    v_and_b32 v35, s90, v97
    v_pk_fma_f32 v[162:163], v[34:35], v[118:119], v[118:119] op_sel:[0,0,1] op_sel_hi:[1,0,1] neg_lo:[0,0,1] neg_hi:[0,0,1]
    v_cvt_pk_bf16_f32 v133, v162, v163
    v_lshlrev_b32 v162, 16, v133
    v_and_b32 v163, s90, v133
    v_pk_add_f32 v[162:163], v[162:163], v[34:35]
    v_cvt_pk_bf16_f32 v133, v162, v163
    ds_write_b64 v68, v[132:133]
    v_lshlrev_b32 v36, 16, v98
    v_and_b32 v37, s90, v98
    v_pk_fma_f32 v[164:165], v[36:37], v[118:119], v[118:119] op_sel:[0,0,1] op_sel_hi:[1,0,1] neg_lo:[0,0,1] neg_hi:[0,0,1]
    v_cvt_pk_bf16_f32 v134, v164, v165
    v_lshlrev_b32 v164, 16, v134
    v_and_b32 v165, s90, v134
    v_pk_add_f32 v[164:165], v[164:165], v[36:37]
    v_cvt_pk_bf16_f32 v134, v164, v165
    v_lshlrev_b32 v38, 16, v99
    v_and_b32 v39, s90, v99
    v_pk_fma_f32 v[166:167], v[38:39], v[118:119], v[118:119] op_sel:[0,0,1] op_sel_hi:[1,0,1] neg_lo:[0,0,1] neg_hi:[0,0,1]
    v_cvt_pk_bf16_f32 v135, v166, v167
    v_lshlrev_b32 v166, 16, v135
    v_and_b32 v167, s90, v135
    v_pk_add_f32 v[166:167], v[166:167], v[38:39]
    v_cvt_pk_bf16_f32 v135, v166, v167
    ds_write_b64 v69, v[134:135]
    v_lshlrev_b32 v40, 16, v100
    v_and_b32 v41, s90, v100
    v_pk_fma_f32 v[168:169], v[40:41], v[118:119], v[118:119] op_sel:[0,0,1] op_sel_hi:[1,0,1] neg_lo:[0,0,1] neg_hi:[0,0,1]
    v_cvt_pk_bf16_f32 v136, v168, v169
    v_lshlrev_b32 v168, 16, v136
    v_and_b32 v169, s90, v136
    v_pk_add_f32 v[168:169], v[168:169], v[40:41]
    v_cvt_pk_bf16_f32 v136, v168, v169
    v_lshlrev_b32 v42, 16, v101
    v_and_b32 v43, s90, v101
    v_pk_fma_f32 v[170:171], v[42:43], v[118:119], v[118:119] op_sel:[0,0,1] op_sel_hi:[1,0,1] neg_lo:[0,0,1] neg_hi:[0,0,1]
    v_cvt_pk_bf16_f32 v137, v170, v171
    v_lshlrev_b32 v170, 16, v137
    v_and_b32 v171, s90, v137
    v_pk_add_f32 v[170:171], v[170:171], v[42:43]
    v_cvt_pk_bf16_f32 v137, v170, v171
    ds_write_b64 v70, v[136:137]
    v_lshlrev_b32 v44, 16, v102
    v_and_b32 v45, s90, v102
    v_pk_fma_f32 v[172:173], v[44:45], v[118:119], v[118:119] op_sel:[0,0,1] op_sel_hi:[1,0,1] neg_lo:[0,0,1] neg_hi:[0,0,1]
    v_cvt_pk_bf16_f32 v138, v172, v173
    v_lshlrev_b32 v172, 16, v138
    v_and_b32 v173, s90, v138
    v_pk_add_f32 v[172:173], v[172:173], v[44:45]
    v_cvt_pk_bf16_f32 v138, v172, v173
    v_lshlrev_b32 v46, 16, v103
    v_and_b32 v47, s90, v103
    v_pk_fma_f32 v[174:175], v[46:47], v[118:119], v[118:119] op_sel:[0,0,1] op_sel_hi:[1,0,1] neg_lo:[0,0,1] neg_hi:[0,0,1]
    v_cvt_pk_bf16_f32 v139, v174, v175
    v_lshlrev_b32 v174, 16, v139
    v_and_b32 v175, s90, v139
    v_pk_add_f32 v[174:175], v[174:175], v[46:47]
    v_cvt_pk_bf16_f32 v139, v174, v175
    ds_write_b64 v71, v[138:139]
    s_sub_u32 s77, s91, s82
    v_lshrrev_b32 v7, 3, v1
    v_sub_u32_e64 v5, s77, v7
    v_mov_b32 v6, 2146435072
    v_and_b32 v8, 7, v1
    v_lshrrev_b32 v9, 4, v1
    v_xor_b32 v8, v8, v9
    v_lshlrev_b32 v8, 4, v8
    v_lshl_add_u32 v7, v7, 11, v8
    v_xor_b32 v8, 64, v7
    s_lshl_b32 s58, s82, 11
    s_lshl_b32 s59, s98, 7
    s_add_u32 s58, s58, s59
    v_cmp_eq_u32 vcc, 0, v5
    s_nop 1
    v_cndmask_b32 v200, v7, v6, vcc
    v_cmp_eq_u32 vcc, 8, v5
    s_nop 1
    v_cndmask_b32 v201, v8, v6, vcc
    v_cmp_eq_u32 vcc, 16, v5
    s_nop 1
    v_cndmask_b32 v202, v7, v6, vcc
    v_cmp_eq_u32 vcc, 24, v5
    s_nop 1
    v_cndmask_b32 v203, v8, v6, vcc
    s_lshl_b32 s77, s62, 12
    s_add_u32 s77, s77, 0
    v_add_u32 v4, s77, v12
    s_waitcnt lgkmcnt(0)
    ds_read_b128 v[48:51], v4 offset:0
    ds_read_b128 v[52:55], v4 offset:1024
    ds_read_b128 v[56:59], v4 offset:2048
    ds_read_b128 v[60:63], v4 offset:3072
    s_waitcnt lgkmcnt(3)
    buffer_store_dwordx4 v[48:51], v200, s[44:47], s58 offen sc1
    s_add_u32 s58, s58, 16384
    s_waitcnt lgkmcnt(2)
    buffer_store_dwordx4 v[52:55], v201, s[44:47], s58 offen sc1
    s_add_u32 s58, s58, 16384
    s_waitcnt lgkmcnt(1)
    buffer_store_dwordx4 v[56:59], v202, s[44:47], s58 offen sc1
    s_add_u32 s58, s58, 16384
    s_waitcnt lgkmcnt(0)
    buffer_store_dwordx4 v[60:63], v203, s[44:47], s58 offen sc1
    s_barrier
    s_barrier
    s_branch L_cdone
L_stay_84:
    v_and_b32 v7, 15, v1
    v_lshlrev_b32_e64 v7, 3, v7
    s_cmp_eq_u32 s62, 0
    s_cbranch_scc0 L_nos4_85
    s_mul_i32 s76, s98, 9344
    s_add_u32 s76, s76, 8388608
    s_branch L_fit_s4
.fill 13, 4, 0xbf800000
L_fit_s4:
    s_add_u32 s20, s26, s99
    s_addc_u32 s21, s27, 0
    s_mov_b32 s88, 0
L_spin_86:
    s_load_dwordx16 s[4:19], s[20:21], 768 glc
    s_waitcnt lgkmcnt(0)
    s_or_b64 s[4:5], s[4:5], s[6:7]
    s_or_b64 s[4:5], s[4:5], s[8:9]
    s_or_b64 s[4:5], s[4:5], s[10:11]
    s_or_b64 s[4:5], s[4:5], s[12:13]
    s_or_b64 s[4:5], s[4:5], s[14:15]
    s_or_b64 s[4:5], s[4:5], s[16:17]
    s_or_b64 s[4:5], s[4:5], s[18:19]
    s_cbranch_scc0 L_gate_87
    s_add_u32 s88, s88, 1
    s_cmp_lt_u32 s88, 65536
    s_cbranch_scc1 L_spin_86
L_gate_87:
    s_mov_b32 s88, 0
L_poll_88:
    buffer_load_dwordx2 v[196:197], v179, s[40:43], s76 offen offset:256 sc1
    buffer_load_dwordx4 v[188:191], v180, s[40:43], s76 offen offset:0 sc1
    buffer_load_dwordx4 v[192:195], v180, s[40:43], s76 offen offset:64 sc1
    s_waitcnt vmcnt(0)
    v_max3_u32 v4, v196, v197, v188
    v_max3_u32 v4, v4, v189, v190
    v_max3_u32 v4, v4, v191, v192
    v_max3_u32 v4, v4, v193, v194
    v_max_u32 v4, v4, v195
    v_cmp_eq_u32_e64 vcc, -1, v4
    s_nop 0
    s_cbranch_vccz L_ok_89
    s_add_u32 s88, s88, 1
    s_cmp_lt_u32 s88, 65536
    s_cbranch_scc1 L_poll_88
L_ok_89:
    ds_write_b128 v12, v[188:191] offset:28672
    ds_write_b128 v12, v[192:195] offset:29696
    ds_write_b64 v7, v[196:197] offset:25728
L_nos4_85:
    s_waitcnt lgkmcnt(0)
    s_barrier
    ds_read_b64 v[8:9], v7 offset:25728
    s_waitcnt lgkmcnt(0)
    v_max_f32_dpp v4, v8, v8 row_ror:8 row_mask:0xf bank_mask:0xf
    s_nop 1
    v_max_f32_dpp v4, v4, v4 row_ror:4 row_mask:0xf bank_mask:0xf
    s_nop 1
    v_max_f32_dpp v4, v4, v4 row_ror:2 row_mask:0xf bank_mask:0xf
    s_nop 1
    v_max_f32_dpp v4, v4, v4 row_ror:1 row_mask:0xf bank_mask:0xf
    v_cmp_eq_f32 vcc, v4, v8
    s_nop 0
    s_ff1_i32_b32 s92, vcc_lo
    s_and_b32 s92, s92, 15
    s_nop 3
    v_readlane_b32 s91, v9, s92
    s_nop 0
    s_cmp_eq_u32 s91, s79
    s_cbranch_scc0 L_noh_90
    s_mov_b32 exec_hi, 0
    buffer_store_dword v182, v177, s[40:43], s99 offen offset:128 sc1
    s_mov_b64 exec, -1
L_noh_90:
    s_sub_u32 s77, s91, s82
    v_lshrrev_b32 v7, 3, v1
    v_sub_u32 v5, s77, v7
    v_mov_b32 v6, 2146435072
    v_and_b32 v8, 7, v1
    v_lshrrev_b32 v9, 4, v1
    v_xor_b32 v8, v8, v9
    v_lshlrev_b32 v8, 4, v8
    v_lshl_add_u32 v7, v7, 11, v8
    v_xor_b32 v8, 64, v7
    s_lshl_b32 s58, s82, 11
    s_lshl_b32 s59, s98, 7
    s_add_u32 s58, s58, s59
    v_cmp_eq_u32 vcc, 0, v5
    s_nop 1
    v_cndmask_b32 v200, v7, v6, vcc
    v_cmp_eq_u32 vcc, 8, v5
    s_nop 1
    v_cndmask_b32 v201, v8, v6, vcc
    v_cmp_eq_u32 vcc, 16, v5
    s_nop 1
    v_cndmask_b32 v202, v7, v6, vcc
    v_cmp_eq_u32 vcc, 24, v5
    s_nop 1
    v_cndmask_b32 v203, v8, v6, vcc
    s_lshl_b32 s77, s62, 12
    s_add_u32 s77, s77, 0
    v_add_u32 v4, s77, v12
    v_lshlrev_b32 v24, 16, v92
    v_and_b32_e64 v25, s90, v92
    v_pk_fma_f32 v[152:153], v[24:25], v[118:119], v[118:119] op_sel:[0,0,1] op_sel_hi:[1,0,1] neg_lo:[0,0,1] neg_hi:[0,0,1]
    v_cvt_pk_bf16_f32 v128, v152, v153
    v_lshlrev_b32 v152, 16, v128
    v_and_b32 v153, s90, v128
    v_pk_add_f32 v[152:153], v[152:153], v[24:25]
    v_cvt_pk_bf16_f32 v128, v152, v153
    v_lshlrev_b32 v26, 16, v93
    v_and_b32 v27, s90, v93
    v_pk_fma_f32 v[154:155], v[26:27], v[118:119], v[118:119] op_sel:[0,0,1] op_sel_hi:[1,0,1] neg_lo:[0,0,1] neg_hi:[0,0,1]
    v_cvt_pk_bf16_f32 v129, v154, v155
    v_lshlrev_b32 v154, 16, v129
    v_and_b32 v155, s90, v129
    v_pk_add_f32 v[154:155], v[154:155], v[26:27]
    v_cvt_pk_bf16_f32 v129, v154, v155
    ds_write_b64 v66, v[128:129]
    v_lshlrev_b32 v28, 16, v94
    v_and_b32 v29, s90, v94
    v_pk_fma_f32 v[156:157], v[28:29], v[118:119], v[118:119] op_sel:[0,0,1] op_sel_hi:[1,0,1] neg_lo:[0,0,1] neg_hi:[0,0,1]
    v_cvt_pk_bf16_f32 v130, v156, v157
    v_lshlrev_b32 v156, 16, v130
    v_and_b32 v157, s90, v130
    v_pk_add_f32 v[156:157], v[156:157], v[28:29]
    v_cvt_pk_bf16_f32 v130, v156, v157
    v_lshlrev_b32 v30, 16, v95
    v_and_b32 v31, s90, v95
    v_pk_fma_f32 v[158:159], v[30:31], v[118:119], v[118:119] op_sel:[0,0,1] op_sel_hi:[1,0,1] neg_lo:[0,0,1] neg_hi:[0,0,1]
    v_cvt_pk_bf16_f32 v131, v158, v159
    v_lshlrev_b32 v158, 16, v131
    v_and_b32 v159, s90, v131
    v_pk_add_f32 v[158:159], v[158:159], v[30:31]
    v_cvt_pk_bf16_f32 v131, v158, v159
    ds_write_b64 v67, v[130:131]
    v_lshlrev_b32 v32, 16, v96
    v_and_b32 v33, s90, v96
    v_pk_fma_f32 v[160:161], v[32:33], v[118:119], v[118:119] op_sel:[0,0,1] op_sel_hi:[1,0,1] neg_lo:[0,0,1] neg_hi:[0,0,1]
    v_cvt_pk_bf16_f32 v132, v160, v161
    v_lshlrev_b32 v160, 16, v132
    v_and_b32 v161, s90, v132
    v_pk_add_f32 v[160:161], v[160:161], v[32:33]
    v_cvt_pk_bf16_f32 v132, v160, v161
    v_lshlrev_b32 v34, 16, v97
    v_and_b32 v35, s90, v97
    v_pk_fma_f32 v[162:163], v[34:35], v[118:119], v[118:119] op_sel:[0,0,1] op_sel_hi:[1,0,1] neg_lo:[0,0,1] neg_hi:[0,0,1]
    v_cvt_pk_bf16_f32 v133, v162, v163
    v_lshlrev_b32 v162, 16, v133
    v_and_b32 v163, s90, v133
    v_pk_add_f32 v[162:163], v[162:163], v[34:35]
    v_cvt_pk_bf16_f32 v133, v162, v163
    ds_write_b64 v68, v[132:133]
    v_lshlrev_b32 v36, 16, v98
    v_and_b32 v37, s90, v98
    v_pk_fma_f32 v[164:165], v[36:37], v[118:119], v[118:119] op_sel:[0,0,1] op_sel_hi:[1,0,1] neg_lo:[0,0,1] neg_hi:[0,0,1]
    v_cvt_pk_bf16_f32 v134, v164, v165
    v_lshlrev_b32 v164, 16, v134
    v_and_b32 v165, s90, v134
    v_pk_add_f32 v[164:165], v[164:165], v[36:37]
    v_cvt_pk_bf16_f32 v134, v164, v165
    v_lshlrev_b32 v38, 16, v99
    v_and_b32 v39, s90, v99
    v_pk_fma_f32 v[166:167], v[38:39], v[118:119], v[118:119] op_sel:[0,0,1] op_sel_hi:[1,0,1] neg_lo:[0,0,1] neg_hi:[0,0,1]
    v_cvt_pk_bf16_f32 v135, v166, v167
    v_lshlrev_b32 v166, 16, v135
    v_and_b32 v167, s90, v135
    v_pk_add_f32 v[166:167], v[166:167], v[38:39]
    v_cvt_pk_bf16_f32 v135, v166, v167
    ds_write_b64 v69, v[134:135]
    v_lshlrev_b32 v40, 16, v100
    v_and_b32 v41, s90, v100
    v_pk_fma_f32 v[168:169], v[40:41], v[118:119], v[118:119] op_sel:[0,0,1] op_sel_hi:[1,0,1] neg_lo:[0,0,1] neg_hi:[0,0,1]
    v_cvt_pk_bf16_f32 v136, v168, v169
    v_lshlrev_b32 v168, 16, v136
    v_and_b32 v169, s90, v136
    v_pk_add_f32 v[168:169], v[168:169], v[40:41]
    v_cvt_pk_bf16_f32 v136, v168, v169
    v_lshlrev_b32 v42, 16, v101
    v_and_b32 v43, s90, v101
    v_pk_fma_f32 v[170:171], v[42:43], v[118:119], v[118:119] op_sel:[0,0,1] op_sel_hi:[1,0,1] neg_lo:[0,0,1] neg_hi:[0,0,1]
    v_cvt_pk_bf16_f32 v137, v170, v171
    v_lshlrev_b32 v170, 16, v137
    v_and_b32 v171, s90, v137
    v_pk_add_f32 v[170:171], v[170:171], v[42:43]
    v_cvt_pk_bf16_f32 v137, v170, v171
    ds_write_b64 v70, v[136:137]
    v_lshlrev_b32 v44, 16, v102
    v_and_b32 v45, s90, v102
    v_pk_fma_f32 v[172:173], v[44:45], v[118:119], v[118:119] op_sel:[0,0,1] op_sel_hi:[1,0,1] neg_lo:[0,0,1] neg_hi:[0,0,1]
    v_cvt_pk_bf16_f32 v138, v172, v173
    v_lshlrev_b32 v172, 16, v138
    v_and_b32 v173, s90, v138
    v_pk_add_f32 v[172:173], v[172:173], v[44:45]
    v_cvt_pk_bf16_f32 v138, v172, v173
    v_lshlrev_b32 v46, 16, v103
    v_and_b32 v47, s90, v103
    v_pk_fma_f32 v[174:175], v[46:47], v[118:119], v[118:119] op_sel:[0,0,1] op_sel_hi:[1,0,1] neg_lo:[0,0,1] neg_hi:[0,0,1]
    v_cvt_pk_bf16_f32 v139, v174, v175
    v_lshlrev_b32 v174, 16, v139
    v_and_b32 v175, s90, v139
    v_pk_add_f32 v[174:175], v[174:175], v[46:47]
    v_cvt_pk_bf16_f32 v139, v174, v175
    ds_write_b64 v71, v[138:139]
    s_barrier
    s_waitcnt lgkmcnt(0)
    ds_read_b128 v[48:51], v4 offset:0
    ds_read_b128 v[52:55], v4 offset:1024
    ds_read_b128 v[56:59], v4 offset:2048
    ds_read_b128 v[60:63], v4 offset:3072
    s_waitcnt lgkmcnt(3)
    buffer_store_dwordx4 v[48:51], v200, s[44:47], s58 offen sc1
    s_add_u32 s58, s58, 16384
    s_waitcnt lgkmcnt(2)
    buffer_store_dwordx4 v[52:55], v201, s[44:47], s58 offen sc1
    s_add_u32 s58, s58, 16384
    s_waitcnt lgkmcnt(1)
    buffer_store_dwordx4 v[56:59], v202, s[44:47], s58 offen sc1
    s_add_u32 s58, s58, 16384
    s_waitcnt lgkmcnt(0)
    buffer_store_dwordx4 v[60:63], v203, s[44:47], s58 offen sc1
L_cdone:
L_cfin:
L_end:
    s_endpgm
L_tr0:
    s_mov_b32 s88, 0
L_trq:
    ds_read_b32 v79, v8 offset:25984
    s_waitcnt lgkmcnt(0)
    v_readfirstlane_b32 s76, v79
    s_nop 0
    s_and_b32 s76, s76, s52
    s_cbranch_scc1 L_bk0
    s_add_u32 s88, s88, 1
    s_cmp_lt_u32 s88, 5
    s_cbranch_scc1 L_trq
    s_cmp_eq_u32 s53, 0
    s_cbranch_scc0 L_sent_68
    s_waitcnt vmcnt(0)
    s_mov_b64 exec, 1
    ds_add_u32 v8, v74 offset:25988
    s_mov_b64 exec, -1
    s_mov_b32 s53, 1
L_sent_68:
    s_call_b64 s[54:55], L_stall
    s_branch L_bk0
L_tr1:
    s_cmp_eq_u32 s53, 0
    s_cbranch_scc0 L_sent_69
    s_waitcnt vmcnt(4)
    s_mov_b64 exec, 1
    ds_add_u32 v8, v74 offset:25988
    s_mov_b64 exec, -1
    s_mov_b32 s53, 1
L_sent_69:
    s_call_b64 s[54:55], L_stall
    s_branch L_bk1
L_tr2:
    s_call_b64 s[54:55], L_stall
    s_branch L_bk2
L_tr3:
    s_call_b64 s[54:55], L_stall
    s_branch L_bk3
L_tr4:
    s_call_b64 s[54:55], L_stall
    s_branch L_bk4
L_tr5:
    s_call_b64 s[54:55], L_stall
    s_branch L_bk5
L_tr6:
    s_call_b64 s[54:55], L_stall
    s_branch L_bk6
L_tr7:
    s_call_b64 s[54:55], L_stall
    s_branch L_bk7
L_tr8:
    s_call_b64 s[54:55], L_stall
    s_branch L_bk8
L_tr9:
    s_call_b64 s[54:55], L_stall
    s_branch L_bk9
L_tr10:
    s_call_b64 s[54:55], L_stall
    s_branch L_bk10
L_tr11:
    s_call_b64 s[54:55], L_stall
    s_branch L_bk11
L_tr12:
    s_call_b64 s[54:55], L_stall
    s_branch L_bk12
L_tr13:
    s_call_b64 s[54:55], L_stall
    s_branch L_bk13
L_tr14:
    s_call_b64 s[54:55], L_stall
    s_branch L_bk14
L_tr15:
    s_call_b64 s[54:55], L_stall
    s_branch L_bk15
L_stall:
    s_cmp_eq_u32 s53, 0
    s_cbranch_scc0 L_sent_67
    s_waitcnt vmcnt(0)
    s_mov_b64 exec, 1
    ds_add_u32 v8, v74 offset:25988
    s_mov_b64 exec, -1
    s_mov_b32 s53, 1
L_sent_67:
    s_mov_b32 s88, 0
L_stall1:
    ds_read_b32 v79, v8 offset:25984
    s_waitcnt lgkmcnt(0)
    v_readfirstlane_b32 s76, v79
    s_nop 0
    s_and_b32 s76, s76, s52
    s_cbranch_scc1 L_stall2
    s_add_u32 s88, s88, 1
    s_cmp_lt_u32 s88, 1048576
    s_cbranch_scc1 L_stall1
    s_mov_b32 s76, s52
L_stall2:
    s_setpc_b64 s[54:55]
L_s3_73:
    v_cmp_eq_u32_e64 vcc, -1, v115
    s_nop 0
    s_cbranch_vccz L_s3skip_75
    buffer_load_dwordx4 v[112:115], v178, s[40:43], s78 offen offset:1024 sc1
L_s3skip_75:
    v_cmp_eq_u32_e64 vcc, -1, v119
    s_nop 0
    s_cbranch_vccz L_s3skip_76
    buffer_load_dwordx4 v[116:119], v178, s[40:43], s48 offen offset:1024 sc1
L_s3skip_76:
    v_cmp_eq_u32_e64 vcc, -1, v123
    s_nop 0
    s_cbranch_vccz L_s3skip_77
    buffer_load_dwordx4 v[120:123], v178, s[40:43], s49 offen offset:1024 sc1
L_s3skip_77:
    v_cmp_eq_u32_e64 vcc, -1, v127
    s_nop 0
    s_cbranch_vccz L_s3skip_78
    buffer_load_dwordx4 v[124:127], v178, s[40:43], s50 offen offset:1024 sc1
L_s3skip_78:
    v_cmp_eq_u32_e64 vcc, -1, v131
    s_nop 0
    s_cbranch_vccz L_s3skip_79
    buffer_load_dwordx4 v[128:131], v178, s[40:43], s51 offen offset:1024 sc1
L_s3skip_79:
    v_cmp_eq_u32_e64 vcc, -1, v135
    s_nop 0
    s_cbranch_vccz L_s3skip_80
    buffer_load_dwordx4 v[132:135], v178, s[40:43], s52 offen offset:1024 sc1
L_s3skip_80:
    v_cmp_eq_u32_e64 vcc, -1, v139
    s_nop 0
    s_cbranch_vccz L_s3skip_81
    buffer_load_dwordx4 v[136:139], v178, s[40:43], s53 offen offset:1024 sc1
L_s3skip_81:
    v_cmp_eq_u32_e64 vcc, -1, v143
    s_nop 0
    s_cbranch_vccz L_s3skip_82
    buffer_load_dwordx4 v[140:143], v178, s[40:43], s54 offen offset:1024 sc1
L_s3skip_82:
    s_waitcnt vmcnt(0)
    v_pk_add_f32 v[108:109], v[112:113], v[116:117]
    v_pk_add_f32 v[110:111], v[114:115], v[118:119]
    v_pk_add_f32 v[108:109], v[108:109], v[120:121]
    v_pk_add_f32 v[110:111], v[110:111], v[122:123]
    v_pk_add_f32 v[108:109], v[108:109], v[124:125]
    v_pk_add_f32 v[110:111], v[110:111], v[126:127]
    v_pk_add_f32 v[108:109], v[108:109], v[128:129]
    v_pk_add_f32 v[110:111], v[110:111], v[130:131]
    v_pk_add_f32 v[108:109], v[108:109], v[132:133]
    v_pk_add_f32 v[110:111], v[110:111], v[134:135]
    v_pk_add_f32 v[108:109], v[108:109], v[136:137]
    v_pk_add_f32 v[110:111], v[110:111], v[138:139]
    v_pk_add_f32 v[108:109], v[108:109], v[140:141]
    v_pk_add_f32 v[110:111], v[110:111], v[142:143]
    v_cmp_u_f32 vcc, v111, v111
    v_mov_b32 v4, v108
    v_mov_b32 v5, v109
    v_mov_b32_e64 v6, v110
    s_cbranch_vccz L_s3ok_74
    s_add_u32 s88, s88, 1
    s_cmp_lt_u32 s88, 65536
    s_cbranch_scc1 L_s3_73
    s_branch L_s3ok_74
L_code_end:
s_endpgm
.p2align 7
.type L_table,@object
L_table:
.long 0x650c3824, 0xfedba97, 0x50110, 0x3006
.long 0x650c3824, 0xfedba97, 0x520200, 0x3060
.long 0x641d0935, 0xfecba87, 0x5000011, 0x3600
.long 0x76543218, 0xfedcba9, 0x15000010, 0x6300
.long 0x641d0935, 0xfecba87, 0x25200, 0x3006
.long 0x54e2a160, 0xfdcb987, 0x501001, 0x3060
.long 0x54e2a160, 0xfdcb987, 0x5000022, 0x3600
.long 0x54f3b271, 0xedca986, 0x50101000, 0x6300
.long 0x54f3b271, 0xedca986, 0x250020, 0x3006
.long 0x650c3824, 0xfedba97, 0x510001, 0x3060
.long 0x650c3824, 0xfedba97, 0x5000202, 0x3600
.long 0x76543218, 0xfedcba9, 0x50000202, 0x6300
.long 0x641d0935, 0xfecba87, 0x15100, 0x3006
.long 0x641d0935, 0xfecba87, 0x500022, 0x3060
.long 0x54e2a160, 0xfdcb987, 0x5100010, 0x3600
.long 0x54e2a160, 0xfdcb987, 0x50202000, 0x6300
.long 0x641d0935, 0xfecba87, 0x500011, 0x3060
.long 0x641d0935, 0xfecba87, 0x5020020, 0x3600
.long 0x54e2a160, 0xfdcb987, 0x50001010, 0x6300
.long 0x76543209, 0xfedcba8, 0x15010, 0x3006
.long 0x54e2a160, 0xfdcb987, 0x500022, 0x3060
.long 0x54f3b271, 0xedca986, 0x5100001, 0x3600
.long 0x54f3b271, 0xedca986, 0x50002020, 0x6300
.long 0x650c3824, 0xfedba97, 0x15100, 0x3006
.long 0x650c3824, 0xfedba97, 0x520020, 0x3060
.long 0x641d0935, 0xfecba87, 0x5010100, 0x3600
.long 0x641d0935, 0xfecba87, 0x50020200, 0x6300
.long 0x76543209, 0xfedcba8, 0x250002, 0x3006
.long 0x54e2a160, 0xfdcb987, 0x5110000, 0x3060
.long 0x54e2a160, 0xfdcb987, 0x5200002, 0x3600
.long 0x54f3b271, 0xedca986, 0x50001010, 0x6300
.long 0x54f3b271, 0xedca986, 0x52020, 0x3006
.long 0x54e2a160, 0xfdcb987, 0x5100100, 0x3600
.long 0x54e2a160, 0xfdcb987, 0x50002002, 0x6300
.long 0x54f3b271, 0xedca986, 0x150010, 0x3006
.long 0x765431a0, 0xfedcb98, 0x150001, 0x3060
.long 0x54f3b271, 0xedca986, 0x5000022, 0x3600
.long 0x650c3824, 0xfedba97, 0x50000101, 0x6300
.long 0x650c3824, 0xfedba97, 0x50220, 0x3006
.long 0x641d0935, 0xfecba87, 0x510100, 0x3060
.long 0x641d0935, 0xfecba87, 0x5000022, 0x3600
.long 0x54e2a160, 0xfdcb987, 0x50001010, 0x6300
.long 0x54e2a160, 0xfdcb987, 0x250002, 0x3006
.long 0x765431a0, 0xfedcb98, 0x500220, 0x3060
.long 0x54f3b271, 0xedca986, 0x5001100, 0x3600
.long 0x54f3b271, 0xedca986, 0x50000022, 0x6300
.long 0x650c3824, 0xfedba97, 0x511000, 0x3006
.long 0x650c3824, 0xfedba97, 0x520002, 0x3060
.long 0x54f3b271, 0xedca986, 0x50100001, 0x6300
.long 0x54f3b271, 0xedca986, 0x52002, 0x3006
.long 0x650c3824, 0xfedba97, 0x500101, 0x3060
.long 0x765421b0, 0xfedca98, 0x1500001, 0x3600
.long 0x650c3824, 0xfedba97, 0x50000022, 0x6300
.long 0x641d0935, 0xfecba87, 0x15100, 0x3006
.long 0x641d0935, 0xfecba87, 0x520020, 0x3060
.long 0x54e2a160, 0xfdcb987, 0x5101000, 0x3600
.long 0x54e2a160, 0xfdcb987, 0x50002020, 0x6300
.long 0x54f3b271, 0xedca986, 0x51010, 0x3006
.long 0x54f3b271, 0xedca986, 0x250020, 0x3060
.long 0x765421b0, 0xfedca98, 0x5000022, 0x3600
.long 0x650c3824, 0xfedba97, 0x50010010, 0x6300
.long 0x650c3824, 0xfedba97, 0x25200, 0x3006
.long 0x641d0935, 0xfecba87, 0x500011, 0x3060
.long 0x641d0935, 0xfecba87, 0x5020200, 0x3600
.long 0x650c3824, 0xfedba97, 0x51010, 0x3006
.long 0x650c3824, 0xfedba97, 0x500022, 0x3060
.long 0x641d0935, 0xfecba87, 0x5100100, 0x3600
.long 0x76532c10, 0xfedba98, 0x15000100, 0x6300
.long 0x641d0935, 0xfecba87, 0x50022, 0x3006
.long 0x54e2a160, 0xfdcb987, 0x150010, 0x3060
.long 0x54e2a160, 0xfdcb987, 0x5202000, 0x3600
.long 0x54f3b271, 0xedca986, 0x50101000, 0x6300
.long 0x54f3b271, 0xedca986, 0x52002, 0x3006
.long 0x650c3824, 0xfedba97, 0x500101, 0x3060
.long 0x650c3824, 0xfedba97, 0x5020020, 0x3600
.long 0x76532c10, 0xfedba98, 0x52000200, 0x6300
.long 0x641d0935, 0xfecba87, 0x15001, 0x3006
.long 0x641d0935, 0xfecba87, 0x520200, 0x3060
.long 0x54e2a160, 0xfdcb987, 0x5001001, 0x3600
.long 0x54e2a160, 0xfdcb987, 0x50000022, 0x6300
.long 0x641d0935, 0xfecba87, 0x501001, 0x3060
.long 0x641d0935, 0xfecba87, 0x5000202, 0x3600
.long 0x54e2a160, 0xfdcb987, 0x50100100, 0x6300
.long 0x76432d10, 0xfecba98, 0x150100, 0x3006
.long 0x54e2a160, 0xfdcb987, 0x252000, 0x3060
.long 0x54f3b271, 0xedca986, 0x5101000, 0x3600
.long 0x54f3b271, 0xedca986, 0x50200002, 0x6300
.long 0x650c3824, 0xfedba97, 0x15100, 0x3006
.long 0x650c3824, 0xfedba97, 0x500202, 0x3060
.long 0x641d0935, 0xfecba87, 0x5000110, 0x3600
.long 0x641d0935, 0xfecba87, 0x50000022, 0x6300
.long 0x76432d10, 0xfecba98, 0x20050200, 0x3006
.long 0x54e2a160, 0xfdcb987, 0x501010, 0x3060
.long 0x54e2a160, 0xfdcb987, 0x5002020, 0x3600
.long 0x54f3b271, 0xedca986, 0x50000110, 0x6300
.long 0x54f3b271, 0xedca986, 0x250002, 0x3006
.long 0x54e2a160, 0xfdcb987, 0x5000011, 0x3600
.long 0x54e2a160, 0xfdcb987, 0x50200020, 0x6300
.long 0x54f3b271, 0xedca986, 0x115000, 0x3006
.long 0x7543e210, 0xfdcba98, 0x501010, 0x3060
.long 0x54f3b271, 0xedca986, 0x5202000, 0x3600
.long 0x650c3824, 0xfedba97, 0x51000001, 0x6300
.long 0x650c3824, 0xfedba97, 0x25002, 0x3006
.long 0x641d0935, 0xfecba87, 0x510100, 0x3060
.long 0x641d0935, 0xfecba87, 0x5020200, 0x3600
.long 0x54e2a160, 0xfdcb987, 0x50011000, 0x6300
.long 0x54e2a160, 0xfdcb987, 0x52020, 0x3006
.long 0x7543e210, 0xfdcba98, 0x522000, 0x3060
.long 0x54f3b271, 0xedca986, 0x5001010, 0x3600
.long 0x54f3b271, 0xedca986, 0x50202000, 0x6300
.long 0x650c3824, 0xfedba97, 0x15100, 0x3006
.long 0x650c3824, 0xfedba97, 0x500220, 0x3060
.long 0x54f3b271, 0xedca986, 0x50001010, 0x6300
.long 0x54f3b271, 0xedca986, 0x250020, 0x3006
.long 0x650c3824, 0xfedba97, 0x500110, 0x3060
.long 0x6543f210, 0xedcba98, 0x15000001, 0x3600
.long 0x650c3824, 0xfedba97, 0x50020200, 0x6300
.long 0x641d0935, 0xfecba87, 0x15001, 0x3006
.long 0x641d0935, 0xfecba87, 0x500202, 0x3060
.long 0x54e2a160, 0xfdcb987, 0x5101000, 0x3600
.long 0x54e2a160, 0xfdcb987, 0x50200002, 0x6300
.long 0x54f3b271, 0xedca986, 0x150001, 0x3006
.long 0x54f3b271, 0xedca986, 0x502002, 0x3060
.long 0x6543f210, 0xedcba98, 0x5202000, 0x3600
.long 0x650c3824, 0xfedba97, 0x50010001, 0x6300
.long 0x650c3824, 0xfedba97, 0x50022, 0x3006
.long 0x641d0935, 0xfecba87, 0x500110, 0x3060
.long 0x641d0935, 0xfecba87, 0x5000022, 0x3600
.long 0x650c3824, 0xfedba97, 0x25002, 0x3006
.long 0x650c3824, 0xfedba97, 0x510010, 0x3060
.long 0x641d0935, 0xfecba87, 0x5020200, 0x3600
.long 0x76543218, 0xfedcba9, 0x50000022, 0x6300
.long 0x641d0935, 0xfecba87, 0x50110, 0x3006
.long 0x54e2a160, 0xfdcb987, 0x250002, 0x3060
.long 0x54e2a160, 0xfdcb987, 0x5101000, 0x3600
.long 0x54f3b271, 0xedca986, 0x50002002, 0x6300
.long 0x54f3b271, 0xedca986, 0x151000, 0x3006
.long 0x650c3824, 0xfedba97, 0x520020, 0x3060
.long 0x650c3824, 0xfedba97, 0x5000101, 0x3600
.long 0x76543218, 0xfedcba9, 0x15000010, 0x6300
.long 0x641d0935, 0xfecba87, 0x25200, 0x3006
.long 0x641d0935, 0xfecba87, 0x510001, 0x3060
.long 0x54e2a160, 0xfdcb987, 0x5000022, 0x3600
.long 0x54e2a160, 0xfdcb987, 0x50000011, 0x6300
.long 0x641d0935, 0xfecba87, 0x500022, 0x3060
.long 0x641d0935, 0xfecba87, 0x5000011, 0x3600
.long 0x54e2a160, 0xfdcb987, 0x50000022, 0x6300
.long 0x76543209, 0xfedcba8, 0x52002, 0x3006
.long 0x54e2a160, 0xfdcb987, 0x501010, 0x3060
.long 0x54f3b271, 0xedca986, 0x5002020, 0x3600
.long 0x54f3b271, 0xedca986, 0x50000011, 0x6300
.long 0x650c3824, 0xfedba97, 0x25020, 0x3006
.long 0x650c3824, 0xfedba97, 0x510100, 0x3060
.long 0x641d0935, 0xfecba87, 0x5000220, 0x3600
.long 0x641d0935, 0xfecba87, 0x50010100, 0x6300
.long 0x76543209, 0xfedcba8, 0x15100, 0x3006
.long 0x54e2a160, 0xfdcb987, 0x252000, 0x3060
.long 0x54e2a160, 0xfdcb987, 0x5100001, 0x3600
.long 0x54f3b271, 0xedca986, 0x50200020, 0x6300
.long 0x54f3b271, 0xedca986, 0x151000, 0x3006
.long 0x54e2a160, 0xfdcb987, 0x5200002, 0x3600
.long 0x54e2a160, 0xfdcb987, 0x50100100, 0x6300
.long 0x54f3b271, 0xedca986, 0x250002, 0x3006
.long 0x765431a0, 0xfedcb98, 0x520020, 0x3060
.long 0x54f3b271, 0xedca986, 0x5001010, 0x3600
.long 0x650c3824, 0xfedba97, 0x50020200, 0x6300
.long 0x650c3824, 0xfedba97, 0x50101, 0x3006
.long 0x641d0935, 0xfecba87, 0x520200, 0x3060
.long 0x641d0935, 0xfecba87, 0x5010100, 0x3600
.long 0x54e2a160, 0xfdcb987, 0x50202000, 0x6300
.long 0x54e2a160, 0xfdcb987, 0x50011, 0x3006
.long 0x765431a0, 0xfedcb98, 0x150010, 0x3060
.long 0x54f3b271, 0xedca986, 0x5200020, 0x3600
.long 0x54f3b271, 0xedca986, 0x50100100, 0x6300
.long 0x650c3824, 0xfedba97, 0x25002, 0x3006
.long 0x650c3824, 0xfedba97, 0x511000, 0x3060
.long 0x54f3b271, 0xedca986, 0x50002002, 0x6300
.long 0x54f3b271, 0xedca986, 0x150010, 0x3006
.long 0x650c3824, 0xfedba97, 0x520200, 0x3060
.long 0x765421b0, 0xfedca98, 0x25000020, 0x3600
.long 0x650c3824, 0xfedba97, 0x50000101, 0x6300
.long 0x641d0935, 0xfecba87, 0x50022, 0x3006
.long 0x641d0935, 0xfecba87, 0x510001, 0x3060
.long 0x54e2a160, 0xfdcb987, 0x5200020, 0x3600
.long 0x54e2a160, 0xfdcb987, 0x50101000, 0x6300
.long 0x54f3b271, 0xedca986, 0x50022, 0x3006
.long 0x54f3b271, 0xedca986, 0x500101, 0x3060
.long 0x765421b0, 0xfedca98, 0x1500010, 0x3600
.long 0x650c3824, 0xfedba97, 0x50000022, 0x6300
.long 0x650c3824, 0xfedba97, 0x511000, 0x3006
.long 0x641d0935, 0xfecba87, 0x520200, 0x3060
.long 0x641d0935, 0xfecba87, 0x5001100, 0x3600
.long 0x650c3824, 0xfedba97, 0x50220, 0x3006
.long 0x650c3824, 0xfedba97, 0x500101, 0x3060
.long 0x641d0935, 0xfecba87, 0x5000022, 0x3600
.long 0x76532c10, 0xfedba98, 0x50000202, 0x6300
.long 0x641d0935, 0xfecba87, 0x50101, 0x3006
.long 0x54e2a160, 0xfdcb987, 0x502020, 0x3060
.long 0x54e2a160, 0xfdcb987, 0x5101000, 0x3600
.long 0x54f3b271, 0xedca986, 0x50200020, 0x6300
.long 0x54f3b271, 0xedca986, 0x151000, 0x3006
.long 0x650c3824, 0xfedba97, 0x500202, 0x3060
.long 0x650c3824, 0xfedba97, 0x5010010, 0x3600
.long 0x76532c10, 0xfedba98, 0x15000001, 0x6300
.long 0x641d0935, 0xfecba87, 0x50022, 0x3006
.long 0x641d0935, 0xfecba87, 0x510010, 0x3060
.long 0x54e2a160, 0xfdcb987, 0x5202000, 0x3600
.long 0x54e2a160, 0xfdcb987, 0x50000110, 0x6300
.long 0x641d0935, 0xfecba87, 0x520200, 0x3060
.long 0x641d0935, 0xfecba87, 0x5000110, 0x3600
.long 0x54e2a160, 0xfdcb987, 0x50202000, 0x6300
.long 0x76432d10, 0xfecba98, 0x52200, 0x3006
.long 0x54e2a160, 0xfdcb987, 0x151000, 0x3060
.long 0x54f3b271, 0xedca986, 0x5200002, 0x3600
.long 0x54f3b271, 0xedca986, 0x50100100, 0x6300
.long 0x650c3824, 0xfedba97, 0x50202, 0x3006
.long 0x650c3824, 0xfedba97, 0x510100, 0x3060
.long 0x641d0935, 0xfecba87, 0x5020002, 0x3600
.long 0x641d0935, 0xfecba87, 0x50010001, 0x6300
.long 0x76432d10, 0xfecba98, 0x150010, 0x3006
.long 0x54e2a160, 0xfdcb987, 0x500022, 0x3060
.long 0x54e2a160, 0xfdcb987, 0x5000011, 0x3600
.long 0x54f3b271, 0xedca986, 0x50002002, 0x6300
.long 0x54f3b271, 0xedca986, 0x51010, 0x3006
.long 0x54e2a160, 0xfdcb987, 0x5002020, 0x3600
.long 0x54e2a160, 0xfdcb987, 0x50101000, 0x6300
.long 0x54f3b271, 0xedca986, 0x52020, 0x3006
.long 0x7543e210, 0xfdcba98, 0x2502000, 0x3060
.long 0x54f3b271, 0xedca986, 0x5001010, 0x3600
.long 0x650c3824, 0xfedba97, 0x50000022, 0x6300
.long 0x650c3824, 0xfedba97, 0x15100, 0x3006
.long 0x641d0935, 0xfecba87, 0x500022, 0x3060
.long 0x641d0935, 0xfecba87, 0x5010100, 0x3600
.long 0x54e2a160, 0xfdcb987, 0x50000022, 0x6300
.long 0x54e2a160, 0xfdcb987, 0x50011, 0x3006
.long 0x7543e210, 0xfdcba98, 0x1500010, 0x3060
.long 0x54f3b271, 0xedca986, 0x5002002, 0x3600
.long 0x54f3b271, 0xedca986, 0x50110000, 0x6300
.long 0x650c3824, 0xfedba97, 0x50220, 0x3006
.long 0x650c3824, 0xfedba97, 0x500011, 0x3060
.long 0x54f3b271, 0xedca986, 0x50200020, 0x6300
.long 0x54f3b271, 0xedca986, 0x15010, 0x3006
.long 0x650c3824, 0xfedba97, 0x500022, 0x3060
.long 0x6543f210, 0xedcba98, 0x25002000, 0x3600
.long 0x650c3824, 0xfedba97, 0x50000101, 0x6300
.long 0x641d0935, 0xfecba87, 0x25200, 0x3006
.long 0x641d0935, 0xfecba87, 0x511000, 0x3060
.long 0x54e2a160, 0xfdcb987, 0x5002002, 0x3600
.long 0x54e2a160, 0xfdcb987, 0x50101000, 0x6300
.long 0x54f3b271, 0xedca986, 0x252000, 0x3006
.long 0x54f3b271, 0xedca986, 0x501001, 0x3060
.long 0x6543f210, 0xedcba98, 0x15001000, 0x3600
.long 0x650c3824, 0xfedba97, 0x50020200, 0x6300
.long 0x650c3824, 0xfedba97, 0x15010, 0x3006
.long 0x641d0935, 0xfecba87, 0x500022, 0x3060
.long 0x641d0935, 0xfecba87, 0x5000101, 0x3600
.fill 1, 4, 0
.size L_table, .-L_table
.section .rodata,"a"
.p2align 6
.amdhsa_kernel sequential_preLN__linear_kernel_hedgehog__moe_arch_mod__prompt_kernel
  .amdhsa_next_free_vgpr 256
  .amdhsa_next_free_sgpr 102
  .amdhsa_accum_offset 256
  .amdhsa_group_segment_fixed_size 0
  .amdhsa_kernarg_size 96
  .amdhsa_user_sgpr_count 2
  .amdhsa_user_sgpr_kernarg_segment_ptr 1
  .amdhsa_system_sgpr_workgroup_id_x 1
  .amdhsa_float_denorm_mode_32 3
.end_amdhsa_kernel
```

```asm
; @launch grid=(256,1,1) block=(512,1,1) lds=163840
.amdgcn_target "amdgcn-amd-amdhsa--gfx950"
.text
.p2align 10
.fill 64, 4, 0xbf800000
.globl sequential_preLN__linear_kernel_hedgehog__moe_arch_mod__prompt_kernel
.p2align 8
.type sequential_preLN__linear_kernel_hedgehog__moe_arch_mod__prompt_kernel,@function
sequential_preLN__linear_kernel_hedgehog__moe_arch_mod__prompt_kernel:
    s_load_dwordx2 s[28:29], s[0:1], 0
    s_load_dwordx2 s[32:33], s[0:1], 8
    s_getpc_b64 s[66:67]
L_pc:
    v_readfirstlane_b32 s79, v0
    s_lshr_b32 s60, s2, 3
    s_cmp_ge_u32 s60, 32
    s_cbranch_scc1 L_end
    v_and_b32_e64 v1, 63, v0
    s_and_b32 s60, s60, 15
    s_lshr_b32 s62, s79, 6
    s_cmp_ge_u32 s62, 4
    s_cbranch_scc1 L_compute
    s_setprio 3
    s_lshr_b32 s76, s2, 3
    s_lshl2_add_u32 s76, s76, s62
    s_mul_i32 s76, s76, 256
    v_lshl_add_u32 v91, v1, 7, s76
    s_mov_b64 exec, 3
    global_load_dword v27, v91, s[66:67]
    s_mov_b64 exec, -1
    s_add_u32 s84, s60, s2
    s_and_b32 s84, s84, 3
    s_and_b32 s76, s60, 7
    s_and_b32 s77, s2, 7
    s_cselect_b32 s84, s84, s76
    v_lshrrev_b32 v4, 3, v1
    v_and_b32 v5, 7, v1
    v_lshrrev_b32 v6, 4, v1
    s_lshl2_add_u32 s76, s60, s62
    s_lshl_b32 s76, s76, 16
    s_movk_i32 s70, 10240
    s_mul_i32 s70, s70, s62
    v_xor_b32 v7, v5, v6
    v_lshlrev_b32 v7, 4, v7
    v_lshl_add_u32 v78, v4, 11, v7
    v_add_u32_e64 v16, s76, v78
    s_mov_b32 s30, 4194304
    s_mov_b32 s31, 0x20000
    s_and_b32 s72, s84, 15
    s_mov_b32 m0, s70
    s_lshl_b32 s71, s72, 7
    s_waitcnt lgkmcnt(0)
    buffer_load_dwordx4 v16, s[28:31], s71 offen offset:0 lds
    s_mul_i32 s72, s72, 393216
    s_lshr_b64 s[84:85], s[84:85], 4
    s_load_dwordx4 s[8:11], s[0:1], 16
    s_load_dwordx16 s[12:27], s[0:1], 32
    v_xor_b32 v7, 64, v16
    v_add_u32 v17, 15360, v7
    buffer_load_dwordx4 v17, s[28:31], s71 offen offset:1024 lds
    v_add_u32 v18, 30720, v16
    buffer_load_dwordx4 v18, s[28:31], s71 offen offset:2048 lds
    v_add_u32 v19, 46080, v7
    buffer_load_dwordx4 v19, s[28:31], s71 offen offset:3072 lds
    s_and_b32 s76, s2, 7
    s_lshl_b32 s76, s76, 3
    s_lshr_b32 s77, s2, 7
    s_lshl2_add_u32 s76, s77, s76
    s_mov_b32 s80, 0x654210b3
    s_mov_b32 s81, 0xfedca987
    s_lshr_b64 s[80:81], s[80:81], s76
    s_and_b32 s61, s80, 15
    v_and_b32 v6, 1, v6
    v_lshlrev_b32 v6, 2, v6
    v_xor_b32 v8, v5, v6
    v_lshlrev_b32_e64 v8, 4, v8
    s_lshl_b32 s76, s61, 7
    s_mul_i32 s77, s62, 98304
    s_add_u32 s76, s76, s77
    v_mul_u32_u24 v7, 6144, v4
    v_add3_u32 v20, v7, v8, s76
    v_xor_b32 v7, 32, v20
    s_mov_b32 s34, 6291456
    s_mov_b32 s35, 0x20000
    s_add_u32 m0, s70, 4096
    s_nop 0
    buffer_load_dwordx4 v20, s[32:35], s72 offen offset:0 lds
    v_add_u32 v21, 48128, v7
    buffer_load_dwordx4 v21, s[32:35], s72 offen offset:1024 lds
    v_add_u32 v22, 0, v20
    buffer_load_dwordx4 v22, s[32:35], s72 offen offset:2048 lds
    v_add_u32 v23, 48128, v7
    buffer_load_dwordx4 v23, s[32:35], s72 offen offset:3072 lds
    v_add_u32 v24, 4096, v20
    s_add_u32 m0, s70, 8192
    s_nop 0
    buffer_load_dwordx4 v24, s[32:35], s72 offen offset:0 lds
    v_add_u32 v25, 52224, v7
    buffer_load_dwordx4 v25, s[32:35], s72 offen offset:1024 lds
    s_add_u32 s70, s70, 40960
    s_cmp_ge_u32 s70, 122880
    s_cselect_b32 s76, 122880, 0
    s_sub_u32 s70, s70, s76
    s_lshl_b32 s76, s60, 8
    s_lshl_b32 s77, s61, 4
    s_add_u32 s76, s76, s77
    s_add_u32 s76, s76, 31596
    s_load_dwordx4 s[84:87], s[66:67], s76
    v_lshl_add_u32 v26, v4, 11, v8
    v_xor_b32 v79, 64, v78
    s_and_b32 s63, s62, 1
    s_lshr_b32 s64, s62, 1
    s_lshl_b32 s73, s60, 4
    s_add_u32 s73, s73, s61
    s_mul_i32 s73, s73, 28800
    s_add_u32 s76, s2, 7
    s_and_b32 s76, s76, 7
    s_bfe_u32 s77, s2, 0x10003
    s_lshl1_add_u32 s97, s76, s77
    s_lshr_b32 s98, s2, 4
    s_lshl_b32 s99, s97, 4
    s_add_u32 s99, s99, s98
    s_mul_i32 s99, s99, 9344
    s_add_u32 s99, s99, 8388608
    s_lshr_b32 s65, s97, 1
    s_lshl_b32 s76, s97, 3
    s_add_u32 s65, s65, s76
    s_mul_i32 s76, s98, 4
    s_add_u32 s65, s65, s76
    s_and_b32 s65, s65, 15
    s_mov_b32 s89, 0x3f803f80
    s_mov_b32 s90, 0xffff0000
    v_and_b32 v2, 31, v1
    v_lshrrev_b32 v3, 5, v1
    v_lshlrev_b32 v12, 4, v1
    v_lshrrev_b32 v4, 3, v1
    v_mul_u32_u24 v13, 460800, v4
    v_and_b32_e64 v4, 7, v1
    v_lshl_add_u32 v13, v4, 4, v13
    s_lshl_b32 s76, s98, 7
    s_lshl_b32 s77, s62, 15
    s_add_u32 s76, s76, s77
    v_add_u32 v26, s76, v26
    v_mov_b32 v28, -1
    v_mov_b32 v29, -1
    v_mov_b32 v30, -1
    v_mov_b32 v31, -1
    s_waitcnt lgkmcnt(0)
    s_and_b32 s72, s84, 15
    s_mov_b32 m0, s70
    s_lshl_b32 s71, s72, 7
    buffer_load_dwordx4 v16, s[28:31], s71 offen offset:0 lds
    s_mul_i32 s72, s72, 393216
    s_lshr_b64 s[84:85], s[84:85], 4
    buffer_load_dwordx4 v17, s[28:31], s71 offen offset:1024 lds
    s_mov_b32 s40, s26
    s_and_b32 s41, s27, 0xffff
    s_mov_b32 s42, 33554432
    s_mov_b32 s43, 0x20000
    buffer_load_dwordx4 v18, s[28:31], s71 offen offset:2048 lds
    s_mov_b32 s56, s8
    s_and_b32 s57, s9, 0xffff
    s_mov_b32 s58, 65536
    s_mov_b32 s59, 0x20000
    buffer_load_dwordx4 v19, s[28:31], s71 offen offset:3072 lds
    s_add_u32 m0, s70, 4096
    s_nop 0
    buffer_load_dwordx4 v20, s[32:35], s72 offen offset:0 lds
    buffer_load_dwordx4 v21, s[32:35], s72 offen offset:1024 lds
    buffer_load_dwordx4 v22, s[32:35], s72 offen offset:2048 lds
    buffer_load_dwordx4 v23, s[32:35], s72 offen offset:3072 lds
    s_add_u32 m0, s70, 8192
    s_nop 0
    buffer_load_dwordx4 v24, s[32:35], s72 offen offset:0 lds
    buffer_load_dwordx4 v25, s[32:35], s72 offen offset:1024 lds
    s_add_u32 s70, s70, 40960
    s_cmp_ge_u32 s70, 122880
    s_cselect_b32 s76, 122880, 0
    s_sub_u32 s70, s70, s76
    s_lshl_b32 s77, s62, 10
    s_add_u32 s76, s77, s73
    buffer_store_dwordx4 v[28:31], v12, s[40:43], s76 offen sc1
    s_lshl_b32 s76, s61, 12
    s_add_u32 s76, s76, s77
    s_add_u32 m0, s77, 122880
    s_nop 0
    buffer_load_dwordx4 v12, s[56:59], s76 offen lds
    v_mov_b32 v4, 13631488
    buffer_load_dwordx2 v[88:89], v4, s[40:43], 0 offen
    s_setprio 0
    s_waitcnt vmcnt(13)
    s_barrier
    s_and_b32 s72, s84, 15
    s_mov_b32 m0, s70
    s_lshl_b32 s71, s72, 7
    buffer_load_dwordx4 v16, s[28:31], s71 offen offset:0 lds
    s_mul_i32 s72, s72, 393216
    s_lshr_b64 s[84:85], s[84:85], 4
    buffer_load_dwordx4 v17, s[28:31], s71 offen offset:1024 lds
    buffer_load_dwordx4 v18, s[28:31], s71 offen offset:2048 lds
    buffer_load_dwordx4 v19, s[28:31], s71 offen offset:3072 lds
    s_add_u32 m0, s70, 4096
    s_nop 0
    buffer_load_dwordx4 v20, s[32:35], s72 offen offset:0 lds
    buffer_load_dwordx4 v21, s[32:35], s72 offen offset:1024 lds
    buffer_load_dwordx4 v22, s[32:35], s72 offen offset:2048 lds
    buffer_load_dwordx4 v23, s[32:35], s72 offen offset:3072 lds
    s_add_u32 m0, s70, 8192
    s_nop 0
    buffer_load_dwordx4 v24, s[32:35], s72 offen offset:0 lds
    s_mov_b32 s36, s10
    s_and_b32 s37, s11, 0xffff
    s_mov_b32 s38, 2097152
    s_mov_b32 s39, 0x20000
    s_mov_b32 s44, s22
    s_and_b32 s45, s23, 0xffff
    s_mov_b32 s46, 4194304
    s_mov_b32 s47, 0x20000
    s_mov_b32 s52, s20
    s_and_b32 s53, s21, 0xffff
    s_mov_b32 s54, 7340032
    s_mov_b32 s55, 0x20000
    s_cmp_eq_u32 s64, 0
    s_cselect_b32 s48, s16, s18
    s_cselect_b32 s49, s17, s19
    s_and_b32 s49, s49, 0xffff
    s_mov_b32 s51, 0x20000
    s_cmp_lt_u32 s97, 14
    s_cselect_b32 s50, 7340032, 0
    s_cselect_b32 s54, 7340032, 0
    v_bfe_u32 v4, v2, 1, 3
    v_xor_b32 v4, v4, v3
    v_lshlrev_b32_e64 v4, 4, v4
    v_lshl_add_u32 v72, v2, 7, v4
    v_bfe_u32 v4, v1, 2, 2
    v_lshl_add_u32 v5, v3, 3, v4
    v_lshlrev_b32 v5, 7, v5
    v_lshrrev_b32 v4, 1, v4
    v_xor_b32_e64 v4, s64, v4
    v_lshl_add_u32 v5, v4, 6, v5
    v_bfe_u32 v4, v1, 4, 1
    v_xor_b32_e64 v4, v4, v3
    v_lshl_add_u32 v5, v4, 5, v5
    v_and_b32_e64 v4, 3, v1
    v_lshl_add_u32 v5, v4, 3, v5
    s_mul_i32 s76, s62, 10240
    s_sub_u32 s76, 4096, s76
    v_add_u32 v73, s76, v5
    v_lshlrev_b32 v74, 3, v2
    v_lshrrev_b32 v4, 4, v1
    v_and_b32 v5, 15, v1
    v_mul_u32_u24 v66, 28800, v4
    v_lshl_add_u32 v66, v5, 4, v66
    v_mul_u32_u24 v75, 460800, v4
    v_lshl_add_u32 v75, v5, 4, v75
    s_lshr_b32 s76, s60, 3
    s_lshl_b32 s76, s76, 2
    v_lshl_add_u32 v6, v4, 3, s76
    s_mov_b32 s69, 0
    v_mov_b32 v7, 0x654210b3
    v_bfe_u32 v7, v7, v6, 4
    v_mul_u32_u24 v7, 28800, v7
    v_lshl_add_u32 v66, v5, 4, v7
    v_mov_b32 v7, 0xfedca987
    v_bfe_u32 v7, v7, v6, 4
    v_mul_u32_u24 v7, 28800, v7
    v_lshl_add_u32 v67, v5, 4, v7
    v_mov_b32 v80, 0
    v_mov_b32 v81, 0
    v_mov_b32 v82, 0
    v_mov_b32 v83, 0
    v_lshrrev_b32 v4, 4, v1
    v_and_b32_e64 v5, 15, v1
    v_mul_u32_u24 v76, 114688, v4
    v_lshl_add_u32 v76, v5, 4, v76
    v_lshlrev_b32_e64 v77, 4, v2
    v_lshl_add_u32 v77, v3, 11, v77
    s_mul_i32 s75, s98, 458752
    s_lshl_b32 s77, s97, 9
    s_add_u32 s75, s75, s77
    s_lshl_b32 s77, s63, 8
    s_add_u32 s75, s75, s77
    s_lshl_b32 s96, s97, 19
    s_lshl_b32 s77, s98, 15
    s_add_u32 s96, s96, s77
    s_lshl_b32 s77, s62, 9
    s_add_u32 s96, s96, s77
    s_mov_b32 s68, 1
    s_getreg_b32 s101, hwreg(HW_REG_XCC_ID, 0, 4)
    s_lshl_b32 s76, s61, 8
    s_add_u32 s76, s76, 12582912
    s_lshl_b32 s77, s60, 8
    s_add_u32 s77, s77, 12586752
    s_lshr_b32 s78, s97, 1
    s_lshl_b32 s78, s78, 9
    s_add_u32 s78, s78, 12590592
    v_mov_b32 v4, s76
    v_mov_b32 v5, s77
    v_mov_b32 v6, s78
    v_cmp_gt_u32 vcc, 16, v1
    s_nop 1
    v_cndmask_b32 v4, v5, v4, vcc
    v_cmp_gt_u32 vcc, 32, v1
    s_nop 1
    v_cndmask_b32 v4, v6, v4, vcc
    v_add_u32_e64 v90, v4, v12
    s_waitcnt vmcnt(9)
    s_barrier
L_hloop:
    s_and_b32 s77, s86, 15
    s_cbranch_scc1 L_event
L_evret:
    s_add_u32 m0, s70, 8192
    s_nop 0
    buffer_load_dwordx4 v25, s[32:35], s72 offen offset:1024 lds
    s_add_u32 s70, s70, 40960
    s_cmp_ge_u32 s70, 122880
    s_cselect_b32 s76, 122880, 0
    s_sub_u32 s70, s70, s76
    s_and_b32 s72, s84, 15
    s_mov_b32 m0, s70
    s_lshl_b32 s71, s72, 7
    buffer_load_dwordx4 v16, s[28:31], s71 offen offset:0 lds
    s_mul_i32 s72, s72, 393216
    s_lshr_b64 s[84:85], s[84:85], 4
    buffer_load_dwordx4 v17, s[28:31], s71 offen offset:1024 lds
    buffer_load_dwordx4 v18, s[28:31], s71 offen offset:2048 lds
    buffer_load_dwordx4 v19, s[28:31], s71 offen offset:3072 lds
    s_add_u32 m0, s70, 4096
    s_nop 0
    buffer_load_dwordx4 v20, s[32:35], s72 offen offset:0 lds
    buffer_load_dwordx4 v21, s[32:35], s72 offen offset:1024 lds
    buffer_load_dwordx4 v22, s[32:35], s72 offen offset:2048 lds
    buffer_load_dwordx4 v23, s[32:35], s72 offen offset:3072 lds
    s_add_u32 m0, s70, 8192
    s_nop 0
    buffer_load_dwordx4 v24, s[32:35], s72 offen offset:0 lds
L_hw10:
    s_waitcnt vmcnt(9)
L_hbar:
    s_lshr_b64 s[86:87], s[86:87], 4
    s_add_u32 s68, s68, 1
    s_cmp_lt_u32 s68, 14
    s_barrier
    s_cbranch_scc1 L_hloop
L_hdone:
    s_add_u32 m0, s70, 8192
    s_nop 0
    buffer_load_dwordx4 v25, s[32:35], s72 offen offset:1024 lds
    s_add_u32 s70, s70, 40960
    s_cmp_ge_u32 s70, 122880
    s_cselect_b32 s76, 122880, 0
    s_sub_u32 s70, s70, s76
    v_add_co_u32 v88, vcc, 1, v88
    s_nop 1
    v_addc_co_u32 v89, vcc, 0, v89, vcc
    v_cmp_ne_u64 vcc, v[92:93], v[88:89]
    s_nop 0
    s_cbranch_vccz L_hello_ok_1
    s_mov_b32 s88, 0
L_spin_2:
    buffer_load_dwordx4 v[92:95], v90, s[40:43], 0 offen sc1
    s_waitcnt vmcnt(0)
    v_cmp_ne_u64 vcc, v[92:93], v[88:89]
    s_nop 0
    s_cbranch_vccz L_hello_ok_1
    s_add_u32 s88, s88, 1
    s_cmp_lt_u32 s88, 65536
    s_cbranch_scc1 L_spin_2
L_hello_ok_1:
    v_cmp_ne_u32_e64 vcc, s101, v94
    s_nop 0
    s_and_b32 s76, vcc_lo, 0xffff
    s_cselect_b32 s100, 0, 1
    s_cmp_eq_u32 vcc_hi, 0
    s_cselect_b32 s76, 2, 0
    s_or_b32 s100, s100, s76
    v_mov_b32 v4, s100
    v_mov_b32 v5, 0
    ds_write_b32 v5, v4 offset:53248
    s_lshl_b32 s81, s62, 8
    s_mul_i32 s80, s60, 460800
    s_add_u32 s80, s80, s81
    buffer_load_dwordx4 v[32:35], v66, s[40:43], s80 offen offset:0 sc1
    buffer_load_dwordx4 v[36:39], v67, s[40:43], s80 offen offset:0 sc1
    s_mul_i32 s80, s61, 28800
    s_add_u32 s80, s80, s81
    s_bitcmp1_b32 s2, 7
    s_cselect_b32 s79, 0, 3686400
    s_add_u32 s80, s80, s79
    buffer_load_dwordx4 v[48:51], v75, s[40:43], s80 offen offset:1024 sc1
    s_add_u32 s80, s80, 1843200
    buffer_load_dwordx4 v[52:55], v75, s[40:43], s80 offen offset:1024 sc1
    v_bfe_u32 v10, v1, 4, 1
    v_lshl_add_u32 v10, v10, 1, v3
    v_min_u32 v10, 2, v10
    v_and_b32 v7, 15, v1
    v_lshlrev_b32_e64 v7, 3, v7
    s_lshl_b32 s76, s62, 7
    v_lshl_add_u32 v10, v10, 9, v7
    v_add_u32_e64 v64, s76, v10
    v_lshl_add_u32 v65, v7, 1, s81
    v_bfe_u32 v10, v1, 4, 1
    v_lshl_add_u32 v65, v10, 3, v65
    s_mul_i32 s78, s62, 2048
    s_add_u32 s78, s78, s99
    s_add_u32 s78, s78, 1024
    v_lshlrev_b32 v11, 7, v1
    s_mov_b64 exec, 65535
    buffer_load_dword v27, v11, s[40:43], s78 offen sc1
    s_mov_b64 exec, -1
    s_add_u32 s78, s65, 0
    s_and_b32 s78, s78, 15
    s_lshl_b32 s78, s78, 17
    s_lshl_b32 s79, s62, 11
    s_add_u32 m0, s79, 57344
    s_add_u32 s79, s78, 15360
    buffer_load_dwordx4 v26, s[36:39], s78 offen lds
    buffer_load_dwordx4 v26, s[36:39], s79 offen offset:1024 lds
    s_waitcnt vmcnt(7)
    s_barrier
    s_add_u32 s78, s65, 1
    s_and_b32 s78, s78, 15
    s_lshl_b32 s78, s78, 17
    s_lshl_b32 s79, s62, 11
    s_add_u32 m0, s79, 65536
    s_add_u32 s79, s78, 15360
    buffer_load_dwordx4 v26, s[36:39], s78 offen lds
    buffer_load_dwordx4 v26, s[36:39], s79 offen offset:1024 lds
    s_setprio 3
    s_mov_b32 s88, 0
    s_waitcnt vmcnt(7)
    s_branch L_g1first_3
L_g1_4:
    s_mul_i32 s80, s60, 460800
    s_add_u32 s80, s80, s81
    buffer_load_dwordx4 v[32:35], v66, s[40:43], s80 offen offset:0 sc1
    buffer_load_dwordx4 v[36:39], v67, s[40:43], s80 offen offset:0 sc1
    s_waitcnt vmcnt(0)
L_g1first_3:
    v_max3_u32 v4, v32, v34, v36
    v_max_u32 v4, v4, v38
    v_cmp_eq_u32 vcc, -1, v4
    s_nop 0
    s_cbranch_vccz L_ok_5
    s_add_u32 s88, s88, 1
    s_cmp_lt_u32 s88, 65536
    s_cbranch_scc1 L_g1_4
L_ok_5:
    v_add_f32 v32, v32, v36
    v_add_f32 v33, v33, v37
    v_add_f32 v34, v34, v38
    v_add_f32_e64 v35, v35, v39
    s_add_u32 s78, s65, 2
    s_and_b32 s78, s78, 15
    s_lshl_b32 s78, s78, 17
    s_lshl_b32 s79, s62, 11
    s_add_u32 m0, s79, 73728
    s_add_u32 s79, s78, 15360
    buffer_load_dwordx4 v26, s[36:39], s78 offen lds
    buffer_load_dwordx4 v26, s[36:39], s79 offen offset:1024 lds
    v_permlane32_swap_b32 v32, v33
    v_permlane32_swap_b32 v34, v35
    v_add_f32 v32, v32, v33
    v_add_f32 v34, v34, v35
    s_nop 1
    v_permlane16_swap_b32 v32, v34
    v_add_f32 v32, v32, v34
    v_mov_b32 v33, v32
    s_nop 1
    v_permlane32_swap_b32 v32, v33
    v_mul_f32 v32, 0x3a800000, v32
    v_mul_f32 v33, 0x3a800000, v33
    v_fma_f32 v7, -v32, v32, v33
    v_max_f32_e64 v7, 0, v7
    v_cvt_pk_bf16_f32 v5, v32, v32
    v_and_b32_e64 v5, s90, v5
    v_cvt_pk_bf16_f32 v7, v7, v7
    v_and_b32_e64 v7, s90, v7
    v_add_f32 v7, 0x3727c5ac, v7
    v_cvt_pk_bf16_f32 v7, v7, v7
    v_and_b32 v7, s90, v7
    v_sqrt_f32_e64 v7, v7
    s_nop 0
    v_cvt_pk_bf16_f32 v7, v7, v7
    v_and_b32 v7, s90, v7
    v_rcp_f32 v9, v7
    v_xor_b32 v5, 0x80000000, v5
    v_cvt_pk_bf16_f32 v8, v5, v5
    ds_write_b64 v65, v[8:9] offset:49152
    s_mov_b32 s88, 0
    s_waitcnt vmcnt(7)
    s_branch L_g1first_6
L_g1_7:
    s_mul_i32 s80, s61, 28800
    s_add_u32 s80, s80, s81
    s_bitcmp1_b32 s2, 7
    s_cselect_b32 s79, 0, 3686400
    s_add_u32 s80, s80, s79
    buffer_load_dwordx4 v[48:51], v75, s[40:43], s80 offen offset:1024 sc1
    s_add_u32 s80, s80, 1843200
    buffer_load_dwordx4 v[52:55], v75, s[40:43], s80 offen offset:1024 sc1
    s_waitcnt vmcnt(0)
L_g1first_6:
    v_max3_u32 v4, v48, v50, v52
    v_max_u32 v4, v4, v54
    v_cmp_eq_u32 vcc, -1, v4
    s_nop 0
    s_cbranch_vccz L_ok_8
    s_add_u32 s88, s88, 1
    s_cmp_lt_u32 s88, 65536
    s_cbranch_scc1 L_g1_7
L_ok_8:
    v_add_f32 v48, v48, v52
    v_add_f32 v49, v49, v53
    v_add_f32 v50, v50, v54
    v_add_f32 v51, v51, v55
    v_add_f32 v49, v49, v51
    v_mov_b32 v51, v49
    v_permlane32_swap_b32 v48, v50
    s_nop 0
    v_permlane32_swap_b32 v49, v51
    v_add_f32 v48, v48, v50
    v_add_f32 v49, v49, v51
    s_nop 1
    v_permlane16_swap_b32 v48, v49
    v_add_f32_e64 v48, v48, v49
    v_cvt_pk_bf16_f32 v49, v48, v48
    v_and_b32 v49, s90, v49
    v_sub_f32 v49, v48, v49
    v_cvt_pk_bf16_f32 v50, v48, v49
    v_and_b32 v51, s90, v50
    v_sub_f32 v49, v49, v51
    v_cvt_pk_bf16_f32 v51, v49, 0
    ds_write_b64 v64, v[50:51] offset:50176
    s_setprio 0
    s_waitcnt lgkmcnt(0)
    s_barrier
    s_add_u32 s78, s65, 3
    s_and_b32 s78, s78, 15
    s_lshl_b32 s78, s78, 17
    s_lshl_b32 s79, s62, 11
    s_add_u32 m0, s79, 81920
    s_add_u32 s79, s78, 15360
    buffer_load_dwordx4 v26, s[36:39], s78 offen lds
    buffer_load_dwordx4 v26, s[36:39], s79 offen offset:1024 lds
    s_add_u32 s78, s65, 4
    s_and_b32 s78, s78, 15
    s_lshl_b32 s78, s78, 17
    s_lshl_b32 s79, s62, 11
    s_add_u32 m0, s79, 90112
    s_add_u32 s79, s78, 15360
    buffer_load_dwordx4 v26, s[36:39], s78 offen lds
    buffer_load_dwordx4 v26, s[36:39], s79 offen offset:1024 lds
    s_lshl_b32 s78, s62, 11
    s_add_u32 s79, s78, s99
    s_bitcmp1_b32 s100, 0
    s_cbranch_scc1 L_loc_9
    buffer_store_dwordx4 v[28:31], v12, s[40:43], s79 offen offset:1024 sc1
    buffer_store_dwordx4 v[28:31], v12, s[40:43], s79 offen offset:2048 sc1
    s_branch L_pubd_10
L_loc_9:
    buffer_store_dwordx4 v[28:31], v12, s[40:43], s79 offen offset:1024
    buffer_store_dwordx4 v[28:31], v12, s[40:43], s79 offen offset:2048
L_pubd_10:
    s_lshl_b32 s79, s62, 8
    s_add_u32 s79, s79, s99
    s_mov_b64 exec, 0xffff
    buffer_store_dwordx4 v[28:31], v12, s[40:43], s79 offen sc1
    s_mov_b64 exec, -1
    s_add_u32 s78, s65, 5
    s_and_b32 s78, s78, 15
    s_lshl_b32 s78, s78, 17
    s_lshl_b32 s79, s62, 11
    s_add_u32 m0, s79, 98304
    s_add_u32 s79, s78, 15360
    buffer_load_dwordx4 v26, s[36:39], s78 offen lds
    buffer_load_dwordx4 v26, s[36:39], s79 offen offset:1024 lds
    s_add_u32 s78, s65, 6
    s_and_b32 s78, s78, 15
    s_lshl_b32 s78, s78, 17
    s_lshl_b32 s79, s62, 11
    s_add_u32 m0, s79, 106496
    s_add_u32 s79, s78, 15360
    buffer_load_dwordx4 v26, s[36:39], s78 offen lds
    buffer_load_dwordx4 v26, s[36:39], s79 offen offset:1024 lds
    s_add_u32 s78, s65, 7
    s_and_b32 s78, s78, 15
    s_lshl_b32 s78, s78, 17
    s_lshl_b32 s79, s62, 11
    s_add_u32 m0, s79, 114688
    s_add_u32 s79, s78, 15360
    buffer_load_dwordx4 v26, s[36:39], s78 offen lds
    buffer_load_dwordx4 v26, s[36:39], s79 offen offset:1024 lds
    s_mul_i32 s78, s62, 384
    s_add_u32 s78, s78, s73
    s_add_u32 s78, s78, 2048
    v_lshlrev_b32 v11, 7, v1
    s_mov_b64 exec, 7
    buffer_load_dword v27, v11, s[40:43], s78 offen sc1
    s_mov_b64 exec, -1
    s_waitcnt vmcnt(7)
    s_lshl_b32 s76, s62, 2
    s_add_u32 s76, s76, s73
    v_mov_b32 v4, 0
    s_mov_b64 exec, 1
    s_bitcmp1_b32 s100, 0
    s_cbranch_scc1 L_loc_11
    buffer_store_dword v4, v4, s[40:43], s76 offen offset:2560 sc1
    s_branch L_pubd_12
L_loc_11:
    buffer_store_dword v4, v4, s[40:43], s76 offen offset:2560
L_pubd_12:
    s_mov_b64 exec, -1
    s_add_u32 s78, s65, 8
    s_and_b32 s78, s78, 15
    s_lshl_b32 s78, s78, 17
    s_lshl_b32 s79, s62, 11
    s_add_u32 m0, s79, 122880
    s_add_u32 s79, s78, 15360
    buffer_load_dwordx4 v26, s[36:39], s78 offen lds
    buffer_load_dwordx4 v26, s[36:39], s79 offen offset:1024 lds
    s_add_u32 s78, s65, 9
    s_and_b32 s78, s78, 15
    s_lshl_b32 s78, s78, 17
    s_lshl_b32 s79, s62, 11
    s_add_u32 m0, s79, 131072
    s_add_u32 s79, s78, 15360
    buffer_load_dwordx4 v26, s[36:39], s78 offen lds
    buffer_load_dwordx4 v26, s[36:39], s79 offen offset:1024 lds
    s_add_u32 s78, s65, 10
    s_and_b32 s78, s78, 15
    s_lshl_b32 s78, s78, 17
    s_lshl_b32 s79, s62, 11
    s_add_u32 m0, s79, 139264
    s_add_u32 s79, s78, 15360
    buffer_load_dwordx4 v26, s[36:39], s78 offen lds
    buffer_load_dwordx4 v26, s[36:39], s79 offen offset:1024 lds
    v_and_b32_e64 v65, 15, v1
    v_mul_u32_u24 v65, 460800, v65
    s_mul_i32 s80, s61, 28800
    s_lshl_b32 s82, s62, 2
    s_add_u32 s82, s82, s80
    v_bfe_u32 v4, v1, 4, 1
    v_lshl_add_u32 v4, v4, 1, v3
    s_lshl_b32 s77, s62, 6
    v_lshl_add_u32 v66, v4, 1, s77
    v_bfe_u32 v4, v1, 2, 1
    v_lshl_add_u32 v66, v4, 5, v66
    v_bfe_u32 v4, v1, 0, 1
    v_lshl_add_u32 v66, v4, 4, v66
    v_bfe_u32 v4, v1, 1, 1
    v_lshl_add_u32 v66, v4, 3, v66
    s_lshl_b32 s83, s62, 7
    s_add_u32 s81, s83, s80
    s_add_u32 s68, s81, 3686400
    s_add_u32 s83, s83, s73
    v_and_b32 v4, 7, v1
    v_lshrrev_b32 v5, 4, v1
    v_lshlrev_b32_e64 v5, 2, v5
    v_lshl_add_u32 v67, v4, 4, v5
    v_bfe_u32 v5, v1, 3, 1
    v_lshrrev_b32_e64 v6, 4, v1
    v_lshl_add_u32 v5, v5, 4, v6
    v_mul_u32_u24 v5, 9344, v5
    v_lshl_add_u32 v61, v4, 4, v5
    s_lshr_b32 s69, s97, 1
    s_lshr_b32 s76, s2, 7
    s_lshl2_add_u32 s69, s69, s76
    s_mul_i32 s69, s69, 74752
    s_add_u32 s69, s69, 8389632
    s_barrier
    s_add_u32 s78, s65, 11
    s_and_b32 s78, s78, 15
    s_lshl_b32 s78, s78, 17
    s_lshl_b32 s79, s62, 11
    s_add_u32 m0, s79, 147456
    s_add_u32 s79, s78, 15360
    buffer_load_dwordx4 v26, s[36:39], s78 offen lds
    buffer_load_dwordx4 v26, s[36:39], s79 offen offset:1024 lds
    s_add_u32 s78, s65, 12
    s_and_b32 s78, s78, 15
    s_lshl_b32 s78, s78, 17
    s_lshl_b32 s79, s62, 11
    s_add_u32 m0, s79, 155648
    s_add_u32 s79, s78, 15360
    buffer_load_dwordx4 v26, s[36:39], s78 offen lds
    buffer_load_dwordx4 v26, s[36:39], s79 offen offset:1024 lds
    buffer_load_dword v64, v65, s[40:43], s82 offen offset:2560 sc1
    s_barrier
    s_setprio 3
    v_mov_b32 v4, s89
    v_lshlrev_b32 v5, 2, v1
    ds_write_b32 v5, v4 offset:24832
    v_mov_b32 v70, 0
    v_mov_b32 v71, 0
    ds_write_b64 v70, v[70:71] offset:25984
    s_mov_b32 s88, 0
    s_branch L_p2first_13
L_p2_14:
    buffer_load_dword v64, v65, s[40:43], s82 offen offset:2560 sc1
L_p2first_13:
    s_waitcnt vmcnt(0)
    v_cmp_eq_u32_e64 vcc, -1, v64
    s_nop 0
    s_cbranch_vccz L_ok_15
    s_add_u32 s88, s88, 1
    s_cmp_lt_u32 s88, 65536
    s_cbranch_scc1 L_p2_14
L_ok_15:
    s_add_u32 s78, s65, 13
    s_and_b32 s78, s78, 15
    s_lshl_b32 s78, s78, 17
    s_lshl_b32 s79, s62, 11
    s_add_u32 m0, s79, 32768
    s_add_u32 s79, s78, 15360
    buffer_load_dwordx4 v26, s[36:39], s78 offen lds
    buffer_load_dwordx4 v26, s[36:39], s79 offen offset:1024 lds
    s_add_u32 s78, s65, 14
    s_and_b32 s78, s78, 15
    s_lshl_b32 s78, s78, 17
    s_lshl_b32 s79, s62, 11
    s_add_u32 m0, s79, 40960
    s_add_u32 s79, s78, 15360
    buffer_load_dwordx4 v26, s[36:39], s78 offen lds
    buffer_load_dwordx4 v26, s[36:39], s79 offen offset:1024 lds
    s_add_u32 s78, s65, 15
    s_and_b32 s78, s78, 15
    s_lshl_b32 s78, s78, 17
    s_lshl_b32 s79, s62, 11
    s_add_u32 m0, s79, 49152
    s_add_u32 s79, s78, 15360
    buffer_load_dwordx4 v26, s[36:39], s78 offen lds
    buffer_load_dwordx4 v26, s[36:39], s79 offen offset:1024 lds
    s_lshl_b32 s76, s62, 11
    s_lshl_b32 s77, s60, 7
    s_add_u32 s76, s76, s77
    s_add_u32 s76, s76, s69
    s_add_u32 s77, s76, 37376
    s_mov_b32 s78, 0x00003f80
    s_mov_b32 s79, 0x3f800000
    s_mov_b32 s88, 0
L_poll_16:
    buffer_load_dwordx4 v[32:35], v61, s[40:43], s76 offen sc1
    buffer_load_dwordx4 v[36:39], v61, s[40:43], s77 offen sc1
    s_waitcnt vmcnt(0)
    v_max_u32 v4, v32, v36
    v_cmp_eq_u32_e64 vcc, -1, v4
    s_nop 0
    s_cbranch_vccz L_ok_17
    s_add_u32 s88, s88, 1
    s_cmp_lt_u32 s88, 65536
    s_cbranch_scc1 L_poll_16
L_ok_17:
    v_dot2_f32_bf16 v48, v32, s78, 0
    v_dot2_f32_bf16 v49, v32, s79, 0
    v_dot2_f32_bf16 v50, v33, s78, 0
    v_dot2_f32_bf16 v51, v33, s79, 0
    v_dot2_f32_bf16 v52, v34, s78, 0
    v_dot2_f32_bf16 v53, v34, s79, 0
    v_dot2_f32_bf16 v54, v35, s78, 0
    v_dot2_f32_bf16 v55, v35, s79, 0
    v_dot2_f32_bf16 v48, v36, s78, v48
    v_dot2_f32_bf16 v49, v36, s79, v49
    v_dot2_f32_bf16 v50, v37, s78, v50
    v_dot2_f32_bf16 v51, v37, s79, v51
    v_dot2_f32_bf16 v52, v38, s78, v52
    v_dot2_f32_bf16 v53, v38, s79, v53
    v_dot2_f32_bf16 v54, v39, s78, v54
    v_dot2_f32_bf16 v55, v39, s79, v55
    buffer_load_dwordx4 v[40:43], v13, s[40:43], s81 offen offset:2048 sc1
    buffer_load_dwordx4 v[44:47], v13, s[40:43], s68 offen offset:2048 sc1
    v_permlane32_swap_b32 v48, v52
    v_permlane32_swap_b32 v49, v53
    v_permlane32_swap_b32 v50, v54
    v_permlane32_swap_b32 v51, v55
    v_add_f32 v48, v48, v52
    v_add_f32 v49, v49, v53
    v_add_f32 v50, v50, v54
    v_add_f32 v51, v51, v55
    s_nop 0
    v_permlane16_swap_b32 v48, v50
    v_permlane16_swap_b32 v49, v51
    v_add_f32 v48, v48, v50
    v_add_f32_e64 v49, v49, v51
    s_nop 0
    v_add_f32_dpp v48, v48, v48 row_ror:8 row_mask:0xf bank_mask:0xf
    v_add_f32_dpp v49, v49, v49 row_ror:8 row_mask:0xf bank_mask:0xf
    v_cvt_pk_bf16_f32 v48, v48, v49
    s_bitcmp1_b32 s100, 0
    s_cbranch_scc1 L_loc_18
    buffer_store_dword v48, v67, s[40:43], s83 offen offset:3072 sc1
    s_branch L_pubd_19
L_loc_18:
    buffer_store_dword v48, v67, s[40:43], s83 offen offset:3072
L_pubd_19:
    s_mov_b32 s88, 0
    s_waitcnt vmcnt(1)
    s_branch L_zfirst_20
L_z_21:
    buffer_load_dwordx4 v[40:43], v13, s[40:43], s81 offen offset:2048 sc1
    buffer_load_dwordx4 v[44:47], v13, s[40:43], s68 offen offset:2048 sc1
    s_waitcnt vmcnt(0)
L_zfirst_20:
    v_max3_u32 v4, v40, v41, v42
    v_max3_u32 v4, v4, v43, v44
    v_max3_u32 v4, v4, v45, v46
    v_max_u32 v4, v4, v47
    v_cmp_eq_u32 vcc, -1, v4
    s_nop 0
    s_cbranch_vccz L_ok_22
    s_add_u32 s88, s88, 1
    s_cmp_lt_u32 s88, 65536
    s_cbranch_scc1 L_z_21
L_ok_22:
    v_add_f32 v40, v40, v44
    v_add_f32 v41, v41, v45
    v_add_f32 v42, v42, v46
    v_add_f32 v43, v43, v47
    v_permlane32_swap_b32 v40, v41
    s_nop 0
    v_permlane32_swap_b32 v42, v43
    v_add_f32 v40, v40, v41
    v_add_f32 v42, v42, v43
    s_nop 1
    v_permlane16_swap_b32 v40, v42
    v_add_f32 v40, v40, v42
    s_nop 1
    v_add_f32_dpp v40, v40, v40 row_ror:8 row_mask:0xf bank_mask:0xf
    v_cvt_pk_bf16_f32 v40, v40, v40
    ds_write_b16 v66, v40 offset:24576
    s_waitcnt lgkmcnt(0)
    s_barrier
    s_setprio 0
    s_mov_b64 exec, 3
    global_load_dword v27, v91, s[66:67]
    s_mov_b64 exec, -1
    s_lshl_b32 s78, s97, 18
    s_lshl_b32 s79, s62, 16
    s_add_u32 s78, s78, s79
    s_lshl_b32 s79, s98, 7
    s_add_u32 s78, s78, s79
    s_lshl_b32 s79, s62, 12
    s_add_u32 m0, s79, 0
    s_nop 0
    buffer_load_dwordx4 v78, s[28:31], s78 offen offset:0 lds
    s_add_u32 s78, s78, 15360
    buffer_load_dwordx4 v79, s[28:31], s78 offen offset:1024 lds
    s_add_u32 s78, s78, 15360
    buffer_load_dwordx4 v78, s[28:31], s78 offen offset:2048 lds
    s_add_u32 s78, s78, 15360
    buffer_load_dwordx4 v79, s[28:31], s78 offen offset:3072 lds
    s_mov_b32 s56, s14
    s_and_b32 s57, s15, 0xffff
    s_mov_b32 s58, 2048
    s_mov_b32 s59, 0x20000
    s_lshl_b32 s78, s62, 9
    s_add_u32 m0, s78, 16384
    s_mov_b32 exec_hi, 0
    buffer_load_dwordx4 v12, s[56:59], s78 offen lds
    s_mov_b64 exec, -1
    s_barrier
    s_lshl4_add_u32 s76, s97, s98
    s_mul_i32 s76, s76, 28800
    s_add_u32 s20, s26, s76
    s_addc_u32 s21, s27, 0
    s_cmp_eq_u32 s62, 0
    s_cbranch_scc0 L_now0_25
    s_load_dwordx16 s[4:19], s[20:21], 3584 glc
    s_waitcnt lgkmcnt(0)
    s_and_b64 s[4:5], s[4:5], s[6:7]
    s_and_b64 s[4:5], s[4:5], s[8:9]
    s_and_b64 s[4:5], s[4:5], s[10:11]
    s_and_b64 s[4:5], s[4:5], s[12:13]
    s_and_b64 s[4:5], s[4:5], s[14:15]
    s_and_b64 s[4:5], s[4:5], s[16:17]
    s_and_b64 s[4:5], s[4:5], s[18:19]
    s_nand_b32 s4, s4, s5
    s_and_b32 s4, s4, 0xffff
    s_mul_i32 s4, s4, 0x10001
    s_lshr_b32 s4, s4, s65
    s_and_b32 s77, s4, 0xffff
    v_mov_b32_e64 v69, s77
    s_mov_b64 exec, 1
    ds_or_b32 v70, v69 offset:25984
    s_mov_b64 exec, -1
    s_waitcnt vmcnt(0) lgkmcnt(0)
    s_load_dwordx16 s[4:19], s[20:21], 3584 glc
    s_barrier
    s_mov_b32 s88, 0
    s_branch L_fo2
L_now0_25:
    s_waitcnt vmcnt(0) lgkmcnt(0)
    s_barrier
    s_cmp_eq_u32 s62, 0
    s_cbranch_scc0 L_now1_23
    s_mov_b32 s88, 0
L_spin_26:
    s_load_dwordx16 s[4:19], s[20:21], 3584 glc
L_fo2:
    s_waitcnt lgkmcnt(0)
    s_and_b64 s[4:5], s[4:5], s[6:7]
    s_and_b64 s[4:5], s[4:5], s[8:9]
    s_and_b64 s[4:5], s[4:5], s[10:11]
    s_and_b64 s[4:5], s[4:5], s[12:13]
    s_and_b64 s[4:5], s[4:5], s[14:15]
    s_and_b64 s[4:5], s[4:5], s[16:17]
    s_and_b64 s[4:5], s[4:5], s[18:19]
    s_nand_b32 s4, s4, s5
    s_and_b32 s4, s4, 0xffff
    s_mul_i32 s4, s4, 0x10001
    s_lshr_b32 s4, s4, s65
    s_and_b32 s77, s4, 0xffff
    v_mov_b32 v69, s77
    s_mov_b64 exec, 1
    ds_or_b32 v70, v69 offset:25984
    s_mov_b64 exec, -1
    s_cmp_eq_u32 s77, 0xffff
    s_cbranch_scc1 L_s2done_24
    s_add_u32 s88, s88, 1
    s_cmp_lt_u32 s88, 65536
    s_cbranch_scc1 L_spin_26
    s_branch L_s2done_24
L_now1_23:
    s_cmp_eq_u32 s62, 1
    s_cbranch_scc0 L_s2done_24
    s_lshl_b32 s77, 1, s61
    s_not_b32 s77, s77
    v_mov_b32 v4, s77
    v_mul_u32_u24 v5, 28800, v1
    s_mul_i32 s76, s60, 460800
    s_lshl2_add_u32 s76, s61, s76
    s_mov_b32 s88, 0
L_spin_27:
    ds_read_b32 v69, v70 offset:25988
    s_waitcnt lgkmcnt(0)
    v_cmp_eq_u32_e64 vcc, 4, v69
    s_nop 0
    s_cbranch_vccnz L_drained_28
    s_add_u32 s88, s88, 1
    s_cmp_lt_u32 s88, 1048576
    s_cbranch_scc1 L_spin_27
L_drained_28:
    s_mov_b64 exec, 0xffff
    buffer_store_dword v4, v5, s[40:43], s76 offen offset:3584 sc1
    s_mov_b64 exec, -1
L_s2done_24:
    s_waitcnt vmcnt(0)
    s_mov_b32 s78, 0x05040100
    s_mov_b32 s79, 0x07060302
    v_perm_b32 v160, v100, v96, s78
    v_perm_b32 v164, v100, v96, s79
    v_perm_b32 v168, v101, v97, s78
    v_perm_b32 v172, v101, v97, s79
    v_perm_b32 v176, v102, v98, s78
    v_perm_b32 v180, v102, v98, s79
    v_perm_b32 v184, v103, v99, s78
    v_perm_b32 v188, v103, v99, s79
    v_perm_b32 v161, v108, v104, s78
    v_perm_b32 v165, v108, v104, s79
    v_perm_b32 v169, v109, v105, s78
    v_perm_b32 v173, v109, v105, s79
    v_perm_b32 v177, v110, v106, s78
    v_perm_b32 v181, v110, v106, s79
    v_perm_b32 v185, v111, v107, s78
    v_perm_b32 v189, v111, v107, s79
    v_perm_b32 v162, v116, v112, s78
    v_perm_b32 v166, v116, v112, s79
    v_perm_b32 v170, v117, v113, s78
    v_perm_b32 v174, v117, v113, s79
    v_perm_b32 v178, v118, v114, s78
    v_perm_b32 v182, v118, v114, s79
    v_perm_b32 v186, v119, v115, s78
    v_perm_b32 v190, v119, v115, s79
    v_perm_b32 v163, v124, v120, s78
    v_perm_b32 v167, v124, v120, s79
    v_perm_b32 v171, v125, v121, s78
    v_perm_b32 v175, v125, v121, s79
    v_perm_b32 v179, v126, v122, s78
    v_perm_b32 v183, v126, v122, s79
    v_perm_b32 v187, v127, v123, s78
    v_perm_b32 v191, v127, v123, s79
    v_perm_b32 v192, v132, v128, s78
    v_perm_b32 v196, v132, v128, s79
    v_perm_b32 v200, v133, v129, s78
    v_perm_b32 v204, v133, v129, s79
    v_perm_b32 v208, v134, v130, s78
    v_perm_b32 v212, v134, v130, s79
    v_perm_b32 v216, v135, v131, s78
    v_perm_b32 v220, v135, v131, s79
    v_perm_b32 v193, v140, v136, s78
    v_perm_b32 v197, v140, v136, s79
    v_perm_b32 v201, v141, v137, s78
    v_perm_b32 v205, v141, v137, s79
    v_perm_b32 v209, v142, v138, s78
    v_perm_b32 v213, v142, v138, s79
    v_perm_b32 v217, v143, v139, s78
    v_perm_b32 v221, v143, v139, s79
    v_perm_b32 v194, v148, v144, s78
    v_perm_b32 v198, v148, v144, s79
    v_perm_b32 v202, v149, v145, s78
    v_perm_b32 v206, v149, v145, s79
    v_perm_b32 v210, v150, v146, s78
    v_perm_b32 v214, v150, v146, s79
    v_perm_b32 v218, v151, v147, s78
    v_perm_b32 v222, v151, v147, s79
    v_perm_b32 v195, v156, v152, s78
    v_perm_b32 v199, v156, v152, s79
    v_perm_b32 v203, v157, v153, s78
    v_perm_b32 v207, v157, v153, s79
    v_perm_b32 v211, v158, v154, s78
    v_perm_b32 v215, v158, v154, s79
    v_perm_b32 v219, v159, v155, s78
    v_perm_b32 v223, v159, v155, s79
    v_lshlrev_b32 v17, 5, v2
    v_lshl_add_u32 v17, v3, 4, v17
    v_and_b32 v4, 15, v1
    v_lshrrev_b32 v5, 1, v4
    v_and_b32 v4, 1, v4
    v_lshlrev_b32 v4, 5, v4
    v_lshl_add_u32 v16, v5, 7, v4
    v_lshrrev_b32 v4, 3, v1
    v_and_b32 v5, 7, v1
    v_lshlrev_b32_e64 v5, 4, v5
    v_mul_u32_u24 v18, 9344, v4
    v_add_u32_e64 v18, v18, v5
    v_bfe_u32 v6, v1, 4, 1
    v_lshl_add_u32 v6, v6, 1, v3
    v_lshl_add_u32 v19, v6, 2, v5
    s_mul_i32 s84, s97, 149504
    s_lshl_b32 s77, s98, 7
    s_add_u32 s84, s84, s77
    s_add_u32 s84, s84, 8388608
    s_lshl_b32 s85, s62, 10
    s_add_u32 s85, s85, s99
    s_add_u32 s85, s85, 5120
    s_and_b32 s87, s97, 1
    s_lshl_b32 s87, s87, 4
    s_add_u32 s87, s87, s98
    s_lshr_b32 s86, s97, 1
    s_mul_i32 s86, s86, 299008
    s_lshl_b32 s77, s87, 7
    s_add_u32 s86, s86, s77
    s_add_u32 s86, s86, 8393728
    s_lshl_b32 s78, s62, 11
    s_add_u32 s79, s78, s99
    s_bitcmp1_b32 s100, 1
    s_cbranch_scc1 L_loc_29
    buffer_store_dwordx4 v[28:31], v12, s[40:43], s79 offen offset:1024 sc1
    buffer_store_dwordx4 v[28:31], v12, s[40:43], s79 offen offset:2048 sc1
    s_branch L_pubd_30
L_loc_29:
    buffer_store_dwordx4 v[28:31], v12, s[40:43], s79 offen offset:1024
    buffer_store_dwordx4 v[28:31], v12, s[40:43], s79 offen offset:2048
L_pubd_30:
    s_lshl4_add_u32 s78, s97, s98
    s_lshl4_add_u32 s78, s78, s62
    s_add_u32 s78, s78, 12591116
    s_waitcnt vmcnt(0)
    s_mov_b64 exec, 1
    s_bitcmp1_b32 s100, 1
    s_cbranch_scc1 L_loc_31
    buffer_store_byte v28, v70, s[40:43], s78 offen sc1
    s_branch L_pubd_32
L_loc_31:
    buffer_store_byte v28, v70, s[40:43], s78 offen
L_pubd_32:
    s_mov_b64 exec, -1
    s_cmp_eq_u32 s62, 0
    s_cbranch_scc0 L_nop3c_33
    s_mov_b32 exec_lo, 0
    s_mov_b32 s88, 0
L_spin_34:
    buffer_load_dword v4, v90, s[40:43], 0 offen offset:12 sc1
    s_waitcnt vmcnt(0)
    v_cmp_ne_u32 vcc, -1, v4
    s_nop 0
    s_cbranch_vccz L_p3ok_35
    s_add_u32 s88, s88, 1
    s_cmp_lt_u32 s88, 65536
    s_cbranch_scc1 L_spin_34
L_p3ok_35:
    s_mov_b64 exec, -1
L_nop3c_33:
    s_barrier
    buffer_load_dwordx4 v[224:227], v77, s[52:55], s96 offen nt
    s_add_u32 s96, s96, 4096
    buffer_load_dwordx4 v[228:231], v77, s[52:55], s96 offen nt
    s_add_u32 s96, s96, 4096
    buffer_load_dwordx4 v[232:235], v77, s[52:55], s96 offen nt
    s_add_u32 s96, s96, 4096
    buffer_load_dwordx4 v[236:239], v77, s[52:55], s96 offen nt
    s_add_u32 s96, s96, 4096
    buffer_load_dwordx4 v[240:243], v77, s[52:55], s96 offen nt
    s_add_u32 s96, s96, 4096
    v_mul_u32_u24 v20, 149504, v1
    s_mul_i32 s72, s98, 9344
    s_lshl2_add_u32 s72, s97, s72
    s_add_u32 s72, s72, 8388608
    s_barrier
    s_cmp_eq_u32 s62, 1
    s_cbranch_scc0 L_nopre_36
    s_mov_b64 exec, 0xffff
    buffer_store_dword v70, v20, s[40:43], s72 offen offset:768 sc1
    s_mov_b64 exec, -1
L_nopre_36:
    buffer_load_dwordx4 v[244:247], v77, s[52:55], s96 offen nt
    s_add_u32 s96, s96, 4096
    buffer_load_dwordx4 v[248:251], v77, s[52:55], s96 offen nt
    s_add_u32 s96, s96, 4096
    buffer_load_dwordx4 v[252:255], v77, s[52:55], s96 offen nt
    s_add_u32 s96, s96, 4096
    s_barrier
    s_waitcnt vmcnt(7)
    s_mov_b32 s78, 0x05040100
    s_mov_b32 s79, 0x07060302
    v_permlane32_swap_b32 v224, v226
    v_permlane32_swap_b32 v225, v227
    v_perm_b32 v32, v226, v224, s78
    v_perm_b32 v33, v226, v224, s79
    v_perm_b32 v34, v227, v225, s78
    v_perm_b32 v35, v227, v225, s79
    s_waitcnt vmcnt(6)
    s_mov_b32 s78, 0x05040100
    s_mov_b32 s79, 0x07060302
    v_permlane32_swap_b32 v228, v230
    v_permlane32_swap_b32_e64 v229, v231
    v_perm_b32 v36, v230, v228, s78
    v_perm_b32 v37, v230, v228, s79
    v_perm_b32 v38, v231, v229, s78
    v_perm_b32 v39, v231, v229, s79
    s_waitcnt vmcnt(5)
    s_mov_b32 s78, 0x05040100
    s_mov_b32 s79, 0x07060302
    v_permlane32_swap_b32 v232, v234
    v_permlane32_swap_b32_e64 v233, v235
    v_perm_b32 v40, v234, v232, s78
    v_perm_b32 v41, v234, v232, s79
    v_perm_b32 v42, v235, v233, s78
    v_perm_b32 v43, v235, v233, s79
    s_waitcnt vmcnt(4)
    s_mov_b32 s78, 0x05040100
    s_mov_b32 s79, 0x07060302
    v_permlane32_swap_b32 v236, v238
    v_permlane32_swap_b32_e64 v237, v239
    v_perm_b32 v44, v238, v236, s78
    v_perm_b32 v45, v238, v236, s79
    v_perm_b32 v46, v239, v237, s78
    v_perm_b32 v47, v239, v237, s79
    s_waitcnt vmcnt(3)
    s_mov_b32 s78, 0x05040100
    s_mov_b32 s79, 0x07060302
    v_permlane32_swap_b32 v240, v242
    v_permlane32_swap_b32_e64 v241, v243
    v_perm_b32 v48, v242, v240, s78
    v_perm_b32 v49, v242, v240, s79
    v_perm_b32 v50, v243, v241, s78
    v_perm_b32 v51, v243, v241, s79
    s_waitcnt vmcnt(2)
    s_mov_b32 s78, 0x05040100
    s_mov_b32 s79, 0x07060302
    v_permlane32_swap_b32 v244, v246
    v_permlane32_swap_b32_e64 v245, v247
    v_perm_b32 v52, v246, v244, s78
    v_perm_b32 v53, v246, v244, s79
    v_perm_b32 v54, v247, v245, s78
    v_perm_b32 v55, v247, v245, s79
    s_waitcnt vmcnt(1)
    s_mov_b32 s78, 0x05040100
    s_mov_b32 s79, 0x07060302
    v_permlane32_swap_b32 v248, v250
    v_permlane32_swap_b32_e64 v249, v251
    v_perm_b32 v56, v250, v248, s78
    v_perm_b32 v57, v250, v248, s79
    v_perm_b32 v58, v251, v249, s78
    v_perm_b32 v59, v251, v249, s79
    s_waitcnt vmcnt(0)
    s_mov_b32 s78, 0x05040100
    s_mov_b32 s79, 0x07060302
    v_permlane32_swap_b32 v252, v254
    v_permlane32_swap_b32_e64 v253, v255
    v_perm_b32 v60, v254, v252, s78
    v_perm_b32 v61, v254, v252, s79
    v_perm_b32 v62, v255, v253, s78
    v_perm_b32 v63, v255, v253, s79
    v_and_b32 v5, 15, v1
    v_lshlrev_b32 v5, 3, v5
    s_lshl_b32 s76, s63, 10
    s_lshl_b32 s77, s64, 6
    s_add_u32 s76, s76, s77
    s_add_u32 s76, s76, s99
    s_mov_b64 s[80:81], 0xffff
    s_add_u32 s68, s84, 74752
    s_add_u32 s69, s86, 74752
    s_add_u32 s70, s86, 149504
    s_add_u32 s71, s86, 224256
    s_branch L_fit_ffn1
.fill 77, 4, 0xbf800000
L_fit_ffn1:
    s_setprio 3
    s_barrier
    ds_read_b128 v[64:67], v12 offset:28672
    ds_read_b128 v[68:71], v12 offset:29696
    ds_read_b64 v[8:9], v5 offset:25728
    s_waitcnt lgkmcnt(2)
    v_mfma_f32_16x16x32_bf16 v[96:99], v[64:67], v[160:163], 0
    v_mfma_f32_16x16x32_bf16 v[100:103], v[64:67], v[164:167], 0
    s_waitcnt lgkmcnt(0)
    v_max_f32_dpp v4, v8, v8 row_ror:8 row_mask:0xf bank_mask:0xf
    v_mfma_f32_16x16x32_bf16 v[104:107], v[64:67], v[168:171], 0
    v_mfma_f32_16x16x32_bf16 v[108:111], v[64:67], v[172:175], 0
    v_max_f32_dpp v4, v4, v4 row_ror:4 row_mask:0xf bank_mask:0xf
    v_mfma_f32_16x16x32_bf16 v[112:115], v[64:67], v[176:179], 0
    v_mfma_f32_16x16x32_bf16 v[116:119], v[64:67], v[180:183], 0
    v_max_f32_dpp v4, v4, v4 row_ror:2 row_mask:0xf bank_mask:0xf
    v_mfma_f32_16x16x32_bf16 v[120:123], v[64:67], v[184:187], 0
    v_mfma_f32_16x16x32_bf16 v[124:127], v[64:67], v[188:191], 0
    v_max_f32_dpp v4, v4, v4 row_ror:1 row_mask:0xf bank_mask:0xf
    v_mfma_f32_16x16x32_bf16 v[96:99], v[68:71], v[192:195], v[96:99]
    v_cmp_eq_f32_e64 vcc, v4, v8
    v_mfma_f32_16x16x32_bf16 v[100:103], v[68:71], v[196:199], v[100:103]
    s_ff1_i32_b32 s92, vcc_lo
    s_and_b32 s92, s92, 15
    v_mfma_f32_16x16x32_bf16 v[104:107], v[68:71], v[200:203], v[104:107]
    s_lshr_b32 s78, s92, 2
    s_lshl_b32 s78, s78, 4
    v_mfma_f32_16x16x32_bf16 v[108:111], v[68:71], v[204:207], v[108:111]
    s_and_b32 s77, s92, 3
    v_mfma_f32_16x16x32_bf16 v[112:115], v[68:71], v[208:211], v[112:115]
    v_readlane_b32 s91, v9, s92
    v_readlane_b32 s93, v8, s92
    v_mfma_f32_16x16x32_bf16 v[116:119], v[68:71], v[212:215], v[116:119]
    v_mfma_f32_16x16x32_bf16 v[120:123], v[68:71], v[216:219], v[120:123]
    v_mfma_f32_16x16x32_bf16 v[124:127], v[68:71], v[220:223], v[124:127]
    s_cmp_ge_u32 s97, 14
    s_cbranch_scc1 L_final
    s_cmp_eq_u32 s77, 0
    s_cbranch_scc0 L_sel_38
    v_mov_b32 v64, v96
    v_mov_b32 v65, v100
    v_mov_b32 v66, v104
    v_mov_b32 v67, v108
    v_mov_b32 v68, v112
    v_mov_b32 v69, v116
    v_mov_b32 v70, v120
    v_mov_b32 v71, v124
    s_branch L_seldone_37
L_sel_38:
    s_cmp_eq_u32 s77, 1
    s_cbranch_scc0 L_sel_39
    v_mov_b32 v64, v97
    v_mov_b32 v65, v101
    v_mov_b32 v66, v105
    v_mov_b32 v67, v109
    v_mov_b32 v68, v113
    v_mov_b32 v69, v117
    v_mov_b32 v70, v121
    v_mov_b32 v71, v125
    s_branch L_seldone_37
L_sel_39:
    s_cmp_eq_u32 s77, 2
    s_cbranch_scc0 L_sel_40
    v_mov_b32 v64, v98
    v_mov_b32 v65, v102
    v_mov_b32 v66, v106
    v_mov_b32 v67, v110
    v_mov_b32 v68, v114
    v_mov_b32 v69, v118
    v_mov_b32 v70, v122
    v_mov_b32 v71, v126
    s_branch L_seldone_37
L_sel_40:
    v_mov_b32 v64, v99
    v_mov_b32 v65, v103
    v_mov_b32 v66, v107
    v_mov_b32 v67, v111
    v_mov_b32 v68, v115
    v_mov_b32 v69, v119
    v_mov_b32 v70, v123
    v_mov_b32_e64 v71, v127
L_seldone_37:
    s_lshl_b64 exec, s[80:81], s78
    s_bitcmp1_b32 s100, 1
    s_cbranch_scc1 L_loc_42
    buffer_store_dwordx4 v[64:67], v16, s[40:43], s76 offen offset:3072 sc1
    buffer_store_dwordx4 v[68:71], v16, s[40:43], s76 offen offset:3088 sc1
    s_branch L_pubd_43
L_loc_42:
    buffer_store_dwordx4 v[64:67], v16, s[40:43], s76 offen offset:3072
    buffer_store_dwordx4 v[68:71], v16, s[40:43], s76 offen offset:3088
L_pubd_43:
    s_mov_b64 exec, -1
    s_branch L_fit_ffn2
.fill 137, 4, 0xbf800000
L_fit_ffn2:
    s_mov_b32 s88, 0
L_poll_44:
    buffer_load_dwordx4 v[128:131], v18, s[40:43], s84 offen offset:3072 sc1
    buffer_load_dwordx4 v[132:135], v18, s[40:43], s68 offen offset:3072 sc1
    s_waitcnt vmcnt(0)
    v_max_u32 v4, v128, v132
    v_cmp_eq_u32_e64 vcc, -1, v4
    s_nop 0
    s_cbranch_vccz L_ok_45
    s_add_u32 s88, s88, 1
    s_cmp_lt_u32 s88, 65536
    s_cbranch_scc1 L_poll_44
L_ok_45:
    v_pk_add_f32 v[152:153], v[128:129], v[132:133]
    v_pk_add_f32 v[154:155], v[130:131], v[134:135]
    s_nop 0
    v_permlane32_swap_b32 v152, v153
    v_permlane32_swap_b32 v154, v155
    v_add_f32 v152, v152, v153
    v_add_f32 v154, v154, v155
    s_nop 1
    v_permlane16_swap_b32 v152, v154
    v_add_f32 v152, v152, v154
    s_nop 1
    v_add_f32_dpp v152, v152, v152 row_ror:8 row_mask:0xf bank_mask:0xf
    v_cvt_pk_bf16_f32 v152, v152, v152
    v_and_b32_e64 v152, s90, v152
    v_mul_f32 v4, 0xbfb8aa3b, v152
    v_exp_f32_e64 v4, v4
    v_mov_b32_dpp v153, v152 row_ror:12 row_mask:0xf bank_mask:0xf
    v_add_f32 v4, 1.0, v4
    v_rcp_f32 v4, v4
    s_nop 0
    v_mul_f32 v4, v4, v152
    v_cvt_pk_bf16_f32 v4, v4, v4
    v_and_b32 v4, s90, v4
    v_mul_f32 v4, v4, v153
    v_mov_b32 v5, v4
    s_nop 1
    v_permlane32_swap_b32_e64 v4, v5
    v_cvt_pk_bf16_f32 v4, v4, v5
    s_nop 0
    v_readlane_b32 s76, v4, 0
    v_readlane_b32 s77, v4, 16
    v_readlane_b32 s78, v4, 1
    v_readlane_b32 s79, v4, 17
    v_readlane_b32 s80, v4, 2
    v_readlane_b32 s81, v4, 18
    v_readlane_b32 s82, v4, 3
    v_readlane_b32 s83, v4, 19
    v_dot2_f32_bf16 v20, v32, s76, 0
    v_dot2_f32_bf16 v21, v33, s76, 0
    v_dot2_f32_bf16 v22, v34, s76, 0
    v_dot2_f32_bf16 v23, v35, s76, 0
    v_dot2_f32_bf16 v20, v36, s77, v20
    v_dot2_f32_bf16 v21, v37, s77, v21
    v_dot2_f32_bf16 v22, v38, s77, v22
    v_dot2_f32_bf16 v23, v39, s77, v23
    v_dot2_f32_bf16 v20, v40, s78, v20
    v_dot2_f32_bf16 v21, v41, s78, v21
    v_dot2_f32_bf16 v22, v42, s78, v22
    v_dot2_f32_bf16 v23, v43, s78, v23
    v_dot2_f32_bf16 v20, v44, s79, v20
    v_dot2_f32_bf16 v21, v45, s79, v21
    v_dot2_f32_bf16 v22, v46, s79, v22
    v_dot2_f32_bf16 v23, v47, s79, v23
    v_dot2_f32_bf16 v20, v48, s80, v20
    v_dot2_f32_bf16 v21, v49, s80, v21
    v_dot2_f32_bf16 v22, v50, s80, v22
    v_dot2_f32_bf16 v23, v51, s80, v23
    v_dot2_f32_bf16 v20, v52, s81, v20
    v_dot2_f32_bf16 v21, v53, s81, v21
    v_dot2_f32_bf16 v22, v54, s81, v22
    v_dot2_f32_bf16 v23, v55, s81, v23
    v_dot2_f32_bf16 v20, v56, s82, v20
    v_dot2_f32_bf16 v21, v57, s82, v21
    v_dot2_f32_bf16 v22, v58, s82, v22
    v_dot2_f32_bf16 v23, v59, s82, v23
    v_dot2_f32_bf16 v20, v60, s83, v20
    v_dot2_f32_bf16 v21, v61, s83, v21
    v_dot2_f32_bf16 v22, v62, s83, v22
    v_dot2_f32_bf16 v23, v63, s83, v23
    s_bitcmp1_b32 s100, 1
    s_cbranch_scc1 L_loc_46
    s_nop 0
    buffer_store_dwordx4 v[20:23], v17, s[40:43], s85 offen sc1
    s_branch L_pubd_47
L_loc_46:
    s_nop 0
    buffer_store_dwordx4 v[20:23], v17, s[40:43], s85 offen
L_pubd_47:
    s_cmp_eq_u32 s62, 0
    s_cbranch_scc0 L_hby
    s_mov_b32 s88, 0
L_poll_48:
    buffer_load_dwordx4 v[136:139], v18, s[40:43], s86 offen sc1
    buffer_load_dwordx4 v[140:143], v18, s[40:43], s69 offen sc1
    buffer_load_dwordx4 v[144:147], v18, s[40:43], s70 offen sc1
    buffer_load_dwordx4 v[148:151], v18, s[40:43], s71 offen sc1
    s_waitcnt vmcnt(0)
    v_max3_u32 v4, v136, v140, v144
    v_max_u32 v4, v4, v148
    v_cmp_eq_u32_e64 vcc, -1, v4
    s_nop 0
    s_cbranch_vccz L_ok_49
    s_add_u32 s88, s88, 1
    s_cmp_lt_u32 s88, 65536
    s_cbranch_scc1 L_poll_48
L_ok_49:
    v_pk_add_f32 v[152:153], v[136:137], v[144:145]
    v_pk_add_f32 v[154:155], v[138:139], v[146:147]
    v_pk_add_f32 v[156:157], v[140:141], v[148:149]
    v_pk_add_f32 v[158:159], v[142:143], v[150:151]
    v_pk_add_f32 v[152:153], v[152:153], v[156:157]
    v_pk_add_f32 v[154:155], v[154:155], v[158:159]
    s_nop 0
    v_permlane32_swap_b32 v152, v153
    v_permlane32_swap_b32 v154, v155
    v_add_f32 v152, v152, v153
    v_add_f32 v154, v154, v155
    s_nop 1
    v_permlane16_swap_b32 v152, v154
    v_add_f32 v152, v152, v154
    s_nop 1
    v_add_f32_dpp v152, v152, v152 row_ror:8 row_mask:0xf bank_mask:0xf
    buffer_store_dword v152, v19, s[40:43], s99 offen offset:512 sc1
L_hby:
    s_barrier
    s_lshl2_add_u32 s72, s87, s62
    s_cmp_eq_u32 s72, 0
    s_cbranch_scc0 L_nowb_50
    s_waitcnt vmcnt(0)
    buffer_wbl2 sc1
L_nowb_50:
    s_branch L_hfin
L_final:
    s_barrier
    s_lshl2_add_u32 s72, s87, s62
    s_cmp_eq_u32 s72, 3
    s_cbranch_scc0 L_nowb_51
    s_waitcnt vmcnt(0)
    buffer_wbl2 sc1
L_nowb_51:
    s_cmp_eq_u32 s62, 1
    s_cbranch_scc0 L_noep_52
    s_cmp_eq_u32 s87, 0
    s_cbranch_scc0 L_noep_52
    v_mov_b32 v4, 13631488
    s_mov_b64 exec, 1
    buffer_store_dwordx2 v[88:89], v4, s[40:43], 0 offen sc1
    s_mov_b64 exec, -1
L_noep_52:
    s_cmp_eq_u32 s62, 0
    s_cbranch_scc0 L_hfin
    v_mov_b32 v8, s93
    v_cvt_pk_bf16_f32 v8, v8, v8
    v_and_b32_e64 v8, s90, v8
    v_mul_f32 v8, 0xbfb8aa3b, v8
    v_exp_f32 v8, v8
    s_nop 0
    v_add_f32 v8, 1.0, v8
    v_rcp_f32_e64 v8, v8
    s_nop 0
    v_cvt_pk_bf16_f32 v8, v8, v8
    v_and_b32 v8, s90, v8
    s_lshl_b32 s76, s92, 4
    s_lshr_b32 s77, s87, 1
    s_add_u32 s76, s76, s77
    s_mul_i32 s76, s76, 9344
    s_add_u32 s76, s76, 8388608
    s_and_b32 s77, s87, 1
    s_lshl_b32 s77, s77, 5
    s_add_u32 s76, s76, s77
    v_and_b32 v10, 1, v1
    v_lshlrev_b32_e64 v10, 6, v10
    v_bfe_u32 v4, v1, 1, 2
    v_lshl_add_u32 v10, v4, 3, v10
    v_bfe_u32 v4, v1, 4, 1
    v_lshl_add_u32 v10, v4, 2, v10
    v_lshrrev_b32_e64 v4, 3, v1
    v_mul_u32_u24 v6, 299008, v4
    v_and_b32_e64 v5, 7, v1
    v_lshl_add_u32 v6, v5, 4, v6
    v_mov_b32 v7, 2146435072
    v_cmp_gt_u32 vcc, 56, v1
    s_nop 1
    v_cndmask_b32_e64 v6, v7, v6, vcc
    s_mul_i32 s79, s87, 9344
    s_add_u32 s79, s79, 8388608
    s_lshl_b32 s80, s91, 11
    s_lshl_b32 s77, s87, 6
    s_add_u32 s80, s80, s77
    s_mov_b32 s88, 0
L_spin_53:
    buffer_load_dword v64, v10, s[40:43], s76 offen offset:0 sc1
    buffer_load_dword v65, v10, s[40:43], s76 offen offset:128 sc1
    s_waitcnt vmcnt(0)
    v_max_u32 v4, v64, v65
    v_cmp_eq_u32 vcc, -1, v4
    s_nop 0
    s_cbranch_vccz L_ok_54
    s_add_u32 s88, s88, 1
    s_cmp_lt_u32 s88, 65536
    s_cbranch_scc1 L_spin_53
L_ok_54:
    v_lshlrev_b32 v4, 4, v3
    v_lshrrev_b32 v64, v4, v64
    v_lshrrev_b32 v65, v4, v65
    v_lshlrev_b32 v64, 16, v64
    v_lshlrev_b32 v65, 16, v65
    v_lshrrev_b32 v9, 1, v19
    s_mov_b32 s88, 0
    buffer_load_dwordx4 v[128:131], v6, s[40:43], s79 offen offset:512 sc1
    buffer_load_dwordx4 v[128:131], v6, s[40:43], s79 offen offset:512 sc1
L_poll_55:
    buffer_load_dwordx4 v[128:131], v6, s[40:43], s79 offen offset:512 sc1
    s_waitcnt vmcnt(2)
    v_max3_u32 v4, v128, v129, v130
    v_max_u32 v4, v4, v131
    v_cmp_eq_u32 vcc, -1, v4
    s_nop 0
    s_cbranch_vccz L_ok_56
    s_add_u32 s88, s88, 1
    s_cmp_lt_u32 s88, 65536
    s_cbranch_scc1 L_poll_55
L_ok_56:
    v_mov_b32 v152, v128
    v_mov_b32 v153, v129
    v_mov_b32 v154, v130
    v_mov_b32 v155, v131
    v_permlane32_swap_b32 v152, v153
    s_nop 0
    v_permlane32_swap_b32 v154, v155
    v_add_f32 v152, v152, v153
    v_add_f32 v154, v154, v155
    s_nop 1
    v_permlane16_swap_b32 v152, v154
    v_add_f32 v152, v152, v154
    s_nop 1
    v_add_f32_dpp v152, v152, v152 row_ror:8 row_mask:0xf bank_mask:0xf
    v_cvt_pk_bf16_f32 v152, v152, v152
    v_and_b32 v152, s90, v152
    v_mul_f32 v152, v152, v8
    v_cvt_pk_bf16_f32 v152, v152, v152
    v_and_b32 v152, s90, v152
    v_add_f32 v152, v152, v64
    v_cvt_pk_bf16_f32 v152, v152, v152
    v_and_b32 v152, s90, v152
    v_add_f32 v152, v152, v65
    v_cvt_pk_bf16_f32 v152, v152, v152
    s_mov_b32 exec_lo, 0x00ff00ff
    s_mov_b32 exec_hi, 0x00ff00ff
    buffer_store_short v152, v9, s[44:47], s80 offen sc1
    s_mov_b64 exec, -1
L_hfin:
    s_endpgm
L_event:
    s_cmp_eq_u32 s77, 3
    s_cbranch_scc0 L_ev1
    buffer_load_dwordx4 v[92:95], v90, s[40:43], 0 offen sc1
    s_mov_b64 exec, 3
    global_load_dword v27, v91, s[66:67]
    s_mov_b64 exec, -1
    s_branch L_evret
L_ev1:
    s_cmp_eq_u32 s77, 5
    s_cbranch_scc0 L_ev_57
    s_add_u32 m0, s70, 8192
    s_nop 0
    buffer_load_dwordx4 v25, s[32:35], s72 offen offset:1024 lds
    s_add_u32 s70, s70, 40960
    s_cmp_ge_u32 s70, 122880
    s_cselect_b32 s76, 122880, 0
    s_sub_u32 s70, s70, s76
    buffer_load_dwordx4 v[96:99], v76, s[48:51], s75 offen nt
    s_add_u32 s75, s75, 7168
    buffer_load_dwordx4 v[100:103], v76, s[48:51], s75 offen nt
    s_add_u32 s75, s75, 7168
    buffer_load_dwordx4 v[104:107], v76, s[48:51], s75 offen nt
    s_add_u32 s75, s75, 7168
    buffer_load_dwordx4 v[108:111], v76, s[48:51], s75 offen nt
    s_add_u32 s75, s75, 7168
    buffer_load_dwordx4 v[128:131], v76, s[48:51], s75 offen nt
    s_add_u32 s75, s75, 7168
    buffer_load_dwordx4 v[132:135], v76, s[48:51], s75 offen nt
    s_add_u32 s75, s75, 7168
    buffer_load_dwordx4 v[136:139], v76, s[48:51], s75 offen nt
    s_add_u32 s75, s75, 7168
    buffer_load_dwordx4 v[140:143], v76, s[48:51], s75 offen nt
    s_add_u32 s75, s75, 7168
    s_lshr_b64 s[86:87], s[86:87], 4
    s_add_u32 s68, s68, 1
    s_waitcnt vmcnt(8)
    s_barrier
    s_and_b32 s72, s84, 15
    s_mov_b32 m0, s70
    s_lshl_b32 s71, s72, 7
    buffer_load_dwordx4 v16, s[28:31], s71 offen offset:0 lds
    s_mul_i32 s72, s72, 393216
    s_lshr_b64 s[84:85], s[84:85], 4
    buffer_load_dwordx4 v17, s[28:31], s71 offen offset:1024 lds
    buffer_load_dwordx4 v18, s[28:31], s71 offen offset:2048 lds
    buffer_load_dwordx4 v19, s[28:31], s71 offen offset:3072 lds
    s_add_u32 m0, s70, 4096
    s_nop 0
    buffer_load_dwordx4 v20, s[32:35], s72 offen offset:0 lds
    buffer_load_dwordx4 v21, s[32:35], s72 offen offset:1024 lds
    buffer_load_dwordx4 v22, s[32:35], s72 offen offset:2048 lds
    buffer_load_dwordx4 v23, s[32:35], s72 offen offset:3072 lds
    s_add_u32 m0, s70, 8192
    s_nop 0
    buffer_load_dwordx4 v24, s[32:35], s72 offen offset:0 lds
    s_cmp_lt_u32 s68, 14
    s_cbranch_scc1 L_hloop
    s_branch L_hdone
L_ev_57:
    s_cmp_eq_u32 s77, 6
    s_cbranch_scc0 L_ev_58
    s_add_u32 m0, s70, 8192
    s_nop 0
    buffer_load_dwordx4 v25, s[32:35], s72 offen offset:1024 lds
    s_add_u32 s70, s70, 40960
    s_cmp_ge_u32 s70, 122880
    s_cselect_b32 s76, 122880, 0
    s_sub_u32 s70, s70, s76
    s_lshl_b32 s78, s62, 9
    v_lshl_add_u32 v11, v1, 7, s78
    s_mov_b64 exec, 15
    global_load_dword v27, v11, s[14:15]
    s_mov_b64 exec, -1
    buffer_load_dwordx4 v[112:115], v76, s[48:51], s75 offen nt
    s_add_u32 s75, s75, 7168
    buffer_load_dwordx4 v[116:119], v76, s[48:51], s75 offen nt
    s_add_u32 s75, s75, 7168
    buffer_load_dwordx4 v[120:123], v76, s[48:51], s75 offen nt
    s_add_u32 s75, s75, 7168
    buffer_load_dwordx4 v[124:127], v76, s[48:51], s75 offen nt
    s_add_u32 s75, s75, 7168
    buffer_load_dwordx4 v[144:147], v76, s[48:51], s75 offen nt
    s_add_u32 s75, s75, 7168
    buffer_load_dwordx4 v[148:151], v76, s[48:51], s75 offen nt
    s_add_u32 s75, s75, 7168
    buffer_load_dwordx4 v[152:155], v76, s[48:51], s75 offen nt
    s_add_u32 s75, s75, 7168
    buffer_load_dwordx4 v[156:159], v76, s[48:51], s75 offen nt
    s_add_u32 s75, s75, 7168
    s_lshr_b64 s[86:87], s[86:87], 4
    s_add_u32 s68, s68, 1
    s_waitcnt vmcnt(9)
    s_barrier
    s_and_b32 s72, s84, 15
    s_mov_b32 m0, s70
    s_lshl_b32 s71, s72, 7
    buffer_load_dwordx4 v16, s[28:31], s71 offen offset:0 lds
    s_mul_i32 s72, s72, 393216
    s_lshr_b64 s[84:85], s[84:85], 4
    buffer_load_dwordx4 v17, s[28:31], s71 offen offset:1024 lds
    buffer_load_dwordx4 v18, s[28:31], s71 offen offset:2048 lds
    buffer_load_dwordx4 v19, s[28:31], s71 offen offset:3072 lds
    s_add_u32 m0, s70, 4096
    s_nop 0
    buffer_load_dwordx4 v20, s[32:35], s72 offen offset:0 lds
    buffer_load_dwordx4 v21, s[32:35], s72 offen offset:1024 lds
    buffer_load_dwordx4 v22, s[32:35], s72 offen offset:2048 lds
    buffer_load_dwordx4 v23, s[32:35], s72 offen offset:3072 lds
    s_add_u32 m0, s70, 8192
    s_nop 0
    buffer_load_dwordx4 v24, s[32:35], s72 offen offset:0 lds
    s_cmp_lt_u32 s68, 14
    s_cbranch_scc1 L_hloop
    s_branch L_hdone
L_ev_58:
    s_add_u32 s78, s70, 81920
    s_cmp_ge_u32 s78, 122880
    s_cselect_b32 s76, 122880, 0
    s_sub_u32 s78, s78, s76
    s_cmp_eq_u32 s77, 2
    s_cbranch_scc1 L_evw
    v_add_u32 v4, s78, v72
    v_xor_b32 v5, 32, v4
    v_xor_b32 v6, 64, v4
    v_xor_b32 v7, 96, v4
    s_add_u32 m0, s70, 8192
    s_nop 0
    buffer_load_dwordx4 v25, s[32:35], s72 offen offset:1024 lds
    s_add_u32 s70, s70, 40960
    s_cmp_ge_u32 s70, 122880
    s_cselect_b32 s76, 122880, 0
    s_sub_u32 s70, s70, s76
    ds_read_b128 v[32:35], v4
    ds_read_b128 v[36:39], v5
    ds_read_b128 v[40:43], v6
    ds_read_b128 v[44:47], v7
    s_and_b32 s72, s84, 15
    s_mov_b32 m0, s70
    s_lshl_b32 s71, s72, 7
    buffer_load_dwordx4 v16, s[28:31], s71 offen offset:0 lds
    s_mul_i32 s72, s72, 393216
    s_lshr_b64 s[84:85], s[84:85], 4
    s_lshl_b32 s79, s62, 8
    s_add_u32 s79, s79, s73
    s_waitcnt lgkmcnt(0)
    v_lshlrev_b32 v8, 16, v32
    v_and_b32 v9, s90, v32
    v_add_f32 v80, v80, v8
    v_add_f32 v82, v82, v9
    v_fmac_f32 v81, v8, v8
    v_fmac_f32 v83, v9, v9
    v_lshlrev_b32 v10, 16, v33
    v_and_b32 v11, s90, v33
    v_add_f32 v80, v80, v10
    v_add_f32 v82, v82, v11
    v_fmac_f32 v81, v10, v10
    v_fmac_f32_e64 v83, v11, v11
    buffer_load_dwordx4 v17, s[28:31], s71 offen offset:1024 lds
    v_lshlrev_b32 v8, 16, v34
    v_and_b32 v9, s90, v34
    v_add_f32 v80, v80, v8
    v_add_f32 v82, v82, v9
    v_fmac_f32 v81, v8, v8
    v_fmac_f32 v83, v9, v9
    v_lshlrev_b32 v10, 16, v35
    v_and_b32 v11, s90, v35
    v_add_f32 v80, v80, v10
    v_add_f32 v82, v82, v11
    v_fmac_f32 v81, v10, v10
    v_fmac_f32 v83, v11, v11
    buffer_load_dwordx4 v18, s[28:31], s71 offen offset:2048 lds
    v_lshlrev_b32 v8, 16, v36
    v_and_b32 v9, s90, v36
    v_add_f32 v80, v80, v8
    v_add_f32 v82, v82, v9
    v_fmac_f32 v81, v8, v8
    v_fmac_f32 v83, v9, v9
    v_lshlrev_b32 v10, 16, v37
    v_and_b32 v11, s90, v37
    v_add_f32 v80, v80, v10
    v_add_f32 v82, v82, v11
    v_fmac_f32 v81, v10, v10
    v_fmac_f32 v83, v11, v11
    buffer_load_dwordx4 v19, s[28:31], s71 offen offset:3072 lds
    v_lshlrev_b32 v8, 16, v38
    v_and_b32 v9, s90, v38
    v_add_f32 v80, v80, v8
    v_add_f32 v82, v82, v9
    v_fmac_f32 v81, v8, v8
    v_fmac_f32 v83, v9, v9
    v_lshlrev_b32 v10, 16, v39
    v_and_b32 v11, s90, v39
    v_add_f32 v80, v80, v10
    v_add_f32 v82, v82, v11
    v_fmac_f32 v81, v10, v10
    v_fmac_f32 v83, v11, v11
    s_add_u32 m0, s70, 4096
    s_nop 0
    buffer_load_dwordx4 v20, s[32:35], s72 offen offset:0 lds
    v_lshlrev_b32 v8, 16, v40
    v_and_b32 v9, s90, v40
    v_add_f32 v80, v80, v8
    v_add_f32 v82, v82, v9
    v_fmac_f32 v81, v8, v8
    v_fmac_f32 v83, v9, v9
    v_lshlrev_b32 v10, 16, v41
    v_and_b32 v11, s90, v41
    v_add_f32 v80, v80, v10
    v_add_f32 v82, v82, v11
    v_fmac_f32 v81, v10, v10
    v_fmac_f32_e64 v83, v11, v11
    buffer_load_dwordx4 v21, s[32:35], s72 offen offset:1024 lds
    v_lshlrev_b32 v8, 16, v42
    v_and_b32 v9, s90, v42
    v_add_f32 v80, v80, v8
    v_add_f32 v82, v82, v9
    v_fmac_f32 v81, v8, v8
    v_fmac_f32 v83, v9, v9
    v_lshlrev_b32 v10, 16, v43
    v_and_b32 v11, s90, v43
    v_add_f32 v80, v80, v10
    v_add_f32 v82, v82, v11
    v_fmac_f32 v81, v10, v10
    v_fmac_f32 v83, v11, v11
    buffer_load_dwordx4 v22, s[32:35], s72 offen offset:2048 lds
    v_lshlrev_b32 v8, 16, v44
    v_and_b32 v9, s90, v44
    v_add_f32 v80, v80, v8
    v_add_f32 v82, v82, v9
    v_fmac_f32 v81, v8, v8
    v_fmac_f32 v83, v9, v9
    v_lshlrev_b32 v10, 16, v45
    v_and_b32 v11, s90, v45
    v_add_f32 v80, v80, v10
    v_add_f32 v82, v82, v11
    v_fmac_f32 v81, v10, v10
    v_fmac_f32 v83, v11, v11
    buffer_load_dwordx4 v23, s[32:35], s72 offen offset:3072 lds
    v_lshlrev_b32 v8, 16, v46
    v_and_b32 v9, s90, v46
    v_add_f32 v80, v80, v8
    v_add_f32 v82, v82, v9
    v_fmac_f32 v81, v8, v8
    v_fmac_f32 v83, v9, v9
    v_lshlrev_b32 v10, 16, v47
    v_and_b32 v11, s90, v47
    v_add_f32 v80, v80, v10
    v_add_f32 v82, v82, v11
    v_fmac_f32 v81, v10, v10
    v_fmac_f32 v83, v11, v11
    s_add_u32 m0, s70, 8192
    s_nop 0
    buffer_load_dwordx4 v24, s[32:35], s72 offen offset:0 lds
    s_xor_b32 s69, s69, 1
    s_cbranch_scc1 L_hw10
    v_add_f32 v80, v80, v82
    v_add_f32 v81, v81, v83
    v_mov_b32 v82, v80
    v_mov_b32 v83, v81
    s_nop 0
    v_permlane32_swap_b32 v80, v82
    v_permlane32_swap_b32 v81, v83
    v_add_f32 v80, v80, v82
    v_add_f32_e64 v81, v81, v83
    s_mov_b32 exec_hi, 0
    buffer_store_dwordx2 v[80:81], v74, s[40:43], s79 offen offset:0 sc1
    s_mov_b64 exec, -1
    s_waitcnt vmcnt(10)
    s_branch L_hbar
L_evw:
    s_mul_i32 s79, s63, 2048
    s_add_u32 s79, s79, s78
    v_add_u32_e64 v4, s79, v73
    s_mul_i32 s79, s63, 20480
    s_add_u32 s79, s79, s78
    v_add_u32 v5, s79, v73
    s_add_u32 m0, s70, 8192
    s_nop 0
    buffer_load_dwordx4 v25, s[32:35], s72 offen offset:1024 lds
    s_add_u32 s70, s70, 40960
    s_cmp_ge_u32 s70, 122880
    s_cselect_b32 s76, 122880, 0
    s_sub_u32 s70, s70, s76
    ds_read_b64_tr_b16 v[32:33], v4 offset:0
    ds_read_b64_tr_b16 v[34:35], v4 offset:512
    ds_read_b64_tr_b16 v[36:37], v4 offset:10240
    ds_read_b64_tr_b16 v[38:39], v4 offset:10752
    ds_read_b64_tr_b16 v[40:41], v4 offset:20480
    ds_read_b64_tr_b16 v[42:43], v4 offset:20992
    ds_read_b64_tr_b16 v[44:45], v4 offset:30720
    ds_read_b64_tr_b16 v[46:47], v4 offset:31232
    ds_read_b64_tr_b16 v[48:49], v5 offset:4096
    ds_read_b64_tr_b16 v[50:51], v5 offset:4608
    ds_read_b64_tr_b16 v[52:53], v5 offset:14336
    ds_read_b64_tr_b16 v[54:55], v5 offset:14848
    s_and_b32 s72, s84, 15
    s_mov_b32 m0, s70
    s_lshl_b32 s71, s72, 7
    buffer_load_dwordx4 v16, s[28:31], s71 offen offset:0 lds
    s_mul_i32 s72, s72, 393216
    s_lshr_b64 s[84:85], s[84:85], 4
    s_lshl_b32 s79, s64, 9
    s_lshl_b32 s80, s63, 3
    s_add_u32 s79, s79, s80
    s_add_u32 s79, s79, s73
    s_waitcnt lgkmcnt(0)
    v_lshlrev_b32 v8, 16, v32
    v_and_b32 v9, s90, v32
    v_add_f32 v80, v80, v8
    v_add_f32 v82, v82, v9
    v_lshlrev_b32 v10, 16, v33
    v_and_b32 v11, s90, v33
    v_add_f32 v80, v80, v10
    v_add_f32 v82, v82, v11
    v_lshlrev_b32 v8, 16, v34
    v_and_b32 v9, s90, v34
    v_add_f32 v80, v80, v8
    v_add_f32_e64 v82, v82, v9
    buffer_load_dwordx4 v17, s[28:31], s71 offen offset:1024 lds
    v_lshlrev_b32 v10, 16, v35
    v_and_b32 v11, s90, v35
    v_add_f32 v80, v80, v10
    v_add_f32 v82, v82, v11
    v_lshlrev_b32 v8, 16, v36
    v_and_b32 v9, s90, v36
    v_add_f32 v80, v80, v8
    v_add_f32 v82, v82, v9
    v_lshlrev_b32 v10, 16, v37
    v_and_b32 v11, s90, v37
    v_add_f32 v80, v80, v10
    v_add_f32 v82, v82, v11
    buffer_load_dwordx4 v18, s[28:31], s71 offen offset:2048 lds
    v_lshlrev_b32 v8, 16, v38
    v_and_b32 v9, s90, v38
    v_add_f32 v80, v80, v8
    v_add_f32 v82, v82, v9
    v_lshlrev_b32 v10, 16, v39
    v_and_b32 v11, s90, v39
    v_add_f32 v80, v80, v10
    v_add_f32 v82, v82, v11
    v_lshlrev_b32 v8, 16, v40
    v_and_b32 v9, s90, v40
    v_add_f32 v80, v80, v8
    v_add_f32 v82, v82, v9
    buffer_load_dwordx4 v19, s[28:31], s71 offen offset:3072 lds
    v_lshlrev_b32 v10, 16, v41
    v_and_b32 v11, s90, v41
    v_add_f32 v80, v80, v10
    v_add_f32 v82, v82, v11
    v_lshlrev_b32 v8, 16, v42
    v_and_b32 v9, s90, v42
    v_add_f32 v80, v80, v8
    v_add_f32 v82, v82, v9
    v_lshlrev_b32 v10, 16, v43
    v_and_b32 v11, s90, v43
    v_add_f32 v80, v80, v10
    v_add_f32 v82, v82, v11
    s_add_u32 m0, s70, 4096
    s_nop 0
    buffer_load_dwordx4 v20, s[32:35], s72 offen offset:0 lds
    v_lshlrev_b32 v8, 16, v44
    v_and_b32 v9, s90, v44
    v_add_f32 v80, v80, v8
    v_add_f32 v82, v82, v9
    v_lshlrev_b32 v10, 16, v45
    v_and_b32 v11, s90, v45
    v_add_f32 v80, v80, v10
    v_add_f32 v82, v82, v11
    v_lshlrev_b32 v8, 16, v46
    v_and_b32 v9, s90, v46
    v_add_f32 v80, v80, v8
    v_add_f32_e64 v82, v82, v9
    buffer_load_dwordx4 v21, s[32:35], s72 offen offset:1024 lds
    v_lshlrev_b32 v10, 16, v47
    v_and_b32 v11, s90, v47
    v_add_f32 v80, v80, v10
    v_add_f32 v82, v82, v11
    v_lshlrev_b32 v8, 16, v48
    v_and_b32 v9, s90, v48
    v_add_f32 v81, v81, v8
    v_add_f32 v83, v83, v9
    v_lshlrev_b32 v10, 16, v49
    v_and_b32 v11, s90, v49
    v_add_f32 v81, v81, v10
    v_add_f32 v83, v83, v11
    buffer_load_dwordx4 v22, s[32:35], s72 offen offset:2048 lds
    v_lshlrev_b32 v8, 16, v50
    v_and_b32 v9, s90, v50
    v_add_f32 v81, v81, v8
    v_add_f32 v83, v83, v9
    v_lshlrev_b32 v10, 16, v51
    v_and_b32 v11, s90, v51
    v_add_f32 v81, v81, v10
    v_add_f32 v83, v83, v11
    v_lshlrev_b32 v8, 16, v52
    v_and_b32 v9, s90, v52
    v_add_f32 v81, v81, v8
    v_add_f32 v83, v83, v9
    buffer_load_dwordx4 v23, s[32:35], s72 offen offset:3072 lds
    v_lshlrev_b32 v10, 16, v53
    v_and_b32 v11, s90, v53
    v_add_f32 v81, v81, v10
    v_add_f32 v83, v83, v11
    v_lshlrev_b32 v8, 16, v54
    v_and_b32 v9, s90, v54
    v_add_f32 v81, v81, v8
    v_add_f32 v83, v83, v9
    v_lshlrev_b32 v10, 16, v55
    v_and_b32 v11, s90, v55
    v_add_f32 v81, v81, v10
    v_add_f32 v83, v83, v11
    s_add_u32 m0, s70, 8192
    s_nop 0
    buffer_load_dwordx4 v24, s[32:35], s72 offen offset:0 lds
    s_xor_b32 s69, s69, 1
    s_cbranch_scc1 L_hw10
    v_add_f32 v80, v80, v82
    v_add_f32 v81, v81, v83
    v_mov_b32 v82, v80
    v_mov_b32 v83, v81
    s_nop 0
    v_permlane32_swap_b32 v80, v82
    v_permlane32_swap_b32 v81, v83
    v_add_f32 v80, v80, v82
    v_add_f32_e64 v81, v81, v83
    s_mov_b32 exec_hi, 0
    buffer_store_dwordx2 v[80:81], v12, s[40:43], s79 offen offset:1024 sc1
    s_mov_b64 exec, -1
    s_waitcnt vmcnt(10)
    s_branch L_hbar
L_compute:
    s_load_dwordx4 s[8:11], s[0:1], 16
    s_load_dwordx16 s[12:27], s[0:1], 32
    s_and_b32 s62, s62, 3
    s_and_b32 s76, s2, 7
    s_lshl_b32 s76, s76, 3
    s_lshr_b32 s77, s2, 7
    s_lshl2_add_u32 s76, s77, s76
    s_mov_b32 s80, 0x654210b3
    s_mov_b32 s81, 0xfedca987
    s_lshr_b64 s[80:81], s[80:81], s76
    s_and_b32 s61, s80, 15
    s_setprio 2
    s_and_b32 s63, s62, 1
    s_lshr_b32 s64, s62, 1
    s_lshl_b32 s73, s60, 4
    s_add_u32 s73, s73, s61
    s_mul_i32 s73, s73, 28800
    s_add_u32 s76, s2, 7
    s_and_b32 s76, s76, 7
    s_bfe_u32 s77, s2, 0x10003
    s_lshl1_add_u32 s97, s76, s77
    s_lshr_b32 s98, s2, 4
    s_lshl_b32 s99, s97, 4
    s_add_u32 s99, s99, s98
    s_mul_i32 s99, s99, 9344
    s_add_u32 s99, s99, 8388608
    s_lshr_b32 s65, s97, 1
    s_lshl_b32 s76, s97, 3
    s_add_u32 s65, s65, s76
    s_mul_i32 s76, s98, 4
    s_add_u32 s65, s65, s76
    s_and_b32 s65, s65, 15
    s_mov_b32 s89, 0x3f803f80
    s_mov_b32 s90, 0xffff0000
    v_and_b32 v2, 31, v1
    v_lshrrev_b32 v3, 5, v1
    v_lshlrev_b32 v12, 4, v1
    v_lshrrev_b32_e64 v4, 3, v1
    v_mul_u32_u24 v13, 460800, v4
    v_and_b32_e64 v4, 7, v1
    v_lshl_add_u32 v13, v4, 4, v13
    v_and_b32 v10, 15, v1
    v_lshrrev_b32 v11, 4, v1
    s_mul_i32 s76, s63, 20480
    v_lshrrev_b32 v4, 1, v10
    v_xor_b32 v4, v4, v11
    v_lshlrev_b32_e64 v4, 4, v4
    v_lshl_add_u32 v4, v10, 7, v4
    v_add_u32 v192, s76, v4
    v_xor_b32 v193, 64, v192
    v_bfe_u32 v4, v1, 2, 2
    v_and_b32_e64 v6, 1, v11
    v_lshl_add_u32 v5, v6, 3, v4
    v_lshlrev_b32 v5, 7, v5
    v_lshrrev_b32 v4, 1, v4
    v_xor_b32_e64 v4, s64, v4
    v_lshl_add_u32 v5, v4, 6, v5
    v_lshl_add_u32 v5, v6, 5, v5
    v_and_b32_e64 v4, 3, v1
    v_lshl_add_u32 v5, v4, 3, v5
    v_mul_u32_u24 v4, 10240, v3
    v_add_u32_e64 v5, v5, v4
    v_add_u32 v194, 4096, v5
    v_xor_b32_e64 v195, 32, v194
    v_add_u32 v196, 40960, v192
    v_add_u32 v197, 40960, v193
    v_add_u32 v198, 40960, v194
    v_add_u32 v199, 40960, v195
    v_add_u32 v200, 81920, v192
    v_add_u32 v201, 81920, v193
    v_add_u32 v202, 81920, v194
    v_add_u32 v203, 81920, v195
    v_bfe_u32 v4, v1, 2, 2
    v_lshl_add_u32 v4, v3, 3, v4
    v_lshlrev_b32 v4, 6, v4
    v_and_b32 v5, 1, v11
    v_lshl_add_u32 v4, v5, 5, v4
    v_and_b32_e64 v5, 3, v1
    v_lshl_add_u32 v4, v5, 3, v4
    s_lshl_b32 s76, s64, 11
    s_add_u32 s76, s76, 122880
    v_add_u32_e64 v212, s76, v4
    s_lshl_b32 s76, s63, 9
    v_lshl_add_u32 v213, v10, 3, s76
    v_lshl_add_u32 v214, v2, 3, s76
    s_lshl_b32 s76, s64, 8
    v_lshl_add_u32 v215, v10, 3, s76
    v_bfe_u32 v4, v10, 1, 1
    v_xor_b32 v4, s64, v4
    v_lshrrev_b32 v5, 2, v10
    v_xor_b32 v5, v5, v3
    v_xor_b32 v6, v10, v11
    v_and_b32 v6, 1, v6
    v_lshlrev_b32_e64 v4, 6, v4
    v_lshl_add_u32 v4, v5, 4, v4
    v_lshl_add_u32 v4, v6, 3, v4
    v_lshl_add_u32 v4, v10, 7, v4
    s_lshl_b32 s76, s63, 13
    v_add_u32 v216, s76, v4
    v_bfe_u32 v4, v2, 1, 1
    v_bfe_u32 v5, v2, 2, 2
    v_and_b32 v6, 1, v2
    v_xor_b32 v6, v6, v3
    v_lshlrev_b32_e64 v4, 6, v4
    v_lshl_add_u32 v4, v5, 4, v4
    v_lshl_add_u32 v4, v6, 3, v4
    v_lshl_add_u32 v4, v2, 7, v4
    s_lshl_b32 s77, s64, 14
    s_add_u32 s76, s76, s77
    v_add_u32_e64 v217, s76, v4
    v_bfe_u32 v4, v1, 2, 2
    v_lshl_add_u32 v5, v3, 3, v4
    v_lshlrev_b32 v5, 7, v5
    v_lshrrev_b32 v6, 1, v4
    v_lshl_add_u32 v5, v6, 6, v5
    v_bfe_u32 v6, v1, 4, 1
    v_xor_b32_e64 v6, v6, v3
    v_lshl_add_u32 v5, v6, 5, v5
    v_bfe_u32 v6, v1, 1, 1
    v_lshl_add_u32 v5, v6, 4, v5
    v_xor_b32 v6, v1, v4
    v_and_b32 v6, 1, v6
    v_lshl_add_u32 v5, v6, 3, v5
    s_lshl_b32 s76, s63, 13
    v_xor_b32 v5, s76, v5
    s_lshl_b32 s76, s63, 6
    s_or_b32 s76, s76, s77
    v_xor_b32 v218, s76, v5
    s_lshl_b32 s76, s64, 6
    v_xor_b32_e64 v220, s76, v5
    v_xor_b32 v219, 528, v218
    v_xor_b32 v221, 528, v220
    v_cmp_gt_u32 s[86:87], 16, v1
    s_waitcnt lgkmcnt(0)
    s_mov_b32 s40, s26
    s_and_b32 s41, s27, 0xffff
    s_mov_b32 s42, 33554432
    s_mov_b32 s43, 0x20000
    s_mov_b32 s44, s22
    s_and_b32 s45, s23, 0xffff
    s_mov_b32 s46, 4194304
    s_mov_b32 s47, 0x20000
    s_mov_b32 s68, 0
    s_getreg_b32 s101, hwreg(HW_REG_XCC_ID, 0, 4)
    v_mov_b32 v9, 13631488
    s_lshl_b32 s76, s61, 8
    s_lshl4_add_u32 s76, s60, s76
    s_add_u32 s76, s76, 12582912
    v_mov_b32 v8, s76
    s_lshl_b32 s76, s60, 8
    s_lshl4_add_u32 s76, s61, s76
    s_add_u32 s76, s76, 12587008
    v_writelane_b32 v8, s76, 1
    s_lshl_b32 s76, s97, 8
    s_lshl4_add_u32 s76, s98, s76
    s_add_u32 s76, s76, 12591104
    v_writelane_b32 v8, s76, 2
    v_mov_b32 v6, s101
    v_mov_b32 v7, 0
    v_mov_b32_e64 v10, 0
    s_cmp_eq_u32 s62, 0
    s_cbranch_scc0 L_noep
    buffer_load_dwordx2 v[4:5], v9, s[40:43], 0 offen
L_noep:
    s_barrier
    ds_read_b128 v[112:115], v192 offset:0
    ds_read_b64_tr_b16 v[128:129], v194 offset:0
    ds_read_b64_tr_b16 v[130:131], v194 offset:512
    ds_read_b128 v[116:119], v192 offset:2048
    ds_read_b128 v[120:123], v192 offset:10240
    ds_read_b128 v[124:127], v192 offset:12288
    ds_read_b64_tr_b16 v[132:133], v195 offset:0
    ds_read_b64_tr_b16 v[134:135], v195 offset:512
    ds_read_b64_tr_b16 v[136:137], v194 offset:2048
    ds_read_b64_tr_b16 v[138:139], v194 offset:2560
    ds_read_b64_tr_b16 v[140:141], v195 offset:2048
    ds_read_b64_tr_b16 v[142:143], v195 offset:2560
    ds_read_b64_tr_b16 v[144:145], v194 offset:4096
    ds_read_b64_tr_b16 v[146:147], v194 offset:4608
    s_waitcnt lgkmcnt(8)
    ds_read_b64_tr_b16 v[148:149], v195 offset:4096
    ds_read_b64_tr_b16 v[150:151], v195 offset:4608
    v_mfma_f32_16x16x32_bf16 v[16:19], v[128:131], v[112:115], 0
    ds_read_b128 v[152:155], v193 offset:0
    v_mfma_f32_16x16x32_bf16 v[20:23], v[128:131], v[116:119], 0
    ds_read_b64_tr_b16 v[168:169], v194 offset:20480
    v_mfma_f32_16x16x32_bf16 v[24:27], v[128:131], v[120:123], 0
    ds_read_b64_tr_b16 v[170:171], v194 offset:20992
    v_mfma_f32_16x16x32_bf16 v[28:31], v[128:131], v[124:127], 0
    ds_read_b128 v[156:159], v193 offset:2048
    s_waitcnt lgkmcnt(4)
    v_mfma_f32_16x16x32_bf16 v[44:47], v[132:135], v[124:127], 0
    ds_read_b128 v[160:163], v193 offset:10240
    v_mfma_f32_16x16x32_bf16 v[40:43], v[132:135], v[120:123], 0
    ds_read_b128 v[164:167], v193 offset:12288
    v_mfma_f32_16x16x32_bf16 v[36:39], v[132:135], v[116:119], 0
    ds_read_b64_tr_b16 v[172:173], v195 offset:20480
    v_mfma_f32_16x16x32_bf16 v[32:35], v[132:135], v[112:115], 0
    ds_read_b64_tr_b16 v[174:175], v195 offset:20992
    v_mfma_f32_16x16x32_bf16 v[48:51], v[136:139], v[112:115], 0
    ds_read_b64_tr_b16 v[176:177], v194 offset:22528
    v_mfma_f32_16x16x32_bf16 v[52:55], v[136:139], v[116:119], 0
    ds_read_b64_tr_b16 v[178:179], v194 offset:23040
    v_mfma_f32_16x16x32_bf16 v[56:59], v[136:139], v[120:123], 0
    ds_read_b64_tr_b16 v[180:181], v195 offset:22528
    v_mfma_f32_16x16x32_bf16 v[60:63], v[136:139], v[124:127], 0
    ds_read_b64_tr_b16 v[182:183], v195 offset:23040
    v_mfma_f32_16x16x32_bf16 v[76:79], v[140:143], v[124:127], 0
    ds_read_b64_tr_b16 v[184:185], v194 offset:24576
    v_mfma_f32_16x16x32_bf16 v[72:75], v[140:143], v[120:123], 0
    ds_read_b64_tr_b16 v[186:187], v194 offset:25088
    v_mfma_f32_16x16x32_bf16 v[68:71], v[140:143], v[116:119], 0
    ds_read_b64_tr_b16 v[188:189], v195 offset:24576
    v_mfma_f32_16x16x32_bf16 v[64:67], v[140:143], v[112:115], 0
    ds_read_b64_tr_b16 v[190:191], v195 offset:25088
    v_mfma_f32_16x16x32_bf16 v[80:83], v[144:147], v[112:115], 0
    v_mfma_f32_16x16x32_bf16 v[84:87], v[144:147], v[116:119], 0
    v_mfma_f32_16x16x32_bf16 v[88:91], v[144:147], v[120:123], 0
    v_mfma_f32_16x16x32_bf16 v[92:95], v[144:147], v[124:127], 0
    v_mfma_f32_16x16x32_bf16 v[108:111], v[148:151], v[124:127], 0
    v_mfma_f32_16x16x32_bf16 v[104:107], v[148:151], v[120:123], 0
    v_mfma_f32_16x16x32_bf16 v[100:103], v[148:151], v[116:119], 0
    v_mfma_f32_16x16x32_bf16 v[96:99], v[148:151], v[112:115], 0
    s_waitcnt lgkmcnt(0)
    v_mfma_f32_16x16x32_bf16 v[16:19], v[168:171], v[152:155], v[16:19]
    s_barrier
    v_mfma_f32_16x16x32_bf16 v[20:23], v[168:171], v[156:159], v[20:23]
    ds_read_b128 v[112:115], v196 offset:0
    ds_read_b64_tr_b16 v[204:205], v212 offset:0
    ds_read_b64_tr_b16 v[206:207], v212 offset:256
    ds_read_b64_tr_b16 v[208:209], v212 offset:1024
    ds_read_b64_tr_b16 v[210:211], v212 offset:1280
    v_mfma_f32_16x16x32_bf16 v[24:27], v[168:171], v[160:163], v[24:27]
    ds_read_b64_tr_b16 v[128:129], v198 offset:0
    s_cmp_eq_u32 s62, 0
    s_cbranch_scc0 L_cloop
    s_waitcnt vmcnt(0)
    v_add_co_u32 v4, vcc, 1, v4
    s_nop 1
    v_addc_co_u32 v5, vcc, 0, v5, vcc
    s_mov_b64 exec, 7
    buffer_store_dwordx4 v[4:7], v8, s[40:43], 0 offen sc1
    s_mov_b64 exec, -1
.p2align 3
L_cloop:
    v_mfma_f32_16x16x32_bf16 v[28:31], v[168:171], v[164:167], v[28:31]
    ds_read_b64_tr_b16 v[130:131], v198 offset:512
    v_mfma_f32_16x16x32_bf16 v[44:47], v[172:175], v[164:167], v[44:47]
    ds_read_b128 v[116:119], v196 offset:2048
    v_mfma_f32_16x16x32_bf16 v[40:43], v[172:175], v[160:163], v[40:43]
    ds_read_b128 v[120:123], v196 offset:10240
    v_mfma_f32_16x16x32_bf16 v[36:39], v[172:175], v[156:159], v[36:39]
    ds_read_b128 v[124:127], v196 offset:12288
    v_mfma_f32_16x16x32_bf16 v[32:35], v[172:175], v[152:155], v[32:35]
    ds_read_b64_tr_b16 v[132:133], v199 offset:0
    v_mfma_f32_16x16x32_bf16 v[48:51], v[176:179], v[152:155], v[48:51]
    ds_read_b64_tr_b16 v[134:135], v199 offset:512
    v_mfma_f32_16x16x32_bf16 v[52:55], v[176:179], v[156:159], v[52:55]
    ds_read_b64_tr_b16 v[136:137], v198 offset:2048
    v_mfma_f32_16x16x32_bf16 v[56:59], v[176:179], v[160:163], v[56:59]
    ds_read_b64_tr_b16 v[138:139], v198 offset:2560
    v_mfma_f32_16x16x32_bf16 v[60:63], v[176:179], v[164:167], v[60:63]
    ds_read_b64_tr_b16 v[140:141], v199 offset:2048
    v_mfma_f32_16x16x32_bf16 v[76:79], v[180:183], v[164:167], v[76:79]
    ds_read_b64_tr_b16 v[142:143], v199 offset:2560
    v_mfma_f32_16x16x32_bf16 v[72:75], v[180:183], v[160:163], v[72:75]
    ds_read_b64_tr_b16 v[144:145], v198 offset:4096
    v_mfma_f32_16x16x32_bf16 v[68:71], v[180:183], v[156:159], v[68:71]
    ds_read_b64_tr_b16 v[146:147], v198 offset:4608
    v_mfma_f32_16x16x32_bf16 v[64:67], v[180:183], v[152:155], v[64:67]
    ds_read_b64_tr_b16 v[148:149], v199 offset:4096
    v_mfma_f32_16x16x32_bf16 v[80:83], v[184:187], v[152:155], v[80:83]
    ds_read_b64_tr_b16 v[150:151], v199 offset:4608
    v_mfma_f32_16x16x32_bf16 v[84:87], v[184:187], v[156:159], v[84:87]
    v_mfma_f32_16x16x32_bf16 v[88:91], v[184:187], v[160:163], v[88:91]
    v_mfma_f32_16x16x32_bf16 v[92:95], v[184:187], v[164:167], v[92:95]
    v_mfma_f32_16x16x32_bf16 v[108:111], v[188:191], v[164:167], v[108:111]
    v_mfma_f32_16x16x32_bf16 v[104:107], v[188:191], v[160:163], v[104:107]
    v_mfma_f32_16x16x32_bf16 v[100:103], v[188:191], v[156:159], v[100:103]
    v_mfma_f32_16x16x32_bf16 v[96:99], v[188:191], v[152:155], v[96:99]
    s_waitcnt lgkmcnt(0)
    v_mfma_f32_16x16x32_bf16 v[16:19], v[128:131], v[112:115], v[16:19]
    ds_read_b128 v[152:155], v197 offset:0
    v_mfma_f32_16x16x32_bf16 v[20:23], v[128:131], v[116:119], v[20:23]
    ds_read_b64_tr_b16 v[168:169], v198 offset:20480
    v_mfma_f32_16x16x32_bf16 v[24:27], v[128:131], v[120:123], v[24:27]
    ds_read_b64_tr_b16 v[170:171], v198 offset:20992
    v_mfma_f32_16x16x32_bf16 v[28:31], v[128:131], v[124:127], v[28:31]
    ds_read_b128 v[156:159], v197 offset:2048
    v_mfma_f32_16x16x32_bf16 v[44:47], v[132:135], v[124:127], v[44:47]
    ds_read_b128 v[160:163], v197 offset:10240
    v_mfma_f32_16x16x32_bf16 v[40:43], v[132:135], v[120:123], v[40:43]
    ds_read_b128 v[164:167], v197 offset:12288
    v_mfma_f32_16x16x32_bf16 v[36:39], v[132:135], v[116:119], v[36:39]
    ds_read_b64_tr_b16 v[172:173], v199 offset:20480
    v_mfma_f32_16x16x32_bf16 v[32:35], v[132:135], v[112:115], v[32:35]
    ds_read_b64_tr_b16 v[174:175], v199 offset:20992
    v_mfma_f32_16x16x32_bf16 v[48:51], v[136:139], v[112:115], v[48:51]
    ds_read_b64_tr_b16 v[176:177], v198 offset:22528
    v_mfma_f32_16x16x32_bf16 v[52:55], v[136:139], v[116:119], v[52:55]
    ds_read_b64_tr_b16 v[178:179], v198 offset:23040
    v_mfma_f32_16x16x32_bf16 v[56:59], v[136:139], v[120:123], v[56:59]
    ds_read_b64_tr_b16 v[180:181], v199 offset:22528
    v_mfma_f32_16x16x32_bf16 v[60:63], v[136:139], v[124:127], v[60:63]
    ds_read_b64_tr_b16 v[182:183], v199 offset:23040
    v_mfma_f32_16x16x32_bf16 v[76:79], v[140:143], v[124:127], v[76:79]
    ds_read_b64_tr_b16 v[184:185], v198 offset:24576
    v_mfma_f32_16x16x32_bf16 v[72:75], v[140:143], v[120:123], v[72:75]
    ds_read_b64_tr_b16 v[186:187], v198 offset:25088
    v_mfma_f32_16x16x32_bf16 v[68:71], v[140:143], v[116:119], v[68:71]
    ds_read_b64_tr_b16 v[188:189], v199 offset:24576
    v_mfma_f32_16x16x32_bf16 v[64:67], v[140:143], v[112:115], v[64:67]
    ds_read_b64_tr_b16 v[190:191], v199 offset:25088
    v_mfma_f32_16x16x32_bf16 v[80:83], v[144:147], v[112:115], v[80:83]
    v_mfma_f32_16x16x32_bf16 v[84:87], v[144:147], v[116:119], v[84:87]
    v_mfma_f32_16x16x32_bf16 v[88:91], v[144:147], v[120:123], v[88:91]
    v_mfma_f32_16x16x32_bf16 v[92:95], v[144:147], v[124:127], v[92:95]
    v_mfma_f32_16x16x32_bf16 v[108:111], v[148:151], v[124:127], v[108:111]
    v_mfma_f32_16x16x32_bf16 v[104:107], v[148:151], v[120:123], v[104:107]
    v_mfma_f32_16x16x32_bf16 v[100:103], v[148:151], v[116:119], v[100:103]
    v_mfma_f32_16x16x32_bf16 v[96:99], v[148:151], v[112:115], v[96:99]
    s_waitcnt lgkmcnt(0)
    v_mfma_f32_16x16x32_bf16 v[16:19], v[168:171], v[152:155], v[16:19]
    s_barrier
    v_mfma_f32_16x16x32_bf16 v[20:23], v[168:171], v[156:159], v[20:23]
    ds_read_b128 v[112:115], v200 offset:0
    v_mfma_f32_16x16x32_bf16 v[24:27], v[168:171], v[160:163], v[24:27]
    ds_read_b64_tr_b16 v[128:129], v202 offset:0
    v_mfma_f32_16x16x32_bf16 v[28:31], v[168:171], v[164:167], v[28:31]
    ds_read_b64_tr_b16 v[130:131], v202 offset:512
    v_mfma_f32_16x16x32_bf16 v[44:47], v[172:175], v[164:167], v[44:47]
    ds_read_b128 v[116:119], v200 offset:2048
    v_mfma_f32_16x16x32_bf16 v[40:43], v[172:175], v[160:163], v[40:43]
    ds_read_b128 v[120:123], v200 offset:10240
    v_mfma_f32_16x16x32_bf16 v[36:39], v[172:175], v[156:159], v[36:39]
    ds_read_b128 v[124:127], v200 offset:12288
    v_mfma_f32_16x16x32_bf16 v[32:35], v[172:175], v[152:155], v[32:35]
    ds_read_b64_tr_b16 v[132:133], v203 offset:0
    v_mfma_f32_16x16x32_bf16 v[48:51], v[176:179], v[152:155], v[48:51]
    ds_read_b64_tr_b16 v[134:135], v203 offset:512
    v_mfma_f32_16x16x32_bf16 v[52:55], v[176:179], v[156:159], v[52:55]
    ds_read_b64_tr_b16 v[136:137], v202 offset:2048
    v_mfma_f32_16x16x32_bf16 v[56:59], v[176:179], v[160:163], v[56:59]
    ds_read_b64_tr_b16 v[138:139], v202 offset:2560
    v_mfma_f32_16x16x32_bf16 v[60:63], v[176:179], v[164:167], v[60:63]
    ds_read_b64_tr_b16 v[140:141], v203 offset:2048
    v_mfma_f32_16x16x32_bf16 v[76:79], v[180:183], v[164:167], v[76:79]
    ds_read_b64_tr_b16 v[142:143], v203 offset:2560
    v_mfma_f32_16x16x32_bf16 v[72:75], v[180:183], v[160:163], v[72:75]
    ds_read_b64_tr_b16 v[144:145], v202 offset:4096
    v_mfma_f32_16x16x32_bf16 v[68:71], v[180:183], v[156:159], v[68:71]
    ds_read_b64_tr_b16 v[146:147], v202 offset:4608
    v_mfma_f32_16x16x32_bf16 v[64:67], v[180:183], v[152:155], v[64:67]
    ds_read_b64_tr_b16 v[148:149], v203 offset:4096
    v_mfma_f32_16x16x32_bf16 v[80:83], v[184:187], v[152:155], v[80:83]
    ds_read_b64_tr_b16 v[150:151], v203 offset:4608
    v_mfma_f32_16x16x32_bf16 v[84:87], v[184:187], v[156:159], v[84:87]
    v_mfma_f32_16x16x32_bf16 v[88:91], v[184:187], v[160:163], v[88:91]
    v_mfma_f32_16x16x32_bf16 v[92:95], v[184:187], v[164:167], v[92:95]
    v_mfma_f32_16x16x32_bf16 v[108:111], v[188:191], v[164:167], v[108:111]
    v_mfma_f32_16x16x32_bf16 v[104:107], v[188:191], v[160:163], v[104:107]
    v_mfma_f32_16x16x32_bf16 v[100:103], v[188:191], v[156:159], v[100:103]
    v_mfma_f32_16x16x32_bf16 v[96:99], v[188:191], v[152:155], v[96:99]
    s_waitcnt lgkmcnt(0)
    v_mfma_f32_16x16x32_bf16 v[16:19], v[128:131], v[112:115], v[16:19]
    ds_read_b128 v[152:155], v201 offset:0
    v_mfma_f32_16x16x32_bf16 v[20:23], v[128:131], v[116:119], v[20:23]
    ds_read_b64_tr_b16 v[168:169], v202 offset:20480
    v_mfma_f32_16x16x32_bf16 v[24:27], v[128:131], v[120:123], v[24:27]
    ds_read_b64_tr_b16 v[170:171], v202 offset:20992
    v_mfma_f32_16x16x32_bf16 v[28:31], v[128:131], v[124:127], v[28:31]
    ds_read_b128 v[156:159], v201 offset:2048
    v_mfma_f32_16x16x32_bf16 v[44:47], v[132:135], v[124:127], v[44:47]
    ds_read_b128 v[160:163], v201 offset:10240
    v_mfma_f32_16x16x32_bf16 v[40:43], v[132:135], v[120:123], v[40:43]
    ds_read_b128 v[164:167], v201 offset:12288
    v_mfma_f32_16x16x32_bf16 v[36:39], v[132:135], v[116:119], v[36:39]
    ds_read_b64_tr_b16 v[172:173], v203 offset:20480
    v_mfma_f32_16x16x32_bf16 v[32:35], v[132:135], v[112:115], v[32:35]
    ds_read_b64_tr_b16 v[174:175], v203 offset:20992
    v_mfma_f32_16x16x32_bf16 v[48:51], v[136:139], v[112:115], v[48:51]
    ds_read_b64_tr_b16 v[176:177], v202 offset:22528
    v_mfma_f32_16x16x32_bf16 v[52:55], v[136:139], v[116:119], v[52:55]
    ds_read_b64_tr_b16 v[178:179], v202 offset:23040
    v_mfma_f32_16x16x32_bf16 v[56:59], v[136:139], v[120:123], v[56:59]
    ds_read_b64_tr_b16 v[180:181], v203 offset:22528
    v_mfma_f32_16x16x32_bf16 v[60:63], v[136:139], v[124:127], v[60:63]
    ds_read_b64_tr_b16 v[182:183], v203 offset:23040
    v_mfma_f32_16x16x32_bf16 v[76:79], v[140:143], v[124:127], v[76:79]
    ds_read_b64_tr_b16 v[184:185], v202 offset:24576
    v_mfma_f32_16x16x32_bf16 v[72:75], v[140:143], v[120:123], v[72:75]
    ds_read_b64_tr_b16 v[186:187], v202 offset:25088
    v_mfma_f32_16x16x32_bf16 v[68:71], v[140:143], v[116:119], v[68:71]
    ds_read_b64_tr_b16 v[188:189], v203 offset:24576
    v_mfma_f32_16x16x32_bf16 v[64:67], v[140:143], v[112:115], v[64:67]
    ds_read_b64_tr_b16 v[190:191], v203 offset:25088
    v_mfma_f32_16x16x32_bf16 v[80:83], v[144:147], v[112:115], v[80:83]
    v_mfma_f32_16x16x32_bf16 v[84:87], v[144:147], v[116:119], v[84:87]
    v_mfma_f32_16x16x32_bf16 v[88:91], v[144:147], v[120:123], v[88:91]
    v_mfma_f32_16x16x32_bf16 v[92:95], v[144:147], v[124:127], v[92:95]
    v_mfma_f32_16x16x32_bf16 v[108:111], v[148:151], v[124:127], v[108:111]
    v_mfma_f32_16x16x32_bf16 v[104:107], v[148:151], v[120:123], v[104:107]
    v_mfma_f32_16x16x32_bf16 v[100:103], v[148:151], v[116:119], v[100:103]
    v_mfma_f32_16x16x32_bf16 v[96:99], v[148:151], v[112:115], v[96:99]
    s_waitcnt lgkmcnt(0)
    v_mfma_f32_16x16x32_bf16 v[16:19], v[168:171], v[152:155], v[16:19]
    s_barrier
    v_mfma_f32_16x16x32_bf16 v[20:23], v[168:171], v[156:159], v[20:23]
    ds_read_b128 v[112:115], v192 offset:0
    v_mfma_f32_16x16x32_bf16 v[24:27], v[168:171], v[160:163], v[24:27]
    ds_read_b64_tr_b16 v[128:129], v194 offset:0
    v_mfma_f32_16x16x32_bf16 v[28:31], v[168:171], v[164:167], v[28:31]
    ds_read_b64_tr_b16 v[130:131], v194 offset:512
    v_mfma_f32_16x16x32_bf16 v[44:47], v[172:175], v[164:167], v[44:47]
    ds_read_b128 v[116:119], v192 offset:2048
    v_mfma_f32_16x16x32_bf16 v[40:43], v[172:175], v[160:163], v[40:43]
    ds_read_b128 v[120:123], v192 offset:10240
    v_mfma_f32_16x16x32_bf16 v[36:39], v[172:175], v[156:159], v[36:39]
    ds_read_b128 v[124:127], v192 offset:12288
    v_mfma_f32_16x16x32_bf16 v[32:35], v[172:175], v[152:155], v[32:35]
    ds_read_b64_tr_b16 v[132:133], v195 offset:0
    v_mfma_f32_16x16x32_bf16 v[48:51], v[176:179], v[152:155], v[48:51]
    ds_read_b64_tr_b16 v[134:135], v195 offset:512
    v_mfma_f32_16x16x32_bf16 v[52:55], v[176:179], v[156:159], v[52:55]
    ds_read_b64_tr_b16 v[136:137], v194 offset:2048
    v_mfma_f32_16x16x32_bf16 v[56:59], v[176:179], v[160:163], v[56:59]
    ds_read_b64_tr_b16 v[138:139], v194 offset:2560
    v_mfma_f32_16x16x32_bf16 v[60:63], v[176:179], v[164:167], v[60:63]
    ds_read_b64_tr_b16 v[140:141], v195 offset:2048
    v_mfma_f32_16x16x32_bf16 v[76:79], v[180:183], v[164:167], v[76:79]
    ds_read_b64_tr_b16 v[142:143], v195 offset:2560
    v_mfma_f32_16x16x32_bf16 v[72:75], v[180:183], v[160:163], v[72:75]
    ds_read_b64_tr_b16 v[144:145], v194 offset:4096
    v_mfma_f32_16x16x32_bf16 v[68:71], v[180:183], v[156:159], v[68:71]
    ds_read_b64_tr_b16 v[146:147], v194 offset:4608
    v_mfma_f32_16x16x32_bf16 v[64:67], v[180:183], v[152:155], v[64:67]
    ds_read_b64_tr_b16 v[148:149], v195 offset:4096
    v_mfma_f32_16x16x32_bf16 v[80:83], v[184:187], v[152:155], v[80:83]
    ds_read_b64_tr_b16 v[150:151], v195 offset:4608
    v_mfma_f32_16x16x32_bf16 v[84:87], v[184:187], v[156:159], v[84:87]
    v_mfma_f32_16x16x32_bf16 v[88:91], v[184:187], v[160:163], v[88:91]
    v_mfma_f32_16x16x32_bf16 v[92:95], v[184:187], v[164:167], v[92:95]
    v_mfma_f32_16x16x32_bf16 v[108:111], v[188:191], v[164:167], v[108:111]
    v_mfma_f32_16x16x32_bf16 v[104:107], v[188:191], v[160:163], v[104:107]
    v_mfma_f32_16x16x32_bf16 v[100:103], v[188:191], v[156:159], v[100:103]
    v_mfma_f32_16x16x32_bf16 v[96:99], v[188:191], v[152:155], v[96:99]
    s_waitcnt lgkmcnt(0)
    v_mfma_f32_16x16x32_bf16 v[16:19], v[128:131], v[112:115], v[16:19]
    ds_read_b128 v[152:155], v193 offset:0
    v_mfma_f32_16x16x32_bf16 v[20:23], v[128:131], v[116:119], v[20:23]
    ds_read_b64_tr_b16 v[168:169], v194 offset:20480
    v_mfma_f32_16x16x32_bf16 v[24:27], v[128:131], v[120:123], v[24:27]
    ds_read_b64_tr_b16 v[170:171], v194 offset:20992
    v_mfma_f32_16x16x32_bf16 v[28:31], v[128:131], v[124:127], v[28:31]
    ds_read_b128 v[156:159], v193 offset:2048
    v_mfma_f32_16x16x32_bf16 v[44:47], v[132:135], v[124:127], v[44:47]
    ds_read_b128 v[160:163], v193 offset:10240
    v_mfma_f32_16x16x32_bf16 v[40:43], v[132:135], v[120:123], v[40:43]
    ds_read_b128 v[164:167], v193 offset:12288
    v_mfma_f32_16x16x32_bf16 v[36:39], v[132:135], v[116:119], v[36:39]
    ds_read_b64_tr_b16 v[172:173], v195 offset:20480
    v_mfma_f32_16x16x32_bf16 v[32:35], v[132:135], v[112:115], v[32:35]
    ds_read_b64_tr_b16 v[174:175], v195 offset:20992
    v_mfma_f32_16x16x32_bf16 v[48:51], v[136:139], v[112:115], v[48:51]
    ds_read_b64_tr_b16 v[176:177], v194 offset:22528
    v_mfma_f32_16x16x32_bf16 v[52:55], v[136:139], v[116:119], v[52:55]
    ds_read_b64_tr_b16 v[178:179], v194 offset:23040
    v_mfma_f32_16x16x32_bf16 v[56:59], v[136:139], v[120:123], v[56:59]
    ds_read_b64_tr_b16 v[180:181], v195 offset:22528
    v_mfma_f32_16x16x32_bf16 v[60:63], v[136:139], v[124:127], v[60:63]
    ds_read_b64_tr_b16 v[182:183], v195 offset:23040
    v_mfma_f32_16x16x32_bf16 v[76:79], v[140:143], v[124:127], v[76:79]
    ds_read_b64_tr_b16 v[184:185], v194 offset:24576
    v_mfma_f32_16x16x32_bf16 v[72:75], v[140:143], v[120:123], v[72:75]
    ds_read_b64_tr_b16 v[186:187], v194 offset:25088
    v_mfma_f32_16x16x32_bf16 v[68:71], v[140:143], v[116:119], v[68:71]
    ds_read_b64_tr_b16 v[188:189], v195 offset:24576
    v_mfma_f32_16x16x32_bf16 v[64:67], v[140:143], v[112:115], v[64:67]
    ds_read_b64_tr_b16 v[190:191], v195 offset:25088
    v_mfma_f32_16x16x32_bf16 v[80:83], v[144:147], v[112:115], v[80:83]
    v_mfma_f32_16x16x32_bf16 v[84:87], v[144:147], v[116:119], v[84:87]
    v_mfma_f32_16x16x32_bf16 v[88:91], v[144:147], v[120:123], v[88:91]
    v_mfma_f32_16x16x32_bf16 v[92:95], v[144:147], v[124:127], v[92:95]
    v_mfma_f32_16x16x32_bf16 v[108:111], v[148:151], v[124:127], v[108:111]
    s_add_u32 s68, s68, 1
    s_cmp_lt_u32 s68, 5
    v_mfma_f32_16x16x32_bf16 v[104:107], v[148:151], v[120:123], v[104:107]
    v_mfma_f32_16x16x32_bf16 v[100:103], v[148:151], v[116:119], v[100:103]
    v_mfma_f32_16x16x32_bf16 v[96:99], v[148:151], v[112:115], v[96:99]
    s_waitcnt lgkmcnt(0)
    v_mfma_f32_16x16x32_bf16 v[16:19], v[168:171], v[152:155], v[16:19]
    s_cbranch_scc0 L_cexit
    s_barrier
    v_mfma_f32_16x16x32_bf16 v[20:23], v[168:171], v[156:159], v[20:23]
    ds_read_b128 v[112:115], v196 offset:0
    v_mfma_f32_16x16x32_bf16 v[24:27], v[168:171], v[160:163], v[24:27]
    ds_read_b64_tr_b16 v[128:129], v198 offset:0
    s_branch L_cloop
L_cexit:
    v_mfma_f32_16x16x32_bf16 v[20:23], v[168:171], v[156:159], v[20:23]
    v_mfma_f32_16x16x32_bf16 v[24:27], v[168:171], v[160:163], v[24:27]
    v_mfma_f32_16x16x32_bf16 v[28:31], v[168:171], v[164:167], v[28:31]
    v_mfma_f32_16x16x32_bf16 v[44:47], v[172:175], v[164:167], v[44:47]
    v_mfma_f32_16x16x32_bf16 v[40:43], v[172:175], v[160:163], v[40:43]
    v_mfma_f32_16x16x32_bf16 v[36:39], v[172:175], v[156:159], v[36:39]
    v_mfma_f32_16x16x32_bf16 v[32:35], v[172:175], v[152:155], v[32:35]
    v_mfma_f32_16x16x32_bf16 v[48:51], v[176:179], v[152:155], v[48:51]
    v_mfma_f32_16x16x32_bf16 v[52:55], v[176:179], v[156:159], v[52:55]
    v_mfma_f32_16x16x32_bf16 v[56:59], v[176:179], v[160:163], v[56:59]
    s_barrier
    ds_read_b32 v11, v10 offset:53248
    ds_read_b64 v[222:223], v213 offset:49152
    ds_read_b64 v[224:225], v213 offset:49280
    v_mfma_f32_16x16x32_bf16 v[60:63], v[176:179], v[164:167], v[60:63]
    ds_read_b64 v[226:227], v213 offset:49408
    ds_read_b64 v[228:229], v213 offset:49536
    v_mfma_f32_16x16x32_bf16 v[76:79], v[180:183], v[164:167], v[76:79]
    ds_read_b64 v[238:239], v215 offset:50176
    ds_read_b64 v[240:241], v215 offset:50304
    v_mfma_f32_16x16x32_bf16 v[72:75], v[180:183], v[160:163], v[72:75]
    ds_read_b64 v[242:243], v215 offset:50688
    ds_read_b64 v[244:245], v215 offset:50816
    v_mfma_f32_16x16x32_bf16 v[68:71], v[180:183], v[156:159], v[68:71]
    ds_read_b64 v[246:247], v215 offset:51200
    ds_read_b64 v[248:249], v215 offset:51328
    v_mfma_f32_16x16x32_bf16 v[64:67], v[180:183], v[152:155], v[64:67]
    ds_read_b32 v250, v214 offset:49156
    ds_read_b32 v252, v214 offset:49412
    v_mfma_f32_16x16x32_bf16 v[80:83], v[184:187], v[152:155], v[80:83]
    s_waitcnt lgkmcnt(8)
    v_readfirstlane_b32 s100, v11
    v_mov_b32_e64 v230, v223
    v_cndmask_b32 v222, 0, v222, s[86:87]
    v_mfma_f32_16x16x32_bf16 v[84:87], v[184:187], v[156:159], v[84:87]
    v_mov_b32_e64 v232, v225
    v_cndmask_b32 v224, 0, v224, s[86:87]
    v_mov_b32_e64 v234, v227
    v_cndmask_b32 v226, 0, v226, s[86:87]
    v_mfma_f32_16x16x32_bf16 v[88:91], v[184:187], v[160:163], v[88:91]
    v_mov_b32_e64 v236, v229
    v_cndmask_b32 v228, 0, v228, s[86:87]
    v_mov_b32 v223, v222
    v_mov_b32 v225, v224
    v_mfma_f32_16x16x32_bf16 v[92:95], v[184:187], v[164:167], v[92:95]
    v_mov_b32 v227, v226
    v_mov_b32_e64 v229, v228
    s_waitcnt lgkmcnt(0)
    v_mul_f32 v251, 0x3fb8aa3b, v250
    v_mfma_f32_16x16x32_bf16 v[108:111], v[188:191], v[164:167], v[108:111]
    v_mul_f32 v253, 0x3fb8aa3b, v252
    v_mfma_f32_16x16x32_bf16 v[104:107], v[188:191], v[160:163], v[104:107]
    v_mfma_f32_16x16x32_bf16 v[100:103], v[188:191], v[156:159], v[100:103]
    v_mfma_f32_16x16x32_bf16 v[96:99], v[188:191], v[152:155], v[96:99]
    v_mfma_f32_16x16x16_bf16 v[48:51], v[242:243], v[222:223], v[48:51]
    v_xor_b32 v168, 0, v217
    v_xor_b32 v169, 16, v217
    v_mfma_f32_16x16x16_bf16 v[52:55], v[242:243], v[224:225], v[52:55]
    v_xor_b32 v170, 32, v217
    v_xor_b32 v171, 48, v217
    v_mfma_f32_16x16x16_bf16 v[64:67], v[244:245], v[222:223], v[64:67]
    v_xor_b32_e64 v172, 64, v217
    v_xor_b32 v173, 80, v217
    v_mfma_f32_16x16x16_bf16 v[68:71], v[244:245], v[224:225], v[68:71]
    v_xor_b32 v174, 96, v217
    v_xor_b32 v175, 112, v217
    v_mfma_f32_16x16x16_bf16 v[56:59], v[242:243], v[226:227], v[56:59]
    v_xor_b32_e64 v4, 32, v216
    v_mfma_f32_16x16x16_bf16 v[60:63], v[242:243], v[228:229], v[60:63]
    v_mfma_f32_16x16x16_bf16 v[72:75], v[244:245], v[226:227], v[72:75]
    v_mfma_f32_16x16x16_bf16 v[76:79], v[244:245], v[228:229], v[76:79]
    v_mfma_f32_16x16x16_bf16 v[80:83], v[246:247], v[222:223], v[80:83]
    v_cvt_pk_bf16_f32 v112, v48, v49
    v_cvt_pk_bf16_f32 v113, v50, v51
    v_mfma_f32_16x16x16_bf16 v[84:87], v[246:247], v[224:225], v[84:87]
    v_cvt_pk_bf16_f32 v114, v52, v53
    v_cvt_pk_bf16_f32 v115, v54, v55
    v_mfma_f32_16x16x16_bf16 v[88:91], v[246:247], v[226:227], v[88:91]
    v_cvt_pk_bf16_f32 v116, v64, v65
    v_cvt_pk_bf16_f32 v117, v66, v67
    v_mfma_f32_16x16x16_bf16 v[92:95], v[246:247], v[228:229], v[92:95]
    v_cvt_pk_bf16_f32 v118, v68, v69
    v_cvt_pk_bf16_f32 v119, v70, v71
    v_mfma_f32_16x16x16_bf16 v[96:99], v[248:249], v[222:223], v[96:99]
    v_cvt_pk_bf16_f32 v120, v56, v57
    v_cvt_pk_bf16_f32 v121, v58, v59
    v_mfma_f32_16x16x16_bf16 v[100:103], v[248:249], v[224:225], v[100:103]
    v_cvt_pk_bf16_f32 v122, v60, v61
    v_cvt_pk_bf16_f32 v123, v62, v63
    v_mfma_f32_16x16x16_bf16 v[104:107], v[248:249], v[226:227], v[104:107]
    v_permlane16_swap_b32 v112, v114
    v_permlane16_swap_b32 v113, v115
    v_mfma_f32_16x16x16_bf16 v[108:111], v[248:249], v[228:229], v[108:111]
    v_permlane16_swap_b32 v116, v118
    v_permlane16_swap_b32 v117, v119
    v_cvt_pk_bf16_f32 v124, v72, v73
    v_cvt_pk_bf16_f32 v125, v74, v75
    v_cvt_pk_bf16_f32 v126, v76, v77
    v_cvt_pk_bf16_f32 v127, v78, v79
    v_permlane16_swap_b32 v120, v122
    v_permlane16_swap_b32 v121, v123
    v_permlane16_swap_b32 v124, v126
    v_permlane16_swap_b32 v125, v127
    v_mfma_f32_32x32x16_bf16 v[48:63], v[204:207], v[112:115], 0
    v_mul_f32 v80, v80, v230
    v_mul_f32 v81, v81, v230
    v_mul_f32 v82, v82, v230
    v_mul_f32 v83, v83, v230
    v_cvt_pk_bf16_f32 v80, v80, v81
    v_cvt_pk_bf16_f32 v81, v82, v83
    v_mfma_f32_32x32x16_bf16 v[64:79], v[204:207], v[120:123], 0
    v_mul_f32 v96, v96, v230
    v_mul_f32 v97, v97, v230
    v_mul_f32 v98, v98, v230
    v_mul_f32 v99, v99, v230
    v_cvt_pk_bf16_f32 v96, v96, v97
    v_cvt_pk_bf16_f32 v97, v98, v99
    v_mfma_f32_32x32x16_bf16 v[48:63], v[208:211], v[116:119], v[48:63]
    v_mul_f32 v84, v84, v232
    v_mul_f32 v85, v85, v232
    v_mul_f32 v86, v86, v232
    v_mul_f32 v87, v87, v232
    v_cvt_pk_bf16_f32 v84, v84, v85
    v_cvt_pk_bf16_f32 v85, v86, v87
    v_mfma_f32_32x32x16_bf16 v[64:79], v[208:211], v[124:127], v[64:79]
    v_mul_f32 v100, v100, v232
    v_mul_f32 v101, v101, v232
    v_mul_f32 v102, v102, v232
    v_mul_f32 v103, v103, v232
    v_cvt_pk_bf16_f32 v100, v100, v101
    v_cvt_pk_bf16_f32 v101, v102, v103
    v_mul_f32 v88, v88, v234
    v_mul_f32 v89, v89, v234
    v_mul_f32 v90, v90, v234
    v_mul_f32 v91, v91, v234
    v_cvt_pk_bf16_f32 v88, v88, v89
    v_cvt_pk_bf16_f32 v89, v90, v91
    v_mul_f32 v104, v104, v234
    v_mul_f32 v105, v105, v234
    v_mul_f32 v106, v106, v234
    v_mul_f32 v107, v107, v234
    v_cvt_pk_bf16_f32 v104, v104, v105
    v_cvt_pk_bf16_f32 v105, v106, v107
    v_mul_f32 v92, v92, v236
    v_mul_f32 v93, v93, v236
    v_mul_f32 v94, v94, v236
    v_mul_f32 v95, v95, v236
    v_cvt_pk_bf16_f32 v92, v92, v93
    v_cvt_pk_bf16_f32 v93, v94, v95
    v_mul_f32 v108, v108, v236
    v_mul_f32 v109, v109, v236
    v_mul_f32 v110, v110, v236
    v_mul_f32 v111, v111, v236
    v_cvt_pk_bf16_f32 v108, v108, v109
    v_cvt_pk_bf16_f32 v109, v110, v111
    v_max3_f32 v160, v48, v49, v50
    v_min3_f32 v162, v48, v49, v50
    v_max3_f32 v160, v160, v51, v52
    v_min3_f32 v162, v162, v51, v52
    v_max3_f32 v160, v160, v53, v54
    v_min3_f32 v162, v162, v53, v54
    v_max3_f32 v160, v160, v55, v56
    v_min3_f32 v162, v162, v55, v56
    v_max3_f32 v160, v160, v57, v58
    v_min3_f32 v162, v162, v57, v58
    v_max3_f32 v160, v160, v59, v60
    v_min3_f32 v162, v162, v59, v60
    v_max3_f32 v160, v160, v61, v62
    v_min3_f32 v162, v162, v61, v62
    v_max_f32 v160, v160, v63
    v_min_f32 v162, v162, v63
    v_max3_f32 v164, v64, v65, v66
    v_min3_f32 v166, v64, v65, v66
    v_max3_f32 v164, v164, v67, v68
    v_min3_f32 v166, v166, v67, v68
    v_max3_f32 v164, v164, v69, v70
    v_min3_f32 v166, v166, v69, v70
    v_max3_f32 v164, v164, v71, v72
    v_min3_f32 v166, v166, v71, v72
    v_max3_f32 v164, v164, v73, v74
    v_min3_f32 v166, v166, v73, v74
    v_max3_f32 v164, v164, v75, v76
    v_min3_f32 v166, v166, v75, v76
    v_max3_f32 v164, v164, v77, v78
    v_min3_f32 v166, v166, v77, v78
    v_max_f32 v164, v164, v79
    v_min_f32 v166, v166, v79
    v_mov_b32 v161, v160
    v_mov_b32 v163, v162
    v_mov_b32 v165, v164
    v_mov_b32 v167, v166
    v_permlane32_swap_b32 v160, v161
    v_permlane32_swap_b32 v162, v163
    v_permlane32_swap_b32 v164, v165
    v_permlane32_swap_b32 v166, v167
    v_max_f32 v160, v160, v161
    v_min_f32 v162, v162, v163
    v_max_f32 v164, v164, v165
    v_min_f32 v166, v166, v167
    v_mul_f32 v160, v160, v251
    v_mul_f32 v162, v162, v251
    v_mul_f32 v164, v164, v253
    v_mul_f32 v166, v166, v253
    v_pk_fma_f32 v[128:129], v[48:49], v[250:251], v[160:161] op_sel:[0,1,0] op_sel_hi:[1,1,0] neg_lo:[0,0,1] neg_hi:[0,0,1]
    v_pk_fma_f32 v[48:49], v[48:49], v[250:251], v[162:163] op_sel:[0,1,0] op_sel_hi:[1,1,0] neg_lo:[0,1,0] neg_hi:[0,1,0]
    v_pk_fma_f32 v[130:131], v[50:51], v[250:251], v[160:161] op_sel:[0,1,0] op_sel_hi:[1,1,0] neg_lo:[0,0,1] neg_hi:[0,0,1]
    v_pk_fma_f32 v[50:51], v[50:51], v[250:251], v[162:163] op_sel:[0,1,0] op_sel_hi:[1,1,0] neg_lo:[0,1,0] neg_hi:[0,1,0]
    v_pk_fma_f32 v[132:133], v[52:53], v[250:251], v[160:161] op_sel:[0,1,0] op_sel_hi:[1,1,0] neg_lo:[0,0,1] neg_hi:[0,0,1]
    v_pk_fma_f32 v[52:53], v[52:53], v[250:251], v[162:163] op_sel:[0,1,0] op_sel_hi:[1,1,0] neg_lo:[0,1,0] neg_hi:[0,1,0]
    v_pk_fma_f32 v[134:135], v[54:55], v[250:251], v[160:161] op_sel:[0,1,0] op_sel_hi:[1,1,0] neg_lo:[0,0,1] neg_hi:[0,0,1]
    v_pk_fma_f32 v[54:55], v[54:55], v[250:251], v[162:163] op_sel:[0,1,0] op_sel_hi:[1,1,0] neg_lo:[0,1,0] neg_hi:[0,1,0]
    v_pk_fma_f32 v[136:137], v[56:57], v[250:251], v[160:161] op_sel:[0,1,0] op_sel_hi:[1,1,0] neg_lo:[0,0,1] neg_hi:[0,0,1]
    v_pk_fma_f32 v[56:57], v[56:57], v[250:251], v[162:163] op_sel:[0,1,0] op_sel_hi:[1,1,0] neg_lo:[0,1,0] neg_hi:[0,1,0]
    v_pk_fma_f32 v[138:139], v[58:59], v[250:251], v[160:161] op_sel:[0,1,0] op_sel_hi:[1,1,0] neg_lo:[0,0,1] neg_hi:[0,0,1]
    v_pk_fma_f32 v[58:59], v[58:59], v[250:251], v[162:163] op_sel:[0,1,0] op_sel_hi:[1,1,0] neg_lo:[0,1,0] neg_hi:[0,1,0]
    v_pk_fma_f32 v[140:141], v[60:61], v[250:251], v[160:161] op_sel:[0,1,0] op_sel_hi:[1,1,0] neg_lo:[0,0,1] neg_hi:[0,0,1]
    v_pk_fma_f32 v[60:61], v[60:61], v[250:251], v[162:163] op_sel:[0,1,0] op_sel_hi:[1,1,0] neg_lo:[0,1,0] neg_hi:[0,1,0]
    v_pk_fma_f32 v[142:143], v[62:63], v[250:251], v[160:161] op_sel:[0,1,0] op_sel_hi:[1,1,0] neg_lo:[0,0,1] neg_hi:[0,0,1]
    v_pk_fma_f32 v[62:63], v[62:63], v[250:251], v[162:163] op_sel:[0,1,0] op_sel_hi:[1,1,0] neg_lo:[0,1,0] neg_hi:[0,1,0]
    v_pk_fma_f32 v[144:145], v[64:65], v[252:253], v[164:165] op_sel:[0,1,0] op_sel_hi:[1,1,0] neg_lo:[0,0,1] neg_hi:[0,0,1]
    v_pk_fma_f32 v[64:65], v[64:65], v[252:253], v[166:167] op_sel:[0,1,0] op_sel_hi:[1,1,0] neg_lo:[0,1,0] neg_hi:[0,1,0]
    v_pk_fma_f32 v[146:147], v[66:67], v[252:253], v[164:165] op_sel:[0,1,0] op_sel_hi:[1,1,0] neg_lo:[0,0,1] neg_hi:[0,0,1]
    v_pk_fma_f32 v[66:67], v[66:67], v[252:253], v[166:167] op_sel:[0,1,0] op_sel_hi:[1,1,0] neg_lo:[0,1,0] neg_hi:[0,1,0]
    v_pk_fma_f32 v[148:149], v[68:69], v[252:253], v[164:165] op_sel:[0,1,0] op_sel_hi:[1,1,0] neg_lo:[0,0,1] neg_hi:[0,0,1]
    v_pk_fma_f32 v[68:69], v[68:69], v[252:253], v[166:167] op_sel:[0,1,0] op_sel_hi:[1,1,0] neg_lo:[0,1,0] neg_hi:[0,1,0]
    v_pk_fma_f32 v[150:151], v[70:71], v[252:253], v[164:165] op_sel:[0,1,0] op_sel_hi:[1,1,0] neg_lo:[0,0,1] neg_hi:[0,0,1]
    v_pk_fma_f32 v[70:71], v[70:71], v[252:253], v[166:167] op_sel:[0,1,0] op_sel_hi:[1,1,0] neg_lo:[0,1,0] neg_hi:[0,1,0]
    v_pk_fma_f32 v[152:153], v[72:73], v[252:253], v[164:165] op_sel:[0,1,0] op_sel_hi:[1,1,0] neg_lo:[0,0,1] neg_hi:[0,0,1]
    v_pk_fma_f32 v[72:73], v[72:73], v[252:253], v[166:167] op_sel:[0,1,0] op_sel_hi:[1,1,0] neg_lo:[0,1,0] neg_hi:[0,1,0]
    v_pk_fma_f32 v[154:155], v[74:75], v[252:253], v[164:165] op_sel:[0,1,0] op_sel_hi:[1,1,0] neg_lo:[0,0,1] neg_hi:[0,0,1]
    v_pk_fma_f32 v[74:75], v[74:75], v[252:253], v[166:167] op_sel:[0,1,0] op_sel_hi:[1,1,0] neg_lo:[0,1,0] neg_hi:[0,1,0]
    v_pk_fma_f32 v[156:157], v[76:77], v[252:253], v[164:165] op_sel:[0,1,0] op_sel_hi:[1,1,0] neg_lo:[0,0,1] neg_hi:[0,0,1]
    v_pk_fma_f32 v[76:77], v[76:77], v[252:253], v[166:167] op_sel:[0,1,0] op_sel_hi:[1,1,0] neg_lo:[0,1,0] neg_hi:[0,1,0]
    v_pk_fma_f32 v[158:159], v[78:79], v[252:253], v[164:165] op_sel:[0,1,0] op_sel_hi:[1,1,0] neg_lo:[0,0,1] neg_hi:[0,0,1]
    v_pk_fma_f32 v[78:79], v[78:79], v[252:253], v[166:167] op_sel:[0,1,0] op_sel_hi:[1,1,0] neg_lo:[0,1,0] neg_hi:[0,1,0]
    v_exp_f32_e64 v128, v128
    v_mfma_f32_16x16x16_bf16 v[16:19], v[238:239], v[222:223], v[16:19]
    v_exp_f32 v144, v144
    v_exp_f32 v129, v129
    v_exp_f32_e64 v145, v145
    v_mfma_f32_16x16x16_bf16 v[20:23], v[238:239], v[224:225], v[20:23]
    ds_write2st64_b64 v216, v[80:81], v[84:85] offset0:64 offset1:68
    v_exp_f32 v130, v130
    v_exp_f32 v146, v146
    v_exp_f32_e64 v131, v131
    v_mfma_f32_16x16x16_bf16 v[24:27], v[238:239], v[226:227], v[24:27]
    v_exp_f32 v147, v147
    v_exp_f32 v132, v132
    v_exp_f32_e64 v148, v148
    v_mfma_f32_16x16x16_bf16 v[28:31], v[238:239], v[228:229], v[28:31]
    ds_write2st64_b64 v4, v[96:97], v[100:101] offset0:64 offset1:68
    v_exp_f32 v133, v133
    v_exp_f32 v149, v149
    v_exp_f32_e64 v134, v134
    v_mfma_f32_16x16x16_bf16 v[32:35], v[240:241], v[222:223], v[32:35]
    v_exp_f32 v150, v150
    v_exp_f32 v135, v135
    v_exp_f32_e64 v151, v151
    v_mfma_f32_16x16x16_bf16 v[36:39], v[240:241], v[224:225], v[36:39]
    ds_write2st64_b64 v216, v[88:89], v[92:93] offset0:72 offset1:76
    v_exp_f32 v136, v136
    v_exp_f32 v152, v152
    v_exp_f32_e64 v137, v137
    v_mfma_f32_16x16x16_bf16 v[40:43], v[240:241], v[226:227], v[40:43]
    v_exp_f32 v153, v153
    v_exp_f32 v138, v138
    v_exp_f32_e64 v154, v154
    v_mfma_f32_16x16x16_bf16 v[44:47], v[240:241], v[228:229], v[44:47]
    ds_write2st64_b64 v4, v[104:105], v[108:109] offset0:72 offset1:76
    v_exp_f32 v139, v139
    v_exp_f32 v155, v155
    v_exp_f32 v140, v140
    v_exp_f32 v156, v156
    v_exp_f32 v141, v141
    v_exp_f32 v157, v157
    v_exp_f32 v142, v142
    v_exp_f32 v158, v158
    v_exp_f32 v143, v143
    v_exp_f32 v159, v159
    v_pk_add_f32 v[176:177], v[128:129], v[130:131]
    v_pk_add_f32 v[178:179], v[144:145], v[146:147]
    v_pk_add_f32 v[176:177], v[176:177], v[132:133]
    v_pk_add_f32 v[178:179], v[178:179], v[148:149]
    v_pk_add_f32 v[176:177], v[176:177], v[134:135]
    v_pk_add_f32 v[178:179], v[178:179], v[150:151]
    v_pk_add_f32 v[176:177], v[176:177], v[136:137]
    v_pk_add_f32 v[178:179], v[178:179], v[152:153]
    v_pk_add_f32 v[176:177], v[176:177], v[138:139]
    v_pk_add_f32 v[178:179], v[178:179], v[154:155]
    v_pk_add_f32 v[176:177], v[176:177], v[140:141]
    v_pk_add_f32 v[178:179], v[178:179], v[156:157]
    v_pk_add_f32 v[176:177], v[176:177], v[142:143]
    v_pk_add_f32 v[178:179], v[178:179], v[158:159]
    v_exp_f32 v48, v48
    v_add_f32 v176, v176, v177
    v_add_f32 v178, v178, v179
    v_exp_f32 v64, v64
    v_mov_b32 v177, v176
    v_mov_b32 v179, v178
    v_exp_f32 v49, v49
    v_permlane32_swap_b32 v176, v177
    v_permlane32_swap_b32 v178, v179
    v_exp_f32 v65, v65
    v_add_f32 v176, v176, v177
    v_add_f32 v178, v178, v179
    v_exp_f32 v50, v50
    v_rcp_f32 v176, v176
    v_rcp_f32 v178, v178
    v_exp_f32 v66, v66
    v_exp_f32 v51, v51
    v_exp_f32 v67, v67
    v_exp_f32 v52, v52
    v_exp_f32 v68, v68
    v_exp_f32 v53, v53
    v_exp_f32 v69, v69
    v_exp_f32 v54, v54
    v_exp_f32 v70, v70
    v_exp_f32 v55, v55
    v_exp_f32 v71, v71
    v_exp_f32 v56, v56
    v_exp_f32 v72, v72
    v_exp_f32 v57, v57
    v_exp_f32 v73, v73
    v_exp_f32 v58, v58
    v_exp_f32 v74, v74
    v_exp_f32 v59, v59
    v_exp_f32 v75, v75
    v_exp_f32 v60, v60
    v_exp_f32 v76, v76
    v_exp_f32 v61, v61
    v_exp_f32 v77, v77
    v_exp_f32 v62, v62
    v_exp_f32 v78, v78
    v_exp_f32 v63, v63
    v_exp_f32 v79, v79
    v_pk_add_f32 v[180:181], v[48:49], v[50:51]
    v_pk_add_f32 v[182:183], v[64:65], v[66:67]
    v_pk_add_f32 v[180:181], v[180:181], v[52:53]
    v_pk_add_f32 v[182:183], v[182:183], v[68:69]
    v_pk_add_f32 v[180:181], v[180:181], v[54:55]
    v_pk_add_f32 v[182:183], v[182:183], v[70:71]
    v_pk_add_f32 v[180:181], v[180:181], v[56:57]
    v_pk_add_f32 v[182:183], v[182:183], v[72:73]
    v_pk_add_f32 v[180:181], v[180:181], v[58:59]
    v_pk_add_f32 v[182:183], v[182:183], v[74:75]
    v_pk_add_f32 v[180:181], v[180:181], v[60:61]
    v_pk_add_f32 v[182:183], v[182:183], v[76:77]
    v_pk_add_f32 v[180:181], v[180:181], v[62:63]
    v_pk_add_f32 v[182:183], v[182:183], v[78:79]
    v_add_f32 v180, v180, v181
    v_add_f32 v182, v182, v183
    v_mov_b32 v181, v180
    v_mov_b32 v183, v182
    v_pk_mul_f32 v[128:129], v[128:129], v[176:177] op_sel_hi:[1,0]
    v_pk_mul_f32 v[130:131], v[130:131], v[176:177] op_sel_hi:[1,0]
    v_cvt_pk_bf16_f32 v128, v128, v129
    v_permlane32_swap_b32 v180, v181
    v_permlane32_swap_b32 v182, v183
    v_cvt_pk_bf16_f32 v129, v130, v131
    v_pk_mul_f32 v[144:145], v[144:145], v[178:179] op_sel_hi:[1,0]
    v_pk_mul_f32 v[146:147], v[146:147], v[178:179] op_sel_hi:[1,0]
    v_cvt_pk_bf16_f32 v144, v144, v145
    v_cvt_pk_bf16_f32 v145, v146, v147
    v_add_f32 v180, v180, v181
    v_add_f32 v182, v182, v183
    ds_write2st64_b64 v168, v[128:129], v[144:145] offset0:0 offset1:8
    v_pk_mul_f32 v[132:133], v[132:133], v[176:177] op_sel_hi:[1,0]
    v_pk_mul_f32 v[134:135], v[134:135], v[176:177] op_sel_hi:[1,0]
    v_cvt_pk_bf16_f32 v132, v132, v133
    v_cvt_pk_bf16_f32 v133, v134, v135
    v_pk_mul_f32 v[148:149], v[148:149], v[178:179] op_sel_hi:[1,0]
    v_rcp_f32 v180, v180
    v_rcp_f32 v182, v182
    v_pk_mul_f32 v[150:151], v[150:151], v[178:179] op_sel_hi:[1,0]
    v_cvt_pk_bf16_f32 v148, v148, v149
    v_cvt_pk_bf16_f32 v149, v150, v151
    ds_write2st64_b64 v169, v[132:133], v[148:149] offset0:0 offset1:8
    v_pk_mul_f32 v[136:137], v[136:137], v[176:177] op_sel_hi:[1,0]
    v_pk_mul_f32 v[138:139], v[138:139], v[176:177] op_sel_hi:[1,0]
    v_cvt_pk_bf16_f32 v136, v136, v137
    v_cvt_pk_bf16_f32 v137, v138, v139
    v_pk_mul_f32 v[152:153], v[152:153], v[178:179] op_sel_hi:[1,0]
    v_pk_mul_f32 v[154:155], v[154:155], v[178:179] op_sel_hi:[1,0]
    v_cvt_pk_bf16_f32 v152, v152, v153
    v_cvt_pk_bf16_f32 v153, v154, v155
    ds_write2st64_b64 v170, v[136:137], v[152:153] offset0:0 offset1:8
    v_pk_mul_f32 v[140:141], v[140:141], v[176:177] op_sel_hi:[1,0]
    v_pk_mul_f32 v[142:143], v[142:143], v[176:177] op_sel_hi:[1,0]
    v_cvt_pk_bf16_f32 v140, v140, v141
    v_cvt_pk_bf16_f32 v141, v142, v143
    v_pk_mul_f32 v[156:157], v[156:157], v[178:179] op_sel_hi:[1,0]
    v_pk_mul_f32 v[158:159], v[158:159], v[178:179] op_sel_hi:[1,0]
    v_cvt_pk_bf16_f32 v156, v156, v157
    v_cvt_pk_bf16_f32 v157, v158, v159
    ds_write2st64_b64 v171, v[140:141], v[156:157] offset0:0 offset1:8
    v_pk_mul_f32 v[48:49], v[48:49], v[180:181] op_sel_hi:[1,0]
    v_pk_mul_f32 v[50:51], v[50:51], v[180:181] op_sel_hi:[1,0]
    v_cvt_pk_bf16_f32 v48, v48, v49
    v_cvt_pk_bf16_f32 v49, v50, v51
    v_pk_mul_f32 v[64:65], v[64:65], v[182:183] op_sel_hi:[1,0]
    v_pk_mul_f32 v[66:67], v[66:67], v[182:183] op_sel_hi:[1,0]
    v_cvt_pk_bf16_f32 v64, v64, v65
    v_cvt_pk_bf16_f32 v65, v66, v67
    ds_write2st64_b64 v172, v[48:49], v[64:65] offset0:0 offset1:8
    v_pk_mul_f32 v[52:53], v[52:53], v[180:181] op_sel_hi:[1,0]
    v_pk_mul_f32 v[54:55], v[54:55], v[180:181] op_sel_hi:[1,0]
    v_cvt_pk_bf16_f32 v52, v52, v53
    v_cvt_pk_bf16_f32 v53, v54, v55
    v_pk_mul_f32 v[68:69], v[68:69], v[182:183] op_sel_hi:[1,0]
    v_pk_mul_f32 v[70:71], v[70:71], v[182:183] op_sel_hi:[1,0]
    v_cvt_pk_bf16_f32 v68, v68, v69
    v_cvt_pk_bf16_f32 v69, v70, v71
    ds_write2st64_b64 v173, v[52:53], v[68:69] offset0:0 offset1:8
    v_pk_mul_f32 v[56:57], v[56:57], v[180:181] op_sel_hi:[1,0]
    v_pk_mul_f32 v[58:59], v[58:59], v[180:181] op_sel_hi:[1,0]
    v_cvt_pk_bf16_f32 v56, v56, v57
    v_cvt_pk_bf16_f32 v57, v58, v59
    v_pk_mul_f32 v[72:73], v[72:73], v[182:183] op_sel_hi:[1,0]
    v_pk_mul_f32 v[74:75], v[74:75], v[182:183] op_sel_hi:[1,0]
    v_cvt_pk_bf16_f32 v72, v72, v73
    v_cvt_pk_bf16_f32 v73, v74, v75
    ds_write2st64_b64 v174, v[56:57], v[72:73] offset0:0 offset1:8
    v_pk_mul_f32 v[60:61], v[60:61], v[180:181] op_sel_hi:[1,0]
    v_pk_mul_f32 v[62:63], v[62:63], v[180:181] op_sel_hi:[1,0]
    v_cvt_pk_bf16_f32 v60, v60, v61
    v_cvt_pk_bf16_f32 v61, v62, v63
    v_pk_mul_f32 v[76:77], v[76:77], v[182:183] op_sel_hi:[1,0]
    v_pk_mul_f32 v[78:79], v[78:79], v[182:183] op_sel_hi:[1,0]
    v_cvt_pk_bf16_f32 v76, v76, v77
    v_cvt_pk_bf16_f32 v77, v78, v79
    ds_write2st64_b64 v175, v[60:61], v[76:77] offset0:0 offset1:8
    ds_read_b64_tr_b16 v[112:113], v218 offset:0
    ds_read_b64_tr_b16 v[114:115], v219 offset:0
    ds_read_b64_tr_b16 v[144:145], v220 offset:32768
    ds_read_b64_tr_b16 v[146:147], v221 offset:32768
    ds_read_b64_tr_b16 v[116:117], v218 offset:2048
    ds_read_b64_tr_b16 v[118:119], v219 offset:2048
    ds_read_b64_tr_b16 v[148:149], v220 offset:34816
    ds_read_b64_tr_b16 v[150:151], v221 offset:34816
    ds_read_b64_tr_b16 v[120:121], v218 offset:4096
    ds_read_b64_tr_b16 v[122:123], v219 offset:4096
    ds_read_b64_tr_b16 v[152:153], v220 offset:36864
    ds_read_b64_tr_b16 v[154:155], v221 offset:36864
    v_cvt_pk_bf16_f32 v176, v16, v17
    v_cvt_pk_bf16_f32 v177, v18, v19
    v_cvt_pk_bf16_f32 v178, v20, v21
    v_cvt_pk_bf16_f32 v179, v22, v23
    v_cvt_pk_bf16_f32 v180, v32, v33
    v_cvt_pk_bf16_f32 v181, v34, v35
    v_cvt_pk_bf16_f32 v182, v36, v37
    v_cvt_pk_bf16_f32 v183, v38, v39
    v_cvt_pk_bf16_f32 v184, v24, v25
    v_cvt_pk_bf16_f32 v185, v26, v27
    v_cvt_pk_bf16_f32 v186, v28, v29
    v_cvt_pk_bf16_f32 v187, v30, v31
    v_cvt_pk_bf16_f32 v188, v40, v41
    v_cvt_pk_bf16_f32 v189, v42, v43
    v_cvt_pk_bf16_f32 v190, v44, v45
    v_cvt_pk_bf16_f32 v191, v46, v47
    s_waitcnt lgkmcnt(8)
    v_mfma_f32_32x32x16_bf16 v[48:63], v[112:115], v[144:147], 0
    ds_read_b64_tr_b16 v[124:125], v218 offset:6144
    ds_read_b64_tr_b16 v[126:127], v219 offset:6144
    ds_read_b64_tr_b16 v[156:157], v220 offset:38912
    ds_read_b64_tr_b16 v[158:159], v221 offset:38912
    s_waitcnt lgkmcnt(8)
    v_mfma_f32_32x32x16_bf16 v[48:63], v[116:119], v[148:151], v[48:63]
    v_xor_b32 v218, 8192, v218
    v_xor_b32 v219, 8192, v219
    v_xor_b32 v220, 8192, v220
    v_xor_b32 v221, 8192, v221
    s_barrier
    ds_read_b64_tr_b16 v[128:129], v218 offset:0
    ds_read_b64_tr_b16 v[130:131], v219 offset:0
    ds_read_b64_tr_b16 v[160:161], v220 offset:32768
    ds_read_b64_tr_b16 v[162:163], v221 offset:32768
    s_waitcnt lgkmcnt(8)
    v_mfma_f32_32x32x16_bf16 v[48:63], v[120:123], v[152:155], v[48:63]
    ds_read_b64_tr_b16 v[132:133], v218 offset:2048
    ds_read_b64_tr_b16 v[134:135], v219 offset:2048
    ds_read_b64_tr_b16 v[164:165], v220 offset:34816
    ds_read_b64_tr_b16 v[166:167], v221 offset:34816
    s_waitcnt lgkmcnt(8)
    v_mfma_f32_32x32x16_bf16 v[48:63], v[124:127], v[156:159], v[48:63]
    ds_read_b64_tr_b16 v[136:137], v218 offset:4096
    ds_read_b64_tr_b16 v[138:139], v219 offset:4096
    ds_read_b64_tr_b16 v[168:169], v220 offset:36864
    ds_read_b64_tr_b16 v[170:171], v221 offset:36864
    s_waitcnt lgkmcnt(8)
    v_mfma_f32_32x32x16_bf16 v[48:63], v[128:131], v[160:163], v[48:63]
    ds_read_b64_tr_b16 v[140:141], v218 offset:6144
    ds_read_b64_tr_b16 v[142:143], v219 offset:6144
    ds_read_b64_tr_b16 v[172:173], v220 offset:38912
    ds_read_b64_tr_b16 v[174:175], v221 offset:38912
    s_waitcnt lgkmcnt(8)
    v_mfma_f32_32x32x16_bf16 v[48:63], v[132:135], v[164:167], v[48:63]
    v_permlane16_swap_b32 v176, v178
    v_permlane16_swap_b32 v177, v179
    s_waitcnt lgkmcnt(4)
    v_mfma_f32_32x32x16_bf16 v[48:63], v[136:139], v[168:171], v[48:63]
    v_permlane16_swap_b32 v180, v182
    v_permlane16_swap_b32 v181, v183
    v_permlane16_swap_b32 v184, v186
    s_waitcnt lgkmcnt(0)
    v_mfma_f32_32x32x16_bf16 v[48:63], v[140:143], v[172:175], v[48:63]
    s_barrier
    v_permlane16_swap_b32 v185, v187
    v_permlane16_swap_b32 v188, v190
    v_permlane16_swap_b32 v189, v191
    s_lshl_b32 s76, s62, 11
    s_add_u32 s76, s76, s99
    v_mfma_f32_32x32x16_bf16 v[16:31], v[204:207], v[176:179], 0
    s_add_u32 s76, s76, 1024
    s_lshl_b32 s77, s62, 7
    s_add_u32 s77, s77, s73
    v_lshlrev_b32_e64 v4, 2, v2
    v_mfma_f32_32x32x16_bf16 v[32:47], v[204:207], v[184:187], 0
    v_cvt_pk_bf16_f32 v64, v48, v49
    v_cvt_pk_bf16_f32 v65, v50, v51
    v_cvt_pk_bf16_f32 v66, v52, v53
    v_cvt_pk_bf16_f32 v67, v54, v55
    v_cvt_pk_bf16_f32 v68, v56, v57
    v_mfma_f32_32x32x16_bf16 v[16:31], v[208:211], v[180:183], v[16:31]
    v_cvt_pk_bf16_f32 v69, v58, v59
    v_cvt_pk_bf16_f32 v70, v60, v61
    v_cvt_pk_bf16_f32 v71, v62, v63
    s_bitcmp1_b32 s100, 0
    s_cbranch_scc1 L_loc_59
    buffer_store_dwordx4 v[64:67], v12, s[40:43], s76 offen offset:0 sc1
    buffer_store_dwordx4 v[68:71], v12, s[40:43], s76 offen offset:1024 sc1
    s_branch L_pubd_60
L_loc_59:
    buffer_store_dwordx4 v[64:67], v12, s[40:43], s76 offen offset:0
    buffer_store_dwordx4 v[68:71], v12, s[40:43], s76 offen offset:1024
L_pubd_60:
    v_mfma_f32_32x32x16_bf16 v[32:47], v[208:211], v[188:191], v[32:47]
    v_and_b32 v216, 1, v1
    v_lshlrev_b32_e64 v216, 8, v216
    v_lshl_add_u32 v216, v3, 4, v216
    s_lshl_b32 s76, s64, 7
    v_add_u32 v216, s76, v216
    s_mul_i32 s78, s61, 28800
    s_lshl_b32 s79, s64, 8
    s_add_u32 s78, s78, s79
    s_add_u32 s79, s78, 3686400
    v_dot2_f32_bf16 v72, v112, s89, 0
    v_dot2_f32_bf16 v73, v113, s89, 0
    v_dot2_f32_bf16 v72, v114, s89, v72
    v_dot2_f32_bf16 v73, v115, s89, v73
    v_dot2_f32_bf16 v72, v116, s89, v72
    v_dot2_f32_bf16 v73, v117, s89, v73
    v_dot2_f32_bf16 v72, v118, s89, v72
    v_dot2_f32_bf16 v73, v119, s89, v73
    v_dot2_f32_bf16 v72, v120, s89, v72
    v_dot2_f32_bf16 v73, v121, s89, v73
    v_dot2_f32_bf16 v72, v122, s89, v72
    v_dot2_f32_bf16 v73, v123, s89, v73
    v_dot2_f32_bf16 v72, v124, s89, v72
    v_dot2_f32_bf16 v73, v125, s89, v73
    v_dot2_f32_bf16 v72, v126, s89, v72
    v_dot2_f32_bf16 v73, v127, s89, v73
    v_dot2_f32_bf16 v72, v128, s89, v72
    v_dot2_f32_bf16 v73, v129, s89, v73
    v_dot2_f32_bf16 v72, v130, s89, v72
    v_dot2_f32_bf16 v73, v131, s89, v73
    v_dot2_f32_bf16 v72, v132, s89, v72
    v_dot2_f32_bf16 v73, v133, s89, v73
    v_dot2_f32_bf16 v72, v134, s89, v72
    v_dot2_f32_bf16 v73, v135, s89, v73
    v_dot2_f32_bf16 v72, v136, s89, v72
    v_dot2_f32_bf16 v73, v137, s89, v73
    v_dot2_f32_bf16 v72, v138, s89, v72
    v_dot2_f32_bf16 v73, v139, s89, v73
    v_dot2_f32_bf16 v72, v140, s89, v72
    v_dot2_f32_bf16 v73, v141, s89, v73
    v_dot2_f32_bf16 v72, v142, s89, v72
    v_dot2_f32_bf16 v73, v143, s89, v73
    s_lshl_b32 s76, s98, 7
    v_lshl_add_u32 v10, v3, 3, s76
    v_lshlrev_b32 v11, 5, v1
    v_add_f32 v72, v72, v73
    v_mov_b32 v73, v72
    s_nop 1
    v_permlane32_swap_b32 v72, v73
    v_add_f32 v72, v72, v73
    s_mov_b32 exec_hi, 0
    s_bitcmp1_b32 s100, 0
    s_cbranch_scc1 L_loc_61
    buffer_store_dword v72, v4, s[40:43], s77 offen offset:2048 sc1
    s_branch L_pubd_62
L_loc_61:
    buffer_store_dword v72, v4, s[40:43], s77 offen offset:2048
L_pubd_62:
    s_mov_b64 exec, -1
    v_max3_f32 v160, v16, v17, v18
    v_min3_f32 v162, v16, v17, v18
    v_max3_f32 v160, v160, v19, v20
    v_min3_f32 v162, v162, v19, v20
    v_max3_f32 v160, v160, v21, v22
    v_min3_f32 v162, v162, v21, v22
    v_max3_f32 v160, v160, v23, v24
    v_min3_f32 v162, v162, v23, v24
    v_max3_f32 v160, v160, v25, v26
    v_min3_f32 v162, v162, v25, v26
    v_max3_f32 v160, v160, v27, v28
    v_min3_f32 v162, v162, v27, v28
    v_max3_f32 v160, v160, v29, v30
    v_min3_f32 v162, v162, v29, v30
    v_max_f32 v160, v160, v31
    v_min_f32 v162, v162, v31
    v_max3_f32 v164, v32, v33, v34
    v_min3_f32 v166, v32, v33, v34
    v_max3_f32 v164, v164, v35, v36
    v_min3_f32 v166, v166, v35, v36
    v_max3_f32 v164, v164, v37, v38
    v_min3_f32 v166, v166, v37, v38
    v_max3_f32 v164, v164, v39, v40
    v_min3_f32 v166, v166, v39, v40
    v_max3_f32 v164, v164, v41, v42
    v_min3_f32 v166, v166, v41, v42
    v_max3_f32 v164, v164, v43, v44
    v_min3_f32 v166, v166, v43, v44
    v_max3_f32 v164, v164, v45, v46
    v_min3_f32 v166, v166, v45, v46
    v_max_f32 v164, v164, v47
    v_min_f32 v166, v166, v47
    v_mov_b32 v161, v160
    v_mov_b32 v163, v162
    v_mov_b32 v165, v164
    v_mov_b32 v167, v166
    v_permlane32_swap_b32 v160, v161
    v_permlane32_swap_b32 v162, v163
    v_permlane32_swap_b32 v164, v165
    v_permlane32_swap_b32 v166, v167
    v_max_f32 v160, v160, v161
    v_min_f32 v162, v162, v163
    v_max_f32 v164, v164, v165
    v_min_f32 v166, v166, v167
    v_mul_f32 v160, v160, v251
    v_mul_f32 v162, v162, v251
    v_mul_f32 v164, v164, v253
    v_mul_f32 v166, v166, v253
    v_pk_fma_f32 v[128:129], v[16:17], v[250:251], v[160:161] op_sel:[0,1,0] op_sel_hi:[1,1,0] neg_lo:[0,0,1] neg_hi:[0,0,1]
    v_pk_fma_f32 v[16:17], v[16:17], v[250:251], v[162:163] op_sel:[0,1,0] op_sel_hi:[1,1,0] neg_lo:[0,1,0] neg_hi:[0,1,0]
    v_pk_fma_f32 v[130:131], v[18:19], v[250:251], v[160:161] op_sel:[0,1,0] op_sel_hi:[1,1,0] neg_lo:[0,0,1] neg_hi:[0,0,1]
    v_pk_fma_f32 v[18:19], v[18:19], v[250:251], v[162:163] op_sel:[0,1,0] op_sel_hi:[1,1,0] neg_lo:[0,1,0] neg_hi:[0,1,0]
    v_pk_fma_f32 v[132:133], v[20:21], v[250:251], v[160:161] op_sel:[0,1,0] op_sel_hi:[1,1,0] neg_lo:[0,0,1] neg_hi:[0,0,1]
    v_pk_fma_f32 v[20:21], v[20:21], v[250:251], v[162:163] op_sel:[0,1,0] op_sel_hi:[1,1,0] neg_lo:[0,1,0] neg_hi:[0,1,0]
    v_pk_fma_f32 v[134:135], v[22:23], v[250:251], v[160:161] op_sel:[0,1,0] op_sel_hi:[1,1,0] neg_lo:[0,0,1] neg_hi:[0,0,1]
    v_pk_fma_f32 v[22:23], v[22:23], v[250:251], v[162:163] op_sel:[0,1,0] op_sel_hi:[1,1,0] neg_lo:[0,1,0] neg_hi:[0,1,0]
    v_pk_fma_f32 v[136:137], v[24:25], v[250:251], v[160:161] op_sel:[0,1,0] op_sel_hi:[1,1,0] neg_lo:[0,0,1] neg_hi:[0,0,1]
    v_pk_fma_f32 v[24:25], v[24:25], v[250:251], v[162:163] op_sel:[0,1,0] op_sel_hi:[1,1,0] neg_lo:[0,1,0] neg_hi:[0,1,0]
    v_pk_fma_f32 v[138:139], v[26:27], v[250:251], v[160:161] op_sel:[0,1,0] op_sel_hi:[1,1,0] neg_lo:[0,0,1] neg_hi:[0,0,1]
    v_pk_fma_f32 v[26:27], v[26:27], v[250:251], v[162:163] op_sel:[0,1,0] op_sel_hi:[1,1,0] neg_lo:[0,1,0] neg_hi:[0,1,0]
    v_pk_fma_f32 v[140:141], v[28:29], v[250:251], v[160:161] op_sel:[0,1,0] op_sel_hi:[1,1,0] neg_lo:[0,0,1] neg_hi:[0,0,1]
    v_pk_fma_f32 v[28:29], v[28:29], v[250:251], v[162:163] op_sel:[0,1,0] op_sel_hi:[1,1,0] neg_lo:[0,1,0] neg_hi:[0,1,0]
    v_pk_fma_f32 v[142:143], v[30:31], v[250:251], v[160:161] op_sel:[0,1,0] op_sel_hi:[1,1,0] neg_lo:[0,0,1] neg_hi:[0,0,1]
    v_pk_fma_f32 v[30:31], v[30:31], v[250:251], v[162:163] op_sel:[0,1,0] op_sel_hi:[1,1,0] neg_lo:[0,1,0] neg_hi:[0,1,0]
    v_pk_fma_f32 v[144:145], v[32:33], v[252:253], v[164:165] op_sel:[0,1,0] op_sel_hi:[1,1,0] neg_lo:[0,0,1] neg_hi:[0,0,1]
    v_pk_fma_f32 v[32:33], v[32:33], v[252:253], v[166:167] op_sel:[0,1,0] op_sel_hi:[1,1,0] neg_lo:[0,1,0] neg_hi:[0,1,0]
    v_pk_fma_f32 v[146:147], v[34:35], v[252:253], v[164:165] op_sel:[0,1,0] op_sel_hi:[1,1,0] neg_lo:[0,0,1] neg_hi:[0,0,1]
    v_pk_fma_f32 v[34:35], v[34:35], v[252:253], v[166:167] op_sel:[0,1,0] op_sel_hi:[1,1,0] neg_lo:[0,1,0] neg_hi:[0,1,0]
    v_pk_fma_f32 v[148:149], v[36:37], v[252:253], v[164:165] op_sel:[0,1,0] op_sel_hi:[1,1,0] neg_lo:[0,0,1] neg_hi:[0,0,1]
    v_pk_fma_f32 v[36:37], v[36:37], v[252:253], v[166:167] op_sel:[0,1,0] op_sel_hi:[1,1,0] neg_lo:[0,1,0] neg_hi:[0,1,0]
    v_pk_fma_f32 v[150:151], v[38:39], v[252:253], v[164:165] op_sel:[0,1,0] op_sel_hi:[1,1,0] neg_lo:[0,0,1] neg_hi:[0,0,1]
    v_pk_fma_f32 v[38:39], v[38:39], v[252:253], v[166:167] op_sel:[0,1,0] op_sel_hi:[1,1,0] neg_lo:[0,1,0] neg_hi:[0,1,0]
    v_pk_fma_f32 v[152:153], v[40:41], v[252:253], v[164:165] op_sel:[0,1,0] op_sel_hi:[1,1,0] neg_lo:[0,0,1] neg_hi:[0,0,1]
    v_pk_fma_f32 v[40:41], v[40:41], v[252:253], v[166:167] op_sel:[0,1,0] op_sel_hi:[1,1,0] neg_lo:[0,1,0] neg_hi:[0,1,0]
    v_pk_fma_f32 v[154:155], v[42:43], v[252:253], v[164:165] op_sel:[0,1,0] op_sel_hi:[1,1,0] neg_lo:[0,0,1] neg_hi:[0,0,1]
    v_pk_fma_f32 v[42:43], v[42:43], v[252:253], v[166:167] op_sel:[0,1,0] op_sel_hi:[1,1,0] neg_lo:[0,1,0] neg_hi:[0,1,0]
    v_pk_fma_f32 v[156:157], v[44:45], v[252:253], v[164:165] op_sel:[0,1,0] op_sel_hi:[1,1,0] neg_lo:[0,0,1] neg_hi:[0,0,1]
    v_pk_fma_f32 v[44:45], v[44:45], v[252:253], v[166:167] op_sel:[0,1,0] op_sel_hi:[1,1,0] neg_lo:[0,1,0] neg_hi:[0,1,0]
    v_pk_fma_f32 v[158:159], v[46:47], v[252:253], v[164:165] op_sel:[0,1,0] op_sel_hi:[1,1,0] neg_lo:[0,0,1] neg_hi:[0,0,1]
    v_pk_fma_f32 v[46:47], v[46:47], v[252:253], v[166:167] op_sel:[0,1,0] op_sel_hi:[1,1,0] neg_lo:[0,1,0] neg_hi:[0,1,0]
    v_exp_f32 v128, v128
    v_exp_f32 v16, v16
    v_exp_f32 v129, v129
    v_exp_f32 v17, v17
    v_exp_f32 v130, v130
    v_exp_f32 v18, v18
    v_exp_f32 v131, v131
    v_exp_f32 v19, v19
    v_exp_f32 v132, v132
    v_exp_f32 v20, v20
    v_exp_f32 v133, v133
    v_exp_f32 v21, v21
    v_exp_f32 v134, v134
    v_exp_f32 v22, v22
    v_exp_f32 v135, v135
    v_exp_f32 v23, v23
    v_exp_f32 v136, v136
    v_exp_f32 v24, v24
    v_exp_f32 v137, v137
    v_exp_f32 v25, v25
    v_exp_f32 v138, v138
    v_exp_f32 v26, v26
    v_exp_f32 v139, v139
    v_exp_f32 v27, v27
    v_exp_f32 v140, v140
    v_exp_f32 v28, v28
    v_exp_f32 v141, v141
    v_exp_f32 v29, v29
    v_exp_f32 v142, v142
    v_exp_f32 v30, v30
    v_exp_f32 v143, v143
    v_exp_f32 v31, v31
    v_cvt_pk_bf16_f32 v218, v128, v129
    v_cvt_pk_bf16_f32 v219, v130, v131
    v_cvt_pk_bf16_f32 v220, v132, v133
    v_cvt_pk_bf16_f32 v221, v134, v135
    v_cvt_pk_bf16_f32 v222, v136, v137
    v_cvt_pk_bf16_f32 v223, v138, v139
    v_cvt_pk_bf16_f32 v224, v140, v141
    v_cvt_pk_bf16_f32 v225, v142, v143
    v_cvt_pk_bf16_f32 v226, v16, v17
    v_cvt_pk_bf16_f32 v227, v18, v19
    v_cvt_pk_bf16_f32 v228, v20, v21
    v_cvt_pk_bf16_f32 v229, v22, v23
    v_cvt_pk_bf16_f32 v230, v24, v25
    v_cvt_pk_bf16_f32 v231, v26, v27
    v_cvt_pk_bf16_f32 v232, v28, v29
    v_cvt_pk_bf16_f32 v233, v30, v31
    v_exp_f32 v144, v144
    v_exp_f32 v32, v32
    v_exp_f32 v145, v145
    v_exp_f32 v33, v33
    v_exp_f32 v146, v146
    v_exp_f32 v34, v34
    v_exp_f32 v147, v147
    v_exp_f32 v35, v35
    v_exp_f32 v148, v148
    v_exp_f32 v36, v36
    v_exp_f32 v149, v149
    v_exp_f32 v37, v37
    v_exp_f32 v150, v150
    v_exp_f32 v38, v38
    v_exp_f32 v151, v151
    v_exp_f32_e64 v39, v39
    s_barrier
    buffer_load_dwordx4 v[48:51], v13, s[40:43], s78 offen offset:3072 sc1
    buffer_load_dwordx4 v[52:55], v13, s[40:43], s79 offen offset:3072 sc1
    buffer_load_dwordx4 v[56:59], v13, s[40:43], s78 offen offset:3200 sc1
    buffer_load_dwordx4 v[60:63], v13, s[40:43], s79 offen offset:3200 sc1
    ds_read_b128 v[168:171], v216 offset:24576
    ds_read_b128 v[172:175], v216 offset:24608
    ds_read_b128 v[176:179], v216 offset:24640
    ds_read_b128 v[180:183], v216 offset:24672
    v_exp_f32 v152, v152
    v_exp_f32 v40, v40
    v_exp_f32 v153, v153
    v_exp_f32 v41, v41
    v_exp_f32 v154, v154
    v_exp_f32 v42, v42
    v_exp_f32 v155, v155
    v_exp_f32 v43, v43
    v_exp_f32 v156, v156
    v_exp_f32_e64 v44, v44
    s_waitcnt lgkmcnt(0)
    v_mfma_f32_32x32x16_bf16 v[64:79], v[168:171], v[218:221], 0
    v_exp_f32 v157, v157
    v_exp_f32 v45, v45
    v_exp_f32_e64 v158, v158
    v_mfma_f32_32x32x16_bf16 v[80:95], v[176:179], v[226:229], 0
    v_exp_f32 v46, v46
    v_exp_f32 v159, v159
    v_exp_f32_e64 v47, v47
    v_mfma_f32_32x32x16_bf16 v[64:79], v[172:175], v[222:225], v[64:79]
    v_cvt_pk_bf16_f32 v234, v144, v145
    v_cvt_pk_bf16_f32 v235, v146, v147
    v_cvt_pk_bf16_f32 v236, v148, v149
    v_cvt_pk_bf16_f32 v237, v150, v151
    v_cvt_pk_bf16_f32 v238, v152, v153
    v_cvt_pk_bf16_f32 v239, v154, v155
    v_mfma_f32_32x32x16_bf16 v[80:95], v[180:183], v[230:233], v[80:95]
    v_cvt_pk_bf16_f32 v240, v156, v157
    v_cvt_pk_bf16_f32 v241, v158, v159
    v_cvt_pk_bf16_f32 v242, v32, v33
    v_cvt_pk_bf16_f32 v243, v34, v35
    v_cvt_pk_bf16_f32 v244, v36, v37
    v_cvt_pk_bf16_f32 v245, v38, v39
    v_cvt_pk_bf16_f32 v246, v40, v41
    v_cvt_pk_bf16_f32 v247, v42, v43
    v_cvt_pk_bf16_f32 v248, v44, v45
    v_cvt_pk_bf16_f32 v249, v46, v47
    v_mfma_f32_32x32x16_bf16 v[96:111], v[168:171], v[234:237], 0
    v_rcp_f32 v184, v65
    v_rcp_f32 v185, v81
    v_mul_f32 v6, v64, v184
    v_fmac_f32 v6, v80, v185
    v_add_f32 v6, 0x358637bd, v6
    v_mfma_f32_32x32x16_bf16 v[112:127], v[176:179], v[242:245], 0
    v_rcp_f32 v6, v6
    v_mov_b32 v8, 0
    v_mul_f32 v184, v184, v6
    v_mul_f32_e64 v185, v185, v6
    s_lshl4_add_u32 s76, s60, s61
    v_mfma_f32_32x32x16_bf16 v[96:111], v[172:175], v[238:241], v[96:111]
    s_mul_i32 s76, s76, 32768
    s_lshl2_add_u32 s77, s63, s64
    s_lshl_b32 s77, s77, 12
    s_add_u32 s76, s76, s77
    s_add_u32 s76, s76, 16777216
    v_mfma_f32_32x32x16_bf16 v[112:127], v[180:183], v[246:249], v[112:127]
    s_add_u32 s77, s76, 8192
    v_add_u32 v14, 128, v12
    v_cmp_gt_u32 vcc, 24, v1
    s_nop 0
    s_nop 0
    v_cndmask_b32_e64 v14, v14, v12, vcc
    s_mov_b32 s88, 0
    s_branch L_pfirst_64
L_poll_63:
    buffer_load_dwordx4 v[48:51], v13, s[40:43], s78 offen offset:3072 sc1
    buffer_load_dwordx4 v[52:55], v13, s[40:43], s79 offen offset:3072 sc1
    buffer_load_dwordx4 v[56:59], v13, s[40:43], s78 offen offset:3200 sc1
    buffer_load_dwordx4 v[60:63], v13, s[40:43], s79 offen offset:3200 sc1
L_pfirst_64:
    s_waitcnt vmcnt(0)
    v_max3_u32 v9, v48, v49, v50
    v_max3_u32 v9, v9, v51, v52
    v_max3_u32 v9, v9, v53, v54
    v_max3_u32 v9, v9, v55, v56
    v_max3_u32 v9, v9, v57, v58
    v_max3_u32 v9, v9, v59, v60
    v_max3_u32 v9, v9, v61, v62
    v_max_u32 v9, v9, v63
    v_cmp_eq_u32 vcc, -1, v9
    s_nop 0
    s_cbranch_vccz L_ok_65
    s_add_u32 s88, s88, 1
    s_cmp_lt_u32 s88, 65536
    s_cbranch_scc1 L_poll_63
L_ok_65:
    v_mfma_f32_32x32x16_bf16 v[16:31], v[48:51], v[218:221], 0
    s_barrier
    v_rcp_f32 v186, v97
    v_rcp_f32 v187, v113
    v_mul_f32_e64 v7, v96, v186
    v_mfma_f32_32x32x16_bf16 v[128:143], v[56:59], v[226:229], 0
    v_fmac_f32_e64 v7, v112, v187
    v_add_f32 v7, 0x358637bd, v7
    v_rcp_f32_e64 v7, v7
    v_bfe_u32 v4, v2, 1, 3
    v_lshlrev_b32_e64 v4, 4, v4
    v_mfma_f32_32x32x16_bf16 v[16:31], v[52:55], v[222:225], v[16:31]
    v_mov_b32 v8, 0
    v_mul_f32 v186, v186, v7
    v_mul_f32_e64 v187, v187, v7
    v_lshl_add_u32 v4, v3, 3, v4
    v_lshl_add_u32 v4, v2, 7, v4
    s_lshl_b32 s56, s62, 12
    v_mfma_f32_32x32x16_bf16 v[128:143], v[60:63], v[230:233], v[128:143]
    s_add_u32 s57, s56, 0
    v_add_u32 v64, s57, v4
    v_xor_b32 v65, 16, v64
    v_xor_b32 v66, 32, v64
    v_xor_b32 v67, 48, v64
    v_xor_b32_e64 v68, 64, v64
    v_mfma_f32_32x32x16_bf16 v[32:47], v[48:51], v[234:237], 0
    v_xor_b32 v69, 80, v64
    v_xor_b32 v70, 96, v64
    v_xor_b32 v71, 112, v64
    v_bfe_u32 v4, v1, 2, 2
    v_lshl_add_u32 v5, v3, 2, v4
    v_lshlrev_b32 v5, 7, v5
    s_bitcmp1_b32 s100, 2
    v_mfma_f32_32x32x16_bf16 v[144:159], v[56:59], v[242:245], 0
    v_mul_f32 v16, v16, v184
    v_mul_f32 v17, v17, v184
    v_mul_f32 v18, v18, v184
    v_mul_f32 v19, v19, v184
    v_mul_f32 v20, v20, v184
    v_mul_f32 v21, v21, v184
    v_mfma_f32_32x32x16_bf16 v[32:47], v[52:55], v[238:241], v[32:47]
    v_mul_f32 v22, v22, v184
    v_mul_f32 v23, v23, v184
    v_mul_f32 v24, v24, v184
    v_mul_f32 v25, v25, v184
    v_mul_f32 v26, v26, v184
    v_mul_f32 v27, v27, v184
    v_mfma_f32_32x32x16_bf16 v[144:159], v[60:63], v[246:249], v[144:159]
    v_mul_f32 v28, v28, v184
    v_mul_f32 v29, v29, v184
    v_mul_f32 v30, v30, v184
    v_mul_f32 v31, v31, v184
    v_fmac_f32 v16, v128, v185
    v_fmac_f32 v17, v129, v185
    v_cvt_pk_bf16_f32 v96, v16, v17
    v_fmac_f32 v18, v130, v185
    v_fmac_f32 v19, v131, v185
    v_cvt_pk_bf16_f32 v97, v18, v19
    v_fmac_f32 v20, v132, v185
    v_fmac_f32 v21, v133, v185
    v_cvt_pk_bf16_f32 v98, v20, v21
    v_fmac_f32 v22, v134, v185
    v_fmac_f32 v23, v135, v185
    v_cvt_pk_bf16_f32 v99, v22, v23
    buffer_store_dwordx4 v[96:99], v14, s[40:43], s76 offen offset:0 sc1
    v_fmac_f32 v24, v136, v185
    v_fmac_f32 v25, v137, v185
    v_cvt_pk_bf16_f32 v100, v24, v25
    v_fmac_f32 v26, v138, v185
    v_fmac_f32 v27, v139, v185
    v_cvt_pk_bf16_f32 v101, v26, v27
    v_fmac_f32 v28, v140, v185
    v_fmac_f32 v29, v141, v185
    v_cvt_pk_bf16_f32 v102, v28, v29
    v_fmac_f32 v30, v142, v185
    v_fmac_f32 v31, v143, v185
    v_cvt_pk_bf16_f32 v103, v30, v31
    buffer_store_dwordx4 v[100:103], v14, s[40:43], s76 offen offset:2048 sc1
    v_pk_mul_f32 v[32:33], v[32:33], v[186:187] op_sel_hi:[1,0]
    v_pk_fma_f32 v[32:33], v[144:145], v[186:187], v[32:33] op_sel:[0,1,0] op_sel_hi:[1,1,1]
    v_cvt_pk_bf16_f32 v104, v32, v33
    v_pk_mul_f32 v[34:35], v[34:35], v[186:187] op_sel_hi:[1,0]
    v_pk_fma_f32 v[34:35], v[146:147], v[186:187], v[34:35] op_sel:[0,1,0] op_sel_hi:[1,1,1]
    v_cvt_pk_bf16_f32 v105, v34, v35
    v_pk_mul_f32 v[36:37], v[36:37], v[186:187] op_sel_hi:[1,0]
    v_pk_fma_f32 v[36:37], v[148:149], v[186:187], v[36:37] op_sel:[0,1,0] op_sel_hi:[1,1,1]
    v_cvt_pk_bf16_f32 v106, v36, v37
    v_pk_mul_f32 v[38:39], v[38:39], v[186:187] op_sel_hi:[1,0]
    v_pk_fma_f32 v[38:39], v[150:151], v[186:187], v[38:39] op_sel:[0,1,0] op_sel_hi:[1,1,1]
    v_cvt_pk_bf16_f32 v107, v38, v39
    buffer_store_dwordx4 v[104:107], v14, s[40:43], s77 offen offset:0 sc1
    v_pk_mul_f32 v[40:41], v[40:41], v[186:187] op_sel_hi:[1,0]
    v_pk_fma_f32 v[40:41], v[152:153], v[186:187], v[40:41] op_sel:[0,1,0] op_sel_hi:[1,1,1]
    v_cvt_pk_bf16_f32 v108, v40, v41
    v_pk_mul_f32 v[42:43], v[42:43], v[186:187] op_sel_hi:[1,0]
    v_pk_fma_f32 v[42:43], v[154:155], v[186:187], v[42:43] op_sel:[0,1,0] op_sel_hi:[1,1,1]
    v_cvt_pk_bf16_f32 v109, v42, v43
    v_pk_mul_f32 v[44:45], v[44:45], v[186:187] op_sel_hi:[1,0]
    v_pk_fma_f32 v[44:45], v[156:157], v[186:187], v[44:45] op_sel:[0,1,0] op_sel_hi:[1,1,1]
    v_cvt_pk_bf16_f32 v110, v44, v45
    v_pk_mul_f32 v[46:47], v[46:47], v[186:187] op_sel_hi:[1,0]
    v_pk_fma_f32 v[46:47], v[158:159], v[186:187], v[46:47] op_sel:[0,1,0] op_sel_hi:[1,1,1]
    v_cvt_pk_bf16_f32 v111, v46, v47
    buffer_store_dwordx4 v[108:111], v14, s[40:43], s77 offen offset:2048 sc1
    v_lshrrev_b32_e64 v4, 1, v4
    v_lshl_add_u32 v5, v4, 6, v5
    v_bfe_u32 v4, v1, 4, 1
    v_lshl_add_u32 v5, v4, 5, v5
    v_and_b32_e64 v4, 3, v1
    v_lshl_add_u32 v5, v4, 3, v5
    v_add_u32 v72, 32768, v5
    v_xor_b32_e64 v73, 64, v72
    s_mul_i32 s80, s97, 524288
    s_mul_i32 s56, s62, 8192
    s_add_u32 s80, s80, s56
    s_add_u32 s80, s80, 16777216
    v_add_u32 v78, 4096, v14
    v_mov_b32 v74, 1
    s_mov_b32 s52, 0xffff
    s_mov_b32 s53, 0
    s_barrier
    ds_read_b32 v79, v8 offset:25984
    ds_read_b64 v[88:89], v64
    ds_read_b64 v[90:91], v65
    ds_read_b64 v[92:93], v66
    ds_read_b64 v[94:95], v67
    ds_read_b64 v[96:97], v68
    ds_read_b64 v[98:99], v69
    ds_read_b64 v[100:101], v70
    ds_read_b64 v[102:103], v71
    s_waitcnt lgkmcnt(8)
    v_readfirstlane_b32 s76, v79
    s_nop 0
    s_and_b32 s76, s76, s52
    s_cbranch_scc0 L_tr0
L_bk0:
    s_ff1_i32_b32 s76, s76
    s_bitset0_b32 s52, s76
    s_add_u32 s77, s76, s65
    s_and_b32 s77, s77, 15
    s_mul_i32 s77, s77, 32768
    s_add_u32 s28, s77, s80
    s_add_u32 s76, s76, 3
    s_and_b32 s76, s76, 15
    s_lshl_b32 s4, s76, 13
    buffer_load_dwordx4 v[128:131], v14, s[40:43], s28 offen offset:0 sc1
    buffer_load_dwordx4 v[132:135], v14, s[40:43], s28 offen offset:2048 sc1
    buffer_load_dwordx4 v[136:139], v78, s[40:43], s28 offen offset:0 sc1
    buffer_load_dwordx4 v[140:143], v78, s[40:43], s28 offen offset:2048 sc1
    v_readfirstlane_b32 s76, v79
    s_nop 0
    s_and_b32 s76, s76, s52
    s_cbranch_scc0 L_tr1
L_bk1:
    s_ff1_i32_b32 s76, s76
    s_bitset0_b32 s52, s76
    s_add_u32 s77, s76, s65
    s_and_b32 s77, s77, 15
    s_mul_i32 s77, s77, 32768
    s_add_u32 s29, s77, s80
    s_add_u32 s76, s76, 3
    s_and_b32 s76, s76, 15
    s_lshl_b32 s5, s76, 13
    buffer_load_dwordx4 v[144:147], v14, s[40:43], s29 offen offset:0 sc1
    buffer_load_dwordx4 v[148:151], v14, s[40:43], s29 offen offset:2048 sc1
    v_add_u32 v80, s4, v72
    v_add_u32 v81, s4, v73
    s_waitcnt lgkmcnt(0)
    v_lshlrev_b32 v16, 16, v88
    v_and_b32 v17, s90, v88
    v_lshlrev_b32 v18, 16, v89
    v_and_b32 v19, s90, v89
    v_lshlrev_b32 v20, 16, v90
    v_and_b32 v21, s90, v90
    v_lshlrev_b32 v22, 16, v91
    v_and_b32 v23, s90, v91
    v_lshlrev_b32 v24, 16, v92
    v_and_b32 v25, s90, v92
    v_lshlrev_b32 v26, 16, v93
    v_and_b32 v27, s90, v93
    v_lshlrev_b32 v28, 16, v94
    v_and_b32 v29, s90, v94
    v_lshlrev_b32 v30, 16, v95
    v_and_b32 v31, s90, v95
    v_lshlrev_b32 v32, 16, v96
    v_and_b32 v33, s90, v96
    v_lshlrev_b32 v34, 16, v97
    v_and_b32 v35, s90, v97
    v_lshlrev_b32 v36, 16, v98
    v_and_b32 v37, s90, v98
    v_lshlrev_b32 v38, 16, v99
    v_and_b32 v39, s90, v99
    v_lshlrev_b32 v40, 16, v100
    v_and_b32 v41, s90, v100
    v_lshlrev_b32 v42, 16, v101
    v_and_b32 v43, s90, v101
    v_lshlrev_b32 v44, 16, v102
    v_and_b32 v45, s90, v102
    v_lshlrev_b32 v46, 16, v103
    v_and_b32 v47, s90, v103
    s_cmp_eq_u32 s53, 0
    s_cbranch_scc0 L_sent_66
    s_waitcnt vmcnt(6)
    s_mov_b64 exec, 1
    ds_add_u32 v8, v74 offset:25988
    s_mov_b64 exec, -1
    s_mov_b32 s53, 1
L_sent_66:
    ds_read_b32 v79, v8 offset:25984
    ds_read_b64_tr_b16 v[104:105], v80 offset:0
    ds_read_b64_tr_b16 v[106:107], v80 offset:1024
    ds_read_b64_tr_b16 v[108:109], v81 offset:0
    ds_read_b64_tr_b16 v[110:111], v81 offset:1024
    ds_read_b64_tr_b16 v[112:113], v80 offset:2048
    ds_read_b64_tr_b16 v[114:115], v80 offset:3072
    ds_read_b64_tr_b16 v[116:117], v81 offset:2048
    ds_read_b64_tr_b16 v[118:119], v81 offset:3072
    s_waitcnt vmcnt(5) lgkmcnt(4)
    v_mfma_f32_32x32x16_bf16 v[16:31], v[104:107], v[128:131], v[16:31]
    ds_read_b64_tr_b16 v[120:121], v80 offset:4096
    ds_read_b64_tr_b16 v[122:123], v80 offset:5120
    buffer_load_dwordx4 v[152:155], v78, s[40:43], s29 offen offset:0 sc1
    v_mfma_f32_32x32x16_bf16 v[32:47], v[108:111], v[128:131], v[32:47]
    ds_read_b64_tr_b16 v[124:125], v81 offset:4096
    ds_read_b64_tr_b16 v[126:127], v81 offset:5120
    buffer_load_dwordx4 v[156:159], v78, s[40:43], s29 offen offset:2048 sc1
    v_readfirstlane_b32 s76, v79
    s_nop 0
    s_and_b32 s76, s76, s52
    s_cbranch_scc0 L_tr2
L_bk2:
    s_ff1_i32_b32 s76, s76
    s_bitset0_b32 s52, s76
    s_add_u32 s77, s76, s65
    s_and_b32 s77, s77, 15
    s_mul_i32 s77, s77, 32768
    s_add_u32 s30, s77, s80
    s_waitcnt vmcnt(6) lgkmcnt(4)
    v_mfma_f32_32x32x16_bf16 v[16:31], v[112:115], v[132:135], v[16:31]
    ds_read_b32 v79, v8 offset:25984
    ds_read_b64_tr_b16 v[104:105], v80 offset:6144
    ds_read_b64_tr_b16 v[106:107], v80 offset:7168
    buffer_load_dwordx4 v[160:163], v14, s[40:43], s30 offen offset:0 sc1
    s_add_u32 s76, s76, 3
    s_and_b32 s76, s76, 15
    s_lshl_b32 s6, s76, 13
    v_mfma_f32_32x32x16_bf16 v[32:47], v[116:119], v[132:135], v[32:47]
    ds_read_b64_tr_b16 v[108:109], v81 offset:6144
    ds_read_b64_tr_b16 v[110:111], v81 offset:7168
    buffer_load_dwordx4 v[164:167], v14, s[40:43], s30 offen offset:2048 sc1
    v_add_u32 v82, s5, v72
    v_add_u32_e64 v83, s5, v73
    s_waitcnt vmcnt(7) lgkmcnt(4)
    v_mfma_f32_32x32x16_bf16 v[16:31], v[120:123], v[136:139], v[16:31]
    ds_read_b64_tr_b16 v[112:113], v82 offset:0
    ds_read_b64_tr_b16 v[114:115], v82 offset:1024
    buffer_load_dwordx4 v[168:171], v78, s[40:43], s30 offen offset:0 sc1
    v_mfma_f32_32x32x16_bf16 v[32:47], v[124:127], v[136:139], v[32:47]
    ds_read_b64_tr_b16 v[116:117], v83 offset:0
    ds_read_b64_tr_b16 v[118:119], v83 offset:1024
    buffer_load_dwordx4 v[172:175], v78, s[40:43], s30 offen offset:2048 sc1
    v_readfirstlane_b32 s76, v79
    s_nop 0
    s_and_b32 s76, s76, s52
    s_cbranch_scc0 L_tr3
L_bk3:
    s_ff1_i32_b32 s76, s76
    s_bitset0_b32 s52, s76
    s_add_u32 s77, s76, s65
    s_and_b32 s77, s77, 15
    s_mul_i32 s77, s77, 32768
    s_add_u32 s31, s77, s80
    s_waitcnt vmcnt(8) lgkmcnt(4)
    v_mfma_f32_32x32x16_bf16 v[16:31], v[104:107], v[140:143], v[16:31]
    ds_read_b32 v79, v8 offset:25984
    ds_read_b64_tr_b16 v[120:121], v82 offset:2048
    ds_read_b64_tr_b16 v[122:123], v82 offset:3072
    buffer_load_dwordx4 v[176:179], v14, s[40:43], s31 offen offset:0 sc1
    s_add_u32 s76, s76, 3
    s_and_b32 s76, s76, 15
    s_lshl_b32 s7, s76, 13
    v_mfma_f32_32x32x16_bf16 v[32:47], v[108:111], v[140:143], v[32:47]
    ds_read_b64_tr_b16 v[124:125], v83 offset:2048
    ds_read_b64_tr_b16 v[126:127], v83 offset:3072
    buffer_load_dwordx4 v[180:183], v14, s[40:43], s31 offen offset:2048 sc1
    s_waitcnt vmcnt(9) lgkmcnt(4)
    v_mfma_f32_32x32x16_bf16 v[16:31], v[112:115], v[144:147], v[16:31]
    ds_read_b64_tr_b16 v[104:105], v82 offset:4096
    ds_read_b64_tr_b16 v[106:107], v82 offset:5120
    buffer_load_dwordx4 v[184:187], v78, s[40:43], s31 offen offset:0 sc1
    v_mfma_f32_32x32x16_bf16 v[32:47], v[116:119], v[144:147], v[32:47]
    ds_read_b64_tr_b16 v[108:109], v83 offset:4096
    ds_read_b64_tr_b16 v[110:111], v83 offset:5120
    buffer_load_dwordx4 v[188:191], v78, s[40:43], s31 offen offset:2048 sc1
    v_readfirstlane_b32 s76, v79
    s_nop 0
    s_and_b32 s76, s76, s52
    s_cbranch_scc0 L_tr4
L_bk4:
    s_ff1_i32_b32 s76, s76
    s_bitset0_b32 s52, s76
    s_add_u32 s77, s76, s65
    s_and_b32 s77, s77, 15
    s_mul_i32 s77, s77, 32768
    s_add_u32 s32, s77, s80
    s_waitcnt vmcnt(10) lgkmcnt(4)
    v_mfma_f32_32x32x16_bf16 v[16:31], v[120:123], v[148:151], v[16:31]
    ds_read_b64_tr_b16 v[112:113], v82 offset:6144
    ds_read_b64_tr_b16 v[114:115], v82 offset:7168
    buffer_load_dwordx4 v[128:131], v14, s[40:43], s32 offen offset:0 sc1
    s_add_u32 s76, s76, 3
    s_and_b32 s76, s76, 15
    s_lshl_b32 s8, s76, 13
    v_mfma_f32_32x32x16_bf16 v[32:47], v[124:127], v[148:151], v[32:47]
    ds_read_b64_tr_b16 v[116:117], v83 offset:6144
    ds_read_b64_tr_b16 v[118:119], v83 offset:7168
    buffer_load_dwordx4 v[132:135], v14, s[40:43], s32 offen offset:2048 sc1
    v_add_u32 v80, s6, v72
    v_add_u32 v81, s6, v73
    s_waitcnt vmcnt(11) lgkmcnt(4)
    v_mfma_f32_32x32x16_bf16 v[16:31], v[104:107], v[152:155], v[16:31]
    ds_read_b32 v79, v8 offset:25984
    ds_read_b64_tr_b16 v[120:121], v80 offset:0
    ds_read_b64_tr_b16 v[122:123], v80 offset:1024
    buffer_load_dwordx4 v[136:139], v78, s[40:43], s32 offen offset:0 sc1
    v_mfma_f32_32x32x16_bf16 v[32:47], v[108:111], v[152:155], v[32:47]
    ds_read_b64_tr_b16 v[124:125], v81 offset:0
    ds_read_b64_tr_b16 v[126:127], v81 offset:1024
    s_waitcnt vmcnt(11) lgkmcnt(4)
    v_mfma_f32_32x32x16_bf16 v[16:31], v[112:115], v[156:159], v[16:31]
    ds_read_b64_tr_b16 v[104:105], v80 offset:2048
    ds_read_b64_tr_b16 v[106:107], v80 offset:3072
    buffer_load_dwordx4 v[140:143], v78, s[40:43], s32 offen offset:2048 sc1
    v_mfma_f32_32x32x16_bf16 v[32:47], v[116:119], v[156:159], v[32:47]
    ds_read_b64_tr_b16 v[108:109], v81 offset:2048
    ds_read_b64_tr_b16 v[110:111], v81 offset:3072
    v_readfirstlane_b32 s76, v79
    s_nop 0
    s_and_b32 s76, s76, s52
    s_cbranch_scc0 L_tr5
L_bk5:
    s_ff1_i32_b32 s76, s76
    s_bitset0_b32 s52, s76
    s_add_u32 s77, s76, s65
    s_and_b32 s77, s77, 15
    s_mul_i32 s77, s77, 32768
    s_add_u32 s33, s77, s80
    s_waitcnt vmcnt(11) lgkmcnt(4)
    v_mfma_f32_32x32x16_bf16 v[16:31], v[120:123], v[160:163], v[16:31]
    ds_read_b64_tr_b16 v[112:113], v80 offset:4096
    ds_read_b64_tr_b16 v[114:115], v80 offset:5120
    buffer_load_dwordx4 v[144:147], v14, s[40:43], s33 offen offset:0 sc1
    s_add_u32 s76, s76, 3
    s_and_b32 s76, s76, 15
    s_lshl_b32 s9, s76, 13
    v_mfma_f32_32x32x16_bf16 v[32:47], v[124:127], v[160:163], v[32:47]
    ds_read_b64_tr_b16 v[116:117], v81 offset:4096
    ds_read_b64_tr_b16 v[118:119], v81 offset:5120
    s_waitcnt vmcnt(11) lgkmcnt(4)
    v_mfma_f32_32x32x16_bf16 v[16:31], v[104:107], v[164:167], v[16:31]
    ds_read_b64_tr_b16 v[120:121], v80 offset:6144
    ds_read_b64_tr_b16 v[122:123], v80 offset:7168
    buffer_load_dwordx4 v[148:151], v14, s[40:43], s33 offen offset:2048 sc1
    v_mfma_f32_32x32x16_bf16 v[32:47], v[108:111], v[164:167], v[32:47]
    ds_read_b64_tr_b16 v[124:125], v81 offset:6144
    ds_read_b64_tr_b16 v[126:127], v81 offset:7168
    v_add_u32 v82, s7, v72
    v_add_u32 v83, s7, v73
    s_waitcnt vmcnt(11) lgkmcnt(4)
    v_mfma_f32_32x32x16_bf16 v[16:31], v[112:115], v[168:171], v[16:31]
    ds_read_b32 v79, v8 offset:25984
    ds_read_b64_tr_b16 v[104:105], v82 offset:0
    ds_read_b64_tr_b16 v[106:107], v82 offset:1024
    buffer_load_dwordx4 v[152:155], v78, s[40:43], s33 offen offset:0 sc1
    v_mfma_f32_32x32x16_bf16 v[32:47], v[116:119], v[168:171], v[32:47]
    ds_read_b64_tr_b16 v[108:109], v83 offset:0
    ds_read_b64_tr_b16 v[110:111], v83 offset:1024
    s_waitcnt vmcnt(11) lgkmcnt(4)
    v_mfma_f32_32x32x16_bf16 v[16:31], v[120:123], v[172:175], v[16:31]
    ds_read_b64_tr_b16 v[112:113], v82 offset:2048
    ds_read_b64_tr_b16 v[114:115], v82 offset:3072
    buffer_load_dwordx4 v[156:159], v78, s[40:43], s33 offen offset:2048 sc1
    v_mfma_f32_32x32x16_bf16 v[32:47], v[124:127], v[172:175], v[32:47]
    ds_read_b64_tr_b16 v[116:117], v83 offset:2048
    ds_read_b64_tr_b16 v[118:119], v83 offset:3072
    v_readfirstlane_b32 s76, v79
    s_nop 0
    s_and_b32 s76, s76, s52
    s_cbranch_scc0 L_tr6
L_bk6:
    s_ff1_i32_b32 s76, s76
    s_bitset0_b32 s52, s76
    s_add_u32 s77, s76, s65
    s_and_b32 s77, s77, 15
    s_mul_i32 s77, s77, 32768
    s_add_u32 s34, s77, s80
    s_waitcnt vmcnt(11) lgkmcnt(4)
    v_mfma_f32_32x32x16_bf16 v[16:31], v[104:107], v[176:179], v[16:31]
    ds_read_b64_tr_b16 v[120:121], v82 offset:4096
    ds_read_b64_tr_b16 v[122:123], v82 offset:5120
    buffer_load_dwordx4 v[160:163], v14, s[40:43], s34 offen offset:0 sc1
    s_add_u32 s76, s76, 3
    s_and_b32 s76, s76, 15
    s_lshl_b32 s10, s76, 13
    v_mfma_f32_32x32x16_bf16 v[32:47], v[108:111], v[176:179], v[32:47]
    ds_read_b64_tr_b16 v[124:125], v83 offset:4096
    ds_read_b64_tr_b16 v[126:127], v83 offset:5120
    s_waitcnt vmcnt(11) lgkmcnt(4)
    v_mfma_f32_32x32x16_bf16 v[16:31], v[112:115], v[180:183], v[16:31]
    ds_read_b64_tr_b16 v[104:105], v82 offset:6144
    ds_read_b64_tr_b16 v[106:107], v82 offset:7168
    buffer_load_dwordx4 v[164:167], v14, s[40:43], s34 offen offset:2048 sc1
    v_mfma_f32_32x32x16_bf16 v[32:47], v[116:119], v[180:183], v[32:47]
    ds_read_b64_tr_b16 v[108:109], v83 offset:6144
    ds_read_b64_tr_b16 v[110:111], v83 offset:7168
    v_add_u32 v80, s8, v72
    v_add_u32 v81, s8, v73
    s_waitcnt vmcnt(11) lgkmcnt(4)
    v_mfma_f32_32x32x16_bf16 v[16:31], v[120:123], v[184:187], v[16:31]
    ds_read_b32 v79, v8 offset:25984
    ds_read_b64_tr_b16 v[112:113], v80 offset:0
    ds_read_b64_tr_b16 v[114:115], v80 offset:1024
    buffer_load_dwordx4 v[168:171], v78, s[40:43], s34 offen offset:0 sc1
    v_mfma_f32_32x32x16_bf16 v[32:47], v[124:127], v[184:187], v[32:47]
    ds_read_b64_tr_b16 v[116:117], v81 offset:0
    ds_read_b64_tr_b16 v[118:119], v81 offset:1024
    s_waitcnt vmcnt(11) lgkmcnt(4)
    v_mfma_f32_32x32x16_bf16 v[16:31], v[104:107], v[188:191], v[16:31]
    ds_read_b64_tr_b16 v[120:121], v80 offset:2048
    ds_read_b64_tr_b16 v[122:123], v80 offset:3072
    buffer_load_dwordx4 v[172:175], v78, s[40:43], s34 offen offset:2048 sc1
    v_mfma_f32_32x32x16_bf16 v[32:47], v[108:111], v[188:191], v[32:47]
    ds_read_b64_tr_b16 v[124:125], v81 offset:2048
    ds_read_b64_tr_b16 v[126:127], v81 offset:3072
    v_readfirstlane_b32 s76, v79
    s_nop 0
    s_and_b32 s76, s76, s52
    s_cbranch_scc0 L_tr7
L_bk7:
    s_ff1_i32_b32 s76, s76
    s_bitset0_b32 s52, s76
    s_add_u32 s77, s76, s65
    s_and_b32 s77, s77, 15
    s_mul_i32 s77, s77, 32768
    s_add_u32 s35, s77, s80
    s_waitcnt vmcnt(11) lgkmcnt(4)
    v_mfma_f32_32x32x16_bf16 v[16:31], v[112:115], v[128:131], v[16:31]
    ds_read_b64_tr_b16 v[104:105], v80 offset:4096
    ds_read_b64_tr_b16 v[106:107], v80 offset:5120
    buffer_load_dwordx4 v[176:179], v14, s[40:43], s35 offen offset:0 sc1
    s_add_u32 s76, s76, 3
    s_and_b32 s76, s76, 15
    s_lshl_b32 s11, s76, 13
    v_mfma_f32_32x32x16_bf16 v[32:47], v[116:119], v[128:131], v[32:47]
    ds_read_b64_tr_b16 v[108:109], v81 offset:4096
    ds_read_b64_tr_b16 v[110:111], v81 offset:5120
    s_waitcnt vmcnt(11) lgkmcnt(4)
    v_mfma_f32_32x32x16_bf16 v[16:31], v[120:123], v[132:135], v[16:31]
    ds_read_b64_tr_b16 v[112:113], v80 offset:6144
    ds_read_b64_tr_b16 v[114:115], v80 offset:7168
    buffer_load_dwordx4 v[180:183], v14, s[40:43], s35 offen offset:2048 sc1
    v_mfma_f32_32x32x16_bf16 v[32:47], v[124:127], v[132:135], v[32:47]
    ds_read_b64_tr_b16 v[116:117], v81 offset:6144
    ds_read_b64_tr_b16 v[118:119], v81 offset:7168
    v_add_u32 v82, s9, v72
    v_add_u32 v83, s9, v73
    s_waitcnt vmcnt(11) lgkmcnt(4)
    v_mfma_f32_32x32x16_bf16 v[16:31], v[104:107], v[136:139], v[16:31]
    ds_read_b32 v79, v8 offset:25984
    ds_read_b64_tr_b16 v[120:121], v82 offset:0
    ds_read_b64_tr_b16 v[122:123], v82 offset:1024
    buffer_load_dwordx4 v[184:187], v78, s[40:43], s35 offen offset:0 sc1
    v_mfma_f32_32x32x16_bf16 v[32:47], v[108:111], v[136:139], v[32:47]
    ds_read_b64_tr_b16 v[124:125], v83 offset:0
    ds_read_b64_tr_b16 v[126:127], v83 offset:1024
    s_waitcnt vmcnt(11) lgkmcnt(4)
    v_mfma_f32_32x32x16_bf16 v[16:31], v[112:115], v[140:143], v[16:31]
    ds_read_b64_tr_b16 v[104:105], v82 offset:2048
    ds_read_b64_tr_b16 v[106:107], v82 offset:3072
    buffer_load_dwordx4 v[188:191], v78, s[40:43], s35 offen offset:2048 sc1
    v_mfma_f32_32x32x16_bf16 v[32:47], v[116:119], v[140:143], v[32:47]
    ds_read_b64_tr_b16 v[108:109], v83 offset:2048
    ds_read_b64_tr_b16 v[110:111], v83 offset:3072
    v_readfirstlane_b32 s76, v79
    s_nop 0
    s_and_b32 s76, s76, s52
    s_cbranch_scc0 L_tr8
L_bk8:
    s_ff1_i32_b32 s76, s76
    s_bitset0_b32 s52, s76
    s_add_u32 s77, s76, s65
    s_and_b32 s77, s77, 15
    s_mul_i32 s77, s77, 32768
    s_add_u32 s36, s77, s80
    s_waitcnt vmcnt(11) lgkmcnt(4)
    v_mfma_f32_32x32x16_bf16 v[16:31], v[120:123], v[144:147], v[16:31]
    ds_read_b64_tr_b16 v[112:113], v82 offset:4096
    ds_read_b64_tr_b16 v[114:115], v82 offset:5120
    buffer_load_dwordx4 v[128:131], v14, s[40:43], s36 offen offset:0 sc1
    s_add_u32 s76, s76, 3
    s_and_b32 s76, s76, 15
    s_lshl_b32 s12, s76, 13
    v_mfma_f32_32x32x16_bf16 v[32:47], v[124:127], v[144:147], v[32:47]
    ds_read_b64_tr_b16 v[116:117], v83 offset:4096
    ds_read_b64_tr_b16 v[118:119], v83 offset:5120
    s_waitcnt vmcnt(11) lgkmcnt(4)
    v_mfma_f32_32x32x16_bf16 v[16:31], v[104:107], v[148:151], v[16:31]
    ds_read_b64_tr_b16 v[120:121], v82 offset:6144
    ds_read_b64_tr_b16 v[122:123], v82 offset:7168
    buffer_load_dwordx4 v[132:135], v14, s[40:43], s36 offen offset:2048 sc1
    v_mfma_f32_32x32x16_bf16 v[32:47], v[108:111], v[148:151], v[32:47]
    ds_read_b64_tr_b16 v[124:125], v83 offset:6144
    ds_read_b64_tr_b16 v[126:127], v83 offset:7168
    v_add_u32 v80, s10, v72
    v_add_u32 v81, s10, v73
    s_waitcnt vmcnt(11) lgkmcnt(4)
    v_mfma_f32_32x32x16_bf16 v[16:31], v[112:115], v[152:155], v[16:31]
    ds_read_b32 v79, v8 offset:25984
    ds_read_b64_tr_b16 v[104:105], v80 offset:0
    ds_read_b64_tr_b16 v[106:107], v80 offset:1024
    buffer_load_dwordx4 v[136:139], v78, s[40:43], s36 offen offset:0 sc1
    v_mfma_f32_32x32x16_bf16 v[32:47], v[116:119], v[152:155], v[32:47]
    ds_read_b64_tr_b16 v[108:109], v81 offset:0
    ds_read_b64_tr_b16 v[110:111], v81 offset:1024
    s_waitcnt vmcnt(11) lgkmcnt(4)
    v_mfma_f32_32x32x16_bf16 v[16:31], v[120:123], v[156:159], v[16:31]
    ds_read_b64_tr_b16 v[112:113], v80 offset:2048
    ds_read_b64_tr_b16 v[114:115], v80 offset:3072
    buffer_load_dwordx4 v[140:143], v78, s[40:43], s36 offen offset:2048 sc1
    v_mfma_f32_32x32x16_bf16 v[32:47], v[124:127], v[156:159], v[32:47]
    ds_read_b64_tr_b16 v[116:117], v81 offset:2048
    ds_read_b64_tr_b16 v[118:119], v81 offset:3072
    v_readfirstlane_b32 s76, v79
    s_nop 0
    s_and_b32 s76, s76, s52
    s_cbranch_scc0 L_tr9
L_bk9:
    s_ff1_i32_b32 s76, s76
    s_bitset0_b32 s52, s76
    s_add_u32 s77, s76, s65
    s_and_b32 s77, s77, 15
    s_mul_i32 s77, s77, 32768
    s_add_u32 s37, s77, s80
    s_waitcnt vmcnt(11) lgkmcnt(4)
    v_mfma_f32_32x32x16_bf16 v[16:31], v[104:107], v[160:163], v[16:31]
    ds_read_b64_tr_b16 v[120:121], v80 offset:4096
    ds_read_b64_tr_b16 v[122:123], v80 offset:5120
    buffer_load_dwordx4 v[144:147], v14, s[40:43], s37 offen offset:0 sc1
    s_add_u32 s76, s76, 3
    s_and_b32 s76, s76, 15
    s_lshl_b32 s13, s76, 13
    v_mfma_f32_32x32x16_bf16 v[32:47], v[108:111], v[160:163], v[32:47]
    ds_read_b64_tr_b16 v[124:125], v81 offset:4096
    ds_read_b64_tr_b16 v[126:127], v81 offset:5120
    s_waitcnt vmcnt(11) lgkmcnt(4)
    v_mfma_f32_32x32x16_bf16 v[16:31], v[112:115], v[164:167], v[16:31]
    ds_read_b64_tr_b16 v[104:105], v80 offset:6144
    ds_read_b64_tr_b16 v[106:107], v80 offset:7168
    buffer_load_dwordx4 v[148:151], v14, s[40:43], s37 offen offset:2048 sc1
    v_mfma_f32_32x32x16_bf16 v[32:47], v[116:119], v[164:167], v[32:47]
    ds_read_b64_tr_b16 v[108:109], v81 offset:6144
    ds_read_b64_tr_b16 v[110:111], v81 offset:7168
    v_add_u32 v82, s11, v72
    v_add_u32 v83, s11, v73
    s_waitcnt vmcnt(11) lgkmcnt(4)
    v_mfma_f32_32x32x16_bf16 v[16:31], v[120:123], v[168:171], v[16:31]
    ds_read_b32 v79, v8 offset:25984
    ds_read_b64_tr_b16 v[112:113], v82 offset:0
    ds_read_b64_tr_b16 v[114:115], v82 offset:1024
    buffer_load_dwordx4 v[152:155], v78, s[40:43], s37 offen offset:0 sc1
    v_mfma_f32_32x32x16_bf16 v[32:47], v[124:127], v[168:171], v[32:47]
    ds_read_b64_tr_b16 v[116:117], v83 offset:0
    ds_read_b64_tr_b16 v[118:119], v83 offset:1024
    s_waitcnt vmcnt(11) lgkmcnt(4)
    v_mfma_f32_32x32x16_bf16 v[16:31], v[104:107], v[172:175], v[16:31]
    ds_read_b64_tr_b16 v[120:121], v82 offset:2048
    ds_read_b64_tr_b16 v[122:123], v82 offset:3072
    buffer_load_dwordx4 v[156:159], v78, s[40:43], s37 offen offset:2048 sc1
    v_mfma_f32_32x32x16_bf16 v[32:47], v[108:111], v[172:175], v[32:47]
    ds_read_b64_tr_b16 v[124:125], v83 offset:2048
    ds_read_b64_tr_b16 v[126:127], v83 offset:3072
    v_readfirstlane_b32 s76, v79
    s_nop 0
    s_and_b32 s76, s76, s52
    s_cbranch_scc0 L_tr10
L_bk10:
    s_ff1_i32_b32 s76, s76
    s_bitset0_b32 s52, s76
    s_add_u32 s77, s76, s65
    s_and_b32 s77, s77, 15
    s_mul_i32 s77, s77, 32768
    s_add_u32 s38, s77, s80
    s_waitcnt vmcnt(11) lgkmcnt(4)
    v_mfma_f32_32x32x16_bf16 v[16:31], v[112:115], v[176:179], v[16:31]
    ds_read_b64_tr_b16 v[104:105], v82 offset:4096
    ds_read_b64_tr_b16 v[106:107], v82 offset:5120
    buffer_load_dwordx4 v[160:163], v14, s[40:43], s38 offen offset:0 sc1
    s_add_u32 s76, s76, 3
    s_and_b32 s76, s76, 15
    s_lshl_b32 s14, s76, 13
    v_mfma_f32_32x32x16_bf16 v[32:47], v[116:119], v[176:179], v[32:47]
    ds_read_b64_tr_b16 v[108:109], v83 offset:4096
    ds_read_b64_tr_b16 v[110:111], v83 offset:5120
    s_waitcnt vmcnt(11) lgkmcnt(4)
    v_mfma_f32_32x32x16_bf16 v[16:31], v[120:123], v[180:183], v[16:31]
    ds_read_b64_tr_b16 v[112:113], v82 offset:6144
    ds_read_b64_tr_b16 v[114:115], v82 offset:7168
    buffer_load_dwordx4 v[164:167], v14, s[40:43], s38 offen offset:2048 sc1
    v_mfma_f32_32x32x16_bf16 v[32:47], v[124:127], v[180:183], v[32:47]
    ds_read_b64_tr_b16 v[116:117], v83 offset:6144
    ds_read_b64_tr_b16 v[118:119], v83 offset:7168
    v_add_u32 v80, s12, v72
    v_add_u32 v81, s12, v73
    s_waitcnt vmcnt(11) lgkmcnt(4)
    v_mfma_f32_32x32x16_bf16 v[16:31], v[104:107], v[184:187], v[16:31]
    ds_read_b32 v79, v8 offset:25984
    ds_read_b64_tr_b16 v[120:121], v80 offset:0
    ds_read_b64_tr_b16 v[122:123], v80 offset:1024
    buffer_load_dwordx4 v[168:171], v78, s[40:43], s38 offen offset:0 sc1
    v_mfma_f32_32x32x16_bf16 v[32:47], v[108:111], v[184:187], v[32:47]
    ds_read_b64_tr_b16 v[124:125], v81 offset:0
    ds_read_b64_tr_b16 v[126:127], v81 offset:1024
    s_waitcnt vmcnt(11) lgkmcnt(4)
    v_mfma_f32_32x32x16_bf16 v[16:31], v[112:115], v[188:191], v[16:31]
    ds_read_b64_tr_b16 v[104:105], v80 offset:2048
    ds_read_b64_tr_b16 v[106:107], v80 offset:3072
    buffer_load_dwordx4 v[172:175], v78, s[40:43], s38 offen offset:2048 sc1
    v_mfma_f32_32x32x16_bf16 v[32:47], v[116:119], v[188:191], v[32:47]
    ds_read_b64_tr_b16 v[108:109], v81 offset:2048
    ds_read_b64_tr_b16 v[110:111], v81 offset:3072
    v_readfirstlane_b32 s76, v79
    s_nop 0
    s_and_b32 s76, s76, s52
    s_cbranch_scc0 L_tr11
L_bk11:
    s_ff1_i32_b32 s76, s76
    s_bitset0_b32 s52, s76
    s_add_u32 s77, s76, s65
    s_and_b32 s77, s77, 15
    s_mul_i32 s77, s77, 32768
    s_add_u32 s39, s77, s80
    s_waitcnt vmcnt(11) lgkmcnt(4)
    v_mfma_f32_32x32x16_bf16 v[16:31], v[120:123], v[128:131], v[16:31]
    ds_read_b64_tr_b16 v[112:113], v80 offset:4096
    ds_read_b64_tr_b16 v[114:115], v80 offset:5120
    buffer_load_dwordx4 v[176:179], v14, s[40:43], s39 offen offset:0 sc1
    s_add_u32 s76, s76, 3
    s_and_b32 s76, s76, 15
    s_lshl_b32 s15, s76, 13
    v_mfma_f32_32x32x16_bf16 v[32:47], v[124:127], v[128:131], v[32:47]
    ds_read_b64_tr_b16 v[116:117], v81 offset:4096
    ds_read_b64_tr_b16 v[118:119], v81 offset:5120
    s_waitcnt vmcnt(11) lgkmcnt(4)
    v_mfma_f32_32x32x16_bf16 v[16:31], v[104:107], v[132:135], v[16:31]
    ds_read_b64_tr_b16 v[120:121], v80 offset:6144
    ds_read_b64_tr_b16 v[122:123], v80 offset:7168
    buffer_load_dwordx4 v[180:183], v14, s[40:43], s39 offen offset:2048 sc1
    v_mfma_f32_32x32x16_bf16 v[32:47], v[108:111], v[132:135], v[32:47]
    ds_read_b64_tr_b16 v[124:125], v81 offset:6144
    ds_read_b64_tr_b16 v[126:127], v81 offset:7168
    v_add_u32 v82, s13, v72
    v_add_u32 v83, s13, v73
    s_waitcnt vmcnt(11) lgkmcnt(4)
    v_mfma_f32_32x32x16_bf16 v[16:31], v[112:115], v[136:139], v[16:31]
    ds_read_b32 v79, v8 offset:25984
    ds_read_b64_tr_b16 v[104:105], v82 offset:0
    ds_read_b64_tr_b16 v[106:107], v82 offset:1024
    buffer_load_dwordx4 v[184:187], v78, s[40:43], s39 offen offset:0 sc1
    v_mfma_f32_32x32x16_bf16 v[32:47], v[116:119], v[136:139], v[32:47]
    ds_read_b64_tr_b16 v[108:109], v83 offset:0
    ds_read_b64_tr_b16 v[110:111], v83 offset:1024
    s_waitcnt vmcnt(11) lgkmcnt(4)
    v_mfma_f32_32x32x16_bf16 v[16:31], v[120:123], v[140:143], v[16:31]
    ds_read_b64_tr_b16 v[112:113], v82 offset:2048
    ds_read_b64_tr_b16 v[114:115], v82 offset:3072
    buffer_load_dwordx4 v[188:191], v78, s[40:43], s39 offen offset:2048 sc1
    v_mfma_f32_32x32x16_bf16 v[32:47], v[124:127], v[140:143], v[32:47]
    ds_read_b64_tr_b16 v[116:117], v83 offset:2048
    ds_read_b64_tr_b16 v[118:119], v83 offset:3072
    v_readfirstlane_b32 s76, v79
    s_nop 0
    s_and_b32 s76, s76, s52
    s_cbranch_scc0 L_tr12
L_bk12:
    s_ff1_i32_b32 s76, s76
    s_bitset0_b32 s52, s76
    s_add_u32 s77, s76, s65
    s_and_b32 s77, s77, 15
    s_mul_i32 s77, s77, 32768
    s_add_u32 s48, s77, s80
    s_waitcnt vmcnt(11) lgkmcnt(4)
    v_mfma_f32_32x32x16_bf16 v[16:31], v[104:107], v[144:147], v[16:31]
    ds_read_b64_tr_b16 v[120:121], v82 offset:4096
    ds_read_b64_tr_b16 v[122:123], v82 offset:5120
    buffer_load_dwordx4 v[128:131], v14, s[40:43], s48 offen offset:0 sc1
    s_add_u32 s76, s76, 3
    s_and_b32 s76, s76, 15
    s_lshl_b32 s16, s76, 13
    v_mfma_f32_32x32x16_bf16 v[32:47], v[108:111], v[144:147], v[32:47]
    ds_read_b64_tr_b16 v[124:125], v83 offset:4096
    ds_read_b64_tr_b16 v[126:127], v83 offset:5120
    s_waitcnt vmcnt(11) lgkmcnt(4)
    v_mfma_f32_32x32x16_bf16 v[16:31], v[112:115], v[148:151], v[16:31]
    ds_read_b64_tr_b16 v[104:105], v82 offset:6144
    ds_read_b64_tr_b16 v[106:107], v82 offset:7168
    buffer_load_dwordx4 v[132:135], v14, s[40:43], s48 offen offset:2048 sc1
    v_mfma_f32_32x32x16_bf16 v[32:47], v[116:119], v[148:151], v[32:47]
    ds_read_b64_tr_b16 v[108:109], v83 offset:6144
    ds_read_b64_tr_b16 v[110:111], v83 offset:7168
    v_add_u32 v80, s14, v72
    v_add_u32 v81, s14, v73
    s_waitcnt vmcnt(11) lgkmcnt(4)
    v_mfma_f32_32x32x16_bf16 v[16:31], v[120:123], v[152:155], v[16:31]
    ds_read_b32 v79, v8 offset:25984
    ds_read_b64_tr_b16 v[112:113], v80 offset:0
    ds_read_b64_tr_b16 v[114:115], v80 offset:1024
    buffer_load_dwordx4 v[136:139], v78, s[40:43], s48 offen offset:0 sc1
    v_mfma_f32_32x32x16_bf16 v[32:47], v[124:127], v[152:155], v[32:47]
    ds_read_b64_tr_b16 v[116:117], v81 offset:0
    ds_read_b64_tr_b16 v[118:119], v81 offset:1024
    s_waitcnt vmcnt(11) lgkmcnt(4)
    v_mfma_f32_32x32x16_bf16 v[16:31], v[104:107], v[156:159], v[16:31]
    ds_read_b64_tr_b16 v[120:121], v80 offset:2048
    ds_read_b64_tr_b16 v[122:123], v80 offset:3072
    buffer_load_dwordx4 v[140:143], v78, s[40:43], s48 offen offset:2048 sc1
    v_mfma_f32_32x32x16_bf16 v[32:47], v[108:111], v[156:159], v[32:47]
    ds_read_b64_tr_b16 v[124:125], v81 offset:2048
    ds_read_b64_tr_b16 v[126:127], v81 offset:3072
    v_readfirstlane_b32 s76, v79
    s_nop 0
    s_and_b32 s76, s76, s52
    s_cbranch_scc0 L_tr13
L_bk13:
    s_ff1_i32_b32 s76, s76
    s_bitset0_b32 s52, s76
    s_add_u32 s77, s76, s65
    s_and_b32 s77, s77, 15
    s_mul_i32 s77, s77, 32768
    s_add_u32 s49, s77, s80
    s_waitcnt vmcnt(11) lgkmcnt(4)
    v_mfma_f32_32x32x16_bf16 v[16:31], v[112:115], v[160:163], v[16:31]
    ds_read_b64_tr_b16 v[104:105], v80 offset:4096
    ds_read_b64_tr_b16 v[106:107], v80 offset:5120
    buffer_load_dwordx4 v[144:147], v14, s[40:43], s49 offen offset:0 sc1
    s_add_u32 s76, s76, 3
    s_and_b32 s76, s76, 15
    s_lshl_b32 s17, s76, 13
    v_mfma_f32_32x32x16_bf16 v[32:47], v[116:119], v[160:163], v[32:47]
    ds_read_b64_tr_b16 v[108:109], v81 offset:4096
    ds_read_b64_tr_b16 v[110:111], v81 offset:5120
    s_waitcnt vmcnt(11) lgkmcnt(4)
    v_mfma_f32_32x32x16_bf16 v[16:31], v[120:123], v[164:167], v[16:31]
    ds_read_b64_tr_b16 v[112:113], v80 offset:6144
    ds_read_b64_tr_b16 v[114:115], v80 offset:7168
    buffer_load_dwordx4 v[148:151], v14, s[40:43], s49 offen offset:2048 sc1
    v_mfma_f32_32x32x16_bf16 v[32:47], v[124:127], v[164:167], v[32:47]
    ds_read_b64_tr_b16 v[116:117], v81 offset:6144
    ds_read_b64_tr_b16 v[118:119], v81 offset:7168
    v_add_u32 v82, s15, v72
    v_add_u32 v83, s15, v73
    s_waitcnt vmcnt(11) lgkmcnt(4)
    v_mfma_f32_32x32x16_bf16 v[16:31], v[104:107], v[168:171], v[16:31]
    ds_read_b32 v79, v8 offset:25984
    ds_read_b64_tr_b16 v[120:121], v82 offset:0
    ds_read_b64_tr_b16 v[122:123], v82 offset:1024
    buffer_load_dwordx4 v[152:155], v78, s[40:43], s49 offen offset:0 sc1
    v_mfma_f32_32x32x16_bf16 v[32:47], v[108:111], v[168:171], v[32:47]
    ds_read_b64_tr_b16 v[124:125], v83 offset:0
    ds_read_b64_tr_b16 v[126:127], v83 offset:1024
    s_waitcnt vmcnt(11) lgkmcnt(4)
    v_mfma_f32_32x32x16_bf16 v[16:31], v[112:115], v[172:175], v[16:31]
    ds_read_b64_tr_b16 v[104:105], v82 offset:2048
    ds_read_b64_tr_b16 v[106:107], v82 offset:3072
    buffer_load_dwordx4 v[156:159], v78, s[40:43], s49 offen offset:2048 sc1
    v_mfma_f32_32x32x16_bf16 v[32:47], v[116:119], v[172:175], v[32:47]
    ds_read_b64_tr_b16 v[108:109], v83 offset:2048
    ds_read_b64_tr_b16 v[110:111], v83 offset:3072
    v_readfirstlane_b32 s76, v79
    s_nop 0
    s_and_b32 s76, s76, s52
    s_cbranch_scc0 L_tr14
L_bk14:
    s_ff1_i32_b32 s76, s76
    s_bitset0_b32 s52, s76
    s_add_u32 s77, s76, s65
    s_and_b32 s77, s77, 15
    s_mul_i32 s77, s77, 32768
    s_add_u32 s50, s77, s80
    s_waitcnt vmcnt(11) lgkmcnt(4)
    v_mfma_f32_32x32x16_bf16 v[16:31], v[120:123], v[176:179], v[16:31]
    ds_read_b64_tr_b16 v[112:113], v82 offset:4096
    ds_read_b64_tr_b16 v[114:115], v82 offset:5120
    buffer_load_dwordx4 v[160:163], v14, s[40:43], s50 offen offset:0 sc1
    s_add_u32 s76, s76, 3
    s_and_b32 s76, s76, 15
    s_lshl_b32 s18, s76, 13
    v_mfma_f32_32x32x16_bf16 v[32:47], v[124:127], v[176:179], v[32:47]
    ds_read_b64_tr_b16 v[116:117], v83 offset:4096
    ds_read_b64_tr_b16 v[118:119], v83 offset:5120
    s_waitcnt vmcnt(11) lgkmcnt(4)
    v_mfma_f32_32x32x16_bf16 v[16:31], v[104:107], v[180:183], v[16:31]
    ds_read_b64_tr_b16 v[120:121], v82 offset:6144
    ds_read_b64_tr_b16 v[122:123], v82 offset:7168
    buffer_load_dwordx4 v[164:167], v14, s[40:43], s50 offen offset:2048 sc1
    v_mfma_f32_32x32x16_bf16 v[32:47], v[108:111], v[180:183], v[32:47]
    ds_read_b64_tr_b16 v[124:125], v83 offset:6144
    ds_read_b64_tr_b16 v[126:127], v83 offset:7168
    v_add_u32 v80, s16, v72
    v_add_u32 v81, s16, v73
    s_waitcnt vmcnt(11) lgkmcnt(4)
    v_mfma_f32_32x32x16_bf16 v[16:31], v[112:115], v[184:187], v[16:31]
    ds_read_b32 v79, v8 offset:25984
    ds_read_b64_tr_b16 v[104:105], v80 offset:0
    ds_read_b64_tr_b16 v[106:107], v80 offset:1024
    buffer_load_dwordx4 v[168:171], v78, s[40:43], s50 offen offset:0 sc1
    v_mfma_f32_32x32x16_bf16 v[32:47], v[116:119], v[184:187], v[32:47]
    ds_read_b64_tr_b16 v[108:109], v81 offset:0
    ds_read_b64_tr_b16 v[110:111], v81 offset:1024
    s_waitcnt vmcnt(11) lgkmcnt(4)
    v_mfma_f32_32x32x16_bf16 v[16:31], v[120:123], v[188:191], v[16:31]
    ds_read_b64_tr_b16 v[112:113], v80 offset:2048
    ds_read_b64_tr_b16 v[114:115], v80 offset:3072
    buffer_load_dwordx4 v[172:175], v78, s[40:43], s50 offen offset:2048 sc1
    v_mfma_f32_32x32x16_bf16 v[32:47], v[124:127], v[188:191], v[32:47]
    ds_read_b64_tr_b16 v[116:117], v81 offset:2048
    ds_read_b64_tr_b16 v[118:119], v81 offset:3072
    v_readfirstlane_b32 s76, v79
    s_nop 0
    s_and_b32 s76, s76, s52
    s_cbranch_scc0 L_tr15
L_bk15:
    s_ff1_i32_b32 s76, s76
    s_bitset0_b32 s52, s76
    s_add_u32 s77, s76, s65
    s_and_b32 s77, s77, 15
    s_mul_i32 s77, s77, 32768
    s_add_u32 s51, s77, s80
    s_waitcnt vmcnt(11) lgkmcnt(4)
    v_mfma_f32_32x32x16_bf16 v[16:31], v[104:107], v[128:131], v[16:31]
    ds_read_b64_tr_b16 v[120:121], v80 offset:4096
    ds_read_b64_tr_b16 v[122:123], v80 offset:5120
    buffer_load_dwordx4 v[176:179], v14, s[40:43], s51 offen offset:0 sc1
    s_add_u32 s76, s76, 3
    s_and_b32 s76, s76, 15
    s_lshl_b32 s19, s76, 13
    v_mfma_f32_32x32x16_bf16 v[32:47], v[108:111], v[128:131], v[32:47]
    ds_read_b64_tr_b16 v[124:125], v81 offset:4096
    ds_read_b64_tr_b16 v[126:127], v81 offset:5120
    s_waitcnt vmcnt(11) lgkmcnt(4)
    v_mfma_f32_32x32x16_bf16 v[16:31], v[112:115], v[132:135], v[16:31]
    ds_read_b64_tr_b16 v[104:105], v80 offset:6144
    ds_read_b64_tr_b16 v[106:107], v80 offset:7168
    buffer_load_dwordx4 v[180:183], v14, s[40:43], s51 offen offset:2048 sc1
    v_mfma_f32_32x32x16_bf16 v[32:47], v[116:119], v[132:135], v[32:47]
    ds_read_b64_tr_b16 v[108:109], v81 offset:6144
    ds_read_b64_tr_b16 v[110:111], v81 offset:7168
    v_add_u32 v82, s17, v72
    v_add_u32 v83, s17, v73
    s_waitcnt vmcnt(11) lgkmcnt(4)
    v_mfma_f32_32x32x16_bf16 v[16:31], v[120:123], v[136:139], v[16:31]
    ds_read_b64 v[192:193], v10 offset:16384
    ds_read_b64_tr_b16 v[112:113], v82 offset:0
    ds_read_b64_tr_b16 v[114:115], v82 offset:1024
    buffer_load_dwordx4 v[184:187], v78, s[40:43], s51 offen offset:0 sc1
    v_mfma_f32_32x32x16_bf16 v[32:47], v[124:127], v[136:139], v[32:47]
    ds_read_b64_tr_b16 v[116:117], v83 offset:0
    ds_read_b64_tr_b16 v[118:119], v83 offset:1024
    s_waitcnt vmcnt(11) lgkmcnt(4)
    v_mfma_f32_32x32x16_bf16 v[16:31], v[104:107], v[140:143], v[16:31]
    ds_read_b64 v[194:195], v10 offset:16400
    ds_read_b64_tr_b16 v[120:121], v82 offset:2048
    ds_read_b64_tr_b16 v[122:123], v82 offset:3072
    buffer_load_dwordx4 v[188:191], v78, s[40:43], s51 offen offset:2048 sc1
    s_barrier
    v_mfma_f32_32x32x16_bf16 v[32:47], v[108:111], v[140:143], v[32:47]
    ds_read_b64_tr_b16 v[124:125], v83 offset:2048
    ds_read_b64_tr_b16 v[126:127], v83 offset:3072
    s_waitcnt vmcnt(11) lgkmcnt(4)
    v_mfma_f32_32x32x16_bf16 v[16:31], v[112:115], v[144:147], v[16:31]
    ds_read_b64 v[196:197], v10 offset:16416
    ds_read_b64_tr_b16 v[104:105], v82 offset:4096
    ds_read_b64_tr_b16 v[106:107], v82 offset:5120
    v_mfma_f32_32x32x16_bf16 v[32:47], v[116:119], v[144:147], v[32:47]
    ds_read_b64_tr_b16 v[108:109], v83 offset:4096
    ds_read_b64_tr_b16 v[110:111], v83 offset:5120
    s_waitcnt vmcnt(10) lgkmcnt(4)
    v_mfma_f32_32x32x16_bf16 v[16:31], v[120:123], v[148:151], v[16:31]
    ds_read_b64 v[198:199], v10 offset:16432
    ds_read_b64_tr_b16 v[112:113], v82 offset:6144
    ds_read_b64_tr_b16 v[114:115], v82 offset:7168
    v_mfma_f32_32x32x16_bf16 v[32:47], v[124:127], v[148:151], v[32:47]
    ds_read_b64_tr_b16 v[116:117], v83 offset:6144
    ds_read_b64_tr_b16 v[118:119], v83 offset:7168
    v_add_u32 v80, s18, v72
    v_add_u32_e64 v81, s18, v73
    s_waitcnt vmcnt(9) lgkmcnt(4)
    v_mfma_f32_32x32x16_bf16 v[16:31], v[104:107], v[152:155], v[16:31]
    ds_read_b64 v[200:201], v10 offset:16448
    ds_read_b64_tr_b16 v[120:121], v80 offset:0
    ds_read_b64_tr_b16 v[122:123], v80 offset:1024
    v_mfma_f32_32x32x16_bf16 v[32:47], v[108:111], v[152:155], v[32:47]
    ds_read_b64_tr_b16 v[124:125], v81 offset:0
    ds_read_b64_tr_b16 v[126:127], v81 offset:1024
    s_waitcnt vmcnt(8) lgkmcnt(4)
    v_mfma_f32_32x32x16_bf16 v[16:31], v[112:115], v[156:159], v[16:31]
    ds_read_b64 v[202:203], v10 offset:16464
    ds_read_b64_tr_b16 v[104:105], v80 offset:2048
    ds_read_b64_tr_b16 v[106:107], v80 offset:3072
    v_mfma_f32_32x32x16_bf16 v[32:47], v[116:119], v[156:159], v[32:47]
    ds_read_b64_tr_b16 v[108:109], v81 offset:2048
    ds_read_b64_tr_b16 v[110:111], v81 offset:3072
    s_waitcnt vmcnt(7) lgkmcnt(4)
    v_mfma_f32_32x32x16_bf16 v[16:31], v[120:123], v[160:163], v[16:31]
    ds_read_b64 v[204:205], v10 offset:16480
    ds_read_b64_tr_b16 v[112:113], v80 offset:4096
    ds_read_b64_tr_b16 v[114:115], v80 offset:5120
    v_mfma_f32_32x32x16_bf16 v[32:47], v[124:127], v[160:163], v[32:47]
    ds_read_b64_tr_b16 v[116:117], v81 offset:4096
    ds_read_b64_tr_b16 v[118:119], v81 offset:5120
    s_waitcnt vmcnt(6) lgkmcnt(4)
    v_mfma_f32_32x32x16_bf16 v[16:31], v[104:107], v[164:167], v[16:31]
    ds_read_b64 v[206:207], v10 offset:16496
    ds_read_b64_tr_b16 v[120:121], v80 offset:6144
    ds_read_b64_tr_b16 v[122:123], v80 offset:7168
    v_mfma_f32_32x32x16_bf16 v[32:47], v[108:111], v[164:167], v[32:47]
    ds_read_b64_tr_b16 v[124:125], v81 offset:6144
    ds_read_b64_tr_b16 v[126:127], v81 offset:7168
    v_add_u32 v82, s19, v72
    v_add_u32 v83, s19, v73
    s_waitcnt vmcnt(5) lgkmcnt(4)
    v_mfma_f32_32x32x16_bf16 v[16:31], v[112:115], v[168:171], v[16:31]
    ds_read_b128 v[208:211], v11 offset:16384
    ds_read_b64_tr_b16 v[104:105], v82 offset:0
    ds_read_b64_tr_b16 v[106:107], v82 offset:1024
    v_mfma_f32_32x32x16_bf16 v[32:47], v[116:119], v[168:171], v[32:47]
    ds_read_b64_tr_b16 v[108:109], v83 offset:0
    ds_read_b64_tr_b16 v[110:111], v83 offset:1024
    s_waitcnt vmcnt(4) lgkmcnt(4)
    v_mfma_f32_32x32x16_bf16 v[16:31], v[120:123], v[172:175], v[16:31]
    ds_read_b128 v[212:215], v11 offset:16400
    ds_read_b64_tr_b16 v[112:113], v82 offset:2048
    ds_read_b64_tr_b16 v[114:115], v82 offset:3072
    v_mfma_f32_32x32x16_bf16 v[32:47], v[124:127], v[172:175], v[32:47]
    ds_read_b64_tr_b16 v[116:117], v83 offset:2048
    ds_read_b64_tr_b16 v[118:119], v83 offset:3072
    s_waitcnt vmcnt(3) lgkmcnt(4)
    v_mfma_f32_32x32x16_bf16 v[16:31], v[104:107], v[176:179], v[16:31]
    ds_read_b64_tr_b16 v[120:121], v82 offset:4096
    ds_read_b64_tr_b16 v[122:123], v82 offset:5120
    v_mfma_f32_32x32x16_bf16 v[32:47], v[108:111], v[176:179], v[32:47]
    ds_read_b64_tr_b16 v[124:125], v83 offset:4096
    ds_read_b64_tr_b16 v[126:127], v83 offset:5120
    s_waitcnt vmcnt(2) lgkmcnt(4)
    v_mfma_f32_32x32x16_bf16 v[16:31], v[112:115], v[180:183], v[16:31]
    ds_read_b64_tr_b16 v[104:105], v82 offset:6144
    ds_read_b64_tr_b16 v[106:107], v82 offset:7168
    v_mfma_f32_32x32x16_bf16 v[32:47], v[116:119], v[180:183], v[32:47]
    ds_read_b64_tr_b16 v[108:109], v83 offset:6144
    ds_read_b64_tr_b16 v[110:111], v83 offset:7168
    s_waitcnt vmcnt(1) lgkmcnt(4)
    v_mfma_f32_32x32x16_bf16 v[16:31], v[120:123], v[184:187], v[16:31]
    v_mfma_f32_32x32x16_bf16 v[32:47], v[124:127], v[184:187], v[32:47]
    s_waitcnt vmcnt(0) lgkmcnt(0)
    v_mfma_f32_32x32x16_bf16 v[16:31], v[104:107], v[188:191], v[16:31]
    v_mfma_f32_32x32x16_bf16 v[32:47], v[108:111], v[188:191], v[32:47]
    s_nop 10
    v_cvt_pk_bf16_f32 v88, v16, v17
    v_cvt_pk_bf16_f32 v89, v18, v19
    v_cvt_pk_bf16_f32 v90, v20, v21
    v_cvt_pk_bf16_f32 v91, v22, v23
    v_cvt_pk_bf16_f32 v92, v24, v25
    v_cvt_pk_bf16_f32 v93, v26, v27
    v_cvt_pk_bf16_f32 v94, v28, v29
    v_cvt_pk_bf16_f32 v95, v30, v31
    v_cvt_pk_bf16_f32 v96, v32, v33
    v_cvt_pk_bf16_f32 v97, v34, v35
    v_cvt_pk_bf16_f32 v98, v36, v37
    v_cvt_pk_bf16_f32 v99, v38, v39
    v_cvt_pk_bf16_f32 v100, v40, v41
    v_cvt_pk_bf16_f32 v101, v42, v43
    v_cvt_pk_bf16_f32 v102, v44, v45
    v_cvt_pk_bf16_f32 v103, v46, v47
    v_dot2_f32_bf16 v104, v88, s89, 0
    v_dot2_f32_bf16 v105, v88, v88, 0
    v_dot2_f32_bf16 v106, v88, v192, 0
    v_dot2_f32_bf16 v104, v89, s89, v104
    v_dot2_f32_bf16 v105, v89, v89, v105
    v_dot2_f32_bf16 v106, v89, v193, v106
    v_dot2_f32_bf16 v104, v90, s89, v104
    v_dot2_f32_bf16 v105, v90, v90, v105
    v_dot2_f32_bf16 v106, v90, v194, v106
    v_dot2_f32_bf16 v104, v91, s89, v104
    v_dot2_f32_bf16 v105, v91, v91, v105
    v_dot2_f32_bf16 v106, v91, v195, v106
    v_dot2_f32_bf16 v104, v92, s89, v104
    v_dot2_f32_bf16 v105, v92, v92, v105
    v_dot2_f32_bf16 v106, v92, v196, v106
    v_dot2_f32_bf16 v104, v93, s89, v104
    v_dot2_f32_bf16 v105, v93, v93, v105
    v_dot2_f32_bf16 v106, v93, v197, v106
    v_dot2_f32_bf16 v104, v94, s89, v104
    v_dot2_f32_bf16 v105, v94, v94, v105
    v_dot2_f32_bf16 v106, v94, v198, v106
    v_dot2_f32_bf16 v104, v95, s89, v104
    v_dot2_f32_bf16 v105, v95, v95, v105
    v_dot2_f32_bf16 v106, v95, v199, v106
    v_dot2_f32_bf16 v104, v96, s89, v104
    v_dot2_f32_bf16 v105, v96, v96, v105
    v_dot2_f32_bf16 v106, v96, v200, v106
    v_dot2_f32_bf16 v104, v97, s89, v104
    v_dot2_f32_bf16 v105, v97, v97, v105
    v_dot2_f32_bf16 v106, v97, v201, v106
    v_dot2_f32_bf16 v104, v98, s89, v104
    v_dot2_f32_bf16 v105, v98, v98, v105
    v_dot2_f32_bf16 v106, v98, v202, v106
    v_dot2_f32_bf16 v104, v99, s89, v104
    v_dot2_f32_bf16 v105, v99, v99, v105
    v_dot2_f32_bf16 v106, v99, v203, v106
    v_dot2_f32_bf16 v104, v100, s89, v104
    v_dot2_f32_bf16 v105, v100, v100, v105
    v_dot2_f32_bf16 v106, v100, v204, v106
    v_dot2_f32_bf16 v104, v101, s89, v104
    v_dot2_f32_bf16 v105, v101, v101, v105
    v_dot2_f32_bf16 v106, v101, v205, v106
    v_dot2_f32_bf16 v104, v102, s89, v104
    v_dot2_f32_bf16 v105, v102, v102, v105
    v_dot2_f32_bf16 v106, v102, v206, v106
    v_dot2_f32_bf16 v104, v103, s89, v104
    v_dot2_f32_bf16 v105, v103, v103, v105
    v_dot2_f32_bf16 v106, v103, v207, v106
    s_lshl_b32 s76, s62, 9
    s_add_u32 s77, s76, s99
    v_mov_b32 v107, 0
    v_mov_b32 v4, v104
    v_mov_b32 v5, v105
    v_mov_b32 v6, v106
    v_permlane32_swap_b32 v104, v4
    v_permlane32_swap_b32 v105, v5
    v_permlane32_swap_b32 v106, v6
    v_add_f32 v104, v104, v4
    v_add_f32 v105, v105, v5
    v_add_f32_e64 v106, v106, v6
    s_mov_b32 exec_hi, 0
    s_bitcmp1_b32 s100, 1
    s_cbranch_scc1 L_loc_70
    buffer_store_dwordx4 v[104:107], v12, s[40:43], s77 offen offset:1024 sc1
    s_branch L_pubd_71
L_loc_70:
    buffer_store_dwordx4 v[104:107], v12, s[40:43], s77 offen offset:1024
L_pubd_71:
    s_mov_b64 exec, -1
    ds_write_b64 v64, v[88:89]
    ds_write_b64 v65, v[90:91]
    ds_write_b64 v66, v[92:93]
    ds_write_b64 v67, v[94:95]
    ds_write_b64 v68, v[96:97]
    ds_write_b64 v69, v[98:99]
    ds_write_b64 v70, v[100:101]
    ds_write_b64 v71, v[102:103]
    v_bfe_u32 v4, v1, 1, 3
    v_bfe_u32 v5, v1, 4, 1
    v_lshlrev_b32_e64 v176, 4, v4
    v_lshl_add_u32 v176, v5, 3, v176
    v_and_b32_e64 v5, 1, v1
    v_lshl_add_u32 v176, v5, 2, v176
    v_lshlrev_b32_e64 v177, 2, v2
    v_lshl_add_u32 v177, v3, 8, v177
    v_and_b32 v4, 15, v1
    v_lshrrev_b32 v5, 4, v1
    v_mul_u32_u24 v179, 149504, v4
    v_lshl_add_u32 v180, v5, 4, v179
    s_lshl_b32 s82, s97, 7
    s_lshl_b32 s79, s62, 5
    s_add_u32 s82, s82, s79
    s_lshl_b32 s79, s62, 2
    v_mov_b32_e64 v7, s79
    v_mul_u32_u24 v178, 9344, v3
    v_lshl_add_u32 v178, v2, 4, v178
    s_mul_i32 s78, s97, 149504
    s_add_u32 s78, s78, s76
    s_add_u32 s78, s78, 8388608
    s_add_u32 s48, s78, 18688
    s_add_u32 s49, s48, 18688
    s_add_u32 s50, s49, 18688
    s_add_u32 s51, s50, 18688
    s_add_u32 s52, s51, 18688
    s_add_u32 s53, s52, 18688
    s_add_u32 s54, s53, 18688
    buffer_load_dwordx4 v[112:115], v178, s[40:43], s78 offen offset:1024 sc1
    buffer_load_dwordx4 v[116:119], v178, s[40:43], s48 offen offset:1024 sc1
    buffer_load_dwordx4 v[120:123], v178, s[40:43], s49 offen offset:1024 sc1
    buffer_load_dwordx4 v[124:127], v178, s[40:43], s50 offen offset:1024 sc1
    buffer_load_dwordx4 v[128:131], v178, s[40:43], s51 offen offset:1024 sc1
    buffer_load_dwordx4 v[132:135], v178, s[40:43], s52 offen offset:1024 sc1
    buffer_load_dwordx4 v[136:139], v178, s[40:43], s53 offen offset:1024 sc1
    buffer_load_dwordx4 v[140:143], v178, s[40:43], s54 offen offset:1024 sc1
    v_dot2_f32_bf16 v76, v208, s89, 0
    v_dot2_f32_bf16 v76, v209, s89, v76
    v_dot2_f32_bf16 v76, v210, s89, v76
    v_dot2_f32_bf16 v76, v211, s89, v76
    v_dot2_f32_bf16 v76, v212, s89, v76
    v_dot2_f32_bf16 v76, v213, s89, v76
    v_dot2_f32_bf16 v76, v214, s89, v76
    v_dot2_f32_bf16 v76, v215, s89, v76
    s_nop 2
    v_add_f32_dpp v76, v76, v76 row_ror:8 row_mask:0xf bank_mask:0xf
    s_nop 1
    v_add_f32_dpp v76, v76, v76 row_ror:4 row_mask:0xf bank_mask:0xf
    s_nop 1
    v_add_f32_dpp v76, v76, v76 row_ror:2 row_mask:0xf bank_mask:0xf
    s_nop 1
    v_add_f32_dpp v76, v76, v76 row_ror:1 row_mask:0xf bank_mask:0xf
    v_mov_b32 v4, v76
    s_nop 1
    v_permlane16_swap_b32 v76, v4
    v_add_f32 v76, v76, v4
    v_mov_b32 v4, v76
    s_nop 1
    v_permlane32_swap_b32 v76, v4
    v_add_f32_e64 v76, v76, v4
    s_mov_b32 s88, 0
    s_waitcnt vmcnt(6)
    v_pk_add_f32 v[108:109], v[112:113], v[116:117]
    v_pk_add_f32 v[110:111], v[114:115], v[118:119]
    s_waitcnt vmcnt(5)
    v_pk_add_f32 v[108:109], v[108:109], v[120:121]
    v_pk_add_f32 v[110:111], v[110:111], v[122:123]
    s_waitcnt vmcnt(4)
    v_pk_add_f32 v[108:109], v[108:109], v[124:125]
    v_pk_add_f32 v[110:111], v[110:111], v[126:127]
    s_waitcnt vmcnt(3)
    v_pk_add_f32 v[108:109], v[108:109], v[128:129]
    v_pk_add_f32 v[110:111], v[110:111], v[130:131]
    s_waitcnt vmcnt(2)
    v_pk_add_f32 v[108:109], v[108:109], v[132:133]
    v_pk_add_f32 v[110:111], v[110:111], v[134:135]
    s_waitcnt vmcnt(1)
    v_pk_add_f32 v[108:109], v[108:109], v[136:137]
    v_pk_add_f32 v[110:111], v[110:111], v[138:139]
    s_waitcnt vmcnt(0)
    v_pk_add_f32 v[108:109], v[108:109], v[140:141]
    v_pk_add_f32 v[110:111], v[110:111], v[142:143]
    v_cmp_u_f32 vcc, v111, v111
    v_mov_b32 v4, v108
    v_mov_b32 v5, v109
    v_mov_b32 v6, v110
    s_cbranch_vccnz L_s3_73
L_s3ok_74:
    v_permlane32_swap_b32 v108, v4
    v_permlane32_swap_b32 v109, v5
    v_permlane32_swap_b32 v110, v6
    s_barrier
    v_add_f32 v108, v108, v4
    v_add_f32 v109, v109, v5
    v_add_f32 v110, v110, v6
    v_mul_f32 v108, 0x3a800000, v108
    v_mul_f32 v109, 0x3a800000, v109
    v_fma_f32 v4, -v108, v108, v109
    v_max_f32_e64 v4, 0, v4
    v_cvt_pk_bf16_f32 v116, v108, v108
    v_and_b32_e64 v116, s90, v116
    v_cvt_pk_bf16_f32 v4, v4, v4
    v_and_b32_e64 v4, s90, v4
    v_add_f32 v4, 0x3727c5ac, v4
    v_cvt_pk_bf16_f32 v4, v4, v4
    v_and_b32 v4, s90, v4
    v_sqrt_f32_e64 v4, v4
    s_nop 0
    v_cvt_pk_bf16_f32 v4, v4, v4
    v_and_b32 v4, s90, v4
    v_rcp_f32 v118, v4
    v_fma_f32 v120, -v116, v76, v110
    v_mul_f32 v119, v116, v118
    v_mul_f32 v120, v120, v118
    v_and_b32 v6, 3, v1
    v_lshlrev_b32 v6, 2, v6
    v_max_f32_dpp v4, v120, v120 row_ror:8 row_mask:0xf bank_mask:0xf
    s_lshl_b32 s83, s62, 12
    v_cmp_gt_u32 s[84:85], 32, v1
    v_max_f32_dpp v4, v4, v4 row_ror:4 row_mask:0xf bank_mask:0xf
    s_lshl_b32 s55, 1, s62
    s_sub_u32 s55, s55, 1
    v_max_f32_dpp v4, v4, v4 row_ror:2 row_mask:0xf bank_mask:0xf
    s_nop 1
    v_max_f32_dpp v4, v4, v4 row_ror:1 row_mask:0xf bank_mask:0xf
    v_mov_b32 v5, v4
    s_nop 1
    v_permlane16_swap_b32 v4, v5
    v_max_f32 v4, v4, v5
    v_cmp_eq_f32_e64 vcc, v4, v120
    ds_write_b32 v7, v4 offset:25600
    s_ff1_i32_b32 s77, vcc_lo
    s_and_b32 s77, s77, 31
    s_bfe_u32 s79, s77, 0x30001
    s_lshl3_add_u32 s79, s77, s79
    s_lshl4_add_u32 s79, s79, s83
    v_xor_b32_e64 v176, s79, v176
    ds_read_b32 v182, v176 offset:0
    s_waitcnt lgkmcnt(1)
    s_barrier
    ds_read_b32 v8, v6 offset:25600
    v_readlane_b32 s80, v118, s77
    v_readlane_b32 s81, v119, s77
    s_add_u32 s79, s82, s77
    v_writelane_b32 v4, s79, 33
    v_mov_b32 v5, s81
    s_waitcnt lgkmcnt(1)
    v_lshlrev_b32 v184, 16, v182
    v_and_b32_e64 v185, s90, v182
    v_fma_f32 v184, v184, s80, -v5
    v_fma_f32 v185, v185, s80, -v5
    v_cvt_pk_bf16_f32 v184, v184, v185
    v_cndmask_b32 v184, v4, v184, s[84:85]
    s_waitcnt lgkmcnt(0)
    v_cmp_eq_f32 s[56:57], v8, v4
    v_cmp_gt_f32 vcc, v8, v4
    s_and_b32 s56, s56, s55
    s_or_b32 s56, s56, vcc_lo
    s_cbranch_scc1 L_nopub_83
    buffer_store_dword v184, v177, s[40:43], s99 offen offset:0 sc1
L_nopub_83:
    v_lshlrev_b32 v16, 16, v88
    v_and_b32_e64 v17, s90, v88
    v_pk_fma_f32 v[144:145], v[16:17], v[118:119], v[118:119] op_sel:[0,0,1] op_sel_hi:[1,0,1] neg_lo:[0,0,1] neg_hi:[0,0,1]
    v_cvt_pk_bf16_f32 v124, v144, v145
    v_lshlrev_b32 v144, 16, v124
    v_and_b32 v145, s90, v124
    v_pk_add_f32 v[144:145], v[144:145], v[16:17]
    v_cvt_pk_bf16_f32 v124, v144, v145
    v_lshlrev_b32 v18, 16, v89
    v_and_b32 v19, s90, v89
    v_pk_fma_f32 v[146:147], v[18:19], v[118:119], v[118:119] op_sel:[0,0,1] op_sel_hi:[1,0,1] neg_lo:[0,0,1] neg_hi:[0,0,1]
    v_cvt_pk_bf16_f32 v125, v146, v147
    v_lshlrev_b32 v146, 16, v125
    v_and_b32 v147, s90, v125
    v_pk_add_f32 v[146:147], v[146:147], v[18:19]
    v_cvt_pk_bf16_f32 v125, v146, v147
    ds_write_b64 v64, v[124:125]
    v_lshlrev_b32 v20, 16, v90
    v_and_b32 v21, s90, v90
    v_pk_fma_f32 v[148:149], v[20:21], v[118:119], v[118:119] op_sel:[0,0,1] op_sel_hi:[1,0,1] neg_lo:[0,0,1] neg_hi:[0,0,1]
    v_cvt_pk_bf16_f32 v126, v148, v149
    v_lshlrev_b32 v148, 16, v126
    v_and_b32 v149, s90, v126
    v_pk_add_f32 v[148:149], v[148:149], v[20:21]
    v_cvt_pk_bf16_f32 v126, v148, v149
    v_lshlrev_b32 v22, 16, v91
    v_and_b32 v23, s90, v91
    v_pk_fma_f32 v[150:151], v[22:23], v[118:119], v[118:119] op_sel:[0,0,1] op_sel_hi:[1,0,1] neg_lo:[0,0,1] neg_hi:[0,0,1]
    v_cvt_pk_bf16_f32 v127, v150, v151
    v_lshlrev_b32 v150, 16, v127
    v_and_b32 v151, s90, v127
    v_pk_add_f32 v[150:151], v[150:151], v[22:23]
    v_cvt_pk_bf16_f32 v127, v150, v151
    ds_write_b64 v65, v[126:127]
    s_cmp_eq_u32 s56, 0
    s_cbranch_scc1 L_stay_84
    s_cmp_gt_u32 s62, 1
    s_cbranch_scc0 L_stay_84
    s_mov_b32 s91, -1
    v_lshlrev_b32 v24, 16, v92
    v_and_b32_e64 v25, s90, v92
    v_pk_fma_f32 v[152:153], v[24:25], v[118:119], v[118:119] op_sel:[0,0,1] op_sel_hi:[1,0,1] neg_lo:[0,0,1] neg_hi:[0,0,1]
    v_cvt_pk_bf16_f32 v128, v152, v153
    v_lshlrev_b32 v152, 16, v128
    v_and_b32 v153, s90, v128
    v_pk_add_f32 v[152:153], v[152:153], v[24:25]
    v_cvt_pk_bf16_f32 v128, v152, v153
    v_lshlrev_b32 v26, 16, v93
    v_and_b32 v27, s90, v93
    v_pk_fma_f32 v[154:155], v[26:27], v[118:119], v[118:119] op_sel:[0,0,1] op_sel_hi:[1,0,1] neg_lo:[0,0,1] neg_hi:[0,0,1]
    v_cvt_pk_bf16_f32 v129, v154, v155
    v_lshlrev_b32 v154, 16, v129
    v_and_b32 v155, s90, v129
    v_pk_add_f32 v[154:155], v[154:155], v[26:27]
    v_cvt_pk_bf16_f32 v129, v154, v155
    ds_write_b64 v66, v[128:129]
    v_lshlrev_b32 v28, 16, v94
    v_and_b32 v29, s90, v94
    v_pk_fma_f32 v[156:157], v[28:29], v[118:119], v[118:119] op_sel:[0,0,1] op_sel_hi:[1,0,1] neg_lo:[0,0,1] neg_hi:[0,0,1]
    v_cvt_pk_bf16_f32 v130, v156, v157
    v_lshlrev_b32 v156, 16, v130
    v_and_b32 v157, s90, v130
    v_pk_add_f32 v[156:157], v[156:157], v[28:29]
    v_cvt_pk_bf16_f32 v130, v156, v157
    v_lshlrev_b32 v30, 16, v95
    v_and_b32 v31, s90, v95
    v_pk_fma_f32 v[158:159], v[30:31], v[118:119], v[118:119] op_sel:[0,0,1] op_sel_hi:[1,0,1] neg_lo:[0,0,1] neg_hi:[0,0,1]
    v_cvt_pk_bf16_f32 v131, v158, v159
    v_lshlrev_b32 v158, 16, v131
    v_and_b32 v159, s90, v131
    v_pk_add_f32 v[158:159], v[158:159], v[30:31]
    v_cvt_pk_bf16_f32 v131, v158, v159
    ds_write_b64 v67, v[130:131]
    v_lshlrev_b32 v32, 16, v96
    v_and_b32 v33, s90, v96
    v_pk_fma_f32 v[160:161], v[32:33], v[118:119], v[118:119] op_sel:[0,0,1] op_sel_hi:[1,0,1] neg_lo:[0,0,1] neg_hi:[0,0,1]
    v_cvt_pk_bf16_f32 v132, v160, v161
    v_lshlrev_b32 v160, 16, v132
    v_and_b32 v161, s90, v132
    v_pk_add_f32 v[160:161], v[160:161], v[32:33]
    v_cvt_pk_bf16_f32 v132, v160, v161
    v_lshlrev_b32 v34, 16, v97
    v_and_b32 v35, s90, v97
    v_pk_fma_f32 v[162:163], v[34:35], v[118:119], v[118:119] op_sel:[0,0,1] op_sel_hi:[1,0,1] neg_lo:[0,0,1] neg_hi:[0,0,1]
    v_cvt_pk_bf16_f32 v133, v162, v163
    v_lshlrev_b32 v162, 16, v133
    v_and_b32 v163, s90, v133
    v_pk_add_f32 v[162:163], v[162:163], v[34:35]
    v_cvt_pk_bf16_f32 v133, v162, v163
    ds_write_b64 v68, v[132:133]
    v_lshlrev_b32 v36, 16, v98
    v_and_b32 v37, s90, v98
    v_pk_fma_f32 v[164:165], v[36:37], v[118:119], v[118:119] op_sel:[0,0,1] op_sel_hi:[1,0,1] neg_lo:[0,0,1] neg_hi:[0,0,1]
    v_cvt_pk_bf16_f32 v134, v164, v165
    v_lshlrev_b32 v164, 16, v134
    v_and_b32 v165, s90, v134
    v_pk_add_f32 v[164:165], v[164:165], v[36:37]
    v_cvt_pk_bf16_f32 v134, v164, v165
    v_lshlrev_b32 v38, 16, v99
    v_and_b32 v39, s90, v99
    v_pk_fma_f32 v[166:167], v[38:39], v[118:119], v[118:119] op_sel:[0,0,1] op_sel_hi:[1,0,1] neg_lo:[0,0,1] neg_hi:[0,0,1]
    v_cvt_pk_bf16_f32 v135, v166, v167
    v_lshlrev_b32 v166, 16, v135
    v_and_b32 v167, s90, v135
    v_pk_add_f32 v[166:167], v[166:167], v[38:39]
    v_cvt_pk_bf16_f32 v135, v166, v167
    ds_write_b64 v69, v[134:135]
    v_lshlrev_b32 v40, 16, v100
    v_and_b32 v41, s90, v100
    v_pk_fma_f32 v[168:169], v[40:41], v[118:119], v[118:119] op_sel:[0,0,1] op_sel_hi:[1,0,1] neg_lo:[0,0,1] neg_hi:[0,0,1]
    v_cvt_pk_bf16_f32 v136, v168, v169
    v_lshlrev_b32 v168, 16, v136
    v_and_b32 v169, s90, v136
    v_pk_add_f32 v[168:169], v[168:169], v[40:41]
    v_cvt_pk_bf16_f32 v136, v168, v169
    v_lshlrev_b32 v42, 16, v101
    v_and_b32 v43, s90, v101
    v_pk_fma_f32 v[170:171], v[42:43], v[118:119], v[118:119] op_sel:[0,0,1] op_sel_hi:[1,0,1] neg_lo:[0,0,1] neg_hi:[0,0,1]
    v_cvt_pk_bf16_f32 v137, v170, v171
    v_lshlrev_b32 v170, 16, v137
    v_and_b32 v171, s90, v137
    v_pk_add_f32 v[170:171], v[170:171], v[42:43]
    v_cvt_pk_bf16_f32 v137, v170, v171
    ds_write_b64 v70, v[136:137]
    v_lshlrev_b32 v44, 16, v102
    v_and_b32 v45, s90, v102
    v_pk_fma_f32 v[172:173], v[44:45], v[118:119], v[118:119] op_sel:[0,0,1] op_sel_hi:[1,0,1] neg_lo:[0,0,1] neg_hi:[0,0,1]
    v_cvt_pk_bf16_f32 v138, v172, v173
    v_lshlrev_b32 v172, 16, v138
    v_and_b32 v173, s90, v138
    v_pk_add_f32 v[172:173], v[172:173], v[44:45]
    v_cvt_pk_bf16_f32 v138, v172, v173
    v_lshlrev_b32 v46, 16, v103
    v_and_b32 v47, s90, v103
    v_pk_fma_f32 v[174:175], v[46:47], v[118:119], v[118:119] op_sel:[0,0,1] op_sel_hi:[1,0,1] neg_lo:[0,0,1] neg_hi:[0,0,1]
    v_cvt_pk_bf16_f32 v139, v174, v175
    v_lshlrev_b32 v174, 16, v139
    v_and_b32 v175, s90, v139
    v_pk_add_f32 v[174:175], v[174:175], v[46:47]
    v_cvt_pk_bf16_f32 v139, v174, v175
    ds_write_b64 v71, v[138:139]
    s_sub_u32 s77, s91, s82
    v_lshrrev_b32 v7, 3, v1
    v_sub_u32_e64 v5, s77, v7
    v_mov_b32 v6, 2146435072
    v_and_b32 v8, 7, v1
    v_lshrrev_b32 v9, 4, v1
    v_xor_b32 v8, v8, v9
    v_lshlrev_b32 v8, 4, v8
    v_lshl_add_u32 v7, v7, 11, v8
    v_xor_b32 v8, 64, v7
    s_lshl_b32 s58, s82, 11
    s_lshl_b32 s59, s98, 7
    s_add_u32 s58, s58, s59
    v_cmp_eq_u32 vcc, 0, v5
    s_nop 1
    v_cndmask_b32 v200, v7, v6, vcc
    v_cmp_eq_u32 vcc, 8, v5
    s_nop 1
    v_cndmask_b32 v201, v8, v6, vcc
    v_cmp_eq_u32 vcc, 16, v5
    s_nop 1
    v_cndmask_b32 v202, v7, v6, vcc
    v_cmp_eq_u32 vcc, 24, v5
    s_nop 1
    v_cndmask_b32 v203, v8, v6, vcc
    s_lshl_b32 s77, s62, 12
    s_add_u32 s77, s77, 0
    v_add_u32 v4, s77, v12
    s_waitcnt lgkmcnt(0)
    ds_read_b128 v[48:51], v4 offset:0
    ds_read_b128 v[52:55], v4 offset:1024
    ds_read_b128 v[56:59], v4 offset:2048
    ds_read_b128 v[60:63], v4 offset:3072
    s_waitcnt lgkmcnt(3)
    buffer_store_dwordx4 v[48:51], v200, s[44:47], s58 offen sc1
    s_add_u32 s58, s58, 16384
    s_waitcnt lgkmcnt(2)
    buffer_store_dwordx4 v[52:55], v201, s[44:47], s58 offen sc1
    s_add_u32 s58, s58, 16384
    s_waitcnt lgkmcnt(1)
    buffer_store_dwordx4 v[56:59], v202, s[44:47], s58 offen sc1
    s_add_u32 s58, s58, 16384
    s_waitcnt lgkmcnt(0)
    buffer_store_dwordx4 v[60:63], v203, s[44:47], s58 offen sc1
    s_barrier
    s_barrier
    s_branch L_cdone
L_stay_84:
    v_and_b32 v7, 15, v1
    v_lshlrev_b32_e64 v7, 3, v7
    s_cmp_eq_u32 s62, 0
    s_cbranch_scc0 L_nos4_85
    s_mul_i32 s76, s98, 9344
    s_add_u32 s76, s76, 8388608
    s_add_u32 s20, s26, s99
    s_addc_u32 s21, s27, 0
    s_mov_b32 s88, 0
L_spin_86:
    s_load_dwordx16 s[4:19], s[20:21], 768 glc
    s_waitcnt lgkmcnt(0)
    s_or_b64 s[4:5], s[4:5], s[6:7]
    s_or_b64 s[4:5], s[4:5], s[8:9]
    s_or_b64 s[4:5], s[4:5], s[10:11]
    s_or_b64 s[4:5], s[4:5], s[12:13]
    s_or_b64 s[4:5], s[4:5], s[14:15]
    s_or_b64 s[4:5], s[4:5], s[16:17]
    s_or_b64 s[4:5], s[4:5], s[18:19]
    s_cbranch_scc0 L_gate_87
    s_add_u32 s88, s88, 1
    s_cmp_lt_u32 s88, 65536
    s_cbranch_scc1 L_spin_86
L_gate_87:
    s_mov_b32 s88, 0
L_poll_88:
    buffer_load_dwordx2 v[196:197], v179, s[40:43], s76 offen offset:256 sc1
    buffer_load_dwordx4 v[188:191], v180, s[40:43], s76 offen offset:0 sc1
    buffer_load_dwordx4 v[192:195], v180, s[40:43], s76 offen offset:64 sc1
    s_waitcnt vmcnt(0)
    v_max3_u32 v4, v196, v197, v188
    v_max3_u32 v4, v4, v189, v190
    v_max3_u32 v4, v4, v191, v192
    v_max3_u32 v4, v4, v193, v194
    v_max_u32 v4, v4, v195
    v_cmp_eq_u32_e64 vcc, -1, v4
    s_nop 0
    s_cbranch_vccz L_ok_89
    s_add_u32 s88, s88, 1
    s_cmp_lt_u32 s88, 65536
    s_cbranch_scc1 L_poll_88
L_ok_89:
    ds_write_b128 v12, v[188:191] offset:28672
    ds_write_b128 v12, v[192:195] offset:29696
    ds_write_b64 v7, v[196:197] offset:25728
L_nos4_85:
    s_waitcnt lgkmcnt(0)
    s_barrier
    ds_read_b64 v[8:9], v7 offset:25728
    s_waitcnt lgkmcnt(0)
    v_max_f32_dpp v4, v8, v8 row_ror:8 row_mask:0xf bank_mask:0xf
    s_nop 1
    v_max_f32_dpp v4, v4, v4 row_ror:4 row_mask:0xf bank_mask:0xf
    s_nop 1
    v_max_f32_dpp v4, v4, v4 row_ror:2 row_mask:0xf bank_mask:0xf
    s_nop 1
    v_max_f32_dpp v4, v4, v4 row_ror:1 row_mask:0xf bank_mask:0xf
    v_cmp_eq_f32 vcc, v4, v8
    s_nop 0
    s_ff1_i32_b32 s92, vcc_lo
    s_and_b32 s92, s92, 15
    s_nop 3
    v_readlane_b32 s91, v9, s92
    s_nop 0
    s_cmp_eq_u32 s91, s79
    s_cbranch_scc0 L_noh_90
    s_mov_b32 exec_hi, 0
    buffer_store_dword v182, v177, s[40:43], s99 offen offset:128 sc1
    s_mov_b64 exec, -1
L_noh_90:
    s_sub_u32 s77, s91, s82
    v_lshrrev_b32 v7, 3, v1
    v_sub_u32 v5, s77, v7
    v_mov_b32 v6, 2146435072
    v_and_b32 v8, 7, v1
    v_lshrrev_b32 v9, 4, v1
    v_xor_b32 v8, v8, v9
    v_lshlrev_b32 v8, 4, v8
    v_lshl_add_u32 v7, v7, 11, v8
    v_xor_b32 v8, 64, v7
    s_lshl_b32 s58, s82, 11
    s_lshl_b32 s59, s98, 7
    s_add_u32 s58, s58, s59
    v_cmp_eq_u32 vcc, 0, v5
    s_nop 1
    v_cndmask_b32 v200, v7, v6, vcc
    v_cmp_eq_u32 vcc, 8, v5
    s_nop 1
    v_cndmask_b32 v201, v8, v6, vcc
    v_cmp_eq_u32 vcc, 16, v5
    s_nop 1
    v_cndmask_b32 v202, v7, v6, vcc
    v_cmp_eq_u32 vcc, 24, v5
    s_nop 1
    v_cndmask_b32 v203, v8, v6, vcc
    s_lshl_b32 s77, s62, 12
    s_add_u32 s77, s77, 0
    v_add_u32 v4, s77, v12
    v_lshlrev_b32 v24, 16, v92
    v_and_b32_e64 v25, s90, v92
    v_pk_fma_f32 v[152:153], v[24:25], v[118:119], v[118:119] op_sel:[0,0,1] op_sel_hi:[1,0,1] neg_lo:[0,0,1] neg_hi:[0,0,1]
    v_cvt_pk_bf16_f32 v128, v152, v153
    v_lshlrev_b32 v152, 16, v128
    v_and_b32 v153, s90, v128
    v_pk_add_f32 v[152:153], v[152:153], v[24:25]
    v_cvt_pk_bf16_f32 v128, v152, v153
    v_lshlrev_b32 v26, 16, v93
    v_and_b32 v27, s90, v93
    v_pk_fma_f32 v[154:155], v[26:27], v[118:119], v[118:119] op_sel:[0,0,1] op_sel_hi:[1,0,1] neg_lo:[0,0,1] neg_hi:[0,0,1]
    v_cvt_pk_bf16_f32 v129, v154, v155
    v_lshlrev_b32 v154, 16, v129
    v_and_b32 v155, s90, v129
    v_pk_add_f32 v[154:155], v[154:155], v[26:27]
    v_cvt_pk_bf16_f32 v129, v154, v155
    ds_write_b64 v66, v[128:129]
    v_lshlrev_b32 v28, 16, v94
    v_and_b32 v29, s90, v94
    v_pk_fma_f32 v[156:157], v[28:29], v[118:119], v[118:119] op_sel:[0,0,1] op_sel_hi:[1,0,1] neg_lo:[0,0,1] neg_hi:[0,0,1]
    v_cvt_pk_bf16_f32 v130, v156, v157
    v_lshlrev_b32 v156, 16, v130
    v_and_b32 v157, s90, v130
    v_pk_add_f32 v[156:157], v[156:157], v[28:29]
    v_cvt_pk_bf16_f32 v130, v156, v157
    v_lshlrev_b32 v30, 16, v95
    v_and_b32 v31, s90, v95
    v_pk_fma_f32 v[158:159], v[30:31], v[118:119], v[118:119] op_sel:[0,0,1] op_sel_hi:[1,0,1] neg_lo:[0,0,1] neg_hi:[0,0,1]
    v_cvt_pk_bf16_f32 v131, v158, v159
    v_lshlrev_b32 v158, 16, v131
    v_and_b32 v159, s90, v131
    v_pk_add_f32 v[158:159], v[158:159], v[30:31]
    v_cvt_pk_bf16_f32 v131, v158, v159
    ds_write_b64 v67, v[130:131]
    v_lshlrev_b32 v32, 16, v96
    v_and_b32 v33, s90, v96
    v_pk_fma_f32 v[160:161], v[32:33], v[118:119], v[118:119] op_sel:[0,0,1] op_sel_hi:[1,0,1] neg_lo:[0,0,1] neg_hi:[0,0,1]
    v_cvt_pk_bf16_f32 v132, v160, v161
    v_lshlrev_b32 v160, 16, v132
    v_and_b32 v161, s90, v132
    v_pk_add_f32 v[160:161], v[160:161], v[32:33]
    v_cvt_pk_bf16_f32 v132, v160, v161
    v_lshlrev_b32 v34, 16, v97
    v_and_b32 v35, s90, v97
    v_pk_fma_f32 v[162:163], v[34:35], v[118:119], v[118:119] op_sel:[0,0,1] op_sel_hi:[1,0,1] neg_lo:[0,0,1] neg_hi:[0,0,1]
    v_cvt_pk_bf16_f32 v133, v162, v163
    v_lshlrev_b32 v162, 16, v133
    v_and_b32 v163, s90, v133
    v_pk_add_f32 v[162:163], v[162:163], v[34:35]
    v_cvt_pk_bf16_f32 v133, v162, v163
    ds_write_b64 v68, v[132:133]
    v_lshlrev_b32 v36, 16, v98
    v_and_b32 v37, s90, v98
    v_pk_fma_f32 v[164:165], v[36:37], v[118:119], v[118:119] op_sel:[0,0,1] op_sel_hi:[1,0,1] neg_lo:[0,0,1] neg_hi:[0,0,1]
    v_cvt_pk_bf16_f32 v134, v164, v165
    v_lshlrev_b32 v164, 16, v134
    v_and_b32 v165, s90, v134
    v_pk_add_f32 v[164:165], v[164:165], v[36:37]
    v_cvt_pk_bf16_f32 v134, v164, v165
    v_lshlrev_b32 v38, 16, v99
    v_and_b32 v39, s90, v99
    v_pk_fma_f32 v[166:167], v[38:39], v[118:119], v[118:119] op_sel:[0,0,1] op_sel_hi:[1,0,1] neg_lo:[0,0,1] neg_hi:[0,0,1]
    v_cvt_pk_bf16_f32 v135, v166, v167
    v_lshlrev_b32 v166, 16, v135
    v_and_b32 v167, s90, v135
    v_pk_add_f32 v[166:167], v[166:167], v[38:39]
    v_cvt_pk_bf16_f32 v135, v166, v167
    ds_write_b64 v69, v[134:135]
    v_lshlrev_b32 v40, 16, v100
    v_and_b32 v41, s90, v100
    v_pk_fma_f32 v[168:169], v[40:41], v[118:119], v[118:119] op_sel:[0,0,1] op_sel_hi:[1,0,1] neg_lo:[0,0,1] neg_hi:[0,0,1]
    v_cvt_pk_bf16_f32 v136, v168, v169
    v_lshlrev_b32 v168, 16, v136
    v_and_b32 v169, s90, v136
    v_pk_add_f32 v[168:169], v[168:169], v[40:41]
    v_cvt_pk_bf16_f32 v136, v168, v169
    v_lshlrev_b32 v42, 16, v101
    v_and_b32 v43, s90, v101
    v_pk_fma_f32 v[170:171], v[42:43], v[118:119], v[118:119] op_sel:[0,0,1] op_sel_hi:[1,0,1] neg_lo:[0,0,1] neg_hi:[0,0,1]
    v_cvt_pk_bf16_f32 v137, v170, v171
    v_lshlrev_b32 v170, 16, v137
    v_and_b32 v171, s90, v137
    v_pk_add_f32 v[170:171], v[170:171], v[42:43]
    v_cvt_pk_bf16_f32 v137, v170, v171
    ds_write_b64 v70, v[136:137]
    v_lshlrev_b32 v44, 16, v102
    v_and_b32 v45, s90, v102
    v_pk_fma_f32 v[172:173], v[44:45], v[118:119], v[118:119] op_sel:[0,0,1] op_sel_hi:[1,0,1] neg_lo:[0,0,1] neg_hi:[0,0,1]
    v_cvt_pk_bf16_f32 v138, v172, v173
    v_lshlrev_b32 v172, 16, v138
    v_and_b32 v173, s90, v138
    v_pk_add_f32 v[172:173], v[172:173], v[44:45]
    v_cvt_pk_bf16_f32 v138, v172, v173
    v_lshlrev_b32 v46, 16, v103
    v_and_b32 v47, s90, v103
    v_pk_fma_f32 v[174:175], v[46:47], v[118:119], v[118:119] op_sel:[0,0,1] op_sel_hi:[1,0,1] neg_lo:[0,0,1] neg_hi:[0,0,1]
    v_cvt_pk_bf16_f32 v139, v174, v175
    v_lshlrev_b32 v174, 16, v139
    v_and_b32 v175, s90, v139
    v_pk_add_f32 v[174:175], v[174:175], v[46:47]
    v_cvt_pk_bf16_f32 v139, v174, v175
    ds_write_b64 v71, v[138:139]
    s_barrier
    s_waitcnt lgkmcnt(0)
    ds_read_b128 v[48:51], v4 offset:0
    ds_read_b128 v[52:55], v4 offset:1024
    ds_read_b128 v[56:59], v4 offset:2048
    ds_read_b128 v[60:63], v4 offset:3072
    s_waitcnt lgkmcnt(3)
    buffer_store_dwordx4 v[48:51], v200, s[44:47], s58 offen sc1
    s_add_u32 s58, s58, 16384
    s_waitcnt lgkmcnt(2)
    buffer_store_dwordx4 v[52:55], v201, s[44:47], s58 offen sc1
    s_add_u32 s58, s58, 16384
    s_waitcnt lgkmcnt(1)
    buffer_store_dwordx4 v[56:59], v202, s[44:47], s58 offen sc1
    s_add_u32 s58, s58, 16384
    s_waitcnt lgkmcnt(0)
    buffer_store_dwordx4 v[60:63], v203, s[44:47], s58 offen sc1
L_cdone:
L_cfin:
L_end:
    s_endpgm
L_tr0:
    s_mov_b32 s88, 0
L_trq:
    ds_read_b32 v79, v8 offset:25984
    s_waitcnt lgkmcnt(0)
    v_readfirstlane_b32 s76, v79
    s_nop 0
    s_and_b32 s76, s76, s52
    s_cbranch_scc1 L_bk0
    s_add_u32 s88, s88, 1
    s_cmp_lt_u32 s88, 5
    s_cbranch_scc1 L_trq
    s_cmp_eq_u32 s53, 0
    s_cbranch_scc0 L_sent_68
    s_waitcnt vmcnt(0)
    s_mov_b64 exec, 1
    ds_add_u32 v8, v74 offset:25988
    s_mov_b64 exec, -1
    s_mov_b32 s53, 1
L_sent_68:
    s_call_b64 s[54:55], L_stall
    s_branch L_bk0
L_tr1:
    s_cmp_eq_u32 s53, 0
    s_cbranch_scc0 L_sent_69
    s_waitcnt vmcnt(4)
    s_mov_b64 exec, 1
    ds_add_u32 v8, v74 offset:25988
    s_mov_b64 exec, -1
    s_mov_b32 s53, 1
L_sent_69:
    s_call_b64 s[54:55], L_stall
    s_branch L_bk1
L_tr2:
    s_call_b64 s[54:55], L_stall
    s_branch L_bk2
L_tr3:
    s_call_b64 s[54:55], L_stall
    s_branch L_bk3
L_tr4:
    s_call_b64 s[54:55], L_stall
    s_branch L_bk4
L_tr5:
    s_call_b64 s[54:55], L_stall
    s_branch L_bk5
L_tr6:
    s_call_b64 s[54:55], L_stall
    s_branch L_bk6
L_tr7:
    s_call_b64 s[54:55], L_stall
    s_branch L_bk7
L_tr8:
    s_call_b64 s[54:55], L_stall
    s_branch L_bk8
L_tr9:
    s_call_b64 s[54:55], L_stall
    s_branch L_bk9
L_tr10:
    s_call_b64 s[54:55], L_stall
    s_branch L_bk10
L_tr11:
    s_call_b64 s[54:55], L_stall
    s_branch L_bk11
L_tr12:
    s_call_b64 s[54:55], L_stall
    s_branch L_bk12
L_tr13:
    s_call_b64 s[54:55], L_stall
    s_branch L_bk13
L_tr14:
    s_call_b64 s[54:55], L_stall
    s_branch L_bk14
L_tr15:
    s_call_b64 s[54:55], L_stall
    s_branch L_bk15
L_stall:
    s_cmp_eq_u32 s53, 0
    s_cbranch_scc0 L_sent_67
    s_waitcnt vmcnt(0)
    s_mov_b64 exec, 1
    ds_add_u32 v8, v74 offset:25988
    s_mov_b64 exec, -1
    s_mov_b32 s53, 1
L_sent_67:
    s_mov_b32 s88, 0
L_stall1:
    ds_read_b32 v79, v8 offset:25984
    s_waitcnt lgkmcnt(0)
    v_readfirstlane_b32 s76, v79
    s_nop 0
    s_and_b32 s76, s76, s52
    s_cbranch_scc1 L_stall2
    s_add_u32 s88, s88, 1
    s_cmp_lt_u32 s88, 1048576
    s_cbranch_scc1 L_stall1
    s_mov_b32 s76, s52
L_stall2:
    s_setpc_b64 s[54:55]
L_s3_73:
    v_cmp_eq_u32_e64 vcc, -1, v115
    s_nop 0
    s_cbranch_vccz L_s3skip_75
    buffer_load_dwordx4 v[112:115], v178, s[40:43], s78 offen offset:1024 sc1
L_s3skip_75:
    v_cmp_eq_u32_e64 vcc, -1, v119
    s_nop 0
    s_cbranch_vccz L_s3skip_76
    buffer_load_dwordx4 v[116:119], v178, s[40:43], s48 offen offset:1024 sc1
L_s3skip_76:
    v_cmp_eq_u32_e64 vcc, -1, v123
    s_nop 0
    s_cbranch_vccz L_s3skip_77
    buffer_load_dwordx4 v[120:123], v178, s[40:43], s49 offen offset:1024 sc1
L_s3skip_77:
    v_cmp_eq_u32_e64 vcc, -1, v127
    s_nop 0
    s_cbranch_vccz L_s3skip_78
    buffer_load_dwordx4 v[124:127], v178, s[40:43], s50 offen offset:1024 sc1
L_s3skip_78:
    v_cmp_eq_u32_e64 vcc, -1, v131
    s_nop 0
    s_cbranch_vccz L_s3skip_79
    buffer_load_dwordx4 v[128:131], v178, s[40:43], s51 offen offset:1024 sc1
L_s3skip_79:
    v_cmp_eq_u32_e64 vcc, -1, v135
    s_nop 0
    s_cbranch_vccz L_s3skip_80
    buffer_load_dwordx4 v[132:135], v178, s[40:43], s52 offen offset:1024 sc1
L_s3skip_80:
    v_cmp_eq_u32_e64 vcc, -1, v139
    s_nop 0
    s_cbranch_vccz L_s3skip_81
    buffer_load_dwordx4 v[136:139], v178, s[40:43], s53 offen offset:1024 sc1
L_s3skip_81:
    v_cmp_eq_u32_e64 vcc, -1, v143
    s_nop 0
    s_cbranch_vccz L_s3skip_82
    buffer_load_dwordx4 v[140:143], v178, s[40:43], s54 offen offset:1024 sc1
L_s3skip_82:
    s_waitcnt vmcnt(0)
    v_pk_add_f32 v[108:109], v[112:113], v[116:117]
    v_pk_add_f32 v[110:111], v[114:115], v[118:119]
    v_pk_add_f32 v[108:109], v[108:109], v[120:121]
    v_pk_add_f32 v[110:111], v[110:111], v[122:123]
    v_pk_add_f32 v[108:109], v[108:109], v[124:125]
    v_pk_add_f32 v[110:111], v[110:111], v[126:127]
    v_pk_add_f32 v[108:109], v[108:109], v[128:129]
    v_pk_add_f32 v[110:111], v[110:111], v[130:131]
    v_pk_add_f32 v[108:109], v[108:109], v[132:133]
    v_pk_add_f32 v[110:111], v[110:111], v[134:135]
    v_pk_add_f32 v[108:109], v[108:109], v[136:137]
    v_pk_add_f32 v[110:111], v[110:111], v[138:139]
    v_pk_add_f32 v[108:109], v[108:109], v[140:141]
    v_pk_add_f32 v[110:111], v[110:111], v[142:143]
    v_cmp_u_f32 vcc, v111, v111
    v_mov_b32 v4, v108
    v_mov_b32 v5, v109
    v_mov_b32_e64 v6, v110
    s_cbranch_vccz L_s3ok_74
    s_add_u32 s88, s88, 1
    s_cmp_lt_u32 s88, 65536
    s_cbranch_scc1 L_s3_73
    s_branch L_s3ok_74
L_code_end:
s_endpgm
.p2align 7
.type L_table,@object
L_table:
.long 0x650c3824, 0xfedba97, 0x50110, 0x3006
.long 0x650c3824, 0xfedba97, 0x520200, 0x3060
.long 0x641d0935, 0xfecba87, 0x5000011, 0x3600
.long 0x76543218, 0xfedcba9, 0x15000010, 0x6300
.long 0x641d0935, 0xfecba87, 0x25200, 0x3006
.long 0x54e2a160, 0xfdcb987, 0x501001, 0x3060
.long 0x54e2a160, 0xfdcb987, 0x5000022, 0x3600
.long 0x54f3b271, 0xedca986, 0x50101000, 0x6300
.long 0x54f3b271, 0xedca986, 0x250020, 0x3006
.long 0x650c3824, 0xfedba97, 0x510001, 0x3060
.long 0x650c3824, 0xfedba97, 0x5000202, 0x3600
.long 0x76543218, 0xfedcba9, 0x50000202, 0x6300
.long 0x641d0935, 0xfecba87, 0x15100, 0x3006
.long 0x641d0935, 0xfecba87, 0x500022, 0x3060
.long 0x54e2a160, 0xfdcb987, 0x5100010, 0x3600
.long 0x54e2a160, 0xfdcb987, 0x50202000, 0x6300
.long 0x641d0935, 0xfecba87, 0x500011, 0x3060
.long 0x641d0935, 0xfecba87, 0x5020020, 0x3600
.long 0x54e2a160, 0xfdcb987, 0x50001010, 0x6300
.long 0x76543209, 0xfedcba8, 0x15010, 0x3006
.long 0x54e2a160, 0xfdcb987, 0x500022, 0x3060
.long 0x54f3b271, 0xedca986, 0x5100001, 0x3600
.long 0x54f3b271, 0xedca986, 0x50002020, 0x6300
.long 0x650c3824, 0xfedba97, 0x15100, 0x3006
.long 0x650c3824, 0xfedba97, 0x520020, 0x3060
.long 0x641d0935, 0xfecba87, 0x5010100, 0x3600
.long 0x641d0935, 0xfecba87, 0x50020200, 0x6300
.long 0x76543209, 0xfedcba8, 0x250002, 0x3006
.long 0x54e2a160, 0xfdcb987, 0x5110000, 0x3060
.long 0x54e2a160, 0xfdcb987, 0x5200002, 0x3600
.long 0x54f3b271, 0xedca986, 0x50001010, 0x6300
.long 0x54f3b271, 0xedca986, 0x52020, 0x3006
.long 0x54e2a160, 0xfdcb987, 0x5100100, 0x3600
.long 0x54e2a160, 0xfdcb987, 0x50002002, 0x6300
.long 0x54f3b271, 0xedca986, 0x150010, 0x3006
.long 0x765431a0, 0xfedcb98, 0x150001, 0x3060
.long 0x54f3b271, 0xedca986, 0x5000022, 0x3600
.long 0x650c3824, 0xfedba97, 0x50000101, 0x6300
.long 0x650c3824, 0xfedba97, 0x50220, 0x3006
.long 0x641d0935, 0xfecba87, 0x510100, 0x3060
.long 0x641d0935, 0xfecba87, 0x5000022, 0x3600
.long 0x54e2a160, 0xfdcb987, 0x50001010, 0x6300
.long 0x54e2a160, 0xfdcb987, 0x250002, 0x3006
.long 0x765431a0, 0xfedcb98, 0x500220, 0x3060
.long 0x54f3b271, 0xedca986, 0x5001100, 0x3600
.long 0x54f3b271, 0xedca986, 0x50000022, 0x6300
.long 0x650c3824, 0xfedba97, 0x511000, 0x3006
.long 0x650c3824, 0xfedba97, 0x520002, 0x3060
.long 0x54f3b271, 0xedca986, 0x50100001, 0x6300
.long 0x54f3b271, 0xedca986, 0x52002, 0x3006
.long 0x650c3824, 0xfedba97, 0x500101, 0x3060
.long 0x765421b0, 0xfedca98, 0x1500001, 0x3600
.long 0x650c3824, 0xfedba97, 0x50000022, 0x6300
.long 0x641d0935, 0xfecba87, 0x15100, 0x3006
.long 0x641d0935, 0xfecba87, 0x520020, 0x3060
.long 0x54e2a160, 0xfdcb987, 0x5101000, 0x3600
.long 0x54e2a160, 0xfdcb987, 0x50002020, 0x6300
.long 0x54f3b271, 0xedca986, 0x51010, 0x3006
.long 0x54f3b271, 0xedca986, 0x250020, 0x3060
.long 0x765421b0, 0xfedca98, 0x5000022, 0x3600
.long 0x650c3824, 0xfedba97, 0x50010010, 0x6300
.long 0x650c3824, 0xfedba97, 0x25200, 0x3006
.long 0x641d0935, 0xfecba87, 0x500011, 0x3060
.long 0x641d0935, 0xfecba87, 0x5020200, 0x3600
.long 0x650c3824, 0xfedba97, 0x51010, 0x3006
.long 0x650c3824, 0xfedba97, 0x500022, 0x3060
.long 0x641d0935, 0xfecba87, 0x5100100, 0x3600
.long 0x76532c10, 0xfedba98, 0x15000100, 0x6300
.long 0x641d0935, 0xfecba87, 0x50022, 0x3006
.long 0x54e2a160, 0xfdcb987, 0x150010, 0x3060
.long 0x54e2a160, 0xfdcb987, 0x5202000, 0x3600
.long 0x54f3b271, 0xedca986, 0x50101000, 0x6300
.long 0x54f3b271, 0xedca986, 0x52002, 0x3006
.long 0x650c3824, 0xfedba97, 0x500101, 0x3060
.long 0x650c3824, 0xfedba97, 0x5020020, 0x3600
.long 0x76532c10, 0xfedba98, 0x52000200, 0x6300
.long 0x641d0935, 0xfecba87, 0x15001, 0x3006
.long 0x641d0935, 0xfecba87, 0x520200, 0x3060
.long 0x54e2a160, 0xfdcb987, 0x5001001, 0x3600
.long 0x54e2a160, 0xfdcb987, 0x50000022, 0x6300
.long 0x641d0935, 0xfecba87, 0x501001, 0x3060
.long 0x641d0935, 0xfecba87, 0x5000202, 0x3600
.long 0x54e2a160, 0xfdcb987, 0x50100100, 0x6300
.long 0x76432d10, 0xfecba98, 0x150100, 0x3006
.long 0x54e2a160, 0xfdcb987, 0x252000, 0x3060
.long 0x54f3b271, 0xedca986, 0x5101000, 0x3600
.long 0x54f3b271, 0xedca986, 0x50200002, 0x6300
.long 0x650c3824, 0xfedba97, 0x15100, 0x3006
.long 0x650c3824, 0xfedba97, 0x500202, 0x3060
.long 0x641d0935, 0xfecba87, 0x5000110, 0x3600
.long 0x641d0935, 0xfecba87, 0x50000022, 0x6300
.long 0x76432d10, 0xfecba98, 0x20050200, 0x3006
.long 0x54e2a160, 0xfdcb987, 0x501010, 0x3060
.long 0x54e2a160, 0xfdcb987, 0x5002020, 0x3600
.long 0x54f3b271, 0xedca986, 0x50000110, 0x6300
.long 0x54f3b271, 0xedca986, 0x250002, 0x3006
.long 0x54e2a160, 0xfdcb987, 0x5000011, 0x3600
.long 0x54e2a160, 0xfdcb987, 0x50200020, 0x6300
.long 0x54f3b271, 0xedca986, 0x115000, 0x3006
.long 0x7543e210, 0xfdcba98, 0x501010, 0x3060
.long 0x54f3b271, 0xedca986, 0x5202000, 0x3600
.long 0x650c3824, 0xfedba97, 0x51000001, 0x6300
.long 0x650c3824, 0xfedba97, 0x25002, 0x3006
.long 0x641d0935, 0xfecba87, 0x510100, 0x3060
.long 0x641d0935, 0xfecba87, 0x5020200, 0x3600
.long 0x54e2a160, 0xfdcb987, 0x50011000, 0x6300
.long 0x54e2a160, 0xfdcb987, 0x52020, 0x3006
.long 0x7543e210, 0xfdcba98, 0x522000, 0x3060
.long 0x54f3b271, 0xedca986, 0x5001010, 0x3600
.long 0x54f3b271, 0xedca986, 0x50202000, 0x6300
.long 0x650c3824, 0xfedba97, 0x15100, 0x3006
.long 0x650c3824, 0xfedba97, 0x500220, 0x3060
.long 0x54f3b271, 0xedca986, 0x50001010, 0x6300
.long 0x54f3b271, 0xedca986, 0x250020, 0x3006
.long 0x650c3824, 0xfedba97, 0x500110, 0x3060
.long 0x6543f210, 0xedcba98, 0x15000001, 0x3600
.long 0x650c3824, 0xfedba97, 0x50020200, 0x6300
.long 0x641d0935, 0xfecba87, 0x15001, 0x3006
.long 0x641d0935, 0xfecba87, 0x500202, 0x3060
.long 0x54e2a160, 0xfdcb987, 0x5101000, 0x3600
.long 0x54e2a160, 0xfdcb987, 0x50200002, 0x6300
.long 0x54f3b271, 0xedca986, 0x150001, 0x3006
.long 0x54f3b271, 0xedca986, 0x502002, 0x3060
.long 0x6543f210, 0xedcba98, 0x5202000, 0x3600
.long 0x650c3824, 0xfedba97, 0x50010001, 0x6300
.long 0x650c3824, 0xfedba97, 0x50022, 0x3006
.long 0x641d0935, 0xfecba87, 0x500110, 0x3060
.long 0x641d0935, 0xfecba87, 0x5000022, 0x3600
.long 0x650c3824, 0xfedba97, 0x25002, 0x3006
.long 0x650c3824, 0xfedba97, 0x510010, 0x3060
.long 0x641d0935, 0xfecba87, 0x5020200, 0x3600
.long 0x76543218, 0xfedcba9, 0x50000022, 0x6300
.long 0x641d0935, 0xfecba87, 0x50110, 0x3006
.long 0x54e2a160, 0xfdcb987, 0x250002, 0x3060
.long 0x54e2a160, 0xfdcb987, 0x5101000, 0x3600
.long 0x54f3b271, 0xedca986, 0x50002002, 0x6300
.long 0x54f3b271, 0xedca986, 0x151000, 0x3006
.long 0x650c3824, 0xfedba97, 0x520020, 0x3060
.long 0x650c3824, 0xfedba97, 0x5000101, 0x3600
.long 0x76543218, 0xfedcba9, 0x15000010, 0x6300
.long 0x641d0935, 0xfecba87, 0x25200, 0x3006
.long 0x641d0935, 0xfecba87, 0x510001, 0x3060
.long 0x54e2a160, 0xfdcb987, 0x5000022, 0x3600
.long 0x54e2a160, 0xfdcb987, 0x50000011, 0x6300
.long 0x641d0935, 0xfecba87, 0x500022, 0x3060
.long 0x641d0935, 0xfecba87, 0x5000011, 0x3600
.long 0x54e2a160, 0xfdcb987, 0x50000022, 0x6300
.long 0x76543209, 0xfedcba8, 0x52002, 0x3006
.long 0x54e2a160, 0xfdcb987, 0x501010, 0x3060
.long 0x54f3b271, 0xedca986, 0x5002020, 0x3600
.long 0x54f3b271, 0xedca986, 0x50000011, 0x6300
.long 0x650c3824, 0xfedba97, 0x25020, 0x3006
.long 0x650c3824, 0xfedba97, 0x510100, 0x3060
.long 0x641d0935, 0xfecba87, 0x5000220, 0x3600
.long 0x641d0935, 0xfecba87, 0x50010100, 0x6300
.long 0x76543209, 0xfedcba8, 0x15100, 0x3006
.long 0x54e2a160, 0xfdcb987, 0x252000, 0x3060
.long 0x54e2a160, 0xfdcb987, 0x5100001, 0x3600
.long 0x54f3b271, 0xedca986, 0x50200020, 0x6300
.long 0x54f3b271, 0xedca986, 0x151000, 0x3006
.long 0x54e2a160, 0xfdcb987, 0x5200002, 0x3600
.long 0x54e2a160, 0xfdcb987, 0x50100100, 0x6300
.long 0x54f3b271, 0xedca986, 0x250002, 0x3006
.long 0x765431a0, 0xfedcb98, 0x520020, 0x3060
.long 0x54f3b271, 0xedca986, 0x5001010, 0x3600
.long 0x650c3824, 0xfedba97, 0x50020200, 0x6300
.long 0x650c3824, 0xfedba97, 0x50101, 0x3006
.long 0x641d0935, 0xfecba87, 0x520200, 0x3060
.long 0x641d0935, 0xfecba87, 0x5010100, 0x3600
.long 0x54e2a160, 0xfdcb987, 0x50202000, 0x6300
.long 0x54e2a160, 0xfdcb987, 0x50011, 0x3006
.long 0x765431a0, 0xfedcb98, 0x150010, 0x3060
.long 0x54f3b271, 0xedca986, 0x5200020, 0x3600
.long 0x54f3b271, 0xedca986, 0x50100100, 0x6300
.long 0x650c3824, 0xfedba97, 0x25002, 0x3006
.long 0x650c3824, 0xfedba97, 0x511000, 0x3060
.long 0x54f3b271, 0xedca986, 0x50002002, 0x6300
.long 0x54f3b271, 0xedca986, 0x150010, 0x3006
.long 0x650c3824, 0xfedba97, 0x520200, 0x3060
.long 0x765421b0, 0xfedca98, 0x25000020, 0x3600
.long 0x650c3824, 0xfedba97, 0x50000101, 0x6300
.long 0x641d0935, 0xfecba87, 0x50022, 0x3006
.long 0x641d0935, 0xfecba87, 0x510001, 0x3060
.long 0x54e2a160, 0xfdcb987, 0x5200020, 0x3600
.long 0x54e2a160, 0xfdcb987, 0x50101000, 0x6300
.long 0x54f3b271, 0xedca986, 0x50022, 0x3006
.long 0x54f3b271, 0xedca986, 0x500101, 0x3060
.long 0x765421b0, 0xfedca98, 0x1500010, 0x3600
.long 0x650c3824, 0xfedba97, 0x50000022, 0x6300
.long 0x650c3824, 0xfedba97, 0x511000, 0x3006
.long 0x641d0935, 0xfecba87, 0x520200, 0x3060
.long 0x641d0935, 0xfecba87, 0x5001100, 0x3600
.long 0x650c3824, 0xfedba97, 0x50220, 0x3006
.long 0x650c3824, 0xfedba97, 0x500101, 0x3060
.long 0x641d0935, 0xfecba87, 0x5000022, 0x3600
.long 0x76532c10, 0xfedba98, 0x50000202, 0x6300
.long 0x641d0935, 0xfecba87, 0x50101, 0x3006
.long 0x54e2a160, 0xfdcb987, 0x502020, 0x3060
.long 0x54e2a160, 0xfdcb987, 0x5101000, 0x3600
.long 0x54f3b271, 0xedca986, 0x50200020, 0x6300
.long 0x54f3b271, 0xedca986, 0x151000, 0x3006
.long 0x650c3824, 0xfedba97, 0x500202, 0x3060
.long 0x650c3824, 0xfedba97, 0x5010010, 0x3600
.long 0x76532c10, 0xfedba98, 0x15000001, 0x6300
.long 0x641d0935, 0xfecba87, 0x50022, 0x3006
.long 0x641d0935, 0xfecba87, 0x510010, 0x3060
.long 0x54e2a160, 0xfdcb987, 0x5202000, 0x3600
.long 0x54e2a160, 0xfdcb987, 0x50000110, 0x6300
.long 0x641d0935, 0xfecba87, 0x520200, 0x3060
.long 0x641d0935, 0xfecba87, 0x5000110, 0x3600
.long 0x54e2a160, 0xfdcb987, 0x50202000, 0x6300
.long 0x76432d10, 0xfecba98, 0x52200, 0x3006
.long 0x54e2a160, 0xfdcb987, 0x151000, 0x3060
.long 0x54f3b271, 0xedca986, 0x5200002, 0x3600
.long 0x54f3b271, 0xedca986, 0x50100100, 0x6300
.long 0x650c3824, 0xfedba97, 0x50202, 0x3006
.long 0x650c3824, 0xfedba97, 0x510100, 0x3060
.long 0x641d0935, 0xfecba87, 0x5020002, 0x3600
.long 0x641d0935, 0xfecba87, 0x50010001, 0x6300
.long 0x76432d10, 0xfecba98, 0x150010, 0x3006
.long 0x54e2a160, 0xfdcb987, 0x500022, 0x3060
.long 0x54e2a160, 0xfdcb987, 0x5000011, 0x3600
.long 0x54f3b271, 0xedca986, 0x50002002, 0x6300
.long 0x54f3b271, 0xedca986, 0x51010, 0x3006
.long 0x54e2a160, 0xfdcb987, 0x5002020, 0x3600
.long 0x54e2a160, 0xfdcb987, 0x50101000, 0x6300
.long 0x54f3b271, 0xedca986, 0x52020, 0x3006
.long 0x7543e210, 0xfdcba98, 0x2502000, 0x3060
.long 0x54f3b271, 0xedca986, 0x5001010, 0x3600
.long 0x650c3824, 0xfedba97, 0x50000022, 0x6300
.long 0x650c3824, 0xfedba97, 0x15100, 0x3006
.long 0x641d0935, 0xfecba87, 0x500022, 0x3060
.long 0x641d0935, 0xfecba87, 0x5010100, 0x3600
.long 0x54e2a160, 0xfdcb987, 0x50000022, 0x6300
.long 0x54e2a160, 0xfdcb987, 0x50011, 0x3006
.long 0x7543e210, 0xfdcba98, 0x1500010, 0x3060
.long 0x54f3b271, 0xedca986, 0x5002002, 0x3600
.long 0x54f3b271, 0xedca986, 0x50110000, 0x6300
.long 0x650c3824, 0xfedba97, 0x50220, 0x3006
.long 0x650c3824, 0xfedba97, 0x500011, 0x3060
.long 0x54f3b271, 0xedca986, 0x50200020, 0x6300
.long 0x54f3b271, 0xedca986, 0x15010, 0x3006
.long 0x650c3824, 0xfedba97, 0x500022, 0x3060
.long 0x6543f210, 0xedcba98, 0x25002000, 0x3600
.long 0x650c3824, 0xfedba97, 0x50000101, 0x6300
.long 0x641d0935, 0xfecba87, 0x25200, 0x3006
.long 0x641d0935, 0xfecba87, 0x511000, 0x3060
.long 0x54e2a160, 0xfdcb987, 0x5002002, 0x3600
.long 0x54e2a160, 0xfdcb987, 0x50101000, 0x6300
.long 0x54f3b271, 0xedca986, 0x252000, 0x3006
.long 0x54f3b271, 0xedca986, 0x501001, 0x3060
.long 0x6543f210, 0xedcba98, 0x15001000, 0x3600
.long 0x650c3824, 0xfedba97, 0x50020200, 0x6300
.long 0x650c3824, 0xfedba97, 0x15010, 0x3006
.long 0x641d0935, 0xfecba87, 0x500022, 0x3060
.long 0x641d0935, 0xfecba87, 0x5000101, 0x3600
.fill 1, 4, 0
.size L_table, .-L_table
.section .rodata,"a"
.p2align 6
.amdhsa_kernel sequential_preLN__linear_kernel_hedgehog__moe_arch_mod__prompt_kernel
  .amdhsa_next_free_vgpr 256
  .amdhsa_next_free_sgpr 102
  .amdhsa_accum_offset 256
  .amdhsa_group_segment_fixed_size 0
  .amdhsa_kernarg_size 96
  .amdhsa_user_sgpr_count 2
  .amdhsa_user_sgpr_kernarg_segment_ptr 1
  .amdhsa_system_sgpr_workgroup_id_x 1
  .amdhsa_float_denorm_mode_32 3
.end_amdhsa_kernel
```

```asm
; @launch grid=(256,1,1) block=(512,1,1) lds=163840
.amdgcn_target "amdgcn-amd-amdhsa--gfx950"
.text
.p2align 10
.fill 64, 4, 0xbf800000
.globl sequential_preLN__linear_kernel_hedgehog__moe_arch_mod__prompt_kernel
.p2align 8
.type sequential_preLN__linear_kernel_hedgehog__moe_arch_mod__prompt_kernel,@function
sequential_preLN__linear_kernel_hedgehog__moe_arch_mod__prompt_kernel:
    s_load_dwordx2 s[28:29], s[0:1], 0
    s_load_dwordx2 s[32:33], s[0:1], 8
    s_getpc_b64 s[66:67]
L_pc:
    v_readfirstlane_b32 s79, v0
    s_lshr_b32 s60, s2, 3
    s_cmp_ge_u32 s60, 32
    s_cbranch_scc1 L_end
    v_and_b32_e64 v1, 63, v0
    s_and_b32 s60, s60, 15
    s_lshr_b32 s62, s79, 6
    s_cmp_ge_u32 s62, 4
    s_cbranch_scc1 L_compute
    s_setprio 3
    s_lshr_b32 s76, s2, 3
    s_lshl2_add_u32 s76, s76, s62
    s_mul_i32 s76, s76, 256
    v_lshl_add_u32 v91, v1, 7, s76
    s_mov_b64 exec, 3
    global_load_dword v27, v91, s[66:67]
    s_mov_b64 exec, -1
    s_add_u32 s84, s60, s2
    s_and_b32 s84, s84, 3
    s_and_b32 s76, s60, 7
    s_and_b32 s77, s2, 7
    s_cselect_b32 s84, s84, s76
    v_lshrrev_b32 v4, 3, v1
    v_and_b32 v5, 7, v1
    v_lshrrev_b32 v6, 4, v1
    s_lshl2_add_u32 s76, s60, s62
    s_lshl_b32 s76, s76, 16
    s_movk_i32 s70, 10240
    s_mul_i32 s70, s70, s62
    v_xor_b32 v7, v5, v6
    v_lshlrev_b32 v7, 4, v7
    v_lshl_add_u32 v78, v4, 11, v7
    v_add_u32_e64 v16, s76, v78
    s_mov_b32 s30, 4194304
    s_mov_b32 s31, 0x20000
    s_and_b32 s72, s84, 15
    s_mov_b32 m0, s70
    s_lshl_b32 s71, s72, 7
    s_waitcnt lgkmcnt(0)
    buffer_load_dwordx4 v16, s[28:31], s71 offen offset:0 lds
    s_mul_i32 s72, s72, 393216
    s_lshr_b64 s[84:85], s[84:85], 4
    s_load_dwordx4 s[8:11], s[0:1], 16
    s_load_dwordx16 s[12:27], s[0:1], 32
    v_xor_b32 v7, 64, v16
    v_add_u32 v17, 15360, v7
    buffer_load_dwordx4 v17, s[28:31], s71 offen offset:1024 lds
    v_add_u32 v18, 30720, v16
    buffer_load_dwordx4 v18, s[28:31], s71 offen offset:2048 lds
    v_add_u32 v19, 46080, v7
    buffer_load_dwordx4 v19, s[28:31], s71 offen offset:3072 lds
    s_and_b32 s76, s2, 7
    s_lshl_b32 s76, s76, 3
    s_lshr_b32 s77, s2, 7
    s_lshl2_add_u32 s76, s77, s76
    s_mov_b32 s80, 0x654210b3
    s_mov_b32 s81, 0xfedca987
    s_lshr_b64 s[80:81], s[80:81], s76
    s_and_b32 s61, s80, 15
    v_and_b32 v6, 1, v6
    v_lshlrev_b32 v6, 2, v6
    v_xor_b32 v8, v5, v6
    v_lshlrev_b32_e64 v8, 4, v8
    s_lshl_b32 s76, s61, 7
    s_mul_i32 s77, s62, 98304
    s_add_u32 s76, s76, s77
    v_mul_u32_u24 v7, 6144, v4
    v_add3_u32 v20, v7, v8, s76
    v_xor_b32 v7, 32, v20
    s_mov_b32 s34, 6291456
    s_mov_b32 s35, 0x20000
    s_add_u32 m0, s70, 4096
    s_nop 0
    buffer_load_dwordx4 v20, s[32:35], s72 offen offset:0 lds
    v_add_u32 v21, 48128, v7
    buffer_load_dwordx4 v21, s[32:35], s72 offen offset:1024 lds
    v_add_u32 v22, 0, v20
    buffer_load_dwordx4 v22, s[32:35], s72 offen offset:2048 lds
    v_add_u32 v23, 48128, v7
    buffer_load_dwordx4 v23, s[32:35], s72 offen offset:3072 lds
    v_add_u32 v24, 4096, v20
    s_add_u32 m0, s70, 8192
    s_nop 0
    buffer_load_dwordx4 v24, s[32:35], s72 offen offset:0 lds
    v_add_u32 v25, 52224, v7
    buffer_load_dwordx4 v25, s[32:35], s72 offen offset:1024 lds
    s_add_u32 s70, s70, 40960
    s_cmp_ge_u32 s70, 122880
    s_cselect_b32 s76, 122880, 0
    s_sub_u32 s70, s70, s76
    s_lshl_b32 s76, s60, 8
    s_lshl_b32 s77, s61, 4
    s_add_u32 s76, s76, s77
    s_add_u32 s76, s76, 30700
    s_load_dwordx4 s[84:87], s[66:67], s76
    v_lshl_add_u32 v26, v4, 11, v8
    v_xor_b32 v79, 64, v78
    s_and_b32 s63, s62, 1
    s_lshr_b32 s64, s62, 1
    s_lshl_b32 s73, s60, 4
    s_add_u32 s73, s73, s61
    s_mul_i32 s73, s73, 28800
    s_add_u32 s76, s2, 7
    s_and_b32 s76, s76, 7
    s_bfe_u32 s77, s2, 0x10003
    s_lshl1_add_u32 s97, s76, s77
    s_lshr_b32 s98, s2, 4
    s_lshl_b32 s99, s97, 4
    s_add_u32 s99, s99, s98
    s_mul_i32 s99, s99, 9344
    s_add_u32 s99, s99, 8388608
    s_lshr_b32 s65, s97, 1
    s_lshl_b32 s76, s97, 3
    s_add_u32 s65, s65, s76
    s_mul_i32 s76, s98, 4
    s_add_u32 s65, s65, s76
    s_and_b32 s65, s65, 15
    s_mov_b32 s89, 0x3f803f80
    s_mov_b32 s90, 0xffff0000
    v_and_b32 v2, 31, v1
    v_lshrrev_b32 v3, 5, v1
    v_lshlrev_b32 v12, 4, v1
    v_lshrrev_b32 v4, 3, v1
    v_mul_u32_u24 v13, 460800, v4
    v_and_b32_e64 v4, 7, v1
    v_lshl_add_u32 v13, v4, 4, v13
    s_lshl_b32 s76, s98, 7
    s_lshl_b32 s77, s62, 15
    s_add_u32 s76, s76, s77
    v_add_u32 v26, s76, v26
    v_mov_b32 v28, -1
    v_mov_b32 v29, -1
    v_mov_b32 v30, -1
    v_mov_b32 v31, -1
    s_waitcnt lgkmcnt(0)
    s_and_b32 s72, s84, 15
    s_mov_b32 m0, s70
    s_lshl_b32 s71, s72, 7
    buffer_load_dwordx4 v16, s[28:31], s71 offen offset:0 lds
    s_mul_i32 s72, s72, 393216
    s_lshr_b64 s[84:85], s[84:85], 4
    buffer_load_dwordx4 v17, s[28:31], s71 offen offset:1024 lds
    s_mov_b32 s40, s26
    s_and_b32 s41, s27, 0xffff
    s_mov_b32 s42, 33554432
    s_mov_b32 s43, 0x20000
    buffer_load_dwordx4 v18, s[28:31], s71 offen offset:2048 lds
    s_mov_b32 s56, s8
    s_and_b32 s57, s9, 0xffff
    s_mov_b32 s58, 65536
    s_mov_b32 s59, 0x20000
    buffer_load_dwordx4 v19, s[28:31], s71 offen offset:3072 lds
    s_add_u32 m0, s70, 4096
    s_nop 0
    buffer_load_dwordx4 v20, s[32:35], s72 offen offset:0 lds
    buffer_load_dwordx4 v21, s[32:35], s72 offen offset:1024 lds
    buffer_load_dwordx4 v22, s[32:35], s72 offen offset:2048 lds
    buffer_load_dwordx4 v23, s[32:35], s72 offen offset:3072 lds
    s_add_u32 m0, s70, 8192
    s_nop 0
    buffer_load_dwordx4 v24, s[32:35], s72 offen offset:0 lds
    buffer_load_dwordx4 v25, s[32:35], s72 offen offset:1024 lds
    s_add_u32 s70, s70, 40960
    s_cmp_ge_u32 s70, 122880
    s_cselect_b32 s76, 122880, 0
    s_sub_u32 s70, s70, s76
    s_lshl_b32 s77, s62, 10
    s_add_u32 s76, s77, s73
    buffer_store_dwordx4 v[28:31], v12, s[40:43], s76 offen sc1
    s_lshl_b32 s76, s61, 12
    s_add_u32 s76, s76, s77
    s_add_u32 m0, s77, 122880
    s_nop 0
    buffer_load_dwordx4 v12, s[56:59], s76 offen lds
    v_mov_b32 v4, 13631488
    buffer_load_dwordx2 v[88:89], v4, s[40:43], 0 offen
    s_setprio 0
    s_waitcnt vmcnt(13)
    s_barrier
    s_and_b32 s72, s84, 15
    s_mov_b32 m0, s70
    s_lshl_b32 s71, s72, 7
    buffer_load_dwordx4 v16, s[28:31], s71 offen offset:0 lds
    s_mul_i32 s72, s72, 393216
    s_lshr_b64 s[84:85], s[84:85], 4
    buffer_load_dwordx4 v17, s[28:31], s71 offen offset:1024 lds
    buffer_load_dwordx4 v18, s[28:31], s71 offen offset:2048 lds
    buffer_load_dwordx4 v19, s[28:31], s71 offen offset:3072 lds
    s_add_u32 m0, s70, 4096
    s_nop 0
    buffer_load_dwordx4 v20, s[32:35], s72 offen offset:0 lds
    buffer_load_dwordx4 v21, s[32:35], s72 offen offset:1024 lds
    buffer_load_dwordx4 v22, s[32:35], s72 offen offset:2048 lds
    buffer_load_dwordx4 v23, s[32:35], s72 offen offset:3072 lds
    s_add_u32 m0, s70, 8192
    s_nop 0
    buffer_load_dwordx4 v24, s[32:35], s72 offen offset:0 lds
    s_mov_b32 s36, s10
    s_and_b32 s37, s11, 0xffff
    s_mov_b32 s38, 2097152
    s_mov_b32 s39, 0x20000
    s_mov_b32 s44, s22
    s_and_b32 s45, s23, 0xffff
    s_mov_b32 s46, 4194304
    s_mov_b32 s47, 0x20000
    s_mov_b32 s52, s20
    s_and_b32 s53, s21, 0xffff
    s_mov_b32 s54, 7340032
    s_mov_b32 s55, 0x20000
    s_cmp_eq_u32 s64, 0
    s_cselect_b32 s48, s16, s18
    s_cselect_b32 s49, s17, s19
    s_and_b32 s49, s49, 0xffff
    s_mov_b32 s51, 0x20000
    s_cmp_lt_u32 s97, 14
    s_cselect_b32 s50, 7340032, 0
    s_cselect_b32 s54, 7340032, 0
    v_bfe_u32 v4, v2, 1, 3
    v_xor_b32 v4, v4, v3
    v_lshlrev_b32_e64 v4, 4, v4
    v_lshl_add_u32 v72, v2, 7, v4
    v_bfe_u32 v4, v1, 2, 2
    v_lshl_add_u32 v5, v3, 3, v4
    v_lshlrev_b32 v5, 7, v5
    v_lshrrev_b32 v4, 1, v4
    v_xor_b32_e64 v4, s64, v4
    v_lshl_add_u32 v5, v4, 6, v5
    v_bfe_u32 v4, v1, 4, 1
    v_xor_b32_e64 v4, v4, v3
    v_lshl_add_u32 v5, v4, 5, v5
    v_and_b32_e64 v4, 3, v1
    v_lshl_add_u32 v5, v4, 3, v5
    s_mul_i32 s76, s62, 10240
    s_sub_u32 s76, 4096, s76
    v_add_u32 v73, s76, v5
    v_lshlrev_b32 v74, 3, v2
    v_lshrrev_b32 v4, 4, v1
    v_and_b32 v5, 15, v1
    v_mul_u32_u24 v66, 28800, v4
    v_lshl_add_u32 v66, v5, 4, v66
    v_mul_u32_u24 v75, 460800, v4
    v_lshl_add_u32 v75, v5, 4, v75
    s_lshr_b32 s76, s60, 3
    s_lshl_b32 s76, s76, 2
    v_lshl_add_u32 v6, v4, 3, s76
    s_mov_b32 s69, 0
    v_mov_b32 v7, 0x654210b3
    v_bfe_u32 v7, v7, v6, 4
    v_mul_u32_u24 v7, 28800, v7
    v_lshl_add_u32 v66, v5, 4, v7
    v_mov_b32 v7, 0xfedca987
    v_bfe_u32 v7, v7, v6, 4
    v_mul_u32_u24 v7, 28800, v7
    v_lshl_add_u32 v67, v5, 4, v7
    v_mov_b32 v80, 0
    v_mov_b32 v81, 0
    v_mov_b32 v82, 0
    v_mov_b32 v83, 0
    v_lshrrev_b32 v4, 4, v1
    v_and_b32_e64 v5, 15, v1
    v_mul_u32_u24 v76, 114688, v4
    v_lshl_add_u32 v76, v5, 4, v76
    v_lshlrev_b32_e64 v77, 4, v2
    v_lshl_add_u32 v77, v3, 11, v77
    s_mul_i32 s75, s98, 458752
    s_lshl_b32 s77, s97, 9
    s_add_u32 s75, s75, s77
    s_lshl_b32 s77, s63, 8
    s_add_u32 s75, s75, s77
    s_lshl_b32 s96, s97, 19
    s_lshl_b32 s77, s98, 15
    s_add_u32 s96, s96, s77
    s_lshl_b32 s77, s62, 9
    s_add_u32 s96, s96, s77
    s_mov_b32 s68, 1
    s_getreg_b32 s101, hwreg(HW_REG_XCC_ID, 0, 4)
    s_lshl_b32 s76, s61, 8
    s_add_u32 s76, s76, 12582912
    s_lshl_b32 s77, s60, 8
    s_add_u32 s77, s77, 12586752
    s_lshr_b32 s78, s97, 1
    s_lshl_b32 s78, s78, 9
    s_add_u32 s78, s78, 12590592
    v_mov_b32 v4, s76
    v_mov_b32 v5, s77
    v_mov_b32 v6, s78
    v_cmp_gt_u32 vcc, 16, v1
    s_nop 1
    v_cndmask_b32 v4, v5, v4, vcc
    v_cmp_gt_u32 vcc, 32, v1
    s_nop 1
    v_cndmask_b32 v4, v6, v4, vcc
    v_add_u32_e64 v90, v4, v12
    s_waitcnt vmcnt(9)
    s_barrier
L_hloop:
    s_and_b32 s77, s86, 15
    s_cbranch_scc1 L_event
L_evret:
    s_add_u32 m0, s70, 8192
    s_nop 0
    buffer_load_dwordx4 v25, s[32:35], s72 offen offset:1024 lds
    s_add_u32 s70, s70, 40960
    s_cmp_ge_u32 s70, 122880
    s_cselect_b32 s76, 122880, 0
    s_sub_u32 s70, s70, s76
    s_and_b32 s72, s84, 15
    s_mov_b32 m0, s70
    s_lshl_b32 s71, s72, 7
    buffer_load_dwordx4 v16, s[28:31], s71 offen offset:0 lds
    s_mul_i32 s72, s72, 393216
    s_lshr_b64 s[84:85], s[84:85], 4
    buffer_load_dwordx4 v17, s[28:31], s71 offen offset:1024 lds
    buffer_load_dwordx4 v18, s[28:31], s71 offen offset:2048 lds
    buffer_load_dwordx4 v19, s[28:31], s71 offen offset:3072 lds
    s_add_u32 m0, s70, 4096
    s_nop 0
    buffer_load_dwordx4 v20, s[32:35], s72 offen offset:0 lds
    buffer_load_dwordx4 v21, s[32:35], s72 offen offset:1024 lds
    buffer_load_dwordx4 v22, s[32:35], s72 offen offset:2048 lds
    buffer_load_dwordx4 v23, s[32:35], s72 offen offset:3072 lds
    s_add_u32 m0, s70, 8192
    s_nop 0
    buffer_load_dwordx4 v24, s[32:35], s72 offen offset:0 lds
L_hw10:
    s_waitcnt vmcnt(9)
L_hbar:
    s_lshr_b64 s[86:87], s[86:87], 4
    s_add_u32 s68, s68, 1
    s_cmp_lt_u32 s68, 14
    s_barrier
    s_cbranch_scc1 L_hloop
L_hdone:
    s_add_u32 m0, s70, 8192
    s_nop 0
    buffer_load_dwordx4 v25, s[32:35], s72 offen offset:1024 lds
    s_add_u32 s70, s70, 40960
    s_cmp_ge_u32 s70, 122880
    s_cselect_b32 s76, 122880, 0
    s_sub_u32 s70, s70, s76
    v_add_co_u32 v88, vcc, 1, v88
    s_nop 1
    v_addc_co_u32 v89, vcc, 0, v89, vcc
    v_cmp_ne_u64 vcc, v[92:93], v[88:89]
    s_cbranch_vccz L_hello_ok_1
    s_mov_b32 s88, 0
L_spin_2:
    buffer_load_dwordx4 v[92:95], v90, s[40:43], 0 offen sc1
    s_waitcnt vmcnt(0)
    v_cmp_ne_u64 vcc, v[92:93], v[88:89]
    s_cbranch_vccz L_hello_ok_1
    s_add_u32 s88, s88, 1
    s_cmp_lt_u32 s88, 65536
    s_cbranch_scc1 L_spin_2
L_hello_ok_1:
    v_cmp_ne_u32_e64 vcc, s101, v94
    s_nop 0
    s_and_b32 s76, vcc_lo, 0xffff
    s_cselect_b32 s100, 0, 1
    s_cmp_eq_u32 vcc_hi, 0
    s_cselect_b32 s76, 2, 0
    s_or_b32 s100, s100, s76
    v_mov_b32 v4, s100
    v_mov_b32 v5, 0
    ds_write_b32 v5, v4 offset:53248
    s_lshl_b32 s81, s62, 8
    s_mul_i32 s80, s60, 460800
    s_add_u32 s80, s80, s81
    buffer_load_dwordx4 v[32:35], v66, s[40:43], s80 offen offset:0 sc1
    buffer_load_dwordx4 v[36:39], v67, s[40:43], s80 offen offset:0 sc1
    s_mul_i32 s80, s61, 28800
    s_add_u32 s80, s80, s81
    s_bitcmp1_b32 s2, 7
    s_cselect_b32 s79, 0, 3686400
    s_add_u32 s80, s80, s79
    buffer_load_dwordx4 v[48:51], v75, s[40:43], s80 offen offset:1024 sc1
    s_add_u32 s80, s80, 1843200
    buffer_load_dwordx4 v[52:55], v75, s[40:43], s80 offen offset:1024 sc1
    v_bfe_u32 v10, v1, 4, 1
    v_lshl_add_u32 v10, v10, 1, v3
    v_min_u32 v10, 2, v10
    v_and_b32 v7, 15, v1
    v_lshlrev_b32_e64 v7, 3, v7
    s_lshl_b32 s76, s62, 7
    v_lshl_add_u32 v10, v10, 9, v7
    v_add_u32_e64 v64, s76, v10
    v_lshl_add_u32 v65, v7, 1, s81
    v_bfe_u32 v10, v1, 4, 1
    v_lshl_add_u32 v65, v10, 3, v65
    s_mul_i32 s78, s62, 2048
    s_add_u32 s78, s78, s99
    s_add_u32 s78, s78, 1024
    v_lshlrev_b32 v11, 7, v1
    s_mov_b64 exec, 65535
    buffer_load_dword v27, v11, s[40:43], s78 offen sc1
    s_mov_b64 exec, -1
    s_add_u32 s78, s65, 0
    s_and_b32 s78, s78, 15
    s_lshl_b32 s78, s78, 17
    s_lshl_b32 s79, s62, 11
    s_add_u32 m0, s79, 57344
    s_add_u32 s79, s78, 15360
    buffer_load_dwordx4 v26, s[36:39], s78 offen lds
    buffer_load_dwordx4 v26, s[36:39], s79 offen offset:1024 lds
    s_waitcnt vmcnt(7)
    s_barrier
    s_add_u32 s78, s65, 1
    s_and_b32 s78, s78, 15
    s_lshl_b32 s78, s78, 17
    s_lshl_b32 s79, s62, 11
    s_add_u32 m0, s79, 65536
    s_add_u32 s79, s78, 15360
    buffer_load_dwordx4 v26, s[36:39], s78 offen lds
    buffer_load_dwordx4 v26, s[36:39], s79 offen offset:1024 lds
    s_setprio 3
    s_mov_b64 s[0:1], -2
    s_waitcnt vmcnt(7)
    s_branch L_g1first_3
L_g1_4:
    s_mul_i32 s80, s60, 460800
    s_add_u32 s80, s80, s81
    buffer_load_dwordx4 v[32:35], v66, s[40:43], s80 offen offset:0 sc1
    buffer_load_dwordx4 v[36:39], v67, s[40:43], s80 offen offset:0 sc1
    s_add_u32 s1, s1, 1
    s_lshr_b32 s0, s1, 16
    s_or_b32 s0, s0, -2
    s_waitcnt vmcnt(0)
L_g1first_3:
    v_max3_u32 v4, v32, v34, v36
    v_max_u32 v4, v4, v38
    v_cmp_lt_u32 vcc, s0, v4
    s_cbranch_vccnz L_g1_4
    v_add_f32 v32, v32, v36
    v_add_f32 v33, v33, v37
    v_add_f32 v34, v34, v38
    v_add_f32_e64 v35, v35, v39
    s_add_u32 s78, s65, 2
    s_and_b32 s78, s78, 15
    s_lshl_b32 s78, s78, 17
    s_lshl_b32 s79, s62, 11
    s_add_u32 m0, s79, 73728
    s_add_u32 s79, s78, 15360
    buffer_load_dwordx4 v26, s[36:39], s78 offen lds
    buffer_load_dwordx4 v26, s[36:39], s79 offen offset:1024 lds
    v_permlane32_swap_b32 v32, v33
    v_permlane32_swap_b32 v34, v35
    v_add_f32 v32, v32, v33
    v_add_f32 v34, v34, v35
    s_nop 1
    v_permlane16_swap_b32 v32, v34
    v_add_f32 v32, v32, v34
    v_mov_b32 v33, v32
    s_nop 1
    v_permlane32_swap_b32 v32, v33
    v_mul_f32 v32, 0x3a800000, v32
    v_mul_f32 v33, 0x3a800000, v33
    v_fma_f32 v7, -v32, v32, v33
    v_max_f32_e64 v7, 0, v7
    v_cvt_pk_bf16_f32 v5, v32, v32
    v_and_b32_e64 v5, s90, v5
    v_cvt_pk_bf16_f32 v7, v7, v7
    v_and_b32_e64 v7, s90, v7
    v_add_f32 v7, 0x3727c5ac, v7
    v_cvt_pk_bf16_f32 v7, v7, v7
    v_and_b32 v7, s90, v7
    v_sqrt_f32_e64 v7, v7
    s_nop 0
    v_cvt_pk_bf16_f32 v7, v7, v7
    v_and_b32 v7, s90, v7
    v_rcp_f32 v9, v7
    v_xor_b32 v5, 0x80000000, v5
    v_cvt_pk_bf16_f32 v8, v5, v5
    ds_write_b64 v65, v[8:9] offset:49152
    s_mov_b64 s[0:1], -2
    s_waitcnt vmcnt(7)
    s_branch L_g1first_5
L_g1_6:
    s_mul_i32 s80, s61, 28800
    s_add_u32 s80, s80, s81
    s_bitcmp1_b32 s2, 7
    s_cselect_b32 s79, 0, 3686400
    s_add_u32 s80, s80, s79
    buffer_load_dwordx4 v[48:51], v75, s[40:43], s80 offen offset:1024 sc1
    s_add_u32 s80, s80, 1843200
    buffer_load_dwordx4 v[52:55], v75, s[40:43], s80 offen offset:1024 sc1
    s_add_u32 s1, s1, 1
    s_lshr_b32 s0, s1, 16
    s_or_b32 s0, s0, -2
    s_waitcnt vmcnt(0)
L_g1first_5:
    v_max3_u32 v4, v48, v50, v52
    v_max_u32 v4, v4, v54
    v_cmp_lt_u32 vcc, s0, v4
    s_cbranch_vccnz L_g1_6
    v_add_f32 v48, v48, v52
    v_add_f32 v49, v49, v53
    v_add_f32 v50, v50, v54
    v_add_f32 v51, v51, v55
    v_add_f32 v49, v49, v51
    v_mov_b32 v51, v49
    v_permlane32_swap_b32 v48, v50
    s_nop 0
    v_permlane32_swap_b32 v49, v51
    v_add_f32 v48, v48, v50
    v_add_f32 v49, v49, v51
    s_nop 1
    v_permlane16_swap_b32 v48, v49
    v_add_f32_e64 v48, v48, v49
    v_cvt_pk_bf16_f32 v49, v48, v48
    v_and_b32 v49, s90, v49
    v_sub_f32 v49, v48, v49
    v_cvt_pk_bf16_f32 v50, v48, v49
    v_and_b32 v51, s90, v50
    v_sub_f32 v49, v49, v51
    v_cvt_pk_bf16_f32 v51, v49, 0
    ds_write_b64 v64, v[50:51] offset:50176
    s_setprio 0
    s_waitcnt lgkmcnt(0)
    s_barrier
    s_add_u32 s78, s65, 3
    s_and_b32 s78, s78, 15
    s_lshl_b32 s78, s78, 17
    s_lshl_b32 s79, s62, 11
    s_add_u32 m0, s79, 81920
    s_add_u32 s79, s78, 15360
    buffer_load_dwordx4 v26, s[36:39], s78 offen lds
    buffer_load_dwordx4 v26, s[36:39], s79 offen offset:1024 lds
    s_add_u32 s78, s65, 4
    s_and_b32 s78, s78, 15
    s_lshl_b32 s78, s78, 17
    s_lshl_b32 s79, s62, 11
    s_add_u32 m0, s79, 90112
    s_add_u32 s79, s78, 15360
    buffer_load_dwordx4 v26, s[36:39], s78 offen lds
    buffer_load_dwordx4 v26, s[36:39], s79 offen offset:1024 lds
    s_lshl_b32 s78, s62, 11
    s_add_u32 s79, s78, s99
    s_bitcmp1_b32 s100, 0
    s_cbranch_scc0 L_loc_7
    buffer_store_dwordx4 v[28:31], v12, s[40:43], s79 offen offset:1024
    buffer_store_dwordx4 v[28:31], v12, s[40:43], s79 offen offset:2048
L_pubd_8:
    s_lshl_b32 s79, s62, 8
    s_add_u32 s79, s79, s99
    s_mov_b64 exec, 0xffff
    buffer_store_dwordx4 v[28:31], v12, s[40:43], s79 offen sc1
    s_mov_b64 exec, -1
    s_add_u32 s78, s65, 5
    s_and_b32 s78, s78, 15
    s_lshl_b32 s78, s78, 17
    s_lshl_b32 s79, s62, 11
    s_add_u32 m0, s79, 98304
    s_add_u32 s79, s78, 15360
    buffer_load_dwordx4 v26, s[36:39], s78 offen lds
    buffer_load_dwordx4 v26, s[36:39], s79 offen offset:1024 lds
    s_add_u32 s78, s65, 6
    s_and_b32 s78, s78, 15
    s_lshl_b32 s78, s78, 17
    s_lshl_b32 s79, s62, 11
    s_add_u32 m0, s79, 106496
    s_add_u32 s79, s78, 15360
    buffer_load_dwordx4 v26, s[36:39], s78 offen lds
    buffer_load_dwordx4 v26, s[36:39], s79 offen offset:1024 lds
    s_add_u32 s78, s65, 7
    s_and_b32 s78, s78, 15
    s_lshl_b32 s78, s78, 17
    s_lshl_b32 s79, s62, 11
    s_add_u32 m0, s79, 114688
    s_add_u32 s79, s78, 15360
    buffer_load_dwordx4 v26, s[36:39], s78 offen lds
    buffer_load_dwordx4 v26, s[36:39], s79 offen offset:1024 lds
    s_mul_i32 s78, s62, 384
    s_add_u32 s78, s78, s73
    s_add_u32 s78, s78, 2048
    v_lshlrev_b32_e64 v11, 7, v1
    s_mov_b64 exec, 7
    buffer_load_dword v27, v11, s[40:43], s78 offen sc1
    s_mov_b64 exec, -1
    s_waitcnt vmcnt(7)
    s_lshl_b32 s76, s62, 2
    s_add_u32 s76, s76, s73
    v_mov_b32 v4, 0
    s_mov_b64 exec, 1
    s_bitcmp1_b32 s100, 0
    s_cbranch_scc0 L_loc_9
    buffer_store_dword v4, v4, s[40:43], s76 offen offset:2560
L_pubd_10:
    s_mov_b64 exec, -1
    s_add_u32 s78, s65, 8
    s_and_b32 s78, s78, 15
    s_lshl_b32 s78, s78, 17
    s_lshl_b32 s79, s62, 11
    s_add_u32 m0, s79, 122880
    s_add_u32 s79, s78, 15360
    buffer_load_dwordx4 v26, s[36:39], s78 offen lds
    buffer_load_dwordx4 v26, s[36:39], s79 offen offset:1024 lds
    s_add_u32 s78, s65, 9
    s_and_b32 s78, s78, 15
    s_lshl_b32 s78, s78, 17
    s_lshl_b32 s79, s62, 11
    s_add_u32 m0, s79, 131072
    s_add_u32 s79, s78, 15360
    buffer_load_dwordx4 v26, s[36:39], s78 offen lds
    buffer_load_dwordx4 v26, s[36:39], s79 offen offset:1024 lds
    s_add_u32 s78, s65, 10
    s_and_b32 s78, s78, 15
    s_lshl_b32 s78, s78, 17
    s_lshl_b32 s79, s62, 11
    s_add_u32 m0, s79, 139264
    s_add_u32 s79, s78, 15360
    buffer_load_dwordx4 v26, s[36:39], s78 offen lds
    buffer_load_dwordx4 v26, s[36:39], s79 offen offset:1024 lds
    v_and_b32 v65, 15, v1
    v_mul_u32_u24 v65, 460800, v65
    s_mul_i32 s80, s61, 28800
    s_lshl_b32 s82, s62, 2
    s_add_u32 s82, s82, s80
    v_bfe_u32 v4, v1, 4, 1
    v_lshl_add_u32 v4, v4, 1, v3
    s_lshl_b32 s77, s62, 6
    v_lshl_add_u32 v66, v4, 1, s77
    v_bfe_u32 v4, v1, 2, 1
    v_lshl_add_u32 v66, v4, 5, v66
    v_bfe_u32 v4, v1, 0, 1
    v_lshl_add_u32 v66, v4, 4, v66
    v_bfe_u32 v4, v1, 1, 1
    v_lshl_add_u32 v66, v4, 3, v66
    s_lshl_b32 s83, s62, 7
    s_add_u32 s81, s83, s80
    s_add_u32 s68, s81, 3686400
    s_add_u32 s83, s83, s73
    v_and_b32 v4, 7, v1
    v_lshrrev_b32 v5, 4, v1
    v_lshlrev_b32_e64 v5, 2, v5
    v_lshl_add_u32 v67, v4, 4, v5
    v_bfe_u32 v5, v1, 3, 1
    v_lshrrev_b32_e64 v6, 4, v1
    v_lshl_add_u32 v5, v5, 4, v6
    v_mul_u32_u24 v5, 9344, v5
    v_lshl_add_u32 v61, v4, 4, v5
    s_lshr_b32 s69, s97, 1
    s_lshr_b32 s76, s2, 7
    s_lshl2_add_u32 s69, s69, s76
    s_mul_i32 s69, s69, 74752
    s_add_u32 s69, s69, 8389632
    s_barrier
    s_add_u32 s78, s65, 11
    s_and_b32 s78, s78, 15
    s_lshl_b32 s78, s78, 17
    s_lshl_b32 s79, s62, 11
    s_add_u32 m0, s79, 147456
    s_add_u32 s79, s78, 15360
    buffer_load_dwordx4 v26, s[36:39], s78 offen lds
    buffer_load_dwordx4 v26, s[36:39], s79 offen offset:1024 lds
    s_add_u32 s78, s65, 12
    s_and_b32 s78, s78, 15
    s_lshl_b32 s78, s78, 17
    s_lshl_b32 s79, s62, 11
    s_add_u32 m0, s79, 155648
    s_add_u32 s79, s78, 15360
    buffer_load_dwordx4 v26, s[36:39], s78 offen lds
    buffer_load_dwordx4 v26, s[36:39], s79 offen offset:1024 lds
    buffer_load_dword v64, v65, s[40:43], s82 offen offset:2560 sc1
    s_barrier
    s_setprio 3
    v_mov_b32 v4, s89
    v_lshlrev_b32 v5, 2, v1
    ds_write_b32 v5, v4 offset:24832
    v_mov_b32 v70, 0
    v_mov_b32 v71, 0
    ds_write_b64 v70, v[70:71] offset:25984
    s_mov_b64 s[0:1], -2
    s_branch L_p2first_11
L_p2_12:
    buffer_load_dword v64, v65, s[40:43], s82 offen offset:2560 sc1
    s_add_u32 s1, s1, 1
    s_lshr_b32 s0, s1, 16
    s_or_b32 s0, s0, -2
L_p2first_11:
    s_waitcnt vmcnt(0)
    v_cmp_lt_u32 vcc, s0, v64
    s_cbranch_vccnz L_p2_12
    s_add_u32 s78, s65, 13
    s_and_b32 s78, s78, 15
    s_lshl_b32 s78, s78, 17
    s_lshl_b32 s79, s62, 11
    s_add_u32 m0, s79, 32768
    s_add_u32 s79, s78, 15360
    buffer_load_dwordx4 v26, s[36:39], s78 offen lds
    buffer_load_dwordx4 v26, s[36:39], s79 offen offset:1024 lds
    s_add_u32 s78, s65, 14
    s_and_b32 s78, s78, 15
    s_lshl_b32 s78, s78, 17
    s_lshl_b32 s79, s62, 11
    s_add_u32 m0, s79, 40960
    s_add_u32 s79, s78, 15360
    buffer_load_dwordx4 v26, s[36:39], s78 offen lds
    buffer_load_dwordx4 v26, s[36:39], s79 offen offset:1024 lds
    s_add_u32 s78, s65, 15
    s_and_b32 s78, s78, 15
    s_lshl_b32 s78, s78, 17
    s_lshl_b32 s79, s62, 11
    s_add_u32 m0, s79, 49152
    s_add_u32 s79, s78, 15360
    buffer_load_dwordx4 v26, s[36:39], s78 offen lds
    buffer_load_dwordx4 v26, s[36:39], s79 offen offset:1024 lds
    s_lshl_b32 s76, s62, 11
    s_lshl_b32 s77, s60, 7
    s_add_u32 s76, s76, s77
    s_add_u32 s76, s76, s69
    s_add_u32 s77, s76, 37376
    s_mov_b32 s78, 0x00003f80
    s_mov_b32 s79, 0x3f800000
    s_branch L_fit_kv1
.fill 1, 4, 0xbf800000
L_fit_kv1:
    s_mov_b64 s[0:1], -2
L_poll_13:
    buffer_load_dwordx4 v[32:35], v61, s[40:43], s76 offen sc1
    buffer_load_dwordx4 v[36:39], v61, s[40:43], s77 offen sc1
    s_add_u32 s1, s1, 1
    s_lshr_b32 s0, s1, 16
    s_or_b32 s0, s0, -2
    s_waitcnt vmcnt(0)
    v_max_u32_e64 v4, v32, v36
    v_cmp_lt_u32 vcc, s0, v4
    s_cbranch_vccnz L_poll_13
    v_dot2_f32_bf16 v48, v32, s78, 0
    v_dot2_f32_bf16 v49, v32, s79, 0
    v_dot2_f32_bf16 v50, v33, s78, 0
    v_dot2_f32_bf16 v51, v33, s79, 0
    v_dot2_f32_bf16 v52, v34, s78, 0
    v_dot2_f32_bf16 v53, v34, s79, 0
    v_dot2_f32_bf16 v54, v35, s78, 0
    v_dot2_f32_bf16 v55, v35, s79, 0
    v_dot2_f32_bf16 v48, v36, s78, v48
    v_dot2_f32_bf16 v49, v36, s79, v49
    v_dot2_f32_bf16 v50, v37, s78, v50
    v_dot2_f32_bf16 v51, v37, s79, v51
    v_dot2_f32_bf16 v52, v38, s78, v52
    v_dot2_f32_bf16 v53, v38, s79, v53
    v_dot2_f32_bf16 v54, v39, s78, v54
    v_dot2_f32_bf16 v55, v39, s79, v55
    buffer_load_dwordx4 v[40:43], v13, s[40:43], s81 offen offset:2048 sc1
    buffer_load_dwordx4 v[44:47], v13, s[40:43], s68 offen offset:2048 sc1
    v_permlane32_swap_b32 v48, v52
    v_permlane32_swap_b32 v49, v53
    v_permlane32_swap_b32 v50, v54
    v_permlane32_swap_b32 v51, v55
    v_add_f32 v48, v48, v52
    v_add_f32 v49, v49, v53
    v_add_f32 v50, v50, v54
    v_add_f32 v51, v51, v55
    s_nop 0
    v_permlane16_swap_b32 v48, v50
    v_permlane16_swap_b32 v49, v51
    v_add_f32 v48, v48, v50
    v_add_f32 v49, v49, v51
    s_nop 0
    v_add_f32_dpp v48, v48, v48 row_ror:8 row_mask:0xf bank_mask:0xf
    v_add_f32_dpp v49, v49, v49 row_ror:8 row_mask:0xf bank_mask:0xf
    v_cvt_pk_bf16_f32 v48, v48, v49
    s_bitcmp1_b32 s100, 0
    s_cbranch_scc0 L_loc_14
    buffer_store_dword v48, v67, s[40:43], s83 offen offset:3072
L_pubd_15:
    s_mov_b64 s[0:1], -2
    s_waitcnt vmcnt(1)
    s_branch L_zfirst_16
L_z_17:
    buffer_load_dwordx4 v[40:43], v13, s[40:43], s81 offen offset:2048 sc1
    buffer_load_dwordx4 v[44:47], v13, s[40:43], s68 offen offset:2048 sc1
    s_add_u32 s1, s1, 1
    s_lshr_b32 s0, s1, 16
    s_or_b32 s0, s0, -2
    s_waitcnt vmcnt(0)
L_zfirst_16:
    v_max3_u32 v4, v40, v41, v42
    v_max3_u32 v4, v4, v43, v44
    v_max3_u32 v4, v4, v45, v46
    v_max_u32 v4, v4, v47
    v_cmp_lt_u32 vcc, s0, v4
    s_cbranch_vccnz L_z_17
    v_add_f32 v40, v40, v44
    v_add_f32 v41, v41, v45
    v_add_f32 v42, v42, v46
    v_add_f32 v43, v43, v47
    v_permlane32_swap_b32 v40, v41
    s_nop 0
    v_permlane32_swap_b32 v42, v43
    v_add_f32 v40, v40, v41
    v_add_f32 v42, v42, v43
    s_nop 1
    v_permlane16_swap_b32 v40, v42
    v_add_f32_e64 v40, v40, v42
    s_nop 1
    v_add_f32_dpp v40, v40, v40 row_ror:8 row_mask:0xf bank_mask:0xf
    v_cvt_pk_bf16_f32 v40, v40, v40
    ds_write_b16 v66, v40 offset:24576
    s_waitcnt lgkmcnt(0)
    s_barrier
    s_setprio 0
    s_mov_b64 exec, 3
    global_load_dword v27, v91, s[66:67]
    s_mov_b64 exec, -1
    s_lshl_b32 s78, s97, 18
    s_lshl_b32 s79, s62, 16
    s_add_u32 s78, s78, s79
    s_lshl_b32 s79, s98, 7
    s_add_u32 s78, s78, s79
    s_lshl_b32 s79, s62, 12
    s_add_u32 m0, s79, 0
    s_nop 0
    buffer_load_dwordx4 v78, s[28:31], s78 offen offset:0 lds
    s_add_u32 s78, s78, 15360
    buffer_load_dwordx4 v79, s[28:31], s78 offen offset:1024 lds
    s_add_u32 s78, s78, 15360
    buffer_load_dwordx4 v78, s[28:31], s78 offen offset:2048 lds
    s_add_u32 s78, s78, 15360
    buffer_load_dwordx4 v79, s[28:31], s78 offen offset:3072 lds
    s_mov_b32 s56, s14
    s_and_b32 s57, s15, 0xffff
    s_mov_b32 s58, 2048
    s_mov_b32 s59, 0x20000
    s_lshl_b32 s78, s62, 9
    s_add_u32 m0, s78, 16384
    s_mov_b32 exec_hi, 0
    buffer_load_dwordx4 v12, s[56:59], s78 offen lds
    s_mov_b64 exec, -1
    s_barrier
    s_lshl4_add_u32 s76, s97, s98
    s_mul_i32 s76, s76, 28800
    s_add_u32 s20, s26, s76
    s_addc_u32 s21, s27, 0
    s_cmp_eq_u32 s62, 0
    s_cbranch_scc0 L_now0_20
    s_load_dwordx16 s[4:19], s[20:21], 3584 glc
    s_waitcnt lgkmcnt(0)
    s_and_b64 s[4:5], s[4:5], s[6:7]
    s_and_b64 s[4:5], s[4:5], s[8:9]
    s_and_b64 s[4:5], s[4:5], s[10:11]
    s_and_b64 s[4:5], s[4:5], s[12:13]
    s_and_b64 s[4:5], s[4:5], s[14:15]
    s_and_b64 s[4:5], s[4:5], s[16:17]
    s_and_b64 s[4:5], s[4:5], s[18:19]
    s_nand_b32 s4, s4, s5
    s_and_b32 s4, s4, 0xffff
    s_mul_i32 s4, s4, 0x10001
    s_lshr_b32 s4, s4, s65
    s_and_b32 s77, s4, 0xffff
    v_mov_b32_e64 v69, s77
    s_mov_b64 exec, 1
    ds_or_b32 v70, v69 offset:25984
    s_mov_b64 exec, -1
    s_waitcnt vmcnt(0) lgkmcnt(0)
    s_load_dwordx16 s[4:19], s[20:21], 3584 glc
    s_barrier
    s_mov_b32 s88, 0
    s_branch L_fo2
L_now0_20:
    s_waitcnt vmcnt(0) lgkmcnt(0)
    s_barrier
    s_cmp_eq_u32 s62, 0
    s_cbranch_scc0 L_now1_18
    s_mov_b32 s88, 0
L_spin_21:
    s_load_dwordx16 s[4:19], s[20:21], 3584 glc
L_fo2:
    s_waitcnt lgkmcnt(0)
    s_and_b64 s[4:5], s[4:5], s[6:7]
    s_and_b64 s[4:5], s[4:5], s[8:9]
    s_and_b64 s[4:5], s[4:5], s[10:11]
    s_and_b64 s[4:5], s[4:5], s[12:13]
    s_and_b64 s[4:5], s[4:5], s[14:15]
    s_and_b64 s[4:5], s[4:5], s[16:17]
    s_and_b64 s[4:5], s[4:5], s[18:19]
    s_nand_b32 s4, s4, s5
    s_and_b32 s4, s4, 0xffff
    s_mul_i32 s4, s4, 0x10001
    s_lshr_b32 s4, s4, s65
    s_and_b32 s77, s4, 0xffff
    v_mov_b32 v69, s77
    s_mov_b64 exec, 1
    ds_or_b32 v70, v69 offset:25984
    s_mov_b64 exec, -1
    s_cmp_eq_u32 s77, 0xffff
    s_cbranch_scc1 L_s2done_19
    s_add_u32 s88, s88, 1
    s_cmp_lt_u32 s88, 65536
    s_cbranch_scc1 L_spin_21
    s_branch L_s2done_19
L_now1_18:
    s_cmp_eq_u32 s62, 1
    s_cbranch_scc0 L_s2done_19
    s_lshl_b32 s77, 1, s61
    s_not_b32 s77, s77
    v_mov_b32 v4, s77
    v_mul_u32_u24 v5, 28800, v1
    s_mul_i32 s76, s60, 460800
    s_lshl2_add_u32 s76, s61, s76
    s_mov_b32 s88, 0
L_spin_22:
    ds_read_b32 v69, v70 offset:25988
    s_waitcnt lgkmcnt(0)
    v_cmp_eq_u32 vcc, 4, v69
    s_cbranch_vccnz L_drained_23
    s_add_u32 s88, s88, 1
    s_cmp_lt_u32 s88, 1048576
    s_cbranch_scc1 L_spin_22
L_drained_23:
    s_mov_b64 exec, 0xffff
    buffer_store_dword v4, v5, s[40:43], s76 offen offset:3584 sc1
    s_mov_b64 exec, -1
L_s2done_19:
    s_waitcnt vmcnt(0)
    s_mov_b32 s78, 0x05040100
    s_mov_b32 s79, 0x07060302
    v_perm_b32 v160, v100, v96, s78
    v_perm_b32 v164, v100, v96, s79
    v_perm_b32 v168, v101, v97, s78
    v_perm_b32 v172, v101, v97, s79
    v_perm_b32 v176, v102, v98, s78
    v_perm_b32 v180, v102, v98, s79
    v_perm_b32 v184, v103, v99, s78
    v_perm_b32 v188, v103, v99, s79
    v_perm_b32 v161, v108, v104, s78
    v_perm_b32 v165, v108, v104, s79
    v_perm_b32 v169, v109, v105, s78
    v_perm_b32 v173, v109, v105, s79
    v_perm_b32 v177, v110, v106, s78
    v_perm_b32 v181, v110, v106, s79
    v_perm_b32 v185, v111, v107, s78
    v_perm_b32 v189, v111, v107, s79
    v_perm_b32 v162, v116, v112, s78
    v_perm_b32 v166, v116, v112, s79
    v_perm_b32 v170, v117, v113, s78
    v_perm_b32 v174, v117, v113, s79
    v_perm_b32 v178, v118, v114, s78
    v_perm_b32 v182, v118, v114, s79
    v_perm_b32 v186, v119, v115, s78
    v_perm_b32 v190, v119, v115, s79
    v_perm_b32 v163, v124, v120, s78
    v_perm_b32 v167, v124, v120, s79
    v_perm_b32 v171, v125, v121, s78
    v_perm_b32 v175, v125, v121, s79
    v_perm_b32 v179, v126, v122, s78
    v_perm_b32 v183, v126, v122, s79
    v_perm_b32 v187, v127, v123, s78
    v_perm_b32 v191, v127, v123, s79
    v_perm_b32 v192, v132, v128, s78
    v_perm_b32 v196, v132, v128, s79
    v_perm_b32 v200, v133, v129, s78
    v_perm_b32 v204, v133, v129, s79
    v_perm_b32 v208, v134, v130, s78
    v_perm_b32 v212, v134, v130, s79
    v_perm_b32 v216, v135, v131, s78
    v_perm_b32 v220, v135, v131, s79
    v_perm_b32 v193, v140, v136, s78
    v_perm_b32 v197, v140, v136, s79
    v_perm_b32 v201, v141, v137, s78
    v_perm_b32 v205, v141, v137, s79
    v_perm_b32 v209, v142, v138, s78
    v_perm_b32 v213, v142, v138, s79
    v_perm_b32 v217, v143, v139, s78
    v_perm_b32 v221, v143, v139, s79
    v_perm_b32 v194, v148, v144, s78
    v_perm_b32 v198, v148, v144, s79
    v_perm_b32 v202, v149, v145, s78
    v_perm_b32 v206, v149, v145, s79
    v_perm_b32 v210, v150, v146, s78
    v_perm_b32 v214, v150, v146, s79
    v_perm_b32 v218, v151, v147, s78
    v_perm_b32 v222, v151, v147, s79
    v_perm_b32 v195, v156, v152, s78
    v_perm_b32 v199, v156, v152, s79
    v_perm_b32 v203, v157, v153, s78
    v_perm_b32 v207, v157, v153, s79
    v_perm_b32 v211, v158, v154, s78
    v_perm_b32 v215, v158, v154, s79
    v_perm_b32 v219, v159, v155, s78
    v_perm_b32 v223, v159, v155, s79
    v_lshlrev_b32 v17, 5, v2
    v_lshl_add_u32 v17, v3, 4, v17
    v_and_b32 v4, 15, v1
    v_lshrrev_b32 v5, 1, v4
    v_and_b32 v4, 1, v4
    v_lshlrev_b32 v4, 5, v4
    v_lshl_add_u32 v16, v5, 7, v4
    v_lshrrev_b32 v4, 3, v1
    v_and_b32 v5, 7, v1
    v_lshlrev_b32_e64 v5, 4, v5
    v_mul_u32_u24 v18, 9344, v4
    v_add_u32_e64 v18, v18, v5
    v_bfe_u32 v6, v1, 4, 1
    v_lshl_add_u32 v6, v6, 1, v3
    v_lshl_add_u32 v19, v6, 2, v5
    s_mul_i32 s84, s97, 149504
    s_lshl_b32 s77, s98, 7
    s_add_u32 s84, s84, s77
    s_add_u32 s84, s84, 8388608
    s_lshl_b32 s85, s62, 10
    s_add_u32 s85, s85, s99
    s_add_u32 s85, s85, 5120
    s_and_b32 s87, s97, 1
    s_lshl_b32 s87, s87, 4
    s_add_u32 s87, s87, s98
    s_lshr_b32 s86, s97, 1
    s_mul_i32 s86, s86, 299008
    s_lshl_b32 s77, s87, 7
    s_add_u32 s86, s86, s77
    s_add_u32 s86, s86, 8393728
    s_lshl_b32 s78, s62, 11
    s_add_u32 s79, s78, s99
    s_bitcmp1_b32 s100, 1
    s_cbranch_scc0 L_loc_24
    buffer_store_dwordx4 v[28:31], v12, s[40:43], s79 offen offset:1024
    buffer_store_dwordx4 v[28:31], v12, s[40:43], s79 offen offset:2048
L_pubd_25:
    s_lshl4_add_u32 s78, s97, s98
    s_lshl4_add_u32 s78, s78, s62
    s_add_u32 s78, s78, 12591116
    s_waitcnt vmcnt(0)
    s_mov_b64 exec, 1
    s_bitcmp1_b32 s100, 1
    s_cbranch_scc0 L_loc_26
    buffer_store_byte v28, v70, s[40:43], s78 offen
L_pubd_27:
    s_mov_b64 exec, -1
    s_cmp_eq_u32 s62, 0
    s_cbranch_scc0 L_nop3c_28
    s_mov_b32 exec_lo, 0
    s_mov_b32 s88, 0
L_spin_29:
    buffer_load_dword v4, v90, s[40:43], 0 offen offset:12 sc1
    s_waitcnt vmcnt(0)
    v_cmp_ne_u32_e64 vcc, -1, v4
    s_cbranch_vccz L_p3ok_30
    s_add_u32 s88, s88, 1
    s_cmp_lt_u32 s88, 65536
    s_cbranch_scc1 L_spin_29
L_p3ok_30:
    s_mov_b64 exec, -1
L_nop3c_28:
    s_barrier
    buffer_load_dwordx4 v[224:227], v77, s[52:55], s96 offen nt
    s_add_u32 s96, s96, 4096
    buffer_load_dwordx4 v[228:231], v77, s[52:55], s96 offen nt
    s_add_u32 s96, s96, 4096
    buffer_load_dwordx4 v[232:235], v77, s[52:55], s96 offen nt
    s_add_u32 s96, s96, 4096
    buffer_load_dwordx4 v[236:239], v77, s[52:55], s96 offen nt
    s_add_u32 s96, s96, 4096
    buffer_load_dwordx4 v[240:243], v77, s[52:55], s96 offen nt
    s_add_u32 s96, s96, 4096
    v_mul_u32_u24 v20, 149504, v1
    s_mul_i32 s72, s98, 9344
    s_lshl2_add_u32 s72, s97, s72
    s_add_u32 s72, s72, 8388608
    s_barrier
    s_cmp_eq_u32 s62, 1
    s_cbranch_scc0 L_nopre_31
    s_mov_b64 exec, 0xffff
    buffer_store_dword v70, v20, s[40:43], s72 offen offset:768 sc1
    s_mov_b64 exec, -1
L_nopre_31:
    buffer_load_dwordx4 v[244:247], v77, s[52:55], s96 offen nt
    s_add_u32 s96, s96, 4096
    buffer_load_dwordx4 v[248:251], v77, s[52:55], s96 offen nt
    s_add_u32 s96, s96, 4096
    buffer_load_dwordx4 v[252:255], v77, s[52:55], s96 offen nt
    s_add_u32 s96, s96, 4096
    s_barrier
    s_waitcnt vmcnt(7)
    s_mov_b32 s78, 0x05040100
    s_mov_b32 s79, 0x07060302
    v_permlane32_swap_b32 v224, v226
    v_permlane32_swap_b32 v225, v227
    v_perm_b32 v32, v226, v224, s78
    v_perm_b32 v33, v226, v224, s79
    v_perm_b32 v34, v227, v225, s78
    v_perm_b32 v35, v227, v225, s79
    s_waitcnt vmcnt(6)
    s_mov_b32 s78, 0x05040100
    s_mov_b32 s79, 0x07060302
    v_permlane32_swap_b32 v228, v230
    v_permlane32_swap_b32_e64 v229, v231
    v_perm_b32 v36, v230, v228, s78
    v_perm_b32 v37, v230, v228, s79
    v_perm_b32 v38, v231, v229, s78
    v_perm_b32 v39, v231, v229, s79
    s_waitcnt vmcnt(5)
    s_mov_b32 s78, 0x05040100
    s_mov_b32 s79, 0x07060302
    v_permlane32_swap_b32 v232, v234
    v_permlane32_swap_b32_e64 v233, v235
    v_perm_b32 v40, v234, v232, s78
    v_perm_b32 v41, v234, v232, s79
    v_perm_b32 v42, v235, v233, s78
    v_perm_b32 v43, v235, v233, s79
    s_waitcnt vmcnt(4)
    s_mov_b32 s78, 0x05040100
    s_mov_b32 s79, 0x07060302
    v_permlane32_swap_b32 v236, v238
    v_permlane32_swap_b32_e64 v237, v239
    v_perm_b32 v44, v238, v236, s78
    v_perm_b32 v45, v238, v236, s79
    v_perm_b32 v46, v239, v237, s78
    v_perm_b32 v47, v239, v237, s79
    s_waitcnt vmcnt(3)
    s_mov_b32 s78, 0x05040100
    s_mov_b32 s79, 0x07060302
    v_permlane32_swap_b32 v240, v242
    v_permlane32_swap_b32_e64 v241, v243
    v_perm_b32 v48, v242, v240, s78
    v_perm_b32 v49, v242, v240, s79
    v_perm_b32 v50, v243, v241, s78
    v_perm_b32 v51, v243, v241, s79
    s_waitcnt vmcnt(2)
    s_mov_b32 s78, 0x05040100
    s_mov_b32 s79, 0x07060302
    v_permlane32_swap_b32 v244, v246
    v_permlane32_swap_b32_e64 v245, v247
    v_perm_b32 v52, v246, v244, s78
    v_perm_b32 v53, v246, v244, s79
    v_perm_b32 v54, v247, v245, s78
    v_perm_b32 v55, v247, v245, s79
    s_waitcnt vmcnt(1)
    s_mov_b32 s78, 0x05040100
    s_mov_b32 s79, 0x07060302
    v_permlane32_swap_b32 v248, v250
    v_permlane32_swap_b32_e64 v249, v251
    v_perm_b32 v56, v250, v248, s78
    v_perm_b32 v57, v250, v248, s79
    v_perm_b32 v58, v251, v249, s78
    v_perm_b32 v59, v251, v249, s79
    s_waitcnt vmcnt(0)
    s_mov_b32 s78, 0x05040100
    s_mov_b32 s79, 0x07060302
    v_permlane32_swap_b32 v252, v254
    v_permlane32_swap_b32_e64 v253, v255
    v_perm_b32 v60, v254, v252, s78
    v_perm_b32 v61, v254, v252, s79
    v_perm_b32 v62, v255, v253, s78
    v_perm_b32 v63, v255, v253, s79
    v_and_b32 v5, 15, v1
    v_lshlrev_b32 v5, 3, v5
    s_lshl_b32 s76, s63, 10
    s_lshl_b32 s77, s64, 6
    s_add_u32 s76, s76, s77
    s_add_u32 s76, s76, s99
    s_mov_b64 s[80:81], 0xffff
    s_add_u32 s68, s84, 74752
    s_add_u32 s69, s86, 74752
    s_add_u32 s70, s86, 149504
    s_add_u32 s71, s86, 224256
    s_setprio 3
    s_barrier
    ds_read_b128 v[64:67], v12 offset:28672
    ds_read_b128 v[68:71], v12 offset:29696
    ds_read_b64 v[8:9], v5 offset:25728
    s_waitcnt lgkmcnt(2)
    v_mfma_f32_16x16x32_bf16 v[96:99], v[64:67], v[160:163], 0
    v_mfma_f32_16x16x32_bf16 v[100:103], v[64:67], v[164:167], 0
    s_waitcnt lgkmcnt(0)
    v_max_f32_dpp v4, v8, v8 row_ror:8 row_mask:0xf bank_mask:0xf
    v_mfma_f32_16x16x32_bf16 v[104:107], v[64:67], v[168:171], 0
    v_mfma_f32_16x16x32_bf16 v[108:111], v[64:67], v[172:175], 0
    v_max_f32_dpp v4, v4, v4 row_ror:4 row_mask:0xf bank_mask:0xf
    v_mfma_f32_16x16x32_bf16 v[112:115], v[64:67], v[176:179], 0
    v_mfma_f32_16x16x32_bf16 v[116:119], v[64:67], v[180:183], 0
    v_max_f32_dpp v4, v4, v4 row_ror:2 row_mask:0xf bank_mask:0xf
    v_mfma_f32_16x16x32_bf16 v[120:123], v[64:67], v[184:187], 0
    v_mfma_f32_16x16x32_bf16 v[124:127], v[64:67], v[188:191], 0
    v_max_f32_dpp v4, v4, v4 row_ror:1 row_mask:0xf bank_mask:0xf
    v_mfma_f32_16x16x32_bf16 v[96:99], v[68:71], v[192:195], v[96:99]
    v_cmp_eq_f32_e64 vcc, v4, v8
    v_mfma_f32_16x16x32_bf16 v[100:103], v[68:71], v[196:199], v[100:103]
    s_ff1_i32_b32 s92, vcc_lo
    s_and_b32 s92, s92, 15
    v_mfma_f32_16x16x32_bf16 v[104:107], v[68:71], v[200:203], v[104:107]
    s_lshr_b32 s78, s92, 2
    s_lshl_b32 s78, s78, 4
    v_mfma_f32_16x16x32_bf16 v[108:111], v[68:71], v[204:207], v[108:111]
    s_and_b32 s77, s92, 3
    v_mfma_f32_16x16x32_bf16 v[112:115], v[68:71], v[208:211], v[112:115]
    v_readlane_b32 s91, v9, s92
    v_readlane_b32 s93, v8, s92
    v_mfma_f32_16x16x32_bf16 v[116:119], v[68:71], v[212:215], v[116:119]
    v_mfma_f32_16x16x32_bf16 v[120:123], v[68:71], v[216:219], v[120:123]
    v_mfma_f32_16x16x32_bf16 v[124:127], v[68:71], v[220:223], v[124:127]
    s_cmp_ge_u32 s97, 14
    s_cbranch_scc1 L_final
    s_lshl_b64 exec, s[80:81], s78
    s_set_gpr_idx_on s77, gpr_idx(SRC0)
    v_mov_b32 v64, v96
    v_mov_b32 v65, v100
    v_mov_b32 v66, v104
    v_mov_b32 v67, v108
    v_mov_b32 v68, v112
    v_mov_b32 v69, v116
    v_mov_b32 v70, v120
    v_mov_b32 v71, v124
    s_set_gpr_idx_off
    s_bitcmp1_b32 s100, 1
    s_cbranch_scc0 L_loc_32
    buffer_store_dwordx4 v[64:67], v16, s[40:43], s76 offen offset:3072
    buffer_store_dwordx4 v[68:71], v16, s[40:43], s76 offen offset:3088
L_pubd_33:
    s_mov_b64 exec, -1
    s_branch L_fit_ffn2
.fill 29, 4, 0xbf800000
L_fit_ffn2:
    s_mov_b64 s[0:1], -2
L_poll_34:
    buffer_load_dwordx4 v[128:131], v18, s[40:43], s84 offen offset:3072 sc1
    buffer_load_dwordx4 v[132:135], v18, s[40:43], s68 offen offset:3072 sc1
    s_add_u32 s1, s1, 1
    s_lshr_b32 s0, s1, 16
    s_or_b32 s0, s0, -2
    s_waitcnt vmcnt(0)
    v_max_u32_e64 v4, v128, v132
    v_cmp_lt_u32 vcc, s0, v4
    s_cbranch_vccnz L_poll_34
    v_pk_add_f32 v[152:153], v[128:129], v[132:133]
    v_pk_add_f32 v[154:155], v[130:131], v[134:135]
    s_nop 0
    v_permlane32_swap_b32 v152, v153
    v_permlane32_swap_b32 v154, v155
    v_add_f32 v152, v152, v153
    v_add_f32 v154, v154, v155
    s_nop 1
    v_permlane16_swap_b32 v152, v154
    v_add_f32_e64 v152, v152, v154
    s_nop 1
    v_add_f32_dpp v152, v152, v152 row_ror:8 row_mask:0xf bank_mask:0xf
    v_cvt_pk_bf16_f32 v152, v152, v152
    v_and_b32_e64 v152, s90, v152
    v_mul_f32 v4, 0xbfb8aa3b, v152
    v_exp_f32_e64 v4, v4
    v_mov_b32_dpp v153, v152 row_ror:12 row_mask:0xf bank_mask:0xf
    v_add_f32 v4, 1.0, v4
    v_rcp_f32 v4, v4
    s_nop 0
    v_mul_f32 v4, v4, v152
    v_cvt_pk_bf16_f32 v4, v4, v4
    v_and_b32 v4, s90, v4
    v_mul_f32 v4, v4, v153
    v_mov_b32 v5, v4
    s_nop 1
    v_permlane32_swap_b32_e64 v4, v5
    v_cvt_pk_bf16_f32 v4, v4, v5
    s_nop 0
    v_readlane_b32 s76, v4, 0
    v_readlane_b32 s77, v4, 16
    v_readlane_b32 s78, v4, 1
    v_readlane_b32 s79, v4, 17
    v_readlane_b32 s80, v4, 2
    v_readlane_b32 s81, v4, 18
    v_readlane_b32 s82, v4, 3
    v_readlane_b32 s83, v4, 19
    v_dot2_f32_bf16 v20, v32, s76, 0
    v_dot2_f32_bf16 v21, v33, s76, 0
    v_dot2_f32_bf16 v22, v34, s76, 0
    v_dot2_f32_bf16 v23, v35, s76, 0
    v_dot2_f32_bf16 v20, v36, s77, v20
    v_dot2_f32_bf16 v21, v37, s77, v21
    v_dot2_f32_bf16 v22, v38, s77, v22
    v_dot2_f32_bf16 v23, v39, s77, v23
    v_dot2_f32_bf16 v20, v40, s78, v20
    v_dot2_f32_bf16 v21, v41, s78, v21
    v_dot2_f32_bf16 v22, v42, s78, v22
    v_dot2_f32_bf16 v23, v43, s78, v23
    v_dot2_f32_bf16 v20, v44, s79, v20
    v_dot2_f32_bf16 v21, v45, s79, v21
    v_dot2_f32_bf16 v22, v46, s79, v22
    v_dot2_f32_bf16 v23, v47, s79, v23
    v_dot2_f32_bf16 v20, v48, s80, v20
    v_dot2_f32_bf16 v21, v49, s80, v21
    v_dot2_f32_bf16 v22, v50, s80, v22
    v_dot2_f32_bf16 v23, v51, s80, v23
    v_dot2_f32_bf16 v20, v52, s81, v20
    v_dot2_f32_bf16 v21, v53, s81, v21
    v_dot2_f32_bf16 v22, v54, s81, v22
    v_dot2_f32_bf16 v23, v55, s81, v23
    v_dot2_f32_bf16 v20, v56, s82, v20
    v_dot2_f32_bf16 v21, v57, s82, v21
    v_dot2_f32_bf16 v22, v58, s82, v22
    v_dot2_f32_bf16 v23, v59, s82, v23
    v_dot2_f32_bf16 v20, v60, s83, v20
    v_dot2_f32_bf16 v21, v61, s83, v21
    v_dot2_f32_bf16 v22, v62, s83, v22
    v_dot2_f32_bf16 v23, v63, s83, v23
    s_bitcmp1_b32 s100, 1
    s_cbranch_scc0 L_loc_35
    s_nop 0
    buffer_store_dwordx4 v[20:23], v17, s[40:43], s85 offen
L_pubd_36:
    s_cmp_eq_u32 s62, 0
    s_cbranch_scc0 L_hby
    s_mov_b64 s[0:1], -2
L_poll_37:
    buffer_load_dwordx4 v[136:139], v18, s[40:43], s86 offen sc1
    buffer_load_dwordx4 v[140:143], v18, s[40:43], s69 offen sc1
    buffer_load_dwordx4 v[144:147], v18, s[40:43], s70 offen sc1
    buffer_load_dwordx4 v[148:151], v18, s[40:43], s71 offen sc1
    s_add_u32 s1, s1, 1
    s_lshr_b32 s0, s1, 16
    s_or_b32 s0, s0, -2
    s_waitcnt vmcnt(0)
    v_max3_u32 v4, v136, v140, v144
    v_max_u32 v4, v4, v148
    v_cmp_lt_u32 vcc, s0, v4
    s_cbranch_vccnz L_poll_37
    v_pk_add_f32 v[152:153], v[136:137], v[144:145]
    v_pk_add_f32 v[154:155], v[138:139], v[146:147]
    v_pk_add_f32 v[156:157], v[140:141], v[148:149]
    v_pk_add_f32 v[158:159], v[142:143], v[150:151]
    v_pk_add_f32 v[152:153], v[152:153], v[156:157]
    v_pk_add_f32 v[154:155], v[154:155], v[158:159]
    s_nop 0
    v_permlane32_swap_b32 v152, v153
    v_permlane32_swap_b32 v154, v155
    v_add_f32 v152, v152, v153
    v_add_f32 v154, v154, v155
    s_nop 1
    v_permlane16_swap_b32 v152, v154
    v_add_f32_e64 v152, v152, v154
    s_nop 1
    v_add_f32_dpp v152, v152, v152 row_ror:8 row_mask:0xf bank_mask:0xf
    buffer_store_dword v152, v19, s[40:43], s99 offen offset:512 sc1
L_hby:
    s_barrier
    s_lshl2_add_u32 s72, s87, s62
    s_cmp_eq_u32 s72, 0
    s_cbranch_scc0 L_nowb_38
    s_waitcnt vmcnt(0)
    buffer_wbl2 sc1
L_nowb_38:
    s_branch L_hfin
L_final:
    s_barrier
    s_lshl2_add_u32 s72, s87, s62
    s_cmp_eq_u32 s72, 3
    s_cbranch_scc0 L_nowb_39
    s_waitcnt vmcnt(0)
    buffer_wbl2 sc1
L_nowb_39:
    s_cmp_eq_u32 s62, 1
    s_cbranch_scc0 L_noep_40
    s_cmp_eq_u32 s87, 0
    s_cbranch_scc0 L_noep_40
    v_mov_b32 v4, 13631488
    s_mov_b64 exec, 1
    buffer_store_dwordx2 v[88:89], v4, s[40:43], 0 offen sc1
    s_mov_b64 exec, -1
L_noep_40:
    s_cmp_eq_u32 s62, 0
    s_cbranch_scc0 L_hfin
    v_mov_b32 v8, s93
    v_cvt_pk_bf16_f32 v8, v8, v8
    v_and_b32_e64 v8, s90, v8
    v_mul_f32 v8, 0xbfb8aa3b, v8
    v_exp_f32 v8, v8
    s_nop 0
    v_add_f32 v8, 1.0, v8
    v_rcp_f32_e64 v8, v8
    s_nop 0
    v_cvt_pk_bf16_f32 v8, v8, v8
    v_and_b32 v8, s90, v8
    s_lshl_b32 s76, s92, 4
    s_lshr_b32 s77, s87, 1
    s_add_u32 s76, s76, s77
    s_mul_i32 s76, s76, 9344
    s_add_u32 s76, s76, 8388608
    s_and_b32 s77, s87, 1
    s_lshl_b32 s77, s77, 5
    s_add_u32 s76, s76, s77
    v_and_b32 v10, 1, v1
    v_lshlrev_b32_e64 v10, 6, v10
    v_bfe_u32 v4, v1, 1, 2
    v_lshl_add_u32 v10, v4, 3, v10
    v_bfe_u32 v4, v1, 4, 1
    v_lshl_add_u32 v10, v4, 2, v10
    v_lshrrev_b32_e64 v4, 3, v1
    v_mul_u32_u24 v6, 299008, v4
    v_and_b32_e64 v5, 7, v1
    v_lshl_add_u32 v6, v5, 4, v6
    v_mov_b32 v7, 2146435072
    v_cmp_gt_u32 vcc, 56, v1
    s_nop 1
    v_cndmask_b32_e64 v6, v7, v6, vcc
    s_mul_i32 s79, s87, 9344
    s_add_u32 s79, s79, 8388608
    s_lshl_b32 s80, s91, 11
    s_lshl_b32 s77, s87, 6
    s_add_u32 s80, s80, s77
    s_mov_b64 s[0:1], -2
L_spin_41:
    buffer_load_dword v64, v10, s[40:43], s76 offen offset:0 sc1
    buffer_load_dword v65, v10, s[40:43], s76 offen offset:128 sc1
    s_add_u32 s1, s1, 1
    s_lshr_b32 s0, s1, 16
    s_or_b32 s0, s0, -2
    s_waitcnt vmcnt(0)
    v_max_u32 v4, v64, v65
    v_cmp_lt_u32 vcc, s0, v4
    s_cbranch_vccnz L_spin_41
    v_lshlrev_b32 v4, 4, v3
    v_lshrrev_b32 v64, v4, v64
    v_lshrrev_b32 v65, v4, v65
    v_lshlrev_b32 v64, 16, v64
    v_lshlrev_b32 v65, 16, v65
    v_lshrrev_b32 v9, 1, v19
    s_mov_b64 s[0:1], -2
    buffer_load_dwordx4 v[128:131], v6, s[40:43], s79 offen offset:512 sc1
    buffer_load_dwordx4 v[128:131], v6, s[40:43], s79 offen offset:512 sc1
L_poll_42:
    buffer_load_dwordx4 v[128:131], v6, s[40:43], s79 offen offset:512 sc1
    s_add_u32 s1, s1, 1
    s_lshr_b32 s0, s1, 16
    s_or_b32 s0, s0, -2
    s_waitcnt vmcnt(2)
    v_max3_u32 v4, v128, v129, v130
    v_max_u32 v4, v4, v131
    v_cmp_lt_u32 vcc, s0, v4
    s_cbranch_vccnz L_poll_42
    v_mov_b32 v152, v128
    v_mov_b32 v153, v129
    v_mov_b32 v154, v130
    v_mov_b32 v155, v131
    v_permlane32_swap_b32 v152, v153
    s_nop 0
    v_permlane32_swap_b32 v154, v155
    v_add_f32 v152, v152, v153
    v_add_f32 v154, v154, v155
    s_nop 1
    v_permlane16_swap_b32 v152, v154
    v_add_f32 v152, v152, v154
    s_nop 1
    v_add_f32_dpp v152, v152, v152 row_ror:8 row_mask:0xf bank_mask:0xf
    v_cvt_pk_bf16_f32 v152, v152, v152
    v_and_b32 v152, s90, v152
    v_mul_f32 v152, v152, v8
    v_cvt_pk_bf16_f32 v152, v152, v152
    v_and_b32 v152, s90, v152
    v_add_f32 v152, v152, v64
    v_cvt_pk_bf16_f32 v152, v152, v152
    v_and_b32 v152, s90, v152
    v_add_f32 v152, v152, v65
    v_cvt_pk_bf16_f32 v152, v152, v152
    s_mov_b32 exec_lo, 0x00ff00ff
    s_mov_b32 exec_hi, 0x00ff00ff
    buffer_store_short v152, v9, s[44:47], s80 offen sc1
    s_mov_b64 exec, -1
L_hfin:
    s_endpgm
L_event:
    s_cmp_eq_u32 s77, 3
    s_cbranch_scc0 L_ev1
    buffer_load_dwordx4 v[92:95], v90, s[40:43], 0 offen sc1
    s_mov_b64 exec, 3
    global_load_dword v27, v91, s[66:67]
    s_mov_b64 exec, -1
    s_branch L_evret
L_ev1:
    s_cmp_eq_u32 s77, 5
    s_cbranch_scc0 L_ev_43
    s_add_u32 m0, s70, 8192
    s_nop 0
    buffer_load_dwordx4 v25, s[32:35], s72 offen offset:1024 lds
    s_add_u32 s70, s70, 40960
    s_cmp_ge_u32 s70, 122880
    s_cselect_b32 s76, 122880, 0
    s_sub_u32 s70, s70, s76
    buffer_load_dwordx4 v[96:99], v76, s[48:51], s75 offen nt
    s_add_u32 s75, s75, 7168
    buffer_load_dwordx4 v[100:103], v76, s[48:51], s75 offen nt
    s_add_u32 s75, s75, 7168
    buffer_load_dwordx4 v[104:107], v76, s[48:51], s75 offen nt
    s_add_u32 s75, s75, 7168
    buffer_load_dwordx4 v[108:111], v76, s[48:51], s75 offen nt
    s_add_u32 s75, s75, 7168
    buffer_load_dwordx4 v[128:131], v76, s[48:51], s75 offen nt
    s_add_u32 s75, s75, 7168
    buffer_load_dwordx4 v[132:135], v76, s[48:51], s75 offen nt
    s_add_u32 s75, s75, 7168
    buffer_load_dwordx4 v[136:139], v76, s[48:51], s75 offen nt
    s_add_u32 s75, s75, 7168
    buffer_load_dwordx4 v[140:143], v76, s[48:51], s75 offen nt
    s_add_u32 s75, s75, 7168
    s_lshr_b64 s[86:87], s[86:87], 4
    s_add_u32 s68, s68, 1
    s_waitcnt vmcnt(8)
    s_barrier
    s_and_b32 s72, s84, 15
    s_mov_b32 m0, s70
    s_lshl_b32 s71, s72, 7
    buffer_load_dwordx4 v16, s[28:31], s71 offen offset:0 lds
    s_mul_i32 s72, s72, 393216
    s_lshr_b64 s[84:85], s[84:85], 4
    buffer_load_dwordx4 v17, s[28:31], s71 offen offset:1024 lds
    buffer_load_dwordx4 v18, s[28:31], s71 offen offset:2048 lds
    buffer_load_dwordx4 v19, s[28:31], s71 offen offset:3072 lds
    s_add_u32 m0, s70, 4096
    s_nop 0
    buffer_load_dwordx4 v20, s[32:35], s72 offen offset:0 lds
    buffer_load_dwordx4 v21, s[32:35], s72 offen offset:1024 lds
    buffer_load_dwordx4 v22, s[32:35], s72 offen offset:2048 lds
    buffer_load_dwordx4 v23, s[32:35], s72 offen offset:3072 lds
    s_add_u32 m0, s70, 8192
    s_nop 0
    buffer_load_dwordx4 v24, s[32:35], s72 offen offset:0 lds
    s_cmp_lt_u32 s68, 14
    s_cbranch_scc1 L_hloop
    s_branch L_hdone
L_ev_43:
    s_cmp_eq_u32 s77, 6
    s_cbranch_scc0 L_ev_44
    s_add_u32 m0, s70, 8192
    s_nop 0
    buffer_load_dwordx4 v25, s[32:35], s72 offen offset:1024 lds
    s_add_u32 s70, s70, 40960
    s_cmp_ge_u32 s70, 122880
    s_cselect_b32 s76, 122880, 0
    s_sub_u32 s70, s70, s76
    s_lshl_b32 s78, s62, 9
    v_lshl_add_u32 v11, v1, 7, s78
    s_mov_b64 exec, 15
    global_load_dword v27, v11, s[14:15]
    s_mov_b64 exec, -1
    buffer_load_dwordx4 v[112:115], v76, s[48:51], s75 offen nt
    s_add_u32 s75, s75, 7168
    buffer_load_dwordx4 v[116:119], v76, s[48:51], s75 offen nt
    s_add_u32 s75, s75, 7168
    buffer_load_dwordx4 v[120:123], v76, s[48:51], s75 offen nt
    s_add_u32 s75, s75, 7168
    buffer_load_dwordx4 v[124:127], v76, s[48:51], s75 offen nt
    s_add_u32 s75, s75, 7168
    buffer_load_dwordx4 v[144:147], v76, s[48:51], s75 offen nt
    s_add_u32 s75, s75, 7168
    buffer_load_dwordx4 v[148:151], v76, s[48:51], s75 offen nt
    s_add_u32 s75, s75, 7168
    buffer_load_dwordx4 v[152:155], v76, s[48:51], s75 offen nt
    s_add_u32 s75, s75, 7168
    buffer_load_dwordx4 v[156:159], v76, s[48:51], s75 offen nt
    s_add_u32 s75, s75, 7168
    s_lshr_b64 s[86:87], s[86:87], 4
    s_add_u32 s68, s68, 1
    s_waitcnt vmcnt(9)
    s_barrier
    s_and_b32 s72, s84, 15
    s_mov_b32 m0, s70
    s_lshl_b32 s71, s72, 7
    buffer_load_dwordx4 v16, s[28:31], s71 offen offset:0 lds
    s_mul_i32 s72, s72, 393216
    s_lshr_b64 s[84:85], s[84:85], 4
    buffer_load_dwordx4 v17, s[28:31], s71 offen offset:1024 lds
    buffer_load_dwordx4 v18, s[28:31], s71 offen offset:2048 lds
    buffer_load_dwordx4 v19, s[28:31], s71 offen offset:3072 lds
    s_add_u32 m0, s70, 4096
    s_nop 0
    buffer_load_dwordx4 v20, s[32:35], s72 offen offset:0 lds
    buffer_load_dwordx4 v21, s[32:35], s72 offen offset:1024 lds
    buffer_load_dwordx4 v22, s[32:35], s72 offen offset:2048 lds
    buffer_load_dwordx4 v23, s[32:35], s72 offen offset:3072 lds
    s_add_u32 m0, s70, 8192
    s_nop 0
    buffer_load_dwordx4 v24, s[32:35], s72 offen offset:0 lds
    s_cmp_lt_u32 s68, 14
    s_cbranch_scc1 L_hloop
    s_branch L_hdone
L_ev_44:
    s_add_u32 s78, s70, 81920
    s_cmp_ge_u32 s78, 122880
    s_cselect_b32 s76, 122880, 0
    s_sub_u32 s78, s78, s76
    s_cmp_eq_u32 s77, 2
    s_cbranch_scc1 L_evw
    v_add_u32 v4, s78, v72
    v_xor_b32 v5, 32, v4
    v_xor_b32 v6, 64, v4
    v_xor_b32 v7, 96, v4
    s_add_u32 m0, s70, 8192
    s_nop 0
    buffer_load_dwordx4 v25, s[32:35], s72 offen offset:1024 lds
    s_add_u32 s70, s70, 40960
    s_cmp_ge_u32 s70, 122880
    s_cselect_b32 s76, 122880, 0
    s_sub_u32 s70, s70, s76
    ds_read_b128 v[32:35], v4
    ds_read_b128 v[36:39], v5
    ds_read_b128 v[40:43], v6
    ds_read_b128 v[44:47], v7
    s_and_b32 s72, s84, 15
    s_mov_b32 m0, s70
    s_lshl_b32 s71, s72, 7
    buffer_load_dwordx4 v16, s[28:31], s71 offen offset:0 lds
    s_mul_i32 s72, s72, 393216
    s_lshr_b64 s[84:85], s[84:85], 4
    s_lshl_b32 s79, s62, 8
    s_add_u32 s79, s79, s73
    s_waitcnt lgkmcnt(0)
    v_lshlrev_b32 v8, 16, v32
    v_and_b32 v9, s90, v32
    v_add_f32 v80, v80, v8
    v_add_f32 v82, v82, v9
    v_fmac_f32 v81, v8, v8
    v_fmac_f32 v83, v9, v9
    v_lshlrev_b32 v10, 16, v33
    v_and_b32 v11, s90, v33
    v_add_f32 v80, v80, v10
    v_add_f32 v82, v82, v11
    v_fmac_f32 v81, v10, v10
    v_fmac_f32_e64 v83, v11, v11
    buffer_load_dwordx4 v17, s[28:31], s71 offen offset:1024 lds
    v_lshlrev_b32 v8, 16, v34
    v_and_b32 v9, s90, v34
    v_add_f32 v80, v80, v8
    v_add_f32 v82, v82, v9
    v_fmac_f32 v81, v8, v8
    v_fmac_f32 v83, v9, v9
    v_lshlrev_b32 v10, 16, v35
    v_and_b32 v11, s90, v35
    v_add_f32 v80, v80, v10
    v_add_f32 v82, v82, v11
    v_fmac_f32 v81, v10, v10
    v_fmac_f32 v83, v11, v11
    buffer_load_dwordx4 v18, s[28:31], s71 offen offset:2048 lds
    v_lshlrev_b32 v8, 16, v36
    v_and_b32 v9, s90, v36
    v_add_f32 v80, v80, v8
    v_add_f32 v82, v82, v9
    v_fmac_f32 v81, v8, v8
    v_fmac_f32 v83, v9, v9
    v_lshlrev_b32 v10, 16, v37
    v_and_b32 v11, s90, v37
    v_add_f32 v80, v80, v10
    v_add_f32 v82, v82, v11
    v_fmac_f32 v81, v10, v10
    v_fmac_f32 v83, v11, v11
    buffer_load_dwordx4 v19, s[28:31], s71 offen offset:3072 lds
    v_lshlrev_b32 v8, 16, v38
    v_and_b32 v9, s90, v38
    v_add_f32 v80, v80, v8
    v_add_f32 v82, v82, v9
    v_fmac_f32 v81, v8, v8
    v_fmac_f32 v83, v9, v9
    v_lshlrev_b32 v10, 16, v39
    v_and_b32 v11, s90, v39
    v_add_f32 v80, v80, v10
    v_add_f32 v82, v82, v11
    v_fmac_f32 v81, v10, v10
    v_fmac_f32 v83, v11, v11
    s_add_u32 m0, s70, 4096
    s_nop 0
    buffer_load_dwordx4 v20, s[32:35], s72 offen offset:0 lds
    v_lshlrev_b32 v8, 16, v40
    v_and_b32 v9, s90, v40
    v_add_f32 v80, v80, v8
    v_add_f32 v82, v82, v9
    v_fmac_f32 v81, v8, v8
    v_fmac_f32 v83, v9, v9
    v_lshlrev_b32 v10, 16, v41
    v_and_b32 v11, s90, v41
    v_add_f32 v80, v80, v10
    v_add_f32 v82, v82, v11
    v_fmac_f32 v81, v10, v10
    v_fmac_f32_e64 v83, v11, v11
    buffer_load_dwordx4 v21, s[32:35], s72 offen offset:1024 lds
    v_lshlrev_b32 v8, 16, v42
    v_and_b32 v9, s90, v42
    v_add_f32 v80, v80, v8
    v_add_f32 v82, v82, v9
    v_fmac_f32 v81, v8, v8
    v_fmac_f32 v83, v9, v9
    v_lshlrev_b32 v10, 16, v43
    v_and_b32 v11, s90, v43
    v_add_f32 v80, v80, v10
    v_add_f32 v82, v82, v11
    v_fmac_f32 v81, v10, v10
    v_fmac_f32 v83, v11, v11
    buffer_load_dwordx4 v22, s[32:35], s72 offen offset:2048 lds
    v_lshlrev_b32 v8, 16, v44
    v_and_b32 v9, s90, v44
    v_add_f32 v80, v80, v8
    v_add_f32 v82, v82, v9
    v_fmac_f32 v81, v8, v8
    v_fmac_f32 v83, v9, v9
    v_lshlrev_b32 v10, 16, v45
    v_and_b32 v11, s90, v45
    v_add_f32 v80, v80, v10
    v_add_f32 v82, v82, v11
    v_fmac_f32 v81, v10, v10
    v_fmac_f32 v83, v11, v11
    buffer_load_dwordx4 v23, s[32:35], s72 offen offset:3072 lds
    v_lshlrev_b32 v8, 16, v46
    v_and_b32 v9, s90, v46
    v_add_f32 v80, v80, v8
    v_add_f32 v82, v82, v9
    v_fmac_f32 v81, v8, v8
    v_fmac_f32 v83, v9, v9
    v_lshlrev_b32 v10, 16, v47
    v_and_b32 v11, s90, v47
    v_add_f32 v80, v80, v10
    v_add_f32 v82, v82, v11
    v_fmac_f32 v81, v10, v10
    v_fmac_f32 v83, v11, v11
    s_add_u32 m0, s70, 8192
    s_nop 0
    buffer_load_dwordx4 v24, s[32:35], s72 offen offset:0 lds
    s_xor_b32 s69, s69, 1
    s_cbranch_scc1 L_hw10
    v_add_f32 v80, v80, v82
    v_add_f32 v81, v81, v83
    v_mov_b32 v82, v80
    v_mov_b32 v83, v81
    s_nop 0
    v_permlane32_swap_b32 v80, v82
    v_permlane32_swap_b32 v81, v83
    v_add_f32 v80, v80, v82
    v_add_f32_e64 v81, v81, v83
    s_mov_b32 exec_hi, 0
    buffer_store_dwordx2 v[80:81], v74, s[40:43], s79 offen offset:0 sc1
    s_mov_b64 exec, -1
    s_waitcnt vmcnt(10)
    s_branch L_hbar
L_evw:
    s_mul_i32 s79, s63, 2048
    s_add_u32 s79, s79, s78
    v_add_u32_e64 v4, s79, v73
    s_mul_i32 s79, s63, 20480
    s_add_u32 s79, s79, s78
    v_add_u32 v5, s79, v73
    s_add_u32 m0, s70, 8192
    s_nop 0
    buffer_load_dwordx4 v25, s[32:35], s72 offen offset:1024 lds
    s_add_u32 s70, s70, 40960
    s_cmp_ge_u32 s70, 122880
    s_cselect_b32 s76, 122880, 0
    s_sub_u32 s70, s70, s76
    ds_read_b64_tr_b16 v[32:33], v4 offset:0
    ds_read_b64_tr_b16 v[34:35], v4 offset:512
    ds_read_b64_tr_b16 v[36:37], v4 offset:10240
    ds_read_b64_tr_b16 v[38:39], v4 offset:10752
    ds_read_b64_tr_b16 v[40:41], v4 offset:20480
    ds_read_b64_tr_b16 v[42:43], v4 offset:20992
    ds_read_b64_tr_b16 v[44:45], v4 offset:30720
    ds_read_b64_tr_b16 v[46:47], v4 offset:31232
    ds_read_b64_tr_b16 v[48:49], v5 offset:4096
    ds_read_b64_tr_b16 v[50:51], v5 offset:4608
    ds_read_b64_tr_b16 v[52:53], v5 offset:14336
    ds_read_b64_tr_b16 v[54:55], v5 offset:14848
    s_and_b32 s72, s84, 15
    s_mov_b32 m0, s70
    s_lshl_b32 s71, s72, 7
    buffer_load_dwordx4 v16, s[28:31], s71 offen offset:0 lds
    s_mul_i32 s72, s72, 393216
    s_lshr_b64 s[84:85], s[84:85], 4
    s_lshl_b32 s79, s64, 9
    s_lshl_b32 s80, s63, 3
    s_add_u32 s79, s79, s80
    s_add_u32 s79, s79, s73
    s_waitcnt lgkmcnt(0)
    v_lshlrev_b32 v8, 16, v32
    v_and_b32 v9, s90, v32
    v_add_f32 v80, v80, v8
    v_add_f32 v82, v82, v9
    v_lshlrev_b32 v10, 16, v33
    v_and_b32 v11, s90, v33
    v_add_f32 v80, v80, v10
    v_add_f32 v82, v82, v11
    v_lshlrev_b32 v8, 16, v34
    v_and_b32 v9, s90, v34
    v_add_f32 v80, v80, v8
    v_add_f32_e64 v82, v82, v9
    buffer_load_dwordx4 v17, s[28:31], s71 offen offset:1024 lds
    v_lshlrev_b32 v10, 16, v35
    v_and_b32 v11, s90, v35
    v_add_f32 v80, v80, v10
    v_add_f32 v82, v82, v11
    v_lshlrev_b32 v8, 16, v36
    v_and_b32 v9, s90, v36
    v_add_f32 v80, v80, v8
    v_add_f32 v82, v82, v9
    v_lshlrev_b32 v10, 16, v37
    v_and_b32 v11, s90, v37
    v_add_f32 v80, v80, v10
    v_add_f32 v82, v82, v11
    buffer_load_dwordx4 v18, s[28:31], s71 offen offset:2048 lds
    v_lshlrev_b32 v8, 16, v38
    v_and_b32 v9, s90, v38
    v_add_f32 v80, v80, v8
    v_add_f32 v82, v82, v9
    v_lshlrev_b32 v10, 16, v39
    v_and_b32 v11, s90, v39
    v_add_f32 v80, v80, v10
    v_add_f32 v82, v82, v11
    v_lshlrev_b32 v8, 16, v40
    v_and_b32 v9, s90, v40
    v_add_f32 v80, v80, v8
    v_add_f32 v82, v82, v9
    buffer_load_dwordx4 v19, s[28:31], s71 offen offset:3072 lds
    v_lshlrev_b32 v10, 16, v41
    v_and_b32 v11, s90, v41
    v_add_f32 v80, v80, v10
    v_add_f32 v82, v82, v11
    v_lshlrev_b32 v8, 16, v42
    v_and_b32 v9, s90, v42
    v_add_f32 v80, v80, v8
    v_add_f32 v82, v82, v9
    v_lshlrev_b32 v10, 16, v43
    v_and_b32 v11, s90, v43
    v_add_f32 v80, v80, v10
    v_add_f32 v82, v82, v11
    s_add_u32 m0, s70, 4096
    s_nop 0
    buffer_load_dwordx4 v20, s[32:35], s72 offen offset:0 lds
    v_lshlrev_b32 v8, 16, v44
    v_and_b32 v9, s90, v44
    v_add_f32 v80, v80, v8
    v_add_f32 v82, v82, v9
    v_lshlrev_b32 v10, 16, v45
    v_and_b32 v11, s90, v45
    v_add_f32 v80, v80, v10
    v_add_f32 v82, v82, v11
    v_lshlrev_b32 v8, 16, v46
    v_and_b32 v9, s90, v46
    v_add_f32 v80, v80, v8
    v_add_f32_e64 v82, v82, v9
    buffer_load_dwordx4 v21, s[32:35], s72 offen offset:1024 lds
    v_lshlrev_b32 v10, 16, v47
    v_and_b32 v11, s90, v47
    v_add_f32 v80, v80, v10
    v_add_f32 v82, v82, v11
    v_lshlrev_b32 v8, 16, v48
    v_and_b32 v9, s90, v48
    v_add_f32 v81, v81, v8
    v_add_f32 v83, v83, v9
    v_lshlrev_b32 v10, 16, v49
    v_and_b32 v11, s90, v49
    v_add_f32 v81, v81, v10
    v_add_f32 v83, v83, v11
    buffer_load_dwordx4 v22, s[32:35], s72 offen offset:2048 lds
    v_lshlrev_b32 v8, 16, v50
    v_and_b32 v9, s90, v50
    v_add_f32 v81, v81, v8
    v_add_f32 v83, v83, v9
    v_lshlrev_b32 v10, 16, v51
    v_and_b32 v11, s90, v51
    v_add_f32 v81, v81, v10
    v_add_f32 v83, v83, v11
    v_lshlrev_b32 v8, 16, v52
    v_and_b32 v9, s90, v52
    v_add_f32 v81, v81, v8
    v_add_f32 v83, v83, v9
    buffer_load_dwordx4 v23, s[32:35], s72 offen offset:3072 lds
    v_lshlrev_b32 v10, 16, v53
    v_and_b32 v11, s90, v53
    v_add_f32 v81, v81, v10
    v_add_f32 v83, v83, v11
    v_lshlrev_b32 v8, 16, v54
    v_and_b32 v9, s90, v54
    v_add_f32 v81, v81, v8
    v_add_f32 v83, v83, v9
    v_lshlrev_b32 v10, 16, v55
    v_and_b32 v11, s90, v55
    v_add_f32 v81, v81, v10
    v_add_f32 v83, v83, v11
    s_add_u32 m0, s70, 8192
    s_nop 0
    buffer_load_dwordx4 v24, s[32:35], s72 offen offset:0 lds
    s_xor_b32 s69, s69, 1
    s_cbranch_scc1 L_hw10
    v_add_f32 v80, v80, v82
    v_add_f32 v81, v81, v83
    v_mov_b32 v82, v80
    v_mov_b32 v83, v81
    s_nop 0
    v_permlane32_swap_b32 v80, v82
    v_permlane32_swap_b32 v81, v83
    v_add_f32 v80, v80, v82
    v_add_f32_e64 v81, v81, v83
    s_mov_b32 exec_hi, 0
    buffer_store_dwordx2 v[80:81], v12, s[40:43], s79 offen offset:1024 sc1
    s_mov_b64 exec, -1
    s_waitcnt vmcnt(10)
    s_branch L_hbar
L_compute:
    s_load_dwordx4 s[8:11], s[0:1], 16
    s_load_dwordx16 s[12:27], s[0:1], 32
    s_and_b32 s62, s62, 3
    s_and_b32 s76, s2, 7
    s_lshl_b32 s76, s76, 3
    s_lshr_b32 s77, s2, 7
    s_lshl2_add_u32 s76, s77, s76
    s_mov_b32 s80, 0x654210b3
    s_mov_b32 s81, 0xfedca987
    s_lshr_b64 s[80:81], s[80:81], s76
    s_and_b32 s61, s80, 15
    s_setprio 2
    s_and_b32 s63, s62, 1
    s_lshr_b32 s64, s62, 1
    s_lshl_b32 s73, s60, 4
    s_add_u32 s73, s73, s61
    s_mul_i32 s73, s73, 28800
    s_add_u32 s76, s2, 7
    s_and_b32 s76, s76, 7
    s_bfe_u32 s77, s2, 0x10003
    s_lshl1_add_u32 s97, s76, s77
    s_lshr_b32 s98, s2, 4
    s_lshl_b32 s99, s97, 4
    s_add_u32 s99, s99, s98
    s_mul_i32 s99, s99, 9344
    s_add_u32 s99, s99, 8388608
    s_lshr_b32 s65, s97, 1
    s_lshl_b32 s76, s97, 3
    s_add_u32 s65, s65, s76
    s_mul_i32 s76, s98, 4
    s_add_u32 s65, s65, s76
    s_and_b32 s65, s65, 15
    s_mov_b32 s89, 0x3f803f80
    s_mov_b32 s90, 0xffff0000
    v_and_b32 v2, 31, v1
    v_lshrrev_b32 v3, 5, v1
    v_lshlrev_b32 v12, 4, v1
    v_lshrrev_b32_e64 v4, 3, v1
    v_mul_u32_u24 v13, 460800, v4
    v_and_b32_e64 v4, 7, v1
    v_lshl_add_u32 v13, v4, 4, v13
    v_and_b32 v10, 15, v1
    v_lshrrev_b32 v11, 4, v1
    s_mul_i32 s76, s63, 20480
    v_lshrrev_b32 v4, 1, v10
    v_xor_b32 v4, v4, v11
    v_lshlrev_b32_e64 v4, 4, v4
    v_lshl_add_u32 v4, v10, 7, v4
    v_add_u32 v192, s76, v4
    v_xor_b32 v193, 64, v192
    v_bfe_u32 v4, v1, 2, 2
    v_and_b32_e64 v6, 1, v11
    v_lshl_add_u32 v5, v6, 3, v4
    v_lshlrev_b32 v5, 7, v5
    v_lshrrev_b32 v4, 1, v4
    v_xor_b32_e64 v4, s64, v4
    v_lshl_add_u32 v5, v4, 6, v5
    v_lshl_add_u32 v5, v6, 5, v5
    v_and_b32_e64 v4, 3, v1
    v_lshl_add_u32 v5, v4, 3, v5
    v_mul_u32_u24 v4, 10240, v3
    v_add_u32_e64 v5, v5, v4
    v_add_u32 v194, 4096, v5
    v_xor_b32_e64 v195, 32, v194
    v_add_u32 v196, 40960, v192
    v_add_u32 v197, 40960, v193
    v_add_u32 v198, 40960, v194
    v_add_u32 v199, 40960, v195
    v_add_u32 v200, 81920, v192
    v_add_u32 v201, 81920, v193
    v_add_u32 v202, 81920, v194
    v_add_u32 v203, 81920, v195
    v_bfe_u32 v4, v1, 2, 2
    v_lshl_add_u32 v4, v3, 3, v4
    v_lshlrev_b32 v4, 6, v4
    v_and_b32 v5, 1, v11
    v_lshl_add_u32 v4, v5, 5, v4
    v_and_b32_e64 v5, 3, v1
    v_lshl_add_u32 v4, v5, 3, v4
    s_lshl_b32 s76, s64, 11
    s_add_u32 s76, s76, 122880
    v_add_u32_e64 v212, s76, v4
    s_lshl_b32 s76, s63, 9
    v_lshl_add_u32 v213, v10, 3, s76
    v_lshl_add_u32 v214, v2, 3, s76
    s_lshl_b32 s76, s64, 8
    v_lshl_add_u32 v215, v10, 3, s76
    v_bfe_u32 v4, v10, 1, 1
    v_xor_b32 v4, s64, v4
    v_lshrrev_b32 v5, 2, v10
    v_xor_b32 v5, v5, v3
    v_xor_b32 v6, v10, v11
    v_and_b32 v6, 1, v6
    v_lshlrev_b32_e64 v4, 6, v4
    v_lshl_add_u32 v4, v5, 4, v4
    v_lshl_add_u32 v4, v6, 3, v4
    v_lshl_add_u32 v4, v10, 7, v4
    s_lshl_b32 s76, s63, 13
    v_add_u32 v216, s76, v4
    v_bfe_u32 v4, v2, 1, 1
    v_bfe_u32 v5, v2, 2, 2
    v_and_b32 v6, 1, v2
    v_xor_b32 v6, v6, v3
    v_lshlrev_b32_e64 v4, 6, v4
    v_lshl_add_u32 v4, v5, 4, v4
    v_lshl_add_u32 v4, v6, 3, v4
    v_lshl_add_u32 v4, v2, 7, v4
    s_lshl_b32 s77, s64, 14
    s_add_u32 s76, s76, s77
    v_add_u32_e64 v217, s76, v4
    v_bfe_u32 v4, v1, 2, 2
    v_lshl_add_u32 v5, v3, 3, v4
    v_lshlrev_b32 v5, 7, v5
    v_lshrrev_b32 v6, 1, v4
    v_lshl_add_u32 v5, v6, 6, v5
    v_bfe_u32 v6, v1, 4, 1
    v_xor_b32_e64 v6, v6, v3
    v_lshl_add_u32 v5, v6, 5, v5
    v_bfe_u32 v6, v1, 1, 1
    v_lshl_add_u32 v5, v6, 4, v5
    v_xor_b32 v6, v1, v4
    v_and_b32 v6, 1, v6
    v_lshl_add_u32 v5, v6, 3, v5
    s_lshl_b32 s76, s63, 13
    v_xor_b32 v5, s76, v5
    s_lshl_b32 s76, s63, 6
    s_or_b32 s76, s76, s77
    v_xor_b32 v218, s76, v5
    s_lshl_b32 s76, s64, 6
    v_xor_b32_e64 v220, s76, v5
    v_xor_b32 v219, 528, v218
    v_xor_b32 v221, 528, v220
    v_cmp_gt_u32 s[86:87], 16, v1
    s_waitcnt lgkmcnt(0)
    s_mov_b32 s40, s26
    s_and_b32 s41, s27, 0xffff
    s_mov_b32 s42, 33554432
    s_mov_b32 s43, 0x20000
    s_mov_b32 s44, s22
    s_and_b32 s45, s23, 0xffff
    s_mov_b32 s46, 4194304
    s_mov_b32 s47, 0x20000
    s_mov_b32 s68, 0
    s_getreg_b32 s101, hwreg(HW_REG_XCC_ID, 0, 4)
    v_mov_b32 v9, 13631488
    s_lshl_b32 s76, s61, 8
    s_lshl4_add_u32 s76, s60, s76
    s_add_u32 s76, s76, 12582912
    v_mov_b32 v8, s76
    s_lshl_b32 s76, s60, 8
    s_lshl4_add_u32 s76, s61, s76
    s_add_u32 s76, s76, 12587008
    v_writelane_b32 v8, s76, 1
    s_lshl_b32 s76, s97, 8
    s_lshl4_add_u32 s76, s98, s76
    s_add_u32 s76, s76, 12591104
    v_writelane_b32 v8, s76, 2
    v_mov_b32 v6, s101
    v_mov_b32 v7, 0
    v_mov_b32_e64 v10, 0
    s_cmp_eq_u32 s62, 0
    s_cbranch_scc0 L_noep
    buffer_load_dwordx2 v[4:5], v9, s[40:43], 0 offen
L_noep:
    s_barrier
    ds_read_b128 v[112:115], v192 offset:0
    ds_read_b64_tr_b16 v[128:129], v194 offset:0
    ds_read_b64_tr_b16 v[130:131], v194 offset:512
    ds_read_b128 v[116:119], v192 offset:2048
    ds_read_b128 v[120:123], v192 offset:10240
    ds_read_b128 v[124:127], v192 offset:12288
    ds_read_b64_tr_b16 v[132:133], v195 offset:0
    ds_read_b64_tr_b16 v[134:135], v195 offset:512
    ds_read_b64_tr_b16 v[136:137], v194 offset:2048
    ds_read_b64_tr_b16 v[138:139], v194 offset:2560
    ds_read_b64_tr_b16 v[140:141], v195 offset:2048
    ds_read_b64_tr_b16 v[142:143], v195 offset:2560
    ds_read_b64_tr_b16 v[144:145], v194 offset:4096
    ds_read_b64_tr_b16 v[146:147], v194 offset:4608
    s_waitcnt lgkmcnt(8)
    ds_read_b64_tr_b16 v[148:149], v195 offset:4096
    ds_read_b64_tr_b16 v[150:151], v195 offset:4608
    v_mfma_f32_16x16x32_bf16 v[16:19], v[128:131], v[112:115], 0
    ds_read_b128 v[152:155], v193 offset:0
    v_mfma_f32_16x16x32_bf16 v[20:23], v[128:131], v[116:119], 0
    ds_read_b64_tr_b16 v[168:169], v194 offset:20480
    v_mfma_f32_16x16x32_bf16 v[24:27], v[128:131], v[120:123], 0
    ds_read_b64_tr_b16 v[170:171], v194 offset:20992
    v_mfma_f32_16x16x32_bf16 v[28:31], v[128:131], v[124:127], 0
    ds_read_b128 v[156:159], v193 offset:2048
    s_waitcnt lgkmcnt(4)
    v_mfma_f32_16x16x32_bf16 v[44:47], v[132:135], v[124:127], 0
    ds_read_b128 v[160:163], v193 offset:10240
    v_mfma_f32_16x16x32_bf16 v[40:43], v[132:135], v[120:123], 0
    ds_read_b128 v[164:167], v193 offset:12288
    v_mfma_f32_16x16x32_bf16 v[36:39], v[132:135], v[116:119], 0
    ds_read_b64_tr_b16 v[172:173], v195 offset:20480
    v_mfma_f32_16x16x32_bf16 v[32:35], v[132:135], v[112:115], 0
    ds_read_b64_tr_b16 v[174:175], v195 offset:20992
    v_mfma_f32_16x16x32_bf16 v[48:51], v[136:139], v[112:115], 0
    ds_read_b64_tr_b16 v[176:177], v194 offset:22528
    v_mfma_f32_16x16x32_bf16 v[52:55], v[136:139], v[116:119], 0
    ds_read_b64_tr_b16 v[178:179], v194 offset:23040
    v_mfma_f32_16x16x32_bf16 v[56:59], v[136:139], v[120:123], 0
    ds_read_b64_tr_b16 v[180:181], v195 offset:22528
    v_mfma_f32_16x16x32_bf16 v[60:63], v[136:139], v[124:127], 0
    ds_read_b64_tr_b16 v[182:183], v195 offset:23040
    v_mfma_f32_16x16x32_bf16 v[76:79], v[140:143], v[124:127], 0
    ds_read_b64_tr_b16 v[184:185], v194 offset:24576
    v_mfma_f32_16x16x32_bf16 v[72:75], v[140:143], v[120:123], 0
    ds_read_b64_tr_b16 v[186:187], v194 offset:25088
    v_mfma_f32_16x16x32_bf16 v[68:71], v[140:143], v[116:119], 0
    ds_read_b64_tr_b16 v[188:189], v195 offset:24576
    v_mfma_f32_16x16x32_bf16 v[64:67], v[140:143], v[112:115], 0
    ds_read_b64_tr_b16 v[190:191], v195 offset:25088
    v_mfma_f32_16x16x32_bf16 v[80:83], v[144:147], v[112:115], 0
    v_mfma_f32_16x16x32_bf16 v[84:87], v[144:147], v[116:119], 0
    v_mfma_f32_16x16x32_bf16 v[88:91], v[144:147], v[120:123], 0
    v_mfma_f32_16x16x32_bf16 v[92:95], v[144:147], v[124:127], 0
    v_mfma_f32_16x16x32_bf16 v[108:111], v[148:151], v[124:127], 0
    v_mfma_f32_16x16x32_bf16 v[104:107], v[148:151], v[120:123], 0
    v_mfma_f32_16x16x32_bf16 v[100:103], v[148:151], v[116:119], 0
    v_mfma_f32_16x16x32_bf16 v[96:99], v[148:151], v[112:115], 0
    s_waitcnt lgkmcnt(0)
    v_mfma_f32_16x16x32_bf16 v[16:19], v[168:171], v[152:155], v[16:19]
    s_barrier
    v_mfma_f32_16x16x32_bf16 v[20:23], v[168:171], v[156:159], v[20:23]
    ds_read_b128 v[112:115], v196 offset:0
    ds_read_b64_tr_b16 v[204:205], v212 offset:0
    ds_read_b64_tr_b16 v[206:207], v212 offset:256
    ds_read_b64_tr_b16 v[208:209], v212 offset:1024
    ds_read_b64_tr_b16 v[210:211], v212 offset:1280
    v_mfma_f32_16x16x32_bf16 v[24:27], v[168:171], v[160:163], v[24:27]
    ds_read_b64_tr_b16 v[128:129], v198 offset:0
    s_cmp_eq_u32 s62, 0
    s_cbranch_scc0 L_cloop
    s_waitcnt vmcnt(0)
    v_add_co_u32 v4, vcc, 1, v4
    s_nop 1
    v_addc_co_u32 v5, vcc, 0, v5, vcc
    s_mov_b64 exec, 7
    buffer_store_dwordx4 v[4:7], v8, s[40:43], 0 offen sc1
    s_mov_b64 exec, -1
.p2align 3
L_cloop:
    v_mfma_f32_16x16x32_bf16 v[28:31], v[168:171], v[164:167], v[28:31]
    ds_read_b64_tr_b16 v[130:131], v198 offset:512
    v_mfma_f32_16x16x32_bf16 v[44:47], v[172:175], v[164:167], v[44:47]
    ds_read_b128 v[116:119], v196 offset:2048
    v_mfma_f32_16x16x32_bf16 v[40:43], v[172:175], v[160:163], v[40:43]
    ds_read_b128 v[120:123], v196 offset:10240
    v_mfma_f32_16x16x32_bf16 v[36:39], v[172:175], v[156:159], v[36:39]
    ds_read_b128 v[124:127], v196 offset:12288
    v_mfma_f32_16x16x32_bf16 v[32:35], v[172:175], v[152:155], v[32:35]
    ds_read_b64_tr_b16 v[132:133], v199 offset:0
    v_mfma_f32_16x16x32_bf16 v[48:51], v[176:179], v[152:155], v[48:51]
    ds_read_b64_tr_b16 v[134:135], v199 offset:512
    v_mfma_f32_16x16x32_bf16 v[52:55], v[176:179], v[156:159], v[52:55]
    ds_read_b64_tr_b16 v[136:137], v198 offset:2048
    v_mfma_f32_16x16x32_bf16 v[56:59], v[176:179], v[160:163], v[56:59]
    ds_read_b64_tr_b16 v[138:139], v198 offset:2560
    v_mfma_f32_16x16x32_bf16 v[60:63], v[176:179], v[164:167], v[60:63]
    ds_read_b64_tr_b16 v[140:141], v199 offset:2048
    v_mfma_f32_16x16x32_bf16 v[76:79], v[180:183], v[164:167], v[76:79]
    ds_read_b64_tr_b16 v[142:143], v199 offset:2560
    v_mfma_f32_16x16x32_bf16 v[72:75], v[180:183], v[160:163], v[72:75]
    ds_read_b64_tr_b16 v[144:145], v198 offset:4096
    v_mfma_f32_16x16x32_bf16 v[68:71], v[180:183], v[156:159], v[68:71]
    ds_read_b64_tr_b16 v[146:147], v198 offset:4608
    v_mfma_f32_16x16x32_bf16 v[64:67], v[180:183], v[152:155], v[64:67]
    ds_read_b64_tr_b16 v[148:149], v199 offset:4096
    v_mfma_f32_16x16x32_bf16 v[80:83], v[184:187], v[152:155], v[80:83]
    ds_read_b64_tr_b16 v[150:151], v199 offset:4608
    v_mfma_f32_16x16x32_bf16 v[84:87], v[184:187], v[156:159], v[84:87]
    v_mfma_f32_16x16x32_bf16 v[88:91], v[184:187], v[160:163], v[88:91]
    v_mfma_f32_16x16x32_bf16 v[92:95], v[184:187], v[164:167], v[92:95]
    v_mfma_f32_16x16x32_bf16 v[108:111], v[188:191], v[164:167], v[108:111]
    v_mfma_f32_16x16x32_bf16 v[104:107], v[188:191], v[160:163], v[104:107]
    v_mfma_f32_16x16x32_bf16 v[100:103], v[188:191], v[156:159], v[100:103]
    v_mfma_f32_16x16x32_bf16 v[96:99], v[188:191], v[152:155], v[96:99]
    s_waitcnt lgkmcnt(0)
    v_mfma_f32_16x16x32_bf16 v[16:19], v[128:131], v[112:115], v[16:19]
    ds_read_b128 v[152:155], v197 offset:0
    v_mfma_f32_16x16x32_bf16 v[20:23], v[128:131], v[116:119], v[20:23]
    ds_read_b64_tr_b16 v[168:169], v198 offset:20480
    v_mfma_f32_16x16x32_bf16 v[24:27], v[128:131], v[120:123], v[24:27]
    ds_read_b64_tr_b16 v[170:171], v198 offset:20992
    v_mfma_f32_16x16x32_bf16 v[28:31], v[128:131], v[124:127], v[28:31]
    ds_read_b128 v[156:159], v197 offset:2048
    v_mfma_f32_16x16x32_bf16 v[44:47], v[132:135], v[124:127], v[44:47]
    ds_read_b128 v[160:163], v197 offset:10240
    v_mfma_f32_16x16x32_bf16 v[40:43], v[132:135], v[120:123], v[40:43]
    ds_read_b128 v[164:167], v197 offset:12288
    v_mfma_f32_16x16x32_bf16 v[36:39], v[132:135], v[116:119], v[36:39]
    ds_read_b64_tr_b16 v[172:173], v199 offset:20480
    v_mfma_f32_16x16x32_bf16 v[32:35], v[132:135], v[112:115], v[32:35]
    ds_read_b64_tr_b16 v[174:175], v199 offset:20992
    v_mfma_f32_16x16x32_bf16 v[48:51], v[136:139], v[112:115], v[48:51]
    ds_read_b64_tr_b16 v[176:177], v198 offset:22528
    v_mfma_f32_16x16x32_bf16 v[52:55], v[136:139], v[116:119], v[52:55]
    ds_read_b64_tr_b16 v[178:179], v198 offset:23040
    v_mfma_f32_16x16x32_bf16 v[56:59], v[136:139], v[120:123], v[56:59]
    ds_read_b64_tr_b16 v[180:181], v199 offset:22528
    v_mfma_f32_16x16x32_bf16 v[60:63], v[136:139], v[124:127], v[60:63]
    ds_read_b64_tr_b16 v[182:183], v199 offset:23040
    v_mfma_f32_16x16x32_bf16 v[76:79], v[140:143], v[124:127], v[76:79]
    ds_read_b64_tr_b16 v[184:185], v198 offset:24576
    v_mfma_f32_16x16x32_bf16 v[72:75], v[140:143], v[120:123], v[72:75]
    ds_read_b64_tr_b16 v[186:187], v198 offset:25088
    v_mfma_f32_16x16x32_bf16 v[68:71], v[140:143], v[116:119], v[68:71]
    ds_read_b64_tr_b16 v[188:189], v199 offset:24576
    v_mfma_f32_16x16x32_bf16 v[64:67], v[140:143], v[112:115], v[64:67]
    ds_read_b64_tr_b16 v[190:191], v199 offset:25088
    v_mfma_f32_16x16x32_bf16 v[80:83], v[144:147], v[112:115], v[80:83]
    v_mfma_f32_16x16x32_bf16 v[84:87], v[144:147], v[116:119], v[84:87]
    v_mfma_f32_16x16x32_bf16 v[88:91], v[144:147], v[120:123], v[88:91]
    v_mfma_f32_16x16x32_bf16 v[92:95], v[144:147], v[124:127], v[92:95]
    v_mfma_f32_16x16x32_bf16 v[108:111], v[148:151], v[124:127], v[108:111]
    v_mfma_f32_16x16x32_bf16 v[104:107], v[148:151], v[120:123], v[104:107]
    v_mfma_f32_16x16x32_bf16 v[100:103], v[148:151], v[116:119], v[100:103]
    v_mfma_f32_16x16x32_bf16 v[96:99], v[148:151], v[112:115], v[96:99]
    s_waitcnt lgkmcnt(0)
    v_mfma_f32_16x16x32_bf16 v[16:19], v[168:171], v[152:155], v[16:19]
    s_barrier
    v_mfma_f32_16x16x32_bf16 v[20:23], v[168:171], v[156:159], v[20:23]
    ds_read_b128 v[112:115], v200 offset:0
    v_mfma_f32_16x16x32_bf16 v[24:27], v[168:171], v[160:163], v[24:27]
    ds_read_b64_tr_b16 v[128:129], v202 offset:0
    v_mfma_f32_16x16x32_bf16 v[28:31], v[168:171], v[164:167], v[28:31]
    ds_read_b64_tr_b16 v[130:131], v202 offset:512
    v_mfma_f32_16x16x32_bf16 v[44:47], v[172:175], v[164:167], v[44:47]
    ds_read_b128 v[116:119], v200 offset:2048
    v_mfma_f32_16x16x32_bf16 v[40:43], v[172:175], v[160:163], v[40:43]
    ds_read_b128 v[120:123], v200 offset:10240
    v_mfma_f32_16x16x32_bf16 v[36:39], v[172:175], v[156:159], v[36:39]
    ds_read_b128 v[124:127], v200 offset:12288
    v_mfma_f32_16x16x32_bf16 v[32:35], v[172:175], v[152:155], v[32:35]
    ds_read_b64_tr_b16 v[132:133], v203 offset:0
    v_mfma_f32_16x16x32_bf16 v[48:51], v[176:179], v[152:155], v[48:51]
    ds_read_b64_tr_b16 v[134:135], v203 offset:512
    v_mfma_f32_16x16x32_bf16 v[52:55], v[176:179], v[156:159], v[52:55]
    ds_read_b64_tr_b16 v[136:137], v202 offset:2048
    v_mfma_f32_16x16x32_bf16 v[56:59], v[176:179], v[160:163], v[56:59]
    ds_read_b64_tr_b16 v[138:139], v202 offset:2560
    v_mfma_f32_16x16x32_bf16 v[60:63], v[176:179], v[164:167], v[60:63]
    ds_read_b64_tr_b16 v[140:141], v203 offset:2048
    v_mfma_f32_16x16x32_bf16 v[76:79], v[180:183], v[164:167], v[76:79]
    ds_read_b64_tr_b16 v[142:143], v203 offset:2560
    v_mfma_f32_16x16x32_bf16 v[72:75], v[180:183], v[160:163], v[72:75]
    ds_read_b64_tr_b16 v[144:145], v202 offset:4096
    v_mfma_f32_16x16x32_bf16 v[68:71], v[180:183], v[156:159], v[68:71]
    ds_read_b64_tr_b16 v[146:147], v202 offset:4608
    v_mfma_f32_16x16x32_bf16 v[64:67], v[180:183], v[152:155], v[64:67]
    ds_read_b64_tr_b16 v[148:149], v203 offset:4096
    v_mfma_f32_16x16x32_bf16 v[80:83], v[184:187], v[152:155], v[80:83]
    ds_read_b64_tr_b16 v[150:151], v203 offset:4608
    v_mfma_f32_16x16x32_bf16 v[84:87], v[184:187], v[156:159], v[84:87]
    v_mfma_f32_16x16x32_bf16 v[88:91], v[184:187], v[160:163], v[88:91]
    v_mfma_f32_16x16x32_bf16 v[92:95], v[184:187], v[164:167], v[92:95]
    v_mfma_f32_16x16x32_bf16 v[108:111], v[188:191], v[164:167], v[108:111]
    v_mfma_f32_16x16x32_bf16 v[104:107], v[188:191], v[160:163], v[104:107]
    v_mfma_f32_16x16x32_bf16 v[100:103], v[188:191], v[156:159], v[100:103]
    v_mfma_f32_16x16x32_bf16 v[96:99], v[188:191], v[152:155], v[96:99]
    s_waitcnt lgkmcnt(0)
    v_mfma_f32_16x16x32_bf16 v[16:19], v[128:131], v[112:115], v[16:19]
    ds_read_b128 v[152:155], v201 offset:0
    v_mfma_f32_16x16x32_bf16 v[20:23], v[128:131], v[116:119], v[20:23]
    ds_read_b64_tr_b16 v[168:169], v202 offset:20480
    v_mfma_f32_16x16x32_bf16 v[24:27], v[128:131], v[120:123], v[24:27]
    ds_read_b64_tr_b16 v[170:171], v202 offset:20992
    v_mfma_f32_16x16x32_bf16 v[28:31], v[128:131], v[124:127], v[28:31]
    ds_read_b128 v[156:159], v201 offset:2048
    v_mfma_f32_16x16x32_bf16 v[44:47], v[132:135], v[124:127], v[44:47]
    ds_read_b128 v[160:163], v201 offset:10240
    v_mfma_f32_16x16x32_bf16 v[40:43], v[132:135], v[120:123], v[40:43]
    ds_read_b128 v[164:167], v201 offset:12288
    v_mfma_f32_16x16x32_bf16 v[36:39], v[132:135], v[116:119], v[36:39]
    ds_read_b64_tr_b16 v[172:173], v203 offset:20480
    v_mfma_f32_16x16x32_bf16 v[32:35], v[132:135], v[112:115], v[32:35]
    ds_read_b64_tr_b16 v[174:175], v203 offset:20992
    v_mfma_f32_16x16x32_bf16 v[48:51], v[136:139], v[112:115], v[48:51]
    ds_read_b64_tr_b16 v[176:177], v202 offset:22528
    v_mfma_f32_16x16x32_bf16 v[52:55], v[136:139], v[116:119], v[52:55]
    ds_read_b64_tr_b16 v[178:179], v202 offset:23040
    v_mfma_f32_16x16x32_bf16 v[56:59], v[136:139], v[120:123], v[56:59]
    ds_read_b64_tr_b16 v[180:181], v203 offset:22528
    v_mfma_f32_16x16x32_bf16 v[60:63], v[136:139], v[124:127], v[60:63]
    ds_read_b64_tr_b16 v[182:183], v203 offset:23040
    v_mfma_f32_16x16x32_bf16 v[76:79], v[140:143], v[124:127], v[76:79]
    ds_read_b64_tr_b16 v[184:185], v202 offset:24576
    v_mfma_f32_16x16x32_bf16 v[72:75], v[140:143], v[120:123], v[72:75]
    ds_read_b64_tr_b16 v[186:187], v202 offset:25088
    v_mfma_f32_16x16x32_bf16 v[68:71], v[140:143], v[116:119], v[68:71]
    ds_read_b64_tr_b16 v[188:189], v203 offset:24576
    v_mfma_f32_16x16x32_bf16 v[64:67], v[140:143], v[112:115], v[64:67]
    ds_read_b64_tr_b16 v[190:191], v203 offset:25088
    v_mfma_f32_16x16x32_bf16 v[80:83], v[144:147], v[112:115], v[80:83]
    v_mfma_f32_16x16x32_bf16 v[84:87], v[144:147], v[116:119], v[84:87]
    v_mfma_f32_16x16x32_bf16 v[88:91], v[144:147], v[120:123], v[88:91]
    v_mfma_f32_16x16x32_bf16 v[92:95], v[144:147], v[124:127], v[92:95]
    v_mfma_f32_16x16x32_bf16 v[108:111], v[148:151], v[124:127], v[108:111]
    v_mfma_f32_16x16x32_bf16 v[104:107], v[148:151], v[120:123], v[104:107]
    v_mfma_f32_16x16x32_bf16 v[100:103], v[148:151], v[116:119], v[100:103]
    v_mfma_f32_16x16x32_bf16 v[96:99], v[148:151], v[112:115], v[96:99]
    s_waitcnt lgkmcnt(0)
    v_mfma_f32_16x16x32_bf16 v[16:19], v[168:171], v[152:155], v[16:19]
    s_barrier
    v_mfma_f32_16x16x32_bf16 v[20:23], v[168:171], v[156:159], v[20:23]
    ds_read_b128 v[112:115], v192 offset:0
    v_mfma_f32_16x16x32_bf16 v[24:27], v[168:171], v[160:163], v[24:27]
    ds_read_b64_tr_b16 v[128:129], v194 offset:0
    v_mfma_f32_16x16x32_bf16 v[28:31], v[168:171], v[164:167], v[28:31]
    ds_read_b64_tr_b16 v[130:131], v194 offset:512
    v_mfma_f32_16x16x32_bf16 v[44:47], v[172:175], v[164:167], v[44:47]
    ds_read_b128 v[116:119], v192 offset:2048
    v_mfma_f32_16x16x32_bf16 v[40:43], v[172:175], v[160:163], v[40:43]
    ds_read_b128 v[120:123], v192 offset:10240
    v_mfma_f32_16x16x32_bf16 v[36:39], v[172:175], v[156:159], v[36:39]
    ds_read_b128 v[124:127], v192 offset:12288
    v_mfma_f32_16x16x32_bf16 v[32:35], v[172:175], v[152:155], v[32:35]
    ds_read_b64_tr_b16 v[132:133], v195 offset:0
    v_mfma_f32_16x16x32_bf16 v[48:51], v[176:179], v[152:155], v[48:51]
    ds_read_b64_tr_b16 v[134:135], v195 offset:512
    v_mfma_f32_16x16x32_bf16 v[52:55], v[176:179], v[156:159], v[52:55]
    ds_read_b64_tr_b16 v[136:137], v194 offset:2048
    v_mfma_f32_16x16x32_bf16 v[56:59], v[176:179], v[160:163], v[56:59]
    ds_read_b64_tr_b16 v[138:139], v194 offset:2560
    v_mfma_f32_16x16x32_bf16 v[60:63], v[176:179], v[164:167], v[60:63]
    ds_read_b64_tr_b16 v[140:141], v195 offset:2048
    v_mfma_f32_16x16x32_bf16 v[76:79], v[180:183], v[164:167], v[76:79]
    ds_read_b64_tr_b16 v[142:143], v195 offset:2560
    v_mfma_f32_16x16x32_bf16 v[72:75], v[180:183], v[160:163], v[72:75]
    ds_read_b64_tr_b16 v[144:145], v194 offset:4096
    v_mfma_f32_16x16x32_bf16 v[68:71], v[180:183], v[156:159], v[68:71]
    ds_read_b64_tr_b16 v[146:147], v194 offset:4608
    v_mfma_f32_16x16x32_bf16 v[64:67], v[180:183], v[152:155], v[64:67]
    ds_read_b64_tr_b16 v[148:149], v195 offset:4096
    v_mfma_f32_16x16x32_bf16 v[80:83], v[184:187], v[152:155], v[80:83]
    ds_read_b64_tr_b16 v[150:151], v195 offset:4608
    v_mfma_f32_16x16x32_bf16 v[84:87], v[184:187], v[156:159], v[84:87]
    v_mfma_f32_16x16x32_bf16 v[88:91], v[184:187], v[160:163], v[88:91]
    v_mfma_f32_16x16x32_bf16 v[92:95], v[184:187], v[164:167], v[92:95]
    v_mfma_f32_16x16x32_bf16 v[108:111], v[188:191], v[164:167], v[108:111]
    v_mfma_f32_16x16x32_bf16 v[104:107], v[188:191], v[160:163], v[104:107]
    v_mfma_f32_16x16x32_bf16 v[100:103], v[188:191], v[156:159], v[100:103]
    v_mfma_f32_16x16x32_bf16 v[96:99], v[188:191], v[152:155], v[96:99]
    s_waitcnt lgkmcnt(0)
    v_mfma_f32_16x16x32_bf16 v[16:19], v[128:131], v[112:115], v[16:19]
    ds_read_b128 v[152:155], v193 offset:0
    v_mfma_f32_16x16x32_bf16 v[20:23], v[128:131], v[116:119], v[20:23]
    ds_read_b64_tr_b16 v[168:169], v194 offset:20480
    v_mfma_f32_16x16x32_bf16 v[24:27], v[128:131], v[120:123], v[24:27]
    ds_read_b64_tr_b16 v[170:171], v194 offset:20992
    v_mfma_f32_16x16x32_bf16 v[28:31], v[128:131], v[124:127], v[28:31]
    ds_read_b128 v[156:159], v193 offset:2048
    v_mfma_f32_16x16x32_bf16 v[44:47], v[132:135], v[124:127], v[44:47]
    ds_read_b128 v[160:163], v193 offset:10240
    v_mfma_f32_16x16x32_bf16 v[40:43], v[132:135], v[120:123], v[40:43]
    ds_read_b128 v[164:167], v193 offset:12288
    v_mfma_f32_16x16x32_bf16 v[36:39], v[132:135], v[116:119], v[36:39]
    ds_read_b64_tr_b16 v[172:173], v195 offset:20480
    v_mfma_f32_16x16x32_bf16 v[32:35], v[132:135], v[112:115], v[32:35]
    ds_read_b64_tr_b16 v[174:175], v195 offset:20992
    v_mfma_f32_16x16x32_bf16 v[48:51], v[136:139], v[112:115], v[48:51]
    ds_read_b64_tr_b16 v[176:177], v194 offset:22528
    v_mfma_f32_16x16x32_bf16 v[52:55], v[136:139], v[116:119], v[52:55]
    ds_read_b64_tr_b16 v[178:179], v194 offset:23040
    v_mfma_f32_16x16x32_bf16 v[56:59], v[136:139], v[120:123], v[56:59]
    ds_read_b64_tr_b16 v[180:181], v195 offset:22528
    v_mfma_f32_16x16x32_bf16 v[60:63], v[136:139], v[124:127], v[60:63]
    ds_read_b64_tr_b16 v[182:183], v195 offset:23040
    v_mfma_f32_16x16x32_bf16 v[76:79], v[140:143], v[124:127], v[76:79]
    ds_read_b64_tr_b16 v[184:185], v194 offset:24576
    v_mfma_f32_16x16x32_bf16 v[72:75], v[140:143], v[120:123], v[72:75]
    ds_read_b64_tr_b16 v[186:187], v194 offset:25088
    v_mfma_f32_16x16x32_bf16 v[68:71], v[140:143], v[116:119], v[68:71]
    ds_read_b64_tr_b16 v[188:189], v195 offset:24576
    v_mfma_f32_16x16x32_bf16 v[64:67], v[140:143], v[112:115], v[64:67]
    ds_read_b64_tr_b16 v[190:191], v195 offset:25088
    v_mfma_f32_16x16x32_bf16 v[80:83], v[144:147], v[112:115], v[80:83]
    v_mfma_f32_16x16x32_bf16 v[84:87], v[144:147], v[116:119], v[84:87]
    v_mfma_f32_16x16x32_bf16 v[88:91], v[144:147], v[120:123], v[88:91]
    v_mfma_f32_16x16x32_bf16 v[92:95], v[144:147], v[124:127], v[92:95]
    v_mfma_f32_16x16x32_bf16 v[108:111], v[148:151], v[124:127], v[108:111]
    s_add_u32 s68, s68, 1
    s_cmp_lt_u32 s68, 5
    v_mfma_f32_16x16x32_bf16 v[104:107], v[148:151], v[120:123], v[104:107]
    v_mfma_f32_16x16x32_bf16 v[100:103], v[148:151], v[116:119], v[100:103]
    v_mfma_f32_16x16x32_bf16 v[96:99], v[148:151], v[112:115], v[96:99]
    s_waitcnt lgkmcnt(0)
    v_mfma_f32_16x16x32_bf16 v[16:19], v[168:171], v[152:155], v[16:19]
    s_cbranch_scc0 L_cexit
    s_barrier
    v_mfma_f32_16x16x32_bf16 v[20:23], v[168:171], v[156:159], v[20:23]
    ds_read_b128 v[112:115], v196 offset:0
    v_mfma_f32_16x16x32_bf16 v[24:27], v[168:171], v[160:163], v[24:27]
    ds_read_b64_tr_b16 v[128:129], v198 offset:0
    s_branch L_cloop
L_cexit:
    v_mfma_f32_16x16x32_bf16 v[20:23], v[168:171], v[156:159], v[20:23]
    v_mfma_f32_16x16x32_bf16 v[24:27], v[168:171], v[160:163], v[24:27]
    v_mfma_f32_16x16x32_bf16 v[28:31], v[168:171], v[164:167], v[28:31]
    v_mfma_f32_16x16x32_bf16 v[44:47], v[172:175], v[164:167], v[44:47]
    v_mfma_f32_16x16x32_bf16 v[40:43], v[172:175], v[160:163], v[40:43]
    v_mfma_f32_16x16x32_bf16 v[36:39], v[172:175], v[156:159], v[36:39]
    v_mfma_f32_16x16x32_bf16 v[32:35], v[172:175], v[152:155], v[32:35]
    v_mfma_f32_16x16x32_bf16 v[48:51], v[176:179], v[152:155], v[48:51]
    v_mfma_f32_16x16x32_bf16 v[52:55], v[176:179], v[156:159], v[52:55]
    v_mfma_f32_16x16x32_bf16 v[56:59], v[176:179], v[160:163], v[56:59]
    s_barrier
    ds_read_b32 v11, v10 offset:53248
    ds_read_b64 v[222:223], v213 offset:49152
    ds_read_b64 v[224:225], v213 offset:49280
    v_mfma_f32_16x16x32_bf16 v[60:63], v[176:179], v[164:167], v[60:63]
    ds_read_b64 v[226:227], v213 offset:49408
    ds_read_b64 v[228:229], v213 offset:49536
    v_mfma_f32_16x16x32_bf16 v[76:79], v[180:183], v[164:167], v[76:79]
    ds_read_b64 v[238:239], v215 offset:50176
    ds_read_b64 v[240:241], v215 offset:50304
    v_mfma_f32_16x16x32_bf16 v[72:75], v[180:183], v[160:163], v[72:75]
    ds_read_b64 v[242:243], v215 offset:50688
    ds_read_b64 v[244:245], v215 offset:50816
    v_mfma_f32_16x16x32_bf16 v[68:71], v[180:183], v[156:159], v[68:71]
    ds_read_b64 v[246:247], v215 offset:51200
    ds_read_b64 v[248:249], v215 offset:51328
    v_mfma_f32_16x16x32_bf16 v[64:67], v[180:183], v[152:155], v[64:67]
    ds_read_b32 v250, v214 offset:49156
    ds_read_b32 v252, v214 offset:49412
    v_mfma_f32_16x16x32_bf16 v[80:83], v[184:187], v[152:155], v[80:83]
    s_waitcnt lgkmcnt(8)
    v_readfirstlane_b32 s100, v11
    v_mov_b32_e64 v230, v223
    v_cndmask_b32 v222, 0, v222, s[86:87]
    v_mfma_f32_16x16x32_bf16 v[84:87], v[184:187], v[156:159], v[84:87]
    v_mov_b32_e64 v232, v225
    v_cndmask_b32 v224, 0, v224, s[86:87]
    v_mov_b32_e64 v234, v227
    v_cndmask_b32 v226, 0, v226, s[86:87]
    v_mfma_f32_16x16x32_bf16 v[88:91], v[184:187], v[160:163], v[88:91]
    v_mov_b32_e64 v236, v229
    v_cndmask_b32 v228, 0, v228, s[86:87]
    v_mov_b32 v223, v222
    v_mov_b32 v225, v224
    v_mfma_f32_16x16x32_bf16 v[92:95], v[184:187], v[164:167], v[92:95]
    v_mov_b32 v227, v226
    v_mov_b32_e64 v229, v228
    s_waitcnt lgkmcnt(0)
    v_mul_f32 v251, 0x3fb8aa3b, v250
    v_mfma_f32_16x16x32_bf16 v[108:111], v[188:191], v[164:167], v[108:111]
    v_mul_f32 v253, 0x3fb8aa3b, v252
    v_mfma_f32_16x16x32_bf16 v[104:107], v[188:191], v[160:163], v[104:107]
    v_mfma_f32_16x16x32_bf16 v[100:103], v[188:191], v[156:159], v[100:103]
    v_mfma_f32_16x16x32_bf16 v[96:99], v[188:191], v[152:155], v[96:99]
    v_mfma_f32_16x16x16_bf16 v[48:51], v[242:243], v[222:223], v[48:51]
    v_xor_b32 v168, 0, v217
    v_xor_b32 v169, 16, v217
    v_mfma_f32_16x16x16_bf16 v[52:55], v[242:243], v[224:225], v[52:55]
    v_xor_b32 v170, 32, v217
    v_xor_b32 v171, 48, v217
    v_mfma_f32_16x16x16_bf16 v[64:67], v[244:245], v[222:223], v[64:67]
    v_xor_b32_e64 v172, 64, v217
    v_xor_b32 v173, 80, v217
    v_mfma_f32_16x16x16_bf16 v[68:71], v[244:245], v[224:225], v[68:71]
    v_xor_b32 v174, 96, v217
    v_xor_b32 v175, 112, v217
    v_mfma_f32_16x16x16_bf16 v[56:59], v[242:243], v[226:227], v[56:59]
    v_xor_b32_e64 v4, 32, v216
    v_mfma_f32_16x16x16_bf16 v[60:63], v[242:243], v[228:229], v[60:63]
    v_mfma_f32_16x16x16_bf16 v[72:75], v[244:245], v[226:227], v[72:75]
    v_mfma_f32_16x16x16_bf16 v[76:79], v[244:245], v[228:229], v[76:79]
    v_mfma_f32_16x16x16_bf16 v[80:83], v[246:247], v[222:223], v[80:83]
    v_cvt_pk_bf16_f32 v112, v48, v49
    v_cvt_pk_bf16_f32 v113, v50, v51
    v_mfma_f32_16x16x16_bf16 v[84:87], v[246:247], v[224:225], v[84:87]
    v_cvt_pk_bf16_f32 v114, v52, v53
    v_cvt_pk_bf16_f32 v115, v54, v55
    v_mfma_f32_16x16x16_bf16 v[88:91], v[246:247], v[226:227], v[88:91]
    v_cvt_pk_bf16_f32 v116, v64, v65
    v_cvt_pk_bf16_f32 v117, v66, v67
    v_mfma_f32_16x16x16_bf16 v[92:95], v[246:247], v[228:229], v[92:95]
    v_cvt_pk_bf16_f32 v118, v68, v69
    v_cvt_pk_bf16_f32 v119, v70, v71
    v_mfma_f32_16x16x16_bf16 v[96:99], v[248:249], v[222:223], v[96:99]
    v_cvt_pk_bf16_f32 v120, v56, v57
    v_cvt_pk_bf16_f32 v121, v58, v59
    v_mfma_f32_16x16x16_bf16 v[100:103], v[248:249], v[224:225], v[100:103]
    v_cvt_pk_bf16_f32 v122, v60, v61
    v_cvt_pk_bf16_f32 v123, v62, v63
    v_mfma_f32_16x16x16_bf16 v[104:107], v[248:249], v[226:227], v[104:107]
    v_permlane16_swap_b32 v112, v114
    v_permlane16_swap_b32 v113, v115
    v_mfma_f32_16x16x16_bf16 v[108:111], v[248:249], v[228:229], v[108:111]
    v_permlane16_swap_b32 v116, v118
    v_permlane16_swap_b32 v117, v119
    v_cvt_pk_bf16_f32 v124, v72, v73
    v_cvt_pk_bf16_f32 v125, v74, v75
    v_cvt_pk_bf16_f32 v126, v76, v77
    v_cvt_pk_bf16_f32 v127, v78, v79
    v_permlane16_swap_b32 v120, v122
    v_permlane16_swap_b32 v121, v123
    v_permlane16_swap_b32 v124, v126
    v_permlane16_swap_b32 v125, v127
    v_mfma_f32_32x32x16_bf16 v[48:63], v[204:207], v[112:115], 0
    v_mul_f32 v80, v80, v230
    v_mul_f32 v81, v81, v230
    v_mul_f32 v82, v82, v230
    v_mul_f32 v83, v83, v230
    v_cvt_pk_bf16_f32 v80, v80, v81
    v_cvt_pk_bf16_f32 v81, v82, v83
    v_mfma_f32_32x32x16_bf16 v[64:79], v[204:207], v[120:123], 0
    v_mul_f32 v96, v96, v230
    v_mul_f32 v97, v97, v230
    v_mul_f32 v98, v98, v230
    v_mul_f32 v99, v99, v230
    v_cvt_pk_bf16_f32 v96, v96, v97
    v_cvt_pk_bf16_f32 v97, v98, v99
    v_mfma_f32_32x32x16_bf16 v[48:63], v[208:211], v[116:119], v[48:63]
    v_mul_f32 v84, v84, v232
    v_mul_f32 v85, v85, v232
    v_mul_f32 v86, v86, v232
    v_mul_f32 v87, v87, v232
    v_cvt_pk_bf16_f32 v84, v84, v85
    v_cvt_pk_bf16_f32 v85, v86, v87
    v_mfma_f32_32x32x16_bf16 v[64:79], v[208:211], v[124:127], v[64:79]
    v_mul_f32 v100, v100, v232
    v_mul_f32 v101, v101, v232
    v_mul_f32 v102, v102, v232
    v_mul_f32 v103, v103, v232
    v_cvt_pk_bf16_f32 v100, v100, v101
    v_cvt_pk_bf16_f32 v101, v102, v103
    v_mul_f32 v88, v88, v234
    v_mul_f32 v89, v89, v234
    v_mul_f32 v90, v90, v234
    v_mul_f32 v91, v91, v234
    v_cvt_pk_bf16_f32 v88, v88, v89
    v_cvt_pk_bf16_f32 v89, v90, v91
    v_mul_f32 v104, v104, v234
    v_mul_f32 v105, v105, v234
    v_mul_f32 v106, v106, v234
    v_mul_f32 v107, v107, v234
    v_cvt_pk_bf16_f32 v104, v104, v105
    v_cvt_pk_bf16_f32 v105, v106, v107
    v_mul_f32 v92, v92, v236
    v_mul_f32 v93, v93, v236
    v_mul_f32 v94, v94, v236
    v_mul_f32 v95, v95, v236
    v_cvt_pk_bf16_f32 v92, v92, v93
    v_cvt_pk_bf16_f32 v93, v94, v95
    v_mul_f32 v108, v108, v236
    v_mul_f32 v109, v109, v236
    v_mul_f32 v110, v110, v236
    v_mul_f32 v111, v111, v236
    v_cvt_pk_bf16_f32 v108, v108, v109
    v_cvt_pk_bf16_f32 v109, v110, v111
    v_max3_f32 v160, v48, v49, v50
    v_min3_f32 v162, v48, v49, v50
    v_max3_f32 v160, v160, v51, v52
    v_min3_f32 v162, v162, v51, v52
    v_max3_f32 v160, v160, v53, v54
    v_min3_f32 v162, v162, v53, v54
    v_max3_f32 v160, v160, v55, v56
    v_min3_f32 v162, v162, v55, v56
    v_max3_f32 v160, v160, v57, v58
    v_min3_f32 v162, v162, v57, v58
    v_max3_f32 v160, v160, v59, v60
    v_min3_f32 v162, v162, v59, v60
    v_max3_f32 v160, v160, v61, v62
    v_min3_f32 v162, v162, v61, v62
    v_max_f32 v160, v160, v63
    v_min_f32 v162, v162, v63
    v_max3_f32 v164, v64, v65, v66
    v_min3_f32 v166, v64, v65, v66
    v_max3_f32 v164, v164, v67, v68
    v_min3_f32 v166, v166, v67, v68
    v_max3_f32 v164, v164, v69, v70
    v_min3_f32 v166, v166, v69, v70
    v_max3_f32 v164, v164, v71, v72
    v_min3_f32 v166, v166, v71, v72
    v_max3_f32 v164, v164, v73, v74
    v_min3_f32 v166, v166, v73, v74
    v_max3_f32 v164, v164, v75, v76
    v_min3_f32 v166, v166, v75, v76
    v_max3_f32 v164, v164, v77, v78
    v_min3_f32 v166, v166, v77, v78
    v_max_f32 v164, v164, v79
    v_min_f32 v166, v166, v79
    v_mov_b32 v161, v160
    v_mov_b32 v163, v162
    v_mov_b32 v165, v164
    v_mov_b32 v167, v166
    v_permlane32_swap_b32 v160, v161
    v_permlane32_swap_b32 v162, v163
    v_permlane32_swap_b32 v164, v165
    v_permlane32_swap_b32 v166, v167
    v_max_f32 v160, v160, v161
    v_min_f32 v162, v162, v163
    v_max_f32 v164, v164, v165
    v_min_f32 v166, v166, v167
    v_mul_f32 v160, v160, v251
    v_mul_f32 v162, v162, v251
    v_mul_f32 v164, v164, v253
    v_mul_f32 v166, v166, v253
    v_pk_fma_f32 v[128:129], v[48:49], v[250:251], v[160:161] op_sel:[0,1,0] op_sel_hi:[1,1,0] neg_lo:[0,0,1] neg_hi:[0,0,1]
    v_pk_fma_f32 v[48:49], v[48:49], v[250:251], v[162:163] op_sel:[0,1,0] op_sel_hi:[1,1,0] neg_lo:[0,1,0] neg_hi:[0,1,0]
    v_pk_fma_f32 v[130:131], v[50:51], v[250:251], v[160:161] op_sel:[0,1,0] op_sel_hi:[1,1,0] neg_lo:[0,0,1] neg_hi:[0,0,1]
    v_pk_fma_f32 v[50:51], v[50:51], v[250:251], v[162:163] op_sel:[0,1,0] op_sel_hi:[1,1,0] neg_lo:[0,1,0] neg_hi:[0,1,0]
    v_pk_fma_f32 v[132:133], v[52:53], v[250:251], v[160:161] op_sel:[0,1,0] op_sel_hi:[1,1,0] neg_lo:[0,0,1] neg_hi:[0,0,1]
    v_pk_fma_f32 v[52:53], v[52:53], v[250:251], v[162:163] op_sel:[0,1,0] op_sel_hi:[1,1,0] neg_lo:[0,1,0] neg_hi:[0,1,0]
    v_pk_fma_f32 v[134:135], v[54:55], v[250:251], v[160:161] op_sel:[0,1,0] op_sel_hi:[1,1,0] neg_lo:[0,0,1] neg_hi:[0,0,1]
    v_pk_fma_f32 v[54:55], v[54:55], v[250:251], v[162:163] op_sel:[0,1,0] op_sel_hi:[1,1,0] neg_lo:[0,1,0] neg_hi:[0,1,0]
    v_pk_fma_f32 v[136:137], v[56:57], v[250:251], v[160:161] op_sel:[0,1,0] op_sel_hi:[1,1,0] neg_lo:[0,0,1] neg_hi:[0,0,1]
    v_pk_fma_f32 v[56:57], v[56:57], v[250:251], v[162:163] op_sel:[0,1,0] op_sel_hi:[1,1,0] neg_lo:[0,1,0] neg_hi:[0,1,0]
    v_pk_fma_f32 v[138:139], v[58:59], v[250:251], v[160:161] op_sel:[0,1,0] op_sel_hi:[1,1,0] neg_lo:[0,0,1] neg_hi:[0,0,1]
    v_pk_fma_f32 v[58:59], v[58:59], v[250:251], v[162:163] op_sel:[0,1,0] op_sel_hi:[1,1,0] neg_lo:[0,1,0] neg_hi:[0,1,0]
    v_pk_fma_f32 v[140:141], v[60:61], v[250:251], v[160:161] op_sel:[0,1,0] op_sel_hi:[1,1,0] neg_lo:[0,0,1] neg_hi:[0,0,1]
    v_pk_fma_f32 v[60:61], v[60:61], v[250:251], v[162:163] op_sel:[0,1,0] op_sel_hi:[1,1,0] neg_lo:[0,1,0] neg_hi:[0,1,0]
    v_pk_fma_f32 v[142:143], v[62:63], v[250:251], v[160:161] op_sel:[0,1,0] op_sel_hi:[1,1,0] neg_lo:[0,0,1] neg_hi:[0,0,1]
    v_pk_fma_f32 v[62:63], v[62:63], v[250:251], v[162:163] op_sel:[0,1,0] op_sel_hi:[1,1,0] neg_lo:[0,1,0] neg_hi:[0,1,0]
    v_pk_fma_f32 v[144:145], v[64:65], v[252:253], v[164:165] op_sel:[0,1,0] op_sel_hi:[1,1,0] neg_lo:[0,0,1] neg_hi:[0,0,1]
    v_pk_fma_f32 v[64:65], v[64:65], v[252:253], v[166:167] op_sel:[0,1,0] op_sel_hi:[1,1,0] neg_lo:[0,1,0] neg_hi:[0,1,0]
    v_pk_fma_f32 v[146:147], v[66:67], v[252:253], v[164:165] op_sel:[0,1,0] op_sel_hi:[1,1,0] neg_lo:[0,0,1] neg_hi:[0,0,1]
    v_pk_fma_f32 v[66:67], v[66:67], v[252:253], v[166:167] op_sel:[0,1,0] op_sel_hi:[1,1,0] neg_lo:[0,1,0] neg_hi:[0,1,0]
    v_pk_fma_f32 v[148:149], v[68:69], v[252:253], v[164:165] op_sel:[0,1,0] op_sel_hi:[1,1,0] neg_lo:[0,0,1] neg_hi:[0,0,1]
    v_pk_fma_f32 v[68:69], v[68:69], v[252:253], v[166:167] op_sel:[0,1,0] op_sel_hi:[1,1,0] neg_lo:[0,1,0] neg_hi:[0,1,0]
    v_pk_fma_f32 v[150:151], v[70:71], v[252:253], v[164:165] op_sel:[0,1,0] op_sel_hi:[1,1,0] neg_lo:[0,0,1] neg_hi:[0,0,1]
    v_pk_fma_f32 v[70:71], v[70:71], v[252:253], v[166:167] op_sel:[0,1,0] op_sel_hi:[1,1,0] neg_lo:[0,1,0] neg_hi:[0,1,0]
    v_pk_fma_f32 v[152:153], v[72:73], v[252:253], v[164:165] op_sel:[0,1,0] op_sel_hi:[1,1,0] neg_lo:[0,0,1] neg_hi:[0,0,1]
    v_pk_fma_f32 v[72:73], v[72:73], v[252:253], v[166:167] op_sel:[0,1,0] op_sel_hi:[1,1,0] neg_lo:[0,1,0] neg_hi:[0,1,0]
    v_pk_fma_f32 v[154:155], v[74:75], v[252:253], v[164:165] op_sel:[0,1,0] op_sel_hi:[1,1,0] neg_lo:[0,0,1] neg_hi:[0,0,1]
    v_pk_fma_f32 v[74:75], v[74:75], v[252:253], v[166:167] op_sel:[0,1,0] op_sel_hi:[1,1,0] neg_lo:[0,1,0] neg_hi:[0,1,0]
    v_pk_fma_f32 v[156:157], v[76:77], v[252:253], v[164:165] op_sel:[0,1,0] op_sel_hi:[1,1,0] neg_lo:[0,0,1] neg_hi:[0,0,1]
    v_pk_fma_f32 v[76:77], v[76:77], v[252:253], v[166:167] op_sel:[0,1,0] op_sel_hi:[1,1,0] neg_lo:[0,1,0] neg_hi:[0,1,0]
    v_pk_fma_f32 v[158:159], v[78:79], v[252:253], v[164:165] op_sel:[0,1,0] op_sel_hi:[1,1,0] neg_lo:[0,0,1] neg_hi:[0,0,1]
    v_pk_fma_f32 v[78:79], v[78:79], v[252:253], v[166:167] op_sel:[0,1,0] op_sel_hi:[1,1,0] neg_lo:[0,1,0] neg_hi:[0,1,0]
    v_exp_f32_e64 v128, v128
    v_mfma_f32_16x16x16_bf16 v[16:19], v[238:239], v[222:223], v[16:19]
    v_exp_f32 v144, v144
    v_exp_f32 v129, v129
    v_exp_f32_e64 v145, v145
    v_mfma_f32_16x16x16_bf16 v[20:23], v[238:239], v[224:225], v[20:23]
    ds_write2st64_b64 v216, v[80:81], v[84:85] offset0:64 offset1:68
    v_exp_f32 v130, v130
    v_exp_f32 v146, v146
    v_exp_f32_e64 v131, v131
    v_mfma_f32_16x16x16_bf16 v[24:27], v[238:239], v[226:227], v[24:27]
    v_exp_f32 v147, v147
    v_exp_f32 v132, v132
    v_exp_f32_e64 v148, v148
    v_mfma_f32_16x16x16_bf16 v[28:31], v[238:239], v[228:229], v[28:31]
    ds_write2st64_b64 v4, v[96:97], v[100:101] offset0:64 offset1:68
    v_exp_f32 v133, v133
    v_exp_f32 v149, v149
    v_exp_f32_e64 v134, v134
    v_mfma_f32_16x16x16_bf16 v[32:35], v[240:241], v[222:223], v[32:35]
    v_exp_f32 v150, v150
    v_exp_f32 v135, v135
    v_exp_f32_e64 v151, v151
    v_mfma_f32_16x16x16_bf16 v[36:39], v[240:241], v[224:225], v[36:39]
    ds_write2st64_b64 v216, v[88:89], v[92:93] offset0:72 offset1:76
    v_exp_f32 v136, v136
    v_exp_f32 v152, v152
    v_exp_f32_e64 v137, v137
    v_mfma_f32_16x16x16_bf16 v[40:43], v[240:241], v[226:227], v[40:43]
    v_exp_f32 v153, v153
    v_exp_f32 v138, v138
    v_exp_f32_e64 v154, v154
    v_mfma_f32_16x16x16_bf16 v[44:47], v[240:241], v[228:229], v[44:47]
    ds_write2st64_b64 v4, v[104:105], v[108:109] offset0:72 offset1:76
    v_exp_f32 v139, v139
    v_exp_f32 v155, v155
    v_exp_f32 v140, v140
    v_exp_f32 v156, v156
    v_exp_f32 v141, v141
    v_exp_f32 v157, v157
    v_exp_f32 v142, v142
    v_exp_f32 v158, v158
    v_exp_f32 v143, v143
    v_exp_f32 v159, v159
    v_pk_add_f32 v[176:177], v[128:129], v[130:131]
    v_pk_add_f32 v[178:179], v[144:145], v[146:147]
    v_pk_add_f32 v[176:177], v[176:177], v[132:133]
    v_pk_add_f32 v[178:179], v[178:179], v[148:149]
    v_pk_add_f32 v[176:177], v[176:177], v[134:135]
    v_pk_add_f32 v[178:179], v[178:179], v[150:151]
    v_pk_add_f32 v[176:177], v[176:177], v[136:137]
    v_pk_add_f32 v[178:179], v[178:179], v[152:153]
    v_pk_add_f32 v[176:177], v[176:177], v[138:139]
    v_pk_add_f32 v[178:179], v[178:179], v[154:155]
    v_pk_add_f32 v[176:177], v[176:177], v[140:141]
    v_pk_add_f32 v[178:179], v[178:179], v[156:157]
    v_pk_add_f32 v[176:177], v[176:177], v[142:143]
    v_pk_add_f32 v[178:179], v[178:179], v[158:159]
    v_exp_f32 v48, v48
    v_add_f32 v176, v176, v177
    v_add_f32 v178, v178, v179
    v_exp_f32 v64, v64
    v_mov_b32 v177, v176
    v_mov_b32 v179, v178
    v_exp_f32 v49, v49
    v_permlane32_swap_b32 v176, v177
    v_permlane32_swap_b32 v178, v179
    v_exp_f32 v65, v65
    v_add_f32 v176, v176, v177
    v_add_f32 v178, v178, v179
    v_exp_f32 v50, v50
    v_rcp_f32 v176, v176
    v_rcp_f32 v178, v178
    v_exp_f32 v66, v66
    v_exp_f32 v51, v51
    v_exp_f32 v67, v67
    v_exp_f32 v52, v52
    v_exp_f32 v68, v68
    v_exp_f32 v53, v53
    v_exp_f32 v69, v69
    v_exp_f32 v54, v54
    v_exp_f32 v70, v70
    v_exp_f32 v55, v55
    v_exp_f32 v71, v71
    v_exp_f32 v56, v56
    v_exp_f32 v72, v72
    v_exp_f32 v57, v57
    v_exp_f32 v73, v73
    v_exp_f32 v58, v58
    v_exp_f32 v74, v74
    v_exp_f32 v59, v59
    v_exp_f32 v75, v75
    v_exp_f32 v60, v60
    v_exp_f32 v76, v76
    v_exp_f32 v61, v61
    v_exp_f32 v77, v77
    v_exp_f32 v62, v62
    v_exp_f32 v78, v78
    v_exp_f32 v63, v63
    v_exp_f32 v79, v79
    v_pk_add_f32 v[180:181], v[48:49], v[50:51]
    v_pk_add_f32 v[182:183], v[64:65], v[66:67]
    v_pk_add_f32 v[180:181], v[180:181], v[52:53]
    v_pk_add_f32 v[182:183], v[182:183], v[68:69]
    v_pk_add_f32 v[180:181], v[180:181], v[54:55]
    v_pk_add_f32 v[182:183], v[182:183], v[70:71]
    v_pk_add_f32 v[180:181], v[180:181], v[56:57]
    v_pk_add_f32 v[182:183], v[182:183], v[72:73]
    v_pk_add_f32 v[180:181], v[180:181], v[58:59]
    v_pk_add_f32 v[182:183], v[182:183], v[74:75]
    v_pk_add_f32 v[180:181], v[180:181], v[60:61]
    v_pk_add_f32 v[182:183], v[182:183], v[76:77]
    v_pk_add_f32 v[180:181], v[180:181], v[62:63]
    v_pk_add_f32 v[182:183], v[182:183], v[78:79]
    v_add_f32 v180, v180, v181
    v_add_f32 v182, v182, v183
    v_mov_b32 v181, v180
    v_mov_b32 v183, v182
    v_pk_mul_f32 v[128:129], v[128:129], v[176:177] op_sel_hi:[1,0]
    v_pk_mul_f32 v[130:131], v[130:131], v[176:177] op_sel_hi:[1,0]
    v_cvt_pk_bf16_f32 v128, v128, v129
    v_permlane32_swap_b32 v180, v181
    v_permlane32_swap_b32 v182, v183
    v_cvt_pk_bf16_f32 v129, v130, v131
    v_pk_mul_f32 v[144:145], v[144:145], v[178:179] op_sel_hi:[1,0]
    v_pk_mul_f32 v[146:147], v[146:147], v[178:179] op_sel_hi:[1,0]
    v_cvt_pk_bf16_f32 v144, v144, v145
    v_cvt_pk_bf16_f32 v145, v146, v147
    v_add_f32 v180, v180, v181
    v_add_f32 v182, v182, v183
    ds_write2st64_b64 v168, v[128:129], v[144:145] offset0:0 offset1:8
    v_pk_mul_f32 v[132:133], v[132:133], v[176:177] op_sel_hi:[1,0]
    v_pk_mul_f32 v[134:135], v[134:135], v[176:177] op_sel_hi:[1,0]
    v_cvt_pk_bf16_f32 v132, v132, v133
    v_cvt_pk_bf16_f32 v133, v134, v135
    v_pk_mul_f32 v[148:149], v[148:149], v[178:179] op_sel_hi:[1,0]
    v_rcp_f32 v180, v180
    v_rcp_f32 v182, v182
    v_pk_mul_f32 v[150:151], v[150:151], v[178:179] op_sel_hi:[1,0]
    v_cvt_pk_bf16_f32 v148, v148, v149
    v_cvt_pk_bf16_f32 v149, v150, v151
    ds_write2st64_b64 v169, v[132:133], v[148:149] offset0:0 offset1:8
    v_pk_mul_f32 v[136:137], v[136:137], v[176:177] op_sel_hi:[1,0]
    v_pk_mul_f32 v[138:139], v[138:139], v[176:177] op_sel_hi:[1,0]
    v_cvt_pk_bf16_f32 v136, v136, v137
    v_cvt_pk_bf16_f32 v137, v138, v139
    v_pk_mul_f32 v[152:153], v[152:153], v[178:179] op_sel_hi:[1,0]
    v_pk_mul_f32 v[154:155], v[154:155], v[178:179] op_sel_hi:[1,0]
    v_cvt_pk_bf16_f32 v152, v152, v153
    v_cvt_pk_bf16_f32 v153, v154, v155
    ds_write2st64_b64 v170, v[136:137], v[152:153] offset0:0 offset1:8
    v_pk_mul_f32 v[140:141], v[140:141], v[176:177] op_sel_hi:[1,0]
    v_pk_mul_f32 v[142:143], v[142:143], v[176:177] op_sel_hi:[1,0]
    v_cvt_pk_bf16_f32 v140, v140, v141
    v_cvt_pk_bf16_f32 v141, v142, v143
    v_pk_mul_f32 v[156:157], v[156:157], v[178:179] op_sel_hi:[1,0]
    v_pk_mul_f32 v[158:159], v[158:159], v[178:179] op_sel_hi:[1,0]
    v_cvt_pk_bf16_f32 v156, v156, v157
    v_cvt_pk_bf16_f32 v157, v158, v159
    ds_write2st64_b64 v171, v[140:141], v[156:157] offset0:0 offset1:8
    v_pk_mul_f32 v[48:49], v[48:49], v[180:181] op_sel_hi:[1,0]
    v_pk_mul_f32 v[50:51], v[50:51], v[180:181] op_sel_hi:[1,0]
    v_cvt_pk_bf16_f32 v48, v48, v49
    v_cvt_pk_bf16_f32 v49, v50, v51
    v_pk_mul_f32 v[64:65], v[64:65], v[182:183] op_sel_hi:[1,0]
    v_pk_mul_f32 v[66:67], v[66:67], v[182:183] op_sel_hi:[1,0]
    v_cvt_pk_bf16_f32 v64, v64, v65
    v_cvt_pk_bf16_f32 v65, v66, v67
    ds_write2st64_b64 v172, v[48:49], v[64:65] offset0:0 offset1:8
    v_pk_mul_f32 v[52:53], v[52:53], v[180:181] op_sel_hi:[1,0]
    v_pk_mul_f32 v[54:55], v[54:55], v[180:181] op_sel_hi:[1,0]
    v_cvt_pk_bf16_f32 v52, v52, v53
    v_cvt_pk_bf16_f32 v53, v54, v55
    v_pk_mul_f32 v[68:69], v[68:69], v[182:183] op_sel_hi:[1,0]
    v_pk_mul_f32 v[70:71], v[70:71], v[182:183] op_sel_hi:[1,0]
    v_cvt_pk_bf16_f32 v68, v68, v69
    v_cvt_pk_bf16_f32 v69, v70, v71
    ds_write2st64_b64 v173, v[52:53], v[68:69] offset0:0 offset1:8
    v_pk_mul_f32 v[56:57], v[56:57], v[180:181] op_sel_hi:[1,0]
    v_pk_mul_f32 v[58:59], v[58:59], v[180:181] op_sel_hi:[1,0]
    v_cvt_pk_bf16_f32 v56, v56, v57
    v_cvt_pk_bf16_f32 v57, v58, v59
    v_pk_mul_f32 v[72:73], v[72:73], v[182:183] op_sel_hi:[1,0]
    v_pk_mul_f32 v[74:75], v[74:75], v[182:183] op_sel_hi:[1,0]
    v_cvt_pk_bf16_f32 v72, v72, v73
    v_cvt_pk_bf16_f32 v73, v74, v75
    ds_write2st64_b64 v174, v[56:57], v[72:73] offset0:0 offset1:8
    v_pk_mul_f32 v[60:61], v[60:61], v[180:181] op_sel_hi:[1,0]
    v_pk_mul_f32 v[62:63], v[62:63], v[180:181] op_sel_hi:[1,0]
    v_cvt_pk_bf16_f32 v60, v60, v61
    v_cvt_pk_bf16_f32 v61, v62, v63
    v_pk_mul_f32 v[76:77], v[76:77], v[182:183] op_sel_hi:[1,0]
    v_pk_mul_f32 v[78:79], v[78:79], v[182:183] op_sel_hi:[1,0]
    v_cvt_pk_bf16_f32 v76, v76, v77
    v_cvt_pk_bf16_f32 v77, v78, v79
    ds_write2st64_b64 v175, v[60:61], v[76:77] offset0:0 offset1:8
    ds_read_b64_tr_b16 v[112:113], v218 offset:0
    ds_read_b64_tr_b16 v[114:115], v219 offset:0
    ds_read_b64_tr_b16 v[144:145], v220 offset:32768
    ds_read_b64_tr_b16 v[146:147], v221 offset:32768
    ds_read_b64_tr_b16 v[116:117], v218 offset:2048
    ds_read_b64_tr_b16 v[118:119], v219 offset:2048
    ds_read_b64_tr_b16 v[148:149], v220 offset:34816
    ds_read_b64_tr_b16 v[150:151], v221 offset:34816
    ds_read_b64_tr_b16 v[120:121], v218 offset:4096
    ds_read_b64_tr_b16 v[122:123], v219 offset:4096
    ds_read_b64_tr_b16 v[152:153], v220 offset:36864
    ds_read_b64_tr_b16 v[154:155], v221 offset:36864
    v_cvt_pk_bf16_f32 v176, v16, v17
    v_cvt_pk_bf16_f32 v177, v18, v19
    v_cvt_pk_bf16_f32 v178, v20, v21
    v_cvt_pk_bf16_f32 v179, v22, v23
    v_cvt_pk_bf16_f32 v180, v32, v33
    v_cvt_pk_bf16_f32 v181, v34, v35
    v_cvt_pk_bf16_f32 v182, v36, v37
    v_cvt_pk_bf16_f32 v183, v38, v39
    v_cvt_pk_bf16_f32 v184, v24, v25
    v_cvt_pk_bf16_f32 v185, v26, v27
    v_cvt_pk_bf16_f32 v186, v28, v29
    v_cvt_pk_bf16_f32 v187, v30, v31
    v_cvt_pk_bf16_f32 v188, v40, v41
    v_cvt_pk_bf16_f32 v189, v42, v43
    v_cvt_pk_bf16_f32 v190, v44, v45
    v_cvt_pk_bf16_f32 v191, v46, v47
    s_waitcnt lgkmcnt(8)
    v_mfma_f32_32x32x16_bf16 v[48:63], v[112:115], v[144:147], 0
    ds_read_b64_tr_b16 v[124:125], v218 offset:6144
    ds_read_b64_tr_b16 v[126:127], v219 offset:6144
    ds_read_b64_tr_b16 v[156:157], v220 offset:38912
    ds_read_b64_tr_b16 v[158:159], v221 offset:38912
    s_waitcnt lgkmcnt(8)
    v_mfma_f32_32x32x16_bf16 v[48:63], v[116:119], v[148:151], v[48:63]
    v_xor_b32 v218, 8192, v218
    v_xor_b32 v219, 8192, v219
    v_xor_b32 v220, 8192, v220
    v_xor_b32 v221, 8192, v221
    s_barrier
    ds_read_b64_tr_b16 v[128:129], v218 offset:0
    ds_read_b64_tr_b16 v[130:131], v219 offset:0
    ds_read_b64_tr_b16 v[160:161], v220 offset:32768
    ds_read_b64_tr_b16 v[162:163], v221 offset:32768
    s_waitcnt lgkmcnt(8)
    v_mfma_f32_32x32x16_bf16 v[48:63], v[120:123], v[152:155], v[48:63]
    ds_read_b64_tr_b16 v[132:133], v218 offset:2048
    ds_read_b64_tr_b16 v[134:135], v219 offset:2048
    ds_read_b64_tr_b16 v[164:165], v220 offset:34816
    ds_read_b64_tr_b16 v[166:167], v221 offset:34816
    s_waitcnt lgkmcnt(8)
    v_mfma_f32_32x32x16_bf16 v[48:63], v[124:127], v[156:159], v[48:63]
    ds_read_b64_tr_b16 v[136:137], v218 offset:4096
    ds_read_b64_tr_b16 v[138:139], v219 offset:4096
    ds_read_b64_tr_b16 v[168:169], v220 offset:36864
    ds_read_b64_tr_b16 v[170:171], v221 offset:36864
    s_waitcnt lgkmcnt(8)
    v_mfma_f32_32x32x16_bf16 v[48:63], v[128:131], v[160:163], v[48:63]
    ds_read_b64_tr_b16 v[140:141], v218 offset:6144
    ds_read_b64_tr_b16 v[142:143], v219 offset:6144
    ds_read_b64_tr_b16 v[172:173], v220 offset:38912
    ds_read_b64_tr_b16 v[174:175], v221 offset:38912
    s_waitcnt lgkmcnt(8)
    v_mfma_f32_32x32x16_bf16 v[48:63], v[132:135], v[164:167], v[48:63]
    v_permlane16_swap_b32 v176, v178
    v_permlane16_swap_b32 v177, v179
    s_waitcnt lgkmcnt(4)
    v_mfma_f32_32x32x16_bf16 v[48:63], v[136:139], v[168:171], v[48:63]
    v_permlane16_swap_b32 v180, v182
    v_permlane16_swap_b32 v181, v183
    v_permlane16_swap_b32 v184, v186
    s_waitcnt lgkmcnt(0)
    v_mfma_f32_32x32x16_bf16 v[48:63], v[140:143], v[172:175], v[48:63]
    s_barrier
    v_permlane16_swap_b32 v185, v187
    v_permlane16_swap_b32 v188, v190
    v_permlane16_swap_b32 v189, v191
    s_lshl_b32 s76, s62, 11
    s_add_u32 s76, s76, s99
    v_mfma_f32_32x32x16_bf16 v[16:31], v[204:207], v[176:179], 0
    s_add_u32 s76, s76, 1024
    s_lshl_b32 s77, s62, 7
    s_add_u32 s77, s77, s73
    v_lshlrev_b32_e64 v4, 2, v2
    v_mfma_f32_32x32x16_bf16 v[32:47], v[204:207], v[184:187], 0
    v_cvt_pk_bf16_f32 v64, v48, v49
    v_cvt_pk_bf16_f32 v65, v50, v51
    v_cvt_pk_bf16_f32 v66, v52, v53
    v_cvt_pk_bf16_f32 v67, v54, v55
    v_cvt_pk_bf16_f32 v68, v56, v57
    v_mfma_f32_32x32x16_bf16 v[16:31], v[208:211], v[180:183], v[16:31]
    v_cvt_pk_bf16_f32 v69, v58, v59
    v_cvt_pk_bf16_f32 v70, v60, v61
    v_cvt_pk_bf16_f32 v71, v62, v63
    s_bitcmp1_b32 s100, 0
    s_cbranch_scc0 L_loc_45
    buffer_store_dwordx4 v[64:67], v12, s[40:43], s76 offen offset:0
    buffer_store_dwordx4 v[68:71], v12, s[40:43], s76 offen offset:1024
L_pubd_46:
    v_mfma_f32_32x32x16_bf16 v[32:47], v[208:211], v[188:191], v[32:47]
    v_and_b32 v216, 1, v1
    v_lshlrev_b32 v216, 8, v216
    v_lshl_add_u32 v216, v3, 4, v216
    s_lshl_b32 s76, s64, 7
    v_add_u32 v216, s76, v216
    s_mul_i32 s78, s61, 28800
    s_lshl_b32 s79, s64, 8
    s_add_u32 s78, s78, s79
    s_add_u32 s79, s78, 3686400
    v_dot2_f32_bf16 v72, v112, s89, 0
    v_dot2_f32_bf16 v73, v113, s89, 0
    v_dot2_f32_bf16 v72, v114, s89, v72
    v_dot2_f32_bf16 v73, v115, s89, v73
    v_dot2_f32_bf16 v72, v116, s89, v72
    v_dot2_f32_bf16 v73, v117, s89, v73
    v_dot2_f32_bf16 v72, v118, s89, v72
    v_dot2_f32_bf16 v73, v119, s89, v73
    v_dot2_f32_bf16 v72, v120, s89, v72
    v_dot2_f32_bf16 v73, v121, s89, v73
    v_dot2_f32_bf16 v72, v122, s89, v72
    v_dot2_f32_bf16 v73, v123, s89, v73
    v_dot2_f32_bf16 v72, v124, s89, v72
    v_dot2_f32_bf16 v73, v125, s89, v73
    v_dot2_f32_bf16 v72, v126, s89, v72
    v_dot2_f32_bf16 v73, v127, s89, v73
    v_dot2_f32_bf16 v72, v128, s89, v72
    v_dot2_f32_bf16 v73, v129, s89, v73
    v_dot2_f32_bf16 v72, v130, s89, v72
    v_dot2_f32_bf16 v73, v131, s89, v73
    v_dot2_f32_bf16 v72, v132, s89, v72
    v_dot2_f32_bf16 v73, v133, s89, v73
    v_dot2_f32_bf16 v72, v134, s89, v72
    v_dot2_f32_bf16 v73, v135, s89, v73
    v_dot2_f32_bf16 v72, v136, s89, v72
    v_dot2_f32_bf16 v73, v137, s89, v73
    v_dot2_f32_bf16 v72, v138, s89, v72
    v_dot2_f32_bf16 v73, v139, s89, v73
    v_dot2_f32_bf16 v72, v140, s89, v72
    v_dot2_f32_bf16 v73, v141, s89, v73
    v_dot2_f32_bf16 v72, v142, s89, v72
    v_dot2_f32_bf16 v73, v143, s89, v73
    s_lshl_b32 s76, s98, 7
    v_lshl_add_u32 v10, v3, 3, s76
    v_lshlrev_b32 v11, 5, v1
    v_add_f32 v72, v72, v73
    v_mov_b32 v73, v72
    s_nop 1
    v_permlane32_swap_b32 v72, v73
    v_add_f32 v72, v72, v73
    s_mov_b32 exec_hi, 0
    s_bitcmp1_b32 s100, 0
    s_cbranch_scc0 L_loc_47
    buffer_store_dword v72, v4, s[40:43], s77 offen offset:2048
L_pubd_48:
    s_mov_b64 exec, -1
    v_max3_f32 v160, v16, v17, v18
    v_min3_f32 v162, v16, v17, v18
    v_max3_f32 v160, v160, v19, v20
    v_min3_f32 v162, v162, v19, v20
    v_max3_f32 v160, v160, v21, v22
    v_min3_f32 v162, v162, v21, v22
    v_max3_f32 v160, v160, v23, v24
    v_min3_f32 v162, v162, v23, v24
    v_max3_f32 v160, v160, v25, v26
    v_min3_f32 v162, v162, v25, v26
    v_max3_f32 v160, v160, v27, v28
    v_min3_f32 v162, v162, v27, v28
    v_max3_f32 v160, v160, v29, v30
    v_min3_f32 v162, v162, v29, v30
    v_max_f32 v160, v160, v31
    v_min_f32_e64 v162, v162, v31
    v_max3_f32 v164, v32, v33, v34
    v_min3_f32 v166, v32, v33, v34
    v_max3_f32 v164, v164, v35, v36
    v_min3_f32 v166, v166, v35, v36
    v_max3_f32 v164, v164, v37, v38
    v_min3_f32 v166, v166, v37, v38
    v_max3_f32 v164, v164, v39, v40
    v_min3_f32 v166, v166, v39, v40
    v_max3_f32 v164, v164, v41, v42
    v_min3_f32 v166, v166, v41, v42
    v_max3_f32 v164, v164, v43, v44
    v_min3_f32 v166, v166, v43, v44
    v_max3_f32 v164, v164, v45, v46
    v_min3_f32 v166, v166, v45, v46
    v_max_f32 v164, v164, v47
    v_min_f32 v166, v166, v47
    v_mov_b32 v161, v160
    v_mov_b32 v163, v162
    v_mov_b32 v165, v164
    v_mov_b32 v167, v166
    v_permlane32_swap_b32 v160, v161
    v_permlane32_swap_b32 v162, v163
    v_permlane32_swap_b32 v164, v165
    v_permlane32_swap_b32 v166, v167
    v_max_f32 v160, v160, v161
    v_min_f32 v162, v162, v163
    v_max_f32 v164, v164, v165
    v_min_f32 v166, v166, v167
    v_mul_f32 v160, v160, v251
    v_mul_f32 v162, v162, v251
    v_mul_f32 v164, v164, v253
    v_mul_f32 v166, v166, v253
    v_pk_fma_f32 v[128:129], v[16:17], v[250:251], v[160:161] op_sel:[0,1,0] op_sel_hi:[1,1,0] neg_lo:[0,0,1] neg_hi:[0,0,1]
    v_pk_fma_f32 v[16:17], v[16:17], v[250:251], v[162:163] op_sel:[0,1,0] op_sel_hi:[1,1,0] neg_lo:[0,1,0] neg_hi:[0,1,0]
    v_pk_fma_f32 v[130:131], v[18:19], v[250:251], v[160:161] op_sel:[0,1,0] op_sel_hi:[1,1,0] neg_lo:[0,0,1] neg_hi:[0,0,1]
    v_pk_fma_f32 v[18:19], v[18:19], v[250:251], v[162:163] op_sel:[0,1,0] op_sel_hi:[1,1,0] neg_lo:[0,1,0] neg_hi:[0,1,0]
    v_pk_fma_f32 v[132:133], v[20:21], v[250:251], v[160:161] op_sel:[0,1,0] op_sel_hi:[1,1,0] neg_lo:[0,0,1] neg_hi:[0,0,1]
    v_pk_fma_f32 v[20:21], v[20:21], v[250:251], v[162:163] op_sel:[0,1,0] op_sel_hi:[1,1,0] neg_lo:[0,1,0] neg_hi:[0,1,0]
    v_pk_fma_f32 v[134:135], v[22:23], v[250:251], v[160:161] op_sel:[0,1,0] op_sel_hi:[1,1,0] neg_lo:[0,0,1] neg_hi:[0,0,1]
    v_pk_fma_f32 v[22:23], v[22:23], v[250:251], v[162:163] op_sel:[0,1,0] op_sel_hi:[1,1,0] neg_lo:[0,1,0] neg_hi:[0,1,0]
    v_pk_fma_f32 v[136:137], v[24:25], v[250:251], v[160:161] op_sel:[0,1,0] op_sel_hi:[1,1,0] neg_lo:[0,0,1] neg_hi:[0,0,1]
    v_pk_fma_f32 v[24:25], v[24:25], v[250:251], v[162:163] op_sel:[0,1,0] op_sel_hi:[1,1,0] neg_lo:[0,1,0] neg_hi:[0,1,0]
    v_pk_fma_f32 v[138:139], v[26:27], v[250:251], v[160:161] op_sel:[0,1,0] op_sel_hi:[1,1,0] neg_lo:[0,0,1] neg_hi:[0,0,1]
    v_pk_fma_f32 v[26:27], v[26:27], v[250:251], v[162:163] op_sel:[0,1,0] op_sel_hi:[1,1,0] neg_lo:[0,1,0] neg_hi:[0,1,0]
    v_pk_fma_f32 v[140:141], v[28:29], v[250:251], v[160:161] op_sel:[0,1,0] op_sel_hi:[1,1,0] neg_lo:[0,0,1] neg_hi:[0,0,1]
    v_pk_fma_f32 v[28:29], v[28:29], v[250:251], v[162:163] op_sel:[0,1,0] op_sel_hi:[1,1,0] neg_lo:[0,1,0] neg_hi:[0,1,0]
    v_pk_fma_f32 v[142:143], v[30:31], v[250:251], v[160:161] op_sel:[0,1,0] op_sel_hi:[1,1,0] neg_lo:[0,0,1] neg_hi:[0,0,1]
    v_pk_fma_f32 v[30:31], v[30:31], v[250:251], v[162:163] op_sel:[0,1,0] op_sel_hi:[1,1,0] neg_lo:[0,1,0] neg_hi:[0,1,0]
    v_pk_fma_f32 v[144:145], v[32:33], v[252:253], v[164:165] op_sel:[0,1,0] op_sel_hi:[1,1,0] neg_lo:[0,0,1] neg_hi:[0,0,1]
    v_pk_fma_f32 v[32:33], v[32:33], v[252:253], v[166:167] op_sel:[0,1,0] op_sel_hi:[1,1,0] neg_lo:[0,1,0] neg_hi:[0,1,0]
    v_pk_fma_f32 v[146:147], v[34:35], v[252:253], v[164:165] op_sel:[0,1,0] op_sel_hi:[1,1,0] neg_lo:[0,0,1] neg_hi:[0,0,1]
    v_pk_fma_f32 v[34:35], v[34:35], v[252:253], v[166:167] op_sel:[0,1,0] op_sel_hi:[1,1,0] neg_lo:[0,1,0] neg_hi:[0,1,0]
    v_pk_fma_f32 v[148:149], v[36:37], v[252:253], v[164:165] op_sel:[0,1,0] op_sel_hi:[1,1,0] neg_lo:[0,0,1] neg_hi:[0,0,1]
    v_pk_fma_f32 v[36:37], v[36:37], v[252:253], v[166:167] op_sel:[0,1,0] op_sel_hi:[1,1,0] neg_lo:[0,1,0] neg_hi:[0,1,0]
    v_pk_fma_f32 v[150:151], v[38:39], v[252:253], v[164:165] op_sel:[0,1,0] op_sel_hi:[1,1,0] neg_lo:[0,0,1] neg_hi:[0,0,1]
    v_pk_fma_f32 v[38:39], v[38:39], v[252:253], v[166:167] op_sel:[0,1,0] op_sel_hi:[1,1,0] neg_lo:[0,1,0] neg_hi:[0,1,0]
    v_pk_fma_f32 v[152:153], v[40:41], v[252:253], v[164:165] op_sel:[0,1,0] op_sel_hi:[1,1,0] neg_lo:[0,0,1] neg_hi:[0,0,1]
    v_pk_fma_f32 v[40:41], v[40:41], v[252:253], v[166:167] op_sel:[0,1,0] op_sel_hi:[1,1,0] neg_lo:[0,1,0] neg_hi:[0,1,0]
    v_pk_fma_f32 v[154:155], v[42:43], v[252:253], v[164:165] op_sel:[0,1,0] op_sel_hi:[1,1,0] neg_lo:[0,0,1] neg_hi:[0,0,1]
    v_pk_fma_f32 v[42:43], v[42:43], v[252:253], v[166:167] op_sel:[0,1,0] op_sel_hi:[1,1,0] neg_lo:[0,1,0] neg_hi:[0,1,0]
    v_pk_fma_f32 v[156:157], v[44:45], v[252:253], v[164:165] op_sel:[0,1,0] op_sel_hi:[1,1,0] neg_lo:[0,0,1] neg_hi:[0,0,1]
    v_pk_fma_f32 v[44:45], v[44:45], v[252:253], v[166:167] op_sel:[0,1,0] op_sel_hi:[1,1,0] neg_lo:[0,1,0] neg_hi:[0,1,0]
    v_pk_fma_f32 v[158:159], v[46:47], v[252:253], v[164:165] op_sel:[0,1,0] op_sel_hi:[1,1,0] neg_lo:[0,0,1] neg_hi:[0,0,1]
    v_pk_fma_f32 v[46:47], v[46:47], v[252:253], v[166:167] op_sel:[0,1,0] op_sel_hi:[1,1,0] neg_lo:[0,1,0] neg_hi:[0,1,0]
    v_exp_f32 v128, v128
    v_exp_f32 v16, v16
    v_exp_f32 v129, v129
    v_exp_f32 v17, v17
    v_exp_f32 v130, v130
    v_exp_f32 v18, v18
    v_exp_f32 v131, v131
    v_exp_f32 v19, v19
    v_exp_f32 v132, v132
    v_exp_f32 v20, v20
    v_exp_f32 v133, v133
    v_exp_f32 v21, v21
    v_exp_f32 v134, v134
    v_exp_f32 v22, v22
    v_exp_f32 v135, v135
    v_exp_f32 v23, v23
    v_exp_f32 v136, v136
    v_exp_f32 v24, v24
    v_exp_f32 v137, v137
    v_exp_f32 v25, v25
    v_exp_f32 v138, v138
    v_exp_f32 v26, v26
    v_exp_f32 v139, v139
    v_exp_f32 v27, v27
    v_exp_f32 v140, v140
    v_exp_f32 v28, v28
    v_exp_f32 v141, v141
    v_exp_f32 v29, v29
    v_exp_f32 v142, v142
    v_exp_f32 v30, v30
    v_exp_f32 v143, v143
    v_exp_f32 v31, v31
    v_cvt_pk_bf16_f32 v218, v128, v129
    v_cvt_pk_bf16_f32 v219, v130, v131
    v_cvt_pk_bf16_f32 v220, v132, v133
    v_cvt_pk_bf16_f32 v221, v134, v135
    v_cvt_pk_bf16_f32 v222, v136, v137
    v_cvt_pk_bf16_f32 v223, v138, v139
    v_cvt_pk_bf16_f32 v224, v140, v141
    v_cvt_pk_bf16_f32 v225, v142, v143
    v_cvt_pk_bf16_f32 v226, v16, v17
    v_cvt_pk_bf16_f32 v227, v18, v19
    v_cvt_pk_bf16_f32 v228, v20, v21
    v_cvt_pk_bf16_f32 v229, v22, v23
    v_cvt_pk_bf16_f32 v230, v24, v25
    v_cvt_pk_bf16_f32 v231, v26, v27
    v_cvt_pk_bf16_f32 v232, v28, v29
    v_cvt_pk_bf16_f32 v233, v30, v31
    v_exp_f32 v144, v144
    v_exp_f32 v32, v32
    v_exp_f32 v145, v145
    v_exp_f32 v33, v33
    v_exp_f32 v146, v146
    v_exp_f32 v34, v34
    v_exp_f32 v147, v147
    v_exp_f32 v35, v35
    v_exp_f32 v148, v148
    v_exp_f32 v36, v36
    v_exp_f32 v149, v149
    v_exp_f32 v37, v37
    v_exp_f32 v150, v150
    v_exp_f32 v38, v38
    v_exp_f32 v151, v151
    v_exp_f32_e64 v39, v39
    s_barrier
    buffer_load_dwordx4 v[48:51], v13, s[40:43], s78 offen offset:3072 sc1
    buffer_load_dwordx4 v[52:55], v13, s[40:43], s79 offen offset:3072 sc1
    buffer_load_dwordx4 v[56:59], v13, s[40:43], s78 offen offset:3200 sc1
    buffer_load_dwordx4 v[60:63], v13, s[40:43], s79 offen offset:3200 sc1
    ds_read_b128 v[168:171], v216 offset:24576
    ds_read_b128 v[172:175], v216 offset:24608
    ds_read_b128 v[176:179], v216 offset:24640
    ds_read_b128 v[180:183], v216 offset:24672
    v_exp_f32 v152, v152
    v_exp_f32 v40, v40
    v_exp_f32 v153, v153
    v_exp_f32 v41, v41
    v_exp_f32 v154, v154
    v_exp_f32 v42, v42
    v_exp_f32 v155, v155
    v_exp_f32 v43, v43
    v_exp_f32 v156, v156
    v_exp_f32_e64 v44, v44
    s_waitcnt lgkmcnt(0)
    v_mfma_f32_32x32x16_bf16 v[64:79], v[168:171], v[218:221], 0
    v_exp_f32 v157, v157
    v_exp_f32 v45, v45
    v_exp_f32_e64 v158, v158
    v_mfma_f32_32x32x16_bf16 v[80:95], v[176:179], v[226:229], 0
    v_exp_f32 v46, v46
    v_exp_f32 v159, v159
    v_exp_f32_e64 v47, v47
    v_mfma_f32_32x32x16_bf16 v[64:79], v[172:175], v[222:225], v[64:79]
    v_cvt_pk_bf16_f32 v234, v144, v145
    v_cvt_pk_bf16_f32 v235, v146, v147
    v_cvt_pk_bf16_f32 v236, v148, v149
    v_cvt_pk_bf16_f32 v237, v150, v151
    v_cvt_pk_bf16_f32 v238, v152, v153
    v_cvt_pk_bf16_f32 v239, v154, v155
    v_mfma_f32_32x32x16_bf16 v[80:95], v[180:183], v[230:233], v[80:95]
    v_cvt_pk_bf16_f32 v240, v156, v157
    v_cvt_pk_bf16_f32 v241, v158, v159
    v_cvt_pk_bf16_f32 v242, v32, v33
    v_cvt_pk_bf16_f32 v243, v34, v35
    v_cvt_pk_bf16_f32 v244, v36, v37
    v_cvt_pk_bf16_f32 v245, v38, v39
    v_cvt_pk_bf16_f32 v246, v40, v41
    v_cvt_pk_bf16_f32 v247, v42, v43
    v_cvt_pk_bf16_f32 v248, v44, v45
    v_cvt_pk_bf16_f32 v249, v46, v47
    v_mfma_f32_32x32x16_bf16 v[96:111], v[168:171], v[234:237], 0
    v_rcp_f32 v184, v65
    v_rcp_f32 v185, v81
    v_mul_f32 v6, v64, v184
    v_fmac_f32 v6, v80, v185
    v_add_f32 v6, 0x358637bd, v6
    v_mfma_f32_32x32x16_bf16 v[112:127], v[176:179], v[242:245], 0
    v_rcp_f32 v6, v6
    v_mov_b32 v8, 0
    v_mul_f32 v184, v184, v6
    v_mul_f32_e64 v185, v185, v6
    s_lshl4_add_u32 s76, s60, s61
    v_mfma_f32_32x32x16_bf16 v[96:111], v[172:175], v[238:241], v[96:111]
    s_mul_i32 s76, s76, 32768
    s_lshl2_add_u32 s77, s63, s64
    s_lshl_b32 s77, s77, 12
    s_add_u32 s76, s76, s77
    s_add_u32 s76, s76, 16777216
    v_mfma_f32_32x32x16_bf16 v[112:127], v[180:183], v[246:249], v[112:127]
    s_add_u32 s77, s76, 8192
    v_add_u32 v14, 128, v12
    v_cmp_gt_u32 vcc, 24, v1
    s_nop 0
    s_nop 0
    v_cndmask_b32_e64 v14, v14, v12, vcc
    s_mov_b64 s[0:1], -2
    s_branch L_pfirst_50
L_poll_49:
    buffer_load_dwordx4 v[48:51], v13, s[40:43], s78 offen offset:3072 sc1
    buffer_load_dwordx4 v[52:55], v13, s[40:43], s79 offen offset:3072 sc1
    buffer_load_dwordx4 v[56:59], v13, s[40:43], s78 offen offset:3200 sc1
    buffer_load_dwordx4 v[60:63], v13, s[40:43], s79 offen offset:3200 sc1
    s_add_u32 s1, s1, 1
    s_lshr_b32 s0, s1, 16
    s_or_b32 s0, s0, -2
L_pfirst_50:
    s_waitcnt vmcnt(0)
    v_max3_u32 v9, v48, v49, v50
    v_max3_u32 v9, v9, v51, v52
    v_max3_u32 v9, v9, v53, v54
    v_max3_u32 v9, v9, v55, v56
    v_max3_u32 v9, v9, v57, v58
    v_max3_u32 v9, v9, v59, v60
    v_max3_u32 v9, v9, v61, v62
    v_max_u32_e64 v9, v9, v63
    v_cmp_lt_u32 vcc, s0, v9
    s_cbranch_vccnz L_poll_49
    v_mfma_f32_32x32x16_bf16 v[16:31], v[48:51], v[218:221], 0
    s_barrier
    v_rcp_f32 v186, v97
    v_rcp_f32 v187, v113
    v_mul_f32 v7, v96, v186
    v_mfma_f32_32x32x16_bf16 v[128:143], v[56:59], v[226:229], 0
    v_fmac_f32_e64 v7, v112, v187
    v_add_f32 v7, 0x358637bd, v7
    v_rcp_f32_e64 v7, v7
    v_bfe_u32 v4, v2, 1, 3
    v_lshlrev_b32_e64 v4, 4, v4
    v_mfma_f32_32x32x16_bf16 v[16:31], v[52:55], v[222:225], v[16:31]
    v_mov_b32 v8, 0
    v_mul_f32 v186, v186, v7
    v_mul_f32_e64 v187, v187, v7
    v_lshl_add_u32 v4, v3, 3, v4
    v_lshl_add_u32 v4, v2, 7, v4
    s_lshl_b32 s56, s62, 12
    v_mfma_f32_32x32x16_bf16 v[128:143], v[60:63], v[230:233], v[128:143]
    s_add_u32 s57, s56, 0
    v_add_u32 v64, s57, v4
    v_xor_b32 v65, 16, v64
    v_xor_b32 v66, 32, v64
    v_xor_b32 v67, 48, v64
    v_xor_b32_e64 v68, 64, v64
    v_mfma_f32_32x32x16_bf16 v[32:47], v[48:51], v[234:237], 0
    v_xor_b32 v69, 80, v64
    v_xor_b32 v70, 96, v64
    v_xor_b32 v71, 112, v64
    v_bfe_u32 v4, v1, 2, 2
    v_lshl_add_u32 v5, v3, 2, v4
    v_lshlrev_b32 v5, 7, v5
    s_bitcmp1_b32 s100, 2
    v_mfma_f32_32x32x16_bf16 v[144:159], v[56:59], v[242:245], 0
    v_mul_f32 v16, v16, v184
    v_mul_f32 v17, v17, v184
    v_mul_f32 v18, v18, v184
    v_mul_f32 v19, v19, v184
    v_mul_f32 v20, v20, v184
    v_mul_f32 v21, v21, v184
    v_mfma_f32_32x32x16_bf16 v[32:47], v[52:55], v[238:241], v[32:47]
    v_mul_f32 v22, v22, v184
    v_mul_f32 v23, v23, v184
    v_mul_f32 v24, v24, v184
    v_mul_f32 v25, v25, v184
    v_mul_f32 v26, v26, v184
    v_mul_f32 v27, v27, v184
    v_mfma_f32_32x32x16_bf16 v[144:159], v[60:63], v[246:249], v[144:159]
    v_mul_f32 v28, v28, v184
    v_mul_f32 v29, v29, v184
    v_mul_f32 v30, v30, v184
    v_mul_f32 v31, v31, v184
    v_fmac_f32 v16, v128, v185
    v_fmac_f32 v17, v129, v185
    v_cvt_pk_bf16_f32 v96, v16, v17
    v_fmac_f32 v18, v130, v185
    v_fmac_f32 v19, v131, v185
    v_cvt_pk_bf16_f32 v97, v18, v19
    v_fmac_f32 v20, v132, v185
    v_fmac_f32 v21, v133, v185
    v_cvt_pk_bf16_f32 v98, v20, v21
    v_fmac_f32 v22, v134, v185
    v_fmac_f32 v23, v135, v185
    v_cvt_pk_bf16_f32 v99, v22, v23
    buffer_store_dwordx4 v[96:99], v14, s[40:43], s76 offen offset:0 sc1
    v_fmac_f32 v24, v136, v185
    v_fmac_f32 v25, v137, v185
    v_cvt_pk_bf16_f32 v100, v24, v25
    v_fmac_f32 v26, v138, v185
    v_fmac_f32 v27, v139, v185
    v_cvt_pk_bf16_f32 v101, v26, v27
    v_fmac_f32 v28, v140, v185
    v_fmac_f32 v29, v141, v185
    v_cvt_pk_bf16_f32 v102, v28, v29
    v_fmac_f32 v30, v142, v185
    v_fmac_f32 v31, v143, v185
    v_cvt_pk_bf16_f32 v103, v30, v31
    buffer_store_dwordx4 v[100:103], v14, s[40:43], s76 offen offset:2048 sc1
    v_pk_mul_f32 v[32:33], v[32:33], v[186:187] op_sel_hi:[1,0]
    v_pk_fma_f32 v[32:33], v[144:145], v[186:187], v[32:33] op_sel:[0,1,0] op_sel_hi:[1,1,1]
    v_cvt_pk_bf16_f32 v104, v32, v33
    v_pk_mul_f32 v[34:35], v[34:35], v[186:187] op_sel_hi:[1,0]
    v_pk_fma_f32 v[34:35], v[146:147], v[186:187], v[34:35] op_sel:[0,1,0] op_sel_hi:[1,1,1]
    v_cvt_pk_bf16_f32 v105, v34, v35
    v_pk_mul_f32 v[36:37], v[36:37], v[186:187] op_sel_hi:[1,0]
    v_pk_fma_f32 v[36:37], v[148:149], v[186:187], v[36:37] op_sel:[0,1,0] op_sel_hi:[1,1,1]
    v_cvt_pk_bf16_f32 v106, v36, v37
    v_pk_mul_f32 v[38:39], v[38:39], v[186:187] op_sel_hi:[1,0]
    v_pk_fma_f32 v[38:39], v[150:151], v[186:187], v[38:39] op_sel:[0,1,0] op_sel_hi:[1,1,1]
    v_cvt_pk_bf16_f32 v107, v38, v39
    buffer_store_dwordx4 v[104:107], v14, s[40:43], s77 offen offset:0 sc1
    v_pk_mul_f32 v[40:41], v[40:41], v[186:187] op_sel_hi:[1,0]
    v_pk_fma_f32 v[40:41], v[152:153], v[186:187], v[40:41] op_sel:[0,1,0] op_sel_hi:[1,1,1]
    v_cvt_pk_bf16_f32 v108, v40, v41
    v_pk_mul_f32 v[42:43], v[42:43], v[186:187] op_sel_hi:[1,0]
    v_pk_fma_f32 v[42:43], v[154:155], v[186:187], v[42:43] op_sel:[0,1,0] op_sel_hi:[1,1,1]
    v_cvt_pk_bf16_f32 v109, v42, v43
    v_pk_mul_f32 v[44:45], v[44:45], v[186:187] op_sel_hi:[1,0]
    v_pk_fma_f32 v[44:45], v[156:157], v[186:187], v[44:45] op_sel:[0,1,0] op_sel_hi:[1,1,1]
    v_cvt_pk_bf16_f32 v110, v44, v45
    v_pk_mul_f32 v[46:47], v[46:47], v[186:187] op_sel_hi:[1,0]
    v_pk_fma_f32 v[46:47], v[158:159], v[186:187], v[46:47] op_sel:[0,1,0] op_sel_hi:[1,1,1]
    v_cvt_pk_bf16_f32 v111, v46, v47
    buffer_store_dwordx4 v[108:111], v14, s[40:43], s77 offen offset:2048 sc1
    v_lshrrev_b32_e64 v4, 1, v4
    v_lshl_add_u32 v5, v4, 6, v5
    v_bfe_u32 v4, v1, 4, 1
    v_lshl_add_u32 v5, v4, 5, v5
    v_and_b32_e64 v4, 3, v1
    v_lshl_add_u32 v5, v4, 3, v5
    v_add_u32 v72, 32768, v5
    v_xor_b32_e64 v73, 64, v72
    s_mul_i32 s80, s97, 524288
    s_mul_i32 s56, s62, 8192
    s_add_u32 s80, s80, s56
    s_add_u32 s80, s80, 16777216
    v_add_u32 v78, 4096, v14
    v_mov_b32 v74, 1
    s_mov_b32 s52, 0xffff
    s_mov_b32 s53, 0
    s_barrier
    ds_read_b32 v79, v8 offset:25984
    ds_read_b64 v[88:89], v64
    ds_read_b64 v[90:91], v65
    ds_read_b64 v[92:93], v66
    ds_read_b64 v[94:95], v67
    ds_read_b64 v[96:97], v68
    ds_read_b64 v[98:99], v69
    ds_read_b64 v[100:101], v70
    ds_read_b64 v[102:103], v71
    s_waitcnt lgkmcnt(8)
    v_readfirstlane_b32 s76, v79
    s_nop 0
    s_and_b32 s76, s76, s52
    s_cbranch_scc0 L_tr0
L_bk0:
    s_ff1_i32_b32 s76, s76
    s_bitset0_b32 s52, s76
    s_add_u32 s77, s76, s65
    s_and_b32 s77, s77, 15
    s_mul_i32 s77, s77, 32768
    s_add_u32 s28, s77, s80
    s_add_u32 s76, s76, 3
    s_and_b32 s76, s76, 15
    s_lshl_b32 s4, s76, 13
    buffer_load_dwordx4 v[128:131], v14, s[40:43], s28 offen offset:0 sc1
    buffer_load_dwordx4 v[132:135], v14, s[40:43], s28 offen offset:2048 sc1
    buffer_load_dwordx4 v[136:139], v78, s[40:43], s28 offen offset:0 sc1
    buffer_load_dwordx4 v[140:143], v78, s[40:43], s28 offen offset:2048 sc1
    v_readfirstlane_b32 s76, v79
    s_nop 0
    s_and_b32 s76, s76, s52
    s_cbranch_scc0 L_tr1
L_bk1:
    s_ff1_i32_b32 s76, s76
    s_bitset0_b32 s52, s76
    s_add_u32 s77, s76, s65
    s_and_b32 s77, s77, 15
    s_mul_i32 s77, s77, 32768
    s_add_u32 s29, s77, s80
    s_add_u32 s76, s76, 3
    s_and_b32 s76, s76, 15
    s_lshl_b32 s5, s76, 13
    buffer_load_dwordx4 v[144:147], v14, s[40:43], s29 offen offset:0 sc1
    buffer_load_dwordx4 v[148:151], v14, s[40:43], s29 offen offset:2048 sc1
    v_add_u32 v80, s4, v72
    v_add_u32 v81, s4, v73
    s_waitcnt lgkmcnt(0)
    v_lshlrev_b32 v16, 16, v88
    v_and_b32 v17, s90, v88
    v_lshlrev_b32 v18, 16, v89
    v_and_b32 v19, s90, v89
    v_lshlrev_b32 v20, 16, v90
    v_and_b32 v21, s90, v90
    v_lshlrev_b32 v22, 16, v91
    v_and_b32 v23, s90, v91
    v_lshlrev_b32 v24, 16, v92
    v_and_b32 v25, s90, v92
    v_lshlrev_b32 v26, 16, v93
    v_and_b32 v27, s90, v93
    v_lshlrev_b32 v28, 16, v94
    v_and_b32 v29, s90, v94
    v_lshlrev_b32 v30, 16, v95
    v_and_b32 v31, s90, v95
    v_lshlrev_b32 v32, 16, v96
    v_and_b32 v33, s90, v96
    v_lshlrev_b32 v34, 16, v97
    v_and_b32 v35, s90, v97
    v_lshlrev_b32 v36, 16, v98
    v_and_b32 v37, s90, v98
    v_lshlrev_b32 v38, 16, v99
    v_and_b32 v39, s90, v99
    v_lshlrev_b32 v40, 16, v100
    v_and_b32 v41, s90, v100
    v_lshlrev_b32 v42, 16, v101
    v_and_b32 v43, s90, v101
    v_lshlrev_b32 v44, 16, v102
    v_and_b32 v45, s90, v102
    v_lshlrev_b32 v46, 16, v103
    v_and_b32 v47, s90, v103
    s_cmp_eq_u32 s53, 0
    s_cbranch_scc0 L_sent_51
    s_waitcnt vmcnt(6)
    s_mov_b64 exec, 1
    ds_add_u32 v8, v74 offset:25988
    s_mov_b64 exec, -1
    s_mov_b32 s53, 1
L_sent_51:
    ds_read_b32 v79, v8 offset:25984
    ds_read_b64_tr_b16 v[104:105], v80 offset:0
    ds_read_b64_tr_b16 v[106:107], v80 offset:1024
    ds_read_b64_tr_b16 v[108:109], v81 offset:0
    ds_read_b64_tr_b16 v[110:111], v81 offset:1024
    ds_read_b64_tr_b16 v[112:113], v80 offset:2048
    ds_read_b64_tr_b16 v[114:115], v80 offset:3072
    ds_read_b64_tr_b16 v[116:117], v81 offset:2048
    ds_read_b64_tr_b16 v[118:119], v81 offset:3072
    s_waitcnt vmcnt(5) lgkmcnt(4)
    v_mfma_f32_32x32x16_bf16 v[16:31], v[104:107], v[128:131], v[16:31]
    ds_read_b64_tr_b16 v[120:121], v80 offset:4096
    ds_read_b64_tr_b16 v[122:123], v80 offset:5120
    buffer_load_dwordx4 v[152:155], v78, s[40:43], s29 offen offset:0 sc1
    v_mfma_f32_32x32x16_bf16 v[32:47], v[108:111], v[128:131], v[32:47]
    ds_read_b64_tr_b16 v[124:125], v81 offset:4096
    ds_read_b64_tr_b16 v[126:127], v81 offset:5120
    buffer_load_dwordx4 v[156:159], v78, s[40:43], s29 offen offset:2048 sc1
    v_readfirstlane_b32 s76, v79
    s_nop 0
    s_and_b32 s76, s76, s52
    s_cbranch_scc0 L_tr2
L_bk2:
    s_ff1_i32_b32 s76, s76
    s_bitset0_b32 s52, s76
    s_add_u32 s77, s76, s65
    s_and_b32 s77, s77, 15
    s_mul_i32 s77, s77, 32768
    s_add_u32 s30, s77, s80
    s_waitcnt vmcnt(6) lgkmcnt(4)
    v_mfma_f32_32x32x16_bf16 v[16:31], v[112:115], v[132:135], v[16:31]
    ds_read_b32 v79, v8 offset:25984
    ds_read_b64_tr_b16 v[104:105], v80 offset:6144
    ds_read_b64_tr_b16 v[106:107], v80 offset:7168
    buffer_load_dwordx4 v[160:163], v14, s[40:43], s30 offen offset:0 sc1
    s_add_u32 s76, s76, 3
    s_and_b32 s76, s76, 15
    s_lshl_b32 s6, s76, 13
    v_mfma_f32_32x32x16_bf16 v[32:47], v[116:119], v[132:135], v[32:47]
    ds_read_b64_tr_b16 v[108:109], v81 offset:6144
    ds_read_b64_tr_b16 v[110:111], v81 offset:7168
    buffer_load_dwordx4 v[164:167], v14, s[40:43], s30 offen offset:2048 sc1
    v_add_u32 v82, s5, v72
    v_add_u32_e64 v83, s5, v73
    s_waitcnt vmcnt(7) lgkmcnt(4)
    v_mfma_f32_32x32x16_bf16 v[16:31], v[120:123], v[136:139], v[16:31]
    ds_read_b64_tr_b16 v[112:113], v82 offset:0
    ds_read_b64_tr_b16 v[114:115], v82 offset:1024
    buffer_load_dwordx4 v[168:171], v78, s[40:43], s30 offen offset:0 sc1
    v_mfma_f32_32x32x16_bf16 v[32:47], v[124:127], v[136:139], v[32:47]
    ds_read_b64_tr_b16 v[116:117], v83 offset:0
    ds_read_b64_tr_b16 v[118:119], v83 offset:1024
    buffer_load_dwordx4 v[172:175], v78, s[40:43], s30 offen offset:2048 sc1
    v_readfirstlane_b32 s76, v79
    s_nop 0
    s_and_b32 s76, s76, s52
    s_cbranch_scc0 L_tr3
L_bk3:
    s_ff1_i32_b32 s76, s76
    s_bitset0_b32 s52, s76
    s_add_u32 s77, s76, s65
    s_and_b32 s77, s77, 15
    s_mul_i32 s77, s77, 32768
    s_add_u32 s31, s77, s80
    s_waitcnt vmcnt(8) lgkmcnt(4)
    v_mfma_f32_32x32x16_bf16 v[16:31], v[104:107], v[140:143], v[16:31]
    ds_read_b32 v79, v8 offset:25984
    ds_read_b64_tr_b16 v[120:121], v82 offset:2048
    ds_read_b64_tr_b16 v[122:123], v82 offset:3072
    buffer_load_dwordx4 v[176:179], v14, s[40:43], s31 offen offset:0 sc1
    s_add_u32 s76, s76, 3
    s_and_b32 s76, s76, 15
    s_lshl_b32 s7, s76, 13
    v_mfma_f32_32x32x16_bf16 v[32:47], v[108:111], v[140:143], v[32:47]
    ds_read_b64_tr_b16 v[124:125], v83 offset:2048
    ds_read_b64_tr_b16 v[126:127], v83 offset:3072
    buffer_load_dwordx4 v[180:183], v14, s[40:43], s31 offen offset:2048 sc1
    s_waitcnt vmcnt(9) lgkmcnt(4)
    v_mfma_f32_32x32x16_bf16 v[16:31], v[112:115], v[144:147], v[16:31]
    ds_read_b64_tr_b16 v[104:105], v82 offset:4096
    ds_read_b64_tr_b16 v[106:107], v82 offset:5120
    buffer_load_dwordx4 v[184:187], v78, s[40:43], s31 offen offset:0 sc1
    v_mfma_f32_32x32x16_bf16 v[32:47], v[116:119], v[144:147], v[32:47]
    ds_read_b64_tr_b16 v[108:109], v83 offset:4096
    ds_read_b64_tr_b16 v[110:111], v83 offset:5120
    buffer_load_dwordx4 v[188:191], v78, s[40:43], s31 offen offset:2048 sc1
    v_readfirstlane_b32 s76, v79
    s_nop 0
    s_and_b32 s76, s76, s52
    s_cbranch_scc0 L_tr4
L_bk4:
    s_ff1_i32_b32 s76, s76
    s_bitset0_b32 s52, s76
    s_add_u32 s77, s76, s65
    s_and_b32 s77, s77, 15
    s_mul_i32 s77, s77, 32768
    s_add_u32 s32, s77, s80
    s_waitcnt vmcnt(10) lgkmcnt(4)
    v_mfma_f32_32x32x16_bf16 v[16:31], v[120:123], v[148:151], v[16:31]
    ds_read_b64_tr_b16 v[112:113], v82 offset:6144
    ds_read_b64_tr_b16 v[114:115], v82 offset:7168
    buffer_load_dwordx4 v[128:131], v14, s[40:43], s32 offen offset:0 sc1
    s_add_u32 s76, s76, 3
    s_and_b32 s76, s76, 15
    s_lshl_b32 s8, s76, 13
    v_mfma_f32_32x32x16_bf16 v[32:47], v[124:127], v[148:151], v[32:47]
    ds_read_b64_tr_b16 v[116:117], v83 offset:6144
    ds_read_b64_tr_b16 v[118:119], v83 offset:7168
    buffer_load_dwordx4 v[132:135], v14, s[40:43], s32 offen offset:2048 sc1
    v_add_u32 v80, s6, v72
    v_add_u32 v81, s6, v73
    s_waitcnt vmcnt(11) lgkmcnt(4)
    v_mfma_f32_32x32x16_bf16 v[16:31], v[104:107], v[152:155], v[16:31]
    ds_read_b32 v79, v8 offset:25984
    ds_read_b64_tr_b16 v[120:121], v80 offset:0
    ds_read_b64_tr_b16 v[122:123], v80 offset:1024
    buffer_load_dwordx4 v[136:139], v78, s[40:43], s32 offen offset:0 sc1
    v_mfma_f32_32x32x16_bf16 v[32:47], v[108:111], v[152:155], v[32:47]
    ds_read_b64_tr_b16 v[124:125], v81 offset:0
    ds_read_b64_tr_b16 v[126:127], v81 offset:1024
    s_waitcnt vmcnt(11) lgkmcnt(4)
    v_mfma_f32_32x32x16_bf16 v[16:31], v[112:115], v[156:159], v[16:31]
    ds_read_b64_tr_b16 v[104:105], v80 offset:2048
    ds_read_b64_tr_b16 v[106:107], v80 offset:3072
    buffer_load_dwordx4 v[140:143], v78, s[40:43], s32 offen offset:2048 sc1
    v_mfma_f32_32x32x16_bf16 v[32:47], v[116:119], v[156:159], v[32:47]
    ds_read_b64_tr_b16 v[108:109], v81 offset:2048
    ds_read_b64_tr_b16 v[110:111], v81 offset:3072
    v_readfirstlane_b32 s76, v79
    s_nop 0
    s_and_b32 s76, s76, s52
    s_cbranch_scc0 L_tr5
L_bk5:
    s_ff1_i32_b32 s76, s76
    s_bitset0_b32 s52, s76
    s_add_u32 s77, s76, s65
    s_and_b32 s77, s77, 15
    s_mul_i32 s77, s77, 32768
    s_add_u32 s33, s77, s80
    s_waitcnt vmcnt(11) lgkmcnt(4)
    v_mfma_f32_32x32x16_bf16 v[16:31], v[120:123], v[160:163], v[16:31]
    ds_read_b64_tr_b16 v[112:113], v80 offset:4096
    ds_read_b64_tr_b16 v[114:115], v80 offset:5120
    buffer_load_dwordx4 v[144:147], v14, s[40:43], s33 offen offset:0 sc1
    s_add_u32 s76, s76, 3
    s_and_b32 s76, s76, 15
    s_lshl_b32 s9, s76, 13
    v_mfma_f32_32x32x16_bf16 v[32:47], v[124:127], v[160:163], v[32:47]
    ds_read_b64_tr_b16 v[116:117], v81 offset:4096
    ds_read_b64_tr_b16 v[118:119], v81 offset:5120
    s_waitcnt vmcnt(11) lgkmcnt(4)
    v_mfma_f32_32x32x16_bf16 v[16:31], v[104:107], v[164:167], v[16:31]
    ds_read_b64_tr_b16 v[120:121], v80 offset:6144
    ds_read_b64_tr_b16 v[122:123], v80 offset:7168
    buffer_load_dwordx4 v[148:151], v14, s[40:43], s33 offen offset:2048 sc1
    v_mfma_f32_32x32x16_bf16 v[32:47], v[108:111], v[164:167], v[32:47]
    ds_read_b64_tr_b16 v[124:125], v81 offset:6144
    ds_read_b64_tr_b16 v[126:127], v81 offset:7168
    v_add_u32 v82, s7, v72
    v_add_u32 v83, s7, v73
    s_waitcnt vmcnt(11) lgkmcnt(4)
    v_mfma_f32_32x32x16_bf16 v[16:31], v[112:115], v[168:171], v[16:31]
    ds_read_b32 v79, v8 offset:25984
    ds_read_b64_tr_b16 v[104:105], v82 offset:0
    ds_read_b64_tr_b16 v[106:107], v82 offset:1024
    buffer_load_dwordx4 v[152:155], v78, s[40:43], s33 offen offset:0 sc1
    v_mfma_f32_32x32x16_bf16 v[32:47], v[116:119], v[168:171], v[32:47]
    ds_read_b64_tr_b16 v[108:109], v83 offset:0
    ds_read_b64_tr_b16 v[110:111], v83 offset:1024
    s_waitcnt vmcnt(11) lgkmcnt(4)
    v_mfma_f32_32x32x16_bf16 v[16:31], v[120:123], v[172:175], v[16:31]
    ds_read_b64_tr_b16 v[112:113], v82 offset:2048
    ds_read_b64_tr_b16 v[114:115], v82 offset:3072
    buffer_load_dwordx4 v[156:159], v78, s[40:43], s33 offen offset:2048 sc1
    v_mfma_f32_32x32x16_bf16 v[32:47], v[124:127], v[172:175], v[32:47]
    ds_read_b64_tr_b16 v[116:117], v83 offset:2048
    ds_read_b64_tr_b16 v[118:119], v83 offset:3072
    v_readfirstlane_b32 s76, v79
    s_nop 0
    s_and_b32 s76, s76, s52
    s_cbranch_scc0 L_tr6
L_bk6:
    s_ff1_i32_b32 s76, s76
    s_bitset0_b32 s52, s76
    s_add_u32 s77, s76, s65
    s_and_b32 s77, s77, 15
    s_mul_i32 s77, s77, 32768
    s_add_u32 s34, s77, s80
    s_waitcnt vmcnt(11) lgkmcnt(4)
    v_mfma_f32_32x32x16_bf16 v[16:31], v[104:107], v[176:179], v[16:31]
    ds_read_b64_tr_b16 v[120:121], v82 offset:4096
    ds_read_b64_tr_b16 v[122:123], v82 offset:5120
    buffer_load_dwordx4 v[160:163], v14, s[40:43], s34 offen offset:0 sc1
    s_add_u32 s76, s76, 3
    s_and_b32 s76, s76, 15
    s_lshl_b32 s10, s76, 13
    v_mfma_f32_32x32x16_bf16 v[32:47], v[108:111], v[176:179], v[32:47]
    ds_read_b64_tr_b16 v[124:125], v83 offset:4096
    ds_read_b64_tr_b16 v[126:127], v83 offset:5120
    s_waitcnt vmcnt(11) lgkmcnt(4)
    v_mfma_f32_32x32x16_bf16 v[16:31], v[112:115], v[180:183], v[16:31]
    ds_read_b64_tr_b16 v[104:105], v82 offset:6144
    ds_read_b64_tr_b16 v[106:107], v82 offset:7168
    buffer_load_dwordx4 v[164:167], v14, s[40:43], s34 offen offset:2048 sc1
    v_mfma_f32_32x32x16_bf16 v[32:47], v[116:119], v[180:183], v[32:47]
    ds_read_b64_tr_b16 v[108:109], v83 offset:6144
    ds_read_b64_tr_b16 v[110:111], v83 offset:7168
    v_add_u32 v80, s8, v72
    v_add_u32 v81, s8, v73
    s_waitcnt vmcnt(11) lgkmcnt(4)
    v_mfma_f32_32x32x16_bf16 v[16:31], v[120:123], v[184:187], v[16:31]
    ds_read_b32 v79, v8 offset:25984
    ds_read_b64_tr_b16 v[112:113], v80 offset:0
    ds_read_b64_tr_b16 v[114:115], v80 offset:1024
    buffer_load_dwordx4 v[168:171], v78, s[40:43], s34 offen offset:0 sc1
    v_mfma_f32_32x32x16_bf16 v[32:47], v[124:127], v[184:187], v[32:47]
    ds_read_b64_tr_b16 v[116:117], v81 offset:0
    ds_read_b64_tr_b16 v[118:119], v81 offset:1024
    s_waitcnt vmcnt(11) lgkmcnt(4)
    v_mfma_f32_32x32x16_bf16 v[16:31], v[104:107], v[188:191], v[16:31]
    ds_read_b64_tr_b16 v[120:121], v80 offset:2048
    ds_read_b64_tr_b16 v[122:123], v80 offset:3072
    buffer_load_dwordx4 v[172:175], v78, s[40:43], s34 offen offset:2048 sc1
    v_mfma_f32_32x32x16_bf16 v[32:47], v[108:111], v[188:191], v[32:47]
    ds_read_b64_tr_b16 v[124:125], v81 offset:2048
    ds_read_b64_tr_b16 v[126:127], v81 offset:3072
    v_readfirstlane_b32 s76, v79
    s_nop 0
    s_and_b32 s76, s76, s52
    s_cbranch_scc0 L_tr7
L_bk7:
    s_ff1_i32_b32 s76, s76
    s_bitset0_b32 s52, s76
    s_add_u32 s77, s76, s65
    s_and_b32 s77, s77, 15
    s_mul_i32 s77, s77, 32768
    s_add_u32 s35, s77, s80
    s_waitcnt vmcnt(11) lgkmcnt(4)
    v_mfma_f32_32x32x16_bf16 v[16:31], v[112:115], v[128:131], v[16:31]
    ds_read_b64_tr_b16 v[104:105], v80 offset:4096
    ds_read_b64_tr_b16 v[106:107], v80 offset:5120
    buffer_load_dwordx4 v[176:179], v14, s[40:43], s35 offen offset:0 sc1
    s_add_u32 s76, s76, 3
    s_and_b32 s76, s76, 15
    s_lshl_b32 s11, s76, 13
    v_mfma_f32_32x32x16_bf16 v[32:47], v[116:119], v[128:131], v[32:47]
    ds_read_b64_tr_b16 v[108:109], v81 offset:4096
    ds_read_b64_tr_b16 v[110:111], v81 offset:5120
    s_waitcnt vmcnt(11) lgkmcnt(4)
    v_mfma_f32_32x32x16_bf16 v[16:31], v[120:123], v[132:135], v[16:31]
    ds_read_b64_tr_b16 v[112:113], v80 offset:6144
    ds_read_b64_tr_b16 v[114:115], v80 offset:7168
    buffer_load_dwordx4 v[180:183], v14, s[40:43], s35 offen offset:2048 sc1
    v_mfma_f32_32x32x16_bf16 v[32:47], v[124:127], v[132:135], v[32:47]
    ds_read_b64_tr_b16 v[116:117], v81 offset:6144
    ds_read_b64_tr_b16 v[118:119], v81 offset:7168
    v_add_u32 v82, s9, v72
    v_add_u32 v83, s9, v73
    s_waitcnt vmcnt(11) lgkmcnt(4)
    v_mfma_f32_32x32x16_bf16 v[16:31], v[104:107], v[136:139], v[16:31]
    ds_read_b32 v79, v8 offset:25984
    ds_read_b64_tr_b16 v[120:121], v82 offset:0
    ds_read_b64_tr_b16 v[122:123], v82 offset:1024
    buffer_load_dwordx4 v[184:187], v78, s[40:43], s35 offen offset:0 sc1
    v_mfma_f32_32x32x16_bf16 v[32:47], v[108:111], v[136:139], v[32:47]
    ds_read_b64_tr_b16 v[124:125], v83 offset:0
    ds_read_b64_tr_b16 v[126:127], v83 offset:1024
    s_waitcnt vmcnt(11) lgkmcnt(4)
    v_mfma_f32_32x32x16_bf16 v[16:31], v[112:115], v[140:143], v[16:31]
    ds_read_b64_tr_b16 v[104:105], v82 offset:2048
    ds_read_b64_tr_b16 v[106:107], v82 offset:3072
    buffer_load_dwordx4 v[188:191], v78, s[40:43], s35 offen offset:2048 sc1
    v_mfma_f32_32x32x16_bf16 v[32:47], v[116:119], v[140:143], v[32:47]
    ds_read_b64_tr_b16 v[108:109], v83 offset:2048
    ds_read_b64_tr_b16 v[110:111], v83 offset:3072
    v_readfirstlane_b32 s76, v79
    s_nop 0
    s_and_b32 s76, s76, s52
    s_cbranch_scc0 L_tr8
L_bk8:
    s_ff1_i32_b32 s76, s76
    s_bitset0_b32 s52, s76
    s_add_u32 s77, s76, s65
    s_and_b32 s77, s77, 15
    s_mul_i32 s77, s77, 32768
    s_add_u32 s36, s77, s80
    s_waitcnt vmcnt(11) lgkmcnt(4)
    v_mfma_f32_32x32x16_bf16 v[16:31], v[120:123], v[144:147], v[16:31]
    ds_read_b64_tr_b16 v[112:113], v82 offset:4096
    ds_read_b64_tr_b16 v[114:115], v82 offset:5120
    buffer_load_dwordx4 v[128:131], v14, s[40:43], s36 offen offset:0 sc1
    s_add_u32 s76, s76, 3
    s_and_b32 s76, s76, 15
    s_lshl_b32 s12, s76, 13
    v_mfma_f32_32x32x16_bf16 v[32:47], v[124:127], v[144:147], v[32:47]
    ds_read_b64_tr_b16 v[116:117], v83 offset:4096
    ds_read_b64_tr_b16 v[118:119], v83 offset:5120
    s_waitcnt vmcnt(11) lgkmcnt(4)
    v_mfma_f32_32x32x16_bf16 v[16:31], v[104:107], v[148:151], v[16:31]
    ds_read_b64_tr_b16 v[120:121], v82 offset:6144
    ds_read_b64_tr_b16 v[122:123], v82 offset:7168
    buffer_load_dwordx4 v[132:135], v14, s[40:43], s36 offen offset:2048 sc1
    v_mfma_f32_32x32x16_bf16 v[32:47], v[108:111], v[148:151], v[32:47]
    ds_read_b64_tr_b16 v[124:125], v83 offset:6144
    ds_read_b64_tr_b16 v[126:127], v83 offset:7168
    v_add_u32 v80, s10, v72
    v_add_u32 v81, s10, v73
    s_waitcnt vmcnt(11) lgkmcnt(4)
    v_mfma_f32_32x32x16_bf16 v[16:31], v[112:115], v[152:155], v[16:31]
    ds_read_b32 v79, v8 offset:25984
    ds_read_b64_tr_b16 v[104:105], v80 offset:0
    ds_read_b64_tr_b16 v[106:107], v80 offset:1024
    buffer_load_dwordx4 v[136:139], v78, s[40:43], s36 offen offset:0 sc1
    v_mfma_f32_32x32x16_bf16 v[32:47], v[116:119], v[152:155], v[32:47]
    ds_read_b64_tr_b16 v[108:109], v81 offset:0
    ds_read_b64_tr_b16 v[110:111], v81 offset:1024
    s_waitcnt vmcnt(11) lgkmcnt(4)
    v_mfma_f32_32x32x16_bf16 v[16:31], v[120:123], v[156:159], v[16:31]
    ds_read_b64_tr_b16 v[112:113], v80 offset:2048
    ds_read_b64_tr_b16 v[114:115], v80 offset:3072
    buffer_load_dwordx4 v[140:143], v78, s[40:43], s36 offen offset:2048 sc1
    v_mfma_f32_32x32x16_bf16 v[32:47], v[124:127], v[156:159], v[32:47]
    ds_read_b64_tr_b16 v[116:117], v81 offset:2048
    ds_read_b64_tr_b16 v[118:119], v81 offset:3072
    v_readfirstlane_b32 s76, v79
    s_nop 0
    s_and_b32 s76, s76, s52
    s_cbranch_scc0 L_tr9
L_bk9:
    s_ff1_i32_b32 s76, s76
    s_bitset0_b32 s52, s76
    s_add_u32 s77, s76, s65
    s_and_b32 s77, s77, 15
    s_mul_i32 s77, s77, 32768
    s_add_u32 s37, s77, s80
    s_waitcnt vmcnt(11) lgkmcnt(4)
    v_mfma_f32_32x32x16_bf16 v[16:31], v[104:107], v[160:163], v[16:31]
    ds_read_b64_tr_b16 v[120:121], v80 offset:4096
    ds_read_b64_tr_b16 v[122:123], v80 offset:5120
    buffer_load_dwordx4 v[144:147], v14, s[40:43], s37 offen offset:0 sc1
    s_add_u32 s76, s76, 3
    s_and_b32 s76, s76, 15
    s_lshl_b32 s13, s76, 13
    v_mfma_f32_32x32x16_bf16 v[32:47], v[108:111], v[160:163], v[32:47]
    ds_read_b64_tr_b16 v[124:125], v81 offset:4096
    ds_read_b64_tr_b16 v[126:127], v81 offset:5120
    s_waitcnt vmcnt(11) lgkmcnt(4)
    v_mfma_f32_32x32x16_bf16 v[16:31], v[112:115], v[164:167], v[16:31]
    ds_read_b64_tr_b16 v[104:105], v80 offset:6144
    ds_read_b64_tr_b16 v[106:107], v80 offset:7168
    buffer_load_dwordx4 v[148:151], v14, s[40:43], s37 offen offset:2048 sc1
    v_mfma_f32_32x32x16_bf16 v[32:47], v[116:119], v[164:167], v[32:47]
    ds_read_b64_tr_b16 v[108:109], v81 offset:6144
    ds_read_b64_tr_b16 v[110:111], v81 offset:7168
    v_add_u32 v82, s11, v72
    v_add_u32 v83, s11, v73
    s_waitcnt vmcnt(11) lgkmcnt(4)
    v_mfma_f32_32x32x16_bf16 v[16:31], v[120:123], v[168:171], v[16:31]
    ds_read_b32 v79, v8 offset:25984
    ds_read_b64_tr_b16 v[112:113], v82 offset:0
    ds_read_b64_tr_b16 v[114:115], v82 offset:1024
    buffer_load_dwordx4 v[152:155], v78, s[40:43], s37 offen offset:0 sc1
    v_mfma_f32_32x32x16_bf16 v[32:47], v[124:127], v[168:171], v[32:47]
    ds_read_b64_tr_b16 v[116:117], v83 offset:0
    ds_read_b64_tr_b16 v[118:119], v83 offset:1024
    s_waitcnt vmcnt(11) lgkmcnt(4)
    v_mfma_f32_32x32x16_bf16 v[16:31], v[104:107], v[172:175], v[16:31]
    ds_read_b64_tr_b16 v[120:121], v82 offset:2048
    ds_read_b64_tr_b16 v[122:123], v82 offset:3072
    buffer_load_dwordx4 v[156:159], v78, s[40:43], s37 offen offset:2048 sc1
    v_mfma_f32_32x32x16_bf16 v[32:47], v[108:111], v[172:175], v[32:47]
    ds_read_b64_tr_b16 v[124:125], v83 offset:2048
    ds_read_b64_tr_b16 v[126:127], v83 offset:3072
    v_readfirstlane_b32 s76, v79
    s_nop 0
    s_and_b32 s76, s76, s52
    s_cbranch_scc0 L_tr10
L_bk10:
    s_ff1_i32_b32 s76, s76
    s_bitset0_b32 s52, s76
    s_add_u32 s77, s76, s65
    s_and_b32 s77, s77, 15
    s_mul_i32 s77, s77, 32768
    s_add_u32 s38, s77, s80
    s_waitcnt vmcnt(11) lgkmcnt(4)
    v_mfma_f32_32x32x16_bf16 v[16:31], v[112:115], v[176:179], v[16:31]
    ds_read_b64_tr_b16 v[104:105], v82 offset:4096
    ds_read_b64_tr_b16 v[106:107], v82 offset:5120
    buffer_load_dwordx4 v[160:163], v14, s[40:43], s38 offen offset:0 sc1
    s_add_u32 s76, s76, 3
    s_and_b32 s76, s76, 15
    s_lshl_b32 s14, s76, 13
    v_mfma_f32_32x32x16_bf16 v[32:47], v[116:119], v[176:179], v[32:47]
    ds_read_b64_tr_b16 v[108:109], v83 offset:4096
    ds_read_b64_tr_b16 v[110:111], v83 offset:5120
    s_waitcnt vmcnt(11) lgkmcnt(4)
    v_mfma_f32_32x32x16_bf16 v[16:31], v[120:123], v[180:183], v[16:31]
    ds_read_b64_tr_b16 v[112:113], v82 offset:6144
    ds_read_b64_tr_b16 v[114:115], v82 offset:7168
    buffer_load_dwordx4 v[164:167], v14, s[40:43], s38 offen offset:2048 sc1
    v_mfma_f32_32x32x16_bf16 v[32:47], v[124:127], v[180:183], v[32:47]
    ds_read_b64_tr_b16 v[116:117], v83 offset:6144
    ds_read_b64_tr_b16 v[118:119], v83 offset:7168
    v_add_u32 v80, s12, v72
    v_add_u32 v81, s12, v73
    s_waitcnt vmcnt(11) lgkmcnt(4)
    v_mfma_f32_32x32x16_bf16 v[16:31], v[104:107], v[184:187], v[16:31]
    ds_read_b32 v79, v8 offset:25984
    ds_read_b64_tr_b16 v[120:121], v80 offset:0
    ds_read_b64_tr_b16 v[122:123], v80 offset:1024
    buffer_load_dwordx4 v[168:171], v78, s[40:43], s38 offen offset:0 sc1
    v_mfma_f32_32x32x16_bf16 v[32:47], v[108:111], v[184:187], v[32:47]
    ds_read_b64_tr_b16 v[124:125], v81 offset:0
    ds_read_b64_tr_b16 v[126:127], v81 offset:1024
    s_waitcnt vmcnt(11) lgkmcnt(4)
    v_mfma_f32_32x32x16_bf16 v[16:31], v[112:115], v[188:191], v[16:31]
    ds_read_b64_tr_b16 v[104:105], v80 offset:2048
    ds_read_b64_tr_b16 v[106:107], v80 offset:3072
    buffer_load_dwordx4 v[172:175], v78, s[40:43], s38 offen offset:2048 sc1
    v_mfma_f32_32x32x16_bf16 v[32:47], v[116:119], v[188:191], v[32:47]
    ds_read_b64_tr_b16 v[108:109], v81 offset:2048
    ds_read_b64_tr_b16 v[110:111], v81 offset:3072
    v_readfirstlane_b32 s76, v79
    s_nop 0
    s_and_b32 s76, s76, s52
    s_cbranch_scc0 L_tr11
L_bk11:
    s_ff1_i32_b32 s76, s76
    s_bitset0_b32 s52, s76
    s_add_u32 s77, s76, s65
    s_and_b32 s77, s77, 15
    s_mul_i32 s77, s77, 32768
    s_add_u32 s39, s77, s80
    s_waitcnt vmcnt(11) lgkmcnt(4)
    v_mfma_f32_32x32x16_bf16 v[16:31], v[120:123], v[128:131], v[16:31]
    ds_read_b64_tr_b16 v[112:113], v80 offset:4096
    ds_read_b64_tr_b16 v[114:115], v80 offset:5120
    buffer_load_dwordx4 v[176:179], v14, s[40:43], s39 offen offset:0 sc1
    s_add_u32 s76, s76, 3
    s_and_b32 s76, s76, 15
    s_lshl_b32 s15, s76, 13
    v_mfma_f32_32x32x16_bf16 v[32:47], v[124:127], v[128:131], v[32:47]
    ds_read_b64_tr_b16 v[116:117], v81 offset:4096
    ds_read_b64_tr_b16 v[118:119], v81 offset:5120
    s_waitcnt vmcnt(11) lgkmcnt(4)
    v_mfma_f32_32x32x16_bf16 v[16:31], v[104:107], v[132:135], v[16:31]
    ds_read_b64_tr_b16 v[120:121], v80 offset:6144
    ds_read_b64_tr_b16 v[122:123], v80 offset:7168
    buffer_load_dwordx4 v[180:183], v14, s[40:43], s39 offen offset:2048 sc1
    v_mfma_f32_32x32x16_bf16 v[32:47], v[108:111], v[132:135], v[32:47]
    ds_read_b64_tr_b16 v[124:125], v81 offset:6144
    ds_read_b64_tr_b16 v[126:127], v81 offset:7168
    v_add_u32 v82, s13, v72
    v_add_u32 v83, s13, v73
    s_waitcnt vmcnt(11) lgkmcnt(4)
    v_mfma_f32_32x32x16_bf16 v[16:31], v[112:115], v[136:139], v[16:31]
    ds_read_b32 v79, v8 offset:25984
    ds_read_b64_tr_b16 v[104:105], v82 offset:0
    ds_read_b64_tr_b16 v[106:107], v82 offset:1024
    buffer_load_dwordx4 v[184:187], v78, s[40:43], s39 offen offset:0 sc1
    v_mfma_f32_32x32x16_bf16 v[32:47], v[116:119], v[136:139], v[32:47]
    ds_read_b64_tr_b16 v[108:109], v83 offset:0
    ds_read_b64_tr_b16 v[110:111], v83 offset:1024
    s_waitcnt vmcnt(11) lgkmcnt(4)
    v_mfma_f32_32x32x16_bf16 v[16:31], v[120:123], v[140:143], v[16:31]
    ds_read_b64_tr_b16 v[112:113], v82 offset:2048
    ds_read_b64_tr_b16 v[114:115], v82 offset:3072
    buffer_load_dwordx4 v[188:191], v78, s[40:43], s39 offen offset:2048 sc1
    v_mfma_f32_32x32x16_bf16 v[32:47], v[124:127], v[140:143], v[32:47]
    ds_read_b64_tr_b16 v[116:117], v83 offset:2048
    ds_read_b64_tr_b16 v[118:119], v83 offset:3072
    v_readfirstlane_b32 s76, v79
    s_nop 0
    s_and_b32 s76, s76, s52
    s_cbranch_scc0 L_tr12
L_bk12:
    s_ff1_i32_b32 s76, s76
    s_bitset0_b32 s52, s76
    s_add_u32 s77, s76, s65
    s_and_b32 s77, s77, 15
    s_mul_i32 s77, s77, 32768
    s_add_u32 s48, s77, s80
    s_waitcnt vmcnt(11) lgkmcnt(4)
    v_mfma_f32_32x32x16_bf16 v[16:31], v[104:107], v[144:147], v[16:31]
    ds_read_b64_tr_b16 v[120:121], v82 offset:4096
    ds_read_b64_tr_b16 v[122:123], v82 offset:5120
    buffer_load_dwordx4 v[128:131], v14, s[40:43], s48 offen offset:0 sc1
    s_add_u32 s76, s76, 3
    s_and_b32 s76, s76, 15
    s_lshl_b32 s16, s76, 13
    v_mfma_f32_32x32x16_bf16 v[32:47], v[108:111], v[144:147], v[32:47]
    ds_read_b64_tr_b16 v[124:125], v83 offset:4096
    ds_read_b64_tr_b16 v[126:127], v83 offset:5120
    s_waitcnt vmcnt(11) lgkmcnt(4)
    v_mfma_f32_32x32x16_bf16 v[16:31], v[112:115], v[148:151], v[16:31]
    ds_read_b64_tr_b16 v[104:105], v82 offset:6144
    ds_read_b64_tr_b16 v[106:107], v82 offset:7168
    buffer_load_dwordx4 v[132:135], v14, s[40:43], s48 offen offset:2048 sc1
    v_mfma_f32_32x32x16_bf16 v[32:47], v[116:119], v[148:151], v[32:47]
    ds_read_b64_tr_b16 v[108:109], v83 offset:6144
    ds_read_b64_tr_b16 v[110:111], v83 offset:7168
    v_add_u32 v80, s14, v72
    v_add_u32 v81, s14, v73
    s_waitcnt vmcnt(11) lgkmcnt(4)
    v_mfma_f32_32x32x16_bf16 v[16:31], v[120:123], v[152:155], v[16:31]
    ds_read_b32 v79, v8 offset:25984
    ds_read_b64_tr_b16 v[112:113], v80 offset:0
    ds_read_b64_tr_b16 v[114:115], v80 offset:1024
    buffer_load_dwordx4 v[136:139], v78, s[40:43], s48 offen offset:0 sc1
    v_mfma_f32_32x32x16_bf16 v[32:47], v[124:127], v[152:155], v[32:47]
    ds_read_b64_tr_b16 v[116:117], v81 offset:0
    ds_read_b64_tr_b16 v[118:119], v81 offset:1024
    s_waitcnt vmcnt(11) lgkmcnt(4)
    v_mfma_f32_32x32x16_bf16 v[16:31], v[104:107], v[156:159], v[16:31]
    ds_read_b64_tr_b16 v[120:121], v80 offset:2048
    ds_read_b64_tr_b16 v[122:123], v80 offset:3072
    buffer_load_dwordx4 v[140:143], v78, s[40:43], s48 offen offset:2048 sc1
    v_mfma_f32_32x32x16_bf16 v[32:47], v[108:111], v[156:159], v[32:47]
    ds_read_b64_tr_b16 v[124:125], v81 offset:2048
    ds_read_b64_tr_b16 v[126:127], v81 offset:3072
    v_readfirstlane_b32 s76, v79
    s_nop 0
    s_and_b32 s76, s76, s52
    s_cbranch_scc0 L_tr13
L_bk13:
    s_ff1_i32_b32 s76, s76
    s_bitset0_b32 s52, s76
    s_add_u32 s77, s76, s65
    s_and_b32 s77, s77, 15
    s_mul_i32 s77, s77, 32768
    s_add_u32 s49, s77, s80
    s_waitcnt vmcnt(11) lgkmcnt(4)
    v_mfma_f32_32x32x16_bf16 v[16:31], v[112:115], v[160:163], v[16:31]
    ds_read_b64_tr_b16 v[104:105], v80 offset:4096
    ds_read_b64_tr_b16 v[106:107], v80 offset:5120
    buffer_load_dwordx4 v[144:147], v14, s[40:43], s49 offen offset:0 sc1
    s_add_u32 s76, s76, 3
    s_and_b32 s76, s76, 15
    s_lshl_b32 s17, s76, 13
    v_mfma_f32_32x32x16_bf16 v[32:47], v[116:119], v[160:163], v[32:47]
    ds_read_b64_tr_b16 v[108:109], v81 offset:4096
    ds_read_b64_tr_b16 v[110:111], v81 offset:5120
    s_waitcnt vmcnt(11) lgkmcnt(4)
    v_mfma_f32_32x32x16_bf16 v[16:31], v[120:123], v[164:167], v[16:31]
    ds_read_b64_tr_b16 v[112:113], v80 offset:6144
    ds_read_b64_tr_b16 v[114:115], v80 offset:7168
    buffer_load_dwordx4 v[148:151], v14, s[40:43], s49 offen offset:2048 sc1
    v_mfma_f32_32x32x16_bf16 v[32:47], v[124:127], v[164:167], v[32:47]
    ds_read_b64_tr_b16 v[116:117], v81 offset:6144
    ds_read_b64_tr_b16 v[118:119], v81 offset:7168
    v_add_u32 v82, s15, v72
    v_add_u32 v83, s15, v73
    s_waitcnt vmcnt(11) lgkmcnt(4)
    v_mfma_f32_32x32x16_bf16 v[16:31], v[104:107], v[168:171], v[16:31]
    ds_read_b32 v79, v8 offset:25984
    ds_read_b64_tr_b16 v[120:121], v82 offset:0
    ds_read_b64_tr_b16 v[122:123], v82 offset:1024
    buffer_load_dwordx4 v[152:155], v78, s[40:43], s49 offen offset:0 sc1
    v_mfma_f32_32x32x16_bf16 v[32:47], v[108:111], v[168:171], v[32:47]
    ds_read_b64_tr_b16 v[124:125], v83 offset:0
    ds_read_b64_tr_b16 v[126:127], v83 offset:1024
    s_waitcnt vmcnt(11) lgkmcnt(4)
    v_mfma_f32_32x32x16_bf16 v[16:31], v[112:115], v[172:175], v[16:31]
    ds_read_b64_tr_b16 v[104:105], v82 offset:2048
    ds_read_b64_tr_b16 v[106:107], v82 offset:3072
    buffer_load_dwordx4 v[156:159], v78, s[40:43], s49 offen offset:2048 sc1
    v_mfma_f32_32x32x16_bf16 v[32:47], v[116:119], v[172:175], v[32:47]
    ds_read_b64_tr_b16 v[108:109], v83 offset:2048
    ds_read_b64_tr_b16 v[110:111], v83 offset:3072
    v_readfirstlane_b32 s76, v79
    s_nop 0
    s_and_b32 s76, s76, s52
    s_cbranch_scc0 L_tr14
L_bk14:
    s_ff1_i32_b32 s76, s76
    s_bitset0_b32 s52, s76
    s_add_u32 s77, s76, s65
    s_and_b32 s77, s77, 15
    s_mul_i32 s77, s77, 32768
    s_add_u32 s50, s77, s80
    s_waitcnt vmcnt(11) lgkmcnt(4)
    v_mfma_f32_32x32x16_bf16 v[16:31], v[120:123], v[176:179], v[16:31]
    ds_read_b64_tr_b16 v[112:113], v82 offset:4096
    ds_read_b64_tr_b16 v[114:115], v82 offset:5120
    buffer_load_dwordx4 v[160:163], v14, s[40:43], s50 offen offset:0 sc1
    s_add_u32 s76, s76, 3
    s_and_b32 s76, s76, 15
    s_lshl_b32 s18, s76, 13
    v_mfma_f32_32x32x16_bf16 v[32:47], v[124:127], v[176:179], v[32:47]
    ds_read_b64_tr_b16 v[116:117], v83 offset:4096
    ds_read_b64_tr_b16 v[118:119], v83 offset:5120
    s_waitcnt vmcnt(11) lgkmcnt(4)
    v_mfma_f32_32x32x16_bf16 v[16:31], v[104:107], v[180:183], v[16:31]
    ds_read_b64_tr_b16 v[120:121], v82 offset:6144
    ds_read_b64_tr_b16 v[122:123], v82 offset:7168
    buffer_load_dwordx4 v[164:167], v14, s[40:43], s50 offen offset:2048 sc1
    v_mfma_f32_32x32x16_bf16 v[32:47], v[108:111], v[180:183], v[32:47]
    ds_read_b64_tr_b16 v[124:125], v83 offset:6144
    ds_read_b64_tr_b16 v[126:127], v83 offset:7168
    v_add_u32 v80, s16, v72
    v_add_u32 v81, s16, v73
    s_waitcnt vmcnt(11) lgkmcnt(4)
    v_mfma_f32_32x32x16_bf16 v[16:31], v[112:115], v[184:187], v[16:31]
    ds_read_b32 v79, v8 offset:25984
    ds_read_b64_tr_b16 v[104:105], v80 offset:0
    ds_read_b64_tr_b16 v[106:107], v80 offset:1024
    buffer_load_dwordx4 v[168:171], v78, s[40:43], s50 offen offset:0 sc1
    v_mfma_f32_32x32x16_bf16 v[32:47], v[116:119], v[184:187], v[32:47]
    ds_read_b64_tr_b16 v[108:109], v81 offset:0
    ds_read_b64_tr_b16 v[110:111], v81 offset:1024
    s_waitcnt vmcnt(11) lgkmcnt(4)
    v_mfma_f32_32x32x16_bf16 v[16:31], v[120:123], v[188:191], v[16:31]
    ds_read_b64_tr_b16 v[112:113], v80 offset:2048
    ds_read_b64_tr_b16 v[114:115], v80 offset:3072
    buffer_load_dwordx4 v[172:175], v78, s[40:43], s50 offen offset:2048 sc1
    v_mfma_f32_32x32x16_bf16 v[32:47], v[124:127], v[188:191], v[32:47]
    ds_read_b64_tr_b16 v[116:117], v81 offset:2048
    ds_read_b64_tr_b16 v[118:119], v81 offset:3072
    v_readfirstlane_b32 s76, v79
    s_nop 0
    s_and_b32 s76, s76, s52
    s_cbranch_scc0 L_tr15
L_bk15:
    s_ff1_i32_b32 s76, s76
    s_bitset0_b32 s52, s76
    s_add_u32 s77, s76, s65
    s_and_b32 s77, s77, 15
    s_mul_i32 s77, s77, 32768
    s_add_u32 s51, s77, s80
    s_waitcnt vmcnt(11) lgkmcnt(4)
    v_mfma_f32_32x32x16_bf16 v[16:31], v[104:107], v[128:131], v[16:31]
    ds_read_b64_tr_b16 v[120:121], v80 offset:4096
    ds_read_b64_tr_b16 v[122:123], v80 offset:5120
    buffer_load_dwordx4 v[176:179], v14, s[40:43], s51 offen offset:0 sc1
    s_add_u32 s76, s76, 3
    s_and_b32 s76, s76, 15
    s_lshl_b32 s19, s76, 13
    v_mfma_f32_32x32x16_bf16 v[32:47], v[108:111], v[128:131], v[32:47]
    ds_read_b64_tr_b16 v[124:125], v81 offset:4096
    ds_read_b64_tr_b16 v[126:127], v81 offset:5120
    s_waitcnt vmcnt(11) lgkmcnt(4)
    v_mfma_f32_32x32x16_bf16 v[16:31], v[112:115], v[132:135], v[16:31]
    ds_read_b64_tr_b16 v[104:105], v80 offset:6144
    ds_read_b64_tr_b16 v[106:107], v80 offset:7168
    buffer_load_dwordx4 v[180:183], v14, s[40:43], s51 offen offset:2048 sc1
    v_mfma_f32_32x32x16_bf16 v[32:47], v[116:119], v[132:135], v[32:47]
    ds_read_b64_tr_b16 v[108:109], v81 offset:6144
    ds_read_b64_tr_b16 v[110:111], v81 offset:7168
    v_add_u32 v82, s17, v72
    v_add_u32 v83, s17, v73
    s_waitcnt vmcnt(11) lgkmcnt(4)
    v_mfma_f32_32x32x16_bf16 v[16:31], v[120:123], v[136:139], v[16:31]
    ds_read_b64 v[192:193], v10 offset:16384
    ds_read_b64_tr_b16 v[112:113], v82 offset:0
    ds_read_b64_tr_b16 v[114:115], v82 offset:1024
    buffer_load_dwordx4 v[184:187], v78, s[40:43], s51 offen offset:0 sc1
    v_mfma_f32_32x32x16_bf16 v[32:47], v[124:127], v[136:139], v[32:47]
    ds_read_b64_tr_b16 v[116:117], v83 offset:0
    ds_read_b64_tr_b16 v[118:119], v83 offset:1024
    s_waitcnt vmcnt(11) lgkmcnt(4)
    v_mfma_f32_32x32x16_bf16 v[16:31], v[104:107], v[140:143], v[16:31]
    ds_read_b64 v[194:195], v10 offset:16400
    ds_read_b64_tr_b16 v[120:121], v82 offset:2048
    ds_read_b64_tr_b16 v[122:123], v82 offset:3072
    buffer_load_dwordx4 v[188:191], v78, s[40:43], s51 offen offset:2048 sc1
    s_barrier
    v_mfma_f32_32x32x16_bf16 v[32:47], v[108:111], v[140:143], v[32:47]
    ds_read_b64_tr_b16 v[124:125], v83 offset:2048
    ds_read_b64_tr_b16 v[126:127], v83 offset:3072
    s_waitcnt vmcnt(11) lgkmcnt(4)
    v_mfma_f32_32x32x16_bf16 v[16:31], v[112:115], v[144:147], v[16:31]
    ds_read_b64 v[196:197], v10 offset:16416
    ds_read_b64_tr_b16 v[104:105], v82 offset:4096
    ds_read_b64_tr_b16 v[106:107], v82 offset:5120
    v_mfma_f32_32x32x16_bf16 v[32:47], v[116:119], v[144:147], v[32:47]
    ds_read_b64_tr_b16 v[108:109], v83 offset:4096
    ds_read_b64_tr_b16 v[110:111], v83 offset:5120
    s_waitcnt vmcnt(10) lgkmcnt(4)
    v_mfma_f32_32x32x16_bf16 v[16:31], v[120:123], v[148:151], v[16:31]
    ds_read_b64 v[198:199], v10 offset:16432
    ds_read_b64_tr_b16 v[112:113], v82 offset:6144
    ds_read_b64_tr_b16 v[114:115], v82 offset:7168
    v_mfma_f32_32x32x16_bf16 v[32:47], v[124:127], v[148:151], v[32:47]
    ds_read_b64_tr_b16 v[116:117], v83 offset:6144
    ds_read_b64_tr_b16 v[118:119], v83 offset:7168
    v_add_u32 v80, s18, v72
    v_add_u32_e64 v81, s18, v73
    s_waitcnt vmcnt(9) lgkmcnt(4)
    v_mfma_f32_32x32x16_bf16 v[16:31], v[104:107], v[152:155], v[16:31]
    ds_read_b64 v[200:201], v10 offset:16448
    ds_read_b64_tr_b16 v[120:121], v80 offset:0
    ds_read_b64_tr_b16 v[122:123], v80 offset:1024
    v_mfma_f32_32x32x16_bf16 v[32:47], v[108:111], v[152:155], v[32:47]
    ds_read_b64_tr_b16 v[124:125], v81 offset:0
    ds_read_b64_tr_b16 v[126:127], v81 offset:1024
    s_waitcnt vmcnt(8) lgkmcnt(4)
    v_mfma_f32_32x32x16_bf16 v[16:31], v[112:115], v[156:159], v[16:31]
    ds_read_b64 v[202:203], v10 offset:16464
    ds_read_b64_tr_b16 v[104:105], v80 offset:2048
    ds_read_b64_tr_b16 v[106:107], v80 offset:3072
    v_mfma_f32_32x32x16_bf16 v[32:47], v[116:119], v[156:159], v[32:47]
    ds_read_b64_tr_b16 v[108:109], v81 offset:2048
    ds_read_b64_tr_b16 v[110:111], v81 offset:3072
    s_waitcnt vmcnt(7) lgkmcnt(4)
    v_mfma_f32_32x32x16_bf16 v[16:31], v[120:123], v[160:163], v[16:31]
    ds_read_b64 v[204:205], v10 offset:16480
    ds_read_b64_tr_b16 v[112:113], v80 offset:4096
    ds_read_b64_tr_b16 v[114:115], v80 offset:5120
    v_mfma_f32_32x32x16_bf16 v[32:47], v[124:127], v[160:163], v[32:47]
    ds_read_b64_tr_b16 v[116:117], v81 offset:4096
    ds_read_b64_tr_b16 v[118:119], v81 offset:5120
    s_waitcnt vmcnt(6) lgkmcnt(4)
    v_mfma_f32_32x32x16_bf16 v[16:31], v[104:107], v[164:167], v[16:31]
    ds_read_b64 v[206:207], v10 offset:16496
    ds_read_b64_tr_b16 v[120:121], v80 offset:6144
    ds_read_b64_tr_b16 v[122:123], v80 offset:7168
    v_mfma_f32_32x32x16_bf16 v[32:47], v[108:111], v[164:167], v[32:47]
    ds_read_b64_tr_b16 v[124:125], v81 offset:6144
    ds_read_b64_tr_b16 v[126:127], v81 offset:7168
    v_add_u32 v82, s19, v72
    v_add_u32 v83, s19, v73
    s_waitcnt vmcnt(5) lgkmcnt(4)
    v_mfma_f32_32x32x16_bf16 v[16:31], v[112:115], v[168:171], v[16:31]
    ds_read_b128 v[208:211], v11 offset:16384
    ds_read_b64_tr_b16 v[104:105], v82 offset:0
    ds_read_b64_tr_b16 v[106:107], v82 offset:1024
    v_mfma_f32_32x32x16_bf16 v[32:47], v[116:119], v[168:171], v[32:47]
    ds_read_b64_tr_b16 v[108:109], v83 offset:0
    ds_read_b64_tr_b16 v[110:111], v83 offset:1024
    s_waitcnt vmcnt(4) lgkmcnt(4)
    v_mfma_f32_32x32x16_bf16 v[16:31], v[120:123], v[172:175], v[16:31]
    ds_read_b128 v[212:215], v11 offset:16400
    ds_read_b64_tr_b16 v[112:113], v82 offset:2048
    ds_read_b64_tr_b16 v[114:115], v82 offset:3072
    v_mfma_f32_32x32x16_bf16 v[32:47], v[124:127], v[172:175], v[32:47]
    ds_read_b64_tr_b16 v[116:117], v83 offset:2048
    ds_read_b64_tr_b16 v[118:119], v83 offset:3072
    s_waitcnt vmcnt(3) lgkmcnt(4)
    v_mfma_f32_32x32x16_bf16 v[16:31], v[104:107], v[176:179], v[16:31]
    ds_read_b64_tr_b16 v[120:121], v82 offset:4096
    ds_read_b64_tr_b16 v[122:123], v82 offset:5120
    v_mfma_f32_32x32x16_bf16 v[32:47], v[108:111], v[176:179], v[32:47]
    ds_read_b64_tr_b16 v[124:125], v83 offset:4096
    ds_read_b64_tr_b16 v[126:127], v83 offset:5120
    s_waitcnt vmcnt(2) lgkmcnt(4)
    v_mfma_f32_32x32x16_bf16 v[16:31], v[112:115], v[180:183], v[16:31]
    ds_read_b64_tr_b16 v[104:105], v82 offset:6144
    ds_read_b64_tr_b16 v[106:107], v82 offset:7168
    v_mfma_f32_32x32x16_bf16 v[32:47], v[116:119], v[180:183], v[32:47]
    ds_read_b64_tr_b16 v[108:109], v83 offset:6144
    ds_read_b64_tr_b16 v[110:111], v83 offset:7168
    s_waitcnt vmcnt(1) lgkmcnt(4)
    v_mfma_f32_32x32x16_bf16 v[16:31], v[120:123], v[184:187], v[16:31]
    v_mfma_f32_32x32x16_bf16 v[32:47], v[124:127], v[184:187], v[32:47]
    s_waitcnt vmcnt(0) lgkmcnt(0)
    v_mfma_f32_32x32x16_bf16 v[16:31], v[104:107], v[188:191], v[16:31]
    v_mfma_f32_32x32x16_bf16 v[32:47], v[108:111], v[188:191], v[32:47]
    s_nop 10
    v_cvt_pk_bf16_f32 v88, v16, v17
    v_cvt_pk_bf16_f32 v89, v18, v19
    v_cvt_pk_bf16_f32 v90, v20, v21
    v_cvt_pk_bf16_f32 v91, v22, v23
    v_cvt_pk_bf16_f32 v92, v24, v25
    v_cvt_pk_bf16_f32 v93, v26, v27
    v_cvt_pk_bf16_f32 v94, v28, v29
    v_cvt_pk_bf16_f32 v95, v30, v31
    v_cvt_pk_bf16_f32 v96, v32, v33
    v_cvt_pk_bf16_f32 v97, v34, v35
    v_cvt_pk_bf16_f32 v98, v36, v37
    v_cvt_pk_bf16_f32 v99, v38, v39
    v_cvt_pk_bf16_f32 v100, v40, v41
    v_cvt_pk_bf16_f32 v101, v42, v43
    v_cvt_pk_bf16_f32 v102, v44, v45
    v_cvt_pk_bf16_f32 v103, v46, v47
    v_dot2_f32_bf16 v104, v88, s89, 0
    v_dot2_f32_bf16 v105, v88, v88, 0
    v_dot2_f32_bf16 v106, v88, v192, 0
    v_dot2_f32_bf16 v104, v89, s89, v104
    v_dot2_f32_bf16 v105, v89, v89, v105
    v_dot2_f32_bf16 v106, v89, v193, v106
    v_dot2_f32_bf16 v104, v90, s89, v104
    v_dot2_f32_bf16 v105, v90, v90, v105
    v_dot2_f32_bf16 v106, v90, v194, v106
    v_dot2_f32_bf16 v104, v91, s89, v104
    v_dot2_f32_bf16 v105, v91, v91, v105
    v_dot2_f32_bf16 v106, v91, v195, v106
    v_dot2_f32_bf16 v104, v92, s89, v104
    v_dot2_f32_bf16 v105, v92, v92, v105
    v_dot2_f32_bf16 v106, v92, v196, v106
    v_dot2_f32_bf16 v104, v93, s89, v104
    v_dot2_f32_bf16 v105, v93, v93, v105
    v_dot2_f32_bf16 v106, v93, v197, v106
    v_dot2_f32_bf16 v104, v94, s89, v104
    v_dot2_f32_bf16 v105, v94, v94, v105
    v_dot2_f32_bf16 v106, v94, v198, v106
    v_dot2_f32_bf16 v104, v95, s89, v104
    v_dot2_f32_bf16 v105, v95, v95, v105
    v_dot2_f32_bf16 v106, v95, v199, v106
    v_dot2_f32_bf16 v104, v96, s89, v104
    v_dot2_f32_bf16 v105, v96, v96, v105
    v_dot2_f32_bf16 v106, v96, v200, v106
    v_dot2_f32_bf16 v104, v97, s89, v104
    v_dot2_f32_bf16 v105, v97, v97, v105
    v_dot2_f32_bf16 v106, v97, v201, v106
    v_dot2_f32_bf16 v104, v98, s89, v104
    v_dot2_f32_bf16 v105, v98, v98, v105
    v_dot2_f32_bf16 v106, v98, v202, v106
    v_dot2_f32_bf16 v104, v99, s89, v104
    v_dot2_f32_bf16 v105, v99, v99, v105
    v_dot2_f32_bf16 v106, v99, v203, v106
    v_dot2_f32_bf16 v104, v100, s89, v104
    v_dot2_f32_bf16 v105, v100, v100, v105
    v_dot2_f32_bf16 v106, v100, v204, v106
    v_dot2_f32_bf16 v104, v101, s89, v104
    v_dot2_f32_bf16 v105, v101, v101, v105
    v_dot2_f32_bf16 v106, v101, v205, v106
    v_dot2_f32_bf16 v104, v102, s89, v104
    v_dot2_f32_bf16 v105, v102, v102, v105
    v_dot2_f32_bf16 v106, v102, v206, v106
    v_dot2_f32_bf16 v104, v103, s89, v104
    v_dot2_f32_bf16 v105, v103, v103, v105
    v_dot2_f32_bf16 v106, v103, v207, v106
    s_lshl_b32 s76, s62, 9
    s_add_u32 s77, s76, s99
    v_mov_b32 v107, 0
    v_mov_b32 v4, v104
    v_mov_b32 v5, v105
    v_mov_b32 v6, v106
    v_permlane32_swap_b32 v104, v4
    v_permlane32_swap_b32 v105, v5
    v_permlane32_swap_b32 v106, v6
    v_add_f32 v104, v104, v4
    v_add_f32 v105, v105, v5
    v_add_f32_e64 v106, v106, v6
    s_mov_b32 exec_hi, 0
    s_bitcmp1_b32 s100, 1
    s_cbranch_scc0 L_loc_55
    buffer_store_dwordx4 v[104:107], v12, s[40:43], s77 offen offset:1024
L_pubd_56:
    s_mov_b64 exec, -1
    ds_write_b64 v64, v[88:89]
    ds_write_b64 v65, v[90:91]
    ds_write_b64 v66, v[92:93]
    ds_write_b64 v67, v[94:95]
    ds_write_b64 v68, v[96:97]
    ds_write_b64 v69, v[98:99]
    ds_write_b64 v70, v[100:101]
    ds_write_b64 v71, v[102:103]
    v_bfe_u32 v4, v1, 1, 3
    v_bfe_u32 v5, v1, 4, 1
    v_lshlrev_b32 v176, 4, v4
    v_lshl_add_u32 v176, v5, 3, v176
    v_and_b32_e64 v5, 1, v1
    v_lshl_add_u32 v176, v5, 2, v176
    v_lshlrev_b32_e64 v177, 2, v2
    v_lshl_add_u32 v177, v3, 8, v177
    v_and_b32 v4, 15, v1
    v_lshrrev_b32 v5, 4, v1
    v_mul_u32_u24 v179, 149504, v4
    v_lshl_add_u32 v180, v5, 4, v179
    s_lshl_b32 s82, s97, 7
    s_lshl_b32 s79, s62, 5
    s_add_u32 s82, s82, s79
    s_lshl_b32 s79, s62, 2
    v_mov_b32_e64 v7, s79
    v_mul_u32_u24 v178, 9344, v3
    v_lshl_add_u32 v178, v2, 4, v178
    s_mul_i32 s78, s97, 149504
    s_add_u32 s78, s78, s76
    s_add_u32 s78, s78, 8388608
    s_add_u32 s48, s78, 18688
    s_add_u32 s49, s48, 18688
    s_add_u32 s50, s49, 18688
    s_add_u32 s51, s50, 18688
    s_add_u32 s52, s51, 18688
    s_add_u32 s53, s52, 18688
    s_add_u32 s54, s53, 18688
    buffer_load_dwordx4 v[112:115], v178, s[40:43], s78 offen offset:1024 sc1
    buffer_load_dwordx4 v[116:119], v178, s[40:43], s48 offen offset:1024 sc1
    buffer_load_dwordx4 v[120:123], v178, s[40:43], s49 offen offset:1024 sc1
    buffer_load_dwordx4 v[124:127], v178, s[40:43], s50 offen offset:1024 sc1
    buffer_load_dwordx4 v[128:131], v178, s[40:43], s51 offen offset:1024 sc1
    buffer_load_dwordx4 v[132:135], v178, s[40:43], s52 offen offset:1024 sc1
    buffer_load_dwordx4 v[136:139], v178, s[40:43], s53 offen offset:1024 sc1
    buffer_load_dwordx4 v[140:143], v178, s[40:43], s54 offen offset:1024 sc1
    v_dot2_f32_bf16 v76, v208, s89, 0
    v_dot2_f32_bf16 v76, v209, s89, v76
    v_dot2_f32_bf16 v76, v210, s89, v76
    v_dot2_f32_bf16 v76, v211, s89, v76
    v_dot2_f32_bf16 v76, v212, s89, v76
    v_dot2_f32_bf16 v76, v213, s89, v76
    v_dot2_f32_bf16 v76, v214, s89, v76
    v_dot2_f32_bf16 v76, v215, s89, v76
    s_nop 2
    v_add_f32_dpp v76, v76, v76 row_ror:8 row_mask:0xf bank_mask:0xf
    s_nop 1
    v_add_f32_dpp v76, v76, v76 row_ror:4 row_mask:0xf bank_mask:0xf
    s_nop 1
    v_add_f32_dpp v76, v76, v76 row_ror:2 row_mask:0xf bank_mask:0xf
    s_nop 1
    v_add_f32_dpp v76, v76, v76 row_ror:1 row_mask:0xf bank_mask:0xf
    v_mov_b32 v4, v76
    s_nop 1
    v_permlane16_swap_b32 v76, v4
    v_add_f32 v76, v76, v4
    v_mov_b32 v4, v76
    s_nop 1
    v_permlane32_swap_b32 v76, v4
    v_add_f32_e64 v76, v76, v4
    s_mov_b32 s88, 0
    s_waitcnt vmcnt(6)
    v_pk_add_f32 v[108:109], v[112:113], v[116:117]
    v_pk_add_f32 v[110:111], v[114:115], v[118:119]
    s_waitcnt vmcnt(5)
    v_pk_add_f32 v[108:109], v[108:109], v[120:121]
    v_pk_add_f32 v[110:111], v[110:111], v[122:123]
    s_waitcnt vmcnt(4)
    v_pk_add_f32 v[108:109], v[108:109], v[124:125]
    v_pk_add_f32 v[110:111], v[110:111], v[126:127]
    s_waitcnt vmcnt(3)
    v_pk_add_f32 v[108:109], v[108:109], v[128:129]
    v_pk_add_f32 v[110:111], v[110:111], v[130:131]
    s_waitcnt vmcnt(2)
    v_pk_add_f32 v[108:109], v[108:109], v[132:133]
    v_pk_add_f32 v[110:111], v[110:111], v[134:135]
    s_waitcnt vmcnt(1)
    v_pk_add_f32 v[108:109], v[108:109], v[136:137]
    v_pk_add_f32 v[110:111], v[110:111], v[138:139]
    s_waitcnt vmcnt(0)
    v_pk_add_f32 v[108:109], v[108:109], v[140:141]
    v_pk_add_f32 v[110:111], v[110:111], v[142:143]
    v_cmp_u_f32 vcc, v111, v111
    v_mov_b32 v4, v108
    v_mov_b32 v5, v109
    v_mov_b32 v6, v110
    s_cbranch_vccnz L_s3_58
L_s3ok_59:
    v_permlane32_swap_b32 v108, v4
    v_permlane32_swap_b32 v109, v5
    v_permlane32_swap_b32 v110, v6
    s_barrier
    v_add_f32 v108, v108, v4
    v_add_f32 v109, v109, v5
    v_add_f32 v110, v110, v6
    v_mul_f32 v108, 0x3a800000, v108
    v_mul_f32 v109, 0x3a800000, v109
    v_fma_f32 v4, -v108, v108, v109
    v_max_f32_e64 v4, 0, v4
    v_cvt_pk_bf16_f32 v116, v108, v108
    v_and_b32_e64 v116, s90, v116
    v_cvt_pk_bf16_f32 v4, v4, v4
    v_and_b32_e64 v4, s90, v4
    v_add_f32 v4, 0x3727c5ac, v4
    v_cvt_pk_bf16_f32 v4, v4, v4
    v_and_b32 v4, s90, v4
    v_sqrt_f32_e64 v4, v4
    s_nop 0
    v_cvt_pk_bf16_f32 v4, v4, v4
    v_and_b32 v4, s90, v4
    v_rcp_f32 v118, v4
    v_fma_f32 v120, -v116, v76, v110
    v_mul_f32 v119, v116, v118
    v_mul_f32 v120, v120, v118
    v_and_b32 v6, 3, v1
    v_lshlrev_b32 v6, 2, v6
    v_max_f32_dpp v4, v120, v120 row_ror:8 row_mask:0xf bank_mask:0xf
    s_lshl_b32 s83, s62, 12
    v_cmp_gt_u32 s[84:85], 32, v1
    v_max_f32_dpp v4, v4, v4 row_ror:4 row_mask:0xf bank_mask:0xf
    s_lshl_b32 s55, 1, s62
    s_sub_u32 s55, s55, 1
    v_max_f32_dpp v4, v4, v4 row_ror:2 row_mask:0xf bank_mask:0xf
    s_nop 1
    v_max_f32_dpp v4, v4, v4 row_ror:1 row_mask:0xf bank_mask:0xf
    v_mov_b32 v5, v4
    s_nop 1
    v_permlane16_swap_b32 v4, v5
    v_max_f32 v4, v4, v5
    v_cmp_eq_f32_e64 vcc, v4, v120
    ds_write_b32 v7, v4 offset:25600
    s_ff1_i32_b32 s77, vcc_lo
    s_and_b32 s77, s77, 31
    s_bfe_u32 s79, s77, 0x30001
    s_lshl3_add_u32 s79, s77, s79
    s_lshl4_add_u32 s79, s79, s83
    v_xor_b32_e64 v176, s79, v176
    ds_read_b32 v182, v176 offset:0
    s_waitcnt lgkmcnt(1)
    s_barrier
    ds_read_b32 v8, v6 offset:25600
    v_readlane_b32 s80, v118, s77
    v_readlane_b32 s81, v119, s77
    s_add_u32 s79, s82, s77
    v_writelane_b32 v4, s79, 33
    v_mov_b32 v5, s81
    s_waitcnt lgkmcnt(1)
    v_lshlrev_b32 v184, 16, v182
    v_and_b32_e64 v185, s90, v182
    v_fma_f32 v184, v184, s80, -v5
    v_fma_f32 v185, v185, s80, -v5
    v_cvt_pk_bf16_f32 v184, v184, v185
    v_cndmask_b32 v184, v4, v184, s[84:85]
    s_waitcnt lgkmcnt(0)
    v_cmp_eq_f32 s[56:57], v8, v4
    v_cmp_gt_f32 vcc, v8, v4
    s_and_b32 s56, s56, s55
    s_or_b32 s56, s56, vcc_lo
    s_cbranch_scc1 L_nopub_68
    buffer_store_dword v184, v177, s[40:43], s99 offen offset:0 sc1
L_nopub_68:
    v_lshlrev_b32 v16, 16, v88
    v_and_b32_e64 v17, s90, v88
    v_pk_fma_f32 v[144:145], v[16:17], v[118:119], v[118:119] op_sel:[0,0,1] op_sel_hi:[1,0,1] neg_lo:[0,0,1] neg_hi:[0,0,1]
    v_cvt_pk_bf16_f32 v124, v144, v145
    v_lshlrev_b32 v144, 16, v124
    v_and_b32 v145, s90, v124
    v_pk_add_f32 v[144:145], v[144:145], v[16:17]
    v_cvt_pk_bf16_f32 v124, v144, v145
    v_lshlrev_b32 v18, 16, v89
    v_and_b32 v19, s90, v89
    v_pk_fma_f32 v[146:147], v[18:19], v[118:119], v[118:119] op_sel:[0,0,1] op_sel_hi:[1,0,1] neg_lo:[0,0,1] neg_hi:[0,0,1]
    v_cvt_pk_bf16_f32 v125, v146, v147
    v_lshlrev_b32 v146, 16, v125
    v_and_b32 v147, s90, v125
    v_pk_add_f32 v[146:147], v[146:147], v[18:19]
    v_cvt_pk_bf16_f32 v125, v146, v147
    ds_write_b64 v64, v[124:125]
    v_lshlrev_b32 v20, 16, v90
    v_and_b32 v21, s90, v90
    v_pk_fma_f32 v[148:149], v[20:21], v[118:119], v[118:119] op_sel:[0,0,1] op_sel_hi:[1,0,1] neg_lo:[0,0,1] neg_hi:[0,0,1]
    v_cvt_pk_bf16_f32 v126, v148, v149
    v_lshlrev_b32 v148, 16, v126
    v_and_b32 v149, s90, v126
    v_pk_add_f32 v[148:149], v[148:149], v[20:21]
    v_cvt_pk_bf16_f32 v126, v148, v149
    v_lshlrev_b32 v22, 16, v91
    v_and_b32 v23, s90, v91
    v_pk_fma_f32 v[150:151], v[22:23], v[118:119], v[118:119] op_sel:[0,0,1] op_sel_hi:[1,0,1] neg_lo:[0,0,1] neg_hi:[0,0,1]
    v_cvt_pk_bf16_f32 v127, v150, v151
    v_lshlrev_b32 v150, 16, v127
    v_and_b32 v151, s90, v127
    v_pk_add_f32 v[150:151], v[150:151], v[22:23]
    v_cvt_pk_bf16_f32 v127, v150, v151
    ds_write_b64 v65, v[126:127]
    s_cmp_eq_u32 s56, 0
    s_cbranch_scc1 L_stay_69
    s_cmp_gt_u32 s62, 1
    s_cbranch_scc0 L_stay_69
    s_mov_b32 s91, -1
    v_lshlrev_b32 v24, 16, v92
    v_and_b32_e64 v25, s90, v92
    v_pk_fma_f32 v[152:153], v[24:25], v[118:119], v[118:119] op_sel:[0,0,1] op_sel_hi:[1,0,1] neg_lo:[0,0,1] neg_hi:[0,0,1]
    v_cvt_pk_bf16_f32 v128, v152, v153
    v_lshlrev_b32 v152, 16, v128
    v_and_b32 v153, s90, v128
    v_pk_add_f32 v[152:153], v[152:153], v[24:25]
    v_cvt_pk_bf16_f32 v128, v152, v153
    v_lshlrev_b32 v26, 16, v93
    v_and_b32 v27, s90, v93
    v_pk_fma_f32 v[154:155], v[26:27], v[118:119], v[118:119] op_sel:[0,0,1] op_sel_hi:[1,0,1] neg_lo:[0,0,1] neg_hi:[0,0,1]
    v_cvt_pk_bf16_f32 v129, v154, v155
    v_lshlrev_b32 v154, 16, v129
    v_and_b32 v155, s90, v129
    v_pk_add_f32 v[154:155], v[154:155], v[26:27]
    v_cvt_pk_bf16_f32 v129, v154, v155
    ds_write_b64 v66, v[128:129]
    v_lshlrev_b32 v28, 16, v94
    v_and_b32 v29, s90, v94
    v_pk_fma_f32 v[156:157], v[28:29], v[118:119], v[118:119] op_sel:[0,0,1] op_sel_hi:[1,0,1] neg_lo:[0,0,1] neg_hi:[0,0,1]
    v_cvt_pk_bf16_f32 v130, v156, v157
    v_lshlrev_b32 v156, 16, v130
    v_and_b32 v157, s90, v130
    v_pk_add_f32 v[156:157], v[156:157], v[28:29]
    v_cvt_pk_bf16_f32 v130, v156, v157
    v_lshlrev_b32 v30, 16, v95
    v_and_b32 v31, s90, v95
    v_pk_fma_f32 v[158:159], v[30:31], v[118:119], v[118:119] op_sel:[0,0,1] op_sel_hi:[1,0,1] neg_lo:[0,0,1] neg_hi:[0,0,1]
    v_cvt_pk_bf16_f32 v131, v158, v159
    v_lshlrev_b32 v158, 16, v131
    v_and_b32 v159, s90, v131
    v_pk_add_f32 v[158:159], v[158:159], v[30:31]
    v_cvt_pk_bf16_f32 v131, v158, v159
    ds_write_b64 v67, v[130:131]
    v_lshlrev_b32 v32, 16, v96
    v_and_b32 v33, s90, v96
    v_pk_fma_f32 v[160:161], v[32:33], v[118:119], v[118:119] op_sel:[0,0,1] op_sel_hi:[1,0,1] neg_lo:[0,0,1] neg_hi:[0,0,1]
    v_cvt_pk_bf16_f32 v132, v160, v161
    v_lshlrev_b32 v160, 16, v132
    v_and_b32 v161, s90, v132
    v_pk_add_f32 v[160:161], v[160:161], v[32:33]
    v_cvt_pk_bf16_f32 v132, v160, v161
    v_lshlrev_b32 v34, 16, v97
    v_and_b32 v35, s90, v97
    v_pk_fma_f32 v[162:163], v[34:35], v[118:119], v[118:119] op_sel:[0,0,1] op_sel_hi:[1,0,1] neg_lo:[0,0,1] neg_hi:[0,0,1]
    v_cvt_pk_bf16_f32 v133, v162, v163
    v_lshlrev_b32 v162, 16, v133
    v_and_b32 v163, s90, v133
    v_pk_add_f32 v[162:163], v[162:163], v[34:35]
    v_cvt_pk_bf16_f32 v133, v162, v163
    ds_write_b64 v68, v[132:133]
    v_lshlrev_b32 v36, 16, v98
    v_and_b32 v37, s90, v98
    v_pk_fma_f32 v[164:165], v[36:37], v[118:119], v[118:119] op_sel:[0,0,1] op_sel_hi:[1,0,1] neg_lo:[0,0,1] neg_hi:[0,0,1]
    v_cvt_pk_bf16_f32 v134, v164, v165
    v_lshlrev_b32 v164, 16, v134
    v_and_b32 v165, s90, v134
    v_pk_add_f32 v[164:165], v[164:165], v[36:37]
    v_cvt_pk_bf16_f32 v134, v164, v165
    v_lshlrev_b32 v38, 16, v99
    v_and_b32 v39, s90, v99
    v_pk_fma_f32 v[166:167], v[38:39], v[118:119], v[118:119] op_sel:[0,0,1] op_sel_hi:[1,0,1] neg_lo:[0,0,1] neg_hi:[0,0,1]
    v_cvt_pk_bf16_f32 v135, v166, v167
    v_lshlrev_b32 v166, 16, v135
    v_and_b32 v167, s90, v135
    v_pk_add_f32 v[166:167], v[166:167], v[38:39]
    v_cvt_pk_bf16_f32 v135, v166, v167
    ds_write_b64 v69, v[134:135]
    v_lshlrev_b32 v40, 16, v100
    v_and_b32 v41, s90, v100
    v_pk_fma_f32 v[168:169], v[40:41], v[118:119], v[118:119] op_sel:[0,0,1] op_sel_hi:[1,0,1] neg_lo:[0,0,1] neg_hi:[0,0,1]
    v_cvt_pk_bf16_f32 v136, v168, v169
    v_lshlrev_b32 v168, 16, v136
    v_and_b32 v169, s90, v136
    v_pk_add_f32 v[168:169], v[168:169], v[40:41]
    v_cvt_pk_bf16_f32 v136, v168, v169
    v_lshlrev_b32 v42, 16, v101
    v_and_b32 v43, s90, v101
    v_pk_fma_f32 v[170:171], v[42:43], v[118:119], v[118:119] op_sel:[0,0,1] op_sel_hi:[1,0,1] neg_lo:[0,0,1] neg_hi:[0,0,1]
    v_cvt_pk_bf16_f32 v137, v170, v171
    v_lshlrev_b32 v170, 16, v137
    v_and_b32 v171, s90, v137
    v_pk_add_f32 v[170:171], v[170:171], v[42:43]
    v_cvt_pk_bf16_f32 v137, v170, v171
    ds_write_b64 v70, v[136:137]
    v_lshlrev_b32 v44, 16, v102
    v_and_b32 v45, s90, v102
    v_pk_fma_f32 v[172:173], v[44:45], v[118:119], v[118:119] op_sel:[0,0,1] op_sel_hi:[1,0,1] neg_lo:[0,0,1] neg_hi:[0,0,1]
    v_cvt_pk_bf16_f32 v138, v172, v173
    v_lshlrev_b32 v172, 16, v138
    v_and_b32 v173, s90, v138
    v_pk_add_f32 v[172:173], v[172:173], v[44:45]
    v_cvt_pk_bf16_f32 v138, v172, v173
    v_lshlrev_b32 v46, 16, v103
    v_and_b32 v47, s90, v103
    v_pk_fma_f32 v[174:175], v[46:47], v[118:119], v[118:119] op_sel:[0,0,1] op_sel_hi:[1,0,1] neg_lo:[0,0,1] neg_hi:[0,0,1]
    v_cvt_pk_bf16_f32 v139, v174, v175
    v_lshlrev_b32 v174, 16, v139
    v_and_b32 v175, s90, v139
    v_pk_add_f32 v[174:175], v[174:175], v[46:47]
    v_cvt_pk_bf16_f32 v139, v174, v175
    ds_write_b64 v71, v[138:139]
    s_sub_u32 s77, s91, s82
    v_lshrrev_b32 v7, 3, v1
    v_sub_u32_e64 v5, s77, v7
    v_mov_b32 v6, 2146435072
    v_and_b32 v8, 7, v1
    v_lshrrev_b32 v9, 4, v1
    v_xor_b32 v8, v8, v9
    v_lshlrev_b32 v8, 4, v8
    v_lshl_add_u32 v7, v7, 11, v8
    v_xor_b32 v8, 64, v7
    s_lshl_b32 s58, s82, 11
    s_lshl_b32 s59, s98, 7
    s_add_u32 s58, s58, s59
    v_cmp_eq_u32 vcc, 0, v5
    s_nop 1
    v_cndmask_b32 v200, v7, v6, vcc
    v_cmp_eq_u32 vcc, 8, v5
    s_nop 1
    v_cndmask_b32 v201, v8, v6, vcc
    v_cmp_eq_u32 vcc, 16, v5
    s_nop 1
    v_cndmask_b32 v202, v7, v6, vcc
    v_cmp_eq_u32 vcc, 24, v5
    s_nop 1
    v_cndmask_b32 v203, v8, v6, vcc
    s_lshl_b32 s77, s62, 12
    s_add_u32 s77, s77, 0
    v_add_u32 v4, s77, v12
    s_waitcnt lgkmcnt(0)
    ds_read_b128 v[48:51], v4 offset:0
    ds_read_b128 v[52:55], v4 offset:1024
    ds_read_b128 v[56:59], v4 offset:2048
    ds_read_b128 v[60:63], v4 offset:3072
    s_waitcnt lgkmcnt(3)
    buffer_store_dwordx4 v[48:51], v200, s[44:47], s58 offen sc1
    s_add_u32 s58, s58, 16384
    s_waitcnt lgkmcnt(2)
    buffer_store_dwordx4 v[52:55], v201, s[44:47], s58 offen sc1
    s_add_u32 s58, s58, 16384
    s_waitcnt lgkmcnt(1)
    buffer_store_dwordx4 v[56:59], v202, s[44:47], s58 offen sc1
    s_add_u32 s58, s58, 16384
    s_waitcnt lgkmcnt(0)
    buffer_store_dwordx4 v[60:63], v203, s[44:47], s58 offen sc1
    s_barrier
    s_barrier
    s_branch L_cdone
L_stay_69:
    v_and_b32 v7, 15, v1
    v_lshlrev_b32_e64 v7, 3, v7
    s_cmp_eq_u32 s62, 0
    s_cbranch_scc0 L_nos4_70
    s_mul_i32 s76, s98, 9344
    s_add_u32 s76, s76, 8388608
    s_branch L_fit_s4
.fill 17, 4, 0xbf800000
L_fit_s4:
    s_add_u32 s20, s26, s99
    s_addc_u32 s21, s27, 0
    s_mov_b32 s88, 0
L_spin_71:
    s_load_dwordx16 s[4:19], s[20:21], 768 glc
    s_add_u32 s88, s88, 1
    s_cmp_lt_u32 s88, 65536
    s_cbranch_scc0 L_gate_72
    s_waitcnt lgkmcnt(0)
    s_or_b64 s[4:5], s[4:5], s[6:7]
    s_or_b64 s[4:5], s[4:5], s[8:9]
    s_or_b64 s[4:5], s[4:5], s[10:11]
    s_or_b64 s[4:5], s[4:5], s[12:13]
    s_or_b64 s[4:5], s[4:5], s[14:15]
    s_or_b64 s[4:5], s[4:5], s[16:17]
    s_or_b64 s[4:5], s[4:5], s[18:19]
    s_cbranch_scc1 L_spin_71
L_gate_72:
    s_mov_b64 s[0:1], -2
L_poll_73:
    buffer_load_dwordx2 v[196:197], v179, s[40:43], s76 offen offset:256 sc1
    buffer_load_dwordx4 v[188:191], v180, s[40:43], s76 offen offset:0 sc1
    buffer_load_dwordx4 v[192:195], v180, s[40:43], s76 offen offset:64 sc1
    s_add_u32 s1, s1, 1
    s_lshr_b32 s0, s1, 16
    s_or_b32 s0, s0, -2
    s_waitcnt vmcnt(0)
    v_max3_u32 v4, v196, v197, v188
    v_max3_u32 v4, v4, v189, v190
    v_max3_u32 v4, v4, v191, v192
    v_max3_u32 v4, v4, v193, v194
    v_max_u32 v4, v4, v195
    v_cmp_lt_u32 vcc, s0, v4
    s_cbranch_vccnz L_poll_73
    ds_write_b128 v12, v[188:191] offset:28672
    ds_write_b128 v12, v[192:195] offset:29696
    ds_write_b64 v7, v[196:197] offset:25728
L_nos4_70:
    s_waitcnt lgkmcnt(0)
    s_barrier
    ds_read_b64 v[8:9], v7 offset:25728
    s_waitcnt lgkmcnt(0)
    v_max_f32_dpp v4, v8, v8 row_ror:8 row_mask:0xf bank_mask:0xf
    s_nop 1
    v_max_f32_dpp v4, v4, v4 row_ror:4 row_mask:0xf bank_mask:0xf
    s_nop 1
    v_max_f32_dpp v4, v4, v4 row_ror:2 row_mask:0xf bank_mask:0xf
    s_nop 1
    v_max_f32_dpp v4, v4, v4 row_ror:1 row_mask:0xf bank_mask:0xf
    v_cmp_eq_f32_e64 vcc, v4, v8
    s_nop 0
    s_ff1_i32_b32 s92, vcc_lo
    s_and_b32 s92, s92, 15
    s_nop 3
    v_readlane_b32 s91, v9, s92
    s_nop 0
    s_cmp_eq_u32 s91, s79
    s_cbranch_scc0 L_noh_74
    s_mov_b32 exec_hi, 0
    buffer_store_dword v182, v177, s[40:43], s99 offen offset:128 sc1
    s_mov_b64 exec, -1
L_noh_74:
    s_sub_u32 s77, s91, s82
    v_lshrrev_b32 v7, 3, v1
    v_sub_u32 v5, s77, v7
    v_mov_b32 v6, 2146435072
    v_and_b32 v8, 7, v1
    v_lshrrev_b32 v9, 4, v1
    v_xor_b32 v8, v8, v9
    v_lshlrev_b32 v8, 4, v8
    v_lshl_add_u32 v7, v7, 11, v8
    v_xor_b32 v8, 64, v7
    s_lshl_b32 s58, s82, 11
    s_lshl_b32 s59, s98, 7
    s_add_u32 s58, s58, s59
    v_cmp_eq_u32 vcc, 0, v5
    s_nop 1
    v_cndmask_b32 v200, v7, v6, vcc
    v_cmp_eq_u32 vcc, 8, v5
    s_nop 1
    v_cndmask_b32 v201, v8, v6, vcc
    v_cmp_eq_u32 vcc, 16, v5
    s_nop 1
    v_cndmask_b32 v202, v7, v6, vcc
    v_cmp_eq_u32 vcc, 24, v5
    s_nop 1
    v_cndmask_b32 v203, v8, v6, vcc
    s_lshl_b32 s77, s62, 12
    s_add_u32 s77, s77, 0
    v_add_u32 v4, s77, v12
    v_lshlrev_b32 v24, 16, v92
    v_and_b32_e64 v25, s90, v92
    v_pk_fma_f32 v[152:153], v[24:25], v[118:119], v[118:119] op_sel:[0,0,1] op_sel_hi:[1,0,1] neg_lo:[0,0,1] neg_hi:[0,0,1]
    v_cvt_pk_bf16_f32 v128, v152, v153
    v_lshlrev_b32 v152, 16, v128
    v_and_b32 v153, s90, v128
    v_pk_add_f32 v[152:153], v[152:153], v[24:25]
    v_cvt_pk_bf16_f32 v128, v152, v153
    v_lshlrev_b32 v26, 16, v93
    v_and_b32 v27, s90, v93
    v_pk_fma_f32 v[154:155], v[26:27], v[118:119], v[118:119] op_sel:[0,0,1] op_sel_hi:[1,0,1] neg_lo:[0,0,1] neg_hi:[0,0,1]
    v_cvt_pk_bf16_f32 v129, v154, v155
    v_lshlrev_b32 v154, 16, v129
    v_and_b32 v155, s90, v129
    v_pk_add_f32 v[154:155], v[154:155], v[26:27]
    v_cvt_pk_bf16_f32 v129, v154, v155
    ds_write_b64 v66, v[128:129]
    v_lshlrev_b32 v28, 16, v94
    v_and_b32 v29, s90, v94
    v_pk_fma_f32 v[156:157], v[28:29], v[118:119], v[118:119] op_sel:[0,0,1] op_sel_hi:[1,0,1] neg_lo:[0,0,1] neg_hi:[0,0,1]
    v_cvt_pk_bf16_f32 v130, v156, v157
    v_lshlrev_b32 v156, 16, v130
    v_and_b32 v157, s90, v130
    v_pk_add_f32 v[156:157], v[156:157], v[28:29]
    v_cvt_pk_bf16_f32 v130, v156, v157
    v_lshlrev_b32 v30, 16, v95
    v_and_b32 v31, s90, v95
    v_pk_fma_f32 v[158:159], v[30:31], v[118:119], v[118:119] op_sel:[0,0,1] op_sel_hi:[1,0,1] neg_lo:[0,0,1] neg_hi:[0,0,1]
    v_cvt_pk_bf16_f32 v131, v158, v159
    v_lshlrev_b32 v158, 16, v131
    v_and_b32 v159, s90, v131
    v_pk_add_f32 v[158:159], v[158:159], v[30:31]
    v_cvt_pk_bf16_f32 v131, v158, v159
    ds_write_b64 v67, v[130:131]
    v_lshlrev_b32 v32, 16, v96
    v_and_b32 v33, s90, v96
    v_pk_fma_f32 v[160:161], v[32:33], v[118:119], v[118:119] op_sel:[0,0,1] op_sel_hi:[1,0,1] neg_lo:[0,0,1] neg_hi:[0,0,1]
    v_cvt_pk_bf16_f32 v132, v160, v161
    v_lshlrev_b32 v160, 16, v132
    v_and_b32 v161, s90, v132
    v_pk_add_f32 v[160:161], v[160:161], v[32:33]
    v_cvt_pk_bf16_f32 v132, v160, v161
    v_lshlrev_b32 v34, 16, v97
    v_and_b32 v35, s90, v97
    v_pk_fma_f32 v[162:163], v[34:35], v[118:119], v[118:119] op_sel:[0,0,1] op_sel_hi:[1,0,1] neg_lo:[0,0,1] neg_hi:[0,0,1]
    v_cvt_pk_bf16_f32 v133, v162, v163
    v_lshlrev_b32 v162, 16, v133
    v_and_b32 v163, s90, v133
    v_pk_add_f32 v[162:163], v[162:163], v[34:35]
    v_cvt_pk_bf16_f32 v133, v162, v163
    ds_write_b64 v68, v[132:133]
    v_lshlrev_b32 v36, 16, v98
    v_and_b32 v37, s90, v98
    v_pk_fma_f32 v[164:165], v[36:37], v[118:119], v[118:119] op_sel:[0,0,1] op_sel_hi:[1,0,1] neg_lo:[0,0,1] neg_hi:[0,0,1]
    v_cvt_pk_bf16_f32 v134, v164, v165
    v_lshlrev_b32 v164, 16, v134
    v_and_b32 v165, s90, v134
    v_pk_add_f32 v[164:165], v[164:165], v[36:37]
    v_cvt_pk_bf16_f32 v134, v164, v165
    v_lshlrev_b32 v38, 16, v99
    v_and_b32 v39, s90, v99
    v_pk_fma_f32 v[166:167], v[38:39], v[118:119], v[118:119] op_sel:[0,0,1] op_sel_hi:[1,0,1] neg_lo:[0,0,1] neg_hi:[0,0,1]
    v_cvt_pk_bf16_f32 v135, v166, v167
    v_lshlrev_b32 v166, 16, v135
    v_and_b32 v167, s90, v135
    v_pk_add_f32 v[166:167], v[166:167], v[38:39]
    v_cvt_pk_bf16_f32 v135, v166, v167
    ds_write_b64 v69, v[134:135]
    v_lshlrev_b32 v40, 16, v100
    v_and_b32 v41, s90, v100
    v_pk_fma_f32 v[168:169], v[40:41], v[118:119], v[118:119] op_sel:[0,0,1] op_sel_hi:[1,0,1] neg_lo:[0,0,1] neg_hi:[0,0,1]
    v_cvt_pk_bf16_f32 v136, v168, v169
    v_lshlrev_b32 v168, 16, v136
    v_and_b32 v169, s90, v136
    v_pk_add_f32 v[168:169], v[168:169], v[40:41]
    v_cvt_pk_bf16_f32 v136, v168, v169
    v_lshlrev_b32 v42, 16, v101
    v_and_b32 v43, s90, v101
    v_pk_fma_f32 v[170:171], v[42:43], v[118:119], v[118:119] op_sel:[0,0,1] op_sel_hi:[1,0,1] neg_lo:[0,0,1] neg_hi:[0,0,1]
    v_cvt_pk_bf16_f32 v137, v170, v171
    v_lshlrev_b32 v170, 16, v137
    v_and_b32 v171, s90, v137
    v_pk_add_f32 v[170:171], v[170:171], v[42:43]
    v_cvt_pk_bf16_f32 v137, v170, v171
    ds_write_b64 v70, v[136:137]
    v_lshlrev_b32 v44, 16, v102
    v_and_b32 v45, s90, v102
    v_pk_fma_f32 v[172:173], v[44:45], v[118:119], v[118:119] op_sel:[0,0,1] op_sel_hi:[1,0,1] neg_lo:[0,0,1] neg_hi:[0,0,1]
    v_cvt_pk_bf16_f32 v138, v172, v173
    v_lshlrev_b32 v172, 16, v138
    v_and_b32 v173, s90, v138
    v_pk_add_f32 v[172:173], v[172:173], v[44:45]
    v_cvt_pk_bf16_f32 v138, v172, v173
    v_lshlrev_b32 v46, 16, v103
    v_and_b32 v47, s90, v103
    v_pk_fma_f32 v[174:175], v[46:47], v[118:119], v[118:119] op_sel:[0,0,1] op_sel_hi:[1,0,1] neg_lo:[0,0,1] neg_hi:[0,0,1]
    v_cvt_pk_bf16_f32 v139, v174, v175
    v_lshlrev_b32 v174, 16, v139
    v_and_b32 v175, s90, v139
    v_pk_add_f32 v[174:175], v[174:175], v[46:47]
    v_cvt_pk_bf16_f32 v139, v174, v175
    ds_write_b64 v71, v[138:139]
    s_barrier
    s_waitcnt lgkmcnt(0)
    ds_read_b128 v[48:51], v4 offset:0
    ds_read_b128 v[52:55], v4 offset:1024
    ds_read_b128 v[56:59], v4 offset:2048
    ds_read_b128 v[60:63], v4 offset:3072
    s_waitcnt lgkmcnt(3)
    buffer_store_dwordx4 v[48:51], v200, s[44:47], s58 offen sc1
    s_add_u32 s58, s58, 16384
    s_waitcnt lgkmcnt(2)
    buffer_store_dwordx4 v[52:55], v201, s[44:47], s58 offen sc1
    s_add_u32 s58, s58, 16384
    s_waitcnt lgkmcnt(1)
    buffer_store_dwordx4 v[56:59], v202, s[44:47], s58 offen sc1
    s_add_u32 s58, s58, 16384
    s_waitcnt lgkmcnt(0)
    buffer_store_dwordx4 v[60:63], v203, s[44:47], s58 offen sc1
L_cdone:
L_cfin:
L_end:
    s_endpgm
L_tr0:
    s_mov_b32 s88, 0
L_trq:
    ds_read_b32 v79, v8 offset:25984
    s_waitcnt lgkmcnt(0)
    v_readfirstlane_b32 s76, v79
    s_nop 0
    s_and_b32 s76, s76, s52
    s_cbranch_scc1 L_bk0
    s_add_u32 s88, s88, 1
    s_cmp_lt_u32 s88, 5
    s_cbranch_scc1 L_trq
    s_cmp_eq_u32 s53, 0
    s_cbranch_scc0 L_sent_53
    s_waitcnt vmcnt(0)
    s_mov_b64 exec, 1
    ds_add_u32 v8, v74 offset:25988
    s_mov_b64 exec, -1
    s_mov_b32 s53, 1
L_sent_53:
    s_call_b64 s[54:55], L_stall
    s_branch L_bk0
L_tr1:
    s_cmp_eq_u32 s53, 0
    s_cbranch_scc0 L_sent_54
    s_waitcnt vmcnt(4)
    s_mov_b64 exec, 1
    ds_add_u32 v8, v74 offset:25988
    s_mov_b64 exec, -1
    s_mov_b32 s53, 1
L_sent_54:
    s_call_b64 s[54:55], L_stall
    s_branch L_bk1
L_tr2:
    s_call_b64 s[54:55], L_stall
    s_branch L_bk2
L_tr3:
    s_call_b64 s[54:55], L_stall
    s_branch L_bk3
L_tr4:
    s_call_b64 s[54:55], L_stall
    s_branch L_bk4
L_tr5:
    s_call_b64 s[54:55], L_stall
    s_branch L_bk5
L_tr6:
    s_call_b64 s[54:55], L_stall
    s_branch L_bk6
L_tr7:
    s_call_b64 s[54:55], L_stall
    s_branch L_bk7
L_tr8:
    s_call_b64 s[54:55], L_stall
    s_branch L_bk8
L_tr9:
    s_call_b64 s[54:55], L_stall
    s_branch L_bk9
L_tr10:
    s_call_b64 s[54:55], L_stall
    s_branch L_bk10
L_tr11:
    s_call_b64 s[54:55], L_stall
    s_branch L_bk11
L_tr12:
    s_call_b64 s[54:55], L_stall
    s_branch L_bk12
L_tr13:
    s_call_b64 s[54:55], L_stall
    s_branch L_bk13
L_tr14:
    s_call_b64 s[54:55], L_stall
    s_branch L_bk14
L_tr15:
    s_call_b64 s[54:55], L_stall
    s_branch L_bk15
L_stall:
    s_cmp_eq_u32 s53, 0
    s_cbranch_scc0 L_sent_52
    s_waitcnt vmcnt(0)
    s_mov_b64 exec, 1
    ds_add_u32 v8, v74 offset:25988
    s_mov_b64 exec, -1
    s_mov_b32 s53, 1
L_sent_52:
    s_mov_b32 s88, 0
L_stall1:
    ds_read_b32 v79, v8 offset:25984
    s_waitcnt lgkmcnt(0)
    v_readfirstlane_b32 s76, v79
    s_nop 0
    s_and_b32 s76, s76, s52
    s_cbranch_scc1 L_stall2
    s_add_u32 s88, s88, 1
    s_cmp_lt_u32 s88, 1048576
    s_cbranch_scc1 L_stall1
    s_mov_b32 s76, s52
L_stall2:
    s_setpc_b64 s[54:55]
L_s3_58:
    v_cmp_eq_u32 vcc, -1, v115
    s_cbranch_vccz L_s3skip_60
    buffer_load_dwordx4 v[112:115], v178, s[40:43], s78 offen offset:1024 sc1
L_s3skip_60:
    v_cmp_eq_u32 vcc, -1, v119
    s_cbranch_vccz L_s3skip_61
    buffer_load_dwordx4 v[116:119], v178, s[40:43], s48 offen offset:1024 sc1
L_s3skip_61:
    v_cmp_eq_u32 vcc, -1, v123
    s_cbranch_vccz L_s3skip_62
    buffer_load_dwordx4 v[120:123], v178, s[40:43], s49 offen offset:1024 sc1
L_s3skip_62:
    v_cmp_eq_u32 vcc, -1, v127
    s_cbranch_vccz L_s3skip_63
    buffer_load_dwordx4 v[124:127], v178, s[40:43], s50 offen offset:1024 sc1
L_s3skip_63:
    v_cmp_eq_u32 vcc, -1, v131
    s_cbranch_vccz L_s3skip_64
    buffer_load_dwordx4 v[128:131], v178, s[40:43], s51 offen offset:1024 sc1
L_s3skip_64:
    v_cmp_eq_u32 vcc, -1, v135
    s_cbranch_vccz L_s3skip_65
    buffer_load_dwordx4 v[132:135], v178, s[40:43], s52 offen offset:1024 sc1
L_s3skip_65:
    v_cmp_eq_u32 vcc, -1, v139
    s_cbranch_vccz L_s3skip_66
    buffer_load_dwordx4 v[136:139], v178, s[40:43], s53 offen offset:1024 sc1
L_s3skip_66:
    v_cmp_eq_u32 vcc, -1, v143
    s_cbranch_vccz L_s3skip_67
    buffer_load_dwordx4 v[140:143], v178, s[40:43], s54 offen offset:1024 sc1
L_s3skip_67:
    s_waitcnt vmcnt(0)
    v_pk_add_f32 v[108:109], v[112:113], v[116:117]
    v_pk_add_f32 v[110:111], v[114:115], v[118:119]
    v_pk_add_f32 v[108:109], v[108:109], v[120:121]
    v_pk_add_f32 v[110:111], v[110:111], v[122:123]
    v_pk_add_f32 v[108:109], v[108:109], v[124:125]
    v_pk_add_f32 v[110:111], v[110:111], v[126:127]
    v_pk_add_f32 v[108:109], v[108:109], v[128:129]
    v_pk_add_f32 v[110:111], v[110:111], v[130:131]
    v_pk_add_f32 v[108:109], v[108:109], v[132:133]
    v_pk_add_f32 v[110:111], v[110:111], v[134:135]
    v_pk_add_f32 v[108:109], v[108:109], v[136:137]
    v_pk_add_f32 v[110:111], v[110:111], v[138:139]
    v_pk_add_f32 v[108:109], v[108:109], v[140:141]
    v_pk_add_f32 v[110:111], v[110:111], v[142:143]
    v_cmp_u_f32 vcc, v111, v111
    v_mov_b32 v4, v108
    v_mov_b32 v5, v109
    v_mov_b32_e64 v6, v110
    s_cbranch_vccz L_s3ok_59
    s_add_u32 s88, s88, 1
    s_cmp_lt_u32 s88, 65536
    s_cbranch_scc1 L_s3_58
    s_branch L_s3ok_59
L_loc_7:
    buffer_store_dwordx4 v[28:31], v12, s[40:43], s79 offen offset:1024 sc1
    buffer_store_dwordx4 v[28:31], v12, s[40:43], s79 offen offset:2048 sc1
    s_branch L_pubd_8
L_loc_9:
    buffer_store_dword v4, v4, s[40:43], s76 offen offset:2560 sc1
    s_branch L_pubd_10
L_loc_14:
    buffer_store_dword v48, v67, s[40:43], s83 offen offset:3072 sc1
    s_branch L_pubd_15
L_loc_24:
    buffer_store_dwordx4 v[28:31], v12, s[40:43], s79 offen offset:1024 sc1
    buffer_store_dwordx4 v[28:31], v12, s[40:43], s79 offen offset:2048 sc1
    s_branch L_pubd_25
L_loc_26:
    buffer_store_byte v28, v70, s[40:43], s78 offen sc1
    s_branch L_pubd_27
L_loc_32:
    buffer_store_dwordx4 v[64:67], v16, s[40:43], s76 offen offset:3072 sc1
    buffer_store_dwordx4 v[68:71], v16, s[40:43], s76 offen offset:3088 sc1
    s_branch L_pubd_33
L_loc_35:
    s_nop 0
    buffer_store_dwordx4 v[20:23], v17, s[40:43], s85 offen sc1
    s_branch L_pubd_36
L_loc_45:
    buffer_store_dwordx4 v[64:67], v12, s[40:43], s76 offen offset:0 sc1
    buffer_store_dwordx4 v[68:71], v12, s[40:43], s76 offen offset:1024 sc1
    s_branch L_pubd_46
L_loc_47:
    buffer_store_dword v72, v4, s[40:43], s77 offen offset:2048 sc1
    s_branch L_pubd_48
L_loc_55:
    buffer_store_dwordx4 v[104:107], v12, s[40:43], s77 offen offset:1024 sc1
    s_branch L_pubd_56
L_code_end:
s_endpgm
.p2align 7
.type L_table,@object
L_table:
.long 0x650c3824, 0xfedba97, 0x50110, 0x3006
.long 0x650c3824, 0xfedba97, 0x520200, 0x3060
.long 0x641d0935, 0xfecba87, 0x5000011, 0x3600
.long 0x76543218, 0xfedcba9, 0x15000010, 0x6300
.long 0x641d0935, 0xfecba87, 0x25200, 0x3006
.long 0x54e2a160, 0xfdcb987, 0x501001, 0x3060
.long 0x54e2a160, 0xfdcb987, 0x5000022, 0x3600
.long 0x54f3b271, 0xedca986, 0x50101000, 0x6300
.long 0x54f3b271, 0xedca986, 0x250020, 0x3006
.long 0x650c3824, 0xfedba97, 0x510001, 0x3060
.long 0x650c3824, 0xfedba97, 0x5000202, 0x3600
.long 0x76543218, 0xfedcba9, 0x50000202, 0x6300
.long 0x641d0935, 0xfecba87, 0x15100, 0x3006
.long 0x641d0935, 0xfecba87, 0x500022, 0x3060
.long 0x54e2a160, 0xfdcb987, 0x5100010, 0x3600
.long 0x54e2a160, 0xfdcb987, 0x50202000, 0x6300
.long 0x641d0935, 0xfecba87, 0x500011, 0x3060
.long 0x641d0935, 0xfecba87, 0x5020020, 0x3600
.long 0x54e2a160, 0xfdcb987, 0x50001010, 0x6300
.long 0x76543209, 0xfedcba8, 0x15010, 0x3006
.long 0x54e2a160, 0xfdcb987, 0x500022, 0x3060
.long 0x54f3b271, 0xedca986, 0x5100001, 0x3600
.long 0x54f3b271, 0xedca986, 0x50002020, 0x6300
.long 0x650c3824, 0xfedba97, 0x15100, 0x3006
.long 0x650c3824, 0xfedba97, 0x520020, 0x3060
.long 0x641d0935, 0xfecba87, 0x5010100, 0x3600
.long 0x641d0935, 0xfecba87, 0x50020200, 0x6300
.long 0x76543209, 0xfedcba8, 0x250002, 0x3006
.long 0x54e2a160, 0xfdcb987, 0x5110000, 0x3060
.long 0x54e2a160, 0xfdcb987, 0x5200002, 0x3600
.long 0x54f3b271, 0xedca986, 0x50001010, 0x6300
.long 0x54f3b271, 0xedca986, 0x52020, 0x3006
.long 0x54e2a160, 0xfdcb987, 0x5100100, 0x3600
.long 0x54e2a160, 0xfdcb987, 0x50002002, 0x6300
.long 0x54f3b271, 0xedca986, 0x150010, 0x3006
.long 0x765431a0, 0xfedcb98, 0x150001, 0x3060
.long 0x54f3b271, 0xedca986, 0x5000022, 0x3600
.long 0x650c3824, 0xfedba97, 0x50000101, 0x6300
.long 0x650c3824, 0xfedba97, 0x50220, 0x3006
.long 0x641d0935, 0xfecba87, 0x510100, 0x3060
.long 0x641d0935, 0xfecba87, 0x5000022, 0x3600
.long 0x54e2a160, 0xfdcb987, 0x50001010, 0x6300
.long 0x54e2a160, 0xfdcb987, 0x250002, 0x3006
.long 0x765431a0, 0xfedcb98, 0x500220, 0x3060
.long 0x54f3b271, 0xedca986, 0x5001100, 0x3600
.long 0x54f3b271, 0xedca986, 0x50000022, 0x6300
.long 0x650c3824, 0xfedba97, 0x511000, 0x3006
.long 0x650c3824, 0xfedba97, 0x520002, 0x3060
.long 0x54f3b271, 0xedca986, 0x50100001, 0x6300
.long 0x54f3b271, 0xedca986, 0x52002, 0x3006
.long 0x650c3824, 0xfedba97, 0x500101, 0x3060
.long 0x765421b0, 0xfedca98, 0x1500001, 0x3600
.long 0x650c3824, 0xfedba97, 0x50000022, 0x6300
.long 0x641d0935, 0xfecba87, 0x15100, 0x3006
.long 0x641d0935, 0xfecba87, 0x520020, 0x3060
.long 0x54e2a160, 0xfdcb987, 0x5101000, 0x3600
.long 0x54e2a160, 0xfdcb987, 0x50002020, 0x6300
.long 0x54f3b271, 0xedca986, 0x51010, 0x3006
.long 0x54f3b271, 0xedca986, 0x250020, 0x3060
.long 0x765421b0, 0xfedca98, 0x5000022, 0x3600
.long 0x650c3824, 0xfedba97, 0x50010010, 0x6300
.long 0x650c3824, 0xfedba97, 0x25200, 0x3006
.long 0x641d0935, 0xfecba87, 0x500011, 0x3060
.long 0x641d0935, 0xfecba87, 0x5020200, 0x3600
.long 0x650c3824, 0xfedba97, 0x51010, 0x3006
.long 0x650c3824, 0xfedba97, 0x500022, 0x3060
.long 0x641d0935, 0xfecba87, 0x5100100, 0x3600
.long 0x76532c10, 0xfedba98, 0x15000100, 0x6300
.long 0x641d0935, 0xfecba87, 0x50022, 0x3006
.long 0x54e2a160, 0xfdcb987, 0x150010, 0x3060
.long 0x54e2a160, 0xfdcb987, 0x5202000, 0x3600
.long 0x54f3b271, 0xedca986, 0x50101000, 0x6300
.long 0x54f3b271, 0xedca986, 0x52002, 0x3006
.long 0x650c3824, 0xfedba97, 0x500101, 0x3060
.long 0x650c3824, 0xfedba97, 0x5020020, 0x3600
.long 0x76532c10, 0xfedba98, 0x52000200, 0x6300
.long 0x641d0935, 0xfecba87, 0x15001, 0x3006
.long 0x641d0935, 0xfecba87, 0x520200, 0x3060
.long 0x54e2a160, 0xfdcb987, 0x5001001, 0x3600
.long 0x54e2a160, 0xfdcb987, 0x50000022, 0x6300
.long 0x641d0935, 0xfecba87, 0x501001, 0x3060
.long 0x641d0935, 0xfecba87, 0x5000202, 0x3600
.long 0x54e2a160, 0xfdcb987, 0x50100100, 0x6300
.long 0x76432d10, 0xfecba98, 0x150100, 0x3006
.long 0x54e2a160, 0xfdcb987, 0x252000, 0x3060
.long 0x54f3b271, 0xedca986, 0x5101000, 0x3600
.long 0x54f3b271, 0xedca986, 0x50200002, 0x6300
.long 0x650c3824, 0xfedba97, 0x15100, 0x3006
.long 0x650c3824, 0xfedba97, 0x500202, 0x3060
.long 0x641d0935, 0xfecba87, 0x5000110, 0x3600
.long 0x641d0935, 0xfecba87, 0x50000022, 0x6300
.long 0x76432d10, 0xfecba98, 0x20050200, 0x3006
.long 0x54e2a160, 0xfdcb987, 0x501010, 0x3060
.long 0x54e2a160, 0xfdcb987, 0x5002020, 0x3600
.long 0x54f3b271, 0xedca986, 0x50000110, 0x6300
.long 0x54f3b271, 0xedca986, 0x250002, 0x3006
.long 0x54e2a160, 0xfdcb987, 0x5000011, 0x3600
.long 0x54e2a160, 0xfdcb987, 0x50200020, 0x6300
.long 0x54f3b271, 0xedca986, 0x115000, 0x3006
.long 0x7543e210, 0xfdcba98, 0x501010, 0x3060
.long 0x54f3b271, 0xedca986, 0x5202000, 0x3600
.long 0x650c3824, 0xfedba97, 0x51000001, 0x6300
.long 0x650c3824, 0xfedba97, 0x25002, 0x3006
.long 0x641d0935, 0xfecba87, 0x510100, 0x3060
.long 0x641d0935, 0xfecba87, 0x5020200, 0x3600
.long 0x54e2a160, 0xfdcb987, 0x50011000, 0x6300
.long 0x54e2a160, 0xfdcb987, 0x52020, 0x3006
.long 0x7543e210, 0xfdcba98, 0x522000, 0x3060
.long 0x54f3b271, 0xedca986, 0x5001010, 0x3600
.long 0x54f3b271, 0xedca986, 0x50202000, 0x6300
.long 0x650c3824, 0xfedba97, 0x15100, 0x3006
.long 0x650c3824, 0xfedba97, 0x500220, 0x3060
.long 0x54f3b271, 0xedca986, 0x50001010, 0x6300
.long 0x54f3b271, 0xedca986, 0x250020, 0x3006
.long 0x650c3824, 0xfedba97, 0x500110, 0x3060
.long 0x6543f210, 0xedcba98, 0x15000001, 0x3600
.long 0x650c3824, 0xfedba97, 0x50020200, 0x6300
.long 0x641d0935, 0xfecba87, 0x15001, 0x3006
.long 0x641d0935, 0xfecba87, 0x500202, 0x3060
.long 0x54e2a160, 0xfdcb987, 0x5101000, 0x3600
.long 0x54e2a160, 0xfdcb987, 0x50200002, 0x6300
.long 0x54f3b271, 0xedca986, 0x150001, 0x3006
.long 0x54f3b271, 0xedca986, 0x502002, 0x3060
.long 0x6543f210, 0xedcba98, 0x5202000, 0x3600
.long 0x650c3824, 0xfedba97, 0x50010001, 0x6300
.long 0x650c3824, 0xfedba97, 0x50022, 0x3006
.long 0x641d0935, 0xfecba87, 0x500110, 0x3060
.long 0x641d0935, 0xfecba87, 0x5000022, 0x3600
.long 0x650c3824, 0xfedba97, 0x25002, 0x3006
.long 0x650c3824, 0xfedba97, 0x510010, 0x3060
.long 0x641d0935, 0xfecba87, 0x5020200, 0x3600
.long 0x76543218, 0xfedcba9, 0x50000022, 0x6300
.long 0x641d0935, 0xfecba87, 0x50110, 0x3006
.long 0x54e2a160, 0xfdcb987, 0x250002, 0x3060
.long 0x54e2a160, 0xfdcb987, 0x5101000, 0x3600
.long 0x54f3b271, 0xedca986, 0x50002002, 0x6300
.long 0x54f3b271, 0xedca986, 0x151000, 0x3006
.long 0x650c3824, 0xfedba97, 0x520020, 0x3060
.long 0x650c3824, 0xfedba97, 0x5000101, 0x3600
.long 0x76543218, 0xfedcba9, 0x15000010, 0x6300
.long 0x641d0935, 0xfecba87, 0x25200, 0x3006
.long 0x641d0935, 0xfecba87, 0x510001, 0x3060
.long 0x54e2a160, 0xfdcb987, 0x5000022, 0x3600
.long 0x54e2a160, 0xfdcb987, 0x50000011, 0x6300
.long 0x641d0935, 0xfecba87, 0x500022, 0x3060
.long 0x641d0935, 0xfecba87, 0x5000011, 0x3600
.long 0x54e2a160, 0xfdcb987, 0x50000022, 0x6300
.long 0x76543209, 0xfedcba8, 0x52002, 0x3006
.long 0x54e2a160, 0xfdcb987, 0x501010, 0x3060
.long 0x54f3b271, 0xedca986, 0x5002020, 0x3600
.long 0x54f3b271, 0xedca986, 0x50000011, 0x6300
.long 0x650c3824, 0xfedba97, 0x25020, 0x3006
.long 0x650c3824, 0xfedba97, 0x510100, 0x3060
.long 0x641d0935, 0xfecba87, 0x5000220, 0x3600
.long 0x641d0935, 0xfecba87, 0x50010100, 0x6300
.long 0x76543209, 0xfedcba8, 0x15100, 0x3006
.long 0x54e2a160, 0xfdcb987, 0x252000, 0x3060
.long 0x54e2a160, 0xfdcb987, 0x5100001, 0x3600
.long 0x54f3b271, 0xedca986, 0x50200020, 0x6300
.long 0x54f3b271, 0xedca986, 0x151000, 0x3006
.long 0x54e2a160, 0xfdcb987, 0x5200002, 0x3600
.long 0x54e2a160, 0xfdcb987, 0x50100100, 0x6300
.long 0x54f3b271, 0xedca986, 0x250002, 0x3006
.long 0x765431a0, 0xfedcb98, 0x520020, 0x3060
.long 0x54f3b271, 0xedca986, 0x5001010, 0x3600
.long 0x650c3824, 0xfedba97, 0x50020200, 0x6300
.long 0x650c3824, 0xfedba97, 0x50101, 0x3006
.long 0x641d0935, 0xfecba87, 0x520200, 0x3060
.long 0x641d0935, 0xfecba87, 0x5010100, 0x3600
.long 0x54e2a160, 0xfdcb987, 0x50202000, 0x6300
.long 0x54e2a160, 0xfdcb987, 0x50011, 0x3006
.long 0x765431a0, 0xfedcb98, 0x150010, 0x3060
.long 0x54f3b271, 0xedca986, 0x5200020, 0x3600
.long 0x54f3b271, 0xedca986, 0x50100100, 0x6300
.long 0x650c3824, 0xfedba97, 0x25002, 0x3006
.long 0x650c3824, 0xfedba97, 0x511000, 0x3060
.long 0x54f3b271, 0xedca986, 0x50002002, 0x6300
.long 0x54f3b271, 0xedca986, 0x150010, 0x3006
.long 0x650c3824, 0xfedba97, 0x520200, 0x3060
.long 0x765421b0, 0xfedca98, 0x25000020, 0x3600
.long 0x650c3824, 0xfedba97, 0x50000101, 0x6300
.long 0x641d0935, 0xfecba87, 0x50022, 0x3006
.long 0x641d0935, 0xfecba87, 0x510001, 0x3060
.long 0x54e2a160, 0xfdcb987, 0x5200020, 0x3600
.long 0x54e2a160, 0xfdcb987, 0x50101000, 0x6300
.long 0x54f3b271, 0xedca986, 0x50022, 0x3006
.long 0x54f3b271, 0xedca986, 0x500101, 0x3060
.long 0x765421b0, 0xfedca98, 0x1500010, 0x3600
.long 0x650c3824, 0xfedba97, 0x50000022, 0x6300
.long 0x650c3824, 0xfedba97, 0x511000, 0x3006
.long 0x641d0935, 0xfecba87, 0x520200, 0x3060
.long 0x641d0935, 0xfecba87, 0x5001100, 0x3600
.long 0x650c3824, 0xfedba97, 0x50220, 0x3006
.long 0x650c3824, 0xfedba97, 0x500101, 0x3060
.long 0x641d0935, 0xfecba87, 0x5000022, 0x3600
.long 0x76532c10, 0xfedba98, 0x50000202, 0x6300
.long 0x641d0935, 0xfecba87, 0x50101, 0x3006
.long 0x54e2a160, 0xfdcb987, 0x502020, 0x3060
.long 0x54e2a160, 0xfdcb987, 0x5101000, 0x3600
.long 0x54f3b271, 0xedca986, 0x50200020, 0x6300
.long 0x54f3b271, 0xedca986, 0x151000, 0x3006
.long 0x650c3824, 0xfedba97, 0x500202, 0x3060
.long 0x650c3824, 0xfedba97, 0x5010010, 0x3600
.long 0x76532c10, 0xfedba98, 0x15000001, 0x6300
.long 0x641d0935, 0xfecba87, 0x50022, 0x3006
.long 0x641d0935, 0xfecba87, 0x510010, 0x3060
.long 0x54e2a160, 0xfdcb987, 0x5202000, 0x3600
.long 0x54e2a160, 0xfdcb987, 0x50000110, 0x6300
.long 0x641d0935, 0xfecba87, 0x520200, 0x3060
.long 0x641d0935, 0xfecba87, 0x5000110, 0x3600
.long 0x54e2a160, 0xfdcb987, 0x50202000, 0x6300
.long 0x76432d10, 0xfecba98, 0x52200, 0x3006
.long 0x54e2a160, 0xfdcb987, 0x151000, 0x3060
.long 0x54f3b271, 0xedca986, 0x5200002, 0x3600
.long 0x54f3b271, 0xedca986, 0x50100100, 0x6300
.long 0x650c3824, 0xfedba97, 0x50202, 0x3006
.long 0x650c3824, 0xfedba97, 0x510100, 0x3060
.long 0x641d0935, 0xfecba87, 0x5020002, 0x3600
.long 0x641d0935, 0xfecba87, 0x50010001, 0x6300
.long 0x76432d10, 0xfecba98, 0x150010, 0x3006
.long 0x54e2a160, 0xfdcb987, 0x500022, 0x3060
.long 0x54e2a160, 0xfdcb987, 0x5000011, 0x3600
.long 0x54f3b271, 0xedca986, 0x50002002, 0x6300
.long 0x54f3b271, 0xedca986, 0x51010, 0x3006
.long 0x54e2a160, 0xfdcb987, 0x5002020, 0x3600
.long 0x54e2a160, 0xfdcb987, 0x50101000, 0x6300
.long 0x54f3b271, 0xedca986, 0x52020, 0x3006
.long 0x7543e210, 0xfdcba98, 0x2502000, 0x3060
.long 0x54f3b271, 0xedca986, 0x5001010, 0x3600
.long 0x650c3824, 0xfedba97, 0x50000022, 0x6300
.long 0x650c3824, 0xfedba97, 0x15100, 0x3006
.long 0x641d0935, 0xfecba87, 0x500022, 0x3060
.long 0x641d0935, 0xfecba87, 0x5010100, 0x3600
.long 0x54e2a160, 0xfdcb987, 0x50000022, 0x6300
.long 0x54e2a160, 0xfdcb987, 0x50011, 0x3006
.long 0x7543e210, 0xfdcba98, 0x1500010, 0x3060
.long 0x54f3b271, 0xedca986, 0x5002002, 0x3600
.long 0x54f3b271, 0xedca986, 0x50110000, 0x6300
.long 0x650c3824, 0xfedba97, 0x50220, 0x3006
.long 0x650c3824, 0xfedba97, 0x500011, 0x3060
.long 0x54f3b271, 0xedca986, 0x50200020, 0x6300
.long 0x54f3b271, 0xedca986, 0x15010, 0x3006
.long 0x650c3824, 0xfedba97, 0x500022, 0x3060
.long 0x6543f210, 0xedcba98, 0x25002000, 0x3600
.long 0x650c3824, 0xfedba97, 0x50000101, 0x6300
.long 0x641d0935, 0xfecba87, 0x25200, 0x3006
.long 0x641d0935, 0xfecba87, 0x511000, 0x3060
.long 0x54e2a160, 0xfdcb987, 0x5002002, 0x3600
.long 0x54e2a160, 0xfdcb987, 0x50101000, 0x6300
.long 0x54f3b271, 0xedca986, 0x252000, 0x3006
.long 0x54f3b271, 0xedca986, 0x501001, 0x3060
.long 0x6543f210, 0xedcba98, 0x15001000, 0x3600
.long 0x650c3824, 0xfedba97, 0x50020200, 0x6300
.long 0x650c3824, 0xfedba97, 0x15010, 0x3006
.long 0x641d0935, 0xfecba87, 0x500022, 0x3060
.long 0x641d0935, 0xfecba87, 0x5000101, 0x3600
.fill 1, 4, 0
.size L_table, .-L_table
.section .rodata,"a"
.p2align 6
.amdhsa_kernel sequential_preLN__linear_kernel_hedgehog__moe_arch_mod__prompt_kernel
  .amdhsa_next_free_vgpr 256
  .amdhsa_next_free_sgpr 102
  .amdhsa_accum_offset 256
  .amdhsa_group_segment_fixed_size 0
  .amdhsa_kernarg_size 96
  .amdhsa_user_sgpr_count 2
  .amdhsa_user_sgpr_kernarg_segment_ptr 1
  .amdhsa_system_sgpr_workgroup_id_x 1
  .amdhsa_float_denorm_mode_32 3
.end_amdhsa_kernel
```
